```python
import torch

def _softmax(x, axis=-1):
    return torch.softmax(x, dim=axis)
def _gelu(x):
    return torch.nn.functional.gelu(x, approximate="tanh")
def _silu(x):
    return torch.nn.functional.silu(x)
def _sigmoid(x):
    return torch.sigmoid(x)
def _layernorm(x, axis=-1, eps=1e-5):
    m = x.mean(dim=axis, keepdim=True)
    v = x.var(dim=axis, keepdim=True, unbiased=False)
    return (x - m) / torch.sqrt(v + eps)
def _scatter_add(tgt, idx, src, axis=0):
    return tgt.clone().index_add_(axis, idx, src)
def _segment_sum(src, seg, n):
    out = torch.zeros((n,) + src.shape[1:], dtype=src.dtype)
    return out.index_add_(0, seg, src)
def _pad(x, pw):
    flat = tuple(v for pair in reversed(pw) for v in pair)
    return torch.nn.functional.pad(x, flat)

kernel_name = 'recurrent_scan__linear_kernel_hedgehog__moe_arch_mod__prompt'

def setup_inputs():

    _w = (lambda a: (lambda t: t.to(torch.bfloat16) if t.is_floating_point() else t)(torch.as_tensor(a)))
    def _A_setup():
        B, S, D, H = 1, 2048, 1024, 32
        Dh = D // H
        return {
            "x": _w((lambda *s: torch.randn(*s, dtype=torch.bfloat16) * 0.05)(B, S, D)),
            "wqkv": _w((lambda *s: torch.randn(*s, dtype=torch.bfloat16) * 0.2)(D, 3 * D)),
            "w_phi": _w((lambda *s: torch.randn(*s, dtype=torch.bfloat16) * 0.2)(H, Dh, Dh) * (Dh ** -0.5)),
            "wo": _w((lambda *s: torch.randn(*s, dtype=torch.bfloat16) * 0.05)(D, D)),
        }
    _A_in = _A_setup()

    def _B_setup():
        B, S, D, F, C = 1, 2048, 1024, 3584, 1
        return {
            "x": _w((lambda *s: torch.randn(*s, dtype=torch.bfloat16) * 0.05)(B, S, D)),
            "w_r": _w((lambda *s: torch.randn(*s, dtype=torch.bfloat16) * 0.05)(D)),
            "w_gate": _w((lambda *s: torch.randn(*s, dtype=torch.bfloat16) * 0.05)(D, F)),
            "w_up": _w((lambda *s: torch.randn(*s, dtype=torch.bfloat16) * 0.05)(D, F)),
            "w_down": _w((lambda *s: torch.randn(*s, dtype=torch.bfloat16) * 0.05)(F, D)),
        }
    _B_in = _B_setup()

    return {
        "A_x": _A_in["x"],
        "A_wqkv": _A_in["wqkv"],
        "A_w_phi": _A_in["w_phi"],
        "A_wo": _A_in["wo"],
        "B_x": _B_in["x"],
        "B_w_r": _B_in["w_r"],
        "B_w_gate": _B_in["w_gate"],
        "B_w_up": _B_in["w_up"],
        "B_w_down": _B_in["w_down"],
    }

def reference(A_x, A_wqkv, A_w_phi, A_wo, B_x, B_w_r, B_w_gate, B_w_up, B_w_down):
    def _A_ref(x, wqkv, w_phi, wo):
        B, S, D = x.shape
        H = 32; Dh = D // H
        qkv = (lambda x, *d: x.permute(*d))((x @ wqkv).reshape(B, S, 3, H, Dh), 2, 0, 3, 1, 4)
        q, k, v = qkv[0], qkv[1], qkv[2]
        pq = torch.einsum("bhsd,hdf->bhsf", q, w_phi)
        pk = torch.einsum("bhsd,hdf->bhsf", k, w_phi)
        phi_q = torch.concatenate([_softmax(pq, axis=-1), _softmax(-pq, axis=-1)], axis=-1)
        phi_k = torch.concatenate([_softmax(pk, axis=-1), _softmax(-pk, axis=-1)], axis=-1)
        kv = torch.einsum("bhsf,bhsd->bhfd", phi_k, v)
        z  = torch.einsum("bhsf->bhf", phi_k)
        num = torch.einsum("bhqf,bhfd->bhqd", phi_q, kv)
        den = torch.einsum("bhqf,bhf->bhq", phi_q, z)[..., None] + 1e-6
        o = num / den
        return (lambda x, *d: x.permute(*d))(o, 0, 2, 1, 3).reshape(B, S, D) @ wo

    def _B_ref(x, w_r, w_gate, w_up, w_down):
        B, S, D = x.shape
        C = 1
        r = x @ w_r
        idx = torch.argsort(-r, axis=-1)[:, :C]
        idx_e = (lambda x, n, axis: torch.repeat_interleave(x, n, dim=axis))(idx.reshape(B, C, 1), D, axis=2)
        x_sel = (lambda x, i, axis: torch.take_along_dim(x, i, dim=axis))(x, idx_e, axis=1)
        g = _silu(x_sel @ w_gate)
        u = x_sel @ w_up
        y = (g * u) @ w_down
        r_sel = _sigmoid((lambda x, i, axis: torch.take_along_dim(x, i, dim=axis))(r, idx, axis=1))
        y = y * r_sel.reshape(B, C, 1)
        b_off = (torch.arange(B) * S).reshape(B, 1)
        flat_idx = (idx + b_off).reshape(B * C)
        zero = (x * 0.0).reshape(B * S, D)
        upd = _scatter_add(zero, flat_idx, y.reshape(B * C, D), axis=0)
        return x + upd.reshape(B, S, D)

    x = A_x
    xn = _layernorm(x, axis=-1)
    s = _A_ref(xn, A_wqkv, A_w_phi, A_wo)
    g = _silu(_B_ref(xn, B_w_r, B_w_gate, B_w_up, B_w_down))
    return x + s * g
```

```asm
; @launch grid=(256,1,1) block=(512,1,1) lds=163840
.amdgcn_target "amdgcn-amd-amdhsa--gfx950"
.text
.globl recurrent_scan__linear_kernel_hedgehog__moe_arch_mod__prompt_kernel
.p2align 8
.type recurrent_scan__linear_kernel_hedgehog__moe_arch_mod__prompt_kernel,@function
recurrent_scan__linear_kernel_hedgehog__moe_arch_mod__prompt_kernel:
    s_cmp_ge_u32 s2, 256
    s_cbranch_scc1 L_done
    s_load_dwordx16 s[4:19], s[0:1], 0
    s_load_dwordx8 s[20:27], s[0:1], 64
    v_and_b32 v1, 63, v0
    v_lshrrev_b32 v2, 6, v0
    s_nop 0
    v_readfirstlane_b32 s39, v2
    s_and_b32 s34, s2, 1
    s_lshl_b32 s34, s34, 3
    s_bfe_u32 s3, s2, 0x30003
    s_add_u32 s36, s34, s3
    s_bfe_u32 s37, s2, 0x20001
    s_lshl_b32 s37, s37, 2
    s_lshr_b32 s28, s2, 6
    s_add_u32 s37, s37, s28
    s_and_b32 s3, s3, 1
    s_add_u32 s34, s34, s3
    s_and_b32 s3, s2, 6
    s_add_u32 s34, s34, s3
    s_lshr_b32 s35, s2, 4
    s_and_b32 s38, s39, 3
    s_cmp_lt_u32 s39, 4
    s_cbranch_scc1 L_C
L_H:
    v_and_b32 v4, 7, v1
    s_lshl_b32 s33, s37, 7
    s_add_u32 s85, s36, s37
    s_and_b32 s85, s85, 3
    s_lshl_b32 s87, s85, 7
    s_lshl_b32 s3, s36, 7
    s_lshl_b32 s28, s38, 5
    s_add_u32 s3, s3, s28
    v_lshrrev_b32 v7, 3, v1
    v_add_u32 v3, s3, v7
    v_lshlrev_b32 v3, 11, v3
    v_lshrrev_b32 v5, 4, v1
    v_xor_b32 v6, v4, v5
    v_xor_b32 v5, 4, v6
    v_lshl_add_u32 v6, v6, 4, v3
    v_lshl_add_u32 v5, v5, 4, v3
    v_add_u32 v8, 0, v6
    v_add_u32 v9, 15360, v5
    v_add_u32 v10, 30720, v6
    v_add_u32 v11, 46080, v5
    s_lshl_b32 s3, s38, 4
    v_add_u32 v7, s3, v7
    v_mul_u32_u24 v7, 6144, v7
    v_bfe_u32 v6, v1, 4, 1
    v_lshlrev_b32 v6, 1, v6
    v_xor_b32 v5, v4, v6
    v_add_u32 v7, s33, v7
    v_xor_b32 v6, 4, v5
    v_lshl_add_u32 v6, v6, 4, v7
    v_lshl_add_u32 v7, v5, 4, v7
    v_add_u32 v12, 0, v7
    v_add_u32 v13, 48128, v6
    v_add_u32 v14, 2048, v7
    v_add_u32 v15, 50176, v6
    v_add_u32 v16, 4096, v7
    v_add_u32 v17, 52224, v6
    v_xor_b32 v12, 512, v12
    v_xor_b32 v13, 512, v13
    s_lshl_b32 s30, s38, 12
    s_lshl_b32 s31, s38, 11
    s_add_u32 s31, s31, 16384
    s_waitcnt lgkmcnt(0)
    s_mov_b32 s44, s6
    s_mov_b32 s45, s7
    s_mov_b32 s46, 6291456
    s_mov_b32 s47, 0x00020000
    s_mov_b32 s40, s4
    s_mov_b32 s41, s5
    s_mov_b32 s42, 4194304
    s_mov_b32 s43, 0x00020000
    s_add_u32 s3, s87, 0
    s_and_b32 s3, s3, 511
    s_or_b32 s3, s3, 0
    s_mul_i32 s28, s3, 3072
    s_add_u32 m0, s30, 0
    s_nop 0
    buffer_load_dwordx4 v8, s[40:43], s3 offen offset:0 lds
    buffer_load_dwordx4 v9, s[40:43], s3 offen offset:1024 lds
    buffer_load_dwordx4 v10, s[40:43], s3 offen offset:2048 lds
    buffer_load_dwordx4 v11, s[40:43], s3 offen offset:3072 lds
    s_add_u32 m0, s31, 0
    s_nop 0
    buffer_load_dwordx4 v12, s[44:47], s28 offen offset:0 lds
    buffer_load_dwordx4 v13, s[44:47], s28 offen offset:1024 lds
    s_add_u32 m0, s31, 8192
    s_nop 0
    buffer_load_dwordx4 v14, s[44:47], s28 offen offset:0 lds
    buffer_load_dwordx4 v15, s[44:47], s28 offen offset:1024 lds
    s_add_u32 m0, s31, 16384
    s_nop 0
    buffer_load_dwordx4 v16, s[44:47], s28 offen offset:0 lds
    buffer_load_dwordx4 v17, s[44:47], s28 offen offset:1024 lds
    s_mov_b32 s48, s26
    s_mov_b32 s49, s27
    s_mov_b32 s50, 268435456
    s_mov_b32 s51, 0x00020000
    v_mov_b32 v19, 16384
    buffer_load_dword v19, v19, s[48:51], 0 offen sc1
    s_add_u32 s3, s87, 128
    s_and_b32 s3, s3, 511
    s_or_b32 s3, s3, 0
    s_mul_i32 s28, s3, 3072
    s_add_u32 m0, s30, 40960
    s_nop 0
    buffer_load_dwordx4 v8, s[40:43], s3 offen offset:0 lds
    buffer_load_dwordx4 v9, s[40:43], s3 offen offset:1024 lds
    buffer_load_dwordx4 v10, s[40:43], s3 offen offset:2048 lds
    buffer_load_dwordx4 v11, s[40:43], s3 offen offset:3072 lds
    s_add_u32 m0, s31, 40960
    s_nop 0
    buffer_load_dwordx4 v12, s[44:47], s28 offen offset:0 lds
    buffer_load_dwordx4 v13, s[44:47], s28 offen offset:1024 lds
    s_add_u32 m0, s31, 49152
    s_nop 0
    buffer_load_dwordx4 v14, s[44:47], s28 offen offset:0 lds
    buffer_load_dwordx4 v15, s[44:47], s28 offen offset:1024 lds
    s_add_u32 m0, s31, 57344
    s_nop 0
    buffer_load_dwordx4 v16, s[44:47], s28 offen offset:0 lds
    buffer_load_dwordx4 v17, s[44:47], s28 offen offset:1024 lds
    v_mov_b32 v248, -1
    v_mov_b32 v249, -1
    v_mov_b32 v250, -1
    v_mov_b32 v251, -1
    v_lshlrev_b32 v252, 4, v1
    s_and_b32 s85, s85, 0
    s_lshl_b32 s3, s37, 4
    s_add_u32 s3, s3, s36
    s_mul_i32 s67, s3, 768
    s_add_u32 s67, s67, 1048576
    s_lshl_b32 s3, s38, 8
    s_add_u32 s67, s67, s3
    s_cmp_eq_u32 s38, 3
    s_cselect_b32 s67, 268435456, s67
    v_mov_b32 v24, 0
    v_mov_b32 v25, 0
    v_mov_b32 v26, 0
    v_mov_b32 v27, 0
    v_mov_b32 v28, 0
    v_mov_b32 v29, 0
    v_mov_b32 v30, 0
    v_mov_b32 v31, 0
    v_lshlrev_b32 v253, 2, v1
    s_cmp_gt_u32 s37, 3
    s_subb_u32 s77, s37, 0
    s_cmp_gt_u32 s37, 11
    s_subb_u32 s77, s77, 0
    s_lshl_b32 s77, s77, 4
    s_add_u32 s77, s77, s36
    s_and_b32 s3, s37, 7
    s_cmp_eq_u32 s3, 3
    s_cselect_b32 s77, 224, s77
    s_bitcmp1_b32 s38, 0
    s_cselect_b32 s52, s18, s16
    s_cselect_b32 s53, s19, s17
    s_cmp_lt_u32 s77, 224
    s_cselect_b32 s54, 7340032, 0
    s_mov_b32 s55, 0x00020000
    s_mov_b32 s56, s20
    s_mov_b32 s57, s21
    s_mov_b32 s58, 7340032
    s_mov_b32 s59, 0x00020000
    s_and_b32 s3, s77, 3
    s_lshl_b32 s3, s3, 8
    s_lshr_b32 s28, s38, 1
    s_lshl_b32 s28, s28, 7
    s_add_u32 s3, s3, s28
    v_lshrrev_b32 v5, 3, v1
    v_lshl_add_u32 v6, v5, 4, s3
    v_mul_u32_u24 v6, 7168, v6
    v_lshl_add_u32 v6, v4, 4, v6
    s_lshr_b32 s3, s77, 2
    s_lshl_b32 s3, s3, 7
    v_add_u32 v21, s3, v6
    s_lshr_b32 s3, s2, 4
    s_mul_i32 s3, s3, 224
    s_mul_i32 s28, s38, 56
    s_add_u32 s71, s3, s28
    v_lshlrev_b32 v6, 14, v5
    v_lshl_add_u32 v6, v4, 4, v6
    s_and_b32 s3, s2, 15
    s_lshl_b32 s3, s3, 7
    v_add_u32 v22, s3, v6
    v_bfe_u32 v5, v1, 4, 1
    v_lshlrev_b32 v5, 5, v5
    v_xor_b32 v5, v5, v252
    s_min_u32 s3, s38, 2
    s_lshl_b32 s3, s3, 13
    s_lshr_b32 s80, s36, 2
    s_lshl_b32 s28, s80, 11
    s_add_u32 s3, s3, s28
    s_add_u32 s3, s3, 16384
    v_add_u32 v18, s3, v5
    s_lshr_b32 s3, s38, 1
    s_lshl_b32 s28, s37, 1
    s_add_u32 s28, s28, s3
    s_and_b32 s29, s38, 1
    s_lshl_b32 s3, s36, 1
    s_add_u32 s29, s29, s3
    s_lshl_b32 s3, s28, 5
    s_add_u32 s3, s3, s29
    s_mul_i32 s3, s3, 4224
    s_add_u32 s78, s3, 8388608
    s_xor_b32 s28, s28, 8
    s_lshl_b32 s3, s29, 7
    s_add_u32 s3, s3, s28
    s_lshl_b32 s3, s3, 10
    s_add_u32 s79, s3, 4194304
    s_waitcnt vmcnt(11)
    s_waitcnt lgkmcnt(0)
    s_barrier
    s_lshl_b32 s3, s36, 7
    s_lshl_b32 s28, s37, 3
    s_add_u32 s3, s3, s28
    s_lshl_b32 s3, s3, 11
    s_add_u32 s3, s3, s30
    s_add_u32 m0, s30, 131072
    s_nop 0
    buffer_load_dwordx4 v252, s[40:43], s3 offen offset:0 lds
    buffer_load_dwordx4 v252, s[40:43], s3 offen offset:1024 lds
    buffer_load_dwordx4 v252, s[40:43], s3 offen offset:2048 lds
    buffer_load_dwordx4 v252, s[40:43], s3 offen offset:3072 lds
    s_mov_b32 s88, s14
    s_mov_b32 s89, s15
    s_mov_b32 s90, 2048
    s_mov_b32 s91, 0x00020000
    s_lshl_b32 s3, s38, 9
    s_add_u32 m0, s3, 122880
    s_mov_b32 exec_hi, 0
    buffer_load_dwordx4 v252, s[88:91], s3 offen lds
    s_mov_b64 exec, -1
    v_add_u32 v2, 0, v18
    v_xor_b32 v3, 64, v2
    ds_read_b128 v[32:35], v2 offset:0
    ds_read_b128 v[36:39], v3 offset:1024
    s_lshl_b32 s3, s38, 12
    s_add_u32 s3, s3, 131084
    v_add_u32 v229, s3, v252
    v_add_u32 v232, 131080, v252
    v_lshrrev_b32 v2, 5, v1
    v_and_b32 v3, 31, v1
    v_lshl_add_u32 v2, v2, 7, v3
    s_lshl_b32 s3, s38, 7
    s_add_u32 s3, s3, 152064
    v_lshl_add_u32 v230, v2, 2, s3
    v_bfe_u32 v4, v1, 2, 2
    v_lshlrev_b32 v4, 3, v4
    v_bfe_u32 v7, v1, 4, 1
    v_lshl_add_u32 v4, v7, 2, v4
    v_and_b32 v7, 3, v1
    v_add_u32 v4, v4, v7
    s_lshl_b32 s3, s38, 6
    s_add_u32 s3, s3, 154624
    v_lshl_add_u32 v231, v4, 1, s3
    s_lshl_b32 s3, s36, 7
    s_lshl_b32 s28, s34, 7
    v_mov_b32 v2, s3
    v_mov_b32 v4, s28
    v_cmp_gt_u32 vcc, 32, v1
    s_lshl_b32 s3, s38, 5
    v_and_b32 v3, 30, v1
    v_cndmask_b32 v2, v4, v2, vcc
    v_add3_u32 v2, v2, v3, s3
    v_and_b32 v3, 1, v1
    v_lshl_add_u32 v2, v2, 1, v3
    v_lshlrev_b32 v2, 2, v2
    v_add_u32 v237, 131072, v2
    s_mul_i32 s3, s38, 48
    v_and_b32 v2, 15, v1
    v_min_u32 v2, 11, v2
    v_lshrrev_b32 v3, 4, v1
    v_lshlrev_b32 v4, 4, v2
    v_lshl_add_u32 v2, v2, 2, v3
    v_add_u32 v2, s3, v2
    v_and_b32 v5, 7, v2
    v_bfe_u32 v6, v2, 3, 3
    v_lshl_add_u32 v5, v5, 3, v6
    v_and_b32 v2, 0xc0, v2
    v_add_u32 v2, v2, v5
    v_lshlrev_b32 v2, 2, v2
    v_add_u32 v233, 154880, v2
    v_mul_u32_u24 v3, 768, v3
    v_add_u32 v235, v3, v4
    v_mov_b32 v234, 162048
    s_waitcnt vmcnt(5)
    s_waitcnt lgkmcnt(0)
    s_barrier
    s_add_u32 s3, s87, 256
    s_and_b32 s3, s3, 511
    s_or_b32 s3, s3, 0
    s_mul_i32 s28, s3, 3072
    s_add_u32 m0, s30, 81920
    s_nop 0
    buffer_load_dwordx4 v8, s[40:43], s3 offen offset:0 lds
    buffer_load_dwordx4 v9, s[40:43], s3 offen offset:1024 lds
    buffer_load_dwordx4 v10, s[40:43], s3 offen offset:2048 lds
    buffer_load_dwordx4 v11, s[40:43], s3 offen offset:3072 lds
    s_add_u32 m0, s31, 81920
    s_nop 0
    buffer_load_dwordx4 v12, s[44:47], s28 offen offset:0 lds
    buffer_load_dwordx4 v13, s[44:47], s28 offen offset:1024 lds
    s_add_u32 m0, s31, 90112
    s_nop 0
    buffer_load_dwordx4 v14, s[44:47], s28 offen offset:0 lds
    buffer_load_dwordx4 v15, s[44:47], s28 offen offset:1024 lds
    s_add_u32 m0, s31, 98304
    s_nop 0
    buffer_load_dwordx4 v16, s[44:47], s28 offen offset:0 lds
    buffer_load_dwordx4 v17, s[44:47], s28 offen offset:1024 lds
    s_waitcnt vmcnt(10)
    v_readfirstlane_b32 s86, v19
    s_nop 0
    s_add_u32 s86, s86, 1
    s_barrier
    s_add_u32 s3, s87, 384
    s_and_b32 s3, s3, 511
    s_or_b32 s3, s3, 0
    s_mul_i32 s28, s3, 3072
    s_add_u32 m0, s30, 0
    s_nop 0
    buffer_load_dwordx4 v8, s[40:43], s3 offen offset:0 lds
    buffer_load_dwordx4 v9, s[40:43], s3 offen offset:1024 lds
    buffer_load_dwordx4 v10, s[40:43], s3 offen offset:2048 lds
    buffer_load_dwordx4 v11, s[40:43], s3 offen offset:3072 lds
    s_add_u32 m0, s31, 0
    s_nop 0
    buffer_load_dwordx4 v12, s[44:47], s28 offen offset:0 lds
    buffer_load_dwordx4 v13, s[44:47], s28 offen offset:1024 lds
    s_add_u32 m0, s31, 8192
    s_nop 0
    buffer_load_dwordx4 v14, s[44:47], s28 offen offset:0 lds
    buffer_load_dwordx4 v15, s[44:47], s28 offen offset:1024 lds
    s_add_u32 m0, s31, 16384
    s_nop 0
    buffer_load_dwordx4 v16, s[44:47], s28 offen offset:0 lds
    buffer_load_dwordx4 v17, s[44:47], s28 offen offset:1024 lds
    v_lshlrev_b32 v2, 16, v32
    v_and_b32 v3, 0xffff0000, v32
    v_add_f32 v24, v24, v2
    v_add_f32 v25, v25, v3
    v_lshlrev_b32 v4, 16, v33
    v_and_b32 v5, 0xffff0000, v33
    v_add_f32 v26, v26, v4
    v_add_f32 v27, v27, v5
    v_lshlrev_b32 v2, 16, v34
    v_and_b32 v3, 0xffff0000, v34
    v_add_f32 v28, v28, v2
    v_add_f32 v29, v29, v3
    v_lshlrev_b32 v4, 16, v35
    v_and_b32 v5, 0xffff0000, v35
    v_add_f32 v30, v30, v4
    v_add_f32 v31, v31, v5
    v_lshlrev_b32 v2, 16, v36
    v_and_b32 v3, 0xffff0000, v36
    v_add_f32 v24, v24, v2
    v_add_f32 v25, v25, v3
    v_lshlrev_b32 v4, 16, v37
    v_and_b32 v5, 0xffff0000, v37
    v_add_f32 v26, v26, v4
    v_add_f32 v27, v27, v5
    v_lshlrev_b32 v2, 16, v38
    v_and_b32 v3, 0xffff0000, v38
    v_add_f32 v28, v28, v2
    v_add_f32 v29, v29, v3
    v_lshlrev_b32 v4, 16, v39
    v_and_b32 v5, 0xffff0000, v39
    v_add_f32 v30, v30, v4
    v_add_f32 v31, v31, v5
    buffer_store_dwordx4 v[248:251], v252, s[48:51], s78 offen offset:0 sc1
    buffer_store_dwordx4 v[248:251], v252, s[48:51], s78 offen offset:1024 sc1
    buffer_store_dwordx4 v[248:251], v252, s[48:51], s78 offen offset:2048 sc1
    buffer_store_dwordx4 v[248:251], v252, s[48:51], s78 offen offset:3072 sc1
    s_add_u32 s3, s78, 4096
    s_mov_b64 exec, 0xff
    buffer_store_dwordx4 v[248:251], v252, s[48:51], s3 offen sc1
    s_mov_b64 exec, -1
    s_waitcnt vmcnt(15)
    s_waitcnt lgkmcnt(0)
    s_barrier
    s_add_u32 s3, s87, 0
    s_and_b32 s3, s3, 511
    s_or_b32 s3, s3, 512
    s_mul_i32 s28, s3, 3072
    s_add_u32 m0, s30, 40960
    s_nop 0
    buffer_load_dwordx4 v8, s[40:43], s3 offen offset:0 lds
    buffer_load_dwordx4 v9, s[40:43], s3 offen offset:1024 lds
    buffer_load_dwordx4 v10, s[40:43], s3 offen offset:2048 lds
    buffer_load_dwordx4 v11, s[40:43], s3 offen offset:3072 lds
    s_add_u32 m0, s31, 40960
    s_nop 0
    buffer_load_dwordx4 v12, s[44:47], s28 offen offset:0 lds
    buffer_load_dwordx4 v13, s[44:47], s28 offen offset:1024 lds
    s_add_u32 m0, s31, 49152
    s_nop 0
    buffer_load_dwordx4 v14, s[44:47], s28 offen offset:0 lds
    buffer_load_dwordx4 v15, s[44:47], s28 offen offset:1024 lds
    s_add_u32 m0, s31, 57344
    s_nop 0
    buffer_load_dwordx4 v16, s[44:47], s28 offen offset:0 lds
    buffer_load_dwordx4 v17, s[44:47], s28 offen offset:1024 lds
    s_mov_b32 s88, s8
    s_mov_b32 s89, s9
    s_mov_b32 s90, 65536
    s_mov_b32 s91, 0x00020000
    s_lshl_b32 s3, s38, 10
    s_add_u32 m0, s3, 147712
    s_lshl_b32 s28, s37, 12
    s_add_u32 s3, s3, s28
    buffer_load_dwordx4 v252, s[88:91], s3 offen lds
    s_add_u32 m0, m0, 8192
    s_xor_b32 s3, s3, 16384
    buffer_load_dwordx4 v252, s[88:91], s3 offen lds
    s_mov_b32 s88, s10
    s_mov_b32 s89, s11
    s_mov_b32 s90, 2097152
    s_mov_b32 s91, 0x00020000
    s_lshl_b32 s3, s2, 13
    s_lshl_b32 s28, s38, 11
    s_add_u32 s3, s3, s28
    v_lshlrev_b32 v3, 7, v1
    s_mov_b64 exec, 0xffff
    buffer_load_dword v117, v3, s[88:91], s3 offen
    s_mov_b64 exec, -1
    s_waitcnt vmcnt(18)
    s_waitcnt lgkmcnt(0)
    s_barrier
    v_lshrrev_b32 v5, 3, v1
    v_lshlrev_b32 v6, 11, v5
    v_bfe_u32 v5, v1, 4, 2
    v_lshlrev_b32 v5, 1, v5
    v_and_b32 v7, 7, v1
    v_xor_b32 v5, v5, v7
    v_lshl_add_u32 v6, v5, 4, v6
    s_lshl_b32 s3, s35, 7
    v_add_u32 v6, s3, v6
    v_add_u32 v220, 0, v6
    v_add_u32 v221, 15360, v6
    v_add_u32 v222, 30720, v6
    v_add_u32 v223, 46080, v6
    s_lshl_b32 s72, s38, 12
    s_lshl_b32 s73, s38, 16
    s_mov_b32 s88, s10
    s_mov_b32 s89, s11
    s_mov_b32 s90, 2097152
    s_mov_b32 s91, 0x00020000
    s_lshl_b32 s3, s36, 2
    s_add_u32 s3, s3, s38
    s_lshr_b32 s28, s3, 5
    s_and_b32 s3, s3, 31
    s_lshl_b32 s74, s3, 7
    s_lshl_b32 s3, s37, 1
    s_add_u32 s75, s3, s28
    v_lshrrev_b32 v5, 3, v1
    v_mul_u32_u24 v5, 4224, v5
    v_and_b32 v7, 7, v1
    v_lshl_add_u32 v112, v7, 4, v5
    s_mul_i32 s76, s75, 135168
    s_add_u32 s76, s76, s74
    s_add_u32 s76, s76, 8388608
    s_mul_i32 s3, s75, 4224
    s_add_u32 s3, s3, s74
    s_add_u32 s74, s3, 1245184
    s_lshl_b32 s75, s37, 1
    s_add_u32 s75, s75, s36
    s_mul_i32 s81, s75, 135168
    s_add_u32 s81, s81, 8392704
    s_mul_i32 s82, s75, 4224
    s_add_u32 s82, s82, 1249280
    s_lshr_b32 s3, s36, 1
    s_or_b32 s83, s3, s38
    s_and_b32 s3, s38, 1
    s_lshl_b32 s3, s3, 3
    s_and_b32 s28, s77, 3
    s_lshl_b32 s28, s28, 1
    s_add_u32 s3, s3, s28
    s_lshr_b32 s28, s38, 1
    s_add_u32 s3, s3, s28
    s_mul_i32 s3, s3, 14336
    s_lshr_b32 s28, s77, 2
    s_lshl_b32 s28, s28, 8
    s_add_u32 s3, s3, s28
    s_add_u32 s3, s3, 1380352
    s_cmp_lt_u32 s77, 224
    s_cselect_b32 s84, s3, 268435456
    s_add_u32 s3, s87, 128
    s_and_b32 s3, s3, 511
    s_or_b32 s3, s3, 512
    s_mul_i32 s28, s3, 3072
    s_add_u32 m0, s30, 81920
    s_nop 0
    buffer_load_dwordx4 v8, s[40:43], s3 offen offset:0 lds
    buffer_load_dwordx4 v9, s[40:43], s3 offen offset:1024 lds
    buffer_load_dwordx4 v10, s[40:43], s3 offen offset:2048 lds
    buffer_load_dwordx4 v11, s[40:43], s3 offen offset:3072 lds
    s_add_u32 m0, s31, 81920
    s_nop 0
    buffer_load_dwordx4 v12, s[44:47], s28 offen offset:0 lds
    buffer_load_dwordx4 v13, s[44:47], s28 offen offset:1024 lds
    s_add_u32 m0, s31, 90112
    s_nop 0
    buffer_load_dwordx4 v14, s[44:47], s28 offen offset:0 lds
    buffer_load_dwordx4 v15, s[44:47], s28 offen offset:1024 lds
    s_add_u32 m0, s31, 98304
    s_nop 0
    buffer_load_dwordx4 v16, s[44:47], s28 offen offset:0 lds
    buffer_load_dwordx4 v17, s[44:47], s28 offen offset:1024 lds
    s_waitcnt vmcnt(13)
    s_waitcnt lgkmcnt(0)
    s_barrier
    v_add_u32 v2, 40960, v18
    v_xor_b32 v3, 64, v2
    ds_read_b128 v[40:43], v2 offset:0
    ds_read_b128 v[44:47], v3 offset:1024
    s_add_u32 s3, s87, 256
    s_and_b32 s3, s3, 511
    s_or_b32 s3, s3, 512
    s_mul_i32 s28, s3, 3072
    s_add_u32 m0, s30, 0
    s_nop 0
    buffer_load_dwordx4 v8, s[40:43], s3 offen offset:0 lds
    buffer_load_dwordx4 v9, s[40:43], s3 offen offset:1024 lds
    buffer_load_dwordx4 v10, s[40:43], s3 offen offset:2048 lds
    buffer_load_dwordx4 v11, s[40:43], s3 offen offset:3072 lds
    s_add_u32 m0, s31, 0
    s_nop 0
    buffer_load_dwordx4 v12, s[44:47], s28 offen offset:0 lds
    buffer_load_dwordx4 v13, s[44:47], s28 offen offset:1024 lds
    s_add_u32 m0, s31, 8192
    s_nop 0
    buffer_load_dwordx4 v14, s[44:47], s28 offen offset:0 lds
    buffer_load_dwordx4 v15, s[44:47], s28 offen offset:1024 lds
    s_add_u32 m0, s31, 16384
    s_nop 0
    buffer_load_dwordx4 v16, s[44:47], s28 offen offset:0 lds
    buffer_load_dwordx4 v17, s[44:47], s28 offen offset:1024 lds
    s_lshl_b32 s3, s38, 12
    s_add_u32 m0, s3, 131072
    s_nop 0
    buffer_load_dwordx4 v252, s[48:51], s3 offen offset:0 sc1 lds
    buffer_load_dwordx4 v252, s[48:51], s3 offen offset:1024 sc1 lds
    buffer_load_dwordx4 v252, s[48:51], s3 offen offset:2048 sc1 lds
    buffer_load_dwordx4 v252, s[48:51], s3 offen offset:3072 sc1 lds
    s_lshr_b32 s3, s71, 3
    s_add_u32 s3, s3, 0
    s_and_b32 s28, s3, 7
    s_lshr_b32 s3, s3, 3
    s_lshl_b32 s3, s3, 6
    s_add_u32 s3, s3, s28
    s_lshl_b32 s3, s3, 11
    buffer_load_dwordx4 v[192:195], v22, s[56:59], s3 offen nt
    s_lshr_b32 s3, s71, 3
    s_add_u32 s3, s3, 1
    s_and_b32 s28, s3, 7
    s_lshr_b32 s3, s3, 3
    s_lshl_b32 s3, s3, 6
    s_add_u32 s3, s3, s28
    s_lshl_b32 s3, s3, 11
    buffer_load_dwordx4 v[196:199], v22, s[56:59], s3 offen nt
    s_lshr_b32 s3, s71, 3
    s_add_u32 s3, s3, 2
    s_and_b32 s28, s3, 7
    s_lshr_b32 s3, s3, 3
    s_lshl_b32 s3, s3, 6
    s_add_u32 s3, s3, s28
    s_lshl_b32 s3, s3, 11
    buffer_load_dwordx4 v[200:203], v22, s[56:59], s3 offen nt
    s_lshr_b32 s3, s71, 3
    s_add_u32 s3, s3, 3
    s_and_b32 s28, s3, 7
    s_lshr_b32 s3, s3, 3
    s_lshl_b32 s3, s3, 6
    s_add_u32 s3, s3, s28
    s_lshl_b32 s3, s3, 11
    buffer_load_dwordx4 v[204:207], v22, s[56:59], s3 offen nt
    s_lshr_b32 s3, s71, 3
    s_add_u32 s3, s3, 4
    s_and_b32 s28, s3, 7
    s_lshr_b32 s3, s3, 3
    s_lshl_b32 s3, s3, 6
    s_add_u32 s3, s3, s28
    s_lshl_b32 s3, s3, 11
    buffer_load_dwordx4 v[208:211], v22, s[56:59], s3 offen nt
    s_lshr_b32 s3, s71, 3
    s_add_u32 s3, s3, 5
    s_and_b32 s28, s3, 7
    s_lshr_b32 s3, s3, 3
    s_lshl_b32 s3, s3, 6
    s_add_u32 s3, s3, s28
    s_lshl_b32 s3, s3, 11
    buffer_load_dwordx4 v[212:215], v22, s[56:59], s3 offen nt
    s_lshr_b32 s3, s71, 3
    s_add_u32 s3, s3, 6
    s_and_b32 s28, s3, 7
    s_lshr_b32 s3, s3, 3
    s_lshl_b32 s3, s3, 6
    s_add_u32 s3, s3, s28
    s_lshl_b32 s3, s3, 11
    buffer_load_dwordx4 v[216:219], v22, s[56:59], s3 offen nt
    s_waitcnt vmcnt(21)
    s_waitcnt lgkmcnt(0)
    s_barrier
    s_add_u32 s3, s87, 384
    s_and_b32 s3, s3, 511
    s_or_b32 s3, s3, 512
    s_mul_i32 s28, s3, 3072
    s_add_u32 m0, s30, 40960
    s_nop 0
    buffer_load_dwordx4 v8, s[40:43], s3 offen offset:0 lds
    buffer_load_dwordx4 v9, s[40:43], s3 offen offset:1024 lds
    buffer_load_dwordx4 v10, s[40:43], s3 offen offset:2048 lds
    buffer_load_dwordx4 v11, s[40:43], s3 offen offset:3072 lds
    s_add_u32 m0, s31, 40960
    s_nop 0
    buffer_load_dwordx4 v12, s[44:47], s28 offen offset:0 lds
    buffer_load_dwordx4 v13, s[44:47], s28 offen offset:1024 lds
    s_add_u32 m0, s31, 49152
    s_nop 0
    buffer_load_dwordx4 v14, s[44:47], s28 offen offset:0 lds
    buffer_load_dwordx4 v15, s[44:47], s28 offen offset:1024 lds
    s_add_u32 m0, s31, 57344
    s_nop 0
    buffer_load_dwordx4 v16, s[44:47], s28 offen offset:0 lds
    buffer_load_dwordx4 v17, s[44:47], s28 offen offset:1024 lds
    v_lshlrev_b32 v2, 16, v40
    v_and_b32 v3, 0xffff0000, v40
    v_add_f32 v24, v24, v2
    v_add_f32 v25, v25, v3
    v_lshlrev_b32 v4, 16, v41
    v_and_b32 v5, 0xffff0000, v41
    v_add_f32 v26, v26, v4
    v_add_f32 v27, v27, v5
    v_lshlrev_b32 v2, 16, v42
    v_and_b32 v3, 0xffff0000, v42
    v_add_f32 v28, v28, v2
    v_add_f32 v29, v29, v3
    v_lshlrev_b32 v4, 16, v43
    v_and_b32 v5, 0xffff0000, v43
    v_add_f32 v30, v30, v4
    v_add_f32 v31, v31, v5
    v_lshlrev_b32 v2, 16, v44
    v_and_b32 v3, 0xffff0000, v44
    v_add_f32 v24, v24, v2
    v_add_f32 v25, v25, v3
    v_lshlrev_b32 v4, 16, v45
    v_and_b32 v5, 0xffff0000, v45
    v_add_f32 v26, v26, v4
    v_add_f32 v27, v27, v5
    v_lshlrev_b32 v2, 16, v46
    v_and_b32 v3, 0xffff0000, v46
    v_add_f32 v28, v28, v2
    v_add_f32 v29, v29, v3
    v_lshlrev_b32 v4, 16, v47
    v_and_b32 v5, 0xffff0000, v47
    v_add_f32 v30, v30, v4
    v_add_f32 v31, v31, v5
    s_waitcnt vmcnt(21)
    s_waitcnt lgkmcnt(0)
    s_barrier
    s_waitcnt vmcnt(17)
    ds_read2st64_b32 v[64:65], v229 offset0:0 offset1:4
    ds_read2st64_b32 v[66:67], v229 offset0:8 offset1:12
    s_waitcnt lgkmcnt(0)
    s_mov_b32 s29, 0
L_k1:
    v_cmp_ne_u32 vcc, s86, v64
    v_cmp_ne_u32 s[92:93], s86, v65
    s_nop 0
    s_or_b64 vcc, vcc, s[92:93]
    v_cmp_ne_u32 s[92:93], s86, v66
    s_nop 0
    s_or_b64 vcc, vcc, s[92:93]
    v_cmp_ne_u32 s[92:93], s86, v67
    s_nop 0
    s_or_b64 vcc, vcc, s[92:93]
    s_cbranch_vccz L_k1k
    s_add_u32 s29, s29, 1
    s_cmp_ge_u32 s29, 200000
    s_cbranch_scc1 L_k1k
    s_sleep 2
    s_lshl_b32 s3, s38, 12
    s_add_u32 m0, s3, 131072
    s_nop 0
    buffer_load_dwordx4 v252, s[48:51], s3 offen offset:0 sc1 lds
    buffer_load_dwordx4 v252, s[48:51], s3 offen offset:1024 sc1 lds
    buffer_load_dwordx4 v252, s[48:51], s3 offen offset:2048 sc1 lds
    buffer_load_dwordx4 v252, s[48:51], s3 offen offset:3072 sc1 lds
    s_waitcnt vmcnt(0)
    ds_read2st64_b32 v[64:65], v229 offset0:0 offset1:4
    ds_read2st64_b32 v[66:67], v229 offset0:8 offset1:12
    s_waitcnt lgkmcnt(0)
    s_branch L_k1
L_k1k:
    s_add_u32 s3, s87, 0
    s_and_b32 s3, s3, 511
    s_or_b32 s3, s3, 1024
    s_mul_i32 s28, s3, 3072
    s_add_u32 m0, s30, 81920
    s_nop 0
    buffer_load_dwordx4 v8, s[40:43], s3 offen offset:0 lds
    buffer_load_dwordx4 v9, s[40:43], s3 offen offset:1024 lds
    buffer_load_dwordx4 v10, s[40:43], s3 offen offset:2048 lds
    buffer_load_dwordx4 v11, s[40:43], s3 offen offset:3072 lds
    s_add_u32 m0, s31, 81920
    s_nop 0
    buffer_load_dwordx4 v12, s[44:47], s28 offen offset:0 lds
    buffer_load_dwordx4 v13, s[44:47], s28 offen offset:1024 lds
    s_add_u32 m0, s31, 90112
    s_nop 0
    buffer_load_dwordx4 v14, s[44:47], s28 offen offset:0 lds
    buffer_load_dwordx4 v15, s[44:47], s28 offen offset:1024 lds
    s_add_u32 m0, s31, 98304
    s_nop 0
    buffer_load_dwordx4 v16, s[44:47], s28 offen offset:0 lds
    buffer_load_dwordx4 v17, s[44:47], s28 offen offset:1024 lds
    v_lshrrev_b32 v2, 3, v1
    v_mul_u32_u24 v2, 6144, v2
    v_and_b32 v3, 7, v1
    v_lshl_add_u32 v2, v3, 4, v2
    s_lshr_b32 s3, s87, 1
    s_lshl_b32 s28, s80, 4
    s_add_u32 s3, s3, s28
    s_add_u32 s3, s3, 768
    s_mul_i32 s3, s3, 6144
    s_lshl_b32 s28, s38, 11
    s_add_u32 s3, s3, s28
    s_add_u32 s3, s3, s33
    s_xor_b32 s28, s3, 512
    s_cmp_eq_u32 s38, 0
    s_cselect_b32 s3, s28, s3
    s_cmp_eq_u32 s38, 3
    s_cselect_b32 s3, 0x7000000, s3
    s_add_u32 s28, s3, 49152
    buffer_load_dwordx4 v[56:59], v2, s[44:47], s3 offen
    buffer_load_dwordx4 v[60:63], v2, s[44:47], s28 offen
    s_waitcnt vmcnt(12)
    s_waitcnt lgkmcnt(0)
    s_barrier
    ds_read_b64 v[80:81], v232 offset:0
    ds_read_b64 v[82:83], v232 offset:1024
    ds_read_b64 v[84:85], v232 offset:2048
    ds_read_b64 v[86:87], v232 offset:3072
    ds_read_b64 v[88:89], v232 offset:4096
    ds_read_b64 v[90:91], v232 offset:5120
    ds_read_b64 v[92:93], v232 offset:6144
    ds_read_b64 v[94:95], v232 offset:7168
    ds_read_b64 v[96:97], v232 offset:8192
    ds_read_b64 v[98:99], v232 offset:9216
    ds_read_b64 v[100:101], v232 offset:10240
    ds_read_b64 v[102:103], v232 offset:11264
    ds_read_b64 v[104:105], v232 offset:12288
    ds_read_b64 v[106:107], v232 offset:13312
    ds_read_b64 v[108:109], v232 offset:14336
    ds_read_b64 v[110:111], v232 offset:15360
    ds_read_b32 v72, v237
    s_waitcnt lgkmcnt(0)
    v_max3_u32 v2, v80, v82, v84
    v_max3_u32 v2, v2, v86, v88
    v_max3_u32 v2, v2, v90, v92
    v_max3_u32 v2, v2, v94, v96
    v_max3_u32 v2, v2, v98, v100
    v_max3_u32 v2, v2, v102, v104
    v_max3_u32 v2, v2, v106, v108
    v_max_u32 v2, v2, v110
    s_nop 1
    v_max_u32 v2, v2, v2 quad_perm:[1,0,3,2] row_mask:0xf bank_mask:0xf
    s_nop 1
    v_max_u32 v2, v2, v2 quad_perm:[2,3,0,1] row_mask:0xf bank_mask:0xf
    s_nop 1
    v_max_u32 v2, v2, v2 row_half_mirror row_mask:0xf bank_mask:0xf
    s_nop 1
    v_max_u32 v2, v2, v2 row_mirror row_mask:0xf bank_mask:0xf
    s_nop 0
    v_readlane_b32 s70, v2, 0
    v_readlane_b32 s3, v2, 16
    v_readlane_b32 s28, v2, 32
    v_readlane_b32 s29, v2, 48
    s_max_u32 s70, s70, s3
    s_max_u32 s28, s28, s29
    s_max_u32 s70, s70, s28
    s_and_b32 s68, s70, 0x7ff
    s_sub_u32 s68, 2047, s68
    s_lshl_b32 s3, s68, 11
    s_and_b32 s28, s77, 3
    s_lshl_b32 s28, s28, 9
    s_add_u32 s3, s3, s28
    s_lshr_b32 s28, s38, 1
    s_lshl_b32 s28, s28, 8
    s_add_u32 s3, s3, s28
    v_lshrrev_b32 v3, 3, v1
    v_lshlrev_b32 v3, 5, v3
    buffer_load_dwordx4 v[64:67], v3, s[40:43], s3 offen
    buffer_load_dwordx4 v[68:71], v3, s[40:43], s3 offen offset:16
    s_lshr_b32 s3, s68, 1
    s_lshl_b32 s3, s3, 4
    s_and_b32 s28, s68, 1
    s_lshl_b32 s28, s28, 2
    s_add_u32 s3, s3, s28
    s_add_u32 s3, s3, 131072
    v_mov_b32 v3, s3
    ds_read_b32 v116, v3
    s_add_u32 s3, s87, 128
    s_and_b32 s3, s3, 511
    s_or_b32 s3, s3, 1024
    s_mul_i32 s28, s3, 3072
    s_add_u32 m0, s30, 0
    s_nop 0
    buffer_load_dwordx4 v8, s[40:43], s3 offen offset:0 lds
    buffer_load_dwordx4 v9, s[40:43], s3 offen offset:1024 lds
    buffer_load_dwordx4 v10, s[40:43], s3 offen offset:2048 lds
    buffer_load_dwordx4 v11, s[40:43], s3 offen offset:3072 lds
    s_add_u32 m0, s31, 0
    s_nop 0
    buffer_load_dwordx4 v12, s[44:47], s28 offen offset:0 lds
    buffer_load_dwordx4 v13, s[44:47], s28 offen offset:1024 lds
    s_add_u32 m0, s31, 8192
    s_nop 0
    buffer_load_dwordx4 v14, s[44:47], s28 offen offset:0 lds
    buffer_load_dwordx4 v15, s[44:47], s28 offen offset:1024 lds
    s_add_u32 m0, s31, 16384
    s_nop 0
    buffer_load_dwordx4 v16, s[44:47], s28 offen offset:0 lds
    buffer_load_dwordx4 v17, s[44:47], s28 offen offset:1024 lds
    s_waitcnt vmcnt(14)
    s_waitcnt lgkmcnt(0)
    s_barrier
    v_add_u32 v2, 81920, v18
    v_xor_b32 v3, 64, v2
    ds_read_b128 v[48:51], v2 offset:0
    ds_read_b128 v[52:55], v3 offset:1024
    s_add_u32 s3, s87, 256
    s_and_b32 s3, s3, 511
    s_or_b32 s3, s3, 1024
    s_mul_i32 s28, s3, 3072
    s_add_u32 m0, s30, 40960
    s_nop 0
    buffer_load_dwordx4 v8, s[40:43], s3 offen offset:0 lds
    buffer_load_dwordx4 v9, s[40:43], s3 offen offset:1024 lds
    buffer_load_dwordx4 v10, s[40:43], s3 offen offset:2048 lds
    buffer_load_dwordx4 v11, s[40:43], s3 offen offset:3072 lds
    s_add_u32 m0, s31, 40960
    s_nop 0
    buffer_load_dwordx4 v12, s[44:47], s28 offen offset:0 lds
    buffer_load_dwordx4 v13, s[44:47], s28 offen offset:1024 lds
    s_add_u32 m0, s31, 49152
    s_nop 0
    buffer_load_dwordx4 v14, s[44:47], s28 offen offset:0 lds
    buffer_load_dwordx4 v15, s[44:47], s28 offen offset:1024 lds
    s_add_u32 m0, s31, 57344
    s_nop 0
    buffer_load_dwordx4 v16, s[44:47], s28 offen offset:0 lds
    buffer_load_dwordx4 v17, s[44:47], s28 offen offset:1024 lds
    s_waitcnt vmcnt(22)
    v_lshlrev_b32 v2, 16, v56
    v_and_b32 v3, 0xffff0000, v56
    v_add_f32 v24, v24, v2
    v_add_f32 v25, v25, v3
    v_lshlrev_b32 v4, 16, v57
    v_and_b32 v5, 0xffff0000, v57
    v_add_f32 v26, v26, v4
    v_add_f32 v27, v27, v5
    v_lshlrev_b32 v2, 16, v58
    v_and_b32 v3, 0xffff0000, v58
    v_add_f32 v28, v28, v2
    v_add_f32 v29, v29, v3
    v_lshlrev_b32 v4, 16, v59
    v_and_b32 v5, 0xffff0000, v59
    v_add_f32 v30, v30, v4
    v_add_f32 v31, v31, v5
    v_lshlrev_b32 v2, 16, v60
    v_and_b32 v3, 0xffff0000, v60
    v_add_f32 v24, v24, v2
    v_add_f32 v25, v25, v3
    v_lshlrev_b32 v4, 16, v61
    v_and_b32 v5, 0xffff0000, v61
    v_add_f32 v26, v26, v4
    v_add_f32 v27, v27, v5
    v_lshlrev_b32 v2, 16, v62
    v_and_b32 v3, 0xffff0000, v62
    v_add_f32 v28, v28, v2
    v_add_f32 v29, v29, v3
    v_lshlrev_b32 v4, 16, v63
    v_and_b32 v5, 0xffff0000, v63
    v_add_f32 v30, v30, v4
    v_add_f32 v31, v31, v5
    s_or_b32 s3, s2, s38
    s_mov_b32 s28, 16384
    s_cmp_lg_u32 s3, 0
    s_cselect_b32 s3, 268435456, s28
    v_mov_b32 v2, s86
    s_mov_b64 exec, 1
    buffer_store_dword v2, v252, s[48:51], s3 offen sc1
    s_mov_b64 exec, -1
    s_waitcnt vmcnt(11)
    s_waitcnt lgkmcnt(0)
    s_barrier
    s_add_u32 s3, s87, 384
    s_and_b32 s3, s3, 511
    s_or_b32 s3, s3, 1024
    s_mul_i32 s28, s3, 3072
    s_add_u32 m0, s30, 81920
    s_nop 0
    buffer_load_dwordx4 v8, s[40:43], s3 offen offset:0 lds
    buffer_load_dwordx4 v9, s[40:43], s3 offen offset:1024 lds
    buffer_load_dwordx4 v10, s[40:43], s3 offen offset:2048 lds
    buffer_load_dwordx4 v11, s[40:43], s3 offen offset:3072 lds
    s_add_u32 m0, s31, 81920
    s_nop 0
    buffer_load_dwordx4 v12, s[44:47], s28 offen offset:0 lds
    buffer_load_dwordx4 v13, s[44:47], s28 offen offset:1024 lds
    s_add_u32 m0, s31, 90112
    s_nop 0
    buffer_load_dwordx4 v14, s[44:47], s28 offen offset:0 lds
    buffer_load_dwordx4 v15, s[44:47], s28 offen offset:1024 lds
    s_add_u32 m0, s31, 98304
    s_nop 0
    buffer_load_dwordx4 v16, s[44:47], s28 offen offset:0 lds
    buffer_load_dwordx4 v17, s[44:47], s28 offen offset:1024 lds
    v_lshlrev_b32 v2, 16, v48
    v_and_b32 v3, 0xffff0000, v48
    v_add_f32 v24, v24, v2
    v_add_f32 v25, v25, v3
    v_lshlrev_b32 v4, 16, v49
    v_and_b32 v5, 0xffff0000, v49
    v_add_f32 v26, v26, v4
    v_add_f32 v27, v27, v5
    v_lshlrev_b32 v2, 16, v50
    v_and_b32 v3, 0xffff0000, v50
    v_add_f32 v28, v28, v2
    v_add_f32 v29, v29, v3
    v_lshlrev_b32 v4, 16, v51
    v_and_b32 v5, 0xffff0000, v51
    v_add_f32 v30, v30, v4
    v_add_f32 v31, v31, v5
    v_lshlrev_b32 v2, 16, v52
    v_and_b32 v3, 0xffff0000, v52
    v_add_f32 v24, v24, v2
    v_add_f32 v25, v25, v3
    v_lshlrev_b32 v4, 16, v53
    v_and_b32 v5, 0xffff0000, v53
    v_add_f32 v26, v26, v4
    v_add_f32 v27, v27, v5
    v_lshlrev_b32 v2, 16, v54
    v_and_b32 v3, 0xffff0000, v54
    v_add_f32 v28, v28, v2
    v_add_f32 v29, v29, v3
    v_lshlrev_b32 v4, 16, v55
    v_and_b32 v5, 0xffff0000, v55
    v_add_f32 v30, v30, v4
    v_add_f32 v31, v31, v5
    s_waitcnt vmcnt(11)
    s_waitcnt lgkmcnt(0)
    s_barrier
    v_permlane32_swap_b32 v24, v28
    v_permlane32_swap_b32 v25, v29
    v_permlane32_swap_b32 v26, v30
    v_permlane32_swap_b32 v27, v31
    v_add_f32 v24, v24, v28
    v_add_f32 v25, v25, v29
    v_add_f32 v26, v26, v30
    v_add_f32 v27, v27, v31
    s_nop 0
    v_permlane16_swap_b32 v24, v26
    v_permlane16_swap_b32 v25, v27
    v_add_f32 v24, v24, v26
    v_add_f32 v25, v25, v27
    s_nop 0
    v_add_f32 v24, v24, v24 row_ror:8 row_mask:0xf bank_mask:0xf
    v_add_f32 v25, v25, v25 row_ror:8 row_mask:0xf bank_mask:0xf
    v_and_b32 v2, 8, v1
    v_cmp_eq_u32 vcc, 0, v2
    s_nop 1
    v_cndmask_b32 v24, v25, v24, vcc
    buffer_store_dword v24, v253, s[48:51], s67 offen sc1
    s_add_u32 s3, s87, 0
    s_and_b32 s3, s3, 511
    s_or_b32 s3, s3, 1536
    s_mul_i32 s28, s3, 3072
    s_add_u32 m0, s30, 0
    s_nop 0
    buffer_load_dwordx4 v8, s[40:43], s3 offen offset:0 lds
    buffer_load_dwordx4 v9, s[40:43], s3 offen offset:1024 lds
    buffer_load_dwordx4 v10, s[40:43], s3 offen offset:2048 lds
    buffer_load_dwordx4 v11, s[40:43], s3 offen offset:3072 lds
    s_add_u32 m0, s31, 0
    s_nop 0
    buffer_load_dwordx4 v12, s[44:47], s28 offen offset:0 lds
    buffer_load_dwordx4 v13, s[44:47], s28 offen offset:1024 lds
    s_add_u32 m0, s31, 8192
    s_nop 0
    buffer_load_dwordx4 v14, s[44:47], s28 offen offset:0 lds
    buffer_load_dwordx4 v15, s[44:47], s28 offen offset:1024 lds
    s_add_u32 m0, s31, 16384
    s_nop 0
    buffer_load_dwordx4 v16, s[44:47], s28 offen offset:0 lds
    buffer_load_dwordx4 v17, s[44:47], s28 offen offset:1024 lds
    v_and_b32 v228, 0xffff0000, v72
    v_lshlrev_b32 v225, 16, v72
    v_rcp_f32 v226, v228
    v_mov_b32 v224, s70
    v_mul_f32 v227, 1069066811, v226
    s_waitcnt vmcnt(11)
    s_waitcnt lgkmcnt(0)
    s_barrier
    v_and_b32 v5, 0xffff0000, v116
    v_lshlrev_b32 v116, 16, v116
    v_rcp_f32 v117, v5
    v_lshlrev_b32 v96, 16, v64
    v_and_b32 v97, 0xffff0000, v64
    v_lshlrev_b32 v98, 16, v65
    v_and_b32 v99, 0xffff0000, v65
    v_lshlrev_b32 v100, 16, v66
    v_and_b32 v101, 0xffff0000, v66
    v_lshlrev_b32 v102, 16, v67
    v_and_b32 v103, 0xffff0000, v67
    v_lshlrev_b32 v104, 16, v68
    v_and_b32 v105, 0xffff0000, v68
    v_lshlrev_b32 v106, 16, v69
    v_and_b32 v107, 0xffff0000, v69
    v_lshlrev_b32 v108, 16, v70
    v_and_b32 v109, 0xffff0000, v70
    v_lshlrev_b32 v110, 16, v71
    v_and_b32 v111, 0xffff0000, v71
    v_mul_f32 v119, v116, v117
    v_fma_f32 v96, v96, v117, -v119
    v_fma_f32 v97, v97, v117, -v119
    v_fma_f32 v98, v98, v117, -v119
    v_fma_f32 v99, v99, v117, -v119
    v_fma_f32 v100, v100, v117, -v119
    v_fma_f32 v101, v101, v117, -v119
    v_fma_f32 v102, v102, v117, -v119
    v_fma_f32 v103, v103, v117, -v119
    v_fma_f32 v104, v104, v117, -v119
    v_fma_f32 v105, v105, v117, -v119
    v_fma_f32 v106, v106, v117, -v119
    v_fma_f32 v107, v107, v117, -v119
    v_fma_f32 v108, v108, v117, -v119
    v_fma_f32 v109, v109, v117, -v119
    v_fma_f32 v110, v110, v117, -v119
    v_fma_f32 v111, v111, v117, -v119
    v_mov_b32 v120, 0
    v_mov_b32 v121, 0
    v_mov_b32 v122, 0
    v_mov_b32 v123, 0
    v_mov_b32 v124, 0
    v_mov_b32 v125, 0
    v_mov_b32 v126, 0
    v_mov_b32 v127, 0
    s_add_u32 s3, s87, 128
    s_and_b32 s3, s3, 511
    s_or_b32 s3, s3, 1536
    s_mul_i32 s28, s3, 3072
    s_add_u32 m0, s30, 40960
    s_nop 0
    buffer_load_dwordx4 v8, s[40:43], s3 offen offset:0 lds
    buffer_load_dwordx4 v9, s[40:43], s3 offen offset:1024 lds
    buffer_load_dwordx4 v10, s[40:43], s3 offen offset:2048 lds
    buffer_load_dwordx4 v11, s[40:43], s3 offen offset:3072 lds
    s_add_u32 m0, s31, 40960
    s_nop 0
    buffer_load_dwordx4 v12, s[44:47], s28 offen offset:0 lds
    buffer_load_dwordx4 v13, s[44:47], s28 offen offset:1024 lds
    s_add_u32 m0, s31, 49152
    s_nop 0
    buffer_load_dwordx4 v14, s[44:47], s28 offen offset:0 lds
    buffer_load_dwordx4 v15, s[44:47], s28 offen offset:1024 lds
    s_add_u32 m0, s31, 57344
    s_nop 0
    buffer_load_dwordx4 v16, s[44:47], s28 offen offset:0 lds
    buffer_load_dwordx4 v17, s[44:47], s28 offen offset:1024 lds
    s_waitcnt vmcnt(10)
    s_waitcnt lgkmcnt(0)
    s_barrier
    s_add_u32 s3, s87, 256
    s_and_b32 s3, s3, 511
    s_or_b32 s3, s3, 1536
    s_mul_i32 s28, s3, 3072
    s_add_u32 m0, s30, 81920
    s_nop 0
    buffer_load_dwordx4 v8, s[40:43], s3 offen offset:0 lds
    buffer_load_dwordx4 v9, s[40:43], s3 offen offset:1024 lds
    buffer_load_dwordx4 v10, s[40:43], s3 offen offset:2048 lds
    buffer_load_dwordx4 v11, s[40:43], s3 offen offset:3072 lds
    s_add_u32 m0, s31, 81920
    s_nop 0
    buffer_load_dwordx4 v12, s[44:47], s28 offen offset:0 lds
    buffer_load_dwordx4 v13, s[44:47], s28 offen offset:1024 lds
    s_add_u32 m0, s31, 90112
    s_nop 0
    buffer_load_dwordx4 v14, s[44:47], s28 offen offset:0 lds
    buffer_load_dwordx4 v15, s[44:47], s28 offen offset:1024 lds
    s_add_u32 m0, s31, 98304
    s_nop 0
    buffer_load_dwordx4 v16, s[44:47], s28 offen offset:0 lds
    buffer_load_dwordx4 v17, s[44:47], s28 offen offset:1024 lds
    s_add_u32 s3, s79, 0
    buffer_store_dwordx4 v[248:251], v252, s[48:51], s3 offen sc1
    s_add_u32 s3, s79, 32768
    buffer_store_dwordx4 v[248:251], v252, s[48:51], s3 offen sc1
    s_waitcnt vmcnt(12)
    s_waitcnt lgkmcnt(0)
    s_barrier
    s_mul_i32 s3, s37, 12288
    s_mul_i32 s28, s38, 192
    s_add_u32 s3, s3, s28
    s_add_u32 s3, s3, 1048576
    s_add_u32 s28, s3, 6144
    buffer_load_dwordx4 v[80:83], v235, s[48:51], s3 offen offset:0 sc1
    buffer_load_dwordx4 v[84:87], v235, s[48:51], s3 offen offset:3072 sc1
    buffer_load_dwordx4 v[88:91], v235, s[48:51], s28 offen offset:0 sc1
    buffer_load_dwordx4 v[92:95], v235, s[48:51], s28 offen offset:3072 sc1
    s_add_u32 s3, s87, 384
    s_and_b32 s3, s3, 511
    s_or_b32 s3, s3, 1536
    s_mul_i32 s28, s3, 3072
    s_add_u32 m0, s30, 0
    s_nop 0
    buffer_load_dwordx4 v8, s[40:43], s3 offen offset:0 lds
    buffer_load_dwordx4 v9, s[40:43], s3 offen offset:1024 lds
    buffer_load_dwordx4 v10, s[40:43], s3 offen offset:2048 lds
    buffer_load_dwordx4 v11, s[40:43], s3 offen offset:3072 lds
    s_add_u32 m0, s31, 0
    s_nop 0
    buffer_load_dwordx4 v12, s[44:47], s28 offen offset:0 lds
    buffer_load_dwordx4 v13, s[44:47], s28 offen offset:1024 lds
    s_add_u32 m0, s31, 8192
    s_nop 0
    buffer_load_dwordx4 v14, s[44:47], s28 offen offset:0 lds
    buffer_load_dwordx4 v15, s[44:47], s28 offen offset:1024 lds
    s_add_u32 m0, s31, 16384
    s_nop 0
    buffer_load_dwordx4 v16, s[44:47], s28 offen offset:0 lds
    buffer_load_dwordx4 v17, s[44:47], s28 offen offset:1024 lds
    s_add_u32 s3, s79, 65536
    buffer_store_dwordx4 v[248:251], v252, s[48:51], s3 offen sc1
    s_add_u32 s3, s79, 98304
    buffer_store_dwordx4 v[248:251], v252, s[48:51], s3 offen sc1
    s_waitcnt vmcnt(18)
    s_waitcnt lgkmcnt(0)
    s_barrier
    s_mov_b32 s3, 0
    buffer_load_dwordx4 v[128:131], v21, s[52:55], s3 offen nt
    s_mov_b32 s3, 7168
    buffer_load_dwordx4 v[132:135], v21, s[52:55], s3 offen nt
    s_mov_b32 s3, 14336
    buffer_load_dwordx4 v[136:139], v21, s[52:55], s3 offen nt
    s_mov_b32 s3, 21504
    buffer_load_dwordx4 v[140:143], v21, s[52:55], s3 offen nt
    s_mov_b32 s3, 28672
    buffer_load_dwordx4 v[144:147], v21, s[52:55], s3 offen nt
    s_mov_b32 s3, 35840
    buffer_load_dwordx4 v[148:151], v21, s[52:55], s3 offen nt
    s_mov_b32 s3, 43008
    buffer_load_dwordx4 v[152:155], v21, s[52:55], s3 offen nt
    s_mov_b32 s3, 50176
    buffer_load_dwordx4 v[156:159], v21, s[52:55], s3 offen nt
    s_waitcnt vmcnt(20)
    s_mov_b32 s29, 0
L_k2:
    v_max3_u32 v2, v80, v81, v82
    v_max3_u32 v2, v2, v83, v84
    v_max3_u32 v2, v2, v85, v86
    v_max3_u32 v2, v2, v87, v88
    v_max3_u32 v2, v2, v89, v90
    v_max3_u32 v2, v2, v91, v92
    v_max3_u32 v2, v2, v93, v94
    v_max_u32 v2, v2, v95
    v_cmp_eq_u32 vcc, -1, v2
    s_cbranch_vccz L_k2k
    s_add_u32 s29, s29, 1
    s_cmp_ge_u32 s29, 200000
    s_cbranch_scc1 L_k2k
    s_sleep 1
    s_mul_i32 s3, s37, 12288
    s_mul_i32 s28, s38, 192
    s_add_u32 s3, s3, s28
    s_add_u32 s3, s3, 1048576
    s_add_u32 s28, s3, 6144
    buffer_load_dwordx4 v[80:83], v235, s[48:51], s3 offen offset:0 sc1
    buffer_load_dwordx4 v[84:87], v235, s[48:51], s3 offen offset:3072 sc1
    buffer_load_dwordx4 v[88:91], v235, s[48:51], s28 offen offset:0 sc1
    buffer_load_dwordx4 v[92:95], v235, s[48:51], s28 offen offset:3072 sc1
    s_waitcnt vmcnt(0)
    s_branch L_k2
L_k2k:
    v_add_f32 v80, v80, v88
    v_add_f32 v81, v81, v89
    v_add_f32 v82, v82, v90
    v_add_f32 v83, v83, v91
    v_add_f32 v84, v84, v92
    v_add_f32 v85, v85, v93
    v_add_f32 v86, v86, v94
    v_add_f32 v87, v87, v95
    v_add_f32 v80, v80, v84
    v_add_f32 v81, v81, v85
    v_add_f32 v82, v82, v86
    v_add_f32 v83, v83, v87
    s_nop 0
    v_permlane32_swap_b32 v80, v82
    v_permlane32_swap_b32 v81, v83
    v_add_f32 v80, v80, v82
    v_add_f32 v81, v81, v83
    s_nop 1
    v_permlane16_swap_b32 v80, v81
    v_add_f32 v80, v80, v81
    ds_write_b32 v234, v224
    ds_write_b32 v230, v225
    ds_write_b32 v230, v226 offset:1024
    ds_write_b32 v233, v80
    s_mov_b32 exec_hi, 0
    ds_write_b32 v230, v227 offset:2048
    ds_write_b16_d16_hi v231, v228
    s_mov_b64 exec, -1
    s_waitcnt lgkmcnt(0)
    s_waitcnt vmcnt(10)
    s_waitcnt lgkmcnt(0)
    s_barrier
    s_mov_b32 s3, 57344
    buffer_load_dwordx4 v[160:163], v21, s[52:55], s3 offen nt
    s_mov_b32 s3, 64512
    buffer_load_dwordx4 v[164:167], v21, s[52:55], s3 offen nt
    s_mov_b32 s3, 71680
    buffer_load_dwordx4 v[168:171], v21, s[52:55], s3 offen nt
    s_mov_b32 s3, 78848
    buffer_load_dwordx4 v[172:175], v21, s[52:55], s3 offen nt
    s_mov_b32 s3, 86016
    buffer_load_dwordx4 v[176:179], v21, s[52:55], s3 offen nt
    s_mov_b32 s3, 93184
    buffer_load_dwordx4 v[180:183], v21, s[52:55], s3 offen nt
    s_mov_b32 s3, 100352
    buffer_load_dwordx4 v[184:187], v21, s[52:55], s3 offen nt
    s_mov_b32 s3, 107520
    buffer_load_dwordx4 v[188:191], v21, s[52:55], s3 offen nt
    s_waitcnt vmcnt(12)
    v_lshlrev_b32 v2, 16, v128
    v_and_b32 v3, 0xffff0000, v128
    v_fmac_f32 v120, v2, v96
    v_fmac_f32 v121, v3, v96
    v_lshlrev_b32 v4, 16, v129
    v_and_b32 v5, 0xffff0000, v129
    v_fmac_f32 v122, v4, v96
    v_fmac_f32 v123, v5, v96
    v_lshlrev_b32 v2, 16, v130
    v_and_b32 v3, 0xffff0000, v130
    v_fmac_f32 v124, v2, v96
    v_fmac_f32 v125, v3, v96
    v_lshlrev_b32 v4, 16, v131
    v_and_b32 v5, 0xffff0000, v131
    v_fmac_f32 v126, v4, v96
    v_fmac_f32 v127, v5, v96
    v_lshlrev_b32 v2, 16, v132
    v_and_b32 v3, 0xffff0000, v132
    v_fmac_f32 v120, v2, v97
    v_fmac_f32 v121, v3, v97
    v_lshlrev_b32 v4, 16, v133
    v_and_b32 v5, 0xffff0000, v133
    v_fmac_f32 v122, v4, v97
    v_fmac_f32 v123, v5, v97
    v_lshlrev_b32 v2, 16, v134
    v_and_b32 v3, 0xffff0000, v134
    v_fmac_f32 v124, v2, v97
    v_fmac_f32 v125, v3, v97
    v_lshlrev_b32 v4, 16, v135
    v_and_b32 v5, 0xffff0000, v135
    v_fmac_f32 v126, v4, v97
    v_fmac_f32 v127, v5, v97
    v_lshlrev_b32 v2, 16, v136
    v_and_b32 v3, 0xffff0000, v136
    v_fmac_f32 v120, v2, v98
    v_fmac_f32 v121, v3, v98
    v_lshlrev_b32 v4, 16, v137
    v_and_b32 v5, 0xffff0000, v137
    v_fmac_f32 v122, v4, v98
    v_fmac_f32 v123, v5, v98
    v_lshlrev_b32 v2, 16, v138
    v_and_b32 v3, 0xffff0000, v138
    v_fmac_f32 v124, v2, v98
    v_fmac_f32 v125, v3, v98
    v_lshlrev_b32 v4, 16, v139
    v_and_b32 v5, 0xffff0000, v139
    v_fmac_f32 v126, v4, v98
    v_fmac_f32 v127, v5, v98
    v_lshlrev_b32 v2, 16, v140
    v_and_b32 v3, 0xffff0000, v140
    v_fmac_f32 v120, v2, v99
    v_fmac_f32 v121, v3, v99
    v_lshlrev_b32 v4, 16, v141
    v_and_b32 v5, 0xffff0000, v141
    v_fmac_f32 v122, v4, v99
    v_fmac_f32 v123, v5, v99
    v_lshlrev_b32 v2, 16, v142
    v_and_b32 v3, 0xffff0000, v142
    v_fmac_f32 v124, v2, v99
    v_fmac_f32 v125, v3, v99
    v_lshlrev_b32 v4, 16, v143
    v_and_b32 v5, 0xffff0000, v143
    v_fmac_f32 v126, v4, v99
    v_fmac_f32 v127, v5, v99
    s_barrier
    s_waitcnt vmcnt(8)
    v_lshlrev_b32 v2, 16, v144
    v_and_b32 v3, 0xffff0000, v144
    v_pk_fma_f32 v[120:121], v[2:3], v[100:101], v[120:121] op_sel_hi:[1,0,1]
    v_lshlrev_b32 v4, 16, v145
    v_and_b32 v5, 0xffff0000, v145
    v_pk_fma_f32 v[122:123], v[4:5], v[100:101], v[122:123] op_sel_hi:[1,0,1]
    v_lshlrev_b32 v2, 16, v146
    v_and_b32 v3, 0xffff0000, v146
    v_pk_fma_f32 v[124:125], v[2:3], v[100:101], v[124:125] op_sel_hi:[1,0,1]
    v_lshlrev_b32 v4, 16, v147
    v_and_b32 v5, 0xffff0000, v147
    v_pk_fma_f32 v[126:127], v[4:5], v[100:101], v[126:127] op_sel_hi:[1,0,1]
    v_lshlrev_b32 v2, 16, v148
    v_and_b32 v3, 0xffff0000, v148
    v_pk_fma_f32 v[120:121], v[2:3], v[100:101], v[120:121] op_sel:[0,1,0]
    v_lshlrev_b32 v4, 16, v149
    v_and_b32 v5, 0xffff0000, v149
    v_pk_fma_f32 v[122:123], v[4:5], v[100:101], v[122:123] op_sel:[0,1,0]
    v_lshlrev_b32 v2, 16, v150
    v_and_b32 v3, 0xffff0000, v150
    v_pk_fma_f32 v[124:125], v[2:3], v[100:101], v[124:125] op_sel:[0,1,0]
    v_lshlrev_b32 v4, 16, v151
    v_and_b32 v5, 0xffff0000, v151
    v_pk_fma_f32 v[126:127], v[4:5], v[100:101], v[126:127] op_sel:[0,1,0]
    v_lshlrev_b32 v2, 16, v152
    v_and_b32 v3, 0xffff0000, v152
    v_pk_fma_f32 v[120:121], v[2:3], v[102:103], v[120:121] op_sel_hi:[1,0,1]
    v_lshlrev_b32 v4, 16, v153
    v_and_b32 v5, 0xffff0000, v153
    v_pk_fma_f32 v[122:123], v[4:5], v[102:103], v[122:123] op_sel_hi:[1,0,1]
    v_lshlrev_b32 v2, 16, v154
    v_and_b32 v3, 0xffff0000, v154
    v_pk_fma_f32 v[124:125], v[2:3], v[102:103], v[124:125] op_sel_hi:[1,0,1]
    v_lshlrev_b32 v4, 16, v155
    v_and_b32 v5, 0xffff0000, v155
    v_pk_fma_f32 v[126:127], v[4:5], v[102:103], v[126:127] op_sel_hi:[1,0,1]
    v_lshlrev_b32 v2, 16, v156
    v_and_b32 v3, 0xffff0000, v156
    v_pk_fma_f32 v[120:121], v[2:3], v[102:103], v[120:121] op_sel:[0,1,0]
    v_lshlrev_b32 v4, 16, v157
    v_and_b32 v5, 0xffff0000, v157
    v_pk_fma_f32 v[122:123], v[4:5], v[102:103], v[122:123] op_sel:[0,1,0]
    v_lshlrev_b32 v2, 16, v158
    v_and_b32 v3, 0xffff0000, v158
    v_pk_fma_f32 v[124:125], v[2:3], v[102:103], v[124:125] op_sel:[0,1,0]
    v_lshlrev_b32 v4, 16, v159
    v_and_b32 v5, 0xffff0000, v159
    v_pk_fma_f32 v[126:127], v[4:5], v[102:103], v[126:127] op_sel:[0,1,0]
    s_waitcnt vmcnt(0)
    s_lshl_b32 s3, s36, 4
    s_add_u32 s3, s3, s37
    s_lshl_b32 s3, s3, 2
    s_add_u32 s3, s3, s38
    s_lshl_b32 s3, s3, 5
    s_add_u32 s3, s3, 32768
    v_mov_b32 v2, s86
    s_mov_b64 exec, 1
    buffer_store_dword v2, v252, s[48:51], s3 offen sc1
    s_mov_b64 exec, -1
    s_add_u32 m0, s72, 49152
    s_add_u32 s3, s73, 786432
    buffer_load_dwordx4 v220, s[88:91], s3 offen offset:0 lds
    buffer_load_dwordx4 v221, s[88:91], s3 offen offset:1024 lds
    buffer_load_dwordx4 v222, s[88:91], s3 offen offset:2048 lds
    buffer_load_dwordx4 v223, s[88:91], s3 offen offset:3072 lds
    s_add_u32 m0, s72, 65536
    s_add_u32 s3, s73, 1048576
    buffer_load_dwordx4 v220, s[88:91], s3 offen offset:0 lds
    buffer_load_dwordx4 v221, s[88:91], s3 offen offset:1024 lds
    buffer_load_dwordx4 v222, s[88:91], s3 offen offset:2048 lds
    buffer_load_dwordx4 v223, s[88:91], s3 offen offset:3072 lds
    s_lshl_b32 s3, s38, 1
    s_lshr_b32 s28, s39, 2
    s_add_u32 s3, s3, s28
    s_lshl_b32 s69, s3, 4
    s_lshl_b32 s3, s34, 7
    s_add_u32 s3, s3, s69
    v_and_b32 v2, 15, v1
    v_add_u32 v23, s3, v2
    v_lshlrev_b32 v23, 11, v23
    v_lshrrev_b32 v2, 4, v1
    v_lshl_add_u32 v23, v2, 3, v23
    s_lshl_b32 s3, s35, 7
    v_add_u32 v23, s3, v23
    buffer_load_dwordx2 v[240:241], v23, s[40:43], 0 offen offset:0
    buffer_load_dwordx2 v[242:243], v23, s[40:43], 0 offen offset:32
    buffer_load_dwordx2 v[244:245], v23, s[40:43], 0 offen offset:64
    buffer_load_dwordx2 v[246:247], v23, s[40:43], 0 offen offset:96
    v_lshlrev_b32 v2, 16, v160
    v_and_b32 v3, 0xffff0000, v160
    v_pk_fma_f32 v[120:121], v[2:3], v[104:105], v[120:121] op_sel_hi:[1,0,1]
    v_lshlrev_b32 v4, 16, v161
    v_and_b32 v5, 0xffff0000, v161
    v_pk_fma_f32 v[122:123], v[4:5], v[104:105], v[122:123] op_sel_hi:[1,0,1]
    v_lshlrev_b32 v2, 16, v162
    v_and_b32 v3, 0xffff0000, v162
    v_pk_fma_f32 v[124:125], v[2:3], v[104:105], v[124:125] op_sel_hi:[1,0,1]
    v_lshlrev_b32 v4, 16, v163
    v_and_b32 v5, 0xffff0000, v163
    v_pk_fma_f32 v[126:127], v[4:5], v[104:105], v[126:127] op_sel_hi:[1,0,1]
    v_lshlrev_b32 v2, 16, v164
    v_and_b32 v3, 0xffff0000, v164
    v_pk_fma_f32 v[120:121], v[2:3], v[104:105], v[120:121] op_sel:[0,1,0]
    v_lshlrev_b32 v4, 16, v165
    v_and_b32 v5, 0xffff0000, v165
    v_pk_fma_f32 v[122:123], v[4:5], v[104:105], v[122:123] op_sel:[0,1,0]
    v_lshlrev_b32 v2, 16, v166
    v_and_b32 v3, 0xffff0000, v166
    v_pk_fma_f32 v[124:125], v[2:3], v[104:105], v[124:125] op_sel:[0,1,0]
    v_lshlrev_b32 v4, 16, v167
    v_and_b32 v5, 0xffff0000, v167
    v_pk_fma_f32 v[126:127], v[4:5], v[104:105], v[126:127] op_sel:[0,1,0]
    v_lshlrev_b32 v2, 16, v168
    v_and_b32 v3, 0xffff0000, v168
    v_pk_fma_f32 v[120:121], v[2:3], v[106:107], v[120:121] op_sel_hi:[1,0,1]
    v_lshlrev_b32 v4, 16, v169
    v_and_b32 v5, 0xffff0000, v169
    v_pk_fma_f32 v[122:123], v[4:5], v[106:107], v[122:123] op_sel_hi:[1,0,1]
    v_lshlrev_b32 v2, 16, v170
    v_and_b32 v3, 0xffff0000, v170
    v_pk_fma_f32 v[124:125], v[2:3], v[106:107], v[124:125] op_sel_hi:[1,0,1]
    v_lshlrev_b32 v4, 16, v171
    v_and_b32 v5, 0xffff0000, v171
    v_pk_fma_f32 v[126:127], v[4:5], v[106:107], v[126:127] op_sel_hi:[1,0,1]
    v_lshlrev_b32 v2, 16, v172
    v_and_b32 v3, 0xffff0000, v172
    v_pk_fma_f32 v[120:121], v[2:3], v[106:107], v[120:121] op_sel:[0,1,0]
    v_lshlrev_b32 v4, 16, v173
    v_and_b32 v5, 0xffff0000, v173
    v_pk_fma_f32 v[122:123], v[4:5], v[106:107], v[122:123] op_sel:[0,1,0]
    v_lshlrev_b32 v2, 16, v174
    v_and_b32 v3, 0xffff0000, v174
    v_pk_fma_f32 v[124:125], v[2:3], v[106:107], v[124:125] op_sel:[0,1,0]
    v_lshlrev_b32 v4, 16, v175
    v_and_b32 v5, 0xffff0000, v175
    v_pk_fma_f32 v[126:127], v[4:5], v[106:107], v[126:127] op_sel:[0,1,0]
    v_lshlrev_b32 v2, 16, v176
    v_and_b32 v3, 0xffff0000, v176
    v_pk_fma_f32 v[120:121], v[2:3], v[108:109], v[120:121] op_sel_hi:[1,0,1]
    v_lshlrev_b32 v4, 16, v177
    v_and_b32 v5, 0xffff0000, v177
    v_pk_fma_f32 v[122:123], v[4:5], v[108:109], v[122:123] op_sel_hi:[1,0,1]
    v_lshlrev_b32 v2, 16, v178
    v_and_b32 v3, 0xffff0000, v178
    v_pk_fma_f32 v[124:125], v[2:3], v[108:109], v[124:125] op_sel_hi:[1,0,1]
    v_lshlrev_b32 v4, 16, v179
    v_and_b32 v5, 0xffff0000, v179
    v_pk_fma_f32 v[126:127], v[4:5], v[108:109], v[126:127] op_sel_hi:[1,0,1]
    v_lshlrev_b32 v2, 16, v180
    v_and_b32 v3, 0xffff0000, v180
    v_pk_fma_f32 v[120:121], v[2:3], v[108:109], v[120:121] op_sel:[0,1,0]
    v_lshlrev_b32 v4, 16, v181
    v_and_b32 v5, 0xffff0000, v181
    v_pk_fma_f32 v[122:123], v[4:5], v[108:109], v[122:123] op_sel:[0,1,0]
    v_lshlrev_b32 v2, 16, v182
    v_and_b32 v3, 0xffff0000, v182
    v_pk_fma_f32 v[124:125], v[2:3], v[108:109], v[124:125] op_sel:[0,1,0]
    v_lshlrev_b32 v4, 16, v183
    v_and_b32 v5, 0xffff0000, v183
    v_pk_fma_f32 v[126:127], v[4:5], v[108:109], v[126:127] op_sel:[0,1,0]
    v_lshlrev_b32 v2, 16, v184
    v_and_b32 v3, 0xffff0000, v184
    v_pk_fma_f32 v[120:121], v[2:3], v[110:111], v[120:121] op_sel_hi:[1,0,1]
    v_lshlrev_b32 v4, 16, v185
    v_and_b32 v5, 0xffff0000, v185
    v_pk_fma_f32 v[122:123], v[4:5], v[110:111], v[122:123] op_sel_hi:[1,0,1]
    v_lshlrev_b32 v2, 16, v186
    v_and_b32 v3, 0xffff0000, v186
    v_pk_fma_f32 v[124:125], v[2:3], v[110:111], v[124:125] op_sel_hi:[1,0,1]
    v_lshlrev_b32 v4, 16, v187
    v_and_b32 v5, 0xffff0000, v187
    v_pk_fma_f32 v[126:127], v[4:5], v[110:111], v[126:127] op_sel_hi:[1,0,1]
    v_lshlrev_b32 v2, 16, v188
    v_and_b32 v3, 0xffff0000, v188
    v_pk_fma_f32 v[120:121], v[2:3], v[110:111], v[120:121] op_sel:[0,1,0]
    v_lshlrev_b32 v4, 16, v189
    v_and_b32 v5, 0xffff0000, v189
    v_pk_fma_f32 v[122:123], v[4:5], v[110:111], v[122:123] op_sel:[0,1,0]
    v_lshlrev_b32 v2, 16, v190
    v_and_b32 v3, 0xffff0000, v190
    v_pk_fma_f32 v[124:125], v[2:3], v[110:111], v[124:125] op_sel:[0,1,0]
    v_lshlrev_b32 v4, 16, v191
    v_and_b32 v5, 0xffff0000, v191
    v_pk_fma_f32 v[126:127], v[4:5], v[110:111], v[126:127] op_sel:[0,1,0]
    v_permlane32_swap_b32 v120, v124
    v_permlane32_swap_b32 v121, v125
    v_permlane32_swap_b32 v122, v126
    v_permlane32_swap_b32 v123, v127
    v_add_f32 v120, v120, v124
    v_add_f32 v121, v121, v125
    v_add_f32 v122, v122, v126
    v_add_f32 v123, v123, v127
    s_nop 0
    v_permlane16_swap_b32 v120, v122
    v_permlane16_swap_b32 v121, v123
    v_add_f32 v120, v120, v122
    v_add_f32 v121, v121, v123
    s_nop 0
    v_add_f32 v120, v120, v120 row_ror:8 row_mask:0xf bank_mask:0xf
    v_add_f32 v121, v121, v121 row_ror:8 row_mask:0xf bank_mask:0xf
    v_and_b32 v2, 8, v1
    v_cmp_eq_u32 vcc, 0, v2
    s_nop 1
    v_cndmask_b32 v120, v121, v120, vcc
    buffer_store_dword v120, v253, s[48:51], s84 offen sc1
    v_mov_b32 v3, 162112
L_fw:
    ds_read_b128 v[4:7], v3
    s_waitcnt lgkmcnt(0)
    v_and_b32 v4, v4, v5
    v_and_b32 v6, v6, v7
    v_and_b32 v4, v4, v6
    s_nop 0
    v_readfirstlane_b32 s3, v4
    s_nop 0
    s_bitcmp1_b32 s3, 0
    s_cbranch_scc1 L_fk
    s_sleep 1
    s_branch L_fw
L_fk:
    s_setprio 3
    s_add_u32 s3, s76, 0
    buffer_load_dwordx4 v[48:51], v112, s[48:51], s3 offen sc1
    s_add_u32 s3, s76, 33792
    buffer_load_dwordx4 v[52:55], v112, s[48:51], s3 offen sc1
    s_add_u32 s3, s76, 67584
    buffer_load_dwordx4 v[56:59], v112, s[48:51], s3 offen sc1
    s_add_u32 s3, s76, 101376
    buffer_load_dwordx4 v[60:63], v112, s[48:51], s3 offen sc1
    s_cmp_lg_u32 s83, 0
    s_cbranch_scc1 L_nz
    s_add_u32 s3, s81, 0
    buffer_load_dwordx4 v[32:35], v112, s[48:51], s3 offen sc1
    s_add_u32 s3, s81, 33792
    buffer_load_dwordx4 v[36:39], v112, s[48:51], s3 offen sc1
    s_add_u32 s3, s81, 67584
    buffer_load_dwordx4 v[40:43], v112, s[48:51], s3 offen sc1
    s_add_u32 s3, s81, 101376
    buffer_load_dwordx4 v[44:47], v112, s[48:51], s3 offen sc1
L_nz:
    s_waitcnt vmcnt(0)
L_h1:
    s_mov_b32 s29, 0
L_k4:
    v_max3_u32 v2, v48, v49, v50
    v_max3_u32 v2, v2, v51, v52
    v_max3_u32 v2, v2, v53, v54
    v_max3_u32 v2, v2, v55, v56
    v_max3_u32 v2, v2, v57, v58
    v_max3_u32 v2, v2, v59, v60
    v_max3_u32 v2, v2, v61, v62
    v_max_u32 v2, v2, v63
    v_cmp_eq_u32 vcc, -1, v2
    s_cbranch_vccz L_k4k
    s_add_u32 s29, s29, 1
    s_cmp_ge_u32 s29, 200000
    s_cbranch_scc1 L_k4k
    s_sleep 1
    s_add_u32 s3, s76, 0
    buffer_load_dwordx4 v[48:51], v112, s[48:51], s3 offen sc1
    s_add_u32 s3, s76, 33792
    buffer_load_dwordx4 v[52:55], v112, s[48:51], s3 offen sc1
    s_add_u32 s3, s76, 67584
    buffer_load_dwordx4 v[56:59], v112, s[48:51], s3 offen sc1
    s_add_u32 s3, s76, 101376
    buffer_load_dwordx4 v[60:63], v112, s[48:51], s3 offen sc1
    s_waitcnt vmcnt(0)
    s_branch L_k4
L_k4k:
    s_cmp_eq_u32 s76, s81
    s_cbranch_scc1 L_nw1
    s_add_u32 m0, s72, 81920
    s_add_u32 s3, s73, 1310720
    buffer_load_dwordx4 v220, s[88:91], s3 offen offset:0 lds
    buffer_load_dwordx4 v221, s[88:91], s3 offen offset:1024 lds
    buffer_load_dwordx4 v222, s[88:91], s3 offen offset:2048 lds
    buffer_load_dwordx4 v223, s[88:91], s3 offen offset:3072 lds
    s_add_u32 m0, s72, 98304
    s_add_u32 s3, s73, 1572864
    buffer_load_dwordx4 v220, s[88:91], s3 offen offset:0 lds
    buffer_load_dwordx4 v221, s[88:91], s3 offen offset:1024 lds
    buffer_load_dwordx4 v222, s[88:91], s3 offen offset:2048 lds
    buffer_load_dwordx4 v223, s[88:91], s3 offen offset:3072 lds
L_nw1:
    v_lshlrev_b32 v64, 16, v48
    v_and_b32 v65, 0xffff0000, v48
    v_lshlrev_b32 v66, 16, v49
    v_and_b32 v67, 0xffff0000, v49
    v_lshlrev_b32 v68, 16, v50
    v_and_b32 v69, 0xffff0000, v50
    v_lshlrev_b32 v70, 16, v51
    v_and_b32 v71, 0xffff0000, v51
    v_lshlrev_b32 v72, 16, v52
    v_and_b32 v73, 0xffff0000, v52
    v_pk_add_f32 v[64:65], v[64:65], v[72:73]
    v_lshlrev_b32 v74, 16, v53
    v_and_b32 v75, 0xffff0000, v53
    v_pk_add_f32 v[66:67], v[66:67], v[74:75]
    v_lshlrev_b32 v76, 16, v54
    v_and_b32 v77, 0xffff0000, v54
    v_pk_add_f32 v[68:69], v[68:69], v[76:77]
    v_lshlrev_b32 v78, 16, v55
    v_and_b32 v79, 0xffff0000, v55
    v_pk_add_f32 v[70:71], v[70:71], v[78:79]
    v_lshlrev_b32 v72, 16, v56
    v_and_b32 v73, 0xffff0000, v56
    v_pk_add_f32 v[64:65], v[64:65], v[72:73]
    v_lshlrev_b32 v74, 16, v57
    v_and_b32 v75, 0xffff0000, v57
    v_pk_add_f32 v[66:67], v[66:67], v[74:75]
    v_lshlrev_b32 v76, 16, v58
    v_and_b32 v77, 0xffff0000, v58
    v_pk_add_f32 v[68:69], v[68:69], v[76:77]
    v_lshlrev_b32 v78, 16, v59
    v_and_b32 v79, 0xffff0000, v59
    v_pk_add_f32 v[70:71], v[70:71], v[78:79]
    v_lshlrev_b32 v72, 16, v60
    v_and_b32 v73, 0xffff0000, v60
    v_pk_add_f32 v[64:65], v[64:65], v[72:73]
    v_lshlrev_b32 v74, 16, v61
    v_and_b32 v75, 0xffff0000, v61
    v_pk_add_f32 v[66:67], v[66:67], v[74:75]
    v_lshlrev_b32 v76, 16, v62
    v_and_b32 v77, 0xffff0000, v62
    v_pk_add_f32 v[68:69], v[68:69], v[76:77]
    v_lshlrev_b32 v78, 16, v63
    v_and_b32 v79, 0xffff0000, v63
    v_pk_add_f32 v[70:71], v[70:71], v[78:79]
    v_permlane32_swap_b32 v64, v68
    v_permlane32_swap_b32 v65, v69
    v_permlane32_swap_b32 v66, v70
    v_permlane32_swap_b32 v67, v71
    v_add_f32 v64, v64, v68
    v_add_f32 v65, v65, v69
    v_add_f32 v66, v66, v70
    v_add_f32 v67, v67, v71
    s_nop 0
    v_permlane16_swap_b32 v64, v66
    v_permlane16_swap_b32 v65, v67
    v_add_f32 v64, v64, v66
    v_add_f32 v65, v65, v67
    s_nop 0
    v_add_f32 v64, v64, v64 row_ror:8 row_mask:0xf bank_mask:0xf
    v_add_f32 v65, v65, v65 row_ror:8 row_mask:0xf bank_mask:0xf
    v_cvt_pk_bf16_f32 v64, v64, v65
    v_mov_b32 v65, v64
    s_nop 1
    v_permlane16_swap_b32 v64, v65
    v_mov_b32 v66, v64
    v_mov_b32 v67, v65
    s_nop 0
    v_permlane32_swap_b32 v64, v66
    v_permlane32_swap_b32 v65, v67
    s_mov_b64 exec, 0xff
    buffer_store_dwordx4 v[64:67], v252, s[48:51], s74 offen sc1
    s_mov_b64 exec, -1
    s_cmp_lg_u32 s83, 0
    s_cbranch_scc1 L_h1e
    s_mov_b32 s83, 1
    s_mov_b32 s76, s81
    s_mov_b32 s74, s82
    v_mov_b64 v[48:49], v[32:33]
    v_mov_b64 v[50:51], v[34:35]
    v_mov_b64 v[52:53], v[36:37]
    v_mov_b64 v[54:55], v[38:39]
    v_mov_b64 v[56:57], v[40:41]
    v_mov_b64 v[58:59], v[42:43]
    v_mov_b64 v[60:61], v[44:45]
    v_mov_b64 v[62:63], v[46:47]
    s_branch L_h1
L_h1e:
    s_lshl_b32 s3, s38, 2
    s_add_u32 s3, s3, 162112
    v_mov_b32 v4, s3
    v_mov_b32 v5, 3
    ds_write_b32 v4, v5
    s_setprio 0
    v_and_b32 v2, 15, v1
    v_min_u32 v2, 13, v2
    v_lshrrev_b32 v3, 4, v1
    v_mul_u32_u24 v3, 14336, v3
    v_lshl_add_u32 v13, v2, 4, v3
    s_lshl_b32 s76, s71, 2
    s_add_u32 s76, s76, 1380352
    s_add_u32 s3, s76, 0
    buffer_load_dwordx4 v[48:51], v13, s[48:51], s3 offen sc1
    s_add_u32 s3, s76, 57344
    buffer_load_dwordx4 v[52:55], v13, s[48:51], s3 offen sc1
    s_add_u32 s3, s76, 114688
    buffer_load_dwordx4 v[56:59], v13, s[48:51], s3 offen sc1
    s_add_u32 s3, s76, 172032
    buffer_load_dwordx4 v[60:63], v13, s[48:51], s3 offen sc1
    v_and_b32 v2, 15, v1
    v_add_u32 v2, s69, v2
    v_lshlrev_b32 v2, 2, v2
    v_add_u32 v2, 152576, v2
    ds_read_b32 v8, v2
    ds_read_b32 v9, v2 offset:1024
    s_waitcnt lgkmcnt(0)
    v_mul_f32 v28, v8, v9
    v_mul_f32 v30, 0xbfb8aa3b, v9
    v_mul_f32 v31, 1069066811, v28
    v_mov_b32 v29, v9
    v_lshlrev_b32 v224, 16, v240
    v_and_b32 v225, 0xffff0000, v240
    v_lshlrev_b32 v226, 16, v241
    v_and_b32 v227, 0xffff0000, v241
    v_lshlrev_b32 v228, 16, v242
    v_and_b32 v229, 0xffff0000, v242
    v_lshlrev_b32 v230, 16, v243
    v_and_b32 v231, 0xffff0000, v243
    v_lshlrev_b32 v232, 16, v244
    v_and_b32 v233, 0xffff0000, v244
    v_lshlrev_b32 v234, 16, v245
    v_and_b32 v235, 0xffff0000, v245
    v_lshlrev_b32 v236, 16, v246
    v_and_b32 v237, 0xffff0000, v246
    v_lshlrev_b32 v238, 16, v247
    v_and_b32 v239, 0xffff0000, v247
    v_pk_fma_f32 v[32:33], v[224:225], v[30:31], v[30:31] op_sel:[0,0,1] op_sel_hi:[1,0,1]
    v_pk_fma_f32 v[34:35], v[226:227], v[30:31], v[30:31] op_sel:[0,0,1] op_sel_hi:[1,0,1]
    v_pk_fma_f32 v[36:37], v[228:229], v[30:31], v[30:31] op_sel:[0,0,1] op_sel_hi:[1,0,1]
    v_pk_fma_f32 v[38:39], v[230:231], v[30:31], v[30:31] op_sel:[0,0,1] op_sel_hi:[1,0,1]
    v_pk_fma_f32 v[40:41], v[232:233], v[30:31], v[30:31] op_sel:[0,0,1] op_sel_hi:[1,0,1]
    v_pk_fma_f32 v[42:43], v[234:235], v[30:31], v[30:31] op_sel:[0,0,1] op_sel_hi:[1,0,1]
    v_pk_fma_f32 v[44:45], v[236:237], v[30:31], v[30:31] op_sel:[0,0,1] op_sel_hi:[1,0,1]
    v_pk_fma_f32 v[46:47], v[238:239], v[30:31], v[30:31] op_sel:[0,0,1] op_sel_hi:[1,0,1]
    v_pk_fma_f32 v[224:225], v[224:225], v[28:29], v[28:29] op_sel:[0,1,0] op_sel_hi:[1,1,0] neg_lo:[0,0,1] neg_hi:[0,0,1]
    v_pk_fma_f32 v[226:227], v[226:227], v[28:29], v[28:29] op_sel:[0,1,0] op_sel_hi:[1,1,0] neg_lo:[0,0,1] neg_hi:[0,0,1]
    v_pk_fma_f32 v[228:229], v[228:229], v[28:29], v[28:29] op_sel:[0,1,0] op_sel_hi:[1,1,0] neg_lo:[0,0,1] neg_hi:[0,0,1]
    v_pk_fma_f32 v[230:231], v[230:231], v[28:29], v[28:29] op_sel:[0,1,0] op_sel_hi:[1,1,0] neg_lo:[0,0,1] neg_hi:[0,0,1]
    v_pk_fma_f32 v[232:233], v[232:233], v[28:29], v[28:29] op_sel:[0,1,0] op_sel_hi:[1,1,0] neg_lo:[0,0,1] neg_hi:[0,0,1]
    v_pk_fma_f32 v[234:235], v[234:235], v[28:29], v[28:29] op_sel:[0,1,0] op_sel_hi:[1,1,0] neg_lo:[0,0,1] neg_hi:[0,0,1]
    v_pk_fma_f32 v[236:237], v[236:237], v[28:29], v[28:29] op_sel:[0,1,0] op_sel_hi:[1,1,0] neg_lo:[0,0,1] neg_hi:[0,0,1]
    v_pk_fma_f32 v[238:239], v[238:239], v[28:29], v[28:29] op_sel:[0,1,0] op_sel_hi:[1,1,0] neg_lo:[0,0,1] neg_hi:[0,0,1]
    v_exp_f32 v32, v32
    v_exp_f32 v33, v33
    v_exp_f32 v34, v34
    v_exp_f32 v35, v35
    v_exp_f32 v36, v36
    v_exp_f32 v37, v37
    v_exp_f32 v38, v38
    v_exp_f32 v39, v39
    v_exp_f32 v40, v40
    v_exp_f32 v41, v41
    v_exp_f32 v42, v42
    v_exp_f32 v43, v43
    v_exp_f32 v44, v44
    v_exp_f32 v45, v45
    v_exp_f32 v46, v46
    v_exp_f32 v47, v47
    v_pk_add_f32 v[32:33], v[32:33], 1.0 op_sel_hi:[1,0]
    v_pk_add_f32 v[34:35], v[34:35], 1.0 op_sel_hi:[1,0]
    v_pk_add_f32 v[36:37], v[36:37], 1.0 op_sel_hi:[1,0]
    v_pk_add_f32 v[38:39], v[38:39], 1.0 op_sel_hi:[1,0]
    v_pk_add_f32 v[40:41], v[40:41], 1.0 op_sel_hi:[1,0]
    v_pk_add_f32 v[42:43], v[42:43], 1.0 op_sel_hi:[1,0]
    v_pk_add_f32 v[44:45], v[44:45], 1.0 op_sel_hi:[1,0]
    v_pk_add_f32 v[46:47], v[46:47], 1.0 op_sel_hi:[1,0]
    v_rcp_f32 v32, v32
    v_rcp_f32 v33, v33
    v_rcp_f32 v34, v34
    v_rcp_f32 v35, v35
    v_rcp_f32 v36, v36
    v_rcp_f32 v37, v37
    v_rcp_f32 v38, v38
    v_rcp_f32 v39, v39
    v_rcp_f32 v40, v40
    v_rcp_f32 v41, v41
    v_rcp_f32 v42, v42
    v_rcp_f32 v43, v43
    v_rcp_f32 v44, v44
    v_rcp_f32 v45, v45
    v_rcp_f32 v46, v46
    v_rcp_f32 v47, v47
    v_pk_mul_f32 v[224:225], v[224:225], v[32:33]
    v_pk_mul_f32 v[226:227], v[226:227], v[34:35]
    v_pk_mul_f32 v[228:229], v[228:229], v[36:37]
    v_pk_mul_f32 v[230:231], v[230:231], v[38:39]
    v_pk_mul_f32 v[232:233], v[232:233], v[40:41]
    v_pk_mul_f32 v[234:235], v[234:235], v[42:43]
    v_pk_mul_f32 v[236:237], v[236:237], v[44:45]
    v_pk_mul_f32 v[238:239], v[238:239], v[46:47]
    s_waitcnt vmcnt(0)
    s_mov_b32 s29, 0
L_k5:
    v_max3_u32 v2, v48, v49, v50
    v_max3_u32 v2, v2, v51, v52
    v_max3_u32 v2, v2, v53, v54
    v_max3_u32 v2, v2, v55, v56
    v_max3_u32 v2, v2, v57, v58
    v_max3_u32 v2, v2, v59, v60
    v_max3_u32 v2, v2, v61, v62
    v_max_u32 v2, v2, v63
    v_cmp_eq_u32 vcc, -1, v2
    s_cbranch_vccz L_k5k
    s_add_u32 s29, s29, 1
    s_cmp_ge_u32 s29, 200000
    s_cbranch_scc1 L_k5k
    s_sleep 1
    s_add_u32 s3, s76, 0
    buffer_load_dwordx4 v[48:51], v13, s[48:51], s3 offen sc1
    s_add_u32 s3, s76, 57344
    buffer_load_dwordx4 v[52:55], v13, s[48:51], s3 offen sc1
    s_add_u32 s3, s76, 114688
    buffer_load_dwordx4 v[56:59], v13, s[48:51], s3 offen sc1
    s_add_u32 s3, s76, 172032
    buffer_load_dwordx4 v[60:63], v13, s[48:51], s3 offen sc1
    s_waitcnt vmcnt(0)
    s_branch L_k5
L_k5k:
    v_pk_add_f32 v[48:49], v[48:49], v[52:53]
    v_pk_add_f32 v[50:51], v[50:51], v[54:55]
    v_pk_add_f32 v[56:57], v[56:57], v[60:61]
    v_pk_add_f32 v[58:59], v[58:59], v[62:63]
    s_nop 0
    v_permlane32_swap_b32 v48, v56
    v_permlane32_swap_b32 v49, v57
    v_permlane32_swap_b32 v50, v58
    v_permlane32_swap_b32 v51, v59
    v_add_f32 v48, v48, v56
    v_add_f32 v49, v49, v57
    v_add_f32 v50, v50, v58
    v_add_f32 v51, v51, v59
    v_permlane16_swap_b32 v48, v49
    s_nop 0
    v_permlane16_swap_b32 v50, v51
    v_add_f32 v48, v48, v49
    v_add_f32 v50, v50, v51
    s_nop 1
    v_permlane32_swap_b32 v48, v50
    v_cvt_pk_bf16_f32 v48, v48, v48
    v_lshlrev_b32 v48, 16, v48
    v_cvt_pk_bf16_f32 v50, v50, v50
    v_lshlrev_b32 v50, 16, v50
    v_mul_f32 v2, 0xbfb8aa3b, v48
    v_exp_f32 v2, v2
    s_nop 0
    v_add_f32 v2, 1.0, v2
    v_rcp_f32 v2, v2
    s_nop 0
    v_mul_f32 v48, v48, v2
    v_cvt_pk_bf16_f32 v48, v48, v48
    v_lshlrev_b32 v48, 16, v48
    v_mul_f32 v48, v48, v50
    v_cvt_pk_bf16_f32 v48, v48, v48
    v_lshlrev_b32 v48, 16, v48
    v_bfe_u32 v2, v1, 3, 2
    v_lshlrev_b32 v2, 6, v2
    v_lshrrev_b32 v3, 5, v1
    v_lshl_add_u32 v2, v3, 2, v2
    ds_bpermute_b32 v56, v2, v48 offset:0
    ds_bpermute_b32 v57, v2, v48 offset:8
    ds_bpermute_b32 v58, v2, v48 offset:16
    ds_bpermute_b32 v59, v2, v48 offset:24
    ds_bpermute_b32 v60, v2, v48 offset:32
    ds_bpermute_b32 v61, v2, v48 offset:40
    ds_bpermute_b32 v62, v2, v48 offset:48
    v_mov_b64 v[120:121], 0
    v_mov_b64 v[122:123], 0
    v_mov_b64 v[124:125], 0
    v_mov_b64 v[126:127], 0
    s_waitcnt lgkmcnt(0)
    v_lshlrev_b32 v2, 16, v192
    v_and_b32 v3, 0xffff0000, v192
    v_pk_fma_f32 v[120:121], v[2:3], v[56:57], v[120:121] op_sel_hi:[1,0,1]
    v_lshlrev_b32 v4, 16, v193
    v_and_b32 v5, 0xffff0000, v193
    v_pk_fma_f32 v[122:123], v[4:5], v[56:57], v[122:123] op_sel_hi:[1,0,1]
    v_lshlrev_b32 v2, 16, v194
    v_and_b32 v3, 0xffff0000, v194
    v_pk_fma_f32 v[124:125], v[2:3], v[56:57], v[124:125] op_sel_hi:[1,0,1]
    v_lshlrev_b32 v4, 16, v195
    v_and_b32 v5, 0xffff0000, v195
    v_pk_fma_f32 v[126:127], v[4:5], v[56:57], v[126:127] op_sel_hi:[1,0,1]
    v_lshlrev_b32 v2, 16, v196
    v_and_b32 v3, 0xffff0000, v196
    v_pk_fma_f32 v[120:121], v[2:3], v[56:57], v[120:121] op_sel:[0,1,0]
    v_lshlrev_b32 v4, 16, v197
    v_and_b32 v5, 0xffff0000, v197
    v_pk_fma_f32 v[122:123], v[4:5], v[56:57], v[122:123] op_sel:[0,1,0]
    v_lshlrev_b32 v2, 16, v198
    v_and_b32 v3, 0xffff0000, v198
    v_pk_fma_f32 v[124:125], v[2:3], v[56:57], v[124:125] op_sel:[0,1,0]
    v_lshlrev_b32 v4, 16, v199
    v_and_b32 v5, 0xffff0000, v199
    v_pk_fma_f32 v[126:127], v[4:5], v[56:57], v[126:127] op_sel:[0,1,0]
    v_lshlrev_b32 v2, 16, v200
    v_and_b32 v3, 0xffff0000, v200
    v_pk_fma_f32 v[120:121], v[2:3], v[58:59], v[120:121] op_sel_hi:[1,0,1]
    v_lshlrev_b32 v4, 16, v201
    v_and_b32 v5, 0xffff0000, v201
    v_pk_fma_f32 v[122:123], v[4:5], v[58:59], v[122:123] op_sel_hi:[1,0,1]
    v_lshlrev_b32 v2, 16, v202
    v_and_b32 v3, 0xffff0000, v202
    v_pk_fma_f32 v[124:125], v[2:3], v[58:59], v[124:125] op_sel_hi:[1,0,1]
    v_lshlrev_b32 v4, 16, v203
    v_and_b32 v5, 0xffff0000, v203
    v_pk_fma_f32 v[126:127], v[4:5], v[58:59], v[126:127] op_sel_hi:[1,0,1]
    v_lshlrev_b32 v2, 16, v204
    v_and_b32 v3, 0xffff0000, v204
    v_pk_fma_f32 v[120:121], v[2:3], v[58:59], v[120:121] op_sel:[0,1,0]
    v_lshlrev_b32 v4, 16, v205
    v_and_b32 v5, 0xffff0000, v205
    v_pk_fma_f32 v[122:123], v[4:5], v[58:59], v[122:123] op_sel:[0,1,0]
    v_lshlrev_b32 v2, 16, v206
    v_and_b32 v3, 0xffff0000, v206
    v_pk_fma_f32 v[124:125], v[2:3], v[58:59], v[124:125] op_sel:[0,1,0]
    v_lshlrev_b32 v4, 16, v207
    v_and_b32 v5, 0xffff0000, v207
    v_pk_fma_f32 v[126:127], v[4:5], v[58:59], v[126:127] op_sel:[0,1,0]
    v_lshlrev_b32 v2, 16, v208
    v_and_b32 v3, 0xffff0000, v208
    v_pk_fma_f32 v[120:121], v[2:3], v[60:61], v[120:121] op_sel_hi:[1,0,1]
    v_lshlrev_b32 v4, 16, v209
    v_and_b32 v5, 0xffff0000, v209
    v_pk_fma_f32 v[122:123], v[4:5], v[60:61], v[122:123] op_sel_hi:[1,0,1]
    v_lshlrev_b32 v2, 16, v210
    v_and_b32 v3, 0xffff0000, v210
    v_pk_fma_f32 v[124:125], v[2:3], v[60:61], v[124:125] op_sel_hi:[1,0,1]
    v_lshlrev_b32 v4, 16, v211
    v_and_b32 v5, 0xffff0000, v211
    v_pk_fma_f32 v[126:127], v[4:5], v[60:61], v[126:127] op_sel_hi:[1,0,1]
    v_lshlrev_b32 v2, 16, v212
    v_and_b32 v3, 0xffff0000, v212
    v_pk_fma_f32 v[120:121], v[2:3], v[60:61], v[120:121] op_sel:[0,1,0]
    v_lshlrev_b32 v4, 16, v213
    v_and_b32 v5, 0xffff0000, v213
    v_pk_fma_f32 v[122:123], v[4:5], v[60:61], v[122:123] op_sel:[0,1,0]
    v_lshlrev_b32 v2, 16, v214
    v_and_b32 v3, 0xffff0000, v214
    v_pk_fma_f32 v[124:125], v[2:3], v[60:61], v[124:125] op_sel:[0,1,0]
    v_lshlrev_b32 v4, 16, v215
    v_and_b32 v5, 0xffff0000, v215
    v_pk_fma_f32 v[126:127], v[4:5], v[60:61], v[126:127] op_sel:[0,1,0]
    v_lshlrev_b32 v2, 16, v216
    v_and_b32 v3, 0xffff0000, v216
    v_pk_fma_f32 v[120:121], v[2:3], v[62:63], v[120:121] op_sel_hi:[1,0,1]
    v_lshlrev_b32 v4, 16, v217
    v_and_b32 v5, 0xffff0000, v217
    v_pk_fma_f32 v[122:123], v[4:5], v[62:63], v[122:123] op_sel_hi:[1,0,1]
    v_lshlrev_b32 v2, 16, v218
    v_and_b32 v3, 0xffff0000, v218
    v_pk_fma_f32 v[124:125], v[2:3], v[62:63], v[124:125] op_sel_hi:[1,0,1]
    v_lshlrev_b32 v4, 16, v219
    v_and_b32 v5, 0xffff0000, v219
    v_pk_fma_f32 v[126:127], v[4:5], v[62:63], v[126:127] op_sel_hi:[1,0,1]
    v_permlane32_swap_b32 v120, v124
    v_permlane32_swap_b32 v121, v125
    v_permlane32_swap_b32 v122, v126
    v_permlane32_swap_b32 v123, v127
    v_add_f32 v120, v120, v124
    v_add_f32 v121, v121, v125
    v_add_f32 v122, v122, v126
    v_add_f32 v123, v123, v127
    s_nop 0
    v_permlane16_swap_b32 v120, v122
    v_permlane16_swap_b32 v121, v123
    v_add_f32 v120, v120, v122
    v_add_f32 v121, v121, v123
    s_nop 0
    v_add_f32 v120, v120, v120 row_ror:8 row_mask:0xf bank_mask:0xf
    v_add_f32 v121, v121, v121 row_ror:8 row_mask:0xf bank_mask:0xf
    v_and_b32 v2, 8, v1
    v_cmp_eq_u32 vcc, 0, v2
    s_and_b32 s3, s2, 15
    s_lshl_b32 s3, s3, 4
    s_lshr_b32 s28, s2, 4
    s_add_u32 s3, s3, s28
    s_lshl_b32 s3, s3, 2
    s_add_u32 s3, s3, s38
    s_lshl_b32 s3, s3, 8
    s_add_u32 s3, s3, 1609728
    v_cndmask_b32 v120, v121, v120, vcc
    buffer_store_dword v120, v253, s[48:51], s3 offen sc1
    s_lshl_b32 s3, s34, 11
    s_add_u32 s3, s3, 32768
    v_lshlrev_b32 v3, 5, v1
    buffer_load_dword v118, v3, s[48:51], s3 offen sc1
    s_waitcnt vmcnt(0)
    s_mov_b32 s29, 0
L_rdy:
    v_cmp_ne_u32 vcc, s86, v118
    s_cbranch_vccz L_rdyk
    s_add_u32 s29, s29, 1
    s_cmp_ge_u32 s29, 200000
    s_cbranch_scc1 L_rdyk
    s_sleep 2
    s_lshl_b32 s3, s34, 11
    s_add_u32 s3, s3, 32768
    v_lshlrev_b32 v3, 5, v1
    buffer_load_dword v118, v3, s[48:51], s3 offen sc1
    s_waitcnt vmcnt(0)
    s_branch L_rdy
L_rdyk:
    s_lshr_b32 s3, s68, 7
    s_cmp_lg_u32 s3, s34
    s_cbranch_scc1 L_nofix
    s_cmp_lg_u32 s38, 3
    s_cbranch_scc1 L_nofix
    v_lshlrev_b32 v13, 4, v1
    s_lshl_b32 s76, s35, 14
    s_add_u32 s76, s76, 1609728
    v_and_b32 v2, 15, v1
    v_lshrrev_b32 v3, 4, v1
    v_lshl_add_u32 v14, v2, 2, v3
    v_and_b32 v2, 7, v14
    v_lshrrev_b32 v14, 3, v14
    v_lshl_add_u32 v14, v2, 3, v14
    v_lshlrev_b32 v2, 1, v14
    s_lshl_b32 s3, s68, 11
    s_lshl_b32 s28, s35, 7
    s_add_u32 s3, s3, s28
    buffer_load_ushort v15, v2, s[40:43], s3 offen
    s_add_u32 s3, s76, 0
    buffer_load_dwordx4 v[128:131], v13, s[48:51], s3 offen offset:0 sc1
    buffer_load_dwordx4 v[132:135], v13, s[48:51], s3 offen offset:1024 sc1
    buffer_load_dwordx4 v[136:139], v13, s[48:51], s3 offen offset:2048 sc1
    buffer_load_dwordx4 v[140:143], v13, s[48:51], s3 offen offset:3072 sc1
    s_add_u32 s3, s76, 4096
    buffer_load_dwordx4 v[144:147], v13, s[48:51], s3 offen offset:0 sc1
    buffer_load_dwordx4 v[148:151], v13, s[48:51], s3 offen offset:1024 sc1
    buffer_load_dwordx4 v[152:155], v13, s[48:51], s3 offen offset:2048 sc1
    buffer_load_dwordx4 v[156:159], v13, s[48:51], s3 offen offset:3072 sc1
    s_add_u32 s3, s76, 8192
    buffer_load_dwordx4 v[160:163], v13, s[48:51], s3 offen offset:0 sc1
    buffer_load_dwordx4 v[164:167], v13, s[48:51], s3 offen offset:1024 sc1
    buffer_load_dwordx4 v[168:171], v13, s[48:51], s3 offen offset:2048 sc1
    buffer_load_dwordx4 v[172:175], v13, s[48:51], s3 offen offset:3072 sc1
    s_add_u32 s3, s76, 12288
    buffer_load_dwordx4 v[176:179], v13, s[48:51], s3 offen offset:0 sc1
    buffer_load_dwordx4 v[180:183], v13, s[48:51], s3 offen offset:1024 sc1
    buffer_load_dwordx4 v[184:187], v13, s[48:51], s3 offen offset:2048 sc1
    buffer_load_dwordx4 v[188:191], v13, s[48:51], s3 offen offset:3072 sc1
    s_and_b32 s3, s70, 0xffff0000
    s_xor_b32 s28, s3, 0x80000000
    s_not_b32 s29, s3
    s_and_b32 s29, s29, 0xffff0000
    s_bitcmp1_b32 s3, 31
    s_cselect_b32 s3, s28, s29
    v_mov_b32 v16, s3
    v_mul_f32 v16, 0xbfb8aa3b, v16
    v_exp_f32 v16, v16
    s_nop 0
    v_add_f32 v16, 1.0, v16
    v_rcp_f32 v16, v16
    s_nop 0
    v_cvt_pk_bf16_f32 v16, v16, v16
    v_lshlrev_b32 v16, 16, v16
    s_waitcnt vmcnt(0)
    s_mov_b32 s29, 0
L_k6:
    v_max3_u32 v2, v128, v129, v130
    v_max3_u32 v2, v2, v131, v132
    v_max3_u32 v2, v2, v133, v134
    v_max3_u32 v2, v2, v135, v136
    v_max3_u32 v2, v2, v137, v138
    v_max3_u32 v2, v2, v139, v140
    v_max3_u32 v2, v2, v141, v142
    v_max3_u32 v2, v2, v143, v144
    v_max3_u32 v2, v2, v145, v146
    v_max3_u32 v2, v2, v147, v148
    v_max3_u32 v2, v2, v149, v150
    v_max3_u32 v2, v2, v151, v152
    v_max3_u32 v2, v2, v153, v154
    v_max3_u32 v2, v2, v155, v156
    v_max3_u32 v2, v2, v157, v158
    v_max3_u32 v2, v2, v159, v160
    v_max3_u32 v2, v2, v161, v162
    v_max3_u32 v2, v2, v163, v164
    v_max3_u32 v2, v2, v165, v166
    v_max3_u32 v2, v2, v167, v168
    v_max3_u32 v2, v2, v169, v170
    v_max3_u32 v2, v2, v171, v172
    v_max3_u32 v2, v2, v173, v174
    v_max3_u32 v2, v2, v175, v176
    v_max3_u32 v2, v2, v177, v178
    v_max3_u32 v2, v2, v179, v180
    v_max3_u32 v2, v2, v181, v182
    v_max3_u32 v2, v2, v183, v184
    v_max3_u32 v2, v2, v185, v186
    v_max3_u32 v2, v2, v187, v188
    v_max3_u32 v2, v2, v189, v190
    v_max_u32 v2, v2, v191
    v_cmp_eq_u32 vcc, -1, v2
    s_cbranch_vccz L_k6k
    s_add_u32 s29, s29, 1
    s_cmp_ge_u32 s29, 200000
    s_cbranch_scc1 L_k6k
    s_sleep 4
    s_add_u32 s3, s76, 0
    buffer_load_dwordx4 v[128:131], v13, s[48:51], s3 offen offset:0 sc1
    buffer_load_dwordx4 v[132:135], v13, s[48:51], s3 offen offset:1024 sc1
    buffer_load_dwordx4 v[136:139], v13, s[48:51], s3 offen offset:2048 sc1
    buffer_load_dwordx4 v[140:143], v13, s[48:51], s3 offen offset:3072 sc1
    s_add_u32 s3, s76, 4096
    buffer_load_dwordx4 v[144:147], v13, s[48:51], s3 offen offset:0 sc1
    buffer_load_dwordx4 v[148:151], v13, s[48:51], s3 offen offset:1024 sc1
    buffer_load_dwordx4 v[152:155], v13, s[48:51], s3 offen offset:2048 sc1
    buffer_load_dwordx4 v[156:159], v13, s[48:51], s3 offen offset:3072 sc1
    s_add_u32 s3, s76, 8192
    buffer_load_dwordx4 v[160:163], v13, s[48:51], s3 offen offset:0 sc1
    buffer_load_dwordx4 v[164:167], v13, s[48:51], s3 offen offset:1024 sc1
    buffer_load_dwordx4 v[168:171], v13, s[48:51], s3 offen offset:2048 sc1
    buffer_load_dwordx4 v[172:175], v13, s[48:51], s3 offen offset:3072 sc1
    s_add_u32 s3, s76, 12288
    buffer_load_dwordx4 v[176:179], v13, s[48:51], s3 offen offset:0 sc1
    buffer_load_dwordx4 v[180:183], v13, s[48:51], s3 offen offset:1024 sc1
    buffer_load_dwordx4 v[184:187], v13, s[48:51], s3 offen offset:2048 sc1
    buffer_load_dwordx4 v[188:191], v13, s[48:51], s3 offen offset:3072 sc1
    s_waitcnt vmcnt(0)
    s_branch L_k6
L_k6k:
    v_pk_add_f32 v[128:129], v[128:129], v[160:161]
    v_pk_add_f32 v[130:131], v[130:131], v[162:163]
    v_pk_add_f32 v[132:133], v[132:133], v[164:165]
    v_pk_add_f32 v[134:135], v[134:135], v[166:167]
    v_pk_add_f32 v[136:137], v[136:137], v[168:169]
    v_pk_add_f32 v[138:139], v[138:139], v[170:171]
    v_pk_add_f32 v[140:141], v[140:141], v[172:173]
    v_pk_add_f32 v[142:143], v[142:143], v[174:175]
    v_pk_add_f32 v[144:145], v[144:145], v[176:177]
    v_pk_add_f32 v[146:147], v[146:147], v[178:179]
    v_pk_add_f32 v[148:149], v[148:149], v[180:181]
    v_pk_add_f32 v[150:151], v[150:151], v[182:183]
    v_pk_add_f32 v[152:153], v[152:153], v[184:185]
    v_pk_add_f32 v[154:155], v[154:155], v[186:187]
    v_pk_add_f32 v[156:157], v[156:157], v[188:189]
    v_pk_add_f32 v[158:159], v[158:159], v[190:191]
    v_pk_add_f32 v[128:129], v[128:129], v[144:145]
    v_pk_add_f32 v[130:131], v[130:131], v[146:147]
    v_pk_add_f32 v[132:133], v[132:133], v[148:149]
    v_pk_add_f32 v[134:135], v[134:135], v[150:151]
    v_pk_add_f32 v[136:137], v[136:137], v[152:153]
    v_pk_add_f32 v[138:139], v[138:139], v[154:155]
    v_pk_add_f32 v[140:141], v[140:141], v[156:157]
    v_pk_add_f32 v[142:143], v[142:143], v[158:159]
    v_pk_add_f32 v[128:129], v[128:129], v[136:137]
    v_pk_add_f32 v[130:131], v[130:131], v[138:139]
    v_pk_add_f32 v[132:133], v[132:133], v[140:141]
    v_pk_add_f32 v[134:135], v[134:135], v[142:143]
    v_pk_add_f32 v[128:129], v[128:129], v[132:133]
    v_pk_add_f32 v[130:131], v[130:131], v[134:135]
    s_nop 1
    v_permlane32_swap_b32 v128, v130
    v_permlane32_swap_b32 v129, v131
    v_add_f32 v128, v128, v130
    v_add_f32 v129, v129, v131
    s_nop 1
    v_permlane16_swap_b32 v128, v129
    v_add_f32 v128, v128, v129
    v_cvt_pk_bf16_f32 v128, v128, v128
    v_lshlrev_b32 v128, 16, v128
    v_mul_f32 v128, v128, v16
    v_lshlrev_b32 v15, 16, v15
    v_sub_f32 v15, v15, v116
    v_cvt_pk_bf16_f32 v128, v128, v128
    v_lshlrev_b32 v128, 16, v128
    v_fmac_f32 v128, v15, v117
    v_mul_f32 v2, 0xbfb8aa3b, v128
    v_exp_f32 v2, v2
    s_nop 0
    v_add_f32 v2, 1.0, v2
    v_rcp_f32 v2, v2
    s_nop 0
    v_mul_f32 v2, v128, v2
    s_bfe_u32 s3, s68, 0x20005
    s_bfe_u32 s28, s68, 0x10004
    s_lshl_b32 s28, s28, 2
    s_add_u32 s3, s3, s28
    s_lshl_b32 s3, s3, 12
    s_add_u32 s3, s3, 131072
    v_lshl_add_u32 v3, v14, 2, s3
    ds_write_b32 v3, v2
L_nofix:
    s_waitcnt vmcnt(0)
    s_branch L_p3
L_C:
    s_and_b32 s64, s38, 1
    s_lshr_b32 s65, s38, 1
    v_and_b32 v3, 15, v1
    v_lshlrev_b32 v3, 7, v3
    s_lshl_b32 s3, s64, 13
    v_add_u32 v3, s3, v3
    v_bfe_u32 v5, v1, 1, 3
    v_lshrrev_b32 v6, 4, v1
    v_xor_b32 v6, v6, v5
    v_lshl_add_u32 v184, v6, 4, v3
    v_xor_b32 v185, 64, v184
    v_lshrrev_b32 v6, 4, v1
    v_lshlrev_b32 v6, 3, v6
    v_bfe_u32 v7, v1, 2, 2
    v_add_u32 v6, v6, v7
    v_lshlrev_b32 v6, 7, v6
    v_and_b32 v7, 3, v1
    v_lshl_add_u32 v6, v7, 3, v6
    v_add_u32 v6, 16384, v6
    v_bfe_u32 v7, v1, 3, 2
    s_lshl_b32 s3, s65, 1
    v_xor_b32 v7, s3, v7
    v_lshl_add_u32 v186, v7, 5, v6
    v_xor_b32 v187, 32, v186
    v_add_u32 v188, 81920, v184
    v_add_u32 v189, 81920, v185
    v_add_u32 v190, 81920, v186
    v_add_u32 v191, 81920, v187
    s_waitcnt lgkmcnt(0)
    s_mov_b32 s48, s26
    s_mov_b32 s49, s27
    s_mov_b32 s50, 268435456
    s_mov_b32 s51, 0x00020000
    s_mov_b32 s40, s4
    s_mov_b32 s41, s5
    s_mov_b32 s42, 4194304
    s_mov_b32 s43, 0x00020000
    s_mov_b32 s88, s10
    s_mov_b32 s89, s11
    s_mov_b32 s90, 2097152
    s_mov_b32 s91, 0x00020000
    s_lshl_b32 s3, s36, 7
    s_lshl_b32 s28, s37, 3
    s_add_u32 s3, s3, s28
    s_lshl_b32 s28, s38, 1
    s_add_u32 s69, s3, s28
    v_lshlrev_b32 v2, 4, v1
    v_mov_b32 v248, 16384
    v_mov_b32 v4, -1
    v_mov_b32 v5, -1
    v_mov_b32 v6, -1
    v_mov_b32 v7, -1
    s_lshl_b32 s28, s2, 2
    s_add_u32 s28, s28, s38
    s_lshl_b32 s28, s28, 10
    s_add_u32 s28, s28, 1048576
    buffer_store_dwordx4 v[4:7], v2, s[48:51], s28 offen sc1
    buffer_load_dword v248, v248, s[48:51], 0 offen sc1
    s_getpc_b64 s[92:93]
L_pc:
    s_sub_u32 s92, s92, L_pc-recurrent_scan__linear_kernel_hedgehog__moe_arch_mod__prompt_kernel
    s_subb_u32 s93, s93, 0
    s_lshr_b32 s3, s2, 3
    s_lshl_b32 s3, s3, 2
    s_add_u32 s3, s3, s38
    s_lshl_b32 s3, s3, 8
    v_lshlrev_b32 v2, 7, v1
    v_add_u32 v2, s3, v2
    s_mov_b64 exec, 3
    global_load_dword v249, v2, s[92:93]
    s_mov_b64 exec, -1
    v_mov_b64 v[8:9], 0
    v_mov_b64 v[10:11], 0
    v_mov_b64 v[12:13], 0
    v_mov_b64 v[14:15], 0
    v_mov_b64 v[16:17], 0
    v_mov_b64 v[18:19], 0
    v_mov_b64 v[20:21], 0
    v_mov_b64 v[22:23], 0
    v_mov_b64 v[24:25], 0
    v_mov_b64 v[26:27], 0
    v_mov_b64 v[28:29], 0
    v_mov_b64 v[30:31], 0
    v_mov_b64 v[32:33], 0
    v_mov_b64 v[34:35], 0
    v_mov_b64 v[36:37], 0
    v_mov_b64 v[38:39], 0
    v_mov_b64 v[40:41], 0
    v_mov_b64 v[42:43], 0
    v_mov_b64 v[44:45], 0
    v_mov_b64 v[46:47], 0
    v_mov_b64 v[48:49], 0
    v_mov_b64 v[50:51], 0
    v_mov_b64 v[52:53], 0
    v_mov_b64 v[54:55], 0
    v_mov_b64 v[56:57], 0
    v_mov_b64 v[58:59], 0
    v_mov_b64 v[60:61], 0
    v_mov_b64 v[62:63], 0
    v_mov_b64 v[64:65], 0
    v_mov_b64 v[66:67], 0
    v_mov_b64 v[68:69], 0
    v_mov_b64 v[70:71], 0
    v_mov_b64 v[72:73], 0
    v_mov_b64 v[74:75], 0
    v_mov_b64 v[76:77], 0
    v_mov_b64 v[78:79], 0
    v_mov_b64 v[80:81], 0
    v_mov_b64 v[82:83], 0
    v_mov_b64 v[84:85], 0
    v_mov_b64 v[86:87], 0
    v_mov_b64 v[88:89], 0
    v_mov_b64 v[90:91], 0
    v_mov_b64 v[92:93], 0
    v_mov_b64 v[94:95], 0
    v_mov_b64 v[96:97], 0
    v_mov_b64 v[98:99], 0
    v_mov_b64 v[100:101], 0
    v_mov_b64 v[102:103], 0
    s_lshl_b32 s3, s38, 2
    s_add_u32 s3, s3, 162112
    v_mov_b32 v2, s3
    v_mov_b32 v3, 0
    ds_write_b32 v2, v3
    s_mov_b32 s66, 0
    s_setprio 2
    s_waitcnt lgkmcnt(0)
    s_barrier
    ds_read_b128 v[104:107], v184 offset:0
    ds_read_b64_tr_b16 v[120:121], v186 offset:0
    ds_read_b64_tr_b16 v[122:123], v186 offset:512
    ds_read_b64_tr_b16 v[124:125], v187 offset:0
    ds_read_b64_tr_b16 v[126:127], v187 offset:512
    ds_read_b64_tr_b16 v[128:129], v186 offset:8192
    ds_read_b64_tr_b16 v[130:131], v186 offset:8704
    ds_read_b64_tr_b16 v[132:133], v187 offset:8192
    ds_read_b64_tr_b16 v[134:135], v187 offset:8704
    ds_read_b64_tr_b16 v[136:137], v186 offset:16384
    ds_read_b64_tr_b16 v[138:139], v186 offset:16896
    ds_read_b64_tr_b16 v[140:141], v187 offset:16384
    ds_read_b64_tr_b16 v[142:143], v187 offset:16896
    ds_read_b128 v[108:111], v184 offset:2048
    ds_read_b128 v[112:115], v184 offset:4096
    ds_read_b128 v[116:119], v184 offset:6144
    s_branch L_cmid
.p2align 6
L_cloop:
    s_waitcnt lgkmcnt(0)
    s_barrier
    v_mfma_f32_16x16x32_bf16 v[8:11], v[160:163], v[144:147], v[8:11]
    ds_read_b128 v[104:107], v184 offset:0
    v_mfma_f32_16x16x32_bf16 v[12:15], v[164:167], v[144:147], v[12:15]
    ds_read_b64_tr_b16 v[120:121], v186 offset:0
    v_mfma_f32_16x16x32_bf16 v[16:19], v[168:171], v[144:147], v[16:19]
    ds_read_b64_tr_b16 v[122:123], v186 offset:512
    v_mfma_f32_16x16x32_bf16 v[20:23], v[172:175], v[144:147], v[20:23]
    ds_read_b64_tr_b16 v[124:125], v187 offset:0
    v_mfma_f32_16x16x32_bf16 v[24:27], v[144:147], v[176:179], v[24:27]
    ds_read_b64_tr_b16 v[126:127], v187 offset:512
    v_mfma_f32_16x16x32_bf16 v[28:31], v[144:147], v[180:183], v[28:31]
    ds_read_b64_tr_b16 v[128:129], v186 offset:8192
    v_mfma_f32_16x16x32_bf16 v[32:35], v[160:163], v[148:151], v[32:35]
    ds_read_b64_tr_b16 v[130:131], v186 offset:8704
    v_mfma_f32_16x16x32_bf16 v[36:39], v[164:167], v[148:151], v[36:39]
    ds_read_b64_tr_b16 v[132:133], v187 offset:8192
    v_mfma_f32_16x16x32_bf16 v[40:43], v[168:171], v[148:151], v[40:43]
    ds_read_b64_tr_b16 v[134:135], v187 offset:8704
    v_mfma_f32_16x16x32_bf16 v[44:47], v[172:175], v[148:151], v[44:47]
    ds_read_b64_tr_b16 v[136:137], v186 offset:16384
    v_mfma_f32_16x16x32_bf16 v[48:51], v[148:151], v[176:179], v[48:51]
    ds_read_b64_tr_b16 v[138:139], v186 offset:16896
    v_mfma_f32_16x16x32_bf16 v[52:55], v[148:151], v[180:183], v[52:55]
    ds_read_b64_tr_b16 v[140:141], v187 offset:16384
    v_mfma_f32_16x16x32_bf16 v[56:59], v[160:163], v[152:155], v[56:59]
    ds_read_b64_tr_b16 v[142:143], v187 offset:16896
    v_mfma_f32_16x16x32_bf16 v[60:63], v[164:167], v[152:155], v[60:63]
    ds_read_b128 v[108:111], v184 offset:2048
    v_mfma_f32_16x16x32_bf16 v[64:67], v[168:171], v[152:155], v[64:67]
    ds_read_b128 v[112:115], v184 offset:4096
    v_mfma_f32_16x16x32_bf16 v[68:71], v[172:175], v[152:155], v[68:71]
    ds_read_b128 v[116:119], v184 offset:6144
    v_mfma_f32_16x16x32_bf16 v[72:75], v[152:155], v[176:179], v[72:75]
    v_mfma_f32_16x16x32_bf16 v[76:79], v[152:155], v[180:183], v[76:79]
    v_mfma_f32_16x16x32_bf16 v[80:83], v[160:163], v[156:159], v[80:83]
    v_mfma_f32_16x16x32_bf16 v[84:87], v[164:167], v[156:159], v[84:87]
    v_mfma_f32_16x16x32_bf16 v[88:91], v[168:171], v[156:159], v[88:91]
    v_mfma_f32_16x16x32_bf16 v[92:95], v[172:175], v[156:159], v[92:95]
    v_mfma_f32_16x16x32_bf16 v[96:99], v[156:159], v[176:179], v[96:99]
    v_mfma_f32_16x16x32_bf16 v[100:103], v[156:159], v[180:183], v[100:103]
L_cmid:
    s_waitcnt lgkmcnt(0)
    s_nop 0
    v_mfma_f32_16x16x32_bf16 v[8:11], v[120:123], v[104:107], v[8:11]
    ds_read_b128 v[144:147], v185 offset:0
    v_mfma_f32_16x16x32_bf16 v[12:15], v[124:127], v[104:107], v[12:15]
    ds_read_b64_tr_b16 v[160:161], v186 offset:4096
    v_mfma_f32_16x16x32_bf16 v[16:19], v[128:131], v[104:107], v[16:19]
    ds_read_b64_tr_b16 v[162:163], v186 offset:4608
    v_mfma_f32_16x16x32_bf16 v[20:23], v[132:135], v[104:107], v[20:23]
    ds_read_b64_tr_b16 v[164:165], v187 offset:4096
    v_mfma_f32_16x16x32_bf16 v[24:27], v[104:107], v[136:139], v[24:27]
    ds_read_b64_tr_b16 v[166:167], v187 offset:4608
    v_mfma_f32_16x16x32_bf16 v[28:31], v[104:107], v[140:143], v[28:31]
    ds_read_b64_tr_b16 v[168:169], v186 offset:12288
    v_mfma_f32_16x16x32_bf16 v[32:35], v[120:123], v[108:111], v[32:35]
    ds_read_b64_tr_b16 v[170:171], v186 offset:12800
    v_mfma_f32_16x16x32_bf16 v[36:39], v[124:127], v[108:111], v[36:39]
    ds_read_b64_tr_b16 v[172:173], v187 offset:12288
    v_mfma_f32_16x16x32_bf16 v[40:43], v[128:131], v[108:111], v[40:43]
    ds_read_b64_tr_b16 v[174:175], v187 offset:12800
    v_mfma_f32_16x16x32_bf16 v[44:47], v[132:135], v[108:111], v[44:47]
    ds_read_b64_tr_b16 v[176:177], v186 offset:20480
    v_mfma_f32_16x16x32_bf16 v[48:51], v[108:111], v[136:139], v[48:51]
    ds_read_b64_tr_b16 v[178:179], v186 offset:20992
    v_mfma_f32_16x16x32_bf16 v[52:55], v[108:111], v[140:143], v[52:55]
    ds_read_b64_tr_b16 v[180:181], v187 offset:20480
    v_mfma_f32_16x16x32_bf16 v[56:59], v[120:123], v[112:115], v[56:59]
    ds_read_b64_tr_b16 v[182:183], v187 offset:20992
    v_mfma_f32_16x16x32_bf16 v[60:63], v[124:127], v[112:115], v[60:63]
    ds_read_b128 v[148:151], v185 offset:2048
    v_mfma_f32_16x16x32_bf16 v[64:67], v[128:131], v[112:115], v[64:67]
    ds_read_b128 v[152:155], v185 offset:4096
    v_mfma_f32_16x16x32_bf16 v[68:71], v[132:135], v[112:115], v[68:71]
    ds_read_b128 v[156:159], v185 offset:6144
    v_mfma_f32_16x16x32_bf16 v[72:75], v[112:115], v[136:139], v[72:75]
    v_mfma_f32_16x16x32_bf16 v[76:79], v[112:115], v[140:143], v[76:79]
    v_mfma_f32_16x16x32_bf16 v[80:83], v[120:123], v[116:119], v[80:83]
    v_mfma_f32_16x16x32_bf16 v[84:87], v[124:127], v[116:119], v[84:87]
    v_mfma_f32_16x16x32_bf16 v[88:91], v[128:131], v[116:119], v[88:91]
    v_mfma_f32_16x16x32_bf16 v[92:95], v[132:135], v[116:119], v[92:95]
    v_mfma_f32_16x16x32_bf16 v[96:99], v[116:119], v[136:139], v[96:99]
    v_mfma_f32_16x16x32_bf16 v[100:103], v[116:119], v[140:143], v[100:103]
    s_waitcnt lgkmcnt(0)
    s_barrier
    v_mfma_f32_16x16x32_bf16 v[8:11], v[160:163], v[144:147], v[8:11]
    ds_read_b128 v[104:107], v184 offset:40960
    v_mfma_f32_16x16x32_bf16 v[12:15], v[164:167], v[144:147], v[12:15]
    ds_read_b64_tr_b16 v[120:121], v186 offset:40960
    v_mfma_f32_16x16x32_bf16 v[16:19], v[168:171], v[144:147], v[16:19]
    ds_read_b64_tr_b16 v[122:123], v186 offset:41472
    v_mfma_f32_16x16x32_bf16 v[20:23], v[172:175], v[144:147], v[20:23]
    ds_read_b64_tr_b16 v[124:125], v187 offset:40960
    v_mfma_f32_16x16x32_bf16 v[24:27], v[144:147], v[176:179], v[24:27]
    ds_read_b64_tr_b16 v[126:127], v187 offset:41472
    v_mfma_f32_16x16x32_bf16 v[28:31], v[144:147], v[180:183], v[28:31]
    ds_read_b64_tr_b16 v[128:129], v186 offset:49152
    v_mfma_f32_16x16x32_bf16 v[32:35], v[160:163], v[148:151], v[32:35]
    ds_read_b64_tr_b16 v[130:131], v186 offset:49664
    v_mfma_f32_16x16x32_bf16 v[36:39], v[164:167], v[148:151], v[36:39]
    ds_read_b64_tr_b16 v[132:133], v187 offset:49152
    v_mfma_f32_16x16x32_bf16 v[40:43], v[168:171], v[148:151], v[40:43]
    ds_read_b64_tr_b16 v[134:135], v187 offset:49664
    v_mfma_f32_16x16x32_bf16 v[44:47], v[172:175], v[148:151], v[44:47]
    ds_read_b64_tr_b16 v[136:137], v186 offset:57344
    v_mfma_f32_16x16x32_bf16 v[48:51], v[148:151], v[176:179], v[48:51]
    ds_read_b64_tr_b16 v[138:139], v186 offset:57856
    v_mfma_f32_16x16x32_bf16 v[52:55], v[148:151], v[180:183], v[52:55]
    ds_read_b64_tr_b16 v[140:141], v187 offset:57344
    v_mfma_f32_16x16x32_bf16 v[56:59], v[160:163], v[152:155], v[56:59]
    ds_read_b64_tr_b16 v[142:143], v187 offset:57856
    v_mfma_f32_16x16x32_bf16 v[60:63], v[164:167], v[152:155], v[60:63]
    ds_read_b128 v[108:111], v184 offset:43008
    v_mfma_f32_16x16x32_bf16 v[64:67], v[168:171], v[152:155], v[64:67]
    ds_read_b128 v[112:115], v184 offset:45056
    v_mfma_f32_16x16x32_bf16 v[68:71], v[172:175], v[152:155], v[68:71]
    ds_read_b128 v[116:119], v184 offset:47104
    v_mfma_f32_16x16x32_bf16 v[72:75], v[152:155], v[176:179], v[72:75]
    v_mfma_f32_16x16x32_bf16 v[76:79], v[152:155], v[180:183], v[76:79]
    v_mfma_f32_16x16x32_bf16 v[80:83], v[160:163], v[156:159], v[80:83]
    v_mfma_f32_16x16x32_bf16 v[84:87], v[164:167], v[156:159], v[84:87]
    v_mfma_f32_16x16x32_bf16 v[88:91], v[168:171], v[156:159], v[88:91]
    v_mfma_f32_16x16x32_bf16 v[92:95], v[172:175], v[156:159], v[92:95]
    v_mfma_f32_16x16x32_bf16 v[96:99], v[156:159], v[176:179], v[96:99]
    v_mfma_f32_16x16x32_bf16 v[100:103], v[156:159], v[180:183], v[100:103]
    s_waitcnt lgkmcnt(0)
    s_nop 0
    v_mfma_f32_16x16x32_bf16 v[8:11], v[120:123], v[104:107], v[8:11]
    ds_read_b128 v[144:147], v185 offset:40960
    v_mfma_f32_16x16x32_bf16 v[12:15], v[124:127], v[104:107], v[12:15]
    ds_read_b64_tr_b16 v[160:161], v186 offset:45056
    v_mfma_f32_16x16x32_bf16 v[16:19], v[128:131], v[104:107], v[16:19]
    ds_read_b64_tr_b16 v[162:163], v186 offset:45568
    v_mfma_f32_16x16x32_bf16 v[20:23], v[132:135], v[104:107], v[20:23]
    ds_read_b64_tr_b16 v[164:165], v187 offset:45056
    v_mfma_f32_16x16x32_bf16 v[24:27], v[104:107], v[136:139], v[24:27]
    ds_read_b64_tr_b16 v[166:167], v187 offset:45568
    v_mfma_f32_16x16x32_bf16 v[28:31], v[104:107], v[140:143], v[28:31]
    ds_read_b64_tr_b16 v[168:169], v186 offset:53248
    v_mfma_f32_16x16x32_bf16 v[32:35], v[120:123], v[108:111], v[32:35]
    ds_read_b64_tr_b16 v[170:171], v186 offset:53760
    v_mfma_f32_16x16x32_bf16 v[36:39], v[124:127], v[108:111], v[36:39]
    ds_read_b64_tr_b16 v[172:173], v187 offset:53248
    v_mfma_f32_16x16x32_bf16 v[40:43], v[128:131], v[108:111], v[40:43]
    ds_read_b64_tr_b16 v[174:175], v187 offset:53760
    v_mfma_f32_16x16x32_bf16 v[44:47], v[132:135], v[108:111], v[44:47]
    ds_read_b64_tr_b16 v[176:177], v186 offset:61440
    v_mfma_f32_16x16x32_bf16 v[48:51], v[108:111], v[136:139], v[48:51]
    ds_read_b64_tr_b16 v[178:179], v186 offset:61952
    v_mfma_f32_16x16x32_bf16 v[52:55], v[108:111], v[140:143], v[52:55]
    ds_read_b64_tr_b16 v[180:181], v187 offset:61440
    v_mfma_f32_16x16x32_bf16 v[56:59], v[120:123], v[112:115], v[56:59]
    ds_read_b64_tr_b16 v[182:183], v187 offset:61952
    v_mfma_f32_16x16x32_bf16 v[60:63], v[124:127], v[112:115], v[60:63]
    ds_read_b128 v[148:151], v185 offset:43008
    v_mfma_f32_16x16x32_bf16 v[64:67], v[128:131], v[112:115], v[64:67]
    ds_read_b128 v[152:155], v185 offset:45056
    v_mfma_f32_16x16x32_bf16 v[68:71], v[132:135], v[112:115], v[68:71]
    ds_read_b128 v[156:159], v185 offset:47104
    v_mfma_f32_16x16x32_bf16 v[72:75], v[112:115], v[136:139], v[72:75]
    s_cmp_eq_u32 s66, 0
    v_mfma_f32_16x16x32_bf16 v[76:79], v[112:115], v[140:143], v[76:79]
    v_mfma_f32_16x16x32_bf16 v[80:83], v[120:123], v[116:119], v[80:83]
    v_mfma_f32_16x16x32_bf16 v[84:87], v[124:127], v[116:119], v[84:87]
    v_mfma_f32_16x16x32_bf16 v[88:91], v[128:131], v[116:119], v[88:91]
    v_mfma_f32_16x16x32_bf16 v[92:95], v[132:135], v[116:119], v[92:95]
    v_mfma_f32_16x16x32_bf16 v[96:99], v[116:119], v[136:139], v[96:99]
    v_mfma_f32_16x16x32_bf16 v[100:103], v[116:119], v[140:143], v[100:103]
    s_cbranch_scc1 L_ln
L_lnr:
    s_waitcnt lgkmcnt(0)
    s_barrier
    v_mfma_f32_16x16x32_bf16 v[8:11], v[160:163], v[144:147], v[8:11]
    ds_read_b128 v[104:107], v188 offset:0
    v_mfma_f32_16x16x32_bf16 v[12:15], v[164:167], v[144:147], v[12:15]
    ds_read_b64_tr_b16 v[120:121], v190 offset:0
    v_mfma_f32_16x16x32_bf16 v[16:19], v[168:171], v[144:147], v[16:19]
    ds_read_b64_tr_b16 v[122:123], v190 offset:512
    v_mfma_f32_16x16x32_bf16 v[20:23], v[172:175], v[144:147], v[20:23]
    ds_read_b64_tr_b16 v[124:125], v191 offset:0
    v_mfma_f32_16x16x32_bf16 v[24:27], v[144:147], v[176:179], v[24:27]
    ds_read_b64_tr_b16 v[126:127], v191 offset:512
    v_mfma_f32_16x16x32_bf16 v[28:31], v[144:147], v[180:183], v[28:31]
    ds_read_b64_tr_b16 v[128:129], v190 offset:8192
    v_mfma_f32_16x16x32_bf16 v[32:35], v[160:163], v[148:151], v[32:35]
    ds_read_b64_tr_b16 v[130:131], v190 offset:8704
    v_mfma_f32_16x16x32_bf16 v[36:39], v[164:167], v[148:151], v[36:39]
    ds_read_b64_tr_b16 v[132:133], v191 offset:8192
    v_mfma_f32_16x16x32_bf16 v[40:43], v[168:171], v[148:151], v[40:43]
    ds_read_b64_tr_b16 v[134:135], v191 offset:8704
    v_mfma_f32_16x16x32_bf16 v[44:47], v[172:175], v[148:151], v[44:47]
    ds_read_b64_tr_b16 v[136:137], v190 offset:16384
    v_mfma_f32_16x16x32_bf16 v[48:51], v[148:151], v[176:179], v[48:51]
    ds_read_b64_tr_b16 v[138:139], v190 offset:16896
    v_mfma_f32_16x16x32_bf16 v[52:55], v[148:151], v[180:183], v[52:55]
    ds_read_b64_tr_b16 v[140:141], v191 offset:16384
    v_mfma_f32_16x16x32_bf16 v[56:59], v[160:163], v[152:155], v[56:59]
    ds_read_b64_tr_b16 v[142:143], v191 offset:16896
    v_mfma_f32_16x16x32_bf16 v[60:63], v[164:167], v[152:155], v[60:63]
    ds_read_b128 v[108:111], v188 offset:2048
    v_mfma_f32_16x16x32_bf16 v[64:67], v[168:171], v[152:155], v[64:67]
    ds_read_b128 v[112:115], v188 offset:4096
    v_mfma_f32_16x16x32_bf16 v[68:71], v[172:175], v[152:155], v[68:71]
    ds_read_b128 v[116:119], v188 offset:6144
    v_mfma_f32_16x16x32_bf16 v[72:75], v[152:155], v[176:179], v[72:75]
    v_mfma_f32_16x16x32_bf16 v[76:79], v[152:155], v[180:183], v[76:79]
    v_mfma_f32_16x16x32_bf16 v[80:83], v[160:163], v[156:159], v[80:83]
    v_mfma_f32_16x16x32_bf16 v[84:87], v[164:167], v[156:159], v[84:87]
    v_mfma_f32_16x16x32_bf16 v[88:91], v[168:171], v[156:159], v[88:91]
    v_mfma_f32_16x16x32_bf16 v[92:95], v[172:175], v[156:159], v[92:95]
    v_mfma_f32_16x16x32_bf16 v[96:99], v[156:159], v[176:179], v[96:99]
    v_mfma_f32_16x16x32_bf16 v[100:103], v[156:159], v[180:183], v[100:103]
    s_waitcnt lgkmcnt(0)
    s_nop 0
    v_mfma_f32_16x16x32_bf16 v[8:11], v[120:123], v[104:107], v[8:11]
    ds_read_b128 v[144:147], v189 offset:0
    v_mfma_f32_16x16x32_bf16 v[12:15], v[124:127], v[104:107], v[12:15]
    ds_read_b64_tr_b16 v[160:161], v190 offset:4096
    v_mfma_f32_16x16x32_bf16 v[16:19], v[128:131], v[104:107], v[16:19]
    ds_read_b64_tr_b16 v[162:163], v190 offset:4608
    v_mfma_f32_16x16x32_bf16 v[20:23], v[132:135], v[104:107], v[20:23]
    ds_read_b64_tr_b16 v[164:165], v191 offset:4096
    v_mfma_f32_16x16x32_bf16 v[24:27], v[104:107], v[136:139], v[24:27]
    ds_read_b64_tr_b16 v[166:167], v191 offset:4608
    v_mfma_f32_16x16x32_bf16 v[28:31], v[104:107], v[140:143], v[28:31]
    ds_read_b64_tr_b16 v[168:169], v190 offset:12288
    v_mfma_f32_16x16x32_bf16 v[32:35], v[120:123], v[108:111], v[32:35]
    ds_read_b64_tr_b16 v[170:171], v190 offset:12800
    v_mfma_f32_16x16x32_bf16 v[36:39], v[124:127], v[108:111], v[36:39]
    ds_read_b64_tr_b16 v[172:173], v191 offset:12288
    v_mfma_f32_16x16x32_bf16 v[40:43], v[128:131], v[108:111], v[40:43]
    ds_read_b64_tr_b16 v[174:175], v191 offset:12800
    v_mfma_f32_16x16x32_bf16 v[44:47], v[132:135], v[108:111], v[44:47]
    ds_read_b64_tr_b16 v[176:177], v190 offset:20480
    v_mfma_f32_16x16x32_bf16 v[48:51], v[108:111], v[136:139], v[48:51]
    ds_read_b64_tr_b16 v[178:179], v190 offset:20992
    v_mfma_f32_16x16x32_bf16 v[52:55], v[108:111], v[140:143], v[52:55]
    ds_read_b64_tr_b16 v[180:181], v191 offset:20480
    v_mfma_f32_16x16x32_bf16 v[56:59], v[120:123], v[112:115], v[56:59]
    ds_read_b64_tr_b16 v[182:183], v191 offset:20992
    v_mfma_f32_16x16x32_bf16 v[60:63], v[124:127], v[112:115], v[60:63]
    ds_read_b128 v[148:151], v189 offset:2048
    v_mfma_f32_16x16x32_bf16 v[64:67], v[128:131], v[112:115], v[64:67]
    ds_read_b128 v[152:155], v189 offset:4096
    v_mfma_f32_16x16x32_bf16 v[68:71], v[132:135], v[112:115], v[68:71]
    ds_read_b128 v[156:159], v189 offset:6144
    v_mfma_f32_16x16x32_bf16 v[72:75], v[112:115], v[136:139], v[72:75]
    s_add_u32 s66, s66, 1
    s_cmp_lt_u32 s66, 5
    v_mfma_f32_16x16x32_bf16 v[76:79], v[112:115], v[140:143], v[76:79]
    v_mfma_f32_16x16x32_bf16 v[80:83], v[120:123], v[116:119], v[80:83]
    v_mfma_f32_16x16x32_bf16 v[84:87], v[124:127], v[116:119], v[84:87]
    v_mfma_f32_16x16x32_bf16 v[88:91], v[128:131], v[116:119], v[88:91]
    v_mfma_f32_16x16x32_bf16 v[92:95], v[132:135], v[116:119], v[92:95]
    v_mfma_f32_16x16x32_bf16 v[96:99], v[116:119], v[136:139], v[96:99]
    v_mfma_f32_16x16x32_bf16 v[100:103], v[116:119], v[140:143], v[100:103]
    s_cbranch_scc1 L_cloop
    s_nop 0
    s_waitcnt lgkmcnt(0)
    s_barrier
    v_mfma_f32_16x16x32_bf16 v[8:11], v[160:163], v[144:147], v[8:11]
    ds_read_b128 v[104:107], v184 offset:0
    v_mfma_f32_16x16x32_bf16 v[12:15], v[164:167], v[144:147], v[12:15]
    ds_read_b64_tr_b16 v[120:121], v186 offset:0
    v_mfma_f32_16x16x32_bf16 v[16:19], v[168:171], v[144:147], v[16:19]
    ds_read_b64_tr_b16 v[122:123], v186 offset:512
    v_mfma_f32_16x16x32_bf16 v[20:23], v[172:175], v[144:147], v[20:23]
    ds_read_b64_tr_b16 v[124:125], v187 offset:0
    v_mfma_f32_16x16x32_bf16 v[24:27], v[144:147], v[176:179], v[24:27]
    ds_read_b64_tr_b16 v[126:127], v187 offset:512
    v_mfma_f32_16x16x32_bf16 v[28:31], v[144:147], v[180:183], v[28:31]
    ds_read_b64_tr_b16 v[128:129], v186 offset:8192
    v_mfma_f32_16x16x32_bf16 v[32:35], v[160:163], v[148:151], v[32:35]
    ds_read_b64_tr_b16 v[130:131], v186 offset:8704
    v_mfma_f32_16x16x32_bf16 v[36:39], v[164:167], v[148:151], v[36:39]
    ds_read_b64_tr_b16 v[132:133], v187 offset:8192
    v_mfma_f32_16x16x32_bf16 v[40:43], v[168:171], v[148:151], v[40:43]
    ds_read_b64_tr_b16 v[134:135], v187 offset:8704
    v_mfma_f32_16x16x32_bf16 v[44:47], v[172:175], v[148:151], v[44:47]
    ds_read_b64_tr_b16 v[136:137], v186 offset:16384
    v_mfma_f32_16x16x32_bf16 v[48:51], v[148:151], v[176:179], v[48:51]
    ds_read_b64_tr_b16 v[138:139], v186 offset:16896
    v_mfma_f32_16x16x32_bf16 v[52:55], v[148:151], v[180:183], v[52:55]
    ds_read_b64_tr_b16 v[140:141], v187 offset:16384
    v_mfma_f32_16x16x32_bf16 v[56:59], v[160:163], v[152:155], v[56:59]
    ds_read_b64_tr_b16 v[142:143], v187 offset:16896
    v_mfma_f32_16x16x32_bf16 v[60:63], v[164:167], v[152:155], v[60:63]
    ds_read_b128 v[108:111], v184 offset:2048
    v_mfma_f32_16x16x32_bf16 v[64:67], v[168:171], v[152:155], v[64:67]
    ds_read_b128 v[112:115], v184 offset:4096
    v_mfma_f32_16x16x32_bf16 v[68:71], v[172:175], v[152:155], v[68:71]
    ds_read_b128 v[116:119], v184 offset:6144
    v_mfma_f32_16x16x32_bf16 v[72:75], v[152:155], v[176:179], v[72:75]
    v_mfma_f32_16x16x32_bf16 v[76:79], v[152:155], v[180:183], v[76:79]
    v_mfma_f32_16x16x32_bf16 v[80:83], v[160:163], v[156:159], v[80:83]
    v_mfma_f32_16x16x32_bf16 v[84:87], v[164:167], v[156:159], v[84:87]
    v_mfma_f32_16x16x32_bf16 v[88:91], v[168:171], v[156:159], v[88:91]
    v_mfma_f32_16x16x32_bf16 v[92:95], v[172:175], v[156:159], v[92:95]
    v_mfma_f32_16x16x32_bf16 v[96:99], v[156:159], v[176:179], v[96:99]
    v_mfma_f32_16x16x32_bf16 v[100:103], v[156:159], v[180:183], v[100:103]
    s_waitcnt lgkmcnt(0)
    s_nop 0
    v_mfma_f32_16x16x32_bf16 v[8:11], v[120:123], v[104:107], v[8:11]
    ds_read_b128 v[144:147], v185 offset:0
    v_mfma_f32_16x16x32_bf16 v[12:15], v[124:127], v[104:107], v[12:15]
    ds_read_b64_tr_b16 v[160:161], v186 offset:4096
    v_mfma_f32_16x16x32_bf16 v[16:19], v[128:131], v[104:107], v[16:19]
    ds_read_b64_tr_b16 v[162:163], v186 offset:4608
    v_mfma_f32_16x16x32_bf16 v[20:23], v[132:135], v[104:107], v[20:23]
    ds_read_b64_tr_b16 v[164:165], v187 offset:4096
    v_mfma_f32_16x16x32_bf16 v[24:27], v[104:107], v[136:139], v[24:27]
    ds_read_b64_tr_b16 v[166:167], v187 offset:4608
    v_mfma_f32_16x16x32_bf16 v[28:31], v[104:107], v[140:143], v[28:31]
    ds_read_b64_tr_b16 v[168:169], v186 offset:12288
    v_mfma_f32_16x16x32_bf16 v[32:35], v[120:123], v[108:111], v[32:35]
    ds_read_b64_tr_b16 v[170:171], v186 offset:12800
    v_mfma_f32_16x16x32_bf16 v[36:39], v[124:127], v[108:111], v[36:39]
    ds_read_b64_tr_b16 v[172:173], v187 offset:12288
    v_mfma_f32_16x16x32_bf16 v[40:43], v[128:131], v[108:111], v[40:43]
    ds_read_b64_tr_b16 v[174:175], v187 offset:12800
    v_mfma_f32_16x16x32_bf16 v[44:47], v[132:135], v[108:111], v[44:47]
    ds_read_b64_tr_b16 v[176:177], v186 offset:20480
    v_mfma_f32_16x16x32_bf16 v[48:51], v[108:111], v[136:139], v[48:51]
    ds_read_b64_tr_b16 v[178:179], v186 offset:20992
    v_mfma_f32_16x16x32_bf16 v[52:55], v[108:111], v[140:143], v[52:55]
    ds_read_b64_tr_b16 v[180:181], v187 offset:20480
    v_mfma_f32_16x16x32_bf16 v[56:59], v[120:123], v[112:115], v[56:59]
    ds_read_b64_tr_b16 v[182:183], v187 offset:20992
    v_mfma_f32_16x16x32_bf16 v[60:63], v[124:127], v[112:115], v[60:63]
    ds_read_b128 v[148:151], v185 offset:2048
    v_mfma_f32_16x16x32_bf16 v[64:67], v[128:131], v[112:115], v[64:67]
    ds_read_b128 v[152:155], v185 offset:4096
    v_mfma_f32_16x16x32_bf16 v[68:71], v[132:135], v[112:115], v[68:71]
    ds_read_b128 v[156:159], v185 offset:6144
    v_mfma_f32_16x16x32_bf16 v[72:75], v[112:115], v[136:139], v[72:75]
    v_mfma_f32_16x16x32_bf16 v[76:79], v[112:115], v[140:143], v[76:79]
    v_mfma_f32_16x16x32_bf16 v[80:83], v[120:123], v[116:119], v[80:83]
    v_mfma_f32_16x16x32_bf16 v[84:87], v[124:127], v[116:119], v[84:87]
    v_mfma_f32_16x16x32_bf16 v[88:91], v[128:131], v[116:119], v[88:91]
    v_mfma_f32_16x16x32_bf16 v[92:95], v[132:135], v[116:119], v[92:95]
    v_mfma_f32_16x16x32_bf16 v[96:99], v[116:119], v[136:139], v[96:99]
    v_mfma_f32_16x16x32_bf16 v[100:103], v[116:119], v[140:143], v[100:103]
    v_and_b32 v2, 15, v1
    v_lshrrev_b32 v3, 4, v1
    s_lshl_b32 s3, s64, 8
    s_add_u32 s3, s3, 152064
    v_lshl_add_u32 v4, v2, 2, s3
    v_lshl_add_u32 v5, v3, 4, s3
    v_bfe_u32 v6, v1, 4, 1
    v_lshl_add_u32 v6, v6, 7, v4
    v_lshrrev_b32 v7, 5, v1
    v_lshl_add_u32 v6, v7, 6, v6
    s_lshl_b32 s3, s65, 7
    s_add_u32 s3, s3, 154880
    v_lshl_add_u32 v7, v3, 4, s3
    v_lshl_add_u32 v248, v2, 2, s3
    s_lshl_b32 s3, s64, 7
    s_add_u32 s3, s3, 154624
    v_lshl_add_u32 v249, v3, 4, s3
    v_lshrrev_b32 v250, 2, v1
    v_lshlrev_b32 v250, 6, v250
    v_and_b32 v251, 3, v1
    v_lshl_add_u32 v250, v251, 3, v250
    s_lshl_b32 s3, s65, 11
    s_add_u32 s3, s3, 147712
    v_add_u32 v250, s3, v250
    v_mov_b32 v252, v250
    s_waitcnt lgkmcnt(0)
    v_mfma_f32_16x16x32_bf16 v[16:19], v[168:171], v[144:147], v[16:19]
    s_barrier
    v_mfma_f32_16x16x32_bf16 v[20:23], v[172:175], v[144:147], v[20:23]
    ds_read2_b32 v[192:193], v4 offset0:0 offset1:16
    v_mfma_f32_16x16x32_bf16 v[40:43], v[168:171], v[148:151], v[40:43]
    ds_read2_b32 v[194:195], v4 offset0:32 offset1:48
    v_mfma_f32_16x16x32_bf16 v[44:47], v[172:175], v[148:151], v[44:47]
    ds_read_b128 v[204:207], v7 offset:256
    v_mfma_f32_16x16x32_bf16 v[64:67], v[168:171], v[152:155], v[64:67]
    ds_read_b128 v[208:211], v7 offset:320
    v_mfma_f32_16x16x32_bf16 v[68:71], v[172:175], v[152:155], v[68:71]
    ds_read_b64_tr_b16 v[224:225], v250 offset:0
    v_mfma_f32_16x16x32_bf16 v[88:91], v[168:171], v[156:159], v[88:91]
    ds_read_b64_tr_b16 v[226:227], v250 offset:1024
    v_mfma_f32_16x16x32_bf16 v[92:95], v[172:175], v[156:159], v[92:95]
    ds_read_b64_tr_b16 v[228:229], v250 offset:32
    v_mfma_f32_16x16x32_bf16 v[24:27], v[144:147], v[176:179], v[24:27]
    ds_read_b64_tr_b16 v[230:231], v250 offset:1056
    v_mfma_f32_16x16x32_bf16 v[28:31], v[144:147], v[180:183], v[28:31]
    ds_read_b128 v[104:107], v5 offset:0
    v_mfma_f32_16x16x32_bf16 v[48:51], v[148:151], v[176:179], v[48:51]
    ds_read_b128 v[108:111], v5 offset:64
    v_mfma_f32_16x16x32_bf16 v[52:55], v[148:151], v[180:183], v[52:55]
    ds_read_b128 v[112:115], v5 offset:128
    v_mfma_f32_16x16x32_bf16 v[72:75], v[152:155], v[176:179], v[72:75]
    ds_read_b128 v[116:119], v5 offset:192
    v_mfma_f32_16x16x32_bf16 v[76:79], v[152:155], v[180:183], v[76:79]
    ds_read2_b32 v[220:221], v248 offset0:128 offset1:144
    v_mfma_f32_16x16x32_bf16 v[96:99], v[156:159], v[176:179], v[96:99]
    ds_read_b32 v196, v4 offset:2048
    v_mfma_f32_16x16x32_bf16 v[100:103], v[156:159], v[180:183], v[100:103]
    ds_read_b32 v197, v4 offset:2112
    v_mfma_f32_16x16x32_bf16 v[8:11], v[160:163], v[144:147], v[8:11]
    ds_read_b32 v198, v4 offset:2176
    v_mfma_f32_16x16x32_bf16 v[12:15], v[164:167], v[144:147], v[12:15]
    ds_read_b32 v199, v4 offset:2240
    v_mfma_f32_16x16x32_bf16 v[32:35], v[160:163], v[148:151], v[32:35]
    ds_read_b32 v200, v6 offset:2048
    v_mfma_f32_16x16x32_bf16 v[36:39], v[164:167], v[148:151], v[36:39]
    ds_read_b32 v201, v6 offset:1024
    v_mfma_f32_16x16x32_bf16 v[56:59], v[160:163], v[152:155], v[56:59]
    ds_read_b128 v[120:123], v249 offset:0
    v_mfma_f32_16x16x32_bf16 v[60:63], v[164:167], v[152:155], v[60:63]
    ds_read_b128 v[124:127], v249 offset:64
    v_mfma_f32_16x16x32_bf16 v[80:83], v[160:163], v[156:159], v[80:83]
    ds_read_b128 v[212:215], v7 offset:0
    v_mfma_f32_16x16x32_bf16 v[84:87], v[164:167], v[156:159], v[84:87]
    ds_read_b128 v[216:219], v7 offset:64
    s_waitcnt lgkmcnt(0)
    v_pk_fma_f32 v[16:17], v[192:193], v[204:205], v[16:17] op_sel:[0,0,0] op_sel_hi:[0,1,1] neg_lo:[1,0,0] neg_hi:[1,0,0]
    v_pk_fma_f32 v[18:19], v[192:193], v[206:207], v[18:19] op_sel:[0,0,0] op_sel_hi:[0,1,1] neg_lo:[1,0,0] neg_hi:[1,0,0]
    v_pk_fma_f32 v[20:21], v[192:193], v[208:209], v[20:21] op_sel:[0,0,0] op_sel_hi:[0,1,1] neg_lo:[1,0,0] neg_hi:[1,0,0]
    v_pk_fma_f32 v[22:23], v[192:193], v[210:211], v[22:23] op_sel:[0,0,0] op_sel_hi:[0,1,1] neg_lo:[1,0,0] neg_hi:[1,0,0]
    v_cvt_pk_bf16_f32 v232, v16, v17
    v_cvt_pk_bf16_f32 v233, v18, v19
    v_cvt_pk_bf16_f32 v234, v20, v21
    v_cvt_pk_bf16_f32 v235, v22, v23
    v_pk_fma_f32 v[40:41], v[192:193], v[204:205], v[40:41] op_sel:[1,0,0] op_sel_hi:[1,1,1] neg_lo:[1,0,0] neg_hi:[1,0,0]
    v_pk_fma_f32 v[42:43], v[192:193], v[206:207], v[42:43] op_sel:[1,0,0] op_sel_hi:[1,1,1] neg_lo:[1,0,0] neg_hi:[1,0,0]
    v_pk_fma_f32 v[44:45], v[192:193], v[208:209], v[44:45] op_sel:[1,0,0] op_sel_hi:[1,1,1] neg_lo:[1,0,0] neg_hi:[1,0,0]
    v_pk_fma_f32 v[46:47], v[192:193], v[210:211], v[46:47] op_sel:[1,0,0] op_sel_hi:[1,1,1] neg_lo:[1,0,0] neg_hi:[1,0,0]
    v_cvt_pk_bf16_f32 v236, v40, v41
    v_cvt_pk_bf16_f32 v237, v42, v43
    v_cvt_pk_bf16_f32 v238, v44, v45
    v_cvt_pk_bf16_f32 v239, v46, v47
    v_pk_fma_f32 v[64:65], v[194:195], v[204:205], v[64:65] op_sel:[0,0,0] op_sel_hi:[0,1,1] neg_lo:[1,0,0] neg_hi:[1,0,0]
    v_pk_fma_f32 v[66:67], v[194:195], v[206:207], v[66:67] op_sel:[0,0,0] op_sel_hi:[0,1,1] neg_lo:[1,0,0] neg_hi:[1,0,0]
    v_pk_fma_f32 v[68:69], v[194:195], v[208:209], v[68:69] op_sel:[0,0,0] op_sel_hi:[0,1,1] neg_lo:[1,0,0] neg_hi:[1,0,0]
    v_pk_fma_f32 v[70:71], v[194:195], v[210:211], v[70:71] op_sel:[0,0,0] op_sel_hi:[0,1,1] neg_lo:[1,0,0] neg_hi:[1,0,0]
    v_cvt_pk_bf16_f32 v240, v64, v65
    v_cvt_pk_bf16_f32 v241, v66, v67
    v_cvt_pk_bf16_f32 v242, v68, v69
    v_cvt_pk_bf16_f32 v243, v70, v71
    v_pk_fma_f32 v[88:89], v[194:195], v[204:205], v[88:89] op_sel:[1,0,0] op_sel_hi:[1,1,1] neg_lo:[1,0,0] neg_hi:[1,0,0]
    v_pk_fma_f32 v[90:91], v[194:195], v[206:207], v[90:91] op_sel:[1,0,0] op_sel_hi:[1,1,1] neg_lo:[1,0,0] neg_hi:[1,0,0]
    v_pk_fma_f32 v[92:93], v[194:195], v[208:209], v[92:93] op_sel:[1,0,0] op_sel_hi:[1,1,1] neg_lo:[1,0,0] neg_hi:[1,0,0]
    v_pk_fma_f32 v[94:95], v[194:195], v[210:211], v[94:95] op_sel:[1,0,0] op_sel_hi:[1,1,1] neg_lo:[1,0,0] neg_hi:[1,0,0]
    v_cvt_pk_bf16_f32 v244, v88, v89
    v_cvt_pk_bf16_f32 v245, v90, v91
    v_cvt_pk_bf16_f32 v246, v92, v93
    v_cvt_pk_bf16_f32 v247, v94, v95
    v_mfma_f32_16x16x32_bf16 v[144:147], v[224:227], v[232:235], 0
    v_mfma_f32_16x16x32_bf16 v[148:151], v[228:231], v[232:235], 0
    v_mfma_f32_16x16x32_bf16 v[152:155], v[224:227], v[236:239], 0
    v_mfma_f32_16x16x32_bf16 v[156:159], v[228:231], v[236:239], 0
    v_mfma_f32_16x16x32_bf16 v[160:163], v[224:227], v[240:243], 0
    v_mfma_f32_16x16x32_bf16 v[164:167], v[228:231], v[240:243], 0
    v_mfma_f32_16x16x32_bf16 v[168:171], v[224:227], v[244:247], 0
    v_mfma_f32_16x16x32_bf16 v[172:175], v[228:231], v[244:247], 0
    v_pk_fma_f32 v[24:25], v[104:105], v[220:221], v[24:25] op_sel:[0,0,0] op_sel_hi:[1,0,1] neg_lo:[1,0,0] neg_hi:[1,0,0]
    v_pk_fma_f32 v[26:27], v[106:107], v[220:221], v[26:27] op_sel:[0,0,0] op_sel_hi:[1,0,1] neg_lo:[1,0,0] neg_hi:[1,0,0]
    v_pk_fma_f32 v[28:29], v[104:105], v[220:221], v[28:29] op_sel:[0,1,0] op_sel_hi:[1,1,1] neg_lo:[1,0,0] neg_hi:[1,0,0]
    v_pk_fma_f32 v[30:31], v[106:107], v[220:221], v[30:31] op_sel:[0,1,0] op_sel_hi:[1,1,1] neg_lo:[1,0,0] neg_hi:[1,0,0]
    v_pk_fma_f32 v[48:49], v[108:109], v[220:221], v[48:49] op_sel:[0,0,0] op_sel_hi:[1,0,1] neg_lo:[1,0,0] neg_hi:[1,0,0]
    v_pk_fma_f32 v[50:51], v[110:111], v[220:221], v[50:51] op_sel:[0,0,0] op_sel_hi:[1,0,1] neg_lo:[1,0,0] neg_hi:[1,0,0]
    v_pk_fma_f32 v[52:53], v[108:109], v[220:221], v[52:53] op_sel:[0,1,0] op_sel_hi:[1,1,1] neg_lo:[1,0,0] neg_hi:[1,0,0]
    v_pk_fma_f32 v[54:55], v[110:111], v[220:221], v[54:55] op_sel:[0,1,0] op_sel_hi:[1,1,1] neg_lo:[1,0,0] neg_hi:[1,0,0]
    v_pk_fma_f32 v[72:73], v[112:113], v[220:221], v[72:73] op_sel:[0,0,0] op_sel_hi:[1,0,1] neg_lo:[1,0,0] neg_hi:[1,0,0]
    v_pk_fma_f32 v[74:75], v[114:115], v[220:221], v[74:75] op_sel:[0,0,0] op_sel_hi:[1,0,1] neg_lo:[1,0,0] neg_hi:[1,0,0]
    v_pk_fma_f32 v[76:77], v[112:113], v[220:221], v[76:77] op_sel:[0,1,0] op_sel_hi:[1,1,1] neg_lo:[1,0,0] neg_hi:[1,0,0]
    v_pk_fma_f32 v[78:79], v[114:115], v[220:221], v[78:79] op_sel:[0,1,0] op_sel_hi:[1,1,1] neg_lo:[1,0,0] neg_hi:[1,0,0]
    v_pk_fma_f32 v[96:97], v[116:117], v[220:221], v[96:97] op_sel:[0,0,0] op_sel_hi:[1,0,1] neg_lo:[1,0,0] neg_hi:[1,0,0]
    v_pk_fma_f32 v[98:99], v[118:119], v[220:221], v[98:99] op_sel:[0,0,0] op_sel_hi:[1,0,1] neg_lo:[1,0,0] neg_hi:[1,0,0]
    v_pk_fma_f32 v[100:101], v[116:117], v[220:221], v[100:101] op_sel:[0,1,0] op_sel_hi:[1,1,1] neg_lo:[1,0,0] neg_hi:[1,0,0]
    v_pk_fma_f32 v[102:103], v[118:119], v[220:221], v[102:103] op_sel:[0,1,0] op_sel_hi:[1,1,1] neg_lo:[1,0,0] neg_hi:[1,0,0]
    v_cvt_pk_bf16_f32 v24, v24, v25
    v_cvt_pk_bf16_f32 v25, v26, v27
    v_cvt_pk_bf16_f32 v26, v48, v49
    v_cvt_pk_bf16_f32 v27, v50, v51
    v_cvt_pk_bf16_f32 v28, v28, v29
    v_cvt_pk_bf16_f32 v29, v30, v31
    v_cvt_pk_bf16_f32 v30, v52, v53
    v_cvt_pk_bf16_f32 v31, v54, v55
    v_cvt_pk_bf16_f32 v72, v72, v73
    v_cvt_pk_bf16_f32 v73, v74, v75
    v_cvt_pk_bf16_f32 v74, v96, v97
    v_cvt_pk_bf16_f32 v75, v98, v99
    v_cvt_pk_bf16_f32 v76, v76, v77
    v_cvt_pk_bf16_f32 v77, v78, v79
    v_cvt_pk_bf16_f32 v78, v100, v101
    v_cvt_pk_bf16_f32 v79, v102, v103
    v_and_b32 v2, 15, v1
    v_bfe_u32 v3, v1, 1, 2
    v_lshlrev_b32 v3, 2, v3
    v_bfe_u32 v4, v1, 3, 1
    v_lshl_add_u32 v3, v4, 1, v3
    v_and_b32 v4, 1, v1
    v_add_u32 v3, v3, v4
    v_lshrrev_b32 v4, 4, v1
    v_xor_b32 v3, v3, v4
    s_lshl_b32 s3, s38, 12
    s_add_u32 s3, s3, 131072
    v_lshl_add_u32 v2, v2, 7, s3
    v_lshl_add_u32 v4, v3, 3, v2
    v_xor_b32 v5, 32, v4
    v_xor_b32 v6, 64, v4
    v_xor_b32 v7, 96, v4
    v_bfe_u32 v2, v1, 3, 2
    v_lshlrev_b32 v2, 2, v2
    v_lshrrev_b32 v3, 5, v1
    v_lshl_add_u32 v2, v3, 1, v2
    v_bfe_u32 v3, v1, 2, 1
    v_add_u32 v2, v2, v3
    v_and_b32 v3, 3, v1
    v_xor_b32 v2, v2, v3
    v_lshrrev_b32 v3, 2, v1
    v_lshl_add_u32 v3, v3, 7, s3
    v_lshl_add_u32 v248, v2, 3, v3
    v_xor_b32 v249, 32, v248
    v_xor_b32 v250, 64, v248
    v_xor_b32 v251, 96, v248
    v_max3_f32 v176, v144, v145, v146
    v_max3_f32 v180, -v144, -v145, -v146
    v_max3_f32 v177, v152, v153, v154
    v_max3_f32 v181, -v152, -v153, -v154
    v_max3_f32 v178, v160, v161, v162
    v_max3_f32 v182, -v160, -v161, -v162
    v_max3_f32 v179, v168, v169, v170
    v_max3_f32 v183, -v168, -v169, -v170
    v_max3_f32 v176, v176, v147, v148
    v_max3_f32 v180, v180, -v147, -v148
    v_max3_f32 v177, v177, v155, v156
    v_max3_f32 v181, v181, -v155, -v156
    v_max3_f32 v178, v178, v163, v164
    v_max3_f32 v182, v182, -v163, -v164
    v_max3_f32 v179, v179, v171, v172
    v_max3_f32 v183, v183, -v171, -v172
    v_max3_f32 v176, v176, v149, v150
    v_max3_f32 v180, v180, -v149, -v150
    v_max3_f32 v177, v177, v157, v158
    v_max3_f32 v181, v181, -v157, -v158
    v_max3_f32 v178, v178, v165, v166
    v_max3_f32 v182, v182, -v165, -v166
    v_max3_f32 v179, v179, v173, v174
    v_max3_f32 v183, v183, -v173, -v174
    v_max_f32 v176, v176, v151
    v_max_f32_e64 v180, v180, -v151
    v_max_f32 v177, v177, v159
    v_max_f32_e64 v181, v181, -v159
    v_max_f32 v178, v178, v167
    v_max_f32_e64 v182, v182, -v167
    v_max_f32 v179, v179, v175
    v_max_f32_e64 v183, v183, -v175
    v_permlane32_swap_b32 v176, v177
    v_permlane32_swap_b32 v178, v179
    v_permlane32_swap_b32 v180, v181
    v_permlane32_swap_b32 v182, v183
    v_max_f32 v176, v176, v177
    v_max_f32 v178, v178, v179
    v_max_f32 v180, v180, v181
    v_max_f32 v182, v182, v183
    v_permlane16_swap_b32 v176, v178
    s_nop 0
    v_permlane16_swap_b32 v180, v182
    v_max_f32 v176, v176, v178
    v_max_f32 v180, v180, v182
    v_mul_f32 v176, v176, v200
    v_mul_f32 v180, v180, v200
    v_mov_b32 v178, v176
    v_mov_b32 v182, v180
    s_nop 0
    v_permlane16_swap_b32 v176, v178
    v_permlane16_swap_b32 v180, v182
    v_mov_b32 v177, v176
    v_mov_b32 v179, v178
    v_mov_b32 v181, v180
    v_mov_b32 v183, v182
    v_permlane32_swap_b32 v176, v177
    v_permlane32_swap_b32 v178, v179
    v_permlane32_swap_b32 v180, v181
    v_permlane32_swap_b32 v182, v183
    v_pk_fma_f32 v[16:17], v[144:145], v[196:197], v[180:181] op_sel:[0,0,0] op_sel_hi:[1,0,0] neg_lo:[1,0,1] neg_hi:[1,0,1]
    v_pk_fma_f32 v[144:145], v[144:145], v[196:197], v[176:177] op_sel:[0,0,0] op_sel_hi:[1,0,0] neg_lo:[0,0,1] neg_hi:[0,0,1]
    v_pk_fma_f32 v[18:19], v[146:147], v[196:197], v[180:181] op_sel:[0,0,0] op_sel_hi:[1,0,0] neg_lo:[1,0,1] neg_hi:[1,0,1]
    v_pk_fma_f32 v[146:147], v[146:147], v[196:197], v[176:177] op_sel:[0,0,0] op_sel_hi:[1,0,0] neg_lo:[0,0,1] neg_hi:[0,0,1]
    v_pk_fma_f32 v[20:21], v[148:149], v[196:197], v[180:181] op_sel:[0,0,0] op_sel_hi:[1,0,0] neg_lo:[1,0,1] neg_hi:[1,0,1]
    v_pk_fma_f32 v[148:149], v[148:149], v[196:197], v[176:177] op_sel:[0,0,0] op_sel_hi:[1,0,0] neg_lo:[0,0,1] neg_hi:[0,0,1]
    v_pk_fma_f32 v[22:23], v[150:151], v[196:197], v[180:181] op_sel:[0,0,0] op_sel_hi:[1,0,0] neg_lo:[1,0,1] neg_hi:[1,0,1]
    v_pk_fma_f32 v[150:151], v[150:151], v[196:197], v[176:177] op_sel:[0,0,0] op_sel_hi:[1,0,0] neg_lo:[0,0,1] neg_hi:[0,0,1]
    v_pk_fma_f32 v[40:41], v[152:153], v[196:197], v[180:181] op_sel:[0,1,1] op_sel_hi:[1,1,1] neg_lo:[1,0,1] neg_hi:[1,0,1]
    v_pk_fma_f32 v[152:153], v[152:153], v[196:197], v[176:177] op_sel:[0,1,1] op_sel_hi:[1,1,1] neg_lo:[0,0,1] neg_hi:[0,0,1]
    v_pk_fma_f32 v[42:43], v[154:155], v[196:197], v[180:181] op_sel:[0,1,1] op_sel_hi:[1,1,1] neg_lo:[1,0,1] neg_hi:[1,0,1]
    v_pk_fma_f32 v[154:155], v[154:155], v[196:197], v[176:177] op_sel:[0,1,1] op_sel_hi:[1,1,1] neg_lo:[0,0,1] neg_hi:[0,0,1]
    v_pk_fma_f32 v[44:45], v[156:157], v[196:197], v[180:181] op_sel:[0,1,1] op_sel_hi:[1,1,1] neg_lo:[1,0,1] neg_hi:[1,0,1]
    v_pk_fma_f32 v[156:157], v[156:157], v[196:197], v[176:177] op_sel:[0,1,1] op_sel_hi:[1,1,1] neg_lo:[0,0,1] neg_hi:[0,0,1]
    v_pk_fma_f32 v[46:47], v[158:159], v[196:197], v[180:181] op_sel:[0,1,1] op_sel_hi:[1,1,1] neg_lo:[1,0,1] neg_hi:[1,0,1]
    v_pk_fma_f32 v[158:159], v[158:159], v[196:197], v[176:177] op_sel:[0,1,1] op_sel_hi:[1,1,1] neg_lo:[0,0,1] neg_hi:[0,0,1]
    v_pk_fma_f32 v[64:65], v[160:161], v[198:199], v[182:183] op_sel:[0,0,0] op_sel_hi:[1,0,0] neg_lo:[1,0,1] neg_hi:[1,0,1]
    v_pk_fma_f32 v[160:161], v[160:161], v[198:199], v[178:179] op_sel:[0,0,0] op_sel_hi:[1,0,0] neg_lo:[0,0,1] neg_hi:[0,0,1]
    v_pk_fma_f32 v[66:67], v[162:163], v[198:199], v[182:183] op_sel:[0,0,0] op_sel_hi:[1,0,0] neg_lo:[1,0,1] neg_hi:[1,0,1]
    v_pk_fma_f32 v[162:163], v[162:163], v[198:199], v[178:179] op_sel:[0,0,0] op_sel_hi:[1,0,0] neg_lo:[0,0,1] neg_hi:[0,0,1]
    v_pk_fma_f32 v[68:69], v[164:165], v[198:199], v[182:183] op_sel:[0,0,0] op_sel_hi:[1,0,0] neg_lo:[1,0,1] neg_hi:[1,0,1]
    v_pk_fma_f32 v[164:165], v[164:165], v[198:199], v[178:179] op_sel:[0,0,0] op_sel_hi:[1,0,0] neg_lo:[0,0,1] neg_hi:[0,0,1]
    v_pk_fma_f32 v[70:71], v[166:167], v[198:199], v[182:183] op_sel:[0,0,0] op_sel_hi:[1,0,0] neg_lo:[1,0,1] neg_hi:[1,0,1]
    v_pk_fma_f32 v[166:167], v[166:167], v[198:199], v[178:179] op_sel:[0,0,0] op_sel_hi:[1,0,0] neg_lo:[0,0,1] neg_hi:[0,0,1]
    v_pk_fma_f32 v[88:89], v[168:169], v[198:199], v[182:183] op_sel:[0,1,1] op_sel_hi:[1,1,1] neg_lo:[1,0,1] neg_hi:[1,0,1]
    v_pk_fma_f32 v[168:169], v[168:169], v[198:199], v[178:179] op_sel:[0,1,1] op_sel_hi:[1,1,1] neg_lo:[0,0,1] neg_hi:[0,0,1]
    v_pk_fma_f32 v[90:91], v[170:171], v[198:199], v[182:183] op_sel:[0,1,1] op_sel_hi:[1,1,1] neg_lo:[1,0,1] neg_hi:[1,0,1]
    v_pk_fma_f32 v[170:171], v[170:171], v[198:199], v[178:179] op_sel:[0,1,1] op_sel_hi:[1,1,1] neg_lo:[0,0,1] neg_hi:[0,0,1]
    v_pk_fma_f32 v[92:93], v[172:173], v[198:199], v[182:183] op_sel:[0,1,1] op_sel_hi:[1,1,1] neg_lo:[1,0,1] neg_hi:[1,0,1]
    v_pk_fma_f32 v[172:173], v[172:173], v[198:199], v[178:179] op_sel:[0,1,1] op_sel_hi:[1,1,1] neg_lo:[0,0,1] neg_hi:[0,0,1]
    v_pk_fma_f32 v[94:95], v[174:175], v[198:199], v[182:183] op_sel:[0,1,1] op_sel_hi:[1,1,1] neg_lo:[1,0,1] neg_hi:[1,0,1]
    v_pk_fma_f32 v[174:175], v[174:175], v[198:199], v[178:179] op_sel:[0,1,1] op_sel_hi:[1,1,1] neg_lo:[0,0,1] neg_hi:[0,0,1]
    v_exp_f32 v16, v16
    v_exp_f32 v144, v144
    v_exp_f32 v17, v17
    v_exp_f32 v145, v145
    v_exp_f32 v18, v18
    v_exp_f32 v146, v146
    v_exp_f32 v19, v19
    v_exp_f32 v147, v147
    v_exp_f32 v20, v20
    v_exp_f32 v148, v148
    v_exp_f32 v21, v21
    v_exp_f32 v149, v149
    v_exp_f32 v22, v22
    v_exp_f32 v150, v150
    v_exp_f32 v23, v23
    v_exp_f32 v151, v151
    v_exp_f32 v40, v40
    v_exp_f32 v152, v152
    v_exp_f32 v41, v41
    v_exp_f32 v153, v153
    v_exp_f32 v42, v42
    v_exp_f32 v154, v154
    v_exp_f32 v43, v43
    v_exp_f32 v155, v155
    v_exp_f32 v44, v44
    v_exp_f32 v156, v156
    v_exp_f32 v45, v45
    v_exp_f32 v157, v157
    v_exp_f32 v46, v46
    v_exp_f32 v158, v158
    v_exp_f32 v47, v47
    v_exp_f32 v159, v159
    v_exp_f32 v64, v64
    v_exp_f32 v160, v160
    v_exp_f32 v65, v65
    v_exp_f32 v161, v161
    v_exp_f32 v66, v66
    v_exp_f32 v162, v162
    v_exp_f32 v67, v67
    v_exp_f32 v163, v163
    v_exp_f32 v68, v68
    v_exp_f32 v164, v164
    v_exp_f32 v69, v69
    v_exp_f32 v165, v165
    v_exp_f32 v70, v70
    v_exp_f32 v166, v166
    v_exp_f32 v71, v71
    v_exp_f32 v167, v167
    v_exp_f32 v88, v88
    v_exp_f32 v168, v168
    v_exp_f32 v89, v89
    v_exp_f32 v169, v169
    v_exp_f32 v90, v90
    v_exp_f32 v170, v170
    v_exp_f32 v91, v91
    v_exp_f32 v171, v171
    v_exp_f32 v92, v92
    v_exp_f32 v172, v172
    v_exp_f32 v93, v93
    v_exp_f32 v173, v173
    v_exp_f32 v94, v94
    v_exp_f32 v174, v174
    v_exp_f32 v95, v95
    v_exp_f32 v175, v175
    v_pk_add_f32 v[128:129], v[144:145], v[146:147]
    v_pk_add_f32 v[130:131], v[16:17], v[18:19]
    v_pk_add_f32 v[132:133], v[152:153], v[154:155]
    v_pk_add_f32 v[134:135], v[40:41], v[42:43]
    v_pk_add_f32 v[136:137], v[160:161], v[162:163]
    v_pk_add_f32 v[138:139], v[64:65], v[66:67]
    v_pk_add_f32 v[140:141], v[168:169], v[170:171]
    v_pk_add_f32 v[142:143], v[88:89], v[90:91]
    v_pk_add_f32 v[128:129], v[128:129], v[148:149]
    v_pk_add_f32 v[130:131], v[130:131], v[20:21]
    v_pk_add_f32 v[132:133], v[132:133], v[156:157]
    v_pk_add_f32 v[134:135], v[134:135], v[44:45]
    v_pk_add_f32 v[136:137], v[136:137], v[164:165]
    v_pk_add_f32 v[138:139], v[138:139], v[68:69]
    v_pk_add_f32 v[140:141], v[140:141], v[172:173]
    v_pk_add_f32 v[142:143], v[142:143], v[92:93]
    v_pk_add_f32 v[128:129], v[128:129], v[150:151]
    v_pk_add_f32 v[130:131], v[130:131], v[22:23]
    v_pk_add_f32 v[132:133], v[132:133], v[158:159]
    v_pk_add_f32 v[134:135], v[134:135], v[46:47]
    v_pk_add_f32 v[136:137], v[136:137], v[166:167]
    v_pk_add_f32 v[138:139], v[138:139], v[70:71]
    v_pk_add_f32 v[140:141], v[140:141], v[174:175]
    v_pk_add_f32 v[142:143], v[142:143], v[94:95]
    v_add_f32 v176, v128, v129
    v_add_f32 v180, v130, v131
    v_add_f32 v177, v132, v133
    v_add_f32 v181, v134, v135
    v_add_f32 v178, v136, v137
    v_add_f32 v182, v138, v139
    v_add_f32 v179, v140, v141
    v_add_f32 v183, v142, v143
    v_permlane32_swap_b32 v176, v177
    v_permlane32_swap_b32 v178, v179
    v_permlane32_swap_b32 v180, v181
    v_permlane32_swap_b32 v182, v183
    v_add_f32 v176, v176, v177
    v_add_f32 v178, v178, v179
    v_add_f32 v180, v180, v181
    v_add_f32 v182, v182, v183
    v_permlane16_swap_b32 v176, v178
    s_nop 0
    v_permlane16_swap_b32 v180, v182
    v_add_f32 v176, v176, v178
    v_add_f32 v180, v180, v182
    v_rcp_f32 v176, v176
    v_rcp_f32 v180, v180
    v_mul_f32 v176, v176, v201
    v_mul_f32 v180, v180, v201
    v_mov_b32 v178, v176
    v_mov_b32 v182, v180
    s_nop 0
    v_permlane16_swap_b32 v176, v178
    v_permlane16_swap_b32 v180, v182
    v_mov_b32 v177, v176
    v_mov_b32 v179, v178
    v_mov_b32 v181, v180
    v_mov_b32 v183, v182
    v_permlane32_swap_b32 v176, v177
    v_permlane32_swap_b32 v178, v179
    v_permlane32_swap_b32 v180, v181
    v_permlane32_swap_b32 v182, v183
    v_pk_mul_f32 v[144:145], v[144:145], v[176:177] op_sel:[0,0] op_sel_hi:[1,0]
    v_pk_mul_f32 v[146:147], v[146:147], v[176:177] op_sel:[0,0] op_sel_hi:[1,0]
    v_pk_mul_f32 v[148:149], v[148:149], v[176:177] op_sel:[0,0] op_sel_hi:[1,0]
    v_pk_mul_f32 v[150:151], v[150:151], v[176:177] op_sel:[0,0] op_sel_hi:[1,0]
    v_cvt_pk_bf16_f32 v144, v144, v145
    v_cvt_pk_bf16_f32 v145, v146, v147
    v_cvt_pk_bf16_f32 v146, v148, v149
    v_cvt_pk_bf16_f32 v147, v150, v151
    v_pk_mul_f32 v[16:17], v[16:17], v[180:181] op_sel:[0,0] op_sel_hi:[1,0]
    v_pk_mul_f32 v[18:19], v[18:19], v[180:181] op_sel:[0,0] op_sel_hi:[1,0]
    v_pk_mul_f32 v[20:21], v[20:21], v[180:181] op_sel:[0,0] op_sel_hi:[1,0]
    v_pk_mul_f32 v[22:23], v[22:23], v[180:181] op_sel:[0,0] op_sel_hi:[1,0]
    v_cvt_pk_bf16_f32 v16, v16, v17
    v_cvt_pk_bf16_f32 v17, v18, v19
    v_cvt_pk_bf16_f32 v18, v20, v21
    v_cvt_pk_bf16_f32 v19, v22, v23
    v_pk_mul_f32 v[152:153], v[152:153], v[176:177] op_sel:[0,1] op_sel_hi:[1,1]
    v_pk_mul_f32 v[154:155], v[154:155], v[176:177] op_sel:[0,1] op_sel_hi:[1,1]
    v_pk_mul_f32 v[156:157], v[156:157], v[176:177] op_sel:[0,1] op_sel_hi:[1,1]
    v_pk_mul_f32 v[158:159], v[158:159], v[176:177] op_sel:[0,1] op_sel_hi:[1,1]
    v_cvt_pk_bf16_f32 v152, v152, v153
    v_cvt_pk_bf16_f32 v153, v154, v155
    v_cvt_pk_bf16_f32 v154, v156, v157
    v_cvt_pk_bf16_f32 v155, v158, v159
    v_pk_mul_f32 v[40:41], v[40:41], v[180:181] op_sel:[0,1] op_sel_hi:[1,1]
    v_pk_mul_f32 v[42:43], v[42:43], v[180:181] op_sel:[0,1] op_sel_hi:[1,1]
    v_pk_mul_f32 v[44:45], v[44:45], v[180:181] op_sel:[0,1] op_sel_hi:[1,1]
    v_pk_mul_f32 v[46:47], v[46:47], v[180:181] op_sel:[0,1] op_sel_hi:[1,1]
    v_cvt_pk_bf16_f32 v40, v40, v41
    v_cvt_pk_bf16_f32 v41, v42, v43
    v_cvt_pk_bf16_f32 v42, v44, v45
    v_cvt_pk_bf16_f32 v43, v46, v47
    v_pk_mul_f32 v[160:161], v[160:161], v[178:179] op_sel:[0,0] op_sel_hi:[1,0]
    v_pk_mul_f32 v[162:163], v[162:163], v[178:179] op_sel:[0,0] op_sel_hi:[1,0]
    v_pk_mul_f32 v[164:165], v[164:165], v[178:179] op_sel:[0,0] op_sel_hi:[1,0]
    v_pk_mul_f32 v[166:167], v[166:167], v[178:179] op_sel:[0,0] op_sel_hi:[1,0]
    v_cvt_pk_bf16_f32 v160, v160, v161
    v_cvt_pk_bf16_f32 v161, v162, v163
    v_cvt_pk_bf16_f32 v162, v164, v165
    v_cvt_pk_bf16_f32 v163, v166, v167
    v_pk_mul_f32 v[64:65], v[64:65], v[182:183] op_sel:[0,0] op_sel_hi:[1,0]
    v_pk_mul_f32 v[66:67], v[66:67], v[182:183] op_sel:[0,0] op_sel_hi:[1,0]
    v_pk_mul_f32 v[68:69], v[68:69], v[182:183] op_sel:[0,0] op_sel_hi:[1,0]
    v_pk_mul_f32 v[70:71], v[70:71], v[182:183] op_sel:[0,0] op_sel_hi:[1,0]
    v_cvt_pk_bf16_f32 v64, v64, v65
    v_cvt_pk_bf16_f32 v65, v66, v67
    v_cvt_pk_bf16_f32 v66, v68, v69
    v_cvt_pk_bf16_f32 v67, v70, v71
    v_pk_mul_f32 v[168:169], v[168:169], v[178:179] op_sel:[0,1] op_sel_hi:[1,1]
    v_pk_mul_f32 v[170:171], v[170:171], v[178:179] op_sel:[0,1] op_sel_hi:[1,1]
    v_pk_mul_f32 v[172:173], v[172:173], v[178:179] op_sel:[0,1] op_sel_hi:[1,1]
    v_pk_mul_f32 v[174:175], v[174:175], v[178:179] op_sel:[0,1] op_sel_hi:[1,1]
    v_cvt_pk_bf16_f32 v168, v168, v169
    v_cvt_pk_bf16_f32 v169, v170, v171
    v_cvt_pk_bf16_f32 v170, v172, v173
    v_cvt_pk_bf16_f32 v171, v174, v175
    v_pk_mul_f32 v[88:89], v[88:89], v[182:183] op_sel:[0,1] op_sel_hi:[1,1]
    v_pk_mul_f32 v[90:91], v[90:91], v[182:183] op_sel:[0,1] op_sel_hi:[1,1]
    v_pk_mul_f32 v[92:93], v[92:93], v[182:183] op_sel:[0,1] op_sel_hi:[1,1]
    v_pk_mul_f32 v[94:95], v[94:95], v[182:183] op_sel:[0,1] op_sel_hi:[1,1]
    v_cvt_pk_bf16_f32 v88, v88, v89
    v_cvt_pk_bf16_f32 v89, v90, v91
    v_cvt_pk_bf16_f32 v90, v92, v93
    v_cvt_pk_bf16_f32 v91, v94, v95
    ds_write_b64 v4, v[144:145] offset:0
    ds_write_b64 v5, v[146:147] offset:0
    ds_write_b64 v6, v[16:17] offset:0
    ds_write_b64 v7, v[18:19] offset:0
    ds_write_b64 v4, v[152:153] offset:2048
    ds_write_b64 v5, v[154:155] offset:2048
    ds_write_b64 v6, v[40:41] offset:2048
    ds_write_b64 v7, v[42:43] offset:2048
    ds_read_b64_tr_b16 v[232:233], v248 offset:0
    ds_read_b64_tr_b16 v[234:235], v248 offset:2048
    ds_read_b64_tr_b16 v[236:237], v249 offset:0
    ds_read_b64_tr_b16 v[238:239], v249 offset:2048
    ds_read_b64_tr_b16 v[240:241], v250 offset:0
    ds_read_b64_tr_b16 v[242:243], v250 offset:2048
    ds_read_b64_tr_b16 v[244:245], v251 offset:0
    ds_read_b64_tr_b16 v[246:247], v251 offset:2048
    ds_write_b64 v4, v[160:161] offset:0
    ds_write_b64 v5, v[162:163] offset:0
    ds_write_b64 v6, v[64:65] offset:0
    ds_write_b64 v7, v[66:67] offset:0
    ds_write_b64 v4, v[168:169] offset:2048
    ds_write_b64 v5, v[170:171] offset:2048
    ds_write_b64 v6, v[88:89] offset:2048
    ds_write_b64 v7, v[90:91] offset:2048
    ds_read_b64_tr_b16 v[176:177], v248 offset:0
    ds_read_b64_tr_b16 v[178:179], v248 offset:2048
    ds_read_b64_tr_b16 v[180:181], v249 offset:0
    ds_read_b64_tr_b16 v[182:183], v249 offset:2048
    ds_read_b64_tr_b16 v[184:185], v250 offset:0
    ds_read_b64_tr_b16 v[186:187], v250 offset:2048
    ds_read_b64_tr_b16 v[188:189], v251 offset:0
    ds_read_b64_tr_b16 v[190:191], v251 offset:2048
    s_lshl_b32 s3, s37, 1
    s_add_u32 s67, s3, s65
    s_lshl_b32 s3, s67, 5
    s_lshl_b32 s28, s36, 1
    s_add_u32 s3, s3, s28
    s_add_u32 s3, s3, s64
    s_mul_i32 s3, s3, 4224
    s_add_u32 s3, s3, 8388608
    v_lshlrev_b32 v2, 4, v1
    v_and_b32 v3, 1, v1
    v_cmp_eq_u32 vcc, 1, v3
    v_lshrrev_b32 v253, 4, v1
    v_lshl_add_u32 v3, v253, 1, v3
    v_lshlrev_b32 v3, 4, v3
    v_add_u32 v3, 4096, v3
    s_waitcnt lgkmcnt(8)
    v_mfma_f32_16x16x32_bf16 v[128:131], v[232:235], v[24:27], 0
    v_mfma_f32_16x16x32_bf16 v[136:139], v[232:235], v[28:31], 0
    v_mfma_f32_16x16x32_bf16 v[160:163], v[232:235], v[120:123], 0
    v_mfma_f32_16x16x32_bf16 v[132:135], v[236:239], v[24:27], 0
    v_mfma_f32_16x16x32_bf16 v[140:143], v[236:239], v[28:31], 0
    v_mfma_f32_16x16x32_bf16 v[164:167], v[236:239], v[120:123], 0
    v_mfma_f32_16x16x32_bf16 v[144:147], v[240:243], v[24:27], 0
    v_mfma_f32_16x16x32_bf16 v[152:155], v[240:243], v[28:31], 0
    v_mfma_f32_16x16x32_bf16 v[168:171], v[240:243], v[120:123], 0
    v_mfma_f32_16x16x32_bf16 v[148:151], v[244:247], v[24:27], 0
    v_mfma_f32_16x16x32_bf16 v[156:159], v[244:247], v[28:31], 0
    v_mfma_f32_16x16x32_bf16 v[172:175], v[244:247], v[120:123], 0
    s_waitcnt lgkmcnt(6)
    v_mfma_f32_16x16x32_bf16 v[128:131], v[176:179], v[72:75], v[128:131]
    v_mfma_f32_16x16x32_bf16 v[136:139], v[176:179], v[76:79], v[136:139]
    v_mfma_f32_16x16x32_bf16 v[160:163], v[176:179], v[124:127], v[160:163]
    s_waitcnt lgkmcnt(4)
    v_mfma_f32_16x16x32_bf16 v[132:135], v[180:183], v[72:75], v[132:135]
    v_mfma_f32_16x16x32_bf16 v[140:143], v[180:183], v[76:79], v[140:143]
    v_mfma_f32_16x16x32_bf16 v[164:167], v[180:183], v[124:127], v[164:167]
    s_waitcnt lgkmcnt(2)
    v_mfma_f32_16x16x32_bf16 v[144:147], v[184:187], v[72:75], v[144:147]
    v_mfma_f32_16x16x32_bf16 v[152:155], v[184:187], v[76:79], v[152:155]
    v_mfma_f32_16x16x32_bf16 v[168:171], v[184:187], v[124:127], v[168:171]
    s_waitcnt lgkmcnt(0)
    v_mfma_f32_16x16x32_bf16 v[148:151], v[188:191], v[72:75], v[148:151]
    v_mfma_f32_16x16x32_bf16 v[156:159], v[188:191], v[76:79], v[156:159]
    v_mfma_f32_16x16x32_bf16 v[172:175], v[188:191], v[124:127], v[172:175]
    v_cvt_pk_bf16_f32 v128, v128, v129
    v_cvt_pk_bf16_f32 v129, v130, v131
    v_cvt_pk_bf16_f32 v130, v132, v133
    v_cvt_pk_bf16_f32 v131, v134, v135
    buffer_store_dwordx4 v[128:131], v2, s[48:51], s3 offen offset:0 sc1
    v_cvt_pk_bf16_f32 v136, v136, v137
    v_cvt_pk_bf16_f32 v137, v138, v139
    v_cvt_pk_bf16_f32 v138, v140, v141
    v_cvt_pk_bf16_f32 v139, v142, v143
    buffer_store_dwordx4 v[136:139], v2, s[48:51], s3 offen offset:1024 sc1
    v_cvt_pk_bf16_f32 v144, v144, v145
    v_cvt_pk_bf16_f32 v145, v146, v147
    v_cvt_pk_bf16_f32 v146, v148, v149
    v_cvt_pk_bf16_f32 v147, v150, v151
    buffer_store_dwordx4 v[144:147], v2, s[48:51], s3 offen offset:2048 sc1
    v_cvt_pk_bf16_f32 v152, v152, v153
    v_cvt_pk_bf16_f32 v153, v154, v155
    v_cvt_pk_bf16_f32 v154, v156, v157
    v_cvt_pk_bf16_f32 v155, v158, v159
    buffer_store_dwordx4 v[152:155], v2, s[48:51], s3 offen offset:3072 sc1
    v_cvt_pk_bf16_f32 v160, v160, v161
    v_cvt_pk_bf16_f32 v161, v162, v163
    v_cvt_pk_bf16_f32 v162, v164, v165
    v_cvt_pk_bf16_f32 v163, v166, v167
    v_cvt_pk_bf16_f32 v168, v168, v169
    v_cvt_pk_bf16_f32 v169, v170, v171
    v_cvt_pk_bf16_f32 v170, v172, v173
    v_cvt_pk_bf16_f32 v171, v174, v175
    v_cndmask_b32 v160, v160, v168, vcc
    v_cndmask_b32 v161, v161, v169, vcc
    v_cndmask_b32 v162, v162, v170, vcc
    v_cndmask_b32 v163, v163, v171, vcc
    s_mov_b32 exec_lo, 0x00030003
    s_mov_b32 exec_hi, 0x00030003
    buffer_store_dwordx4 v[160:163], v3, s[48:51], s3 offen sc1
    s_mov_b64 exec, -1
    ds_read_b64_tr_b16 v[224:225], v252 offset:8192
    ds_read_b64_tr_b16 v[226:227], v252 offset:9216
    ds_read_b64_tr_b16 v[228:229], v252 offset:8224
    ds_read_b64_tr_b16 v[230:231], v252 offset:9248
    s_xor_b32 s67, s67, 8
    s_lshl_b32 s3, s38, 2
    s_add_u32 s3, s3, 162112
    v_mov_b32 v4, s3
    v_mov_b32 v5, 1
    ds_write_b32 v4, v5
    s_setprio 0
    v_pk_fma_f32 v[8:9], v[192:193], v[212:213], v[8:9] op_sel:[0,0,0] op_sel_hi:[0,1,1] neg_lo:[1,0,0] neg_hi:[1,0,0]
    v_pk_fma_f32 v[10:11], v[192:193], v[214:215], v[10:11] op_sel:[0,0,0] op_sel_hi:[0,1,1] neg_lo:[1,0,0] neg_hi:[1,0,0]
    v_pk_fma_f32 v[12:13], v[192:193], v[216:217], v[12:13] op_sel:[0,0,0] op_sel_hi:[0,1,1] neg_lo:[1,0,0] neg_hi:[1,0,0]
    v_pk_fma_f32 v[14:15], v[192:193], v[218:219], v[14:15] op_sel:[0,0,0] op_sel_hi:[0,1,1] neg_lo:[1,0,0] neg_hi:[1,0,0]
    v_cvt_pk_bf16_f32 v232, v8, v9
    v_cvt_pk_bf16_f32 v233, v10, v11
    v_cvt_pk_bf16_f32 v234, v12, v13
    v_cvt_pk_bf16_f32 v235, v14, v15
    v_pk_fma_f32 v[32:33], v[192:193], v[212:213], v[32:33] op_sel:[1,0,0] op_sel_hi:[1,1,1] neg_lo:[1,0,0] neg_hi:[1,0,0]
    v_pk_fma_f32 v[34:35], v[192:193], v[214:215], v[34:35] op_sel:[1,0,0] op_sel_hi:[1,1,1] neg_lo:[1,0,0] neg_hi:[1,0,0]
    v_pk_fma_f32 v[36:37], v[192:193], v[216:217], v[36:37] op_sel:[1,0,0] op_sel_hi:[1,1,1] neg_lo:[1,0,0] neg_hi:[1,0,0]
    v_pk_fma_f32 v[38:39], v[192:193], v[218:219], v[38:39] op_sel:[1,0,0] op_sel_hi:[1,1,1] neg_lo:[1,0,0] neg_hi:[1,0,0]
    v_cvt_pk_bf16_f32 v236, v32, v33
    v_cvt_pk_bf16_f32 v237, v34, v35
    v_cvt_pk_bf16_f32 v238, v36, v37
    v_cvt_pk_bf16_f32 v239, v38, v39
    v_pk_fma_f32 v[56:57], v[194:195], v[212:213], v[56:57] op_sel:[0,0,0] op_sel_hi:[0,1,1] neg_lo:[1,0,0] neg_hi:[1,0,0]
    v_pk_fma_f32 v[58:59], v[194:195], v[214:215], v[58:59] op_sel:[0,0,0] op_sel_hi:[0,1,1] neg_lo:[1,0,0] neg_hi:[1,0,0]
    v_pk_fma_f32 v[60:61], v[194:195], v[216:217], v[60:61] op_sel:[0,0,0] op_sel_hi:[0,1,1] neg_lo:[1,0,0] neg_hi:[1,0,0]
    v_pk_fma_f32 v[62:63], v[194:195], v[218:219], v[62:63] op_sel:[0,0,0] op_sel_hi:[0,1,1] neg_lo:[1,0,0] neg_hi:[1,0,0]
    v_cvt_pk_bf16_f32 v240, v56, v57
    v_cvt_pk_bf16_f32 v241, v58, v59
    v_cvt_pk_bf16_f32 v242, v60, v61
    v_cvt_pk_bf16_f32 v243, v62, v63
    v_pk_fma_f32 v[80:81], v[194:195], v[212:213], v[80:81] op_sel:[1,0,0] op_sel_hi:[1,1,1] neg_lo:[1,0,0] neg_hi:[1,0,0]
    v_pk_fma_f32 v[82:83], v[194:195], v[214:215], v[82:83] op_sel:[1,0,0] op_sel_hi:[1,1,1] neg_lo:[1,0,0] neg_hi:[1,0,0]
    v_pk_fma_f32 v[84:85], v[194:195], v[216:217], v[84:85] op_sel:[1,0,0] op_sel_hi:[1,1,1] neg_lo:[1,0,0] neg_hi:[1,0,0]
    v_pk_fma_f32 v[86:87], v[194:195], v[218:219], v[86:87] op_sel:[1,0,0] op_sel_hi:[1,1,1] neg_lo:[1,0,0] neg_hi:[1,0,0]
    v_cvt_pk_bf16_f32 v244, v80, v81
    v_cvt_pk_bf16_f32 v245, v82, v83
    v_cvt_pk_bf16_f32 v246, v84, v85
    v_cvt_pk_bf16_f32 v247, v86, v87
    s_waitcnt lgkmcnt(1)
    v_mfma_f32_16x16x32_bf16 v[144:147], v[224:227], v[232:235], 0
    v_mfma_f32_16x16x32_bf16 v[148:151], v[228:231], v[232:235], 0
    v_mfma_f32_16x16x32_bf16 v[152:155], v[224:227], v[236:239], 0
    v_mfma_f32_16x16x32_bf16 v[156:159], v[228:231], v[236:239], 0
    v_mfma_f32_16x16x32_bf16 v[160:163], v[224:227], v[240:243], 0
    v_mfma_f32_16x16x32_bf16 v[164:167], v[228:231], v[240:243], 0
    v_mfma_f32_16x16x32_bf16 v[168:171], v[224:227], v[244:247], 0
    v_mfma_f32_16x16x32_bf16 v[172:175], v[228:231], v[244:247], 0
    s_nop 0
    v_max3_f32 v176, v144, v145, v146
    v_max3_f32 v180, -v144, -v145, -v146
    v_max3_f32 v177, v152, v153, v154
    v_max3_f32 v181, -v152, -v153, -v154
    v_max3_f32 v178, v160, v161, v162
    v_max3_f32 v182, -v160, -v161, -v162
    v_max3_f32 v179, v168, v169, v170
    v_max3_f32 v183, -v168, -v169, -v170
    v_max3_f32 v176, v176, v147, v148
    v_max3_f32 v180, v180, -v147, -v148
    v_max3_f32 v177, v177, v155, v156
    v_max3_f32 v181, v181, -v155, -v156
    v_max3_f32 v178, v178, v163, v164
    v_max3_f32 v182, v182, -v163, -v164
    v_max3_f32 v179, v179, v171, v172
    v_max3_f32 v183, v183, -v171, -v172
    v_max3_f32 v176, v176, v149, v150
    v_max3_f32 v180, v180, -v149, -v150
    v_max3_f32 v177, v177, v157, v158
    v_max3_f32 v181, v181, -v157, -v158
    v_max3_f32 v178, v178, v165, v166
    v_max3_f32 v182, v182, -v165, -v166
    v_max3_f32 v179, v179, v173, v174
    v_max3_f32 v183, v183, -v173, -v174
    v_max_f32 v176, v176, v151
    v_max_f32_e64 v180, v180, -v151
    v_max_f32 v177, v177, v159
    v_max_f32_e64 v181, v181, -v159
    v_max_f32 v178, v178, v167
    v_max_f32_e64 v182, v182, -v167
    v_max_f32 v179, v179, v175
    v_max_f32_e64 v183, v183, -v175
    v_permlane32_swap_b32 v176, v177
    v_permlane32_swap_b32 v178, v179
    v_permlane32_swap_b32 v180, v181
    v_permlane32_swap_b32 v182, v183
    v_max_f32 v176, v176, v177
    v_max_f32 v178, v178, v179
    v_max_f32 v180, v180, v181
    v_max_f32 v182, v182, v183
    v_permlane16_swap_b32 v176, v178
    s_nop 0
    v_permlane16_swap_b32 v180, v182
    v_max_f32 v176, v176, v178
    v_max_f32 v180, v180, v182
    v_mul_f32 v176, v176, v200
    v_mul_f32 v180, v180, v200
    v_mov_b32 v178, v176
    v_mov_b32 v182, v180
    s_nop 0
    v_permlane16_swap_b32 v176, v178
    v_permlane16_swap_b32 v180, v182
    v_mov_b32 v177, v176
    v_mov_b32 v179, v178
    v_mov_b32 v181, v180
    v_mov_b32 v183, v182
    v_permlane32_swap_b32 v176, v177
    v_permlane32_swap_b32 v178, v179
    v_permlane32_swap_b32 v180, v181
    v_permlane32_swap_b32 v182, v183
    v_pk_fma_f32 v[8:9], v[144:145], v[196:197], v[180:181] op_sel:[0,0,0] op_sel_hi:[1,0,0] neg_lo:[1,0,1] neg_hi:[1,0,1]
    v_pk_fma_f32 v[144:145], v[144:145], v[196:197], v[176:177] op_sel:[0,0,0] op_sel_hi:[1,0,0] neg_lo:[0,0,1] neg_hi:[0,0,1]
    v_pk_fma_f32 v[10:11], v[146:147], v[196:197], v[180:181] op_sel:[0,0,0] op_sel_hi:[1,0,0] neg_lo:[1,0,1] neg_hi:[1,0,1]
    v_pk_fma_f32 v[146:147], v[146:147], v[196:197], v[176:177] op_sel:[0,0,0] op_sel_hi:[1,0,0] neg_lo:[0,0,1] neg_hi:[0,0,1]
    v_pk_fma_f32 v[12:13], v[148:149], v[196:197], v[180:181] op_sel:[0,0,0] op_sel_hi:[1,0,0] neg_lo:[1,0,1] neg_hi:[1,0,1]
    v_pk_fma_f32 v[148:149], v[148:149], v[196:197], v[176:177] op_sel:[0,0,0] op_sel_hi:[1,0,0] neg_lo:[0,0,1] neg_hi:[0,0,1]
    v_pk_fma_f32 v[14:15], v[150:151], v[196:197], v[180:181] op_sel:[0,0,0] op_sel_hi:[1,0,0] neg_lo:[1,0,1] neg_hi:[1,0,1]
    v_pk_fma_f32 v[150:151], v[150:151], v[196:197], v[176:177] op_sel:[0,0,0] op_sel_hi:[1,0,0] neg_lo:[0,0,1] neg_hi:[0,0,1]
    v_pk_fma_f32 v[32:33], v[152:153], v[196:197], v[180:181] op_sel:[0,1,1] op_sel_hi:[1,1,1] neg_lo:[1,0,1] neg_hi:[1,0,1]
    v_pk_fma_f32 v[152:153], v[152:153], v[196:197], v[176:177] op_sel:[0,1,1] op_sel_hi:[1,1,1] neg_lo:[0,0,1] neg_hi:[0,0,1]
    v_pk_fma_f32 v[34:35], v[154:155], v[196:197], v[180:181] op_sel:[0,1,1] op_sel_hi:[1,1,1] neg_lo:[1,0,1] neg_hi:[1,0,1]
    v_pk_fma_f32 v[154:155], v[154:155], v[196:197], v[176:177] op_sel:[0,1,1] op_sel_hi:[1,1,1] neg_lo:[0,0,1] neg_hi:[0,0,1]
    v_pk_fma_f32 v[36:37], v[156:157], v[196:197], v[180:181] op_sel:[0,1,1] op_sel_hi:[1,1,1] neg_lo:[1,0,1] neg_hi:[1,0,1]
    v_pk_fma_f32 v[156:157], v[156:157], v[196:197], v[176:177] op_sel:[0,1,1] op_sel_hi:[1,1,1] neg_lo:[0,0,1] neg_hi:[0,0,1]
    v_pk_fma_f32 v[38:39], v[158:159], v[196:197], v[180:181] op_sel:[0,1,1] op_sel_hi:[1,1,1] neg_lo:[1,0,1] neg_hi:[1,0,1]
    v_pk_fma_f32 v[158:159], v[158:159], v[196:197], v[176:177] op_sel:[0,1,1] op_sel_hi:[1,1,1] neg_lo:[0,0,1] neg_hi:[0,0,1]
    v_pk_fma_f32 v[56:57], v[160:161], v[198:199], v[182:183] op_sel:[0,0,0] op_sel_hi:[1,0,0] neg_lo:[1,0,1] neg_hi:[1,0,1]
    v_pk_fma_f32 v[160:161], v[160:161], v[198:199], v[178:179] op_sel:[0,0,0] op_sel_hi:[1,0,0] neg_lo:[0,0,1] neg_hi:[0,0,1]
    v_pk_fma_f32 v[58:59], v[162:163], v[198:199], v[182:183] op_sel:[0,0,0] op_sel_hi:[1,0,0] neg_lo:[1,0,1] neg_hi:[1,0,1]
    v_pk_fma_f32 v[162:163], v[162:163], v[198:199], v[178:179] op_sel:[0,0,0] op_sel_hi:[1,0,0] neg_lo:[0,0,1] neg_hi:[0,0,1]
    v_pk_fma_f32 v[60:61], v[164:165], v[198:199], v[182:183] op_sel:[0,0,0] op_sel_hi:[1,0,0] neg_lo:[1,0,1] neg_hi:[1,0,1]
    v_pk_fma_f32 v[164:165], v[164:165], v[198:199], v[178:179] op_sel:[0,0,0] op_sel_hi:[1,0,0] neg_lo:[0,0,1] neg_hi:[0,0,1]
    v_pk_fma_f32 v[62:63], v[166:167], v[198:199], v[182:183] op_sel:[0,0,0] op_sel_hi:[1,0,0] neg_lo:[1,0,1] neg_hi:[1,0,1]
    v_pk_fma_f32 v[166:167], v[166:167], v[198:199], v[178:179] op_sel:[0,0,0] op_sel_hi:[1,0,0] neg_lo:[0,0,1] neg_hi:[0,0,1]
    v_pk_fma_f32 v[80:81], v[168:169], v[198:199], v[182:183] op_sel:[0,1,1] op_sel_hi:[1,1,1] neg_lo:[1,0,1] neg_hi:[1,0,1]
    v_pk_fma_f32 v[168:169], v[168:169], v[198:199], v[178:179] op_sel:[0,1,1] op_sel_hi:[1,1,1] neg_lo:[0,0,1] neg_hi:[0,0,1]
    v_pk_fma_f32 v[82:83], v[170:171], v[198:199], v[182:183] op_sel:[0,1,1] op_sel_hi:[1,1,1] neg_lo:[1,0,1] neg_hi:[1,0,1]
    v_pk_fma_f32 v[170:171], v[170:171], v[198:199], v[178:179] op_sel:[0,1,1] op_sel_hi:[1,1,1] neg_lo:[0,0,1] neg_hi:[0,0,1]
    v_pk_fma_f32 v[84:85], v[172:173], v[198:199], v[182:183] op_sel:[0,1,1] op_sel_hi:[1,1,1] neg_lo:[1,0,1] neg_hi:[1,0,1]
    v_pk_fma_f32 v[172:173], v[172:173], v[198:199], v[178:179] op_sel:[0,1,1] op_sel_hi:[1,1,1] neg_lo:[0,0,1] neg_hi:[0,0,1]
    v_pk_fma_f32 v[86:87], v[174:175], v[198:199], v[182:183] op_sel:[0,1,1] op_sel_hi:[1,1,1] neg_lo:[1,0,1] neg_hi:[1,0,1]
    v_pk_fma_f32 v[174:175], v[174:175], v[198:199], v[178:179] op_sel:[0,1,1] op_sel_hi:[1,1,1] neg_lo:[0,0,1] neg_hi:[0,0,1]
    v_exp_f32 v8, v8
    v_exp_f32 v144, v144
    v_exp_f32 v9, v9
    v_exp_f32 v145, v145
    v_exp_f32 v10, v10
    v_exp_f32 v146, v146
    v_exp_f32 v11, v11
    v_exp_f32 v147, v147
    v_exp_f32 v12, v12
    v_exp_f32 v148, v148
    v_exp_f32 v13, v13
    v_exp_f32 v149, v149
    v_exp_f32 v14, v14
    v_exp_f32 v150, v150
    v_exp_f32 v15, v15
    v_exp_f32 v151, v151
    v_exp_f32 v32, v32
    v_exp_f32 v152, v152
    v_exp_f32 v33, v33
    v_exp_f32 v153, v153
    v_exp_f32 v34, v34
    v_exp_f32 v154, v154
    v_exp_f32 v35, v35
    v_exp_f32 v155, v155
    v_exp_f32 v36, v36
    v_exp_f32 v156, v156
    v_exp_f32 v37, v37
    v_exp_f32 v157, v157
    v_exp_f32 v38, v38
    v_exp_f32 v158, v158
    v_exp_f32 v39, v39
    v_exp_f32 v159, v159
    v_exp_f32 v56, v56
    v_exp_f32 v160, v160
    v_exp_f32 v57, v57
    v_exp_f32 v161, v161
    v_exp_f32 v58, v58
    v_exp_f32 v162, v162
    v_exp_f32 v59, v59
    v_exp_f32 v163, v163
    v_exp_f32 v60, v60
    v_exp_f32 v164, v164
    v_exp_f32 v61, v61
    v_exp_f32 v165, v165
    v_exp_f32 v62, v62
    v_exp_f32 v166, v166
    v_exp_f32 v63, v63
    v_exp_f32 v167, v167
    v_exp_f32 v80, v80
    v_exp_f32 v168, v168
    v_exp_f32 v81, v81
    v_exp_f32 v169, v169
    v_exp_f32 v82, v82
    v_exp_f32 v170, v170
    v_exp_f32 v83, v83
    v_exp_f32 v171, v171
    v_exp_f32 v84, v84
    v_exp_f32 v172, v172
    v_exp_f32 v85, v85
    v_exp_f32 v173, v173
    v_exp_f32 v86, v86
    v_exp_f32 v174, v174
    v_exp_f32 v87, v87
    v_exp_f32 v175, v175
    v_pk_add_f32 v[128:129], v[144:145], v[146:147]
    v_pk_add_f32 v[130:131], v[8:9], v[10:11]
    v_pk_add_f32 v[132:133], v[152:153], v[154:155]
    v_pk_add_f32 v[134:135], v[32:33], v[34:35]
    v_pk_add_f32 v[136:137], v[160:161], v[162:163]
    v_pk_add_f32 v[138:139], v[56:57], v[58:59]
    v_pk_add_f32 v[140:141], v[168:169], v[170:171]
    v_pk_add_f32 v[142:143], v[80:81], v[82:83]
    v_pk_add_f32 v[128:129], v[128:129], v[148:149]
    v_pk_add_f32 v[130:131], v[130:131], v[12:13]
    v_pk_add_f32 v[132:133], v[132:133], v[156:157]
    v_pk_add_f32 v[134:135], v[134:135], v[36:37]
    v_pk_add_f32 v[136:137], v[136:137], v[164:165]
    v_pk_add_f32 v[138:139], v[138:139], v[60:61]
    v_pk_add_f32 v[140:141], v[140:141], v[172:173]
    v_pk_add_f32 v[142:143], v[142:143], v[84:85]
    v_pk_add_f32 v[128:129], v[128:129], v[150:151]
    v_pk_add_f32 v[130:131], v[130:131], v[14:15]
    v_pk_add_f32 v[132:133], v[132:133], v[158:159]
    v_pk_add_f32 v[134:135], v[134:135], v[38:39]
    v_pk_add_f32 v[136:137], v[136:137], v[166:167]
    v_pk_add_f32 v[138:139], v[138:139], v[62:63]
    v_pk_add_f32 v[140:141], v[140:141], v[174:175]
    v_pk_add_f32 v[142:143], v[142:143], v[86:87]
    v_add_f32 v176, v128, v129
    v_add_f32 v180, v130, v131
    v_add_f32 v177, v132, v133
    v_add_f32 v181, v134, v135
    v_add_f32 v178, v136, v137
    v_add_f32 v182, v138, v139
    v_add_f32 v179, v140, v141
    v_add_f32 v183, v142, v143
    v_permlane32_swap_b32 v176, v177
    v_permlane32_swap_b32 v178, v179
    v_permlane32_swap_b32 v180, v181
    v_permlane32_swap_b32 v182, v183
    v_add_f32 v176, v176, v177
    v_add_f32 v178, v178, v179
    v_add_f32 v180, v180, v181
    v_add_f32 v182, v182, v183
    v_permlane16_swap_b32 v176, v178
    s_nop 0
    v_permlane16_swap_b32 v180, v182
    v_add_f32 v176, v176, v178
    v_add_f32 v180, v180, v182
    v_rcp_f32 v176, v176
    v_rcp_f32 v180, v180
    v_mov_b32 v178, v176
    v_mov_b32 v182, v180
    s_nop 0
    v_permlane16_swap_b32 v176, v178
    v_permlane16_swap_b32 v180, v182
    v_mov_b32 v177, v176
    v_mov_b32 v179, v178
    v_mov_b32 v181, v180
    v_mov_b32 v183, v182
    v_permlane32_swap_b32 v176, v177
    v_permlane32_swap_b32 v178, v179
    v_permlane32_swap_b32 v180, v181
    v_permlane32_swap_b32 v182, v183
    v_pk_mul_f32 v[144:145], v[144:145], v[176:177] op_sel:[0,0] op_sel_hi:[1,0]
    v_pk_mul_f32 v[146:147], v[146:147], v[176:177] op_sel:[0,0] op_sel_hi:[1,0]
    v_pk_mul_f32 v[148:149], v[148:149], v[176:177] op_sel:[0,0] op_sel_hi:[1,0]
    v_pk_mul_f32 v[150:151], v[150:151], v[176:177] op_sel:[0,0] op_sel_hi:[1,0]
    v_cvt_pk_bf16_f32 v144, v144, v145
    v_cvt_pk_bf16_f32 v145, v146, v147
    v_cvt_pk_bf16_f32 v146, v148, v149
    v_cvt_pk_bf16_f32 v147, v150, v151
    v_pk_mul_f32 v[8:9], v[8:9], v[180:181] op_sel:[0,0] op_sel_hi:[1,0]
    v_pk_mul_f32 v[10:11], v[10:11], v[180:181] op_sel:[0,0] op_sel_hi:[1,0]
    v_pk_mul_f32 v[12:13], v[12:13], v[180:181] op_sel:[0,0] op_sel_hi:[1,0]
    v_pk_mul_f32 v[14:15], v[14:15], v[180:181] op_sel:[0,0] op_sel_hi:[1,0]
    v_cvt_pk_bf16_f32 v8, v8, v9
    v_cvt_pk_bf16_f32 v9, v10, v11
    v_cvt_pk_bf16_f32 v10, v12, v13
    v_cvt_pk_bf16_f32 v11, v14, v15
    v_pk_mul_f32 v[152:153], v[152:153], v[176:177] op_sel:[0,1] op_sel_hi:[1,1]
    v_pk_mul_f32 v[154:155], v[154:155], v[176:177] op_sel:[0,1] op_sel_hi:[1,1]
    v_pk_mul_f32 v[156:157], v[156:157], v[176:177] op_sel:[0,1] op_sel_hi:[1,1]
    v_pk_mul_f32 v[158:159], v[158:159], v[176:177] op_sel:[0,1] op_sel_hi:[1,1]
    v_cvt_pk_bf16_f32 v152, v152, v153
    v_cvt_pk_bf16_f32 v153, v154, v155
    v_cvt_pk_bf16_f32 v154, v156, v157
    v_cvt_pk_bf16_f32 v155, v158, v159
    v_pk_mul_f32 v[32:33], v[32:33], v[180:181] op_sel:[0,1] op_sel_hi:[1,1]
    v_pk_mul_f32 v[34:35], v[34:35], v[180:181] op_sel:[0,1] op_sel_hi:[1,1]
    v_pk_mul_f32 v[36:37], v[36:37], v[180:181] op_sel:[0,1] op_sel_hi:[1,1]
    v_pk_mul_f32 v[38:39], v[38:39], v[180:181] op_sel:[0,1] op_sel_hi:[1,1]
    v_cvt_pk_bf16_f32 v32, v32, v33
    v_cvt_pk_bf16_f32 v33, v34, v35
    v_cvt_pk_bf16_f32 v34, v36, v37
    v_cvt_pk_bf16_f32 v35, v38, v39
    v_pk_mul_f32 v[160:161], v[160:161], v[178:179] op_sel:[0,0] op_sel_hi:[1,0]
    v_pk_mul_f32 v[162:163], v[162:163], v[178:179] op_sel:[0,0] op_sel_hi:[1,0]
    v_pk_mul_f32 v[164:165], v[164:165], v[178:179] op_sel:[0,0] op_sel_hi:[1,0]
    v_pk_mul_f32 v[166:167], v[166:167], v[178:179] op_sel:[0,0] op_sel_hi:[1,0]
    v_cvt_pk_bf16_f32 v160, v160, v161
    v_cvt_pk_bf16_f32 v161, v162, v163
    v_cvt_pk_bf16_f32 v162, v164, v165
    v_cvt_pk_bf16_f32 v163, v166, v167
    v_pk_mul_f32 v[56:57], v[56:57], v[182:183] op_sel:[0,0] op_sel_hi:[1,0]
    v_pk_mul_f32 v[58:59], v[58:59], v[182:183] op_sel:[0,0] op_sel_hi:[1,0]
    v_pk_mul_f32 v[60:61], v[60:61], v[182:183] op_sel:[0,0] op_sel_hi:[1,0]
    v_pk_mul_f32 v[62:63], v[62:63], v[182:183] op_sel:[0,0] op_sel_hi:[1,0]
    v_cvt_pk_bf16_f32 v56, v56, v57
    v_cvt_pk_bf16_f32 v57, v58, v59
    v_cvt_pk_bf16_f32 v58, v60, v61
    v_cvt_pk_bf16_f32 v59, v62, v63
    v_pk_mul_f32 v[168:169], v[168:169], v[178:179] op_sel:[0,1] op_sel_hi:[1,1]
    v_pk_mul_f32 v[170:171], v[170:171], v[178:179] op_sel:[0,1] op_sel_hi:[1,1]
    v_pk_mul_f32 v[172:173], v[172:173], v[178:179] op_sel:[0,1] op_sel_hi:[1,1]
    v_pk_mul_f32 v[174:175], v[174:175], v[178:179] op_sel:[0,1] op_sel_hi:[1,1]
    v_cvt_pk_bf16_f32 v168, v168, v169
    v_cvt_pk_bf16_f32 v169, v170, v171
    v_cvt_pk_bf16_f32 v170, v172, v173
    v_cvt_pk_bf16_f32 v171, v174, v175
    v_pk_mul_f32 v[80:81], v[80:81], v[182:183] op_sel:[0,1] op_sel_hi:[1,1]
    v_pk_mul_f32 v[82:83], v[82:83], v[182:183] op_sel:[0,1] op_sel_hi:[1,1]
    v_pk_mul_f32 v[84:85], v[84:85], v[182:183] op_sel:[0,1] op_sel_hi:[1,1]
    v_pk_mul_f32 v[86:87], v[86:87], v[182:183] op_sel:[0,1] op_sel_hi:[1,1]
    v_cvt_pk_bf16_f32 v80, v80, v81
    v_cvt_pk_bf16_f32 v81, v82, v83
    v_cvt_pk_bf16_f32 v82, v84, v85
    v_cvt_pk_bf16_f32 v83, v86, v87
    s_lshl_b32 s3, s38, 1
    s_lshr_b32 s28, s39, 2
    s_add_u32 s3, s3, s28
    s_lshl_b32 s69, s3, 4
    s_lshl_b32 s3, s34, 7
    s_add_u32 s3, s3, s69
    v_and_b32 v2, 15, v1
    v_add_u32 v4, s3, v2
    v_lshlrev_b32 v4, 11, v4
    v_lshrrev_b32 v2, 4, v1
    v_lshl_add_u32 v4, v2, 3, v4
    s_lshl_b32 s3, s35, 7
    v_add_u32 v4, s3, v4
    buffer_load_dwordx2 v[240:241], v4, s[40:43], 0 offen offset:0
    buffer_load_dwordx2 v[242:243], v4, s[40:43], 0 offen offset:32
    buffer_load_dwordx2 v[244:245], v4, s[40:43], 0 offen offset:64
    buffer_load_dwordx2 v[246:247], v4, s[40:43], 0 offen offset:96
    v_mov_b32 v2, 162048
    ds_read_b32 v248, v2
    v_lshrrev_b32 v5, 3, v1
    v_lshlrev_b32 v6, 11, v5
    v_bfe_u32 v5, v1, 4, 2
    v_lshlrev_b32 v5, 1, v5
    v_and_b32 v7, 7, v1
    v_xor_b32 v5, v5, v7
    v_lshl_add_u32 v6, v5, 4, v6
    s_lshl_b32 s3, s35, 7
    v_add_u32 v6, s3, v6
    v_add_u32 v216, 0, v6
    v_add_u32 v217, 15360, v6
    v_add_u32 v218, 30720, v6
    v_add_u32 v219, 46080, v6
    s_lshl_b32 s72, s38, 12
    s_lshl_b32 s73, s38, 16
    v_and_b32 v2, 15, v1
    v_add_u32 v2, s69, v2
    v_lshlrev_b32 v2, 2, v2
    v_add_u32 v2, 152576, v2
    ds_read_b32 v192, v2
    ds_read_b32 v193, v2 offset:1024
    s_mul_i32 s76, s67, 4224
    s_add_u32 s76, s76, 1245184
    v_lshlrev_b32 v5, 4, v1
    v_and_b32 v6, 48, v1
    v_lshlrev_b32 v6, 1, v6
    v_add_u32 v6, 4096, v6
    s_lshl_b32 s3, s38, 2
    s_add_u32 s3, s3, 162112
    v_mov_b32 v3, s3
L_gw:
    ds_read_b32 v2, v3
    s_waitcnt lgkmcnt(0)
    v_readfirstlane_b32 s3, v2
    s_nop 0
    s_cmp_eq_u32 s3, 3
    s_cbranch_scc1 L_gk
    s_sleep 1
    s_branch L_gw
L_gk:
    buffer_load_dwordx4 v[104:107], v5, s[48:51], s76 offen offset:0 sc1
    buffer_load_dwordx4 v[108:111], v5, s[48:51], s76 offen offset:1024 sc1
    buffer_load_dwordx4 v[112:115], v5, s[48:51], s76 offen offset:2048 sc1
    buffer_load_dwordx4 v[116:119], v5, s[48:51], s76 offen offset:3072 sc1
    buffer_load_dwordx4 v[120:123], v6, s[48:51], s76 offen offset:0 sc1
    buffer_load_dwordx4 v[124:127], v6, s[48:51], s76 offen offset:16 sc1
    s_waitcnt lgkmcnt(0)
    v_readfirstlane_b32 s70, v248
    s_nop 0
    s_and_b32 s68, s70, 0x7ff
    s_sub_u32 s68, 2047, s68
    s_lshl_b32 s3, s36, 3
    s_lshl_b32 s28, s64, 2
    s_add_u32 s3, s3, s28
    s_lshl_b32 s3, s3, 5
    s_add_u32 s3, s3, s67
    s_lshl_b32 s77, s3, 10
    s_add_u32 s77, s77, 4194304
    s_waitcnt vmcnt(0)
    s_mov_b32 s29, 0
L_k7:
    v_max3_u32 v2, v104, v105, v106
    v_max3_u32 v2, v2, v107, v108
    v_max3_u32 v2, v2, v109, v110
    v_max3_u32 v2, v2, v111, v112
    v_max3_u32 v2, v2, v113, v114
    v_max3_u32 v2, v2, v115, v116
    v_max3_u32 v2, v2, v117, v118
    v_max3_u32 v2, v2, v119, v120
    v_max3_u32 v2, v2, v121, v122
    v_max3_u32 v2, v2, v123, v124
    v_max3_u32 v2, v2, v125, v126
    v_max_u32 v2, v2, v127
    v_cmp_eq_u32 vcc, -1, v2
    s_cbranch_vccz L_k7k
    s_add_u32 s29, s29, 1
    s_cmp_ge_u32 s29, 200000
    s_cbranch_scc1 L_k7k
    s_sleep 1
    buffer_load_dwordx4 v[104:107], v5, s[48:51], s76 offen offset:0 sc1
    buffer_load_dwordx4 v[108:111], v5, s[48:51], s76 offen offset:1024 sc1
    buffer_load_dwordx4 v[112:115], v5, s[48:51], s76 offen offset:2048 sc1
    buffer_load_dwordx4 v[116:119], v5, s[48:51], s76 offen offset:3072 sc1
    buffer_load_dwordx4 v[120:123], v6, s[48:51], s76 offen offset:0 sc1
    buffer_load_dwordx4 v[124:127], v6, s[48:51], s76 offen offset:16 sc1
    s_waitcnt vmcnt(0)
    s_branch L_k7
L_k7k:
    s_setprio 2
    s_add_u32 m0, s72, 114688
    s_add_u32 s3, s73, 1835008
    buffer_load_dwordx4 v216, s[88:91], s3 offen offset:0 lds
    buffer_load_dwordx4 v217, s[88:91], s3 offen offset:1024 lds
    buffer_load_dwordx4 v218, s[88:91], s3 offen offset:2048 lds
    buffer_load_dwordx4 v219, s[88:91], s3 offen offset:3072 lds
    s_add_u32 m0, s72, 0
    s_add_u32 s3, s73, 0
    buffer_load_dwordx4 v216, s[88:91], s3 offen offset:0 lds
    buffer_load_dwordx4 v217, s[88:91], s3 offen offset:1024 lds
    buffer_load_dwordx4 v218, s[88:91], s3 offen offset:2048 lds
    buffer_load_dwordx4 v219, s[88:91], s3 offen offset:3072 lds
    v_mfma_f32_16x16x32_bf16 v[24:27], v[120:123], v[144:147], 0
    v_mfma_f32_16x16x32_bf16 v[16:19], v[104:107], v[144:147], 0
    v_mfma_f32_16x16x32_bf16 v[20:23], v[108:111], v[144:147], 0
    v_mfma_f32_16x16x32_bf16 v[24:27], v[124:127], v[8:11], v[24:27]
    v_mfma_f32_16x16x32_bf16 v[16:19], v[112:115], v[8:11], v[16:19]
    v_mfma_f32_16x16x32_bf16 v[20:23], v[116:119], v[8:11], v[20:23]
    v_mfma_f32_16x16x32_bf16 v[48:51], v[120:123], v[152:155], 0
    v_mfma_f32_16x16x32_bf16 v[40:43], v[104:107], v[152:155], 0
    v_mfma_f32_16x16x32_bf16 v[44:47], v[108:111], v[152:155], 0
    v_mfma_f32_16x16x32_bf16 v[48:51], v[124:127], v[32:35], v[48:51]
    v_mfma_f32_16x16x32_bf16 v[40:43], v[112:115], v[32:35], v[40:43]
    v_mfma_f32_16x16x32_bf16 v[44:47], v[116:119], v[32:35], v[44:47]
    v_mfma_f32_16x16x32_bf16 v[72:75], v[120:123], v[160:163], 0
    v_mfma_f32_16x16x32_bf16 v[64:67], v[104:107], v[160:163], 0
    v_mfma_f32_16x16x32_bf16 v[68:71], v[108:111], v[160:163], 0
    v_mfma_f32_16x16x32_bf16 v[72:75], v[124:127], v[56:59], v[72:75]
    v_mfma_f32_16x16x32_bf16 v[64:67], v[112:115], v[56:59], v[64:67]
    v_mfma_f32_16x16x32_bf16 v[68:71], v[116:119], v[56:59], v[68:71]
    v_mfma_f32_16x16x32_bf16 v[96:99], v[120:123], v[168:171], 0
    v_mfma_f32_16x16x32_bf16 v[88:91], v[104:107], v[168:171], 0
    v_mfma_f32_16x16x32_bf16 v[92:95], v[108:111], v[168:171], 0
    v_mfma_f32_16x16x32_bf16 v[96:99], v[124:127], v[80:83], v[96:99]
    v_mfma_f32_16x16x32_bf16 v[88:91], v[112:115], v[80:83], v[88:91]
    v_mfma_f32_16x16x32_bf16 v[92:95], v[116:119], v[80:83], v[92:95]
    v_add_f32 v24, 0x358637bd, v24
    v_add_f32 v48, 0x358637bd, v48
    v_add_f32 v72, 0x358637bd, v72
    s_nop 2
    v_add_f32 v96, 0x358637bd, v96
    v_rcp_f32 v24, v24
    v_rcp_f32 v48, v48
    v_rcp_f32 v72, v72
    v_rcp_f32 v96, v96
    v_pk_mul_f32 v[16:17], v[16:17], v[24:25] op_sel_hi:[1,0]
    v_pk_mul_f32 v[18:19], v[18:19], v[24:25] op_sel_hi:[1,0]
    v_pk_mul_f32 v[20:21], v[20:21], v[24:25] op_sel_hi:[1,0]
    v_pk_mul_f32 v[22:23], v[22:23], v[24:25] op_sel_hi:[1,0]
    v_cvt_pk_bf16_f32 v16, v16, v17
    v_cvt_pk_bf16_f32 v17, v18, v19
    v_cvt_pk_bf16_f32 v18, v20, v21
    v_cvt_pk_bf16_f32 v19, v22, v23
    buffer_store_dwordx4 v[16:19], v5, s[48:51], s77 offen sc1
    s_add_u32 s77, s77, 32768
    v_pk_mul_f32 v[40:41], v[40:41], v[48:49] op_sel_hi:[1,0]
    v_pk_mul_f32 v[42:43], v[42:43], v[48:49] op_sel_hi:[1,0]
    v_pk_mul_f32 v[44:45], v[44:45], v[48:49] op_sel_hi:[1,0]
    v_pk_mul_f32 v[46:47], v[46:47], v[48:49] op_sel_hi:[1,0]
    v_cvt_pk_bf16_f32 v40, v40, v41
    v_cvt_pk_bf16_f32 v41, v42, v43
    v_cvt_pk_bf16_f32 v42, v44, v45
    v_cvt_pk_bf16_f32 v43, v46, v47
    buffer_store_dwordx4 v[40:43], v5, s[48:51], s77 offen sc1
    s_add_u32 s77, s77, 32768
    v_pk_mul_f32 v[64:65], v[64:65], v[72:73] op_sel_hi:[1,0]
    v_pk_mul_f32 v[66:67], v[66:67], v[72:73] op_sel_hi:[1,0]
    v_pk_mul_f32 v[68:69], v[68:69], v[72:73] op_sel_hi:[1,0]
    v_pk_mul_f32 v[70:71], v[70:71], v[72:73] op_sel_hi:[1,0]
    v_cvt_pk_bf16_f32 v64, v64, v65
    v_cvt_pk_bf16_f32 v65, v66, v67
    v_cvt_pk_bf16_f32 v66, v68, v69
    v_cvt_pk_bf16_f32 v67, v70, v71
    buffer_store_dwordx4 v[64:67], v5, s[48:51], s77 offen sc1
    s_add_u32 s77, s77, 32768
    v_pk_mul_f32 v[88:89], v[88:89], v[96:97] op_sel_hi:[1,0]
    v_pk_mul_f32 v[90:91], v[90:91], v[96:97] op_sel_hi:[1,0]
    v_pk_mul_f32 v[92:93], v[92:93], v[96:97] op_sel_hi:[1,0]
    v_pk_mul_f32 v[94:95], v[94:95], v[96:97] op_sel_hi:[1,0]
    v_cvt_pk_bf16_f32 v88, v88, v89
    v_cvt_pk_bf16_f32 v89, v90, v91
    v_cvt_pk_bf16_f32 v90, v92, v93
    v_cvt_pk_bf16_f32 v91, v94, v95
    buffer_store_dwordx4 v[88:91], v5, s[48:51], s77 offen sc1
    s_add_u32 m0, s72, 16384
    s_add_u32 s3, s73, 262144
    buffer_load_dwordx4 v216, s[88:91], s3 offen offset:0 lds
    buffer_load_dwordx4 v217, s[88:91], s3 offen offset:1024 lds
    buffer_load_dwordx4 v218, s[88:91], s3 offen offset:2048 lds
    buffer_load_dwordx4 v219, s[88:91], s3 offen offset:3072 lds
    s_add_u32 m0, s72, 32768
    s_add_u32 s3, s73, 524288
    buffer_load_dwordx4 v216, s[88:91], s3 offen offset:0 lds
    buffer_load_dwordx4 v217, s[88:91], s3 offen offset:1024 lds
    buffer_load_dwordx4 v218, s[88:91], s3 offen offset:2048 lds
    buffer_load_dwordx4 v219, s[88:91], s3 offen offset:3072 lds
    s_setprio 0
    v_mul_f32 v196, v192, v193
    v_mul_f32 v198, 0xbfb8aa3b, v193
    v_mul_f32 v199, 1069066811, v196
    v_mov_b32 v197, v193
    v_lshlrev_b32 v224, 16, v240
    v_and_b32 v225, 0xffff0000, v240
    v_lshlrev_b32 v226, 16, v241
    v_and_b32 v227, 0xffff0000, v241
    v_lshlrev_b32 v228, 16, v242
    v_and_b32 v229, 0xffff0000, v242
    v_lshlrev_b32 v230, 16, v243
    v_and_b32 v231, 0xffff0000, v243
    v_lshlrev_b32 v232, 16, v244
    v_and_b32 v233, 0xffff0000, v244
    v_lshlrev_b32 v234, 16, v245
    v_and_b32 v235, 0xffff0000, v245
    v_lshlrev_b32 v236, 16, v246
    v_and_b32 v237, 0xffff0000, v246
    v_lshlrev_b32 v238, 16, v247
    v_and_b32 v239, 0xffff0000, v247
    v_pk_fma_f32 v[200:201], v[224:225], v[198:199], v[198:199] op_sel:[0,0,1] op_sel_hi:[1,0,1]
    v_pk_fma_f32 v[202:203], v[226:227], v[198:199], v[198:199] op_sel:[0,0,1] op_sel_hi:[1,0,1]
    v_pk_fma_f32 v[204:205], v[228:229], v[198:199], v[198:199] op_sel:[0,0,1] op_sel_hi:[1,0,1]
    v_pk_fma_f32 v[206:207], v[230:231], v[198:199], v[198:199] op_sel:[0,0,1] op_sel_hi:[1,0,1]
    v_pk_fma_f32 v[208:209], v[232:233], v[198:199], v[198:199] op_sel:[0,0,1] op_sel_hi:[1,0,1]
    v_pk_fma_f32 v[210:211], v[234:235], v[198:199], v[198:199] op_sel:[0,0,1] op_sel_hi:[1,0,1]
    v_pk_fma_f32 v[212:213], v[236:237], v[198:199], v[198:199] op_sel:[0,0,1] op_sel_hi:[1,0,1]
    v_pk_fma_f32 v[214:215], v[238:239], v[198:199], v[198:199] op_sel:[0,0,1] op_sel_hi:[1,0,1]
    v_pk_fma_f32 v[224:225], v[224:225], v[196:197], v[196:197] op_sel:[0,1,0] op_sel_hi:[1,1,0] neg_lo:[0,0,1] neg_hi:[0,0,1]
    v_pk_fma_f32 v[226:227], v[226:227], v[196:197], v[196:197] op_sel:[0,1,0] op_sel_hi:[1,1,0] neg_lo:[0,0,1] neg_hi:[0,0,1]
    v_pk_fma_f32 v[228:229], v[228:229], v[196:197], v[196:197] op_sel:[0,1,0] op_sel_hi:[1,1,0] neg_lo:[0,0,1] neg_hi:[0,0,1]
    v_pk_fma_f32 v[230:231], v[230:231], v[196:197], v[196:197] op_sel:[0,1,0] op_sel_hi:[1,1,0] neg_lo:[0,0,1] neg_hi:[0,0,1]
    v_pk_fma_f32 v[232:233], v[232:233], v[196:197], v[196:197] op_sel:[0,1,0] op_sel_hi:[1,1,0] neg_lo:[0,0,1] neg_hi:[0,0,1]
    v_pk_fma_f32 v[234:235], v[234:235], v[196:197], v[196:197] op_sel:[0,1,0] op_sel_hi:[1,1,0] neg_lo:[0,0,1] neg_hi:[0,0,1]
    v_pk_fma_f32 v[236:237], v[236:237], v[196:197], v[196:197] op_sel:[0,1,0] op_sel_hi:[1,1,0] neg_lo:[0,0,1] neg_hi:[0,0,1]
    v_pk_fma_f32 v[238:239], v[238:239], v[196:197], v[196:197] op_sel:[0,1,0] op_sel_hi:[1,1,0] neg_lo:[0,0,1] neg_hi:[0,0,1]
    v_exp_f32 v200, v200
    v_exp_f32 v201, v201
    v_exp_f32 v202, v202
    v_exp_f32 v203, v203
    v_exp_f32 v204, v204
    v_exp_f32 v205, v205
    v_exp_f32 v206, v206
    v_exp_f32 v207, v207
    v_exp_f32 v208, v208
    v_exp_f32 v209, v209
    v_exp_f32 v210, v210
    v_exp_f32 v211, v211
    v_exp_f32 v212, v212
    v_exp_f32 v213, v213
    v_exp_f32 v214, v214
    v_exp_f32 v215, v215
    v_pk_add_f32 v[200:201], v[200:201], 1.0 op_sel_hi:[1,0]
    v_pk_add_f32 v[202:203], v[202:203], 1.0 op_sel_hi:[1,0]
    v_pk_add_f32 v[204:205], v[204:205], 1.0 op_sel_hi:[1,0]
    v_pk_add_f32 v[206:207], v[206:207], 1.0 op_sel_hi:[1,0]
    v_pk_add_f32 v[208:209], v[208:209], 1.0 op_sel_hi:[1,0]
    v_pk_add_f32 v[210:211], v[210:211], 1.0 op_sel_hi:[1,0]
    v_pk_add_f32 v[212:213], v[212:213], 1.0 op_sel_hi:[1,0]
    v_pk_add_f32 v[214:215], v[214:215], 1.0 op_sel_hi:[1,0]
    v_rcp_f32 v200, v200
    v_rcp_f32 v201, v201
    v_rcp_f32 v202, v202
    v_rcp_f32 v203, v203
    v_rcp_f32 v204, v204
    v_rcp_f32 v205, v205
    v_rcp_f32 v206, v206
    v_rcp_f32 v207, v207
    v_rcp_f32 v208, v208
    v_rcp_f32 v209, v209
    v_rcp_f32 v210, v210
    v_rcp_f32 v211, v211
    v_rcp_f32 v212, v212
    v_rcp_f32 v213, v213
    v_rcp_f32 v214, v214
    v_rcp_f32 v215, v215
    v_pk_mul_f32 v[224:225], v[224:225], v[200:201]
    v_pk_mul_f32 v[226:227], v[226:227], v[202:203]
    v_pk_mul_f32 v[228:229], v[228:229], v[204:205]
    v_pk_mul_f32 v[230:231], v[230:231], v[206:207]
    v_pk_mul_f32 v[232:233], v[232:233], v[208:209]
    v_pk_mul_f32 v[234:235], v[234:235], v[210:211]
    v_pk_mul_f32 v[236:237], v[236:237], v[212:213]
    v_pk_mul_f32 v[238:239], v[238:239], v[214:215]
    s_waitcnt vmcnt(0)
L_p3:
    s_nop 3
    s_mov_b32 s56, s22
    s_mov_b32 s57, s23
    s_mov_b32 s58, 4194304
    s_mov_b32 s59, 0x00020000
    s_lshr_b32 s64, s39, 2
    s_lshl_b32 s3, s34, 2
    s_add_u32 s3, s3, s38
    s_lshl_b32 s3, s3, 16
    s_lshl_b32 s28, s64, 14
    s_add_u32 s3, s3, s28
    s_add_u32 s76, s3, 4194304
    s_lshl_b32 s3, s64, 15
    v_lshlrev_b32 v2, 4, v1
    v_add_u32 v108, s3, v2
    v_xor_b32 v109, 0x8000, v108
    v_lshrrev_b32 v2, 2, v1
    v_lshlrev_b32 v2, 7, v2
    v_bfe_u32 v3, v1, 3, 2
    v_lshl_add_u32 v2, v3, 5, v2
    v_and_b32 v3, 3, v1
    v_lshl_add_u32 v2, v3, 3, v2
    s_lshl_b32 s3, s64, 16
    v_add_u32 v104, s3, v2
    v_xor_b32 v105, 32, v104
    v_xor_b32 v106, 64, v104
    v_xor_b32 v107, 96, v104
    s_waitcnt lgkmcnt(0)
    s_barrier
    s_add_u32 s77, s76, 0
    buffer_load_dwordx4 v[40:43], v108, s[48:51], s77 offen offset:0 sc1
    buffer_load_dwordx4 v[44:47], v109, s[48:51], s77 offen offset:0 sc1
    buffer_load_dwordx4 v[48:51], v108, s[48:51], s77 offen offset:1024 sc1
    buffer_load_dwordx4 v[52:55], v109, s[48:51], s77 offen offset:1024 sc1
    buffer_load_dwordx4 v[56:59], v108, s[48:51], s77 offen offset:2048 sc1
    buffer_load_dwordx4 v[60:63], v109, s[48:51], s77 offen offset:2048 sc1
    s_lshl_b32 s3, s34, 7
    s_add_u32 s3, s3, s69
    s_andn2_b32 s28, s68, 15
    s_cmp_lg_u32 s3, s28
    s_cbranch_scc1 L_nov
    s_lshl_b32 s3, s39, 12
    s_add_u32 s3, s3, 131072
    v_and_b32 v2, 48, v1
    v_add_u32 v2, s3, v2
    s_and_b32 s3, s68, 15
    s_lshl_b32 exec_lo, 0x00010001, s3
    s_mov_b32 exec_hi, exec_lo
    ds_read_b128 v[224:227], v2 offset:0
    ds_read_b128 v[228:231], v2 offset:64
    ds_read_b128 v[232:235], v2 offset:128
    ds_read_b128 v[236:239], v2 offset:192
    s_mov_b64 exec, -1
L_nov:
    ds_read_b64_tr_b16 v[72:73], v104 offset:0
    ds_read_b64_tr_b16 v[74:75], v104 offset:2048
    ds_read_b64_tr_b16 v[76:77], v105 offset:0
    ds_read_b64_tr_b16 v[78:79], v105 offset:2048
    ds_read_b64_tr_b16 v[80:81], v106 offset:0
    ds_read_b64_tr_b16 v[82:83], v106 offset:2048
    ds_read_b64_tr_b16 v[84:85], v107 offset:0
    ds_read_b64_tr_b16 v[86:87], v107 offset:2048
    s_mov_b32 s29, 0
    buffer_load_dwordx4 v[64:67], v108, s[48:51], s77 offen offset:3072 sc1
    buffer_load_dwordx4 v[68:71], v109, s[48:51], s77 offen offset:3072 sc1
    s_waitcnt vmcnt(6)
L_c0:
    v_max3_u32 v2, v40, v41, v42
    v_max3_u32 v2, v2, v43, v44
    v_max3_u32 v2, v2, v45, v46
    v_max_u32 v2, v2, v47
    v_cmp_eq_u32 vcc, -1, v2
    s_cbranch_vccnz L_r0
L_g0:
    s_waitcnt lgkmcnt(0)
    v_mfma_f32_16x16x32_bf16 v[8:11], v[72:75], v[40:43], 0
    ds_read_b64_tr_b16 v[88:89], v104 offset:4096
    v_mfma_f32_16x16x32_bf16 v[24:27], v[72:75], v[44:47], 0
    ds_read_b64_tr_b16 v[90:91], v104 offset:6144
    v_mfma_f32_16x16x32_bf16 v[12:15], v[76:79], v[40:43], 0
    ds_read_b64_tr_b16 v[92:93], v105 offset:4096
    v_mfma_f32_16x16x32_bf16 v[28:31], v[76:79], v[44:47], 0
    ds_read_b64_tr_b16 v[94:95], v105 offset:6144
    v_mfma_f32_16x16x32_bf16 v[16:19], v[80:83], v[40:43], 0
    ds_read_b64_tr_b16 v[96:97], v106 offset:4096
    v_mfma_f32_16x16x32_bf16 v[32:35], v[80:83], v[44:47], 0
    ds_read_b64_tr_b16 v[98:99], v106 offset:6144
    v_mfma_f32_16x16x32_bf16 v[20:23], v[84:87], v[40:43], 0
    ds_read_b64_tr_b16 v[100:101], v107 offset:4096
    v_mfma_f32_16x16x32_bf16 v[36:39], v[84:87], v[44:47], 0
    ds_read_b64_tr_b16 v[102:103], v107 offset:6144
    s_add_u32 s77, s76, 4096
    buffer_load_dwordx4 v[40:43], v108, s[48:51], s77 offen offset:0 sc1
    buffer_load_dwordx4 v[44:47], v109, s[48:51], s77 offen offset:0 sc1
    s_waitcnt vmcnt(6)
L_c1:
    v_max3_u32 v2, v48, v49, v50
    v_max3_u32 v2, v2, v51, v52
    v_max3_u32 v2, v2, v53, v54
    v_max_u32 v2, v2, v55
    v_cmp_eq_u32 vcc, -1, v2
    s_cbranch_vccnz L_r1
L_g1:
    s_waitcnt lgkmcnt(0)
    v_mfma_f32_16x16x32_bf16 v[8:11], v[88:91], v[48:51], v[8:11]
    ds_read_b64_tr_b16 v[72:73], v104 offset:8192
    v_mfma_f32_16x16x32_bf16 v[24:27], v[88:91], v[52:55], v[24:27]
    ds_read_b64_tr_b16 v[74:75], v104 offset:10240
    v_mfma_f32_16x16x32_bf16 v[12:15], v[92:95], v[48:51], v[12:15]
    ds_read_b64_tr_b16 v[76:77], v105 offset:8192
    v_mfma_f32_16x16x32_bf16 v[28:31], v[92:95], v[52:55], v[28:31]
    ds_read_b64_tr_b16 v[78:79], v105 offset:10240
    v_mfma_f32_16x16x32_bf16 v[16:19], v[96:99], v[48:51], v[16:19]
    ds_read_b64_tr_b16 v[80:81], v106 offset:8192
    v_mfma_f32_16x16x32_bf16 v[32:35], v[96:99], v[52:55], v[32:35]
    ds_read_b64_tr_b16 v[82:83], v106 offset:10240
    v_mfma_f32_16x16x32_bf16 v[20:23], v[100:103], v[48:51], v[20:23]
    ds_read_b64_tr_b16 v[84:85], v107 offset:8192
    v_mfma_f32_16x16x32_bf16 v[36:39], v[100:103], v[52:55], v[36:39]
    ds_read_b64_tr_b16 v[86:87], v107 offset:10240
    buffer_load_dwordx4 v[48:51], v108, s[48:51], s77 offen offset:1024 sc1
    buffer_load_dwordx4 v[52:55], v109, s[48:51], s77 offen offset:1024 sc1
    s_waitcnt vmcnt(6)
L_c2:
    v_max3_u32 v2, v56, v57, v58
    v_max3_u32 v2, v2, v59, v60
    v_max3_u32 v2, v2, v61, v62
    v_max_u32 v2, v2, v63
    v_cmp_eq_u32 vcc, -1, v2
    s_cbranch_vccnz L_r2
L_g2:
    s_waitcnt lgkmcnt(0)
    v_mfma_f32_16x16x32_bf16 v[8:11], v[72:75], v[56:59], v[8:11]
    ds_read_b64_tr_b16 v[88:89], v104 offset:12288
    v_mfma_f32_16x16x32_bf16 v[24:27], v[72:75], v[60:63], v[24:27]
    ds_read_b64_tr_b16 v[90:91], v104 offset:14336
    v_mfma_f32_16x16x32_bf16 v[12:15], v[76:79], v[56:59], v[12:15]
    ds_read_b64_tr_b16 v[92:93], v105 offset:12288
    v_mfma_f32_16x16x32_bf16 v[28:31], v[76:79], v[60:63], v[28:31]
    ds_read_b64_tr_b16 v[94:95], v105 offset:14336
    v_mfma_f32_16x16x32_bf16 v[16:19], v[80:83], v[56:59], v[16:19]
    ds_read_b64_tr_b16 v[96:97], v106 offset:12288
    v_mfma_f32_16x16x32_bf16 v[32:35], v[80:83], v[60:63], v[32:35]
    ds_read_b64_tr_b16 v[98:99], v106 offset:14336
    v_mfma_f32_16x16x32_bf16 v[20:23], v[84:87], v[56:59], v[20:23]
    ds_read_b64_tr_b16 v[100:101], v107 offset:12288
    v_mfma_f32_16x16x32_bf16 v[36:39], v[84:87], v[60:63], v[36:39]
    ds_read_b64_tr_b16 v[102:103], v107 offset:14336
    buffer_load_dwordx4 v[56:59], v108, s[48:51], s77 offen offset:2048 sc1
    buffer_load_dwordx4 v[60:63], v109, s[48:51], s77 offen offset:2048 sc1
    s_waitcnt vmcnt(6)
L_c3:
    v_max3_u32 v2, v64, v65, v66
    v_max3_u32 v2, v2, v67, v68
    v_max3_u32 v2, v2, v69, v70
    v_max_u32 v2, v2, v71
    v_cmp_eq_u32 vcc, -1, v2
    s_cbranch_vccnz L_r3
L_g3:
    s_waitcnt lgkmcnt(0)
    v_mfma_f32_16x16x32_bf16 v[8:11], v[88:91], v[64:67], v[8:11]
    ds_read_b64_tr_b16 v[72:73], v104 offset:16384
    v_mfma_f32_16x16x32_bf16 v[24:27], v[88:91], v[68:71], v[24:27]
    ds_read_b64_tr_b16 v[74:75], v104 offset:18432
    v_mfma_f32_16x16x32_bf16 v[12:15], v[92:95], v[64:67], v[12:15]
    ds_read_b64_tr_b16 v[76:77], v105 offset:16384
    v_mfma_f32_16x16x32_bf16 v[28:31], v[92:95], v[68:71], v[28:31]
    ds_read_b64_tr_b16 v[78:79], v105 offset:18432
    v_mfma_f32_16x16x32_bf16 v[16:19], v[96:99], v[64:67], v[16:19]
    ds_read_b64_tr_b16 v[80:81], v106 offset:16384
    v_mfma_f32_16x16x32_bf16 v[32:35], v[96:99], v[68:71], v[32:35]
    ds_read_b64_tr_b16 v[82:83], v106 offset:18432
    v_mfma_f32_16x16x32_bf16 v[20:23], v[100:103], v[64:67], v[20:23]
    ds_read_b64_tr_b16 v[84:85], v107 offset:16384
    v_mfma_f32_16x16x32_bf16 v[36:39], v[100:103], v[68:71], v[36:39]
    ds_read_b64_tr_b16 v[86:87], v107 offset:18432
    buffer_load_dwordx4 v[64:67], v108, s[48:51], s77 offen offset:3072 sc1
    buffer_load_dwordx4 v[68:71], v109, s[48:51], s77 offen offset:3072 sc1
    s_waitcnt vmcnt(6)
L_c4:
    v_max3_u32 v2, v40, v41, v42
    v_max3_u32 v2, v2, v43, v44
    v_max3_u32 v2, v2, v45, v46
    v_max_u32 v2, v2, v47
    v_cmp_eq_u32 vcc, -1, v2
    s_cbranch_vccnz L_r4
L_g4:
    s_waitcnt lgkmcnt(0)
    v_mfma_f32_16x16x32_bf16 v[8:11], v[72:75], v[40:43], v[8:11]
    ds_read_b64_tr_b16 v[88:89], v104 offset:20480
    v_mfma_f32_16x16x32_bf16 v[24:27], v[72:75], v[44:47], v[24:27]
    ds_read_b64_tr_b16 v[90:91], v104 offset:22528
    v_mfma_f32_16x16x32_bf16 v[12:15], v[76:79], v[40:43], v[12:15]
    ds_read_b64_tr_b16 v[92:93], v105 offset:20480
    v_mfma_f32_16x16x32_bf16 v[28:31], v[76:79], v[44:47], v[28:31]
    ds_read_b64_tr_b16 v[94:95], v105 offset:22528
    v_mfma_f32_16x16x32_bf16 v[16:19], v[80:83], v[40:43], v[16:19]
    ds_read_b64_tr_b16 v[96:97], v106 offset:20480
    v_mfma_f32_16x16x32_bf16 v[32:35], v[80:83], v[44:47], v[32:35]
    ds_read_b64_tr_b16 v[98:99], v106 offset:22528
    v_mfma_f32_16x16x32_bf16 v[20:23], v[84:87], v[40:43], v[20:23]
    ds_read_b64_tr_b16 v[100:101], v107 offset:20480
    v_mfma_f32_16x16x32_bf16 v[36:39], v[84:87], v[44:47], v[36:39]
    ds_read_b64_tr_b16 v[102:103], v107 offset:22528
    s_add_u32 s77, s76, 8192
    buffer_load_dwordx4 v[40:43], v108, s[48:51], s77 offen offset:0 sc1
    buffer_load_dwordx4 v[44:47], v109, s[48:51], s77 offen offset:0 sc1
    s_waitcnt vmcnt(6)
L_c5:
    v_max3_u32 v2, v48, v49, v50
    v_max3_u32 v2, v2, v51, v52
    v_max3_u32 v2, v2, v53, v54
    v_max_u32 v2, v2, v55
    v_cmp_eq_u32 vcc, -1, v2
    s_cbranch_vccnz L_r5
L_g5:
    s_waitcnt lgkmcnt(0)
    v_mfma_f32_16x16x32_bf16 v[8:11], v[88:91], v[48:51], v[8:11]
    ds_read_b64_tr_b16 v[72:73], v104 offset:24576
    v_mfma_f32_16x16x32_bf16 v[24:27], v[88:91], v[52:55], v[24:27]
    ds_read_b64_tr_b16 v[74:75], v104 offset:26624
    v_mfma_f32_16x16x32_bf16 v[12:15], v[92:95], v[48:51], v[12:15]
    ds_read_b64_tr_b16 v[76:77], v105 offset:24576
    v_mfma_f32_16x16x32_bf16 v[28:31], v[92:95], v[52:55], v[28:31]
    ds_read_b64_tr_b16 v[78:79], v105 offset:26624
    v_mfma_f32_16x16x32_bf16 v[16:19], v[96:99], v[48:51], v[16:19]
    ds_read_b64_tr_b16 v[80:81], v106 offset:24576
    v_mfma_f32_16x16x32_bf16 v[32:35], v[96:99], v[52:55], v[32:35]
    ds_read_b64_tr_b16 v[82:83], v106 offset:26624
    v_mfma_f32_16x16x32_bf16 v[20:23], v[100:103], v[48:51], v[20:23]
    ds_read_b64_tr_b16 v[84:85], v107 offset:24576
    v_mfma_f32_16x16x32_bf16 v[36:39], v[100:103], v[52:55], v[36:39]
    ds_read_b64_tr_b16 v[86:87], v107 offset:26624
    buffer_load_dwordx4 v[48:51], v108, s[48:51], s77 offen offset:1024 sc1
    buffer_load_dwordx4 v[52:55], v109, s[48:51], s77 offen offset:1024 sc1
    s_waitcnt vmcnt(6)
L_c6:
    v_max3_u32 v2, v56, v57, v58
    v_max3_u32 v2, v2, v59, v60
    v_max3_u32 v2, v2, v61, v62
    v_max_u32 v2, v2, v63
    v_cmp_eq_u32 vcc, -1, v2
    s_cbranch_vccnz L_r6
L_g6:
    s_waitcnt lgkmcnt(0)
    v_mfma_f32_16x16x32_bf16 v[8:11], v[72:75], v[56:59], v[8:11]
    ds_read_b64_tr_b16 v[88:89], v104 offset:28672
    v_mfma_f32_16x16x32_bf16 v[24:27], v[72:75], v[60:63], v[24:27]
    ds_read_b64_tr_b16 v[90:91], v104 offset:30720
    v_mfma_f32_16x16x32_bf16 v[12:15], v[76:79], v[56:59], v[12:15]
    ds_read_b64_tr_b16 v[92:93], v105 offset:28672
    v_mfma_f32_16x16x32_bf16 v[28:31], v[76:79], v[60:63], v[28:31]
    ds_read_b64_tr_b16 v[94:95], v105 offset:30720
    v_mfma_f32_16x16x32_bf16 v[16:19], v[80:83], v[56:59], v[16:19]
    ds_read_b64_tr_b16 v[96:97], v106 offset:28672
    v_mfma_f32_16x16x32_bf16 v[32:35], v[80:83], v[60:63], v[32:35]
    ds_read_b64_tr_b16 v[98:99], v106 offset:30720
    v_mfma_f32_16x16x32_bf16 v[20:23], v[84:87], v[56:59], v[20:23]
    ds_read_b64_tr_b16 v[100:101], v107 offset:28672
    v_mfma_f32_16x16x32_bf16 v[36:39], v[84:87], v[60:63], v[36:39]
    ds_read_b64_tr_b16 v[102:103], v107 offset:30720
    buffer_load_dwordx4 v[56:59], v108, s[48:51], s77 offen offset:2048 sc1
    buffer_load_dwordx4 v[60:63], v109, s[48:51], s77 offen offset:2048 sc1
    s_waitcnt vmcnt(6)
L_c7:
    v_max3_u32 v2, v64, v65, v66
    v_max3_u32 v2, v2, v67, v68
    v_max3_u32 v2, v2, v69, v70
    v_max_u32 v2, v2, v71
    v_cmp_eq_u32 vcc, -1, v2
    s_cbranch_vccnz L_r7
L_g7:
    s_waitcnt lgkmcnt(0)
    v_mfma_f32_16x16x32_bf16 v[8:11], v[88:91], v[64:67], v[8:11]
    ds_read_b64_tr_b16 v[72:73], v104 offset:32768
    v_mfma_f32_16x16x32_bf16 v[24:27], v[88:91], v[68:71], v[24:27]
    ds_read_b64_tr_b16 v[74:75], v104 offset:34816
    v_mfma_f32_16x16x32_bf16 v[12:15], v[92:95], v[64:67], v[12:15]
    ds_read_b64_tr_b16 v[76:77], v105 offset:32768
    v_mfma_f32_16x16x32_bf16 v[28:31], v[92:95], v[68:71], v[28:31]
    ds_read_b64_tr_b16 v[78:79], v105 offset:34816
    v_mfma_f32_16x16x32_bf16 v[16:19], v[96:99], v[64:67], v[16:19]
    ds_read_b64_tr_b16 v[80:81], v106 offset:32768
    v_mfma_f32_16x16x32_bf16 v[32:35], v[96:99], v[68:71], v[32:35]
    ds_read_b64_tr_b16 v[82:83], v106 offset:34816
    v_mfma_f32_16x16x32_bf16 v[20:23], v[100:103], v[64:67], v[20:23]
    ds_read_b64_tr_b16 v[84:85], v107 offset:32768
    v_mfma_f32_16x16x32_bf16 v[36:39], v[100:103], v[68:71], v[36:39]
    ds_read_b64_tr_b16 v[86:87], v107 offset:34816
    buffer_load_dwordx4 v[64:67], v108, s[48:51], s77 offen offset:3072 sc1
    buffer_load_dwordx4 v[68:71], v109, s[48:51], s77 offen offset:3072 sc1
    s_waitcnt vmcnt(6)
L_c8:
    v_max3_u32 v2, v40, v41, v42
    v_max3_u32 v2, v2, v43, v44
    v_max3_u32 v2, v2, v45, v46
    v_max_u32 v2, v2, v47
    v_cmp_eq_u32 vcc, -1, v2
    s_cbranch_vccnz L_r8
L_g8:
    s_waitcnt lgkmcnt(0)
    v_mfma_f32_16x16x32_bf16 v[8:11], v[72:75], v[40:43], v[8:11]
    ds_read_b64_tr_b16 v[88:89], v104 offset:36864
    v_mfma_f32_16x16x32_bf16 v[24:27], v[72:75], v[44:47], v[24:27]
    ds_read_b64_tr_b16 v[90:91], v104 offset:38912
    v_mfma_f32_16x16x32_bf16 v[12:15], v[76:79], v[40:43], v[12:15]
    ds_read_b64_tr_b16 v[92:93], v105 offset:36864
    v_mfma_f32_16x16x32_bf16 v[28:31], v[76:79], v[44:47], v[28:31]
    ds_read_b64_tr_b16 v[94:95], v105 offset:38912
    v_mfma_f32_16x16x32_bf16 v[16:19], v[80:83], v[40:43], v[16:19]
    ds_read_b64_tr_b16 v[96:97], v106 offset:36864
    v_mfma_f32_16x16x32_bf16 v[32:35], v[80:83], v[44:47], v[32:35]
    ds_read_b64_tr_b16 v[98:99], v106 offset:38912
    v_mfma_f32_16x16x32_bf16 v[20:23], v[84:87], v[40:43], v[20:23]
    ds_read_b64_tr_b16 v[100:101], v107 offset:36864
    v_mfma_f32_16x16x32_bf16 v[36:39], v[84:87], v[44:47], v[36:39]
    ds_read_b64_tr_b16 v[102:103], v107 offset:38912
    s_add_u32 s77, s76, 12288
    buffer_load_dwordx4 v[40:43], v108, s[48:51], s77 offen offset:0 sc1
    buffer_load_dwordx4 v[44:47], v109, s[48:51], s77 offen offset:0 sc1
    s_waitcnt vmcnt(6)
L_c9:
    v_max3_u32 v2, v48, v49, v50
    v_max3_u32 v2, v2, v51, v52
    v_max3_u32 v2, v2, v53, v54
    v_max_u32 v2, v2, v55
    v_cmp_eq_u32 vcc, -1, v2
    s_cbranch_vccnz L_r9
L_g9:
    s_waitcnt lgkmcnt(0)
    v_mfma_f32_16x16x32_bf16 v[8:11], v[88:91], v[48:51], v[8:11]
    ds_read_b64_tr_b16 v[72:73], v104 offset:40960
    v_mfma_f32_16x16x32_bf16 v[24:27], v[88:91], v[52:55], v[24:27]
    ds_read_b64_tr_b16 v[74:75], v104 offset:43008
    v_mfma_f32_16x16x32_bf16 v[12:15], v[92:95], v[48:51], v[12:15]
    ds_read_b64_tr_b16 v[76:77], v105 offset:40960
    v_mfma_f32_16x16x32_bf16 v[28:31], v[92:95], v[52:55], v[28:31]
    ds_read_b64_tr_b16 v[78:79], v105 offset:43008
    v_mfma_f32_16x16x32_bf16 v[16:19], v[96:99], v[48:51], v[16:19]
    ds_read_b64_tr_b16 v[80:81], v106 offset:40960
    v_mfma_f32_16x16x32_bf16 v[32:35], v[96:99], v[52:55], v[32:35]
    ds_read_b64_tr_b16 v[82:83], v106 offset:43008
    v_mfma_f32_16x16x32_bf16 v[20:23], v[100:103], v[48:51], v[20:23]
    ds_read_b64_tr_b16 v[84:85], v107 offset:40960
    v_mfma_f32_16x16x32_bf16 v[36:39], v[100:103], v[52:55], v[36:39]
    ds_read_b64_tr_b16 v[86:87], v107 offset:43008
    buffer_load_dwordx4 v[48:51], v108, s[48:51], s77 offen offset:1024 sc1
    buffer_load_dwordx4 v[52:55], v109, s[48:51], s77 offen offset:1024 sc1
    s_waitcnt vmcnt(6)
L_c10:
    v_max3_u32 v2, v56, v57, v58
    v_max3_u32 v2, v2, v59, v60
    v_max3_u32 v2, v2, v61, v62
    v_max_u32 v2, v2, v63
    v_cmp_eq_u32 vcc, -1, v2
    s_cbranch_vccnz L_r10
L_g10:
    s_waitcnt lgkmcnt(0)
    v_mfma_f32_16x16x32_bf16 v[8:11], v[72:75], v[56:59], v[8:11]
    ds_read_b64_tr_b16 v[88:89], v104 offset:45056
    v_mfma_f32_16x16x32_bf16 v[24:27], v[72:75], v[60:63], v[24:27]
    ds_read_b64_tr_b16 v[90:91], v104 offset:47104
    v_mfma_f32_16x16x32_bf16 v[12:15], v[76:79], v[56:59], v[12:15]
    ds_read_b64_tr_b16 v[92:93], v105 offset:45056
    v_mfma_f32_16x16x32_bf16 v[28:31], v[76:79], v[60:63], v[28:31]
    ds_read_b64_tr_b16 v[94:95], v105 offset:47104
    v_mfma_f32_16x16x32_bf16 v[16:19], v[80:83], v[56:59], v[16:19]
    ds_read_b64_tr_b16 v[96:97], v106 offset:45056
    v_mfma_f32_16x16x32_bf16 v[32:35], v[80:83], v[60:63], v[32:35]
    ds_read_b64_tr_b16 v[98:99], v106 offset:47104
    v_mfma_f32_16x16x32_bf16 v[20:23], v[84:87], v[56:59], v[20:23]
    ds_read_b64_tr_b16 v[100:101], v107 offset:45056
    v_mfma_f32_16x16x32_bf16 v[36:39], v[84:87], v[60:63], v[36:39]
    ds_read_b64_tr_b16 v[102:103], v107 offset:47104
    buffer_load_dwordx4 v[56:59], v108, s[48:51], s77 offen offset:2048 sc1
    buffer_load_dwordx4 v[60:63], v109, s[48:51], s77 offen offset:2048 sc1
    s_waitcnt vmcnt(6)
L_c11:
    v_max3_u32 v2, v64, v65, v66
    v_max3_u32 v2, v2, v67, v68
    v_max3_u32 v2, v2, v69, v70
    v_max_u32 v2, v2, v71
    v_cmp_eq_u32 vcc, -1, v2
    s_cbranch_vccnz L_r11
L_g11:
    s_waitcnt lgkmcnt(0)
    v_mfma_f32_16x16x32_bf16 v[8:11], v[88:91], v[64:67], v[8:11]
    ds_read_b64_tr_b16 v[72:73], v104 offset:49152
    v_mfma_f32_16x16x32_bf16 v[24:27], v[88:91], v[68:71], v[24:27]
    ds_read_b64_tr_b16 v[74:75], v104 offset:51200
    v_mfma_f32_16x16x32_bf16 v[12:15], v[92:95], v[64:67], v[12:15]
    ds_read_b64_tr_b16 v[76:77], v105 offset:49152
    v_mfma_f32_16x16x32_bf16 v[28:31], v[92:95], v[68:71], v[28:31]
    ds_read_b64_tr_b16 v[78:79], v105 offset:51200
    v_mfma_f32_16x16x32_bf16 v[16:19], v[96:99], v[64:67], v[16:19]
    ds_read_b64_tr_b16 v[80:81], v106 offset:49152
    v_mfma_f32_16x16x32_bf16 v[32:35], v[96:99], v[68:71], v[32:35]
    ds_read_b64_tr_b16 v[82:83], v106 offset:51200
    v_mfma_f32_16x16x32_bf16 v[20:23], v[100:103], v[64:67], v[20:23]
    ds_read_b64_tr_b16 v[84:85], v107 offset:49152
    v_mfma_f32_16x16x32_bf16 v[36:39], v[100:103], v[68:71], v[36:39]
    ds_read_b64_tr_b16 v[86:87], v107 offset:51200
    buffer_load_dwordx4 v[64:67], v108, s[48:51], s77 offen offset:3072 sc1
    buffer_load_dwordx4 v[68:71], v109, s[48:51], s77 offen offset:3072 sc1
    s_waitcnt vmcnt(6)
L_c12:
    v_max3_u32 v2, v40, v41, v42
    v_max3_u32 v2, v2, v43, v44
    v_max3_u32 v2, v2, v45, v46
    v_max_u32 v2, v2, v47
    v_cmp_eq_u32 vcc, -1, v2
    s_cbranch_vccnz L_r12
L_g12:
    s_waitcnt lgkmcnt(0)
    v_mfma_f32_16x16x32_bf16 v[8:11], v[72:75], v[40:43], v[8:11]
    ds_read_b64_tr_b16 v[88:89], v104 offset:53248
    v_mfma_f32_16x16x32_bf16 v[24:27], v[72:75], v[44:47], v[24:27]
    ds_read_b64_tr_b16 v[90:91], v104 offset:55296
    v_mfma_f32_16x16x32_bf16 v[12:15], v[76:79], v[40:43], v[12:15]
    ds_read_b64_tr_b16 v[92:93], v105 offset:53248
    v_mfma_f32_16x16x32_bf16 v[28:31], v[76:79], v[44:47], v[28:31]
    ds_read_b64_tr_b16 v[94:95], v105 offset:55296
    v_mfma_f32_16x16x32_bf16 v[16:19], v[80:83], v[40:43], v[16:19]
    ds_read_b64_tr_b16 v[96:97], v106 offset:53248
    v_mfma_f32_16x16x32_bf16 v[32:35], v[80:83], v[44:47], v[32:35]
    ds_read_b64_tr_b16 v[98:99], v106 offset:55296
    v_mfma_f32_16x16x32_bf16 v[20:23], v[84:87], v[40:43], v[20:23]
    ds_read_b64_tr_b16 v[100:101], v107 offset:53248
    v_mfma_f32_16x16x32_bf16 v[36:39], v[84:87], v[44:47], v[36:39]
    ds_read_b64_tr_b16 v[102:103], v107 offset:55296
    s_waitcnt vmcnt(4)
L_c13:
    v_max3_u32 v2, v48, v49, v50
    v_max3_u32 v2, v2, v51, v52
    v_max3_u32 v2, v2, v53, v54
    v_max_u32 v2, v2, v55
    v_cmp_eq_u32 vcc, -1, v2
    s_cbranch_vccnz L_r13
L_g13:
    s_waitcnt lgkmcnt(0)
    v_mfma_f32_16x16x32_bf16 v[8:11], v[88:91], v[48:51], v[8:11]
    ds_read_b64_tr_b16 v[72:73], v104 offset:57344
    v_mfma_f32_16x16x32_bf16 v[24:27], v[88:91], v[52:55], v[24:27]
    ds_read_b64_tr_b16 v[74:75], v104 offset:59392
    v_mfma_f32_16x16x32_bf16 v[12:15], v[92:95], v[48:51], v[12:15]
    ds_read_b64_tr_b16 v[76:77], v105 offset:57344
    v_mfma_f32_16x16x32_bf16 v[28:31], v[92:95], v[52:55], v[28:31]
    ds_read_b64_tr_b16 v[78:79], v105 offset:59392
    v_mfma_f32_16x16x32_bf16 v[16:19], v[96:99], v[48:51], v[16:19]
    ds_read_b64_tr_b16 v[80:81], v106 offset:57344
    v_mfma_f32_16x16x32_bf16 v[32:35], v[96:99], v[52:55], v[32:35]
    ds_read_b64_tr_b16 v[82:83], v106 offset:59392
    v_mfma_f32_16x16x32_bf16 v[20:23], v[100:103], v[48:51], v[20:23]
    ds_read_b64_tr_b16 v[84:85], v107 offset:57344
    v_mfma_f32_16x16x32_bf16 v[36:39], v[100:103], v[52:55], v[36:39]
    ds_read_b64_tr_b16 v[86:87], v107 offset:59392
    s_waitcnt vmcnt(2)
L_c14:
    v_max3_u32 v2, v56, v57, v58
    v_max3_u32 v2, v2, v59, v60
    v_max3_u32 v2, v2, v61, v62
    v_max_u32 v2, v2, v63
    v_cmp_eq_u32 vcc, -1, v2
    s_cbranch_vccnz L_r14
L_g14:
    s_waitcnt lgkmcnt(0)
    v_mfma_f32_16x16x32_bf16 v[8:11], v[72:75], v[56:59], v[8:11]
    ds_read_b64_tr_b16 v[88:89], v104 offset:61440
    v_mfma_f32_16x16x32_bf16 v[24:27], v[72:75], v[60:63], v[24:27]
    ds_read_b64_tr_b16 v[90:91], v104 offset:63488
    v_mfma_f32_16x16x32_bf16 v[12:15], v[76:79], v[56:59], v[12:15]
    ds_read_b64_tr_b16 v[92:93], v105 offset:61440
    v_mfma_f32_16x16x32_bf16 v[28:31], v[76:79], v[60:63], v[28:31]
    ds_read_b64_tr_b16 v[94:95], v105 offset:63488
    v_mfma_f32_16x16x32_bf16 v[16:19], v[80:83], v[56:59], v[16:19]
    ds_read_b64_tr_b16 v[96:97], v106 offset:61440
    v_mfma_f32_16x16x32_bf16 v[32:35], v[80:83], v[60:63], v[32:35]
    ds_read_b64_tr_b16 v[98:99], v106 offset:63488
    v_mfma_f32_16x16x32_bf16 v[20:23], v[84:87], v[56:59], v[20:23]
    ds_read_b64_tr_b16 v[100:101], v107 offset:61440
    v_mfma_f32_16x16x32_bf16 v[36:39], v[84:87], v[60:63], v[36:39]
    ds_read_b64_tr_b16 v[102:103], v107 offset:63488
    s_waitcnt vmcnt(0)
L_c15:
    v_max3_u32 v2, v64, v65, v66
    v_max3_u32 v2, v2, v67, v68
    v_max3_u32 v2, v2, v69, v70
    v_max_u32 v2, v2, v71
    v_cmp_eq_u32 vcc, -1, v2
    s_cbranch_vccnz L_r15
L_g15:
    s_waitcnt lgkmcnt(0)
    v_mfma_f32_16x16x32_bf16 v[8:11], v[88:91], v[64:67], v[8:11]
    v_mfma_f32_16x16x32_bf16 v[24:27], v[88:91], v[68:71], v[24:27]
    v_mfma_f32_16x16x32_bf16 v[12:15], v[92:95], v[64:67], v[12:15]
    v_mfma_f32_16x16x32_bf16 v[28:31], v[92:95], v[68:71], v[28:31]
    v_mfma_f32_16x16x32_bf16 v[16:19], v[96:99], v[64:67], v[16:19]
    v_mfma_f32_16x16x32_bf16 v[32:35], v[96:99], v[68:71], v[32:35]
    v_mfma_f32_16x16x32_bf16 v[20:23], v[100:103], v[64:67], v[20:23]
    v_mfma_f32_16x16x32_bf16 v[36:39], v[100:103], v[68:71], v[36:39]
    s_lshl_b32 s3, s39, 12
    s_add_u32 s3, s3, 131072
    v_lshlrev_b32 v2, 4, v1
    v_add_u32 v2, s3, v2
    v_xor_b32 v3, 0x4000, v2
    s_xor_b32 s28, s3, 0x4000
    ds_write_b128 v2, v[24:27] offset:0
    ds_write_b128 v2, v[28:31] offset:1024
    ds_write_b128 v2, v[32:35] offset:2048
    ds_write_b128 v2, v[36:39] offset:3072
    v_lshlrev_b32 v40, 16, v240
    v_and_b32 v41, 0xffff0000, v240
    v_lshlrev_b32 v42, 16, v241
    v_and_b32 v43, 0xffff0000, v241
    v_lshlrev_b32 v44, 16, v242
    v_and_b32 v45, 0xffff0000, v242
    v_lshlrev_b32 v46, 16, v243
    v_and_b32 v47, 0xffff0000, v243
    v_lshlrev_b32 v48, 16, v244
    v_and_b32 v49, 0xffff0000, v244
    v_lshlrev_b32 v50, 16, v245
    v_and_b32 v51, 0xffff0000, v245
    v_lshlrev_b32 v52, 16, v246
    v_and_b32 v53, 0xffff0000, v246
    v_lshlrev_b32 v54, 16, v247
    v_and_b32 v55, 0xffff0000, v247
    v_and_b32 v4, 15, v1
    v_lshrrev_b32 v5, 4, v1
    v_lshlrev_b32 v6, 1, v4
    v_and_b32 v6, 14, v6
    v_xor_b32 v5, v5, v6
    v_lshl_add_u32 v4, v4, 7, s28
    v_lshl_add_u32 v4, v5, 3, v4
    v_lshrrev_b32 v5, 3, v1
    v_and_b32 v6, 7, v1
    v_xor_b32 v7, v6, v5
    v_lshl_add_u32 v7, v7, 4, s28
    v_lshl_add_u32 v7, v5, 7, v7
    s_lshl_b32 s3, s34, 7
    s_add_u32 s3, s3, s69
    v_add_u32 v5, s3, v5
    v_lshlrev_b32 v5, 11, v5
    v_lshl_add_u32 v5, v6, 4, v5
    s_lshl_b32 s3, s35, 7
    s_add_u32 s28, s3, 16384
    s_waitcnt lgkmcnt(0)
    s_barrier
    ds_read_b128 v[24:27], v3 offset:0
    ds_read_b128 v[28:31], v3 offset:1024
    ds_read_b128 v[32:35], v3 offset:2048
    ds_read_b128 v[36:39], v3 offset:3072
    s_waitcnt lgkmcnt(3)
    v_pk_add_f32 v[8:9], v[8:9], v[24:25]
    v_pk_add_f32 v[10:11], v[10:11], v[26:27]
    v_pk_fma_f32 v[40:41], v[8:9], v[224:225], v[40:41]
    v_pk_fma_f32 v[42:43], v[10:11], v[226:227], v[42:43]
    v_cvt_pk_bf16_f32 v8, v40, v41
    v_cvt_pk_bf16_f32 v9, v42, v43
    s_waitcnt lgkmcnt(2)
    v_pk_add_f32 v[12:13], v[12:13], v[28:29]
    v_pk_add_f32 v[14:15], v[14:15], v[30:31]
    v_pk_fma_f32 v[44:45], v[12:13], v[228:229], v[44:45]
    v_pk_fma_f32 v[46:47], v[14:15], v[230:231], v[46:47]
    v_cvt_pk_bf16_f32 v10, v44, v45
    v_cvt_pk_bf16_f32 v11, v46, v47
    s_waitcnt lgkmcnt(1)
    v_pk_add_f32 v[16:17], v[16:17], v[32:33]
    v_pk_add_f32 v[18:19], v[18:19], v[34:35]
    v_pk_fma_f32 v[48:49], v[16:17], v[232:233], v[48:49]
    v_pk_fma_f32 v[50:51], v[18:19], v[234:235], v[50:51]
    v_cvt_pk_bf16_f32 v12, v48, v49
    v_cvt_pk_bf16_f32 v13, v50, v51
    s_waitcnt lgkmcnt(0)
    v_pk_add_f32 v[20:21], v[20:21], v[36:37]
    v_pk_add_f32 v[22:23], v[22:23], v[38:39]
    v_pk_fma_f32 v[52:53], v[20:21], v[236:237], v[52:53]
    v_pk_fma_f32 v[54:55], v[22:23], v[238:239], v[54:55]
    v_cvt_pk_bf16_f32 v14, v52, v53
    v_cvt_pk_bf16_f32 v15, v54, v55
    ds_write_b64 v4, v[8:9]
    v_xor_b32 v6, 32, v4
    ds_write_b64 v6, v[10:11]
    v_xor_b32 v6, 64, v4
    ds_write_b64 v6, v[12:13]
    v_xor_b32 v6, 96, v4
    ds_write_b64 v6, v[14:15]
    ds_read_b128 v[24:27], v7 offset:0
    ds_read_b128 v[28:31], v7 offset:1024
    s_waitcnt lgkmcnt(1)
    buffer_store_dwordx4 v[24:27], v5, s[56:59], s3 offen nt
    s_waitcnt lgkmcnt(0)
    buffer_store_dwordx4 v[28:31], v5, s[56:59], s28 offen nt
L_done:
    s_endpgm
L_ln:
    s_lshl_b32 s3, s38, 12
    s_add_u32 s3, s3, 131072
    v_lshlrev_b32 v2, 4, v1
    v_add_u32 v3, s3, v2
    v_add_u32 v2, 122880, v2
    s_barrier
    ds_read_b128 v[192:195], v3 offset:0
    ds_read_b128 v[196:199], v3 offset:1024
    ds_read_b128 v[200:203], v3 offset:2048
    ds_read_b128 v[204:207], v3 offset:3072
    ds_read_b128 v[208:211], v2 offset:0
    ds_read_b128 v[212:215], v2 offset:1024
    s_waitcnt lgkmcnt(0)
    v_lshlrev_b32 v104, 16, v192
    v_and_b32 v105, 0xffff0000, v192
    v_lshlrev_b32 v106, 16, v193
    v_and_b32 v107, 0xffff0000, v193
    v_lshlrev_b32 v108, 16, v194
    v_and_b32 v109, 0xffff0000, v194
    v_lshlrev_b32 v110, 16, v195
    v_and_b32 v111, 0xffff0000, v195
    v_lshlrev_b32 v112, 16, v196
    v_and_b32 v113, 0xffff0000, v196
    v_lshlrev_b32 v114, 16, v197
    v_and_b32 v115, 0xffff0000, v197
    v_lshlrev_b32 v116, 16, v198
    v_and_b32 v117, 0xffff0000, v198
    v_lshlrev_b32 v118, 16, v199
    v_and_b32 v119, 0xffff0000, v199
    v_lshlrev_b32 v120, 16, v200
    v_and_b32 v121, 0xffff0000, v200
    v_lshlrev_b32 v122, 16, v201
    v_and_b32 v123, 0xffff0000, v201
    v_lshlrev_b32 v124, 16, v202
    v_and_b32 v125, 0xffff0000, v202
    v_lshlrev_b32 v126, 16, v203
    v_and_b32 v127, 0xffff0000, v203
    v_lshlrev_b32 v128, 16, v204
    v_and_b32 v129, 0xffff0000, v204
    v_lshlrev_b32 v130, 16, v205
    v_and_b32 v131, 0xffff0000, v205
    v_lshlrev_b32 v132, 16, v206
    v_and_b32 v133, 0xffff0000, v206
    v_lshlrev_b32 v134, 16, v207
    v_and_b32 v135, 0xffff0000, v207
    v_pk_add_f32 v[232:233], v[104:105], v[106:107]
    v_pk_add_f32 v[232:233], v[232:233], v[108:109]
    v_pk_add_f32 v[232:233], v[232:233], v[110:111]
    v_pk_add_f32 v[232:233], v[232:233], v[112:113]
    v_pk_add_f32 v[232:233], v[232:233], v[114:115]
    v_pk_add_f32 v[232:233], v[232:233], v[116:117]
    v_pk_add_f32 v[232:233], v[232:233], v[118:119]
    v_pk_add_f32 v[234:235], v[120:121], v[122:123]
    v_pk_add_f32 v[234:235], v[234:235], v[124:125]
    v_pk_add_f32 v[234:235], v[234:235], v[126:127]
    v_pk_add_f32 v[234:235], v[234:235], v[128:129]
    v_pk_add_f32 v[234:235], v[234:235], v[130:131]
    v_pk_add_f32 v[234:235], v[234:235], v[132:133]
    v_pk_add_f32 v[234:235], v[234:235], v[134:135]
    v_add_f32 v232, v232, v233
    v_add_f32 v234, v234, v235
    s_nop 1
    v_permlane32_swap_b32 v232, v234
    v_add_f32 v232, v232, v234
    s_nop 1
    v_add_f32 v232, v232, v232 quad_perm:[1,0,3,2] row_mask:0xf bank_mask:0xf
    s_nop 1
    v_add_f32 v232, v232, v232 quad_perm:[2,3,0,1] row_mask:0xf bank_mask:0xf
    s_nop 1
    v_add_f32 v232, v232, v232 row_half_mirror row_mask:0xf bank_mask:0xf
    s_nop 1
    v_add_f32 v232, v232, v232 row_mirror row_mask:0xf bank_mask:0xf
    v_mov_b32 v233, v232
    s_nop 1
    v_permlane16_swap_b32 v232, v233
    v_add_f32 v232, v232, v233
    v_mul_f32 v232, 0x3a800000, v232
    v_cvt_pk_bf16_f32 v233, v232, v232
    v_lshlrev_b32 v233, 16, v233
    v_mov_b32 v234, v233
    v_mov_b32 v235, v233
    v_sub_f32 v232, v232, v233
    s_waitcnt vmcnt(0)
    v_permlane32_swap_b32 v234, v235
    v_lshlrev_b32 v216, 16, v208
    v_and_b32 v217, 0xffff0000, v208
    v_lshlrev_b32 v218, 16, v209
    v_and_b32 v219, 0xffff0000, v209
    v_lshlrev_b32 v220, 16, v210
    v_and_b32 v221, 0xffff0000, v210
    v_lshlrev_b32 v222, 16, v211
    v_and_b32 v223, 0xffff0000, v211
    v_lshlrev_b32 v224, 16, v212
    v_and_b32 v225, 0xffff0000, v212
    v_lshlrev_b32 v226, 16, v213
    v_and_b32 v227, 0xffff0000, v213
    v_lshlrev_b32 v228, 16, v214
    v_and_b32 v229, 0xffff0000, v214
    v_lshlrev_b32 v230, 16, v215
    v_and_b32 v231, 0xffff0000, v215
    v_pk_add_f32 v[104:105], v[104:105], v[234:235] op_sel:[0,0] op_sel_hi:[1,0] neg_lo:[0,1] neg_hi:[0,1]
    v_pk_add_f32 v[106:107], v[106:107], v[234:235] op_sel:[0,0] op_sel_hi:[1,0] neg_lo:[0,1] neg_hi:[0,1]
    v_pk_add_f32 v[108:109], v[108:109], v[234:235] op_sel:[0,0] op_sel_hi:[1,0] neg_lo:[0,1] neg_hi:[0,1]
    v_pk_add_f32 v[110:111], v[110:111], v[234:235] op_sel:[0,0] op_sel_hi:[1,0] neg_lo:[0,1] neg_hi:[0,1]
    v_pk_add_f32 v[112:113], v[112:113], v[234:235] op_sel:[0,0] op_sel_hi:[1,0] neg_lo:[0,1] neg_hi:[0,1]
    v_pk_add_f32 v[114:115], v[114:115], v[234:235] op_sel:[0,0] op_sel_hi:[1,0] neg_lo:[0,1] neg_hi:[0,1]
    v_pk_add_f32 v[116:117], v[116:117], v[234:235] op_sel:[0,0] op_sel_hi:[1,0] neg_lo:[0,1] neg_hi:[0,1]
    v_pk_add_f32 v[118:119], v[118:119], v[234:235] op_sel:[0,0] op_sel_hi:[1,0] neg_lo:[0,1] neg_hi:[0,1]
    v_pk_mul_f32 v[236:237], v[104:105], v[104:105]
    v_pk_mul_f32 v[244:245], v[104:105], v[216:217]
    v_pk_fma_f32 v[236:237], v[106:107], v[106:107], v[236:237]
    v_pk_fma_f32 v[244:245], v[106:107], v[218:219], v[244:245]
    v_pk_fma_f32 v[236:237], v[108:109], v[108:109], v[236:237]
    v_pk_fma_f32 v[244:245], v[108:109], v[220:221], v[244:245]
    v_pk_fma_f32 v[236:237], v[110:111], v[110:111], v[236:237]
    v_pk_fma_f32 v[244:245], v[110:111], v[222:223], v[244:245]
    v_pk_fma_f32 v[236:237], v[112:113], v[112:113], v[236:237]
    v_pk_fma_f32 v[244:245], v[112:113], v[224:225], v[244:245]
    v_pk_fma_f32 v[236:237], v[114:115], v[114:115], v[236:237]
    v_pk_fma_f32 v[244:245], v[114:115], v[226:227], v[244:245]
    v_pk_fma_f32 v[236:237], v[116:117], v[116:117], v[236:237]
    v_pk_fma_f32 v[244:245], v[116:117], v[228:229], v[244:245]
    v_pk_fma_f32 v[236:237], v[118:119], v[118:119], v[236:237]
    v_pk_fma_f32 v[244:245], v[118:119], v[230:231], v[244:245]
    v_pk_add_f32 v[120:121], v[120:121], v[234:235] op_sel:[0,1] op_sel_hi:[1,1] neg_lo:[0,1] neg_hi:[0,1]
    v_pk_add_f32 v[122:123], v[122:123], v[234:235] op_sel:[0,1] op_sel_hi:[1,1] neg_lo:[0,1] neg_hi:[0,1]
    v_pk_add_f32 v[124:125], v[124:125], v[234:235] op_sel:[0,1] op_sel_hi:[1,1] neg_lo:[0,1] neg_hi:[0,1]
    v_pk_add_f32 v[126:127], v[126:127], v[234:235] op_sel:[0,1] op_sel_hi:[1,1] neg_lo:[0,1] neg_hi:[0,1]
    v_pk_add_f32 v[128:129], v[128:129], v[234:235] op_sel:[0,1] op_sel_hi:[1,1] neg_lo:[0,1] neg_hi:[0,1]
    v_pk_add_f32 v[130:131], v[130:131], v[234:235] op_sel:[0,1] op_sel_hi:[1,1] neg_lo:[0,1] neg_hi:[0,1]
    v_pk_add_f32 v[132:133], v[132:133], v[234:235] op_sel:[0,1] op_sel_hi:[1,1] neg_lo:[0,1] neg_hi:[0,1]
    v_pk_add_f32 v[134:135], v[134:135], v[234:235] op_sel:[0,1] op_sel_hi:[1,1] neg_lo:[0,1] neg_hi:[0,1]
    v_pk_mul_f32 v[238:239], v[120:121], v[120:121]
    v_pk_mul_f32 v[246:247], v[120:121], v[216:217]
    v_pk_fma_f32 v[238:239], v[122:123], v[122:123], v[238:239]
    v_pk_fma_f32 v[246:247], v[122:123], v[218:219], v[246:247]
    v_pk_fma_f32 v[238:239], v[124:125], v[124:125], v[238:239]
    v_pk_fma_f32 v[246:247], v[124:125], v[220:221], v[246:247]
    v_pk_fma_f32 v[238:239], v[126:127], v[126:127], v[238:239]
    v_pk_fma_f32 v[246:247], v[126:127], v[222:223], v[246:247]
    v_pk_fma_f32 v[238:239], v[128:129], v[128:129], v[238:239]
    v_pk_fma_f32 v[246:247], v[128:129], v[224:225], v[246:247]
    v_pk_fma_f32 v[238:239], v[130:131], v[130:131], v[238:239]
    v_pk_fma_f32 v[246:247], v[130:131], v[226:227], v[246:247]
    v_pk_fma_f32 v[238:239], v[132:133], v[132:133], v[238:239]
    v_pk_fma_f32 v[246:247], v[132:133], v[228:229], v[246:247]
    v_pk_fma_f32 v[238:239], v[134:135], v[134:135], v[238:239]
    v_pk_fma_f32 v[246:247], v[134:135], v[230:231], v[246:247]
    v_add_f32 v236, v236, v237
    v_add_f32 v238, v238, v239
    v_add_f32 v244, v244, v245
    v_add_f32 v246, v246, v247
    v_permlane32_swap_b32 v236, v238
    s_nop 0
    v_permlane32_swap_b32 v244, v246
    v_add_f32 v236, v236, v238
    v_add_f32 v244, v244, v246
    s_nop 0
    v_add_f32 v236, v236, v236 quad_perm:[1,0,3,2] row_mask:0xf bank_mask:0xf
    v_add_f32 v244, v244, v244 quad_perm:[1,0,3,2] row_mask:0xf bank_mask:0xf
    s_nop 0
    v_add_f32 v236, v236, v236 quad_perm:[2,3,0,1] row_mask:0xf bank_mask:0xf
    v_add_f32 v244, v244, v244 quad_perm:[2,3,0,1] row_mask:0xf bank_mask:0xf
    s_nop 0
    v_add_f32 v236, v236, v236 row_half_mirror row_mask:0xf bank_mask:0xf
    v_add_f32 v244, v244, v244 row_half_mirror row_mask:0xf bank_mask:0xf
    s_nop 0
    v_add_f32 v236, v236, v236 row_mirror row_mask:0xf bank_mask:0xf
    v_add_f32 v244, v244, v244 row_mirror row_mask:0xf bank_mask:0xf
    v_mov_b32 v237, v236
    v_mov_b32 v245, v244
    s_nop 0
    v_permlane16_swap_b32 v236, v237
    v_permlane16_swap_b32 v244, v245
    v_add_f32 v236, v236, v237
    v_add_f32 v244, v244, v245
    v_mul_f32 v236, 0x3a800000, v236
    v_fma_f32 v236, -v232, v232, v236
    v_max_f32 v236, 0, v236
    v_cvt_pk_bf16_f32 v236, v236, v236
    v_lshlrev_b32 v236, 16, v236
    v_add_f32 v236, 0x3727c5ac, v236
    v_cvt_pk_bf16_f32 v236, v236, v236
    v_lshlrev_b32 v236, 16, v236
    v_sqrt_f32 v236, v236
    s_nop 0
    v_cvt_pk_bf16_f32 v236, v236, v236
    v_lshlrev_b32 v236, 16, v236
    v_rcp_f32 v2, v236
    v_lshrrev_b32 v3, 16, v233
    v_or_b32 v4, v3, v236
    v_mul_f32 v244, v244, v2
    v_cvt_pk_bf16_f32 v244, v244, v244
    v_lshlrev_b32 v244, 16, v244
    v_ashrrev_i32 v2, 31, v244
    v_or_b32 v2, 0x80000000, v2
    v_xor_b32 v2, v244, v2
    v_and_b32 v2, 0xffff0000, v2
    v_lshrrev_b32 v3, 5, v1
    v_add_u32 v5, s69, v3
    v_sub_u32 v5, 2047, v5
    v_or_b32 v6, v2, v5
    v_mov_b32 v2, v6
    v_mov_b32 v5, v4
    v_add_u32 v7, 1, v248
    v_mov_b32 v3, 0
    v_permlane32_swap_b32 v6, v2
    v_permlane32_swap_b32 v4, v5
    v_max_u32 v6, v6, v2
    s_lshl_b32 s3, s69, 3
    s_mov_b64 exec, 1
    buffer_store_dwordx4 v[4:7], v3, s[48:51], s3 offen sc1
    s_mov_b64 exec, -1
    s_branch L_lnr
L_r0:
    s_add_u32 s29, s29, 1
    s_cmp_ge_u32 s29, 200000
    s_cbranch_scc1 L_g0
    s_add_u32 s3, s76, 0
    buffer_load_dwordx4 v[40:43], v108, s[48:51], s3 offen sc1
    buffer_load_dwordx4 v[44:47], v109, s[48:51], s3 offen sc1
    s_waitcnt vmcnt(0)
    s_branch L_c0
L_r1:
    s_add_u32 s29, s29, 1
    s_cmp_ge_u32 s29, 200000
    s_cbranch_scc1 L_g1
    s_add_u32 s3, s76, 1024
    buffer_load_dwordx4 v[48:51], v108, s[48:51], s3 offen sc1
    buffer_load_dwordx4 v[52:55], v109, s[48:51], s3 offen sc1
    s_waitcnt vmcnt(0)
    s_branch L_c1
L_r2:
    s_add_u32 s29, s29, 1
    s_cmp_ge_u32 s29, 200000
    s_cbranch_scc1 L_g2
    s_add_u32 s3, s76, 2048
    buffer_load_dwordx4 v[56:59], v108, s[48:51], s3 offen sc1
    buffer_load_dwordx4 v[60:63], v109, s[48:51], s3 offen sc1
    s_waitcnt vmcnt(0)
    s_branch L_c2
L_r3:
    s_add_u32 s29, s29, 1
    s_cmp_ge_u32 s29, 200000
    s_cbranch_scc1 L_g3
    s_add_u32 s3, s76, 3072
    buffer_load_dwordx4 v[64:67], v108, s[48:51], s3 offen sc1
    buffer_load_dwordx4 v[68:71], v109, s[48:51], s3 offen sc1
    s_waitcnt vmcnt(0)
    s_branch L_c3
L_r4:
    s_add_u32 s29, s29, 1
    s_cmp_ge_u32 s29, 200000
    s_cbranch_scc1 L_g4
    s_add_u32 s3, s76, 4096
    buffer_load_dwordx4 v[40:43], v108, s[48:51], s3 offen sc1
    buffer_load_dwordx4 v[44:47], v109, s[48:51], s3 offen sc1
    s_waitcnt vmcnt(0)
    s_branch L_c4
L_r5:
    s_add_u32 s29, s29, 1
    s_cmp_ge_u32 s29, 200000
    s_cbranch_scc1 L_g5
    s_add_u32 s3, s76, 5120
    buffer_load_dwordx4 v[48:51], v108, s[48:51], s3 offen sc1
    buffer_load_dwordx4 v[52:55], v109, s[48:51], s3 offen sc1
    s_waitcnt vmcnt(0)
    s_branch L_c5
L_r6:
    s_add_u32 s29, s29, 1
    s_cmp_ge_u32 s29, 200000
    s_cbranch_scc1 L_g6
    s_add_u32 s3, s76, 6144
    buffer_load_dwordx4 v[56:59], v108, s[48:51], s3 offen sc1
    buffer_load_dwordx4 v[60:63], v109, s[48:51], s3 offen sc1
    s_waitcnt vmcnt(0)
    s_branch L_c6
L_r7:
    s_add_u32 s29, s29, 1
    s_cmp_ge_u32 s29, 200000
    s_cbranch_scc1 L_g7
    s_add_u32 s3, s76, 7168
    buffer_load_dwordx4 v[64:67], v108, s[48:51], s3 offen sc1
    buffer_load_dwordx4 v[68:71], v109, s[48:51], s3 offen sc1
    s_waitcnt vmcnt(0)
    s_branch L_c7
L_r8:
    s_add_u32 s29, s29, 1
    s_cmp_ge_u32 s29, 200000
    s_cbranch_scc1 L_g8
    s_add_u32 s3, s76, 8192
    buffer_load_dwordx4 v[40:43], v108, s[48:51], s3 offen sc1
    buffer_load_dwordx4 v[44:47], v109, s[48:51], s3 offen sc1
    s_waitcnt vmcnt(0)
    s_branch L_c8
L_r9:
    s_add_u32 s29, s29, 1
    s_cmp_ge_u32 s29, 200000
    s_cbranch_scc1 L_g9
    s_add_u32 s3, s76, 9216
    buffer_load_dwordx4 v[48:51], v108, s[48:51], s3 offen sc1
    buffer_load_dwordx4 v[52:55], v109, s[48:51], s3 offen sc1
    s_waitcnt vmcnt(0)
    s_branch L_c9
L_r10:
    s_add_u32 s29, s29, 1
    s_cmp_ge_u32 s29, 200000
    s_cbranch_scc1 L_g10
    s_add_u32 s3, s76, 10240
    buffer_load_dwordx4 v[56:59], v108, s[48:51], s3 offen sc1
    buffer_load_dwordx4 v[60:63], v109, s[48:51], s3 offen sc1
    s_waitcnt vmcnt(0)
    s_branch L_c10
L_r11:
    s_add_u32 s29, s29, 1
    s_cmp_ge_u32 s29, 200000
    s_cbranch_scc1 L_g11
    s_add_u32 s3, s76, 11264
    buffer_load_dwordx4 v[64:67], v108, s[48:51], s3 offen sc1
    buffer_load_dwordx4 v[68:71], v109, s[48:51], s3 offen sc1
    s_waitcnt vmcnt(0)
    s_branch L_c11
L_r12:
    s_add_u32 s29, s29, 1
    s_cmp_ge_u32 s29, 200000
    s_cbranch_scc1 L_g12
    s_add_u32 s3, s76, 12288
    buffer_load_dwordx4 v[40:43], v108, s[48:51], s3 offen sc1
    buffer_load_dwordx4 v[44:47], v109, s[48:51], s3 offen sc1
    s_waitcnt vmcnt(0)
    s_branch L_c12
L_r13:
    s_add_u32 s29, s29, 1
    s_cmp_ge_u32 s29, 200000
    s_cbranch_scc1 L_g13
    s_add_u32 s3, s76, 13312
    buffer_load_dwordx4 v[48:51], v108, s[48:51], s3 offen sc1
    buffer_load_dwordx4 v[52:55], v109, s[48:51], s3 offen sc1
    s_waitcnt vmcnt(0)
    s_branch L_c13
L_r14:
    s_add_u32 s29, s29, 1
    s_cmp_ge_u32 s29, 200000
    s_cbranch_scc1 L_g14
    s_add_u32 s3, s76, 14336
    buffer_load_dwordx4 v[56:59], v108, s[48:51], s3 offen sc1
    buffer_load_dwordx4 v[60:63], v109, s[48:51], s3 offen sc1
    s_waitcnt vmcnt(0)
    s_branch L_c14
L_r15:
    s_add_u32 s29, s29, 1
    s_cmp_ge_u32 s29, 200000
    s_cbranch_scc1 L_g15
    s_add_u32 s3, s76, 15360
    buffer_load_dwordx4 v[64:67], v108, s[48:51], s3 offen sc1
    buffer_load_dwordx4 v[68:71], v109, s[48:51], s3 offen sc1
    s_waitcnt vmcnt(0)
    s_branch L_c15
.p2align 8
.fill 4096, 4, 0xbf800000
.section .rodata,"a"
.p2align 6
.amdhsa_kernel recurrent_scan__linear_kernel_hedgehog__moe_arch_mod__prompt_kernel
  .amdhsa_next_free_vgpr 256
  .amdhsa_next_free_sgpr 102
  .amdhsa_accum_offset 256
  .amdhsa_group_segment_fixed_size 0
  .amdhsa_kernarg_size 96
  .amdhsa_user_sgpr_count 2
  .amdhsa_user_sgpr_kernarg_segment_ptr 1
  .amdhsa_system_sgpr_workgroup_id_x 1
.end_amdhsa_kernel
```

```asm
; @launch grid=(256,1,1) block=(512,1,1) lds=163840
.amdgcn_target "amdgcn-amd-amdhsa--gfx950"
.text
.globl recurrent_scan__linear_kernel_hedgehog__moe_arch_mod__prompt_kernel
.p2align 8
.type recurrent_scan__linear_kernel_hedgehog__moe_arch_mod__prompt_kernel,@function
recurrent_scan__linear_kernel_hedgehog__moe_arch_mod__prompt_kernel:
    s_cmp_ge_u32 s2, 256
    s_cbranch_scc1 L_done
    s_load_dwordx16 s[4:19], s[0:1], 0
    s_load_dwordx8 s[20:27], s[0:1], 64
    v_and_b32 v1, 63, v0
    v_lshrrev_b32 v2, 6, v0
    s_nop 0
    v_readfirstlane_b32 s39, v2
    s_and_b32 s34, s2, 1
    s_lshl_b32 s34, s34, 3
    s_bfe_u32 s3, s2, 0x30003
    s_add_u32 s36, s34, s3
    s_bfe_u32 s37, s2, 0x20001
    s_lshl_b32 s37, s37, 2
    s_lshr_b32 s28, s2, 6
    s_add_u32 s37, s37, s28
    s_mov_b32 s34, s36
    s_xor_b32 s35, s37, 1
    s_and_b32 s38, s39, 3
    s_cmp_lt_u32 s39, 4
    s_cbranch_scc1 L_C
L_H:
    v_and_b32 v4, 7, v1
    s_lshl_b32 s33, s37, 7
    s_add_u32 s85, s36, s37
    s_and_b32 s85, s85, 3
    s_lshl_b32 s87, s85, 7
    s_lshl_b32 s3, s36, 7
    s_lshl_b32 s28, s38, 5
    s_add_u32 s3, s3, s28
    v_lshrrev_b32 v7, 3, v1
    v_add_u32 v3, s3, v7
    v_lshlrev_b32 v3, 11, v3
    v_lshrrev_b32 v5, 4, v1
    v_xor_b32 v6, v4, v5
    v_xor_b32 v5, 4, v6
    v_lshl_add_u32 v6, v6, 4, v3
    v_lshl_add_u32 v5, v5, 4, v3
    v_add_u32_e64 v8, 0, v6
    v_add_u32 v9, 15360, v5
    v_add_u32 v10, 30720, v6
    v_add_u32 v11, 46080, v5
    s_lshr_b32 s32, s36, 1
    s_and_b32 s32, s32, 2
    s_xor_b32 s32, s32, s38
    s_lshl_b32 s3, s32, 4
    v_add_u32_e64 v7, s3, v7
    v_mul_u32_u24 v7, 6144, v7
    v_bfe_u32 v6, v1, 4, 1
    v_lshlrev_b32 v6, 1, v6
    v_xor_b32 v5, v4, v6
    v_add_u32 v7, s33, v7
    v_xor_b32 v6, 4, v5
    v_lshl_add_u32 v6, v6, 4, v7
    v_lshl_add_u32 v7, v5, 4, v7
    v_add_u32_e64 v12, 0, v7
    v_add_u32 v13, 48128, v6
    v_add_u32 v14, 2048, v7
    v_add_u32 v15, 50176, v6
    v_add_u32 v16, 4096, v7
    v_add_u32 v17, 52224, v6
    v_xor_b32 v12, 512, v12
    v_xor_b32 v13, 512, v13
    s_lshl_b32 s30, s38, 12
    s_lshl_b32 s31, s32, 11
    s_add_u32 s31, s31, 16384
    s_waitcnt lgkmcnt(0)
    s_mov_b32 s44, s6
    s_mov_b32 s45, s7
    s_mov_b32 s46, 6291456
    s_mov_b32 s47, 0x00020000
    s_mov_b32 s40, s4
    s_mov_b32 s41, s5
    s_mov_b32 s42, 4194304
    s_mov_b32 s43, 0x00020000
    s_add_u32 s3, s87, 0
    s_and_b32 s3, s3, 511
    s_or_b32 s3, s3, 0
    s_mul_i32 s28, s3, 3072
    s_add_u32 m0, s30, 0
    s_nop 0
    buffer_load_dwordx4 v8, s[40:43], s3 offen offset:0 lds
    buffer_load_dwordx4 v9, s[40:43], s3 offen offset:1024 lds
    buffer_load_dwordx4 v10, s[40:43], s3 offen offset:2048 lds
    buffer_load_dwordx4 v11, s[40:43], s3 offen offset:3072 lds
    s_add_u32 m0, s31, 0
    s_nop 0
    buffer_load_dwordx4 v12, s[44:47], s28 offen offset:0 lds
    buffer_load_dwordx4 v13, s[44:47], s28 offen offset:1024 lds
    s_add_u32 m0, s31, 8192
    s_nop 0
    buffer_load_dwordx4 v14, s[44:47], s28 offen offset:0 lds
    buffer_load_dwordx4 v15, s[44:47], s28 offen offset:1024 lds
    s_add_u32 m0, s31, 16384
    s_nop 0
    buffer_load_dwordx4 v16, s[44:47], s28 offen offset:0 lds
    buffer_load_dwordx4 v17, s[44:47], s28 offen offset:1024 lds
    s_mov_b32 s48, s26
    s_mov_b32 s49, s27
    s_nop 0
    s_mov_b32 s50, 268435456
    s_mov_b32 s51, 0x00020000
    v_mov_b32 v19, 16384
    buffer_load_dword v19, v19, s[48:51], 0 offen sc1
    s_add_u32 s3, s87, 128
    s_and_b32 s3, s3, 511
    s_or_b32 s3, s3, 0
    s_mul_i32 s28, s3, 3072
    s_add_u32 m0, s30, 40960
    s_nop 0
    buffer_load_dwordx4 v8, s[40:43], s3 offen offset:0 lds
    buffer_load_dwordx4 v9, s[40:43], s3 offen offset:1024 lds
    buffer_load_dwordx4 v10, s[40:43], s3 offen offset:2048 lds
    buffer_load_dwordx4 v11, s[40:43], s3 offen offset:3072 lds
    s_add_u32 m0, s31, 40960
    s_nop 0
    buffer_load_dwordx4 v12, s[44:47], s28 offen offset:0 lds
    buffer_load_dwordx4 v13, s[44:47], s28 offen offset:1024 lds
    s_add_u32 m0, s31, 49152
    s_nop 0
    buffer_load_dwordx4 v14, s[44:47], s28 offen offset:0 lds
    buffer_load_dwordx4 v15, s[44:47], s28 offen offset:1024 lds
    s_add_u32 m0, s31, 57344
    s_nop 0
    buffer_load_dwordx4 v16, s[44:47], s28 offen offset:0 lds
    buffer_load_dwordx4 v17, s[44:47], s28 offen offset:1024 lds
    v_mov_b32 v248, -1
    v_mov_b32 v249, -1
    v_mov_b32 v250, -1
    v_mov_b32 v251, -1
    v_lshlrev_b32_e64 v252, 4, v1
    s_and_b32 s85, s85, 0
    s_lshl_b32 s3, s37, 4
    s_add_u32 s3, s3, s36
    s_mul_i32 s67, s3, 768
    s_add_u32 s67, s67, 1048576
    s_lshl_b32 s3, s38, 8
    s_add_u32 s67, s67, s3
    s_cmp_eq_u32 s38, 3
    s_cselect_b32 s67, 268435456, s67
    v_mov_b32 v24, 0
    v_mov_b32 v25, 0
    v_mov_b32 v26, 0
    v_mov_b32 v27, 0
    v_mov_b32 v28, 0
    v_mov_b32 v29, 0
    v_mov_b32 v30, 0
    v_mov_b32 v31, 0
    v_lshlrev_b32 v253, 2, v1
    s_cmp_gt_u32 s37, 3
    s_subb_u32 s77, s37, 0
    s_cmp_gt_u32 s37, 11
    s_subb_u32 s77, s77, 0
    s_lshl_b32 s77, s77, 4
    s_add_u32 s77, s77, s36
    s_and_b32 s3, s37, 7
    s_cmp_eq_u32 s3, 3
    s_cselect_b32 s77, 224, s77
    s_bitcmp1_b32 s38, 0
    s_cselect_b32 s52, s18, s16
    s_cselect_b32 s53, s19, s17
    s_cmp_lt_u32 s77, 224
    s_cselect_b32 s54, 7340032, 0
    s_mov_b32 s55, 0x00020000
    s_mov_b32 s56, s20
    s_mov_b32 s57, s21
    s_mov_b32 s58, 7340032
    s_mov_b32 s59, 0x00020000
    s_and_b32 s3, s77, 3
    s_lshl_b32 s3, s3, 8
    s_lshr_b32 s28, s38, 1
    s_lshl_b32 s28, s28, 7
    s_add_u32 s3, s3, s28
    v_lshrrev_b32_e64 v5, 3, v1
    v_lshl_add_u32 v6, v5, 4, s3
    v_mul_u32_u24 v6, 7168, v6
    v_lshl_add_u32 v6, v4, 4, v6
    s_lshr_b32 s3, s77, 2
    s_lshl_b32 s3, s3, 7
    v_add_u32 v21, s3, v6
    s_lshr_b32 s3, s2, 4
    s_mul_i32 s3, s3, 224
    s_mul_i32 s28, s38, 56
    s_add_u32 s71, s3, s28
    v_lshlrev_b32 v6, 14, v5
    v_lshl_add_u32 v6, v4, 4, v6
    s_and_b32 s3, s2, 15
    s_lshl_b32 s3, s3, 7
    v_add_u32 v22, s3, v6
    v_bfe_u32 v5, v1, 4, 1
    v_lshlrev_b32 v5, 5, v5
    v_xor_b32 v5, v5, v252
    s_min_u32 s3, s38, 2
    s_lshl_b32 s3, s3, 13
    s_lshr_b32 s80, s36, 2
    s_lshl_b32 s28, s80, 11
    s_add_u32 s3, s3, s28
    s_add_u32 s3, s3, 16384
    v_add_u32 v18, s3, v5
    s_lshr_b32 s3, s38, 1
    s_lshl_b32 s28, s37, 1
    s_add_u32 s28, s28, s3
    s_and_b32 s29, s38, 1
    s_lshl_b32 s3, s28, 4
    s_add_u32 s3, s3, s36
    s_mul_i32 s3, s3, 4224
    s_mul_i32 s78, s29, 2112
    s_add_u32 s78, s78, s3
    s_add_u32 s78, s78, 8388608
    s_lshl_b32 s3, s36, 1
    s_add_u32 s29, s29, s3
    s_xor_b32 s28, s28, 8
    s_lshl_b32 s3, s29, 7
    s_add_u32 s3, s3, s28
    s_lshl_b32 s3, s3, 10
    s_add_u32 s79, s3, 4194304
    s_mov_b32 s88, s10
    s_mov_b32 s89, s11
    s_mov_b32 s90, 2097152
    s_mov_b32 s91, 0x00020000
    s_waitcnt vmcnt(11)
    s_waitcnt lgkmcnt(0)
    s_barrier
    v_add_u32 v2, 0, v18
    v_xor_b32 v3, 64, v2
    ds_read_b128 v[32:35], v2 offset:0
    ds_read_b128 v[36:39], v3 offset:1024
    s_add_u32 s3, s87, 256
    s_and_b32 s3, s3, 511
    s_or_b32 s3, s3, 0
    s_mul_i32 s28, s3, 3072
    s_add_u32 m0, s30, 81920
    s_nop 0
    buffer_load_dwordx4 v8, s[40:43], s3 offen offset:0 lds
    buffer_load_dwordx4 v9, s[40:43], s3 offen offset:1024 lds
    buffer_load_dwordx4 v10, s[40:43], s3 offen offset:2048 lds
    buffer_load_dwordx4 v11, s[40:43], s3 offen offset:3072 lds
    s_add_u32 m0, s31, 81920
    s_nop 0
    buffer_load_dwordx4 v12, s[44:47], s28 offen offset:0 lds
    buffer_load_dwordx4 v13, s[44:47], s28 offen offset:1024 lds
    s_add_u32 m0, s31, 90112
    s_nop 0
    buffer_load_dwordx4 v14, s[44:47], s28 offen offset:0 lds
    buffer_load_dwordx4 v15, s[44:47], s28 offen offset:1024 lds
    s_add_u32 m0, s31, 98304
    s_nop 0
    buffer_load_dwordx4 v16, s[44:47], s28 offen offset:0 lds
    buffer_load_dwordx4 v17, s[44:47], s28 offen offset:1024 lds
    v_add_u32 v232, 131080, v252
    v_lshrrev_b32 v2, 5, v1
    v_and_b32 v3, 31, v1
    v_lshl_add_u32 v2, v2, 7, v3
    s_lshl_b32 s3, s38, 7
    s_add_u32 s3, s3, 152064
    v_lshl_add_u32 v230, v2, 2, s3
    v_bfe_u32 v4, v1, 2, 2
    v_lshlrev_b32_e64 v4, 3, v4
    v_bfe_u32 v7, v1, 4, 1
    v_lshl_add_u32 v4, v7, 2, v4
    v_and_b32 v7, 3, v1
    v_add_u32_e64 v4, v4, v7
    s_lshl_b32 s3, s38, 6
    s_add_u32 s3, s3, 154624
    v_lshl_add_u32 v231, v4, 1, s3
    s_waitcnt vmcnt(10)
    s_waitcnt lgkmcnt(0)
    s_barrier
    s_add_u32 s3, s87, 384
    s_and_b32 s3, s3, 511
    s_or_b32 s3, s3, 0
    s_mul_i32 s28, s3, 3072
    s_add_u32 m0, s30, 0
    s_nop 0
    buffer_load_dwordx4 v8, s[40:43], s3 offen offset:0 lds
    buffer_load_dwordx4 v9, s[40:43], s3 offen offset:1024 lds
    buffer_load_dwordx4 v10, s[40:43], s3 offen offset:2048 lds
    buffer_load_dwordx4 v11, s[40:43], s3 offen offset:3072 lds
    s_add_u32 m0, s31, 0
    s_nop 0
    buffer_load_dwordx4 v12, s[44:47], s28 offen offset:0 lds
    buffer_load_dwordx4 v13, s[44:47], s28 offen offset:1024 lds
    s_add_u32 m0, s31, 8192
    s_nop 0
    buffer_load_dwordx4 v14, s[44:47], s28 offen offset:0 lds
    buffer_load_dwordx4 v15, s[44:47], s28 offen offset:1024 lds
    s_add_u32 m0, s31, 16384
    s_nop 0
    buffer_load_dwordx4 v16, s[44:47], s28 offen offset:0 lds
    buffer_load_dwordx4 v17, s[44:47], s28 offen offset:1024 lds
    s_lshl_b32 s3, s36, 7
    s_lshl_b32 s28, s34, 7
    v_mov_b32 v2, s3
    v_mov_b32 v4, s28
    v_cmp_gt_u32 vcc, 32, v1
    s_lshl_b32 s3, s38, 5
    v_and_b32 v3, 30, v1
    v_cndmask_b32 v2, v4, v2, vcc
    v_add3_u32 v2, v2, v3, s3
    v_and_b32 v3, 1, v1
    v_lshl_add_u32 v2, v2, 1, v3
    v_lshlrev_b32 v2, 2, v2
    v_add_u32 v237, 131072, v2
    s_mul_i32 s3, s38, 48
    v_and_b32 v2, 15, v1
    v_min_u32 v2, 11, v2
    v_lshrrev_b32 v3, 4, v1
    v_lshlrev_b32 v4, 4, v2
    v_lshl_add_u32 v2, v2, 2, v3
    v_add_u32 v2, s3, v2
    v_and_b32_e64 v5, 7, v2
    v_bfe_u32 v6, v2, 3, 3
    v_lshl_add_u32 v5, v5, 3, v6
    v_and_b32 v2, 0xc0, v2
    v_add_u32 v2, v2, v5
    v_lshlrev_b32 v2, 2, v2
    v_add_u32 v233, 154880, v2
    v_mul_u32_u24 v3, 768, v3
    v_add_u32 v235, v3, v4
    v_mov_b32 v234, 162048
    v_readfirstlane_b32 s86, v19
    s_nop 0
    s_add_u32 s86, s86, 1
    s_lshl_b32 s3, s36, 7
    s_lshl_b32 s28, s37, 3
    s_add_u32 s3, s3, s28
    s_lshl_b32 s3, s3, 11
    s_add_u32 s3, s3, s30
    s_add_u32 m0, s30, 131072
    s_nop 0
    buffer_load_dwordx4 v252, s[40:43], s3 offen offset:0 lds
    buffer_load_dwordx4 v252, s[40:43], s3 offen offset:2048 lds
    s_lshl_b32 s3, s36, 7
    s_lshl_b32 s28, s37, 3
    s_add_u32 s3, s3, s28
    s_lshl_b32 s3, s3, 11
    s_add_u32 s3, s3, s30
    s_add_u32 m0, s30, 131072
    s_nop 0
    buffer_load_dwordx4 v252, s[40:43], s3 offen offset:1024 lds
    buffer_load_dwordx4 v252, s[40:43], s3 offen offset:3072 lds
    s_mov_b32 s60, s14
    s_mov_b32 s61, s15
    s_mov_b32 s62, 2048
    s_mov_b32 s63, 0x00020000
    s_lshl_b32 s3, s38, 9
    s_add_u32 m0, s3, 122880
    s_mov_b32 exec_hi, 0
    buffer_load_dwordx4 v252, s[60:63], s3 offen lds
    s_mov_b64 exec, -1
    s_waitcnt vmcnt(15)
    s_waitcnt lgkmcnt(0)
    s_barrier
    v_lshlrev_b32 v2, 16, v32
    v_and_b32 v3, 0xffff0000, v32
    v_add_f32 v24, v24, v2
    v_add_f32 v25, v25, v3
    v_lshlrev_b32 v4, 16, v33
    v_and_b32 v5, 0xffff0000, v33
    v_add_f32 v26, v26, v4
    v_add_f32 v27, v27, v5
    v_lshlrev_b32 v2, 16, v34
    v_and_b32 v3, 0xffff0000, v34
    v_add_f32 v28, v28, v2
    v_add_f32 v29, v29, v3
    v_lshlrev_b32 v4, 16, v35
    v_and_b32 v5, 0xffff0000, v35
    v_add_f32 v30, v30, v4
    v_add_f32 v31, v31, v5
    v_lshlrev_b32 v2, 16, v36
    v_and_b32 v3, 0xffff0000, v36
    v_add_f32 v24, v24, v2
    v_add_f32 v25, v25, v3
    v_lshlrev_b32 v4, 16, v37
    v_and_b32 v5, 0xffff0000, v37
    v_add_f32 v26, v26, v4
    v_add_f32 v27, v27, v5
    v_lshlrev_b32 v2, 16, v38
    v_and_b32 v3, 0xffff0000, v38
    v_add_f32 v28, v28, v2
    v_add_f32 v29, v29, v3
    v_lshlrev_b32 v4, 16, v39
    v_and_b32 v5, 0xffff0000, v39
    v_add_f32 v30, v30, v4
    v_add_f32_e64 v31, v31, v5
    s_add_u32 s3, s87, 0
    s_and_b32 s3, s3, 511
    s_or_b32 s3, s3, 512
    s_mul_i32 s28, s3, 3072
    s_add_u32 m0, s30, 40960
    s_nop 0
    buffer_load_dwordx4 v8, s[40:43], s3 offen offset:0 lds
    buffer_load_dwordx4 v9, s[40:43], s3 offen offset:1024 lds
    buffer_load_dwordx4 v10, s[40:43], s3 offen offset:2048 lds
    buffer_load_dwordx4 v11, s[40:43], s3 offen offset:3072 lds
    s_add_u32 m0, s31, 40960
    s_nop 0
    buffer_load_dwordx4 v12, s[44:47], s28 offen offset:0 lds
    buffer_load_dwordx4 v13, s[44:47], s28 offen offset:1024 lds
    s_add_u32 m0, s31, 49152
    s_nop 0
    buffer_load_dwordx4 v14, s[44:47], s28 offen offset:0 lds
    buffer_load_dwordx4 v15, s[44:47], s28 offen offset:1024 lds
    s_add_u32 m0, s31, 57344
    s_nop 0
    buffer_load_dwordx4 v16, s[44:47], s28 offen offset:0 lds
    buffer_load_dwordx4 v17, s[44:47], s28 offen offset:1024 lds
    s_waitcnt vmcnt(10)
    s_barrier
    v_lshrrev_b32 v5, 3, v1
    v_lshlrev_b32 v6, 11, v5
    v_bfe_u32 v5, v1, 4, 2
    v_lshlrev_b32 v5, 1, v5
    v_and_b32 v7, 7, v1
    v_xor_b32 v5, v5, v7
    v_lshl_add_u32 v6, v5, 4, v6
    s_lshl_b32 s3, s35, 7
    v_add_u32 v6, s3, v6
    v_add_u32 v220, 0, v6
    v_add_u32 v221, 15360, v6
    v_add_u32 v222, 30720, v6
    v_add_u32 v223, 46080, v6
    s_lshl_b32 s72, s38, 12
    s_lshl_b32 s73, s38, 16
    s_lshl_b32 s3, s36, 2
    s_add_u32 s3, s3, s38
    s_lshr_b32 s28, s3, 5
    s_and_b32 s3, s3, 31
    s_lshl_b32 s74, s3, 7
    s_lshl_b32 s3, s37, 1
    s_add_u32 s75, s3, s28
    v_lshrrev_b32 v5, 3, v1
    v_mul_u32_u24 v5, 4224, v5
    v_and_b32_e64 v7, 7, v1
    v_lshl_add_u32 v112, v7, 4, v5
    s_mul_i32 s76, s75, 67584
    s_add_u32 s76, s76, s74
    s_add_u32 s76, s76, 8388608
    s_mul_i32 s3, s75, 4224
    s_add_u32 s3, s3, s74
    s_add_u32 s74, s3, 1245184
    s_lshl_b32 s75, s37, 1
    s_add_u32 s75, s75, s36
    s_mul_i32 s81, s75, 67584
    s_add_u32 s81, s81, 8392704
    s_mul_i32 s82, s75, 4224
    s_add_u32 s82, s82, 1249280
    s_lshr_b32 s3, s36, 1
    s_or_b32 s83, s3, s38
    s_and_b32 s3, s38, 1
    s_lshl_b32 s3, s3, 3
    s_and_b32 s28, s77, 3
    s_lshl_b32 s28, s28, 1
    s_add_u32 s3, s3, s28
    s_lshr_b32 s28, s38, 1
    s_add_u32 s3, s3, s28
    s_mul_i32 s3, s3, 14336
    s_lshr_b32 s28, s77, 2
    s_lshl_b32 s28, s28, 8
    s_add_u32 s3, s3, s28
    s_add_u32 s3, s3, 1380352
    s_cmp_lt_u32 s77, 224
    s_cselect_b32 s84, s3, 268435456
    v_and_b32 v2, 15, v1
    v_bfe_u32 v3, v1, 4, 1
    v_mul_u32_u24 v3, 4, v3
    v_xor_b32_e64 v3, s37, v3
    v_lshl_add_u32 v3, v3, 4, v2
    v_lshl_add_u32 v2, v2, 4, s34
    v_cmp_gt_u32 vcc, 32, v1
    s_nop 1
    v_cndmask_b32 v2, v2, v3, vcc
    v_lshlrev_b32 v113, 7, v2
    v_lshrrev_b32 v2, 3, v1
    v_mul_u32_u24 v2, 6144, v2
    v_and_b32 v3, 7, v1
    v_lshl_add_u32 v2, v3, 4, v2
    s_lshr_b32 s3, s87, 1
    s_lshl_b32 s28, s80, 4
    s_add_u32 s3, s3, s28
    s_add_u32 s3, s3, 768
    s_mul_i32 s3, s3, 6144
    s_lshl_b32 s28, s38, 11
    s_add_u32 s3, s3, s28
    s_add_u32 s3, s3, s33
    s_xor_b32 s28, s3, 512
    s_cmp_eq_u32 s38, 0
    s_cselect_b32 s3, s28, s3
    s_cmp_eq_u32 s38, 3
    s_cselect_b32 s3, 0x7000000, s3
    s_add_u32 s28, s3, 49152
    buffer_load_dwordx4 v[56:59], v2, s[44:47], s3 offen
    buffer_load_dwordx4 v[60:63], v2, s[44:47], s28 offen
    s_mov_b32 s60, s8
    s_mov_b32 s61, s9
    s_mov_b32 s62, 65536
    s_mov_b32 s63, 0x00020000
    s_lshl_b32 s3, s38, 10
    s_add_u32 m0, s3, 147712
    s_lshl_b32 s28, s37, 12
    s_add_u32 s3, s3, s28
    buffer_load_dwordx4 v252, s[60:63], s3 offen lds
    s_add_u32 m0, m0, 8192
    s_xor_b32 s3, s3, 16384
    buffer_load_dwordx4 v252, s[60:63], s3 offen lds
    s_lshl_b32 s3, s2, 13
    s_lshl_b32 s28, s38, 11
    s_add_u32 s3, s3, s28
    v_lshlrev_b32 v3, 7, v1
    s_mov_b64 exec, 0xffff
    buffer_load_dword v20, v3, s[88:91], s3 offen
    s_mov_b64 exec, -1
    s_waitcnt lgkmcnt(0)
    s_barrier
    s_add_u32 s3, s87, 128
    s_and_b32 s3, s3, 511
    s_or_b32 s3, s3, 512
    s_mul_i32 s28, s3, 3072
    s_add_u32 m0, s30, 81920
    s_nop 0
    buffer_load_dwordx4 v8, s[40:43], s3 offen offset:0 lds
    buffer_load_dwordx4 v9, s[40:43], s3 offen offset:1024 lds
    buffer_load_dwordx4 v10, s[40:43], s3 offen offset:2048 lds
    buffer_load_dwordx4 v11, s[40:43], s3 offen offset:3072 lds
    s_add_u32 m0, s31, 81920
    s_nop 0
    buffer_load_dwordx4 v12, s[44:47], s28 offen offset:0 lds
    buffer_load_dwordx4 v13, s[44:47], s28 offen offset:1024 lds
    s_add_u32 m0, s31, 90112
    s_nop 0
    buffer_load_dwordx4 v14, s[44:47], s28 offen offset:0 lds
    buffer_load_dwordx4 v15, s[44:47], s28 offen offset:1024 lds
    s_add_u32 m0, s31, 98304
    s_nop 0
    buffer_load_dwordx4 v16, s[44:47], s28 offen offset:0 lds
    buffer_load_dwordx4 v17, s[44:47], s28 offen offset:1024 lds
    s_waitcnt vmcnt(15)
    s_waitcnt lgkmcnt(0)
    s_barrier
    v_add_u32 v2, 40960, v18
    v_xor_b32_e64 v3, 64, v2
    ds_read_b128 v[40:43], v2 offset:0
    ds_read_b128 v[44:47], v3 offset:1024
    s_add_u32 s3, s87, 256
    s_and_b32 s3, s3, 511
    s_or_b32 s3, s3, 512
    s_mul_i32 s28, s3, 3072
    s_add_u32 m0, s30, 0
    s_nop 0
    buffer_load_dwordx4 v8, s[40:43], s3 offen offset:0 lds
    buffer_load_dwordx4 v9, s[40:43], s3 offen offset:1024 lds
    buffer_load_dwordx4 v10, s[40:43], s3 offen offset:2048 lds
    buffer_load_dwordx4 v11, s[40:43], s3 offen offset:3072 lds
    s_add_u32 m0, s31, 0
    s_nop 0
    buffer_load_dwordx4 v12, s[44:47], s28 offen offset:0 lds
    buffer_load_dwordx4 v13, s[44:47], s28 offen offset:1024 lds
    s_add_u32 m0, s31, 8192
    s_nop 0
    buffer_load_dwordx4 v14, s[44:47], s28 offen offset:0 lds
    buffer_load_dwordx4 v15, s[44:47], s28 offen offset:1024 lds
    s_add_u32 m0, s31, 16384
    s_nop 0
    buffer_load_dwordx4 v16, s[44:47], s28 offen offset:0 lds
    buffer_load_dwordx4 v17, s[44:47], s28 offen offset:1024 lds
    s_waitcnt vmcnt(23)
    v_lshlrev_b32 v2, 16, v56
    v_and_b32 v3, 0xffff0000, v56
    v_add_f32 v24, v24, v2
    v_add_f32 v25, v25, v3
    v_lshlrev_b32 v4, 16, v57
    v_and_b32 v5, 0xffff0000, v57
    v_add_f32 v26, v26, v4
    v_add_f32 v27, v27, v5
    v_lshlrev_b32 v2, 16, v58
    v_and_b32 v3, 0xffff0000, v58
    v_add_f32 v28, v28, v2
    v_add_f32 v29, v29, v3
    v_lshlrev_b32 v4, 16, v59
    v_and_b32 v5, 0xffff0000, v59
    v_add_f32 v30, v30, v4
    v_add_f32 v31, v31, v5
    v_lshlrev_b32 v2, 16, v60
    v_and_b32 v3, 0xffff0000, v60
    v_add_f32 v24, v24, v2
    v_add_f32 v25, v25, v3
    v_lshlrev_b32 v4, 16, v61
    v_and_b32 v5, 0xffff0000, v61
    v_add_f32 v26, v26, v4
    v_add_f32 v27, v27, v5
    v_lshlrev_b32 v2, 16, v62
    v_and_b32 v3, 0xffff0000, v62
    v_add_f32 v28, v28, v2
    v_add_f32 v29, v29, v3
    v_lshlrev_b32 v4, 16, v63
    v_and_b32 v5, 0xffff0000, v63
    v_add_f32 v30, v30, v4
    v_add_f32_e64 v31, v31, v5
    buffer_store_dwordx4 v[248:251], v252, s[48:51], s78 offen offset:0 sc1
    buffer_store_dwordx4 v[248:251], v252, s[48:51], s78 offen offset:1024 sc1
    s_mov_b64 exec, 15
    buffer_store_dwordx4 v[248:251], v252, s[48:51], s78 offen offset:2048 sc1
    s_mov_b64 exec, -1
    s_waitcnt vmcnt(13)
    s_waitcnt lgkmcnt(0)
    s_barrier
    s_add_u32 s3, s87, 384
    s_and_b32 s3, s3, 511
    s_or_b32 s3, s3, 512
    s_mul_i32 s28, s3, 3072
    s_add_u32 m0, s30, 40960
    s_nop 0
    buffer_load_dwordx4 v8, s[40:43], s3 offen offset:0 lds
    buffer_load_dwordx4 v9, s[40:43], s3 offen offset:1024 lds
    buffer_load_dwordx4 v10, s[40:43], s3 offen offset:2048 lds
    buffer_load_dwordx4 v11, s[40:43], s3 offen offset:3072 lds
    s_add_u32 m0, s31, 40960
    s_nop 0
    buffer_load_dwordx4 v12, s[44:47], s28 offen offset:0 lds
    buffer_load_dwordx4 v13, s[44:47], s28 offen offset:1024 lds
    s_add_u32 m0, s31, 49152
    s_nop 0
    buffer_load_dwordx4 v14, s[44:47], s28 offen offset:0 lds
    buffer_load_dwordx4 v15, s[44:47], s28 offen offset:1024 lds
    s_add_u32 m0, s31, 57344
    s_nop 0
    buffer_load_dwordx4 v16, s[44:47], s28 offen offset:0 lds
    buffer_load_dwordx4 v17, s[44:47], s28 offen offset:1024 lds
    s_lshl_b32 s3, s38, 12
    s_add_u32 m0, s3, 131072
    s_nop 0
    buffer_load_dwordx4 v252, s[48:51], s3 offen offset:0 sc1 lds
    buffer_load_dwordx4 v252, s[48:51], s3 offen offset:1024 sc1 lds
    buffer_load_dwordx4 v252, s[48:51], s3 offen offset:2048 sc1 lds
    buffer_load_dwordx4 v252, s[48:51], s3 offen offset:3072 sc1 lds
    s_waitcnt vmcnt(17)
    s_waitcnt lgkmcnt(0)
    s_barrier
    s_add_u32 s3, s87, 0
    s_and_b32 s3, s3, 511
    s_or_b32 s3, s3, 1024
    s_mul_i32 s28, s3, 3072
    s_add_u32 m0, s30, 81920
    s_nop 0
    buffer_load_dwordx4 v8, s[40:43], s3 offen offset:0 lds
    buffer_load_dwordx4 v9, s[40:43], s3 offen offset:1024 lds
    buffer_load_dwordx4 v10, s[40:43], s3 offen offset:2048 lds
    buffer_load_dwordx4 v11, s[40:43], s3 offen offset:3072 lds
    s_add_u32 m0, s31, 81920
    s_nop 0
    buffer_load_dwordx4 v12, s[44:47], s28 offen offset:0 lds
    buffer_load_dwordx4 v13, s[44:47], s28 offen offset:1024 lds
    s_add_u32 m0, s31, 90112
    s_nop 0
    buffer_load_dwordx4 v14, s[44:47], s28 offen offset:0 lds
    buffer_load_dwordx4 v15, s[44:47], s28 offen offset:1024 lds
    s_add_u32 m0, s31, 98304
    s_nop 0
    buffer_load_dwordx4 v16, s[44:47], s28 offen offset:0 lds
    buffer_load_dwordx4 v17, s[44:47], s28 offen offset:1024 lds
    v_lshlrev_b32 v2, 16, v40
    v_and_b32 v3, 0xffff0000, v40
    v_add_f32 v24, v24, v2
    v_add_f32 v25, v25, v3
    v_lshlrev_b32 v4, 16, v41
    v_and_b32 v5, 0xffff0000, v41
    v_add_f32 v26, v26, v4
    v_add_f32 v27, v27, v5
    v_lshlrev_b32 v2, 16, v42
    v_and_b32 v3, 0xffff0000, v42
    v_add_f32 v28, v28, v2
    v_add_f32 v29, v29, v3
    v_lshlrev_b32 v4, 16, v43
    v_and_b32 v5, 0xffff0000, v43
    v_add_f32 v30, v30, v4
    v_add_f32 v31, v31, v5
    v_lshlrev_b32 v2, 16, v44
    v_and_b32 v3, 0xffff0000, v44
    v_add_f32 v24, v24, v2
    v_add_f32 v25, v25, v3
    v_lshlrev_b32 v4, 16, v45
    v_and_b32 v5, 0xffff0000, v45
    v_add_f32 v26, v26, v4
    v_add_f32 v27, v27, v5
    v_lshlrev_b32 v2, 16, v46
    v_and_b32 v3, 0xffff0000, v46
    v_add_f32 v28, v28, v2
    v_add_f32 v29, v29, v3
    v_lshlrev_b32 v4, 16, v47
    v_and_b32 v5, 0xffff0000, v47
    v_add_f32 v30, v30, v4
    v_add_f32 v31, v31, v5
    s_waitcnt vmcnt(10)
    s_waitcnt lgkmcnt(0)
    s_barrier
    ds_read_b64 v[80:81], v232 offset:0
    ds_read_b64 v[82:83], v232 offset:1024
    ds_read_b64 v[84:85], v232 offset:2048
    ds_read_b64 v[86:87], v232 offset:3072
    ds_read_b64 v[88:89], v232 offset:4096
    ds_read_b64 v[90:91], v232 offset:5120
    ds_read_b64 v[92:93], v232 offset:6144
    ds_read_b64 v[94:95], v232 offset:7168
    ds_read_b64 v[96:97], v232 offset:8192
    ds_read_b64 v[98:99], v232 offset:9216
    ds_read_b64 v[100:101], v232 offset:10240
    ds_read_b64 v[102:103], v232 offset:11264
    ds_read_b64 v[104:105], v232 offset:12288
    ds_read_b64 v[106:107], v232 offset:13312
    ds_read_b64 v[108:109], v232 offset:14336
    ds_read_b64 v[110:111], v232 offset:15360
    ds_read_b32 v72, v237
    s_waitcnt lgkmcnt(0)
    s_nop 0
    v_min3_u32 v4, v81, v83, v85
    v_max3_u32 v5, v81, v83, v85
    v_min3_u32 v4, v4, v87, v89
    v_max3_u32 v5, v5, v87, v89
    v_min3_u32 v4, v4, v91, v93
    v_max3_u32 v5, v5, v91, v93
    v_min3_u32 v4, v4, v95, v97
    v_max3_u32 v5, v5, v95, v97
    v_min3_u32 v4, v4, v99, v101
    v_max3_u32 v5, v5, v99, v101
    v_min3_u32 v4, v4, v103, v105
    v_max3_u32 v5, v5, v103, v105
    v_min3_u32 v4, v4, v107, v109
    v_max3_u32 v5, v5, v107, v109
    s_mov_b32 s29, 0
L_k1:
    v_cmp_ne_u32 vcc, s86, v4
    v_cmp_ne_u32 s[92:93], s86, v5
    s_nop 0
    s_or_b64 vcc, vcc, s[92:93]
    v_cmp_ne_u32 s[92:93], s86, v111
    s_nop 0
    s_or_b64 vcc, vcc, s[92:93]
    s_cbranch_vccz L_k1k
    s_add_u32 s29, s29, 1
    s_cmp_ge_u32 s29, 200000
    s_cbranch_scc1 L_k1k
    s_sleep 2
    s_mov_b32 m0, 131072
    s_movk_i32 s3, 0
    buffer_load_dwordx4 v252, s[48:51], s3 offen offset:0 sc1 lds
    buffer_load_dwordx4 v252, s[48:51], s3 offen offset:1024 sc1 lds
    buffer_load_dwordx4 v252, s[48:51], s3 offen offset:2048 sc1 lds
    buffer_load_dwordx4 v252, s[48:51], s3 offen offset:3072 sc1 lds
    s_mov_b32 m0, 135168
    s_movk_i32 s3, 4096
    buffer_load_dwordx4 v252, s[48:51], s3 offen offset:0 sc1 lds
    buffer_load_dwordx4 v252, s[48:51], s3 offen offset:1024 sc1 lds
    buffer_load_dwordx4 v252, s[48:51], s3 offen offset:2048 sc1 lds
    buffer_load_dwordx4 v252, s[48:51], s3 offen offset:3072 sc1 lds
    s_mov_b32 m0, 139264
    s_movk_i32 s3, 8192
    buffer_load_dwordx4 v252, s[48:51], s3 offen offset:0 sc1 lds
    buffer_load_dwordx4 v252, s[48:51], s3 offen offset:1024 sc1 lds
    buffer_load_dwordx4 v252, s[48:51], s3 offen offset:2048 sc1 lds
    buffer_load_dwordx4 v252, s[48:51], s3 offen offset:3072 sc1 lds
    s_mov_b32 m0, 143360
    s_movk_i32 s3, 12288
    buffer_load_dwordx4 v252, s[48:51], s3 offen offset:0 sc1 lds
    buffer_load_dwordx4 v252, s[48:51], s3 offen offset:1024 sc1 lds
    buffer_load_dwordx4 v252, s[48:51], s3 offen offset:2048 sc1 lds
    buffer_load_dwordx4 v252, s[48:51], s3 offen offset:3072 sc1 lds
    s_waitcnt vmcnt(0)
    s_nop 0
    ds_read_b64 v[80:81], v232 offset:0
    ds_read_b64 v[82:83], v232 offset:1024
    ds_read_b64 v[84:85], v232 offset:2048
    ds_read_b64 v[86:87], v232 offset:3072
    ds_read_b64 v[88:89], v232 offset:4096
    ds_read_b64 v[90:91], v232 offset:5120
    ds_read_b64 v[92:93], v232 offset:6144
    ds_read_b64 v[94:95], v232 offset:7168
    ds_read_b64 v[96:97], v232 offset:8192
    ds_read_b64 v[98:99], v232 offset:9216
    ds_read_b64 v[100:101], v232 offset:10240
    ds_read_b64 v[102:103], v232 offset:11264
    ds_read_b64 v[104:105], v232 offset:12288
    ds_read_b64 v[106:107], v232 offset:13312
    ds_read_b64 v[108:109], v232 offset:14336
    ds_read_b64 v[110:111], v232 offset:15360
    ds_read_b32 v72, v237
    s_waitcnt lgkmcnt(0)
    s_nop 0
    v_min3_u32 v4, v81, v83, v85
    v_max3_u32 v5, v81, v83, v85
    v_min3_u32 v4, v4, v87, v89
    v_max3_u32 v5, v5, v87, v89
    v_min3_u32 v4, v4, v91, v93
    v_max3_u32 v5, v5, v91, v93
    v_min3_u32 v4, v4, v95, v97
    v_max3_u32 v5, v5, v95, v97
    v_min3_u32 v4, v4, v99, v101
    v_max3_u32 v5, v5, v99, v101
    v_min3_u32 v4, v4, v103, v105
    v_max3_u32 v5, v5, v103, v105
    v_min3_u32 v4, v4, v107, v109
    v_max3_u32 v5, v5, v107, v109
    s_branch L_k1
L_k1k:
    s_add_u32 s3, s87, 128
    s_and_b32 s3, s3, 511
    s_or_b32 s3, s3, 1024
    s_mul_i32 s28, s3, 3072
    s_add_u32 m0, s30, 0
    s_nop 0
    buffer_load_dwordx4 v8, s[40:43], s3 offen offset:0 lds
    buffer_load_dwordx4 v9, s[40:43], s3 offen offset:1024 lds
    buffer_load_dwordx4 v10, s[40:43], s3 offen offset:2048 lds
    buffer_load_dwordx4 v11, s[40:43], s3 offen offset:3072 lds
    s_add_u32 m0, s31, 0
    s_nop 0
    buffer_load_dwordx4 v12, s[44:47], s28 offen offset:0 lds
    buffer_load_dwordx4 v13, s[44:47], s28 offen offset:1024 lds
    s_add_u32 m0, s31, 8192
    s_nop 0
    buffer_load_dwordx4 v14, s[44:47], s28 offen offset:0 lds
    buffer_load_dwordx4 v15, s[44:47], s28 offen offset:1024 lds
    s_add_u32 m0, s31, 16384
    s_nop 0
    buffer_load_dwordx4 v16, s[44:47], s28 offen offset:0 lds
    buffer_load_dwordx4 v17, s[44:47], s28 offen offset:1024 lds
    s_waitcnt vmcnt(10)
    s_waitcnt lgkmcnt(0)
    s_barrier
    v_add_u32 v2, 81920, v18
    v_xor_b32_e64 v3, 64, v2
    ds_read_b128 v[48:51], v2 offset:0
    ds_read_b128 v[52:55], v3 offset:1024
    s_add_u32 s3, s87, 256
    s_and_b32 s3, s3, 511
    s_or_b32 s3, s3, 1024
    s_mul_i32 s28, s3, 3072
    s_add_u32 m0, s30, 40960
    s_nop 0
    buffer_load_dwordx4 v8, s[40:43], s3 offen offset:0 lds
    buffer_load_dwordx4 v9, s[40:43], s3 offen offset:1024 lds
    buffer_load_dwordx4 v10, s[40:43], s3 offen offset:2048 lds
    buffer_load_dwordx4 v11, s[40:43], s3 offen offset:3072 lds
    s_add_u32 m0, s31, 40960
    s_nop 0
    buffer_load_dwordx4 v12, s[44:47], s28 offen offset:0 lds
    buffer_load_dwordx4 v13, s[44:47], s28 offen offset:1024 lds
    s_add_u32 m0, s31, 49152
    s_nop 0
    buffer_load_dwordx4 v14, s[44:47], s28 offen offset:0 lds
    buffer_load_dwordx4 v15, s[44:47], s28 offen offset:1024 lds
    s_add_u32 m0, s31, 57344
    s_nop 0
    buffer_load_dwordx4 v16, s[44:47], s28 offen offset:0 lds
    buffer_load_dwordx4 v17, s[44:47], s28 offen offset:1024 lds
    v_max3_u32 v2, v80, v82, v84
    v_max3_u32 v2, v2, v86, v88
    v_max3_u32 v2, v2, v90, v92
    v_max3_u32 v2, v2, v94, v96
    v_max3_u32 v2, v2, v98, v100
    v_max3_u32 v2, v2, v102, v104
    v_max3_u32 v2, v2, v106, v108
    v_max_u32 v2, v2, v110
    s_nop 1
    v_max_u32 v2, v2, v2 quad_perm:[1,0,3,2] row_mask:0xf bank_mask:0xf
    s_nop 1
    v_max_u32 v2, v2, v2 quad_perm:[2,3,0,1] row_mask:0xf bank_mask:0xf
    s_nop 1
    v_max_u32 v2, v2, v2 row_half_mirror row_mask:0xf bank_mask:0xf
    s_nop 1
    v_max_u32 v2, v2, v2 row_mirror row_mask:0xf bank_mask:0xf
    s_nop 0
    v_readlane_b32 s70, v2, 0
    v_readlane_b32 s3, v2, 16
    v_readlane_b32 s28, v2, 32
    v_readlane_b32 s29, v2, 48
    s_max_u32 s70, s70, s3
    s_max_u32 s28, s28, s29
    s_max_u32 s70, s70, s28
    s_and_b32 s68, s70, 0x7ff
    s_sub_u32 s68, 2047, s68
    s_lshl_b32 s3, s68, 11
    s_and_b32 s28, s77, 3
    s_lshl_b32 s28, s28, 9
    s_add_u32 s3, s3, s28
    s_lshr_b32 s28, s38, 1
    s_lshl_b32 s28, s28, 8
    s_add_u32 s3, s3, s28
    v_lshrrev_b32 v3, 3, v1
    v_lshlrev_b32 v3, 5, v3
    buffer_load_dwordx4 v[64:67], v3, s[40:43], s3 offen
    buffer_load_dwordx4 v[68:71], v3, s[40:43], s3 offen offset:16
    s_lshr_b32 s3, s68, 1
    s_lshl_b32 s3, s3, 4
    s_and_b32 s28, s68, 1
    s_lshl_b32 s28, s28, 2
    s_add_u32 s3, s3, s28
    s_add_u32 s3, s3, 131072
    v_mov_b32 v3, s3
    ds_read_b32 v116, v3
    s_or_b32 s3, s2, s38
    s_mov_b32 s28, 16384
    s_cmp_lg_u32 s3, 0
    s_cselect_b32 s3, 268435456, s28
    v_mov_b32 v2, s86
    s_mov_b64 exec, 1
    buffer_store_dword v2, v252, s[48:51], s3 offen sc1
    s_mov_b64 exec, -1
    s_add_u32 s3, s79, 0
    buffer_store_dwordx4 v[248:251], v252, s[48:51], s3 offen sc1
    s_add_u32 s3, s79, 32768
    buffer_store_dwordx4 v[248:251], v252, s[48:51], s3 offen sc1
    s_waitcnt vmcnt(15)
    s_waitcnt lgkmcnt(0)
    s_barrier
    s_add_u32 s3, s87, 384
    s_and_b32 s3, s3, 511
    s_or_b32 s3, s3, 1024
    s_mul_i32 s28, s3, 3072
    s_add_u32 m0, s30, 81920
    s_nop 0
    buffer_load_dwordx4 v8, s[40:43], s3 offen offset:0 lds
    buffer_load_dwordx4 v9, s[40:43], s3 offen offset:1024 lds
    buffer_load_dwordx4 v10, s[40:43], s3 offen offset:2048 lds
    buffer_load_dwordx4 v11, s[40:43], s3 offen offset:3072 lds
    s_add_u32 m0, s31, 81920
    s_nop 0
    buffer_load_dwordx4 v12, s[44:47], s28 offen offset:0 lds
    buffer_load_dwordx4 v13, s[44:47], s28 offen offset:1024 lds
    s_add_u32 m0, s31, 90112
    s_nop 0
    buffer_load_dwordx4 v14, s[44:47], s28 offen offset:0 lds
    buffer_load_dwordx4 v15, s[44:47], s28 offen offset:1024 lds
    s_add_u32 m0, s31, 98304
    s_nop 0
    buffer_load_dwordx4 v16, s[44:47], s28 offen offset:0 lds
    buffer_load_dwordx4 v17, s[44:47], s28 offen offset:1024 lds
    v_lshlrev_b32 v2, 16, v48
    v_and_b32 v3, 0xffff0000, v48
    v_add_f32 v24, v24, v2
    v_add_f32 v25, v25, v3
    v_lshlrev_b32 v4, 16, v49
    v_and_b32 v5, 0xffff0000, v49
    v_add_f32 v26, v26, v4
    v_add_f32 v27, v27, v5
    v_lshlrev_b32 v2, 16, v50
    v_and_b32 v3, 0xffff0000, v50
    v_add_f32 v28, v28, v2
    v_add_f32 v29, v29, v3
    v_lshlrev_b32 v4, 16, v51
    v_and_b32 v5, 0xffff0000, v51
    v_add_f32 v30, v30, v4
    v_add_f32 v31, v31, v5
    v_lshlrev_b32 v2, 16, v52
    v_and_b32 v3, 0xffff0000, v52
    v_add_f32 v24, v24, v2
    v_add_f32 v25, v25, v3
    v_lshlrev_b32 v4, 16, v53
    v_and_b32 v5, 0xffff0000, v53
    v_add_f32 v26, v26, v4
    v_add_f32 v27, v27, v5
    v_lshlrev_b32 v2, 16, v54
    v_and_b32 v3, 0xffff0000, v54
    v_add_f32 v28, v28, v2
    v_add_f32 v29, v29, v3
    v_lshlrev_b32 v4, 16, v55
    v_and_b32 v5, 0xffff0000, v55
    v_add_f32 v30, v30, v4
    v_add_f32_e64 v31, v31, v5
    s_add_u32 s3, s79, 65536
    buffer_store_dwordx4 v[248:251], v252, s[48:51], s3 offen sc1
    s_add_u32 s3, s79, 98304
    buffer_store_dwordx4 v[248:251], v252, s[48:51], s3 offen sc1
    s_waitcnt vmcnt(17)
    s_waitcnt lgkmcnt(0)
    s_barrier
    v_permlane32_swap_b32 v24, v28
    v_permlane32_swap_b32 v25, v29
    v_permlane32_swap_b32 v26, v30
    v_permlane32_swap_b32 v27, v31
    v_add_f32 v24, v24, v28
    v_add_f32 v25, v25, v29
    v_add_f32 v26, v26, v30
    v_add_f32 v27, v27, v31
    s_nop 0
    v_permlane16_swap_b32 v24, v26
    v_permlane16_swap_b32 v25, v27
    v_add_f32 v24, v24, v26
    v_add_f32_e64 v25, v25, v27
    s_nop 0
    v_add_f32 v24, v24, v24 row_ror:8 row_mask:0xf bank_mask:0xf
    v_add_f32 v25, v25, v25 row_ror:8 row_mask:0xf bank_mask:0xf
    v_and_b32 v2, 8, v1
    v_cmp_eq_u32 vcc, 0, v2
    s_nop 1
    v_cndmask_b32 v24, v25, v24, vcc
    buffer_store_dword v24, v253, s[48:51], s67 offen sc1
    s_add_u32 s3, s87, 0
    s_and_b32 s3, s3, 511
    s_or_b32 s3, s3, 1536
    s_mul_i32 s28, s3, 3072
    s_add_u32 m0, s30, 0
    s_nop 0
    buffer_load_dwordx4 v8, s[40:43], s3 offen offset:0 lds
    buffer_load_dwordx4 v9, s[40:43], s3 offen offset:1024 lds
    buffer_load_dwordx4 v10, s[40:43], s3 offen offset:2048 lds
    buffer_load_dwordx4 v11, s[40:43], s3 offen offset:3072 lds
    s_add_u32 m0, s31, 0
    s_nop 0
    buffer_load_dwordx4 v12, s[44:47], s28 offen offset:0 lds
    buffer_load_dwordx4 v13, s[44:47], s28 offen offset:1024 lds
    s_add_u32 m0, s31, 8192
    s_nop 0
    buffer_load_dwordx4 v14, s[44:47], s28 offen offset:0 lds
    buffer_load_dwordx4 v15, s[44:47], s28 offen offset:1024 lds
    s_add_u32 m0, s31, 16384
    s_nop 0
    buffer_load_dwordx4 v16, s[44:47], s28 offen offset:0 lds
    buffer_load_dwordx4 v17, s[44:47], s28 offen offset:1024 lds
    v_and_b32 v228, 0xffff0000, v72
    v_lshlrev_b32 v225, 16, v72
    v_rcp_f32 v226, v228
    v_mov_b32 v224, s70
    v_mul_f32 v227, 1069066811, v226
    s_waitcnt vmcnt(13)
    s_waitcnt lgkmcnt(0)
    s_barrier
    v_and_b32 v5, 0xffff0000, v116
    v_lshlrev_b32 v116, 16, v116
    v_rcp_f32 v117, v5
    v_lshlrev_b32 v96, 16, v64
    v_and_b32 v97, 0xffff0000, v64
    v_lshlrev_b32 v98, 16, v65
    v_and_b32 v99, 0xffff0000, v65
    v_lshlrev_b32 v100, 16, v66
    v_and_b32 v101, 0xffff0000, v66
    v_lshlrev_b32 v102, 16, v67
    v_and_b32 v103, 0xffff0000, v67
    v_lshlrev_b32 v104, 16, v68
    v_and_b32 v105, 0xffff0000, v68
    v_lshlrev_b32 v106, 16, v69
    v_and_b32 v107, 0xffff0000, v69
    v_lshlrev_b32 v108, 16, v70
    v_and_b32 v109, 0xffff0000, v70
    v_lshlrev_b32 v110, 16, v71
    v_and_b32 v111, 0xffff0000, v71
    v_mul_f32 v119, v116, v117
    v_fma_f32 v96, v96, v117, -v119
    v_fma_f32 v97, v97, v117, -v119
    v_fma_f32 v98, v98, v117, -v119
    v_fma_f32 v99, v99, v117, -v119
    v_fma_f32 v100, v100, v117, -v119
    v_fma_f32 v101, v101, v117, -v119
    v_fma_f32 v102, v102, v117, -v119
    v_fma_f32 v103, v103, v117, -v119
    v_fma_f32 v104, v104, v117, -v119
    v_fma_f32 v105, v105, v117, -v119
    v_fma_f32 v106, v106, v117, -v119
    v_fma_f32 v107, v107, v117, -v119
    v_fma_f32 v108, v108, v117, -v119
    v_fma_f32 v109, v109, v117, -v119
    v_fma_f32 v110, v110, v117, -v119
    v_fma_f32 v111, v111, v117, -v119
    v_mov_b32 v120, 0
    v_mov_b32 v121, 0
    v_mov_b32 v122, 0
    v_mov_b32 v123, 0
    v_mov_b32 v124, 0
    v_mov_b32 v125, 0
    v_mov_b32 v126, 0
    v_mov_b32 v127, 0
    s_add_u32 s3, s87, 128
    s_and_b32 s3, s3, 511
    s_or_b32 s3, s3, 1536
    s_mul_i32 s28, s3, 3072
    s_add_u32 m0, s30, 40960
    s_nop 0
    buffer_load_dwordx4 v8, s[40:43], s3 offen offset:0 lds
    buffer_load_dwordx4 v9, s[40:43], s3 offen offset:1024 lds
    buffer_load_dwordx4 v10, s[40:43], s3 offen offset:2048 lds
    buffer_load_dwordx4 v11, s[40:43], s3 offen offset:3072 lds
    s_add_u32 m0, s31, 40960
    s_nop 0
    buffer_load_dwordx4 v12, s[44:47], s28 offen offset:0 lds
    buffer_load_dwordx4 v13, s[44:47], s28 offen offset:1024 lds
    s_add_u32 m0, s31, 49152
    s_nop 0
    buffer_load_dwordx4 v14, s[44:47], s28 offen offset:0 lds
    buffer_load_dwordx4 v15, s[44:47], s28 offen offset:1024 lds
    s_add_u32 m0, s31, 57344
    s_nop 0
    buffer_load_dwordx4 v16, s[44:47], s28 offen offset:0 lds
    buffer_load_dwordx4 v17, s[44:47], s28 offen offset:1024 lds
    s_mov_b32 s3, 0
    s_nop 0
    buffer_load_dwordx4 v[128:131], v21, s[52:55], s3 offen nt
    s_mov_b32 s3, 7168
    buffer_load_dwordx4 v[132:135], v21, s[52:55], s3 offen nt
    s_mov_b32 s3, 14336
    buffer_load_dwordx4 v[136:139], v21, s[52:55], s3 offen nt
    s_mov_b32 s3, 21504
    buffer_load_dwordx4 v[140:143], v21, s[52:55], s3 offen nt
    s_mov_b32 s3, 28672
    buffer_load_dwordx4 v[144:147], v21, s[52:55], s3 offen nt
    s_mov_b32 s3, 35840
    buffer_load_dwordx4 v[148:151], v21, s[52:55], s3 offen nt
    s_mov_b32 s3, 43008
    buffer_load_dwordx4 v[152:155], v21, s[52:55], s3 offen nt
    s_mov_b32 s3, 50176
    buffer_load_dwordx4 v[156:159], v21, s[52:55], s3 offen nt
    s_waitcnt vmcnt(18)
    s_waitcnt lgkmcnt(0)
    s_barrier
    s_add_u32 s3, s87, 256
    s_and_b32 s3, s3, 511
    s_or_b32 s3, s3, 1536
    s_mul_i32 s28, s3, 3072
    s_add_u32 m0, s30, 81920
    s_nop 0
    buffer_load_dwordx4 v8, s[40:43], s3 offen offset:0 lds
    buffer_load_dwordx4 v9, s[40:43], s3 offen offset:1024 lds
    buffer_load_dwordx4 v10, s[40:43], s3 offen offset:2048 lds
    buffer_load_dwordx4 v11, s[40:43], s3 offen offset:3072 lds
    s_add_u32 m0, s31, 81920
    s_nop 0
    buffer_load_dwordx4 v12, s[44:47], s28 offen offset:0 lds
    buffer_load_dwordx4 v13, s[44:47], s28 offen offset:1024 lds
    s_add_u32 m0, s31, 90112
    s_nop 0
    buffer_load_dwordx4 v14, s[44:47], s28 offen offset:0 lds
    buffer_load_dwordx4 v15, s[44:47], s28 offen offset:1024 lds
    s_add_u32 m0, s31, 98304
    s_nop 0
    buffer_load_dwordx4 v16, s[44:47], s28 offen offset:0 lds
    buffer_load_dwordx4 v17, s[44:47], s28 offen offset:1024 lds
    s_mul_i32 s3, s37, 12288
    s_mul_i32 s28, s38, 192
    s_add_u32 s3, s3, s28
    s_add_u32 s3, s3, 1048576
    s_add_u32 s28, s3, 6144
    buffer_load_dwordx4 v[80:83], v235, s[48:51], s3 offen offset:0 sc1
    buffer_load_dwordx4 v[84:87], v235, s[48:51], s3 offen offset:3072 sc1
    buffer_load_dwordx4 v[88:91], v235, s[48:51], s28 offen offset:0 sc1
    buffer_load_dwordx4 v[92:95], v235, s[48:51], s28 offen offset:3072 sc1
    s_waitcnt vmcnt(22)
    s_waitcnt lgkmcnt(0)
    s_barrier
    s_add_u32 s3, s87, 384
    s_and_b32 s3, s3, 511
    s_or_b32 s3, s3, 1536
    s_mul_i32 s28, s3, 3072
    s_add_u32 m0, s30, 0
    s_nop 0
    buffer_load_dwordx4 v8, s[40:43], s3 offen offset:0 lds
    buffer_load_dwordx4 v9, s[40:43], s3 offen offset:1024 lds
    buffer_load_dwordx4 v10, s[40:43], s3 offen offset:2048 lds
    buffer_load_dwordx4 v11, s[40:43], s3 offen offset:3072 lds
    s_add_u32 m0, s31, 0
    s_nop 0
    buffer_load_dwordx4 v12, s[44:47], s28 offen offset:0 lds
    buffer_load_dwordx4 v13, s[44:47], s28 offen offset:1024 lds
    s_add_u32 m0, s31, 8192
    s_nop 0
    buffer_load_dwordx4 v14, s[44:47], s28 offen offset:0 lds
    buffer_load_dwordx4 v15, s[44:47], s28 offen offset:1024 lds
    s_add_u32 m0, s31, 16384
    s_nop 0
    buffer_load_dwordx4 v16, s[44:47], s28 offen offset:0 lds
    buffer_load_dwordx4 v17, s[44:47], s28 offen offset:1024 lds
    s_waitcnt vmcnt(10)
    s_mov_b32 s29, 0
L_k2:
    s_nop 0
    v_max3_u32 v2, v80, v81, v82
    v_max3_u32 v2, v2, v83, v84
    v_max3_u32 v2, v2, v85, v86
    v_max3_u32 v2, v2, v87, v88
    v_max3_u32 v2, v2, v89, v90
    v_max3_u32 v2, v2, v91, v92
    v_max3_u32 v2, v2, v93, v94
    v_max_u32 v2, v2, v95
    v_cmp_eq_u32 vcc, -1, v2
    s_cbranch_vccz L_k2k
    s_add_u32 s29, s29, 1
    s_cmp_ge_u32 s29, 200000
    s_cbranch_scc1 L_k2k
    s_sleep 1
    s_mul_i32 s3, s37, 12288
    s_mul_i32 s28, s38, 192
    s_add_u32 s3, s3, s28
    s_nop 0
    s_add_u32 s3, s3, 1048576
    s_add_u32 s28, s3, 6144
    buffer_load_dwordx4 v[80:83], v235, s[48:51], s3 offen offset:0 sc1
    buffer_load_dwordx4 v[84:87], v235, s[48:51], s3 offen offset:3072 sc1
    buffer_load_dwordx4 v[88:91], v235, s[48:51], s28 offen offset:0 sc1
    buffer_load_dwordx4 v[92:95], v235, s[48:51], s28 offen offset:3072 sc1
    s_waitcnt vmcnt(0)
    s_branch L_k2
L_k2k:
    v_add_f32 v80, v80, v88
    v_add_f32 v81, v81, v89
    v_add_f32 v82, v82, v90
    v_add_f32 v83, v83, v91
    v_add_f32 v84, v84, v92
    v_add_f32 v85, v85, v93
    v_add_f32 v86, v86, v94
    v_add_f32 v87, v87, v95
    v_add_f32 v80, v80, v84
    v_add_f32 v81, v81, v85
    v_add_f32 v82, v82, v86
    v_add_f32 v83, v83, v87
    s_nop 0
    v_permlane32_swap_b32 v80, v82
    v_permlane32_swap_b32 v81, v83
    v_add_f32 v80, v80, v82
    v_add_f32 v81, v81, v83
    s_nop 1
    v_permlane16_swap_b32 v80, v81
    v_add_f32 v80, v80, v81
    s_waitcnt lgkmcnt(0)
    s_barrier
    s_mov_b32 s3, 57344
    buffer_load_dwordx4 v[160:163], v21, s[52:55], s3 offen nt
    s_mov_b32 s3, 64512
    buffer_load_dwordx4 v[164:167], v21, s[52:55], s3 offen nt
    s_mov_b32 s3, 71680
    buffer_load_dwordx4 v[168:171], v21, s[52:55], s3 offen nt
    s_mov_b32 s3, 78848
    buffer_load_dwordx4 v[172:175], v21, s[52:55], s3 offen nt
    s_mov_b32 s3, 86016
    buffer_load_dwordx4 v[176:179], v21, s[52:55], s3 offen nt
    s_mov_b32 s3, 93184
    buffer_load_dwordx4 v[180:183], v21, s[52:55], s3 offen nt
    s_mov_b32 s3, 100352
    buffer_load_dwordx4 v[184:187], v21, s[52:55], s3 offen nt
    s_mov_b32 s3, 107520
    buffer_load_dwordx4 v[188:191], v21, s[52:55], s3 offen nt
    v_lshlrev_b32 v2, 16, v128
    v_and_b32 v3, 0xffff0000, v128
    v_fmac_f32 v120, v2, v96
    v_fmac_f32 v121, v3, v96
    v_lshlrev_b32 v4, 16, v129
    v_and_b32 v5, 0xffff0000, v129
    v_fmac_f32 v122, v4, v96
    v_fmac_f32 v123, v5, v96
    v_lshlrev_b32 v2, 16, v130
    v_and_b32 v3, 0xffff0000, v130
    v_fmac_f32 v124, v2, v96
    v_fmac_f32 v125, v3, v96
    v_lshlrev_b32 v4, 16, v131
    v_and_b32 v5, 0xffff0000, v131
    v_fmac_f32 v126, v4, v96
    v_fmac_f32 v127, v5, v96
    v_lshlrev_b32 v2, 16, v132
    v_and_b32 v3, 0xffff0000, v132
    v_fmac_f32 v120, v2, v97
    v_fmac_f32 v121, v3, v97
    v_lshlrev_b32 v4, 16, v133
    v_and_b32 v5, 0xffff0000, v133
    v_fmac_f32 v122, v4, v97
    v_fmac_f32 v123, v5, v97
    v_lshlrev_b32 v2, 16, v134
    v_and_b32 v3, 0xffff0000, v134
    v_fmac_f32 v124, v2, v97
    v_fmac_f32 v125, v3, v97
    v_lshlrev_b32 v4, 16, v135
    v_and_b32 v5, 0xffff0000, v135
    v_fmac_f32 v126, v4, v97
    v_fmac_f32 v127, v5, v97
    v_lshlrev_b32 v2, 16, v136
    v_and_b32 v3, 0xffff0000, v136
    v_fmac_f32 v120, v2, v98
    v_fmac_f32 v121, v3, v98
    v_lshlrev_b32 v4, 16, v137
    v_and_b32 v5, 0xffff0000, v137
    v_fmac_f32 v122, v4, v98
    v_fmac_f32 v123, v5, v98
    v_lshlrev_b32 v2, 16, v138
    v_and_b32 v3, 0xffff0000, v138
    v_fmac_f32 v124, v2, v98
    v_fmac_f32 v125, v3, v98
    v_lshlrev_b32 v4, 16, v139
    v_and_b32 v5, 0xffff0000, v139
    v_fmac_f32 v126, v4, v98
    v_fmac_f32 v127, v5, v98
    ds_write_b32 v234, v224
    ds_write_b32 v230, v225
    ds_write_b32 v230, v226 offset:1024
    ds_write_b32 v233, v80
    s_mov_b32 exec_hi, 0
    ds_write_b32 v230, v227 offset:2048
    ds_write_b16_d16_hi v231, v228
    s_mov_b64 exec, -1
    s_waitcnt lgkmcnt(0)
    s_waitcnt vmcnt(8)
    s_waitcnt lgkmcnt(0)
    s_barrier
    v_lshlrev_b32 v2, 16, v140
    v_and_b32 v3, 0xffff0000, v140
    v_fmac_f32 v120, v2, v99
    v_fmac_f32 v121, v3, v99
    v_lshlrev_b32 v4, 16, v141
    v_and_b32 v5, 0xffff0000, v141
    v_fmac_f32 v122, v4, v99
    v_fmac_f32 v123, v5, v99
    v_lshlrev_b32 v2, 16, v142
    v_and_b32 v3, 0xffff0000, v142
    v_fmac_f32 v124, v2, v99
    v_fmac_f32 v125, v3, v99
    v_lshlrev_b32 v4, 16, v143
    v_and_b32 v5, 0xffff0000, v143
    v_fmac_f32 v126, v4, v99
    v_fmac_f32 v127, v5, v99
    v_lshlrev_b32 v2, 16, v144
    v_and_b32 v3, 0xffff0000, v144
    v_fmac_f32 v120, v2, v100
    v_fmac_f32 v121, v3, v100
    v_lshlrev_b32 v4, 16, v145
    v_and_b32 v5, 0xffff0000, v145
    v_fmac_f32 v122, v4, v100
    v_fmac_f32 v123, v5, v100
    v_lshlrev_b32 v2, 16, v146
    v_and_b32 v3, 0xffff0000, v146
    v_fmac_f32 v124, v2, v100
    v_fmac_f32 v125, v3, v100
    v_lshlrev_b32 v4, 16, v147
    v_and_b32 v5, 0xffff0000, v147
    v_fmac_f32 v126, v4, v100
    v_fmac_f32 v127, v5, v100
    v_lshlrev_b32 v2, 16, v148
    v_and_b32 v3, 0xffff0000, v148
    v_fmac_f32 v120, v2, v101
    v_fmac_f32 v121, v3, v101
    v_lshlrev_b32 v4, 16, v149
    v_and_b32 v5, 0xffff0000, v149
    v_fmac_f32 v122, v4, v101
    v_fmac_f32 v123, v5, v101
    v_lshlrev_b32 v2, 16, v150
    v_and_b32 v3, 0xffff0000, v150
    v_fmac_f32 v124, v2, v101
    v_fmac_f32 v125, v3, v101
    v_lshlrev_b32 v4, 16, v151
    v_and_b32 v5, 0xffff0000, v151
    v_fmac_f32 v126, v4, v101
    v_fmac_f32 v127, v5, v101
    v_lshlrev_b32 v2, 16, v152
    v_and_b32 v3, 0xffff0000, v152
    v_fmac_f32 v120, v2, v102
    v_fmac_f32 v121, v3, v102
    v_lshlrev_b32 v4, 16, v153
    v_and_b32 v5, 0xffff0000, v153
    v_fmac_f32 v122, v4, v102
    v_fmac_f32 v123, v5, v102
    v_lshlrev_b32 v2, 16, v154
    v_and_b32 v3, 0xffff0000, v154
    v_fmac_f32 v124, v2, v102
    v_fmac_f32 v125, v3, v102
    v_lshlrev_b32 v4, 16, v155
    v_and_b32 v5, 0xffff0000, v155
    v_fmac_f32 v126, v4, v102
    v_fmac_f32 v127, v5, v102
    v_lshlrev_b32 v2, 16, v156
    v_and_b32 v3, 0xffff0000, v156
    v_fmac_f32 v120, v2, v103
    v_fmac_f32 v121, v3, v103
    v_lshlrev_b32 v4, 16, v157
    v_and_b32 v5, 0xffff0000, v157
    v_fmac_f32 v122, v4, v103
    v_fmac_f32 v123, v5, v103
    v_lshlrev_b32 v2, 16, v158
    v_and_b32 v3, 0xffff0000, v158
    v_fmac_f32 v124, v2, v103
    v_fmac_f32 v125, v3, v103
    v_lshlrev_b32 v4, 16, v159
    v_and_b32 v5, 0xffff0000, v159
    v_fmac_f32 v126, v4, v103
    v_fmac_f32 v127, v5, v103
    s_barrier
    v_and_b32 v2, 15, v1
    v_min_u32 v2, 13, v2
    v_lshrrev_b32 v3, 4, v1
    v_mul_u32_u24 v3, 14336, v3
    v_lshl_add_u32 v13, v2, 4, v3
    s_lshl_b32 s75, s71, 2
    s_add_u32 s75, s75, 1380352
    s_add_u32 m0, s72, 0
    s_add_u32 s3, s73, 0
    s_nop 0
    buffer_load_dwordx4 v220, s[88:91], s3 offen offset:0 lds
    buffer_load_dwordx4 v221, s[88:91], s3 offen offset:1024 lds
    buffer_load_dwordx4 v222, s[88:91], s3 offen offset:2048 lds
    buffer_load_dwordx4 v223, s[88:91], s3 offen offset:3072 lds
    s_add_u32 m0, s72, 16384
    s_add_u32 s3, s73, 262144
    buffer_load_dwordx4 v220, s[88:91], s3 offen offset:0 lds
    buffer_load_dwordx4 v221, s[88:91], s3 offen offset:1024 lds
    buffer_load_dwordx4 v222, s[88:91], s3 offen offset:2048 lds
    buffer_load_dwordx4 v223, s[88:91], s3 offen offset:3072 lds
    s_add_u32 m0, s72, 65536
    s_add_u32 s3, s73, 1048576
    buffer_load_dwordx4 v220, s[88:91], s3 offen offset:0 lds
    buffer_load_dwordx4 v221, s[88:91], s3 offen offset:1024 lds
    buffer_load_dwordx4 v222, s[88:91], s3 offen offset:2048 lds
    buffer_load_dwordx4 v223, s[88:91], s3 offen offset:3072 lds
    s_lshl_b32 s3, s38, 1
    s_lshr_b32 s28, s39, 2
    s_add_u32 s3, s3, s28
    s_lshl_b32 s69, s3, 4
    s_lshl_b32 s3, s34, 7
    s_add_u32 s3, s3, s69
    v_and_b32 v2, 15, v1
    v_add_u32 v23, s3, v2
    v_lshlrev_b32 v23, 11, v23
    v_lshrrev_b32 v2, 4, v1
    v_lshl_add_u32 v23, v2, 3, v23
    s_lshl_b32 s3, s35, 7
    v_add_u32 v23, s3, v23
    buffer_load_dwordx2 v[240:241], v23, s[40:43], 0 offen offset:0
    buffer_load_dwordx2 v[242:243], v23, s[40:43], 0 offen offset:32
    buffer_load_dwordx2 v[244:245], v23, s[40:43], 0 offen offset:64
    buffer_load_dwordx2 v[246:247], v23, s[40:43], 0 offen offset:96
    s_lshr_b32 s3, s71, 3
    s_add_u32 s3, s3, 0
    s_and_b32 s28, s3, 7
    s_lshr_b32 s3, s3, 3
    s_lshl_b32 s3, s3, 6
    s_add_u32 s3, s3, s28
    s_lshl_b32 s3, s3, 11
    buffer_load_dwordx4 v[192:195], v22, s[56:59], s3 offen nt
    s_lshr_b32 s3, s71, 3
    s_add_u32 s3, s3, 1
    s_and_b32 s28, s3, 7
    s_lshr_b32 s3, s3, 3
    s_lshl_b32 s3, s3, 6
    s_add_u32 s3, s3, s28
    s_lshl_b32 s3, s3, 11
    buffer_load_dwordx4 v[196:199], v22, s[56:59], s3 offen nt
    s_lshr_b32 s3, s71, 3
    s_add_u32 s3, s3, 2
    s_and_b32 s28, s3, 7
    s_lshr_b32 s3, s3, 3
    s_lshl_b32 s3, s3, 6
    s_add_u32 s3, s3, s28
    s_lshl_b32 s3, s3, 11
    buffer_load_dwordx4 v[200:203], v22, s[56:59], s3 offen nt
    s_lshr_b32 s3, s71, 3
    s_add_u32 s3, s3, 3
    s_and_b32 s28, s3, 7
    s_lshr_b32 s3, s3, 3
    s_lshl_b32 s3, s3, 6
    s_add_u32 s3, s3, s28
    s_lshl_b32 s3, s3, 11
    buffer_load_dwordx4 v[204:207], v22, s[56:59], s3 offen nt
    s_lshr_b32 s3, s71, 3
    s_add_u32 s3, s3, 4
    s_and_b32 s28, s3, 7
    s_lshr_b32 s3, s3, 3
    s_lshl_b32 s3, s3, 6
    s_add_u32 s3, s3, s28
    s_lshl_b32 s3, s3, 11
    buffer_load_dwordx4 v[208:211], v22, s[56:59], s3 offen nt
    s_lshr_b32 s3, s71, 3
    s_add_u32 s3, s3, 5
    s_and_b32 s28, s3, 7
    s_lshr_b32 s3, s3, 3
    s_lshl_b32 s3, s3, 6
    s_add_u32 s3, s3, s28
    s_lshl_b32 s3, s3, 11
    buffer_load_dwordx4 v[212:215], v22, s[56:59], s3 offen nt
    s_lshr_b32 s3, s71, 3
    s_add_u32 s3, s3, 6
    s_and_b32 s28, s3, 7
    s_lshr_b32 s3, s3, 3
    s_lshl_b32 s3, s3, 6
    s_add_u32 s3, s3, s28
    s_lshl_b32 s3, s3, 11
    buffer_load_dwordx4 v[216:219], v22, s[56:59], s3 offen nt
    s_waitcnt vmcnt(19)
    s_waitcnt vmcnt(15)
    s_waitcnt vmcnt(11)
    s_barrier
    s_setprio 3
    s_cmp_lg_u32 s38, 3
    s_cbranch_scc1 L_npl
    s_mov_b32 s3, 32768
    s_mov_b32 s29, 0
    s_mov_b32 exec_lo, -1
    s_mov_b32 exec_hi, 65535
L_rp:
    buffer_load_dword v118, v113, s[48:51], s3 offen sc1
    s_waitcnt vmcnt(0)
    v_cmp_ne_u32 vcc, s86, v118
    s_cbranch_vccz L_rpk
    s_mov_b64 exec, vcc
    s_add_u32 s29, s29, 1
    s_cmp_lt_u32 s29, 200000
    s_cbranch_scc1 L_rp
L_rpk:
    s_mov_b64 exec, -1
    v_mov_b32 v4, 162128
    v_mov_b32 v5, 1
    ds_write_b32 v4, v5
L_npl:
    v_min_u32 v3, 4, v1
    v_lshlrev_b32 v3, 2, v3
    v_add_u32 v3, 162112, v3
L_fw:
    ds_read_b32 v4, v3
    s_waitcnt lgkmcnt(0)
    v_cmp_eq_u32 vcc, 0, v4
    s_cbranch_vccz L_fk
    s_sleep 1
    s_branch L_fw
L_fk:
    v_lshlrev_b32 v2, 16, v160
    v_and_b32 v3, 0xffff0000, v160
    v_pk_fma_f32 v[120:121], v[2:3], v[104:105], v[120:121] op_sel_hi:[1,0,1]
    v_lshlrev_b32_e64 v4, 16, v161
    v_and_b32 v5, 0xffff0000, v161
    v_pk_fma_f32 v[122:123], v[4:5], v[104:105], v[122:123] op_sel_hi:[1,0,1]
    v_lshlrev_b32_e64 v2, 16, v162
    v_and_b32 v3, 0xffff0000, v162
    v_pk_fma_f32 v[124:125], v[2:3], v[104:105], v[124:125] op_sel_hi:[1,0,1]
    v_lshlrev_b32_e64 v4, 16, v163
    v_and_b32 v5, 0xffff0000, v163
    v_pk_fma_f32 v[126:127], v[4:5], v[104:105], v[126:127] op_sel_hi:[1,0,1]
    v_lshlrev_b32 v2, 16, v164
    v_and_b32 v3, 0xffff0000, v164
    v_mov_b32 v104, v105
    v_pk_fma_f32 v[120:121], v[2:3], v[104:105], v[120:121] op_sel_hi:[1,0,1]
    v_lshlrev_b32_e64 v4, 16, v165
    v_and_b32 v5, 0xffff0000, v165
    v_pk_fma_f32 v[122:123], v[4:5], v[104:105], v[122:123] op_sel_hi:[1,0,1]
    v_lshlrev_b32_e64 v2, 16, v166
    v_and_b32 v3, 0xffff0000, v166
    v_pk_fma_f32 v[124:125], v[2:3], v[104:105], v[124:125] op_sel_hi:[1,0,1]
    v_lshlrev_b32_e64 v4, 16, v167
    v_and_b32 v5, 0xffff0000, v167
    v_pk_fma_f32 v[126:127], v[4:5], v[104:105], v[126:127] op_sel_hi:[1,0,1]
    v_lshlrev_b32_e64 v2, 16, v168
    v_and_b32 v3, 0xffff0000, v168
    v_pk_fma_f32 v[120:121], v[2:3], v[106:107], v[120:121] op_sel_hi:[1,0,1]
    v_lshlrev_b32_e64 v4, 16, v169
    v_and_b32 v5, 0xffff0000, v169
    v_pk_fma_f32 v[122:123], v[4:5], v[106:107], v[122:123] op_sel_hi:[1,0,1]
    v_lshlrev_b32_e64 v2, 16, v170
    v_and_b32 v3, 0xffff0000, v170
    v_pk_fma_f32 v[124:125], v[2:3], v[106:107], v[124:125] op_sel_hi:[1,0,1]
    v_lshlrev_b32_e64 v4, 16, v171
    v_and_b32 v5, 0xffff0000, v171
    v_pk_fma_f32 v[126:127], v[4:5], v[106:107], v[126:127] op_sel_hi:[1,0,1]
    s_add_u32 s3, s76, 0
    buffer_load_dwordx4 v[48:51], v112, s[48:51], s3 offen sc1
    s_add_u32 s3, s76, 33792
    buffer_load_dwordx4 v[52:55], v112, s[48:51], s3 offen sc1
    s_cmp_lg_u32 s83, 0
    s_cbranch_scc1 L_nz
    s_add_u32 s3, s81, 0
    buffer_load_dwordx4 v[32:35], v112, s[48:51], s3 offen sc1
    s_add_u32 s3, s81, 33792
    buffer_load_dwordx4 v[36:39], v112, s[48:51], s3 offen sc1
L_nz:
    v_lshlrev_b32 v2, 16, v172
    v_and_b32 v3, 0xffff0000, v172
    v_mov_b32 v106, v107
    v_pk_fma_f32 v[120:121], v[2:3], v[106:107], v[120:121] op_sel_hi:[1,0,1]
    v_lshlrev_b32_e64 v4, 16, v173
    v_and_b32 v5, 0xffff0000, v173
    v_pk_fma_f32 v[122:123], v[4:5], v[106:107], v[122:123] op_sel_hi:[1,0,1]
    v_lshlrev_b32_e64 v2, 16, v174
    v_and_b32 v3, 0xffff0000, v174
    v_pk_fma_f32 v[124:125], v[2:3], v[106:107], v[124:125] op_sel_hi:[1,0,1]
    v_lshlrev_b32_e64 v4, 16, v175
    v_and_b32 v5, 0xffff0000, v175
    v_pk_fma_f32 v[126:127], v[4:5], v[106:107], v[126:127] op_sel_hi:[1,0,1]
    v_lshlrev_b32_e64 v2, 16, v176
    v_and_b32 v3, 0xffff0000, v176
    v_pk_fma_f32 v[120:121], v[2:3], v[108:109], v[120:121] op_sel_hi:[1,0,1]
    v_lshlrev_b32_e64 v4, 16, v177
    v_and_b32 v5, 0xffff0000, v177
    v_pk_fma_f32 v[122:123], v[4:5], v[108:109], v[122:123] op_sel_hi:[1,0,1]
    v_lshlrev_b32_e64 v2, 16, v178
    v_and_b32 v3, 0xffff0000, v178
    v_pk_fma_f32 v[124:125], v[2:3], v[108:109], v[124:125] op_sel_hi:[1,0,1]
    v_lshlrev_b32_e64 v4, 16, v179
    v_and_b32 v5, 0xffff0000, v179
    v_pk_fma_f32 v[126:127], v[4:5], v[108:109], v[126:127] op_sel_hi:[1,0,1]
    v_lshlrev_b32 v2, 16, v180
    v_and_b32 v3, 0xffff0000, v180
    v_mov_b32 v108, v109
    v_pk_fma_f32 v[120:121], v[2:3], v[108:109], v[120:121] op_sel_hi:[1,0,1]
    v_lshlrev_b32_e64 v4, 16, v181
    v_and_b32 v5, 0xffff0000, v181
    v_pk_fma_f32 v[122:123], v[4:5], v[108:109], v[122:123] op_sel_hi:[1,0,1]
    v_lshlrev_b32_e64 v2, 16, v182
    v_and_b32 v3, 0xffff0000, v182
    v_pk_fma_f32 v[124:125], v[2:3], v[108:109], v[124:125] op_sel_hi:[1,0,1]
    v_lshlrev_b32_e64 v4, 16, v183
    v_and_b32 v5, 0xffff0000, v183
    v_pk_fma_f32 v[126:127], v[4:5], v[108:109], v[126:127] op_sel_hi:[1,0,1]
    v_lshlrev_b32_e64 v2, 16, v184
    v_and_b32 v3, 0xffff0000, v184
    v_pk_fma_f32 v[120:121], v[2:3], v[110:111], v[120:121] op_sel_hi:[1,0,1]
    v_lshlrev_b32_e64 v4, 16, v185
    v_and_b32 v5, 0xffff0000, v185
    v_pk_fma_f32 v[122:123], v[4:5], v[110:111], v[122:123] op_sel_hi:[1,0,1]
    v_lshlrev_b32_e64 v2, 16, v186
    v_and_b32 v3, 0xffff0000, v186
    v_pk_fma_f32 v[124:125], v[2:3], v[110:111], v[124:125] op_sel_hi:[1,0,1]
    v_lshlrev_b32_e64 v4, 16, v187
    v_and_b32 v5, 0xffff0000, v187
    v_pk_fma_f32 v[126:127], v[4:5], v[110:111], v[126:127] op_sel_hi:[1,0,1]
    v_lshlrev_b32 v2, 16, v188
    v_and_b32 v3, 0xffff0000, v188
    v_mov_b32 v110, v111
    v_pk_fma_f32 v[120:121], v[2:3], v[110:111], v[120:121] op_sel_hi:[1,0,1]
    v_lshlrev_b32_e64 v4, 16, v189
    v_and_b32 v5, 0xffff0000, v189
    v_pk_fma_f32 v[122:123], v[4:5], v[110:111], v[122:123] op_sel_hi:[1,0,1]
    v_lshlrev_b32_e64 v2, 16, v190
    v_and_b32 v3, 0xffff0000, v190
    v_pk_fma_f32 v[124:125], v[2:3], v[110:111], v[124:125] op_sel_hi:[1,0,1]
    v_lshlrev_b32_e64 v4, 16, v191
    v_and_b32 v5, 0xffff0000, v191
    v_pk_fma_f32 v[126:127], v[4:5], v[110:111], v[126:127] op_sel_hi:[1,0,1]
    v_permlane32_swap_b32 v120, v124
    v_permlane32_swap_b32 v121, v125
    v_permlane32_swap_b32 v122, v126
    v_permlane32_swap_b32 v123, v127
    v_add_f32 v120, v120, v124
    v_add_f32 v121, v121, v125
    v_add_f32 v122, v122, v126
    v_add_f32 v123, v123, v127
    s_nop 0
    v_permlane16_swap_b32 v120, v122
    v_permlane16_swap_b32 v121, v123
    v_add_f32 v120, v120, v122
    v_add_f32 v121, v121, v123
    s_nop 0
    v_add_f32 v120, v120, v120 row_ror:8 row_mask:0xf bank_mask:0xf
    v_add_f32 v121, v121, v121 row_ror:8 row_mask:0xf bank_mask:0xf
    v_and_b32 v2, 8, v1
    v_cmp_eq_u32 vcc, 0, v2
    s_nop 1
    v_cndmask_b32 v120, v121, v120, vcc
    buffer_store_dword v120, v253, s[48:51], s84 offen sc1
    s_waitcnt vmcnt(1)
    s_cmp_eq_u32 s83, 0
    s_cbranch_scc1 L_hz
    s_mov_b32 s29, 0
L_k4:
    v_max3_u32 v2, v48, v49, v50
    v_max3_u32 v2, v2, v51, v52
    v_max3_u32 v2, v2, v53, v54
    v_max_u32 v2, v2, v55
    v_cmp_eq_u32 vcc, -1, v2
    s_cbranch_vccz L_k4k
    s_add_u32 s29, s29, 1
    s_cmp_ge_u32 s29, 200000
    s_cbranch_scc1 L_k4k
    s_sleep 1
    s_add_u32 s3, s76, 0
    buffer_load_dwordx4 v[48:51], v112, s[48:51], s3 offen sc1
    s_add_u32 s3, s76, 33792
    buffer_load_dwordx4 v[52:55], v112, s[48:51], s3 offen sc1
    s_waitcnt vmcnt(0)
    s_branch L_k4
L_k4k:
    v_lshlrev_b32 v64, 16, v48
    v_and_b32 v65, 0xffff0000, v48
    v_lshlrev_b32 v66, 16, v49
    v_and_b32 v67, 0xffff0000, v49
    v_lshlrev_b32 v68, 16, v50
    v_and_b32 v69, 0xffff0000, v50
    v_lshlrev_b32 v70, 16, v51
    v_and_b32 v71, 0xffff0000, v51
    v_lshlrev_b32 v72, 16, v52
    v_and_b32 v73, 0xffff0000, v52
    v_pk_add_f32 v[64:65], v[64:65], v[72:73]
    v_lshlrev_b32_e64 v74, 16, v53
    v_and_b32 v75, 0xffff0000, v53
    v_pk_add_f32 v[66:67], v[66:67], v[74:75]
    v_lshlrev_b32_e64 v76, 16, v54
    v_and_b32 v77, 0xffff0000, v54
    v_pk_add_f32 v[68:69], v[68:69], v[76:77]
    v_lshlrev_b32_e64 v78, 16, v55
    v_and_b32 v79, 0xffff0000, v55
    v_pk_add_f32 v[70:71], v[70:71], v[78:79]
    v_permlane32_swap_b32 v64, v68
    v_permlane32_swap_b32 v65, v69
    v_permlane32_swap_b32 v66, v70
    v_permlane32_swap_b32 v67, v71
    v_add_f32 v64, v64, v68
    v_add_f32 v65, v65, v69
    v_add_f32 v66, v66, v70
    v_add_f32 v67, v67, v71
    s_nop 0
    v_permlane16_swap_b32 v64, v66
    v_permlane16_swap_b32 v65, v67
    v_add_f32 v64, v64, v66
    v_add_f32 v65, v65, v67
    s_nop 0
    v_add_f32 v64, v64, v64 row_ror:8 row_mask:0xf bank_mask:0xf
    v_add_f32 v65, v65, v65 row_ror:8 row_mask:0xf bank_mask:0xf
    v_cvt_pk_bf16_f32 v64, v64, v65
    v_mov_b32 v65, v64
    s_nop 1
    v_permlane16_swap_b32 v64, v65
    v_mov_b32 v66, v64
    v_mov_b32 v67, v65
    s_nop 0
    v_permlane32_swap_b32 v64, v66
    v_permlane32_swap_b32 v65, v67
    s_mov_b64 exec, 0xff
    buffer_store_dwordx4 v[64:67], v252, s[48:51], s74 offen sc1
    s_branch L_h1e
L_hz:
    s_mov_b32 s29, 0
L_k3:
    v_max3_u32 v2, v48, v49, v50
    v_max3_u32 v2, v2, v51, v52
    v_max3_u32 v2, v2, v53, v54
    v_max3_u32 v2, v2, v55, v32
    v_max3_u32 v2, v2, v33, v34
    v_max3_u32 v2, v2, v35, v36
    v_max3_u32 v2, v2, v37, v38
    v_max_u32 v2, v2, v39
    v_cmp_eq_u32 vcc, -1, v2
    s_cbranch_vccz L_k3k
    s_add_u32 s29, s29, 1
    s_cmp_ge_u32 s29, 200000
    s_cbranch_scc1 L_k3k
    s_sleep 1
    s_add_u32 s3, s76, 0
    buffer_load_dwordx4 v[48:51], v112, s[48:51], s3 offen sc1
    s_add_u32 s3, s76, 33792
    buffer_load_dwordx4 v[52:55], v112, s[48:51], s3 offen sc1
    s_add_u32 s3, s81, 0
    buffer_load_dwordx4 v[32:35], v112, s[48:51], s3 offen sc1
    s_add_u32 s3, s81, 33792
    buffer_load_dwordx4 v[36:39], v112, s[48:51], s3 offen sc1
    s_waitcnt vmcnt(0)
    s_branch L_k3
L_k3k:
    v_lshlrev_b32 v64, 16, v48
    v_lshlrev_b32 v96, 16, v32
    v_and_b32 v65, 0xffff0000, v48
    v_and_b32 v97, 0xffff0000, v32
    v_lshlrev_b32 v66, 16, v49
    v_lshlrev_b32 v98, 16, v33
    v_and_b32 v67, 0xffff0000, v49
    v_and_b32 v99, 0xffff0000, v33
    v_lshlrev_b32 v68, 16, v50
    v_lshlrev_b32 v100, 16, v34
    v_and_b32 v69, 0xffff0000, v50
    v_and_b32 v101, 0xffff0000, v34
    v_lshlrev_b32 v70, 16, v51
    v_lshlrev_b32 v102, 16, v35
    v_and_b32 v71, 0xffff0000, v51
    v_and_b32 v103, 0xffff0000, v35
    v_lshlrev_b32 v72, 16, v52
    v_lshlrev_b32 v104, 16, v36
    v_and_b32 v73, 0xffff0000, v52
    v_and_b32 v105, 0xffff0000, v36
    v_pk_add_f32 v[64:65], v[64:65], v[72:73]
    v_pk_add_f32 v[96:97], v[96:97], v[104:105]
    v_lshlrev_b32 v74, 16, v53
    v_lshlrev_b32 v106, 16, v37
    v_and_b32 v75, 0xffff0000, v53
    v_and_b32 v107, 0xffff0000, v37
    v_pk_add_f32 v[66:67], v[66:67], v[74:75]
    v_pk_add_f32 v[98:99], v[98:99], v[106:107]
    v_lshlrev_b32 v76, 16, v54
    v_lshlrev_b32 v108, 16, v38
    v_and_b32 v77, 0xffff0000, v54
    v_and_b32 v109, 0xffff0000, v38
    v_pk_add_f32 v[68:69], v[68:69], v[76:77]
    v_pk_add_f32 v[100:101], v[100:101], v[108:109]
    v_lshlrev_b32 v78, 16, v55
    v_lshlrev_b32 v110, 16, v39
    v_and_b32 v79, 0xffff0000, v55
    v_and_b32 v111, 0xffff0000, v39
    v_pk_add_f32 v[70:71], v[70:71], v[78:79]
    v_pk_add_f32 v[102:103], v[102:103], v[110:111]
    v_permlane32_swap_b32 v64, v68
    v_permlane32_swap_b32 v96, v100
    v_permlane32_swap_b32 v65, v69
    v_permlane32_swap_b32 v97, v101
    v_permlane32_swap_b32 v66, v70
    v_permlane32_swap_b32 v98, v102
    v_permlane32_swap_b32 v67, v71
    v_permlane32_swap_b32 v99, v103
    v_add_f32 v64, v64, v68
    v_add_f32 v96, v96, v100
    v_add_f32 v65, v65, v69
    v_add_f32 v97, v97, v101
    v_add_f32 v66, v66, v70
    v_add_f32 v98, v98, v102
    v_add_f32 v67, v67, v71
    v_add_f32 v99, v99, v103
    v_permlane16_swap_b32 v64, v66
    v_permlane16_swap_b32 v96, v98
    v_permlane16_swap_b32 v65, v67
    v_permlane16_swap_b32 v97, v99
    v_add_f32 v64, v64, v66
    v_add_f32 v96, v96, v98
    v_add_f32 v65, v65, v67
    v_add_f32 v97, v97, v99
    v_add_f32 v64, v64, v64 row_ror:8 row_mask:0xf bank_mask:0xf
    v_add_f32 v96, v96, v96 row_ror:8 row_mask:0xf bank_mask:0xf
    v_add_f32 v65, v65, v65 row_ror:8 row_mask:0xf bank_mask:0xf
    v_add_f32 v97, v97, v97 row_ror:8 row_mask:0xf bank_mask:0xf
    v_cvt_pk_bf16_f32 v64, v64, v65
    v_cvt_pk_bf16_f32 v96, v96, v97
    v_mov_b32 v65, v64
    v_mov_b32 v97, v96
    s_nop 0
    v_permlane16_swap_b32 v64, v65
    v_permlane16_swap_b32 v96, v97
    v_mov_b32 v66, v64
    v_mov_b32 v98, v96
    v_mov_b32 v67, v65
    v_mov_b32 v99, v97
    v_permlane32_swap_b32 v64, v66
    v_permlane32_swap_b32 v96, v98
    v_permlane32_swap_b32 v65, v67
    v_permlane32_swap_b32_e64 v97, v99
    s_mov_b64 exec, 0xff
    buffer_store_dwordx4 v[64:67], v252, s[48:51], s74 offen sc1
    buffer_store_dwordx4 v[96:99], v252, s[48:51], s82 offen sc1
L_h1e:
    s_mov_b64 exec, -1
    s_lshl_b32 s3, s38, 2
    s_add_u32 s3, s3, 162112
    v_mov_b32 v4, s3
    v_mov_b32 v5, 3
    ds_write_b32 v4, v5
    s_setprio 0
    s_waitcnt lgkmcnt(0)
    s_add_u32 m0, s72, 81920
    s_add_u32 s3, s73, 1310720
    buffer_load_dwordx4 v220, s[88:91], s3 offen offset:0 lds
    buffer_load_dwordx4 v221, s[88:91], s3 offen offset:1024 lds
    buffer_load_dwordx4 v222, s[88:91], s3 offen offset:2048 lds
    buffer_load_dwordx4 v223, s[88:91], s3 offen offset:3072 lds
    s_add_u32 m0, s72, 32768
    s_add_u32 s3, s73, 524288
    buffer_load_dwordx4 v220, s[88:91], s3 offen offset:0 lds
    buffer_load_dwordx4 v221, s[88:91], s3 offen offset:1024 lds
    buffer_load_dwordx4 v222, s[88:91], s3 offen offset:2048 lds
    buffer_load_dwordx4 v223, s[88:91], s3 offen offset:3072 lds
    v_and_b32 v2, 15, v1
    v_add_u32 v2, s69, v2
    v_lshlrev_b32_e64 v2, 2, v2
    v_add_u32 v2, 152576, v2
    ds_read_b32 v9, v2
    ds_read_b32 v8, v2 offset:1024
    s_waitcnt lgkmcnt(0)
    v_mul_f32 v28, v9, v8
    v_mov_b32 v30, 0xbfb8aa3b
    v_lshlrev_b32 v224, 16, v240
    v_and_b32 v225, 0xffff0000, v240
    v_lshlrev_b32 v226, 16, v241
    v_and_b32 v227, 0xffff0000, v241
    v_lshlrev_b32 v228, 16, v242
    v_and_b32 v229, 0xffff0000, v242
    v_lshlrev_b32 v230, 16, v243
    v_and_b32 v231, 0xffff0000, v243
    v_lshlrev_b32 v232, 16, v244
    v_and_b32 v233, 0xffff0000, v244
    v_lshlrev_b32 v234, 16, v245
    v_and_b32 v235, 0xffff0000, v245
    v_lshlrev_b32 v236, 16, v246
    v_and_b32 v237, 0xffff0000, v246
    v_lshlrev_b32 v238, 16, v247
    v_and_b32 v239, 0xffff0000, v247
    v_pk_fma_f32 v[224:225], v[224:225], v[8:9], v[28:29] op_sel_hi:[1,0,0] neg_lo:[0,0,1] neg_hi:[0,0,1]
    v_pk_fma_f32 v[226:227], v[226:227], v[8:9], v[28:29] op_sel_hi:[1,0,0] neg_lo:[0,0,1] neg_hi:[0,0,1]
    v_pk_fma_f32 v[228:229], v[228:229], v[8:9], v[28:29] op_sel_hi:[1,0,0] neg_lo:[0,0,1] neg_hi:[0,0,1]
    v_pk_fma_f32 v[230:231], v[230:231], v[8:9], v[28:29] op_sel_hi:[1,0,0] neg_lo:[0,0,1] neg_hi:[0,0,1]
    v_pk_fma_f32 v[232:233], v[232:233], v[8:9], v[28:29] op_sel_hi:[1,0,0] neg_lo:[0,0,1] neg_hi:[0,0,1]
    v_pk_fma_f32 v[234:235], v[234:235], v[8:9], v[28:29] op_sel_hi:[1,0,0] neg_lo:[0,0,1] neg_hi:[0,0,1]
    v_pk_fma_f32 v[236:237], v[236:237], v[8:9], v[28:29] op_sel_hi:[1,0,0] neg_lo:[0,0,1] neg_hi:[0,0,1]
    v_pk_fma_f32 v[238:239], v[238:239], v[8:9], v[28:29] op_sel_hi:[1,0,0] neg_lo:[0,0,1] neg_hi:[0,0,1]
    v_pk_mul_f32 v[32:33], v[224:225], v[30:31] op_sel_hi:[1,0]
    v_pk_mul_f32 v[34:35], v[226:227], v[30:31] op_sel_hi:[1,0]
    v_pk_mul_f32 v[36:37], v[228:229], v[30:31] op_sel_hi:[1,0]
    v_pk_mul_f32 v[38:39], v[230:231], v[30:31] op_sel_hi:[1,0]
    v_pk_mul_f32 v[40:41], v[232:233], v[30:31] op_sel_hi:[1,0]
    v_pk_mul_f32 v[42:43], v[234:235], v[30:31] op_sel_hi:[1,0]
    v_pk_mul_f32 v[44:45], v[236:237], v[30:31] op_sel_hi:[1,0]
    v_pk_mul_f32 v[46:47], v[238:239], v[30:31] op_sel_hi:[1,0]
    v_exp_f32 v32, v32
    v_exp_f32 v33, v33
    v_exp_f32 v34, v34
    v_exp_f32 v35, v35
    v_exp_f32 v36, v36
    v_exp_f32 v37, v37
    v_exp_f32 v38, v38
    v_exp_f32 v39, v39
    v_exp_f32 v40, v40
    v_exp_f32 v41, v41
    v_exp_f32 v42, v42
    v_exp_f32 v43, v43
    v_exp_f32 v44, v44
    v_exp_f32 v45, v45
    v_exp_f32 v46, v46
    v_exp_f32 v47, v47
    v_pk_add_f32 v[32:33], v[32:33], 1.0 op_sel_hi:[1,0]
    v_pk_add_f32 v[34:35], v[34:35], 1.0 op_sel_hi:[1,0]
    v_pk_add_f32 v[36:37], v[36:37], 1.0 op_sel_hi:[1,0]
    v_pk_add_f32 v[38:39], v[38:39], 1.0 op_sel_hi:[1,0]
    v_pk_add_f32 v[40:41], v[40:41], 1.0 op_sel_hi:[1,0]
    v_pk_add_f32 v[42:43], v[42:43], 1.0 op_sel_hi:[1,0]
    v_pk_add_f32 v[44:45], v[44:45], 1.0 op_sel_hi:[1,0]
    v_pk_add_f32 v[46:47], v[46:47], 1.0 op_sel_hi:[1,0]
    v_rcp_f32 v32, v32
    v_rcp_f32 v33, v33
    v_rcp_f32 v34, v34
    v_rcp_f32 v35, v35
    v_rcp_f32 v36, v36
    v_rcp_f32 v37, v37
    v_rcp_f32 v38, v38
    v_rcp_f32 v39, v39
    v_rcp_f32 v40, v40
    v_rcp_f32 v41, v41
    v_rcp_f32 v42, v42
    v_rcp_f32 v43, v43
    v_rcp_f32 v44, v44
    v_rcp_f32 v45, v45
    v_rcp_f32 v46, v46
    v_rcp_f32 v47, v47
    v_pk_mul_f32 v[224:225], v[224:225], v[32:33]
    v_pk_mul_f32 v[226:227], v[226:227], v[34:35]
    v_pk_mul_f32 v[228:229], v[228:229], v[36:37]
    v_pk_mul_f32 v[230:231], v[230:231], v[38:39]
    v_pk_mul_f32 v[232:233], v[232:233], v[40:41]
    v_pk_mul_f32 v[234:235], v[234:235], v[42:43]
    v_pk_mul_f32 v[236:237], v[236:237], v[44:45]
    v_pk_mul_f32 v[238:239], v[238:239], v[46:47]
    s_add_u32 s3, s75, 0
    s_nop 0
    buffer_load_dwordx4 v[80:83], v13, s[48:51], s3 offen sc1
    s_add_u32 s3, s75, 57344
    buffer_load_dwordx4 v[84:87], v13, s[48:51], s3 offen sc1
    s_add_u32 s3, s75, 114688
    buffer_load_dwordx4 v[88:91], v13, s[48:51], s3 offen sc1
    s_add_u32 s3, s75, 172032
    buffer_load_dwordx4 v[92:95], v13, s[48:51], s3 offen sc1
    s_waitcnt vmcnt(0)
    s_mov_b32 s29, 0
L_k5:
    v_max3_u32 v2, v80, v81, v82
    v_max3_u32 v2, v2, v83, v84
    v_max3_u32 v2, v2, v85, v86
    v_max3_u32 v2, v2, v87, v88
    v_max3_u32 v2, v2, v89, v90
    v_max3_u32 v2, v2, v91, v92
    v_max3_u32 v2, v2, v93, v94
    v_max_u32 v2, v2, v95
    v_cmp_eq_u32 vcc, -1, v2
    s_cbranch_vccz L_k5k
    s_add_u32 s29, s29, 1
    s_cmp_ge_u32 s29, 200000
    s_cbranch_scc1 L_k5k
    s_sleep 1
    s_add_u32 s3, s75, 0
    s_nop 0
    buffer_load_dwordx4 v[80:83], v13, s[48:51], s3 offen sc1
    s_add_u32 s3, s75, 57344
    buffer_load_dwordx4 v[84:87], v13, s[48:51], s3 offen sc1
    s_add_u32 s3, s75, 114688
    buffer_load_dwordx4 v[88:91], v13, s[48:51], s3 offen sc1
    s_add_u32 s3, s75, 172032
    buffer_load_dwordx4 v[92:95], v13, s[48:51], s3 offen sc1
    s_waitcnt vmcnt(0)
    s_branch L_k5
L_k5k:
    v_pk_add_f32 v[80:81], v[80:81], v[84:85]
    v_pk_add_f32 v[82:83], v[82:83], v[86:87]
    v_pk_add_f32 v[88:89], v[88:89], v[92:93]
    v_pk_add_f32 v[90:91], v[90:91], v[94:95]
    s_nop 0
    v_permlane32_swap_b32 v80, v88
    v_permlane32_swap_b32 v81, v89
    v_permlane32_swap_b32 v82, v90
    v_permlane32_swap_b32 v83, v91
    v_add_f32 v80, v80, v88
    v_add_f32 v81, v81, v89
    v_add_f32 v82, v82, v90
    v_add_f32 v83, v83, v91
    v_permlane16_swap_b32 v80, v81
    s_nop 0
    v_permlane16_swap_b32 v82, v83
    v_add_f32 v80, v80, v81
    v_add_f32 v82, v82, v83
    s_nop 1
    v_permlane32_swap_b32 v80, v82
    v_cvt_pk_bf16_f32 v80, v80, v80
    v_lshlrev_b32 v80, 16, v80
    v_cvt_pk_bf16_f32 v82, v82, v82
    v_lshlrev_b32 v82, 16, v82
    v_mul_f32 v2, 0xbfb8aa3b, v80
    v_exp_f32 v2, v2
    s_nop 0
    v_add_f32 v2, 1.0, v2
    v_rcp_f32 v2, v2
    s_nop 0
    v_mul_f32 v80, v80, v2
    v_cvt_pk_bf16_f32 v80, v80, v80
    v_lshlrev_b32 v80, 16, v80
    v_mul_f32 v80, v80, v82
    v_cvt_pk_bf16_f32 v80, v80, v80
    v_lshlrev_b32 v80, 16, v80
    v_bfe_u32 v2, v1, 3, 2
    v_lshlrev_b32 v2, 6, v2
    v_lshrrev_b32_e64 v3, 5, v1
    v_lshl_add_u32 v2, v3, 2, v2
    ds_bpermute_b32 v56, v2, v80 offset:0
    ds_bpermute_b32 v58, v2, v80 offset:8
    ds_bpermute_b32 v60, v2, v80 offset:16
    ds_bpermute_b32 v62, v2, v80 offset:24
    ds_bpermute_b32 v64, v2, v80 offset:32
    ds_bpermute_b32 v66, v2, v80 offset:40
    ds_bpermute_b32 v68, v2, v80 offset:48
    v_mov_b64 v[120:121], 0
    v_mov_b64 v[122:123], 0
    v_mov_b64 v[124:125], 0
    v_mov_b64 v[126:127], 0
    s_waitcnt lgkmcnt(0)
    v_lshlrev_b32 v2, 16, v192
    v_and_b32 v3, 0xffff0000, v192
    v_pk_fma_f32 v[120:121], v[2:3], v[56:57], v[120:121] op_sel_hi:[1,0,1]
    v_lshlrev_b32_e64 v4, 16, v193
    v_and_b32 v5, 0xffff0000, v193
    v_pk_fma_f32 v[122:123], v[4:5], v[56:57], v[122:123] op_sel_hi:[1,0,1]
    v_lshlrev_b32_e64 v2, 16, v194
    v_and_b32 v3, 0xffff0000, v194
    v_pk_fma_f32 v[124:125], v[2:3], v[56:57], v[124:125] op_sel_hi:[1,0,1]
    v_lshlrev_b32_e64 v4, 16, v195
    v_and_b32 v5, 0xffff0000, v195
    v_pk_fma_f32 v[126:127], v[4:5], v[56:57], v[126:127] op_sel_hi:[1,0,1]
    v_lshlrev_b32_e64 v2, 16, v196
    v_and_b32 v3, 0xffff0000, v196
    v_pk_fma_f32 v[120:121], v[2:3], v[58:59], v[120:121] op_sel_hi:[1,0,1]
    v_lshlrev_b32_e64 v4, 16, v197
    v_and_b32 v5, 0xffff0000, v197
    v_pk_fma_f32 v[122:123], v[4:5], v[58:59], v[122:123] op_sel_hi:[1,0,1]
    v_lshlrev_b32_e64 v2, 16, v198
    v_and_b32 v3, 0xffff0000, v198
    v_pk_fma_f32 v[124:125], v[2:3], v[58:59], v[124:125] op_sel_hi:[1,0,1]
    v_lshlrev_b32_e64 v4, 16, v199
    v_and_b32 v5, 0xffff0000, v199
    v_pk_fma_f32 v[126:127], v[4:5], v[58:59], v[126:127] op_sel_hi:[1,0,1]
    v_lshlrev_b32_e64 v2, 16, v200
    v_and_b32 v3, 0xffff0000, v200
    v_pk_fma_f32 v[120:121], v[2:3], v[60:61], v[120:121] op_sel_hi:[1,0,1]
    v_lshlrev_b32_e64 v4, 16, v201
    v_and_b32 v5, 0xffff0000, v201
    v_pk_fma_f32 v[122:123], v[4:5], v[60:61], v[122:123] op_sel_hi:[1,0,1]
    v_lshlrev_b32_e64 v2, 16, v202
    v_and_b32 v3, 0xffff0000, v202
    v_pk_fma_f32 v[124:125], v[2:3], v[60:61], v[124:125] op_sel_hi:[1,0,1]
    v_lshlrev_b32_e64 v4, 16, v203
    v_and_b32 v5, 0xffff0000, v203
    v_pk_fma_f32 v[126:127], v[4:5], v[60:61], v[126:127] op_sel_hi:[1,0,1]
    v_lshlrev_b32_e64 v2, 16, v204
    v_and_b32 v3, 0xffff0000, v204
    v_pk_fma_f32 v[120:121], v[2:3], v[62:63], v[120:121] op_sel_hi:[1,0,1]
    v_lshlrev_b32_e64 v4, 16, v205
    v_and_b32 v5, 0xffff0000, v205
    v_pk_fma_f32 v[122:123], v[4:5], v[62:63], v[122:123] op_sel_hi:[1,0,1]
    v_lshlrev_b32_e64 v2, 16, v206
    v_and_b32 v3, 0xffff0000, v206
    v_pk_fma_f32 v[124:125], v[2:3], v[62:63], v[124:125] op_sel_hi:[1,0,1]
    v_lshlrev_b32_e64 v4, 16, v207
    v_and_b32 v5, 0xffff0000, v207
    v_pk_fma_f32 v[126:127], v[4:5], v[62:63], v[126:127] op_sel_hi:[1,0,1]
    v_lshlrev_b32_e64 v2, 16, v208
    v_and_b32 v3, 0xffff0000, v208
    v_pk_fma_f32 v[120:121], v[2:3], v[64:65], v[120:121] op_sel_hi:[1,0,1]
    v_lshlrev_b32_e64 v4, 16, v209
    v_and_b32 v5, 0xffff0000, v209
    v_pk_fma_f32 v[122:123], v[4:5], v[64:65], v[122:123] op_sel_hi:[1,0,1]
    v_lshlrev_b32_e64 v2, 16, v210
    v_and_b32 v3, 0xffff0000, v210
    v_pk_fma_f32 v[124:125], v[2:3], v[64:65], v[124:125] op_sel_hi:[1,0,1]
    v_lshlrev_b32_e64 v4, 16, v211
    v_and_b32 v5, 0xffff0000, v211
    v_pk_fma_f32 v[126:127], v[4:5], v[64:65], v[126:127] op_sel_hi:[1,0,1]
    v_lshlrev_b32_e64 v2, 16, v212
    v_and_b32 v3, 0xffff0000, v212
    v_pk_fma_f32 v[120:121], v[2:3], v[66:67], v[120:121] op_sel_hi:[1,0,1]
    v_lshlrev_b32_e64 v4, 16, v213
    v_and_b32 v5, 0xffff0000, v213
    v_pk_fma_f32 v[122:123], v[4:5], v[66:67], v[122:123] op_sel_hi:[1,0,1]
    v_lshlrev_b32_e64 v2, 16, v214
    v_and_b32 v3, 0xffff0000, v214
    v_pk_fma_f32 v[124:125], v[2:3], v[66:67], v[124:125] op_sel_hi:[1,0,1]
    v_lshlrev_b32_e64 v4, 16, v215
    v_and_b32 v5, 0xffff0000, v215
    v_pk_fma_f32 v[126:127], v[4:5], v[66:67], v[126:127] op_sel_hi:[1,0,1]
    v_lshlrev_b32_e64 v2, 16, v216
    v_and_b32 v3, 0xffff0000, v216
    v_pk_fma_f32 v[120:121], v[2:3], v[68:69], v[120:121] op_sel_hi:[1,0,1]
    v_lshlrev_b32_e64 v4, 16, v217
    v_and_b32 v5, 0xffff0000, v217
    v_pk_fma_f32 v[122:123], v[4:5], v[68:69], v[122:123] op_sel_hi:[1,0,1]
    v_lshlrev_b32_e64 v2, 16, v218
    v_and_b32 v3, 0xffff0000, v218
    v_pk_fma_f32 v[124:125], v[2:3], v[68:69], v[124:125] op_sel_hi:[1,0,1]
    v_lshlrev_b32_e64 v4, 16, v219
    v_and_b32 v5, 0xffff0000, v219
    v_pk_fma_f32 v[126:127], v[4:5], v[68:69], v[126:127] op_sel_hi:[1,0,1]
    v_permlane32_swap_b32 v120, v124
    v_permlane32_swap_b32 v121, v125
    v_permlane32_swap_b32 v122, v126
    v_permlane32_swap_b32 v123, v127
    v_add_f32 v120, v120, v124
    v_add_f32 v121, v121, v125
    v_add_f32 v122, v122, v126
    v_add_f32 v123, v123, v127
    s_nop 0
    v_permlane16_swap_b32 v120, v122
    v_permlane16_swap_b32 v121, v123
    v_add_f32 v120, v120, v122
    v_add_f32 v121, v121, v123
    s_nop 0
    v_add_f32 v120, v120, v120 row_ror:8 row_mask:0xf bank_mask:0xf
    v_add_f32 v121, v121, v121 row_ror:8 row_mask:0xf bank_mask:0xf
    v_and_b32 v2, 8, v1
    v_cmp_eq_u32 vcc, 0, v2
    s_and_b32 s3, s2, 15
    s_lshl_b32 s3, s3, 4
    s_lshr_b32 s28, s2, 4
    s_add_u32 s3, s3, s28
    s_lshl_b32 s3, s3, 2
    s_add_u32 s3, s3, s38
    s_lshl_b32 s3, s3, 8
    s_add_u32 s3, s3, 1609728
    v_cndmask_b32 v120, v121, v120, vcc
    buffer_store_dword v120, v253, s[48:51], s3 offen sc1
    v_and_b32 v3, 3, v1
    v_lshlrev_b32 v3, 2, v3
    v_add_u32 v3, 162112, v3
L_ow:
    ds_read_b32 v2, v3
    s_waitcnt lgkmcnt(0)
    v_cmp_ne_u32 vcc, 7, v2
    s_cbranch_vccz L_owk
    s_sleep 1
    s_branch L_ow
L_owk:
    s_sleep 4
    s_branch L_p3
L_C:
    s_and_b32 s64, s38, 1
    s_lshr_b32 s65, s38, 1
    v_and_b32 v3, 15, v1
    v_lshlrev_b32 v3, 7, v3
    s_lshl_b32 s3, s64, 13
    v_add_u32 v3, s3, v3
    v_bfe_u32 v5, v1, 1, 3
    v_lshrrev_b32 v6, 4, v1
    v_xor_b32 v6, v6, v5
    v_lshl_add_u32 v184, v6, 4, v3
    v_xor_b32 v185, 64, v184
    v_lshrrev_b32 v6, 4, v1
    v_lshlrev_b32 v6, 3, v6
    v_bfe_u32 v7, v1, 2, 2
    v_add_u32 v6, v6, v7
    v_lshlrev_b32 v6, 7, v6
    v_and_b32_e64 v7, 3, v1
    v_lshl_add_u32 v6, v7, 3, v6
    v_add_u32 v6, 16384, v6
    v_bfe_u32 v7, v1, 3, 2
    s_lshl_b32 s3, s65, 1
    v_xor_b32 v7, s3, v7
    v_lshl_add_u32 v186, v7, 5, v6
    v_xor_b32_e64 v187, 32, v186
    v_add_u32 v188, 81920, v184
    v_add_u32 v189, 81920, v185
    v_add_u32 v190, 81920, v186
    v_add_u32 v191, 81920, v187
    s_waitcnt lgkmcnt(0)
    s_mov_b32 s48, s26
    s_mov_b32 s49, s27
    s_mov_b32 s50, 268435456
    s_mov_b32 s51, 0x00020000
    s_mov_b32 s40, s4
    s_mov_b32 s41, s5
    s_mov_b32 s42, 4194304
    s_mov_b32 s43, 0x00020000
    s_mov_b32 s88, s10
    s_mov_b32 s89, s11
    s_mov_b32 s90, 2097152
    s_mov_b32 s91, 0x00020000
    s_lshl_b32 s3, s36, 7
    s_lshl_b32 s28, s37, 3
    s_add_u32 s3, s3, s28
    s_lshl_b32 s28, s38, 1
    s_add_u32 s69, s3, s28
    v_lshlrev_b32 v2, 4, v1
    v_mov_b32 v248, 16384
    v_mov_b32 v4, -1
    v_mov_b32 v5, -1
    v_mov_b32 v6, -1
    v_mov_b32 v7, -1
    s_lshl_b32 s28, s2, 2
    s_add_u32 s28, s28, s38
    s_lshl_b32 s28, s28, 10
    s_add_u32 s28, s28, 1048576
    buffer_store_dwordx4 v[4:7], v2, s[48:51], s28 offen sc1
    buffer_load_dword v248, v248, s[48:51], 0 offen sc1
    s_getpc_b64 s[92:93]
L_pc:
    s_sub_u32 s92, s92, L_pc-recurrent_scan__linear_kernel_hedgehog__moe_arch_mod__prompt_kernel
    s_subb_u32 s93, s93, 0
    s_lshr_b32 s3, s2, 3
    s_lshl_b32 s3, s3, 2
    s_add_u32 s3, s3, s38
    s_lshl_b32 s3, s3, 8
    v_lshlrev_b32 v2, 7, v1
    v_add_u32 v2, s3, v2
    s_mov_b64 exec, 3
    global_load_dword v249, v2, s[92:93]
    s_mov_b64 exec, -1
    v_mov_b64 v[8:9], 0
    v_mov_b64 v[10:11], 0
    v_mov_b64 v[12:13], 0
    v_mov_b64 v[14:15], 0
    v_mov_b64 v[16:17], 0
    v_mov_b64 v[18:19], 0
    v_mov_b64 v[20:21], 0
    v_mov_b64 v[22:23], 0
    v_mov_b64 v[24:25], 0
    v_mov_b64 v[26:27], 0
    v_mov_b64 v[28:29], 0
    v_mov_b64 v[30:31], 0
    v_mov_b64 v[32:33], 0
    v_mov_b64 v[34:35], 0
    v_mov_b64 v[36:37], 0
    v_mov_b64 v[38:39], 0
    v_mov_b64 v[40:41], 0
    v_mov_b64 v[42:43], 0
    v_mov_b64 v[44:45], 0
    v_mov_b64 v[46:47], 0
    v_mov_b64 v[48:49], 0
    v_mov_b64 v[50:51], 0
    v_mov_b64 v[52:53], 0
    v_mov_b64 v[54:55], 0
    v_mov_b64 v[56:57], 0
    v_mov_b64 v[58:59], 0
    v_mov_b64 v[60:61], 0
    v_mov_b64 v[62:63], 0
    v_mov_b64 v[64:65], 0
    v_mov_b64 v[66:67], 0
    v_mov_b64 v[68:69], 0
    v_mov_b64 v[70:71], 0
    v_mov_b64 v[72:73], 0
    v_mov_b64 v[74:75], 0
    v_mov_b64 v[76:77], 0
    v_mov_b64 v[78:79], 0
    v_mov_b64 v[80:81], 0
    v_mov_b64 v[82:83], 0
    v_mov_b64 v[84:85], 0
    v_mov_b64 v[86:87], 0
    v_mov_b64 v[88:89], 0
    v_mov_b64 v[90:91], 0
    v_mov_b64 v[92:93], 0
    v_mov_b64 v[94:95], 0
    v_mov_b64 v[96:97], 0
    v_mov_b64 v[98:99], 0
    v_mov_b64 v[100:101], 0
    v_mov_b64 v[102:103], 0
    s_lshl_b32 s3, s38, 2
    s_add_u32 s3, s3, 162112
    v_mov_b32 v2, s3
    v_mov_b32_e64 v3, 0
    ds_write_b32 v2, v3
    ds_write_b32 v2, v3 offset:16
    s_mov_b32 s86, 0
    s_mov_b32 s66, 0
    s_setprio 2
    s_waitcnt lgkmcnt(0)
    s_barrier
    s_nop 0
    ds_read_b128 v[104:107], v184 offset:0
    ds_read_b64_tr_b16 v[120:121], v186 offset:0
    ds_read_b64_tr_b16 v[122:123], v186 offset:512
    ds_read_b64_tr_b16 v[124:125], v187 offset:0
    ds_read_b64_tr_b16 v[126:127], v187 offset:512
    ds_read_b64_tr_b16 v[128:129], v186 offset:8192
    ds_read_b64_tr_b16 v[130:131], v186 offset:8704
    ds_read_b64_tr_b16 v[132:133], v187 offset:8192
    ds_read_b64_tr_b16 v[134:135], v187 offset:8704
    ds_read_b64_tr_b16 v[136:137], v186 offset:16384
    ds_read_b64_tr_b16 v[138:139], v186 offset:16896
    ds_read_b64_tr_b16 v[140:141], v187 offset:16384
    ds_read_b64_tr_b16 v[142:143], v187 offset:16896
    ds_read_b128 v[108:111], v184 offset:2048
    ds_read_b128 v[112:115], v184 offset:4096
    ds_read_b128 v[116:119], v184 offset:6144
    s_branch L_cmid
.p2align 6
L_cloop:
    s_cmp_eq_u32 s66, 1
    s_cbranch_scc1 L_ln
L_lnr:
    s_waitcnt lgkmcnt(0)
    s_barrier
    v_mfma_f32_16x16x32_bf16 v[8:11], v[160:163], v[144:147], v[8:11]
    ds_read_b128 v[104:107], v184 offset:0
    v_mfma_f32_16x16x32_bf16 v[12:15], v[164:167], v[144:147], v[12:15]
    ds_read_b64_tr_b16 v[120:121], v186 offset:0
    v_mfma_f32_16x16x32_bf16 v[16:19], v[168:171], v[144:147], v[16:19]
    ds_read_b64_tr_b16 v[122:123], v186 offset:512
    v_mfma_f32_16x16x32_bf16 v[20:23], v[172:175], v[144:147], v[20:23]
    ds_read_b64_tr_b16 v[124:125], v187 offset:0
    v_mfma_f32_16x16x32_bf16 v[24:27], v[144:147], v[176:179], v[24:27]
    ds_read_b64_tr_b16 v[126:127], v187 offset:512
    v_mfma_f32_16x16x32_bf16 v[28:31], v[144:147], v[180:183], v[28:31]
    ds_read_b64_tr_b16 v[128:129], v186 offset:8192
    v_mfma_f32_16x16x32_bf16 v[32:35], v[160:163], v[148:151], v[32:35]
    ds_read_b64_tr_b16 v[130:131], v186 offset:8704
    v_mfma_f32_16x16x32_bf16 v[36:39], v[164:167], v[148:151], v[36:39]
    ds_read_b64_tr_b16 v[132:133], v187 offset:8192
    v_mfma_f32_16x16x32_bf16 v[40:43], v[168:171], v[148:151], v[40:43]
    ds_read_b64_tr_b16 v[134:135], v187 offset:8704
    v_mfma_f32_16x16x32_bf16 v[44:47], v[172:175], v[148:151], v[44:47]
    ds_read_b64_tr_b16 v[136:137], v186 offset:16384
    v_mfma_f32_16x16x32_bf16 v[48:51], v[148:151], v[176:179], v[48:51]
    ds_read_b64_tr_b16 v[138:139], v186 offset:16896
    v_mfma_f32_16x16x32_bf16 v[52:55], v[148:151], v[180:183], v[52:55]
    ds_read_b64_tr_b16 v[140:141], v187 offset:16384
    v_mfma_f32_16x16x32_bf16 v[56:59], v[160:163], v[152:155], v[56:59]
    ds_read_b64_tr_b16 v[142:143], v187 offset:16896
    v_mfma_f32_16x16x32_bf16 v[60:63], v[164:167], v[152:155], v[60:63]
    ds_read_b128 v[108:111], v184 offset:2048
    v_mfma_f32_16x16x32_bf16 v[64:67], v[168:171], v[152:155], v[64:67]
    ds_read_b128 v[112:115], v184 offset:4096
    v_mfma_f32_16x16x32_bf16 v[68:71], v[172:175], v[152:155], v[68:71]
    ds_read_b128 v[116:119], v184 offset:6144
    v_mfma_f32_16x16x32_bf16 v[72:75], v[152:155], v[176:179], v[72:75]
    v_mfma_f32_16x16x32_bf16 v[76:79], v[152:155], v[180:183], v[76:79]
    v_mfma_f32_16x16x32_bf16 v[80:83], v[160:163], v[156:159], v[80:83]
    v_mfma_f32_16x16x32_bf16 v[84:87], v[164:167], v[156:159], v[84:87]
    v_mfma_f32_16x16x32_bf16 v[88:91], v[168:171], v[156:159], v[88:91]
    v_mfma_f32_16x16x32_bf16 v[92:95], v[172:175], v[156:159], v[92:95]
    v_mfma_f32_16x16x32_bf16 v[96:99], v[156:159], v[176:179], v[96:99]
    v_mfma_f32_16x16x32_bf16 v[100:103], v[156:159], v[180:183], v[100:103]
L_cmid:
    s_waitcnt lgkmcnt(0)
    s_nop 0
    v_mfma_f32_16x16x32_bf16 v[8:11], v[120:123], v[104:107], v[8:11]
    ds_read_b128 v[144:147], v185 offset:0
    v_mfma_f32_16x16x32_bf16 v[12:15], v[124:127], v[104:107], v[12:15]
    ds_read_b64_tr_b16 v[160:161], v186 offset:4096
    v_mfma_f32_16x16x32_bf16 v[16:19], v[128:131], v[104:107], v[16:19]
    ds_read_b64_tr_b16 v[162:163], v186 offset:4608
    v_mfma_f32_16x16x32_bf16 v[20:23], v[132:135], v[104:107], v[20:23]
    ds_read_b64_tr_b16 v[164:165], v187 offset:4096
    v_mfma_f32_16x16x32_bf16 v[24:27], v[104:107], v[136:139], v[24:27]
    ds_read_b64_tr_b16 v[166:167], v187 offset:4608
    v_mfma_f32_16x16x32_bf16 v[28:31], v[104:107], v[140:143], v[28:31]
    ds_read_b64_tr_b16 v[168:169], v186 offset:12288
    v_mfma_f32_16x16x32_bf16 v[32:35], v[120:123], v[108:111], v[32:35]
    ds_read_b64_tr_b16 v[170:171], v186 offset:12800
    v_mfma_f32_16x16x32_bf16 v[36:39], v[124:127], v[108:111], v[36:39]
    ds_read_b64_tr_b16 v[172:173], v187 offset:12288
    v_mfma_f32_16x16x32_bf16 v[40:43], v[128:131], v[108:111], v[40:43]
    ds_read_b64_tr_b16 v[174:175], v187 offset:12800
    v_mfma_f32_16x16x32_bf16 v[44:47], v[132:135], v[108:111], v[44:47]
    ds_read_b64_tr_b16 v[176:177], v186 offset:20480
    v_mfma_f32_16x16x32_bf16 v[48:51], v[108:111], v[136:139], v[48:51]
    ds_read_b64_tr_b16 v[178:179], v186 offset:20992
    v_mfma_f32_16x16x32_bf16 v[52:55], v[108:111], v[140:143], v[52:55]
    ds_read_b64_tr_b16 v[180:181], v187 offset:20480
    v_mfma_f32_16x16x32_bf16 v[56:59], v[120:123], v[112:115], v[56:59]
    ds_read_b64_tr_b16 v[182:183], v187 offset:20992
    v_mfma_f32_16x16x32_bf16 v[60:63], v[124:127], v[112:115], v[60:63]
    ds_read_b128 v[148:151], v185 offset:2048
    v_mfma_f32_16x16x32_bf16 v[64:67], v[128:131], v[112:115], v[64:67]
    ds_read_b128 v[152:155], v185 offset:4096
    v_mfma_f32_16x16x32_bf16 v[68:71], v[132:135], v[112:115], v[68:71]
    ds_read_b128 v[156:159], v185 offset:6144
    v_mfma_f32_16x16x32_bf16 v[72:75], v[112:115], v[136:139], v[72:75]
    v_mfma_f32_16x16x32_bf16 v[76:79], v[112:115], v[140:143], v[76:79]
    v_mfma_f32_16x16x32_bf16 v[80:83], v[120:123], v[116:119], v[80:83]
    v_mfma_f32_16x16x32_bf16 v[84:87], v[124:127], v[116:119], v[84:87]
    v_mfma_f32_16x16x32_bf16 v[88:91], v[128:131], v[116:119], v[88:91]
    v_mfma_f32_16x16x32_bf16 v[92:95], v[132:135], v[116:119], v[92:95]
    v_mfma_f32_16x16x32_bf16 v[96:99], v[116:119], v[136:139], v[96:99]
    v_mfma_f32_16x16x32_bf16 v[100:103], v[116:119], v[140:143], v[100:103]
    s_waitcnt lgkmcnt(0)
    s_barrier
    v_mfma_f32_16x16x32_bf16 v[8:11], v[160:163], v[144:147], v[8:11]
    ds_read_b128 v[104:107], v184 offset:40960
    v_mfma_f32_16x16x32_bf16 v[12:15], v[164:167], v[144:147], v[12:15]
    ds_read_b64_tr_b16 v[120:121], v186 offset:40960
    v_mfma_f32_16x16x32_bf16 v[16:19], v[168:171], v[144:147], v[16:19]
    ds_read_b64_tr_b16 v[122:123], v186 offset:41472
    v_mfma_f32_16x16x32_bf16 v[20:23], v[172:175], v[144:147], v[20:23]
    ds_read_b64_tr_b16 v[124:125], v187 offset:40960
    v_mfma_f32_16x16x32_bf16 v[24:27], v[144:147], v[176:179], v[24:27]
    ds_read_b64_tr_b16 v[126:127], v187 offset:41472
    v_mfma_f32_16x16x32_bf16 v[28:31], v[144:147], v[180:183], v[28:31]
    ds_read_b64_tr_b16 v[128:129], v186 offset:49152
    v_mfma_f32_16x16x32_bf16 v[32:35], v[160:163], v[148:151], v[32:35]
    ds_read_b64_tr_b16 v[130:131], v186 offset:49664
    v_mfma_f32_16x16x32_bf16 v[36:39], v[164:167], v[148:151], v[36:39]
    ds_read_b64_tr_b16 v[132:133], v187 offset:49152
    v_mfma_f32_16x16x32_bf16 v[40:43], v[168:171], v[148:151], v[40:43]
    ds_read_b64_tr_b16 v[134:135], v187 offset:49664
    v_mfma_f32_16x16x32_bf16 v[44:47], v[172:175], v[148:151], v[44:47]
    ds_read_b64_tr_b16 v[136:137], v186 offset:57344
    v_mfma_f32_16x16x32_bf16 v[48:51], v[148:151], v[176:179], v[48:51]
    ds_read_b64_tr_b16 v[138:139], v186 offset:57856
    v_mfma_f32_16x16x32_bf16 v[52:55], v[148:151], v[180:183], v[52:55]
    ds_read_b64_tr_b16 v[140:141], v187 offset:57344
    v_mfma_f32_16x16x32_bf16 v[56:59], v[160:163], v[152:155], v[56:59]
    ds_read_b64_tr_b16 v[142:143], v187 offset:57856
    v_mfma_f32_16x16x32_bf16 v[60:63], v[164:167], v[152:155], v[60:63]
    ds_read_b128 v[108:111], v184 offset:43008
    v_mfma_f32_16x16x32_bf16 v[64:67], v[168:171], v[152:155], v[64:67]
    ds_read_b128 v[112:115], v184 offset:45056
    v_mfma_f32_16x16x32_bf16 v[68:71], v[172:175], v[152:155], v[68:71]
    ds_read_b128 v[116:119], v184 offset:47104
    v_mfma_f32_16x16x32_bf16 v[72:75], v[152:155], v[176:179], v[72:75]
    v_mfma_f32_16x16x32_bf16 v[76:79], v[152:155], v[180:183], v[76:79]
    v_mfma_f32_16x16x32_bf16 v[80:83], v[160:163], v[156:159], v[80:83]
    v_mfma_f32_16x16x32_bf16 v[84:87], v[164:167], v[156:159], v[84:87]
    v_mfma_f32_16x16x32_bf16 v[88:91], v[168:171], v[156:159], v[88:91]
    v_mfma_f32_16x16x32_bf16 v[92:95], v[172:175], v[156:159], v[92:95]
    v_mfma_f32_16x16x32_bf16 v[96:99], v[156:159], v[176:179], v[96:99]
    v_mfma_f32_16x16x32_bf16 v[100:103], v[156:159], v[180:183], v[100:103]
    s_waitcnt lgkmcnt(0)
    s_nop 0
    v_mfma_f32_16x16x32_bf16 v[8:11], v[120:123], v[104:107], v[8:11]
    ds_read_b128 v[144:147], v185 offset:40960
    v_mfma_f32_16x16x32_bf16 v[12:15], v[124:127], v[104:107], v[12:15]
    ds_read_b64_tr_b16 v[160:161], v186 offset:45056
    v_mfma_f32_16x16x32_bf16 v[16:19], v[128:131], v[104:107], v[16:19]
    ds_read_b64_tr_b16 v[162:163], v186 offset:45568
    v_mfma_f32_16x16x32_bf16 v[20:23], v[132:135], v[104:107], v[20:23]
    ds_read_b64_tr_b16 v[164:165], v187 offset:45056
    v_mfma_f32_16x16x32_bf16 v[24:27], v[104:107], v[136:139], v[24:27]
    ds_read_b64_tr_b16 v[166:167], v187 offset:45568
    v_mfma_f32_16x16x32_bf16 v[28:31], v[104:107], v[140:143], v[28:31]
    ds_read_b64_tr_b16 v[168:169], v186 offset:53248
    v_mfma_f32_16x16x32_bf16 v[32:35], v[120:123], v[108:111], v[32:35]
    ds_read_b64_tr_b16 v[170:171], v186 offset:53760
    v_mfma_f32_16x16x32_bf16 v[36:39], v[124:127], v[108:111], v[36:39]
    ds_read_b64_tr_b16 v[172:173], v187 offset:53248
    v_mfma_f32_16x16x32_bf16 v[40:43], v[128:131], v[108:111], v[40:43]
    ds_read_b64_tr_b16 v[174:175], v187 offset:53760
    v_mfma_f32_16x16x32_bf16 v[44:47], v[132:135], v[108:111], v[44:47]
    ds_read_b64_tr_b16 v[176:177], v186 offset:61440
    v_mfma_f32_16x16x32_bf16 v[48:51], v[108:111], v[136:139], v[48:51]
    ds_read_b64_tr_b16 v[178:179], v186 offset:61952
    v_mfma_f32_16x16x32_bf16 v[52:55], v[108:111], v[140:143], v[52:55]
    ds_read_b64_tr_b16 v[180:181], v187 offset:61440
    v_mfma_f32_16x16x32_bf16 v[56:59], v[120:123], v[112:115], v[56:59]
    ds_read_b64_tr_b16 v[182:183], v187 offset:61952
    v_mfma_f32_16x16x32_bf16 v[60:63], v[124:127], v[112:115], v[60:63]
    ds_read_b128 v[148:151], v185 offset:43008
    v_mfma_f32_16x16x32_bf16 v[64:67], v[128:131], v[112:115], v[64:67]
    ds_read_b128 v[152:155], v185 offset:45056
    v_mfma_f32_16x16x32_bf16 v[68:71], v[132:135], v[112:115], v[68:71]
    ds_read_b128 v[156:159], v185 offset:47104
    v_mfma_f32_16x16x32_bf16 v[72:75], v[112:115], v[136:139], v[72:75]
    v_mfma_f32_16x16x32_bf16 v[76:79], v[112:115], v[140:143], v[76:79]
    v_mfma_f32_16x16x32_bf16 v[80:83], v[120:123], v[116:119], v[80:83]
    v_mfma_f32_16x16x32_bf16 v[84:87], v[124:127], v[116:119], v[84:87]
    v_mfma_f32_16x16x32_bf16 v[88:91], v[128:131], v[116:119], v[88:91]
    v_mfma_f32_16x16x32_bf16 v[92:95], v[132:135], v[116:119], v[92:95]
    v_mfma_f32_16x16x32_bf16 v[96:99], v[116:119], v[136:139], v[96:99]
    v_mfma_f32_16x16x32_bf16 v[100:103], v[116:119], v[140:143], v[100:103]
    s_waitcnt lgkmcnt(0)
    s_barrier
    v_mfma_f32_16x16x32_bf16 v[8:11], v[160:163], v[144:147], v[8:11]
    ds_read_b128 v[104:107], v188 offset:0
    v_mfma_f32_16x16x32_bf16 v[12:15], v[164:167], v[144:147], v[12:15]
    ds_read_b64_tr_b16 v[120:121], v190 offset:0
    v_mfma_f32_16x16x32_bf16 v[16:19], v[168:171], v[144:147], v[16:19]
    ds_read_b64_tr_b16 v[122:123], v190 offset:512
    v_mfma_f32_16x16x32_bf16 v[20:23], v[172:175], v[144:147], v[20:23]
    ds_read_b64_tr_b16 v[124:125], v191 offset:0
    v_mfma_f32_16x16x32_bf16 v[24:27], v[144:147], v[176:179], v[24:27]
    ds_read_b64_tr_b16 v[126:127], v191 offset:512
    v_mfma_f32_16x16x32_bf16 v[28:31], v[144:147], v[180:183], v[28:31]
    ds_read_b64_tr_b16 v[128:129], v190 offset:8192
    v_mfma_f32_16x16x32_bf16 v[32:35], v[160:163], v[148:151], v[32:35]
    ds_read_b64_tr_b16 v[130:131], v190 offset:8704
    v_mfma_f32_16x16x32_bf16 v[36:39], v[164:167], v[148:151], v[36:39]
    ds_read_b64_tr_b16 v[132:133], v191 offset:8192
    v_mfma_f32_16x16x32_bf16 v[40:43], v[168:171], v[148:151], v[40:43]
    ds_read_b64_tr_b16 v[134:135], v191 offset:8704
    v_mfma_f32_16x16x32_bf16 v[44:47], v[172:175], v[148:151], v[44:47]
    ds_read_b64_tr_b16 v[136:137], v190 offset:16384
    v_mfma_f32_16x16x32_bf16 v[48:51], v[148:151], v[176:179], v[48:51]
    ds_read_b64_tr_b16 v[138:139], v190 offset:16896
    v_mfma_f32_16x16x32_bf16 v[52:55], v[148:151], v[180:183], v[52:55]
    ds_read_b64_tr_b16 v[140:141], v191 offset:16384
    v_mfma_f32_16x16x32_bf16 v[56:59], v[160:163], v[152:155], v[56:59]
    ds_read_b64_tr_b16 v[142:143], v191 offset:16896
    v_mfma_f32_16x16x32_bf16 v[60:63], v[164:167], v[152:155], v[60:63]
    ds_read_b128 v[108:111], v188 offset:2048
    v_mfma_f32_16x16x32_bf16 v[64:67], v[168:171], v[152:155], v[64:67]
    ds_read_b128 v[112:115], v188 offset:4096
    v_mfma_f32_16x16x32_bf16 v[68:71], v[172:175], v[152:155], v[68:71]
    ds_read_b128 v[116:119], v188 offset:6144
    v_mfma_f32_16x16x32_bf16 v[72:75], v[152:155], v[176:179], v[72:75]
    v_mfma_f32_16x16x32_bf16 v[76:79], v[152:155], v[180:183], v[76:79]
    v_mfma_f32_16x16x32_bf16 v[80:83], v[160:163], v[156:159], v[80:83]
    v_mfma_f32_16x16x32_bf16 v[84:87], v[164:167], v[156:159], v[84:87]
    v_mfma_f32_16x16x32_bf16 v[88:91], v[168:171], v[156:159], v[88:91]
    v_mfma_f32_16x16x32_bf16 v[92:95], v[172:175], v[156:159], v[92:95]
    v_mfma_f32_16x16x32_bf16 v[96:99], v[156:159], v[176:179], v[96:99]
    v_mfma_f32_16x16x32_bf16 v[100:103], v[156:159], v[180:183], v[100:103]
    s_waitcnt lgkmcnt(0)
    s_nop 0
    v_mfma_f32_16x16x32_bf16 v[8:11], v[120:123], v[104:107], v[8:11]
    ds_read_b128 v[144:147], v189 offset:0
    v_mfma_f32_16x16x32_bf16 v[12:15], v[124:127], v[104:107], v[12:15]
    ds_read_b64_tr_b16 v[160:161], v190 offset:4096
    v_mfma_f32_16x16x32_bf16 v[16:19], v[128:131], v[104:107], v[16:19]
    ds_read_b64_tr_b16 v[162:163], v190 offset:4608
    v_mfma_f32_16x16x32_bf16 v[20:23], v[132:135], v[104:107], v[20:23]
    ds_read_b64_tr_b16 v[164:165], v191 offset:4096
    v_mfma_f32_16x16x32_bf16 v[24:27], v[104:107], v[136:139], v[24:27]
    ds_read_b64_tr_b16 v[166:167], v191 offset:4608
    v_mfma_f32_16x16x32_bf16 v[28:31], v[104:107], v[140:143], v[28:31]
    ds_read_b64_tr_b16 v[168:169], v190 offset:12288
    v_mfma_f32_16x16x32_bf16 v[32:35], v[120:123], v[108:111], v[32:35]
    ds_read_b64_tr_b16 v[170:171], v190 offset:12800
    v_mfma_f32_16x16x32_bf16 v[36:39], v[124:127], v[108:111], v[36:39]
    ds_read_b64_tr_b16 v[172:173], v191 offset:12288
    v_mfma_f32_16x16x32_bf16 v[40:43], v[128:131], v[108:111], v[40:43]
    ds_read_b64_tr_b16 v[174:175], v191 offset:12800
    v_mfma_f32_16x16x32_bf16 v[44:47], v[132:135], v[108:111], v[44:47]
    ds_read_b64_tr_b16 v[176:177], v190 offset:20480
    v_mfma_f32_16x16x32_bf16 v[48:51], v[108:111], v[136:139], v[48:51]
    ds_read_b64_tr_b16 v[178:179], v190 offset:20992
    v_mfma_f32_16x16x32_bf16 v[52:55], v[108:111], v[140:143], v[52:55]
    ds_read_b64_tr_b16 v[180:181], v191 offset:20480
    v_mfma_f32_16x16x32_bf16 v[56:59], v[120:123], v[112:115], v[56:59]
    ds_read_b64_tr_b16 v[182:183], v191 offset:20992
    v_mfma_f32_16x16x32_bf16 v[60:63], v[124:127], v[112:115], v[60:63]
    ds_read_b128 v[148:151], v189 offset:2048
    v_mfma_f32_16x16x32_bf16 v[64:67], v[128:131], v[112:115], v[64:67]
    ds_read_b128 v[152:155], v189 offset:4096
    v_mfma_f32_16x16x32_bf16 v[68:71], v[132:135], v[112:115], v[68:71]
    ds_read_b128 v[156:159], v189 offset:6144
    v_mfma_f32_16x16x32_bf16 v[72:75], v[112:115], v[136:139], v[72:75]
    s_add_u32 s66, s66, 1
    s_cmp_lt_u32 s66, 5
    v_mfma_f32_16x16x32_bf16 v[76:79], v[112:115], v[140:143], v[76:79]
    v_mfma_f32_16x16x32_bf16 v[80:83], v[120:123], v[116:119], v[80:83]
    v_mfma_f32_16x16x32_bf16 v[84:87], v[124:127], v[116:119], v[84:87]
    v_mfma_f32_16x16x32_bf16 v[88:91], v[128:131], v[116:119], v[88:91]
    v_mfma_f32_16x16x32_bf16 v[92:95], v[132:135], v[116:119], v[92:95]
    v_mfma_f32_16x16x32_bf16 v[96:99], v[116:119], v[136:139], v[96:99]
    v_mfma_f32_16x16x32_bf16 v[100:103], v[116:119], v[140:143], v[100:103]
    s_cbranch_scc1 L_cloop
    s_nop 0
    s_waitcnt lgkmcnt(0)
    s_barrier
    v_mfma_f32_16x16x32_bf16 v[8:11], v[160:163], v[144:147], v[8:11]
    ds_read_b128 v[104:107], v184 offset:0
    v_and_b32_e64 v2, 15, v1
    v_mfma_f32_16x16x32_bf16 v[12:15], v[164:167], v[144:147], v[12:15]
    ds_read_b64_tr_b16 v[120:121], v186 offset:0
    v_lshrrev_b32_e64 v3, 4, v1
    v_mfma_f32_16x16x32_bf16 v[16:19], v[168:171], v[144:147], v[16:19]
    ds_read_b64_tr_b16 v[122:123], v186 offset:512
    s_lshl_b32 s3, s64, 8
    s_nop 0
    v_mfma_f32_16x16x32_bf16 v[20:23], v[172:175], v[144:147], v[20:23]
    ds_read_b64_tr_b16 v[124:125], v187 offset:0
    s_add_u32 s3, s3, 152064
    v_mfma_f32_16x16x32_bf16 v[24:27], v[144:147], v[176:179], v[24:27]
    ds_read_b64_tr_b16 v[126:127], v187 offset:512
    v_lshl_add_u32 v188, v2, 2, s3
    v_mfma_f32_16x16x32_bf16 v[28:31], v[144:147], v[180:183], v[28:31]
    ds_read_b64_tr_b16 v[128:129], v186 offset:8192
    v_lshl_add_u32 v189, v3, 4, s3
    v_mfma_f32_16x16x32_bf16 v[32:35], v[160:163], v[148:151], v[32:35]
    ds_read_b64_tr_b16 v[130:131], v186 offset:8704
    v_lshrrev_b32_e64 v7, 5, v1
    v_mfma_f32_16x16x32_bf16 v[36:39], v[164:167], v[148:151], v[36:39]
    ds_read_b64_tr_b16 v[132:133], v187 offset:8192
    v_lshl_add_u32 v190, v7, 6, v188
    v_mfma_f32_16x16x32_bf16 v[40:43], v[168:171], v[148:151], v[40:43]
    ds_read_b64_tr_b16 v[134:135], v187 offset:8704
    s_lshl_b32 s3, s65, 7
    s_nop 0
    v_mfma_f32_16x16x32_bf16 v[44:47], v[172:175], v[148:151], v[44:47]
    ds_read_b64_tr_b16 v[136:137], v186 offset:16384
    s_add_u32 s3, s3, 154880
    v_mfma_f32_16x16x32_bf16 v[48:51], v[148:151], v[176:179], v[48:51]
    ds_read_b64_tr_b16 v[138:139], v186 offset:16896
    v_lshl_add_u32 v191, v3, 4, s3
    v_mfma_f32_16x16x32_bf16 v[52:55], v[148:151], v[180:183], v[52:55]
    ds_read_b64_tr_b16 v[140:141], v187 offset:16384
    v_lshl_add_u32 v248, v2, 2, s3
    v_mfma_f32_16x16x32_bf16 v[56:59], v[160:163], v[152:155], v[56:59]
    ds_read_b64_tr_b16 v[142:143], v187 offset:16896
    s_lshl_b32 s3, s64, 7
    s_nop 0
    v_mfma_f32_16x16x32_bf16 v[60:63], v[164:167], v[152:155], v[60:63]
    ds_read_b128 v[108:111], v184 offset:2048
    s_add_u32 s3, s3, 154624
    v_mfma_f32_16x16x32_bf16 v[64:67], v[168:171], v[152:155], v[64:67]
    ds_read_b128 v[112:115], v184 offset:4096
    v_lshl_add_u32 v249, v3, 4, s3
    v_mfma_f32_16x16x32_bf16 v[68:71], v[172:175], v[152:155], v[68:71]
    ds_read_b128 v[116:119], v184 offset:6144
    v_xor_b32 v253, 128, v249
    v_mfma_f32_16x16x32_bf16 v[72:75], v[152:155], v[176:179], v[72:75]
    v_lshrrev_b32 v250, 2, v1
    v_lshlrev_b32 v250, 6, v250
    v_mfma_f32_16x16x32_bf16 v[76:79], v[152:155], v[180:183], v[76:79]
    v_and_b32_e64 v251, 3, v1
    v_lshl_add_u32 v250, v251, 3, v250
    v_mfma_f32_16x16x32_bf16 v[80:83], v[160:163], v[156:159], v[80:83]
    s_lshl_b32 s3, s65, 11
    s_add_u32 s3, s3, 147712
    v_mfma_f32_16x16x32_bf16 v[84:87], v[164:167], v[156:159], v[84:87]
    v_add_u32 v252, s3, v250
    v_bfe_u32 v5, v1, 1, 2
    v_mfma_f32_16x16x32_bf16 v[88:91], v[168:171], v[156:159], v[88:91]
    v_lshlrev_b32_e64 v5, 2, v5
    v_bfe_u32 v4, v1, 3, 1
    v_mfma_f32_16x16x32_bf16 v[92:95], v[172:175], v[156:159], v[92:95]
    v_lshl_add_u32 v5, v4, 1, v5
    v_and_b32 v4, 1, v1
    v_mfma_f32_16x16x32_bf16 v[96:99], v[156:159], v[176:179], v[96:99]
    v_add_u32 v5, v5, v4
    v_xor_b32 v5, v5, v3
    v_mfma_f32_16x16x32_bf16 v[100:103], v[156:159], v[180:183], v[100:103]
    s_lshl_b32 s3, s38, 13
    s_add_u32 s3, s3, 98304
    s_waitcnt lgkmcnt(0)
    s_nop 0
    v_mfma_f32_16x16x32_bf16 v[8:11], v[120:123], v[104:107], v[8:11]
    ds_read_b128 v[144:147], v185 offset:0
    v_lshl_add_u32 v2, v2, 7, s3
    v_mfma_f32_16x16x32_bf16 v[12:15], v[124:127], v[104:107], v[12:15]
    ds_read_b64_tr_b16 v[160:161], v186 offset:4096
    v_lshl_add_u32 v4, v5, 3, v2
    v_mfma_f32_16x16x32_bf16 v[16:19], v[128:131], v[104:107], v[16:19]
    ds_read_b64_tr_b16 v[162:163], v186 offset:4608
    v_xor_b32_e64 v5, 32, v4
    v_mfma_f32_16x16x32_bf16 v[20:23], v[132:135], v[104:107], v[20:23]
    ds_read_b64_tr_b16 v[164:165], v187 offset:4096
    v_xor_b32_e64 v6, 64, v4
    v_mfma_f32_16x16x32_bf16 v[24:27], v[104:107], v[136:139], v[24:27]
    ds_read_b64_tr_b16 v[166:167], v187 offset:4608
    v_xor_b32 v7, 96, v4
    v_mfma_f32_16x16x32_bf16 v[28:31], v[104:107], v[140:143], v[28:31]
    ds_read_b64_tr_b16 v[168:169], v186 offset:12288
    v_bfe_u32 v2, v1, 3, 2
    v_mfma_f32_16x16x32_bf16 v[32:35], v[120:123], v[108:111], v[32:35]
    ds_read_b64_tr_b16 v[170:171], v186 offset:12800
    v_lshlrev_b32_e64 v2, 2, v2
    v_mfma_f32_16x16x32_bf16 v[36:39], v[124:127], v[108:111], v[36:39]
    ds_read_b64_tr_b16 v[172:173], v187 offset:12288
    v_lshrrev_b32_e64 v3, 5, v1
    v_mfma_f32_16x16x32_bf16 v[40:43], v[128:131], v[108:111], v[40:43]
    ds_read_b64_tr_b16 v[174:175], v187 offset:12800
    v_lshl_add_u32 v2, v3, 1, v2
    v_mfma_f32_16x16x32_bf16 v[44:47], v[132:135], v[108:111], v[44:47]
    ds_read_b64_tr_b16 v[176:177], v186 offset:20480
    v_bfe_u32 v3, v1, 2, 1
    v_mfma_f32_16x16x32_bf16 v[48:51], v[108:111], v[136:139], v[48:51]
    ds_read_b64_tr_b16 v[178:179], v186 offset:20992
    v_add_u32_e64 v2, v2, v3
    v_mfma_f32_16x16x32_bf16 v[52:55], v[108:111], v[140:143], v[52:55]
    ds_read_b64_tr_b16 v[180:181], v187 offset:20480
    v_xor_b32_e64 v2, v2, v251
    v_mfma_f32_16x16x32_bf16 v[56:59], v[120:123], v[112:115], v[56:59]
    ds_read_b64_tr_b16 v[182:183], v187 offset:20992
    v_lshrrev_b32_e64 v3, 2, v1
    v_mfma_f32_16x16x32_bf16 v[60:63], v[124:127], v[112:115], v[60:63]
    ds_read_b128 v[148:151], v185 offset:2048
    v_lshl_add_u32 v3, v3, 7, s3
    v_mfma_f32_16x16x32_bf16 v[64:67], v[128:131], v[112:115], v[64:67]
    ds_read_b128 v[152:155], v185 offset:4096
    v_lshl_add_u32 v2, v2, 3, v3
    v_mfma_f32_16x16x32_bf16 v[68:71], v[132:135], v[112:115], v[68:71]
    ds_read_b128 v[156:159], v185 offset:6144
    s_lshl_b32 s28, s64, 6
    v_mfma_f32_16x16x32_bf16 v[72:75], v[112:115], v[136:139], v[72:75]
    v_xor_b32 v201, s28, v2
    v_xor_b32 v203, 32, v201
    v_mfma_f32_16x16x32_bf16 v[76:79], v[112:115], v[140:143], v[76:79]
    s_lshl_b32 s3, s38, 12
    s_add_u32 s3, s3, 131072
    v_mfma_f32_16x16x32_bf16 v[80:83], v[120:123], v[116:119], v[80:83]
    v_lshlrev_b32 v199, 4, v1
    v_add_u32 v197, s3, v199
    v_mfma_f32_16x16x32_bf16 v[84:87], v[124:127], v[116:119], v[84:87]
    s_lshl_b32 s3, s37, 1
    s_add_u32 s67, s3, s65
    v_mfma_f32_16x16x32_bf16 v[88:91], v[128:131], v[116:119], v[88:91]
    s_lshl_b32 s3, s67, 4
    s_add_u32 s3, s3, s36
    v_mfma_f32_16x16x32_bf16 v[92:95], v[132:135], v[116:119], v[92:95]
    s_mul_i32 s3, s3, 4224
    s_add_u32 s75, s3, 8388608
    v_mfma_f32_16x16x32_bf16 v[96:99], v[116:119], v[136:139], v[96:99]
    s_lshl_b32 s3, s64, 11
    s_add_u32 s74, s75, s3
    v_mfma_f32_16x16x32_bf16 v[100:103], v[116:119], v[140:143], v[100:103]
    s_lshl_b32 s3, s64, 6
    s_add_u32 s75, s75, s3
    s_add_u32 s75, s75, 4096
    s_lshl_b32 s3, s37, 4
    s_add_u32 s3, s3, s36
    s_lshl_b32 s3, s3, 7
    s_add_u32 s3, s3, 32768
    v_mov_b32 v251, s86
    s_cmp_lg_u32 s38, 0
    s_cselect_b32 s76, 268435456, s3
    s_waitcnt lgkmcnt(0)
    v_mfma_f32_16x16x32_bf16 v[16:19], v[168:171], v[144:147], v[16:19]
    s_barrier
    s_nop 0
    v_mfma_f32_16x16x32_bf16 v[20:23], v[172:175], v[144:147], v[20:23]
    ds_read_b32 v192, v188 offset:0
    ds_read_b32 v194, v188 offset:64
    v_mfma_f32_16x16x32_bf16 v[40:43], v[168:171], v[148:151], v[40:43]
    ds_read_b32 v196, v188 offset:128
    ds_read_b32 v198, v188 offset:192
    v_mfma_f32_16x16x32_bf16 v[44:47], v[172:175], v[148:151], v[44:47]
    ds_read_b128 v[204:207], v191 offset:256
    v_mfma_f32_16x16x32_bf16 v[64:67], v[168:171], v[152:155], v[64:67]
    ds_read_b128 v[208:211], v191 offset:320
    v_mfma_f32_16x16x32_bf16 v[68:71], v[172:175], v[152:155], v[68:71]
    ds_read_b64_tr_b16 v[224:225], v252 offset:0
    v_mfma_f32_16x16x32_bf16 v[88:91], v[168:171], v[156:159], v[88:91]
    ds_read_b64_tr_b16 v[226:227], v252 offset:1024
    v_mfma_f32_16x16x32_bf16 v[92:95], v[172:175], v[156:159], v[92:95]
    ds_read_b64_tr_b16 v[228:229], v252 offset:32
    v_mfma_f32_16x16x32_bf16 v[24:27], v[144:147], v[176:179], v[24:27]
    ds_read_b64_tr_b16 v[230:231], v252 offset:1056
    v_mfma_f32_16x16x32_bf16 v[28:31], v[144:147], v[180:183], v[28:31]
    ds_read_b128 v[104:107], v189 offset:0
    v_mfma_f32_16x16x32_bf16 v[48:51], v[148:151], v[176:179], v[48:51]
    ds_read_b128 v[108:111], v189 offset:64
    v_mfma_f32_16x16x32_bf16 v[52:55], v[148:151], v[180:183], v[52:55]
    ds_read_b128 v[112:115], v189 offset:128
    v_mfma_f32_16x16x32_bf16 v[72:75], v[152:155], v[176:179], v[72:75]
    ds_read_b128 v[116:119], v189 offset:192
    v_mfma_f32_16x16x32_bf16 v[76:79], v[152:155], v[180:183], v[76:79]
    ds_read_b32 v250, v248 offset:576
    ds_read_b32 v248, v248 offset:512
    v_mfma_f32_16x16x32_bf16 v[96:99], v[156:159], v[176:179], v[96:99]
    ds_read_b32 v200, v188 offset:2048
    v_mfma_f32_16x16x32_bf16 v[100:103], v[156:159], v[180:183], v[100:103]
    ds_read_b32 v202, v188 offset:2112
    v_mfma_f32_16x16x32_bf16 v[8:11], v[160:163], v[144:147], v[8:11]
    ds_read_b32 v220, v188 offset:2176
    v_mfma_f32_16x16x32_bf16 v[12:15], v[164:167], v[144:147], v[12:15]
    ds_read_b32 v222, v188 offset:2240
    v_mfma_f32_16x16x32_bf16 v[32:35], v[160:163], v[148:151], v[32:35]
    ds_read_b32 v193, v190 offset:2048
    ds_read_b32 v195, v190 offset:1024
    v_mfma_f32_16x16x32_bf16 v[36:39], v[164:167], v[148:151], v[36:39]
    ds_read_b32 v221, v190 offset:2176
    ds_read_b32 v223, v190 offset:1152
    v_mfma_f32_16x16x32_bf16 v[56:59], v[160:163], v[152:155], v[56:59]
    ds_read_b128 v[120:123], v249 offset:0
    v_mfma_f32_16x16x32_bf16 v[60:63], v[164:167], v[152:155], v[60:63]
    ds_read_b128 v[124:127], v249 offset:64
    v_mfma_f32_16x16x32_bf16 v[80:83], v[160:163], v[156:159], v[80:83]
    ds_read_b128 v[212:215], v191 offset:0
    v_mfma_f32_16x16x32_bf16 v[84:87], v[164:167], v[156:159], v[84:87]
    ds_read_b128 v[216:219], v191 offset:64
    s_waitcnt lgkmcnt(4)
    s_nop 0
    v_pk_fma_f32 v[16:17], v[192:193], v[204:205], v[16:17] op_sel_hi:[0,1,1] neg_lo:[1,0,0] neg_hi:[1,0,0]
    v_pk_fma_f32 v[18:19], v[192:193], v[206:207], v[18:19] op_sel_hi:[0,1,1] neg_lo:[1,0,0] neg_hi:[1,0,0]
    v_pk_fma_f32 v[20:21], v[192:193], v[208:209], v[20:21] op_sel_hi:[0,1,1] neg_lo:[1,0,0] neg_hi:[1,0,0]
    v_pk_fma_f32 v[22:23], v[192:193], v[210:211], v[22:23] op_sel_hi:[0,1,1] neg_lo:[1,0,0] neg_hi:[1,0,0]
    v_cvt_pk_bf16_f32 v232, v16, v17
    v_cvt_pk_bf16_f32 v233, v18, v19
    v_cvt_pk_bf16_f32 v234, v20, v21
    v_cvt_pk_bf16_f32 v235, v22, v23
    v_pk_fma_f32 v[40:41], v[194:195], v[204:205], v[40:41] op_sel_hi:[0,1,1] neg_lo:[1,0,0] neg_hi:[1,0,0]
    v_pk_fma_f32 v[42:43], v[194:195], v[206:207], v[42:43] op_sel_hi:[0,1,1] neg_lo:[1,0,0] neg_hi:[1,0,0]
    v_pk_fma_f32 v[44:45], v[194:195], v[208:209], v[44:45] op_sel_hi:[0,1,1] neg_lo:[1,0,0] neg_hi:[1,0,0]
    v_pk_fma_f32 v[46:47], v[194:195], v[210:211], v[46:47] op_sel_hi:[0,1,1] neg_lo:[1,0,0] neg_hi:[1,0,0]
    v_cvt_pk_bf16_f32 v236, v40, v41
    v_cvt_pk_bf16_f32 v237, v42, v43
    v_cvt_pk_bf16_f32 v238, v44, v45
    v_cvt_pk_bf16_f32 v239, v46, v47
    v_pk_fma_f32 v[64:65], v[196:197], v[204:205], v[64:65] op_sel_hi:[0,1,1] neg_lo:[1,0,0] neg_hi:[1,0,0]
    v_pk_fma_f32 v[66:67], v[196:197], v[206:207], v[66:67] op_sel_hi:[0,1,1] neg_lo:[1,0,0] neg_hi:[1,0,0]
    v_pk_fma_f32 v[68:69], v[196:197], v[208:209], v[68:69] op_sel_hi:[0,1,1] neg_lo:[1,0,0] neg_hi:[1,0,0]
    v_pk_fma_f32 v[70:71], v[196:197], v[210:211], v[70:71] op_sel_hi:[0,1,1] neg_lo:[1,0,0] neg_hi:[1,0,0]
    v_cvt_pk_bf16_f32 v240, v64, v65
    v_cvt_pk_bf16_f32 v241, v66, v67
    v_cvt_pk_bf16_f32 v242, v68, v69
    v_cvt_pk_bf16_f32 v243, v70, v71
    v_pk_fma_f32 v[88:89], v[198:199], v[204:205], v[88:89] op_sel_hi:[0,1,1] neg_lo:[1,0,0] neg_hi:[1,0,0]
    v_pk_fma_f32 v[90:91], v[198:199], v[206:207], v[90:91] op_sel_hi:[0,1,1] neg_lo:[1,0,0] neg_hi:[1,0,0]
    v_pk_fma_f32 v[92:93], v[198:199], v[208:209], v[92:93] op_sel_hi:[0,1,1] neg_lo:[1,0,0] neg_hi:[1,0,0]
    v_pk_fma_f32 v[94:95], v[198:199], v[210:211], v[94:95] op_sel_hi:[0,1,1] neg_lo:[1,0,0] neg_hi:[1,0,0]
    v_cvt_pk_bf16_f32 v244, v88, v89
    v_cvt_pk_bf16_f32 v245, v90, v91
    v_cvt_pk_bf16_f32 v246, v92, v93
    v_cvt_pk_bf16_f32 v247, v94, v95
    v_mfma_f32_16x16x32_bf16 v[144:147], v[224:227], v[232:235], 0
    v_mfma_f32_16x16x32_bf16 v[148:151], v[228:231], v[232:235], 0
    v_mfma_f32_16x16x32_bf16 v[152:155], v[224:227], v[236:239], 0
    v_mfma_f32_16x16x32_bf16 v[156:159], v[228:231], v[236:239], 0
    v_mfma_f32_16x16x32_bf16 v[160:163], v[224:227], v[240:243], 0
    v_mfma_f32_16x16x32_bf16 v[164:167], v[228:231], v[240:243], 0
    v_mfma_f32_16x16x32_bf16 v[168:171], v[224:227], v[244:247], 0
    v_mfma_f32_16x16x32_bf16 v[172:175], v[228:231], v[244:247], 0
    v_pk_fma_f32 v[24:25], v[104:105], v[248:249], v[24:25] op_sel_hi:[1,0,1] neg_lo:[1,0,0] neg_hi:[1,0,0]
    v_pk_fma_f32 v[26:27], v[106:107], v[248:249], v[26:27] op_sel_hi:[1,0,1] neg_lo:[1,0,0] neg_hi:[1,0,0]
    v_pk_fma_f32 v[28:29], v[104:105], v[250:251], v[28:29] op_sel_hi:[1,0,1] neg_lo:[1,0,0] neg_hi:[1,0,0]
    v_pk_fma_f32 v[30:31], v[106:107], v[250:251], v[30:31] op_sel_hi:[1,0,1] neg_lo:[1,0,0] neg_hi:[1,0,0]
    v_pk_fma_f32 v[48:49], v[108:109], v[248:249], v[48:49] op_sel_hi:[1,0,1] neg_lo:[1,0,0] neg_hi:[1,0,0]
    v_pk_fma_f32 v[50:51], v[110:111], v[248:249], v[50:51] op_sel_hi:[1,0,1] neg_lo:[1,0,0] neg_hi:[1,0,0]
    v_pk_fma_f32 v[52:53], v[108:109], v[250:251], v[52:53] op_sel_hi:[1,0,1] neg_lo:[1,0,0] neg_hi:[1,0,0]
    v_pk_fma_f32 v[54:55], v[110:111], v[250:251], v[54:55] op_sel_hi:[1,0,1] neg_lo:[1,0,0] neg_hi:[1,0,0]
    v_pk_fma_f32 v[72:73], v[112:113], v[248:249], v[72:73] op_sel_hi:[1,0,1] neg_lo:[1,0,0] neg_hi:[1,0,0]
    v_pk_fma_f32 v[74:75], v[114:115], v[248:249], v[74:75] op_sel_hi:[1,0,1] neg_lo:[1,0,0] neg_hi:[1,0,0]
    v_pk_fma_f32 v[76:77], v[112:113], v[250:251], v[76:77] op_sel_hi:[1,0,1] neg_lo:[1,0,0] neg_hi:[1,0,0]
    v_pk_fma_f32 v[78:79], v[114:115], v[250:251], v[78:79] op_sel_hi:[1,0,1] neg_lo:[1,0,0] neg_hi:[1,0,0]
    v_pk_fma_f32 v[96:97], v[116:117], v[248:249], v[96:97] op_sel_hi:[1,0,1] neg_lo:[1,0,0] neg_hi:[1,0,0]
    v_pk_fma_f32 v[98:99], v[118:119], v[248:249], v[98:99] op_sel_hi:[1,0,1] neg_lo:[1,0,0] neg_hi:[1,0,0]
    v_pk_fma_f32 v[100:101], v[116:117], v[250:251], v[100:101] op_sel_hi:[1,0,1] neg_lo:[1,0,0] neg_hi:[1,0,0]
    v_pk_fma_f32 v[102:103], v[118:119], v[250:251], v[102:103] op_sel_hi:[1,0,1] neg_lo:[1,0,0] neg_hi:[1,0,0]
    v_cvt_pk_bf16_f32 v24, v24, v25
    v_cvt_pk_bf16_f32 v25, v26, v27
    v_cvt_pk_bf16_f32 v26, v48, v49
    v_cvt_pk_bf16_f32 v27, v50, v51
    v_cvt_pk_bf16_f32 v28, v28, v29
    v_cvt_pk_bf16_f32 v29, v30, v31
    v_cvt_pk_bf16_f32 v30, v52, v53
    v_cvt_pk_bf16_f32 v31, v54, v55
    v_cvt_pk_bf16_f32 v72, v72, v73
    v_cvt_pk_bf16_f32 v73, v74, v75
    v_cvt_pk_bf16_f32 v74, v96, v97
    v_cvt_pk_bf16_f32 v75, v98, v99
    v_cvt_pk_bf16_f32 v76, v76, v77
    v_cvt_pk_bf16_f32 v77, v78, v79
    v_cvt_pk_bf16_f32 v78, v100, v101
    v_cvt_pk_bf16_f32 v79, v102, v103
    ds_read_b128 v[104:107], v253 offset:0
    ds_read_b128 v[108:111], v253 offset:64
    v_max3_f32 v176, v144, v145, v146
    v_max3_f32 v184, -v144, -v145, -v146
    v_max3_f32 v178, v152, v153, v154
    v_max3_f32 v186, -v152, -v153, -v154
    v_max3_f32 v176, v176, v147, v148
    v_max3_f32 v184, v184, -v147, -v148
    v_max3_f32 v178, v178, v155, v156
    v_max3_f32 v186, v186, -v155, -v156
    v_max3_f32 v176, v176, v149, v150
    v_max3_f32 v184, v184, -v149, -v150
    v_max3_f32 v178, v178, v157, v158
    v_max3_f32 v186, v186, -v157, -v158
    v_max_f32_e64 v176, v176, v151
    v_max_f32_e64 v184, v184, -v151
    v_max_f32_e64 v178, v178, v159
    v_max_f32_e64 v186, v186, -v159
    s_nop 0
    v_permlane32_swap_b32 v176, v178
    v_permlane32_swap_b32_e64 v184, v186
    v_max3_f32 v180, v160, v161, v162
    v_max3_f32 v188, -v160, -v161, -v162
    v_max_f32 v176, v176, v178
    v_max_f32 v184, v184, v186
    v_max3_f32 v182, v168, v169, v170
    v_max3_f32 v190, -v168, -v169, -v170
    v_permlane16_swap_b32 v176, v184
    v_max_f32 v176, v176, v184
    v_max3_f32 v180, v180, v163, v164
    v_max3_f32 v188, v188, -v163, -v164
    v_mul_f32 v184, v176, v193
    v_mul_f32 v176, v176, v193
    v_max3_f32 v182, v182, v171, v172
    v_max3_f32 v190, v190, -v171, -v172
    v_permlane16_swap_b32 v176, v184
    v_mov_b32 v178, v176
    v_max3_f32 v180, v180, v165, v166
    v_max3_f32 v188, v188, -v165, -v166
    v_mov_b32_e64 v186, v184
    v_max3_f32 v182, v182, v173, v174
    v_max3_f32 v190, v190, -v173, -v174
    v_permlane32_swap_b32 v176, v178
    v_permlane32_swap_b32 v184, v186
    v_max_f32_e64 v180, v180, v167
    v_max_f32_e64 v188, v188, -v167
    v_max_f32_e64 v182, v182, v175
    v_max_f32_e64 v190, v190, -v175
    s_nop 0
    v_permlane32_swap_b32 v180, v182
    v_permlane32_swap_b32_e64 v188, v190
    v_pk_fma_f32 v[16:17], v[144:145], v[200:201], v[184:185] op_sel_hi:[1,0,0] neg_lo:[1,0,1] neg_hi:[1,0,1]
    v_pk_fma_f32 v[144:145], v[144:145], v[200:201], v[176:177] op_sel_hi:[1,0,0] neg_lo:[0,0,1] neg_hi:[0,0,1]
    v_max_f32 v180, v180, v182
    v_max_f32 v188, v188, v190
    v_pk_fma_f32 v[18:19], v[146:147], v[200:201], v[184:185] op_sel_hi:[1,0,0] neg_lo:[1,0,1] neg_hi:[1,0,1]
    v_pk_fma_f32 v[146:147], v[146:147], v[200:201], v[176:177] op_sel_hi:[1,0,0] neg_lo:[0,0,1] neg_hi:[0,0,1]
    v_permlane16_swap_b32 v180, v188
    v_max_f32 v180, v180, v188
    v_pk_fma_f32 v[20:21], v[148:149], v[200:201], v[184:185] op_sel_hi:[1,0,0] neg_lo:[1,0,1] neg_hi:[1,0,1]
    v_pk_fma_f32 v[148:149], v[148:149], v[200:201], v[176:177] op_sel_hi:[1,0,0] neg_lo:[0,0,1] neg_hi:[0,0,1]
    v_mul_f32 v188, v180, v221
    v_mul_f32 v180, v180, v221
    v_pk_fma_f32 v[22:23], v[150:151], v[200:201], v[184:185] op_sel_hi:[1,0,0] neg_lo:[1,0,1] neg_hi:[1,0,1]
    v_pk_fma_f32 v[150:151], v[150:151], v[200:201], v[176:177] op_sel_hi:[1,0,0] neg_lo:[0,0,1] neg_hi:[0,0,1]
    v_permlane16_swap_b32 v180, v188
    v_mov_b32 v182, v180
    v_pk_fma_f32 v[40:41], v[152:153], v[202:203], v[186:187] op_sel_hi:[1,0,0] neg_lo:[1,0,1] neg_hi:[1,0,1]
    v_pk_fma_f32 v[152:153], v[152:153], v[202:203], v[178:179] op_sel_hi:[1,0,0] neg_lo:[0,0,1] neg_hi:[0,0,1]
    v_mov_b32_e64 v190, v188
    v_pk_fma_f32 v[42:43], v[154:155], v[202:203], v[186:187] op_sel_hi:[1,0,0] neg_lo:[1,0,1] neg_hi:[1,0,1]
    v_pk_fma_f32 v[154:155], v[154:155], v[202:203], v[178:179] op_sel_hi:[1,0,0] neg_lo:[0,0,1] neg_hi:[0,0,1]
    v_permlane32_swap_b32 v180, v182
    v_permlane32_swap_b32 v188, v190
    v_pk_fma_f32 v[44:45], v[156:157], v[202:203], v[186:187] op_sel_hi:[1,0,0] neg_lo:[1,0,1] neg_hi:[1,0,1]
    v_pk_fma_f32 v[156:157], v[156:157], v[202:203], v[178:179] op_sel_hi:[1,0,0] neg_lo:[0,0,1] neg_hi:[0,0,1]
    v_pk_fma_f32 v[46:47], v[158:159], v[202:203], v[186:187] op_sel_hi:[1,0,0] neg_lo:[1,0,1] neg_hi:[1,0,1]
    v_pk_fma_f32 v[158:159], v[158:159], v[202:203], v[178:179] op_sel_hi:[1,0,0] neg_lo:[0,0,1] neg_hi:[0,0,1]
    v_exp_f32 v16, v16
    v_exp_f32 v144, v144
    v_exp_f32 v17, v17
    v_exp_f32 v145, v145
    v_exp_f32 v18, v18
    v_exp_f32 v146, v146
    v_exp_f32 v19, v19
    v_exp_f32 v147, v147
    v_exp_f32 v20, v20
    v_exp_f32 v148, v148
    v_exp_f32 v21, v21
    v_exp_f32 v149, v149
    v_exp_f32 v22, v22
    v_exp_f32 v150, v150
    v_exp_f32 v23, v23
    v_exp_f32 v151, v151
    v_exp_f32 v40, v40
    v_exp_f32 v152, v152
    v_exp_f32 v41, v41
    v_exp_f32 v153, v153
    v_exp_f32 v42, v42
    v_exp_f32 v154, v154
    v_exp_f32 v43, v43
    v_exp_f32 v155, v155
    v_exp_f32 v44, v44
    v_exp_f32 v156, v156
    v_exp_f32 v45, v45
    v_exp_f32 v157, v157
    v_exp_f32 v46, v46
    v_exp_f32 v158, v158
    v_exp_f32 v47, v47
    v_exp_f32 v159, v159
    v_pk_add_f32 v[128:129], v[144:145], v[146:147]
    v_pk_add_f32 v[130:131], v[16:17], v[18:19]
    v_pk_add_f32 v[132:133], v[152:153], v[154:155]
    v_pk_add_f32 v[134:135], v[40:41], v[42:43]
    v_pk_add_f32 v[128:129], v[128:129], v[148:149]
    v_pk_add_f32 v[130:131], v[130:131], v[20:21]
    v_pk_add_f32 v[132:133], v[132:133], v[156:157]
    v_pk_add_f32 v[134:135], v[134:135], v[44:45]
    v_pk_add_f32 v[128:129], v[128:129], v[150:151]
    v_pk_add_f32 v[130:131], v[130:131], v[22:23]
    v_pk_add_f32 v[132:133], v[132:133], v[158:159]
    v_pk_add_f32 v[134:135], v[134:135], v[46:47]
    v_add_f32 v176, v128, v129
    v_add_f32 v184, v130, v131
    v_add_f32 v178, v132, v133
    v_add_f32 v186, v134, v135
    s_nop 0
    v_permlane32_swap_b32 v176, v178
    v_permlane32_swap_b32_e64 v184, v186
    v_pk_fma_f32 v[64:65], v[160:161], v[220:221], v[188:189] op_sel_hi:[1,0,0] neg_lo:[1,0,1] neg_hi:[1,0,1]
    v_pk_fma_f32 v[160:161], v[160:161], v[220:221], v[180:181] op_sel_hi:[1,0,0] neg_lo:[0,0,1] neg_hi:[0,0,1]
    v_add_f32 v176, v176, v178
    v_add_f32 v184, v184, v186
    v_pk_fma_f32 v[66:67], v[162:163], v[220:221], v[188:189] op_sel_hi:[1,0,0] neg_lo:[1,0,1] neg_hi:[1,0,1]
    v_pk_fma_f32 v[162:163], v[162:163], v[220:221], v[180:181] op_sel_hi:[1,0,0] neg_lo:[0,0,1] neg_hi:[0,0,1]
    v_permlane16_swap_b32 v176, v184
    v_add_f32 v176, v176, v184
    v_pk_fma_f32 v[68:69], v[164:165], v[220:221], v[188:189] op_sel_hi:[1,0,0] neg_lo:[1,0,1] neg_hi:[1,0,1]
    v_pk_fma_f32 v[164:165], v[164:165], v[220:221], v[180:181] op_sel_hi:[1,0,0] neg_lo:[0,0,1] neg_hi:[0,0,1]
    v_rcp_f32_e64 v176, v176
    v_pk_fma_f32 v[70:71], v[166:167], v[220:221], v[188:189] op_sel_hi:[1,0,0] neg_lo:[1,0,1] neg_hi:[1,0,1]
    v_pk_fma_f32 v[166:167], v[166:167], v[220:221], v[180:181] op_sel_hi:[1,0,0] neg_lo:[0,0,1] neg_hi:[0,0,1]
    v_mul_f32 v184, v176, v195
    v_mul_f32 v176, v176, v195
    v_pk_fma_f32 v[88:89], v[168:169], v[222:223], v[190:191] op_sel_hi:[1,0,0] neg_lo:[1,0,1] neg_hi:[1,0,1]
    v_pk_fma_f32 v[168:169], v[168:169], v[222:223], v[182:183] op_sel_hi:[1,0,0] neg_lo:[0,0,1] neg_hi:[0,0,1]
    v_permlane16_swap_b32 v176, v184
    v_mov_b32 v178, v176
    v_pk_fma_f32 v[90:91], v[170:171], v[222:223], v[190:191] op_sel_hi:[1,0,0] neg_lo:[1,0,1] neg_hi:[1,0,1]
    v_pk_fma_f32 v[170:171], v[170:171], v[222:223], v[182:183] op_sel_hi:[1,0,0] neg_lo:[0,0,1] neg_hi:[0,0,1]
    v_mov_b32_e64 v186, v184
    v_pk_fma_f32 v[92:93], v[172:173], v[222:223], v[190:191] op_sel_hi:[1,0,0] neg_lo:[1,0,1] neg_hi:[1,0,1]
    v_pk_fma_f32 v[172:173], v[172:173], v[222:223], v[182:183] op_sel_hi:[1,0,0] neg_lo:[0,0,1] neg_hi:[0,0,1]
    v_permlane32_swap_b32 v176, v178
    v_permlane32_swap_b32 v184, v186
    v_pk_fma_f32 v[94:95], v[174:175], v[222:223], v[190:191] op_sel_hi:[1,0,0] neg_lo:[1,0,1] neg_hi:[1,0,1]
    v_pk_fma_f32 v[174:175], v[174:175], v[222:223], v[182:183] op_sel_hi:[1,0,0] neg_lo:[0,0,1] neg_hi:[0,0,1]
    v_pk_mul_f32 v[144:145], v[144:145], v[176:177] op_sel_hi:[1,0]
    v_pk_mul_f32 v[146:147], v[146:147], v[176:177] op_sel_hi:[1,0]
    v_pk_mul_f32 v[148:149], v[148:149], v[176:177] op_sel_hi:[1,0]
    v_pk_mul_f32 v[150:151], v[150:151], v[176:177] op_sel_hi:[1,0]
    v_cvt_pk_bf16_f32 v144, v144, v145
    v_cvt_pk_bf16_f32 v145, v146, v147
    v_cvt_pk_bf16_f32 v146, v148, v149
    v_cvt_pk_bf16_f32 v147, v150, v151
    ds_write_b64 v4, v[144:145] offset:0
    ds_write_b64 v5, v[146:147] offset:0
    ds_write_b128 v197, v[24:27] offset:0
    v_pk_mul_f32 v[16:17], v[16:17], v[184:185] op_sel_hi:[1,0]
    v_pk_mul_f32 v[18:19], v[18:19], v[184:185] op_sel_hi:[1,0]
    v_pk_mul_f32 v[20:21], v[20:21], v[184:185] op_sel_hi:[1,0]
    v_pk_mul_f32 v[22:23], v[22:23], v[184:185] op_sel_hi:[1,0]
    v_cvt_pk_bf16_f32 v16, v16, v17
    v_cvt_pk_bf16_f32 v17, v18, v19
    v_cvt_pk_bf16_f32 v18, v20, v21
    v_cvt_pk_bf16_f32 v19, v22, v23
    ds_write_b64 v6, v[16:17] offset:0
    ds_write_b64 v7, v[18:19] offset:0
    ds_write_b128 v197, v[28:31] offset:1024
    v_pk_mul_f32 v[152:153], v[152:153], v[178:179] op_sel_hi:[1,0]
    v_pk_mul_f32 v[154:155], v[154:155], v[178:179] op_sel_hi:[1,0]
    v_pk_mul_f32 v[156:157], v[156:157], v[178:179] op_sel_hi:[1,0]
    v_pk_mul_f32 v[158:159], v[158:159], v[178:179] op_sel_hi:[1,0]
    v_cvt_pk_bf16_f32 v152, v152, v153
    v_cvt_pk_bf16_f32 v153, v154, v155
    v_cvt_pk_bf16_f32 v154, v156, v157
    v_cvt_pk_bf16_f32 v155, v158, v159
    ds_write_b64 v4, v[152:153] offset:2048
    ds_write_b64 v5, v[154:155] offset:2048
    ds_write_b128 v197, v[72:75] offset:2048
    v_pk_mul_f32 v[40:41], v[40:41], v[186:187] op_sel_hi:[1,0]
    v_pk_mul_f32 v[42:43], v[42:43], v[186:187] op_sel_hi:[1,0]
    v_pk_mul_f32 v[44:45], v[44:45], v[186:187] op_sel_hi:[1,0]
    v_pk_mul_f32 v[46:47], v[46:47], v[186:187] op_sel_hi:[1,0]
    v_cvt_pk_bf16_f32 v40, v40, v41
    v_cvt_pk_bf16_f32 v41, v42, v43
    v_cvt_pk_bf16_f32 v42, v44, v45
    v_cvt_pk_bf16_f32 v43, v46, v47
    ds_write_b64 v6, v[40:41] offset:2048
    ds_write_b64 v7, v[42:43] offset:2048
    ds_write_b128 v197, v[76:79] offset:3072
    ds_read_b64_tr_b16 v[232:233], v201 offset:0
    ds_read_b64_tr_b16 v[234:235], v201 offset:2048
    ds_read_b64_tr_b16 v[236:237], v203 offset:0
    ds_read_b64_tr_b16 v[238:239], v203 offset:2048
    v_exp_f32 v64, v64
    v_exp_f32 v160, v160
    v_exp_f32 v65, v65
    v_exp_f32 v161, v161
    v_exp_f32 v66, v66
    v_exp_f32 v162, v162
    v_exp_f32 v67, v67
    v_exp_f32 v163, v163
    v_exp_f32 v68, v68
    v_exp_f32 v164, v164
    v_exp_f32 v69, v69
    v_exp_f32 v165, v165
    v_exp_f32 v70, v70
    v_exp_f32 v166, v166
    v_exp_f32 v71, v71
    v_exp_f32 v167, v167
    v_exp_f32 v88, v88
    v_exp_f32 v168, v168
    v_exp_f32 v89, v89
    v_exp_f32 v169, v169
    v_exp_f32 v90, v90
    v_exp_f32 v170, v170
    v_exp_f32 v91, v91
    v_exp_f32 v171, v171
    v_exp_f32 v92, v92
    v_exp_f32 v172, v172
    v_exp_f32 v93, v93
    v_exp_f32 v173, v173
    v_exp_f32 v94, v94
    v_exp_f32 v174, v174
    v_exp_f32 v95, v95
    v_exp_f32 v175, v175
    s_mov_b64 exec, 1
    buffer_store_dword v251, v199, s[48:51], s76 offen sc1
    s_mov_b64 exec, -1
    v_pk_add_f32 v[136:137], v[160:161], v[162:163]
    v_pk_add_f32 v[138:139], v[64:65], v[66:67]
    v_pk_add_f32 v[140:141], v[168:169], v[170:171]
    v_pk_add_f32 v[142:143], v[88:89], v[90:91]
    v_pk_add_f32 v[136:137], v[136:137], v[164:165]
    v_pk_add_f32 v[138:139], v[138:139], v[68:69]
    v_pk_add_f32 v[140:141], v[140:141], v[172:173]
    v_pk_add_f32 v[142:143], v[142:143], v[92:93]
    v_pk_add_f32 v[136:137], v[136:137], v[166:167]
    v_pk_add_f32 v[138:139], v[138:139], v[70:71]
    v_pk_add_f32 v[140:141], v[140:141], v[174:175]
    v_pk_add_f32 v[142:143], v[142:143], v[94:95]
    v_add_f32 v180, v136, v137
    v_add_f32 v188, v138, v139
    v_add_f32 v182, v140, v141
    v_add_f32 v190, v142, v143
    s_nop 0
    v_permlane32_swap_b32 v180, v182
    v_permlane32_swap_b32 v188, v190
    s_waitcnt lgkmcnt(0)
    s_nop 0
    v_mfma_f32_16x16x32_bf16 v[144:147], v[232:235], v[24:27], 0
    v_add_f32 v180, v180, v182
    v_add_f32 v188, v188, v190
    v_mfma_f32_16x16x32_bf16 v[148:151], v[236:239], v[24:27], 0
    s_nop 0
    v_permlane16_swap_b32 v180, v188
    v_add_f32 v180, v180, v188
    v_mfma_f32_16x16x32_bf16 v[152:155], v[232:235], v[28:31], 0
    v_rcp_f32_e64 v180, v180
    v_mfma_f32_16x16x32_bf16 v[156:159], v[236:239], v[28:31], 0
    v_mul_f32 v188, v180, v223
    v_mul_f32 v180, v180, v223
    v_mfma_f32_16x16x32_bf16 v[16:19], v[232:235], v[120:123], 0
    s_nop 0
    v_permlane16_swap_b32 v180, v188
    v_mov_b32_e64 v182, v180
    v_mfma_f32_16x16x32_bf16 v[20:23], v[236:239], v[120:123], 0
    v_mov_b32_e64 v190, v188
    v_permlane32_swap_b32 v180, v182
    s_nop 0
    v_permlane32_swap_b32_e64 v188, v190
    v_pk_mul_f32 v[160:161], v[160:161], v[180:181] op_sel_hi:[1,0]
    v_pk_mul_f32 v[162:163], v[162:163], v[180:181] op_sel_hi:[1,0]
    v_pk_mul_f32 v[164:165], v[164:165], v[180:181] op_sel_hi:[1,0]
    v_pk_mul_f32 v[166:167], v[166:167], v[180:181] op_sel_hi:[1,0]
    v_cvt_pk_bf16_f32 v160, v160, v161
    v_cvt_pk_bf16_f32 v161, v162, v163
    v_cvt_pk_bf16_f32 v162, v164, v165
    v_cvt_pk_bf16_f32 v163, v166, v167
    ds_write_b64 v4, v[160:161] offset:4096
    ds_write_b64 v5, v[162:163] offset:4096
    v_pk_mul_f32 v[64:65], v[64:65], v[188:189] op_sel_hi:[1,0]
    v_pk_mul_f32 v[66:67], v[66:67], v[188:189] op_sel_hi:[1,0]
    v_pk_mul_f32 v[68:69], v[68:69], v[188:189] op_sel_hi:[1,0]
    v_pk_mul_f32 v[70:71], v[70:71], v[188:189] op_sel_hi:[1,0]
    v_cvt_pk_bf16_f32 v64, v64, v65
    v_cvt_pk_bf16_f32 v65, v66, v67
    v_cvt_pk_bf16_f32 v66, v68, v69
    v_cvt_pk_bf16_f32 v67, v70, v71
    ds_write_b64 v6, v[64:65] offset:4096
    ds_write_b64 v7, v[66:67] offset:4096
    v_pk_mul_f32 v[168:169], v[168:169], v[182:183] op_sel_hi:[1,0]
    v_pk_mul_f32 v[170:171], v[170:171], v[182:183] op_sel_hi:[1,0]
    v_pk_mul_f32 v[172:173], v[172:173], v[182:183] op_sel_hi:[1,0]
    v_pk_mul_f32 v[174:175], v[174:175], v[182:183] op_sel_hi:[1,0]
    v_cvt_pk_bf16_f32 v168, v168, v169
    v_cvt_pk_bf16_f32 v169, v170, v171
    v_cvt_pk_bf16_f32 v170, v172, v173
    v_cvt_pk_bf16_f32 v171, v174, v175
    ds_write_b64 v4, v[168:169] offset:6144
    ds_write_b64 v5, v[170:171] offset:6144
    v_pk_mul_f32 v[88:89], v[88:89], v[190:191] op_sel_hi:[1,0]
    v_pk_mul_f32 v[90:91], v[90:91], v[190:191] op_sel_hi:[1,0]
    v_pk_mul_f32 v[92:93], v[92:93], v[190:191] op_sel_hi:[1,0]
    v_pk_mul_f32 v[94:95], v[94:95], v[190:191] op_sel_hi:[1,0]
    v_cvt_pk_bf16_f32 v88, v88, v89
    v_cvt_pk_bf16_f32 v89, v90, v91
    v_cvt_pk_bf16_f32 v90, v92, v93
    v_cvt_pk_bf16_f32 v91, v94, v95
    ds_write_b64 v6, v[88:89] offset:6144
    ds_write_b64 v7, v[90:91] offset:6144
    ds_read_b64_tr_b16 v[240:241], v201 offset:4096
    ds_read_b64_tr_b16 v[242:243], v201 offset:6144
    ds_read_b64_tr_b16 v[244:245], v203 offset:4096
    ds_read_b64_tr_b16 v[246:247], v203 offset:6144
    v_xor_b32 v201, 0x2000, v201
    v_xor_b32 v203, 0x2000, v203
    v_xor_b32 v197, 0x1000, v197
    s_waitcnt lgkmcnt(4)
    s_barrier
    ds_read_b64_tr_b16 v[128:129], v201 offset:0
    ds_read_b64_tr_b16 v[130:131], v201 offset:2048
    ds_read_b64_tr_b16 v[132:133], v203 offset:0
    ds_read_b64_tr_b16 v[134:135], v203 offset:2048
    ds_read_b128 v[48:51], v197 offset:0
    ds_read_b128 v[52:55], v197 offset:1024
    ds_read_b64_tr_b16 v[136:137], v201 offset:4096
    ds_read_b64_tr_b16 v[138:139], v201 offset:6144
    ds_read_b64_tr_b16 v[140:141], v203 offset:4096
    ds_read_b64_tr_b16 v[142:143], v203 offset:6144
    ds_read_b128 v[96:99], v197 offset:2048
    ds_read_b128 v[100:103], v197 offset:3072
    s_waitcnt lgkmcnt(12)
    s_nop 0
    v_mfma_f32_16x16x32_bf16 v[144:147], v[240:243], v[72:75], v[144:147]
    v_mfma_f32_16x16x32_bf16 v[148:151], v[244:247], v[72:75], v[148:151]
    v_mfma_f32_16x16x32_bf16 v[152:155], v[240:243], v[76:79], v[152:155]
    v_mfma_f32_16x16x32_bf16 v[156:159], v[244:247], v[76:79], v[156:159]
    v_mfma_f32_16x16x32_bf16 v[16:19], v[240:243], v[124:127], v[16:19]
    v_mfma_f32_16x16x32_bf16 v[20:23], v[244:247], v[124:127], v[20:23]
    s_waitcnt lgkmcnt(6)
    s_nop 0
    v_mfma_f32_16x16x32_bf16 v[144:147], v[128:131], v[48:51], v[144:147]
    v_mfma_f32_16x16x32_bf16 v[148:151], v[132:135], v[48:51], v[148:151]
    v_mfma_f32_16x16x32_bf16 v[152:155], v[128:131], v[52:55], v[152:155]
    v_mfma_f32_16x16x32_bf16 v[156:159], v[132:135], v[52:55], v[156:159]
    v_mfma_f32_16x16x32_bf16 v[16:19], v[128:131], v[104:107], v[16:19]
    v_mfma_f32_16x16x32_bf16 v[20:23], v[132:135], v[104:107], v[20:23]
    s_waitcnt lgkmcnt(0)
    s_nop 0
    v_mfma_f32_16x16x32_bf16 v[144:147], v[136:139], v[96:99], v[144:147]
    v_mfma_f32_16x16x32_bf16 v[148:151], v[140:143], v[96:99], v[148:151]
    v_mfma_f32_16x16x32_bf16 v[152:155], v[136:139], v[100:103], v[152:155]
    v_mfma_f32_16x16x32_bf16 v[156:159], v[140:143], v[100:103], v[156:159]
    v_mfma_f32_16x16x32_bf16 v[16:19], v[136:139], v[108:111], v[16:19]
    v_mfma_f32_16x16x32_bf16 v[20:23], v[140:143], v[108:111], v[20:23]
    ds_read_b64_tr_b16 v[224:225], v252 offset:8192
    ds_read_b64_tr_b16 v[226:227], v252 offset:9216
    ds_read_b64_tr_b16 v[228:229], v252 offset:8224
    ds_read_b64_tr_b16 v[230:231], v252 offset:9248
    s_xor_b32 s67, s67, 8
    s_lshl_b32 s3, s38, 2
    s_add_u32 s3, s3, 162112
    v_mov_b32 v4, s3
    v_mov_b32 v5, 1
    v_cvt_pk_bf16_f32 v144, v144, v145
    v_cvt_pk_bf16_f32 v145, v146, v147
    v_cvt_pk_bf16_f32 v146, v148, v149
    v_cvt_pk_bf16_f32 v147, v150, v151
    buffer_store_dwordx4 v[144:147], v199, s[48:51], s74 offen offset:0 sc1
    v_cvt_pk_bf16_f32 v152, v152, v153
    v_cvt_pk_bf16_f32 v153, v154, v155
    v_cvt_pk_bf16_f32 v154, v156, v157
    v_cvt_pk_bf16_f32 v155, v158, v159
    buffer_store_dwordx4 v[152:155], v199, s[48:51], s74 offen offset:1024 sc1
    v_cvt_pk_bf16_f32 v16, v16, v17
    v_cvt_pk_bf16_f32 v17, v18, v19
    v_cvt_pk_bf16_f32 v18, v20, v21
    v_cvt_pk_bf16_f32 v19, v22, v23
    s_mov_b32 exec_lo, 0x00010001
    s_mov_b32 exec_hi, 0x00010001
    buffer_store_dwordx4 v[16:19], v1, s[48:51], s75 offen sc1
    s_mov_b64 exec, -1
    ds_write_b32 v4, v5
    s_setprio 0
    v_pk_fma_f32 v[8:9], v[192:193], v[212:213], v[8:9] op_sel_hi:[0,1,1] neg_lo:[1,0,0] neg_hi:[1,0,0]
    v_pk_fma_f32 v[10:11], v[192:193], v[214:215], v[10:11] op_sel_hi:[0,1,1] neg_lo:[1,0,0] neg_hi:[1,0,0]
    v_pk_fma_f32 v[12:13], v[192:193], v[216:217], v[12:13] op_sel_hi:[0,1,1] neg_lo:[1,0,0] neg_hi:[1,0,0]
    v_pk_fma_f32 v[14:15], v[192:193], v[218:219], v[14:15] op_sel_hi:[0,1,1] neg_lo:[1,0,0] neg_hi:[1,0,0]
    v_cvt_pk_bf16_f32 v232, v8, v9
    v_cvt_pk_bf16_f32 v233, v10, v11
    v_cvt_pk_bf16_f32 v234, v12, v13
    v_cvt_pk_bf16_f32 v235, v14, v15
    v_pk_fma_f32 v[32:33], v[194:195], v[212:213], v[32:33] op_sel_hi:[0,1,1] neg_lo:[1,0,0] neg_hi:[1,0,0]
    v_pk_fma_f32 v[34:35], v[194:195], v[214:215], v[34:35] op_sel_hi:[0,1,1] neg_lo:[1,0,0] neg_hi:[1,0,0]
    v_pk_fma_f32 v[36:37], v[194:195], v[216:217], v[36:37] op_sel_hi:[0,1,1] neg_lo:[1,0,0] neg_hi:[1,0,0]
    v_pk_fma_f32 v[38:39], v[194:195], v[218:219], v[38:39] op_sel_hi:[0,1,1] neg_lo:[1,0,0] neg_hi:[1,0,0]
    v_cvt_pk_bf16_f32 v236, v32, v33
    v_cvt_pk_bf16_f32 v237, v34, v35
    v_cvt_pk_bf16_f32 v238, v36, v37
    v_cvt_pk_bf16_f32 v239, v38, v39
    v_pk_fma_f32 v[56:57], v[196:197], v[212:213], v[56:57] op_sel_hi:[0,1,1] neg_lo:[1,0,0] neg_hi:[1,0,0]
    v_pk_fma_f32 v[58:59], v[196:197], v[214:215], v[58:59] op_sel_hi:[0,1,1] neg_lo:[1,0,0] neg_hi:[1,0,0]
    v_pk_fma_f32 v[60:61], v[196:197], v[216:217], v[60:61] op_sel_hi:[0,1,1] neg_lo:[1,0,0] neg_hi:[1,0,0]
    v_pk_fma_f32 v[62:63], v[196:197], v[218:219], v[62:63] op_sel_hi:[0,1,1] neg_lo:[1,0,0] neg_hi:[1,0,0]
    v_cvt_pk_bf16_f32 v240, v56, v57
    v_cvt_pk_bf16_f32 v241, v58, v59
    v_cvt_pk_bf16_f32 v242, v60, v61
    v_cvt_pk_bf16_f32 v243, v62, v63
    v_pk_fma_f32 v[80:81], v[198:199], v[212:213], v[80:81] op_sel_hi:[0,1,1] neg_lo:[1,0,0] neg_hi:[1,0,0]
    v_pk_fma_f32 v[82:83], v[198:199], v[214:215], v[82:83] op_sel_hi:[0,1,1] neg_lo:[1,0,0] neg_hi:[1,0,0]
    v_pk_fma_f32 v[84:85], v[198:199], v[216:217], v[84:85] op_sel_hi:[0,1,1] neg_lo:[1,0,0] neg_hi:[1,0,0]
    v_pk_fma_f32 v[86:87], v[198:199], v[218:219], v[86:87] op_sel_hi:[0,1,1] neg_lo:[1,0,0] neg_hi:[1,0,0]
    v_cvt_pk_bf16_f32 v244, v80, v81
    v_cvt_pk_bf16_f32 v245, v82, v83
    v_cvt_pk_bf16_f32 v246, v84, v85
    v_cvt_pk_bf16_f32 v247, v86, v87
    s_waitcnt lgkmcnt(1)
    s_nop 0
    v_mfma_f32_16x16x32_bf16 v[144:147], v[224:227], v[232:235], 0
    v_mfma_f32_16x16x32_bf16 v[148:151], v[228:231], v[232:235], 0
    v_mfma_f32_16x16x32_bf16 v[152:155], v[224:227], v[236:239], 0
    v_mfma_f32_16x16x32_bf16 v[156:159], v[228:231], v[236:239], 0
    v_mfma_f32_16x16x32_bf16 v[160:163], v[224:227], v[240:243], 0
    v_mfma_f32_16x16x32_bf16 v[164:167], v[228:231], v[240:243], 0
    v_mfma_f32_16x16x32_bf16 v[168:171], v[224:227], v[244:247], 0
    v_mfma_f32_16x16x32_bf16 v[172:175], v[228:231], v[244:247], 0
    s_nop 0
    s_nop 0
    v_max3_f32 v176, v144, v145, v146
    v_max3_f32 v184, -v144, -v145, -v146
    v_max3_f32 v178, v152, v153, v154
    v_max3_f32 v186, -v152, -v153, -v154
    v_max3_f32 v176, v176, v147, v148
    v_max3_f32 v184, v184, -v147, -v148
    v_max3_f32 v178, v178, v155, v156
    v_max3_f32 v186, v186, -v155, -v156
    v_max3_f32 v176, v176, v149, v150
    v_max3_f32 v184, v184, -v149, -v150
    v_max3_f32 v178, v178, v157, v158
    v_max3_f32 v186, v186, -v157, -v158
    v_max_f32_e64 v176, v176, v151
    v_max_f32_e64 v184, v184, -v151
    v_max_f32_e64 v178, v178, v159
    v_max_f32_e64 v186, v186, -v159
    s_nop 0
    v_permlane32_swap_b32 v176, v178
    v_permlane32_swap_b32_e64 v184, v186
    v_max3_f32 v180, v160, v161, v162
    v_max3_f32 v188, -v160, -v161, -v162
    v_max_f32 v176, v176, v178
    v_max_f32 v184, v184, v186
    v_max3_f32 v182, v168, v169, v170
    v_max3_f32 v190, -v168, -v169, -v170
    v_permlane16_swap_b32 v176, v184
    v_max_f32 v176, v176, v184
    v_max3_f32 v180, v180, v163, v164
    v_max3_f32 v188, v188, -v163, -v164
    v_mul_f32 v184, v176, v193
    v_mul_f32 v176, v176, v193
    v_max3_f32 v182, v182, v171, v172
    v_max3_f32 v190, v190, -v171, -v172
    v_permlane16_swap_b32 v176, v184
    v_mov_b32 v178, v176
    v_max3_f32 v180, v180, v165, v166
    v_max3_f32 v188, v188, -v165, -v166
    v_mov_b32_e64 v186, v184
    v_max3_f32 v182, v182, v173, v174
    v_max3_f32 v190, v190, -v173, -v174
    v_permlane32_swap_b32 v176, v178
    v_permlane32_swap_b32 v184, v186
    v_max_f32_e64 v180, v180, v167
    v_max_f32_e64 v188, v188, -v167
    v_max_f32_e64 v182, v182, v175
    v_max_f32_e64 v190, v190, -v175
    s_nop 0
    v_permlane32_swap_b32 v180, v182
    v_permlane32_swap_b32_e64 v188, v190
    v_pk_fma_f32 v[8:9], v[144:145], v[200:201], v[184:185] op_sel_hi:[1,0,0] neg_lo:[1,0,1] neg_hi:[1,0,1]
    v_pk_fma_f32 v[144:145], v[144:145], v[200:201], v[176:177] op_sel_hi:[1,0,0] neg_lo:[0,0,1] neg_hi:[0,0,1]
    v_max_f32 v180, v180, v182
    v_max_f32 v188, v188, v190
    v_pk_fma_f32 v[10:11], v[146:147], v[200:201], v[184:185] op_sel_hi:[1,0,0] neg_lo:[1,0,1] neg_hi:[1,0,1]
    v_pk_fma_f32 v[146:147], v[146:147], v[200:201], v[176:177] op_sel_hi:[1,0,0] neg_lo:[0,0,1] neg_hi:[0,0,1]
    v_permlane16_swap_b32 v180, v188
    v_max_f32 v180, v180, v188
    v_pk_fma_f32 v[12:13], v[148:149], v[200:201], v[184:185] op_sel_hi:[1,0,0] neg_lo:[1,0,1] neg_hi:[1,0,1]
    v_pk_fma_f32 v[148:149], v[148:149], v[200:201], v[176:177] op_sel_hi:[1,0,0] neg_lo:[0,0,1] neg_hi:[0,0,1]
    v_mul_f32 v188, v180, v221
    v_mul_f32 v180, v180, v221
    v_pk_fma_f32 v[14:15], v[150:151], v[200:201], v[184:185] op_sel_hi:[1,0,0] neg_lo:[1,0,1] neg_hi:[1,0,1]
    v_pk_fma_f32 v[150:151], v[150:151], v[200:201], v[176:177] op_sel_hi:[1,0,0] neg_lo:[0,0,1] neg_hi:[0,0,1]
    v_permlane16_swap_b32 v180, v188
    v_mov_b32 v182, v180
    v_pk_fma_f32 v[32:33], v[152:153], v[202:203], v[186:187] op_sel_hi:[1,0,0] neg_lo:[1,0,1] neg_hi:[1,0,1]
    v_pk_fma_f32 v[152:153], v[152:153], v[202:203], v[178:179] op_sel_hi:[1,0,0] neg_lo:[0,0,1] neg_hi:[0,0,1]
    v_mov_b32_e64 v190, v188
    v_pk_fma_f32 v[34:35], v[154:155], v[202:203], v[186:187] op_sel_hi:[1,0,0] neg_lo:[1,0,1] neg_hi:[1,0,1]
    v_pk_fma_f32 v[154:155], v[154:155], v[202:203], v[178:179] op_sel_hi:[1,0,0] neg_lo:[0,0,1] neg_hi:[0,0,1]
    v_permlane32_swap_b32 v180, v182
    v_permlane32_swap_b32 v188, v190
    v_pk_fma_f32 v[36:37], v[156:157], v[202:203], v[186:187] op_sel_hi:[1,0,0] neg_lo:[1,0,1] neg_hi:[1,0,1]
    v_pk_fma_f32 v[156:157], v[156:157], v[202:203], v[178:179] op_sel_hi:[1,0,0] neg_lo:[0,0,1] neg_hi:[0,0,1]
    v_pk_fma_f32 v[38:39], v[158:159], v[202:203], v[186:187] op_sel_hi:[1,0,0] neg_lo:[1,0,1] neg_hi:[1,0,1]
    v_pk_fma_f32 v[158:159], v[158:159], v[202:203], v[178:179] op_sel_hi:[1,0,0] neg_lo:[0,0,1] neg_hi:[0,0,1]
    v_exp_f32 v8, v8
    v_exp_f32 v144, v144
    v_exp_f32 v9, v9
    v_exp_f32 v145, v145
    v_exp_f32 v10, v10
    v_exp_f32 v146, v146
    v_exp_f32 v11, v11
    v_exp_f32 v147, v147
    v_exp_f32 v12, v12
    v_exp_f32 v148, v148
    v_exp_f32 v13, v13
    v_exp_f32 v149, v149
    v_exp_f32 v14, v14
    v_exp_f32 v150, v150
    v_exp_f32 v15, v15
    v_exp_f32 v151, v151
    v_exp_f32 v32, v32
    v_exp_f32 v152, v152
    v_exp_f32 v33, v33
    v_exp_f32 v153, v153
    v_exp_f32 v34, v34
    v_exp_f32 v154, v154
    v_exp_f32 v35, v35
    v_exp_f32 v155, v155
    v_exp_f32 v36, v36
    v_exp_f32 v156, v156
    v_exp_f32 v37, v37
    v_exp_f32 v157, v157
    v_exp_f32 v38, v38
    v_exp_f32 v158, v158
    v_exp_f32 v39, v39
    v_exp_f32 v159, v159
    v_pk_add_f32 v[128:129], v[144:145], v[146:147]
    v_pk_add_f32 v[130:131], v[8:9], v[10:11]
    v_pk_add_f32 v[132:133], v[152:153], v[154:155]
    v_pk_add_f32 v[134:135], v[32:33], v[34:35]
    v_pk_add_f32 v[128:129], v[128:129], v[148:149]
    v_pk_add_f32 v[130:131], v[130:131], v[12:13]
    v_pk_add_f32 v[132:133], v[132:133], v[156:157]
    v_pk_add_f32 v[134:135], v[134:135], v[36:37]
    v_pk_add_f32 v[128:129], v[128:129], v[150:151]
    v_pk_add_f32 v[130:131], v[130:131], v[14:15]
    v_pk_add_f32 v[132:133], v[132:133], v[158:159]
    v_pk_add_f32 v[134:135], v[134:135], v[38:39]
    v_add_f32 v176, v128, v129
    v_add_f32 v184, v130, v131
    v_add_f32 v178, v132, v133
    v_add_f32 v186, v134, v135
    s_nop 0
    v_permlane32_swap_b32 v176, v178
    v_permlane32_swap_b32_e64 v184, v186
    v_pk_fma_f32 v[56:57], v[160:161], v[220:221], v[188:189] op_sel_hi:[1,0,0] neg_lo:[1,0,1] neg_hi:[1,0,1]
    v_pk_fma_f32 v[160:161], v[160:161], v[220:221], v[180:181] op_sel_hi:[1,0,0] neg_lo:[0,0,1] neg_hi:[0,0,1]
    v_add_f32 v176, v176, v178
    v_add_f32 v184, v184, v186
    v_pk_fma_f32 v[58:59], v[162:163], v[220:221], v[188:189] op_sel_hi:[1,0,0] neg_lo:[1,0,1] neg_hi:[1,0,1]
    v_pk_fma_f32 v[162:163], v[162:163], v[220:221], v[180:181] op_sel_hi:[1,0,0] neg_lo:[0,0,1] neg_hi:[0,0,1]
    v_permlane16_swap_b32 v176, v184
    v_add_f32 v176, v176, v184
    v_pk_fma_f32 v[60:61], v[164:165], v[220:221], v[188:189] op_sel_hi:[1,0,0] neg_lo:[1,0,1] neg_hi:[1,0,1]
    v_pk_fma_f32 v[164:165], v[164:165], v[220:221], v[180:181] op_sel_hi:[1,0,0] neg_lo:[0,0,1] neg_hi:[0,0,1]
    v_rcp_f32_e64 v176, v176
    v_pk_fma_f32 v[62:63], v[166:167], v[220:221], v[188:189] op_sel_hi:[1,0,0] neg_lo:[1,0,1] neg_hi:[1,0,1]
    v_pk_fma_f32 v[166:167], v[166:167], v[220:221], v[180:181] op_sel_hi:[1,0,0] neg_lo:[0,0,1] neg_hi:[0,0,1]
    v_mov_b32_e64 v184, v176
    v_pk_fma_f32 v[80:81], v[168:169], v[222:223], v[190:191] op_sel_hi:[1,0,0] neg_lo:[1,0,1] neg_hi:[1,0,1]
    v_pk_fma_f32 v[168:169], v[168:169], v[222:223], v[182:183] op_sel_hi:[1,0,0] neg_lo:[0,0,1] neg_hi:[0,0,1]
    v_permlane16_swap_b32 v176, v184
    v_mov_b32 v178, v176
    v_pk_fma_f32 v[82:83], v[170:171], v[222:223], v[190:191] op_sel_hi:[1,0,0] neg_lo:[1,0,1] neg_hi:[1,0,1]
    v_pk_fma_f32 v[170:171], v[170:171], v[222:223], v[182:183] op_sel_hi:[1,0,0] neg_lo:[0,0,1] neg_hi:[0,0,1]
    v_mov_b32_e64 v186, v184
    v_pk_fma_f32 v[84:85], v[172:173], v[222:223], v[190:191] op_sel_hi:[1,0,0] neg_lo:[1,0,1] neg_hi:[1,0,1]
    v_pk_fma_f32 v[172:173], v[172:173], v[222:223], v[182:183] op_sel_hi:[1,0,0] neg_lo:[0,0,1] neg_hi:[0,0,1]
    v_permlane32_swap_b32 v176, v178
    v_permlane32_swap_b32 v184, v186
    v_pk_fma_f32 v[86:87], v[174:175], v[222:223], v[190:191] op_sel_hi:[1,0,0] neg_lo:[1,0,1] neg_hi:[1,0,1]
    v_pk_fma_f32 v[174:175], v[174:175], v[222:223], v[182:183] op_sel_hi:[1,0,0] neg_lo:[0,0,1] neg_hi:[0,0,1]
    v_pk_mul_f32 v[144:145], v[144:145], v[176:177] op_sel_hi:[1,0]
    v_pk_mul_f32 v[146:147], v[146:147], v[176:177] op_sel_hi:[1,0]
    v_pk_mul_f32 v[148:149], v[148:149], v[176:177] op_sel_hi:[1,0]
    v_pk_mul_f32 v[150:151], v[150:151], v[176:177] op_sel_hi:[1,0]
    v_cvt_pk_bf16_f32 v144, v144, v145
    v_cvt_pk_bf16_f32 v145, v146, v147
    v_cvt_pk_bf16_f32 v146, v148, v149
    v_cvt_pk_bf16_f32 v147, v150, v151
    v_pk_mul_f32 v[8:9], v[8:9], v[184:185] op_sel_hi:[1,0]
    v_pk_mul_f32 v[10:11], v[10:11], v[184:185] op_sel_hi:[1,0]
    v_pk_mul_f32 v[12:13], v[12:13], v[184:185] op_sel_hi:[1,0]
    v_pk_mul_f32 v[14:15], v[14:15], v[184:185] op_sel_hi:[1,0]
    v_cvt_pk_bf16_f32 v8, v8, v9
    v_cvt_pk_bf16_f32 v9, v10, v11
    v_cvt_pk_bf16_f32 v10, v12, v13
    v_cvt_pk_bf16_f32 v11, v14, v15
    v_pk_mul_f32 v[152:153], v[152:153], v[178:179] op_sel_hi:[1,0]
    v_pk_mul_f32 v[154:155], v[154:155], v[178:179] op_sel_hi:[1,0]
    v_pk_mul_f32 v[156:157], v[156:157], v[178:179] op_sel_hi:[1,0]
    v_pk_mul_f32 v[158:159], v[158:159], v[178:179] op_sel_hi:[1,0]
    v_cvt_pk_bf16_f32 v152, v152, v153
    v_cvt_pk_bf16_f32 v153, v154, v155
    v_cvt_pk_bf16_f32 v154, v156, v157
    v_cvt_pk_bf16_f32 v155, v158, v159
    v_pk_mul_f32 v[32:33], v[32:33], v[186:187] op_sel_hi:[1,0]
    v_pk_mul_f32 v[34:35], v[34:35], v[186:187] op_sel_hi:[1,0]
    v_pk_mul_f32 v[36:37], v[36:37], v[186:187] op_sel_hi:[1,0]
    v_pk_mul_f32 v[38:39], v[38:39], v[186:187] op_sel_hi:[1,0]
    v_cvt_pk_bf16_f32 v32, v32, v33
    v_cvt_pk_bf16_f32 v33, v34, v35
    v_cvt_pk_bf16_f32 v34, v36, v37
    v_cvt_pk_bf16_f32 v35, v38, v39
    v_exp_f32 v56, v56
    v_exp_f32 v160, v160
    v_exp_f32 v57, v57
    v_exp_f32 v161, v161
    v_exp_f32 v58, v58
    v_exp_f32 v162, v162
    v_exp_f32 v59, v59
    v_exp_f32 v163, v163
    v_exp_f32 v60, v60
    v_exp_f32 v164, v164
    v_exp_f32 v61, v61
    v_exp_f32 v165, v165
    v_exp_f32 v62, v62
    v_exp_f32 v166, v166
    v_exp_f32 v63, v63
    v_exp_f32 v167, v167
    v_exp_f32 v80, v80
    v_exp_f32 v168, v168
    v_exp_f32 v81, v81
    v_exp_f32 v169, v169
    v_exp_f32 v82, v82
    v_exp_f32 v170, v170
    v_exp_f32 v83, v83
    v_exp_f32 v171, v171
    v_exp_f32 v84, v84
    v_exp_f32 v172, v172
    v_exp_f32 v85, v85
    v_exp_f32 v173, v173
    v_exp_f32 v86, v86
    v_exp_f32 v174, v174
    v_exp_f32 v87, v87
    v_exp_f32 v175, v175
    v_pk_add_f32 v[136:137], v[160:161], v[162:163]
    v_pk_add_f32 v[138:139], v[56:57], v[58:59]
    v_pk_add_f32 v[140:141], v[168:169], v[170:171]
    v_pk_add_f32 v[142:143], v[80:81], v[82:83]
    v_pk_add_f32 v[136:137], v[136:137], v[164:165]
    v_pk_add_f32 v[138:139], v[138:139], v[60:61]
    v_pk_add_f32 v[140:141], v[140:141], v[172:173]
    v_pk_add_f32 v[142:143], v[142:143], v[84:85]
    v_pk_add_f32 v[136:137], v[136:137], v[166:167]
    v_pk_add_f32 v[138:139], v[138:139], v[62:63]
    v_pk_add_f32 v[140:141], v[140:141], v[174:175]
    v_pk_add_f32 v[142:143], v[142:143], v[86:87]
    v_add_f32 v180, v136, v137
    v_add_f32 v188, v138, v139
    v_add_f32 v182, v140, v141
    v_add_f32 v190, v142, v143
    s_nop 0
    v_permlane32_swap_b32 v180, v182
    v_permlane32_swap_b32 v188, v190
    v_add_f32 v180, v180, v182
    v_add_f32 v188, v188, v190
    s_nop 1
    v_permlane16_swap_b32 v180, v188
    v_add_f32 v180, v180, v188
    v_rcp_f32_e64 v180, v180
    s_nop 0
    v_mov_b32_e64 v188, v180
    s_nop 1
    v_permlane16_swap_b32 v180, v188
    v_mov_b32 v182, v180
    v_mov_b32_e64 v190, v188
    s_nop 0
    v_permlane32_swap_b32 v180, v182
    v_permlane32_swap_b32_e64 v188, v190
    v_pk_mul_f32 v[160:161], v[160:161], v[180:181] op_sel_hi:[1,0]
    v_pk_mul_f32 v[162:163], v[162:163], v[180:181] op_sel_hi:[1,0]
    v_pk_mul_f32 v[164:165], v[164:165], v[180:181] op_sel_hi:[1,0]
    v_pk_mul_f32 v[166:167], v[166:167], v[180:181] op_sel_hi:[1,0]
    v_cvt_pk_bf16_f32 v160, v160, v161
    v_cvt_pk_bf16_f32 v161, v162, v163
    v_cvt_pk_bf16_f32 v162, v164, v165
    v_cvt_pk_bf16_f32 v163, v166, v167
    v_pk_mul_f32 v[56:57], v[56:57], v[188:189] op_sel_hi:[1,0]
    v_pk_mul_f32 v[58:59], v[58:59], v[188:189] op_sel_hi:[1,0]
    v_pk_mul_f32 v[60:61], v[60:61], v[188:189] op_sel_hi:[1,0]
    v_pk_mul_f32 v[62:63], v[62:63], v[188:189] op_sel_hi:[1,0]
    v_cvt_pk_bf16_f32 v56, v56, v57
    v_cvt_pk_bf16_f32 v57, v58, v59
    v_cvt_pk_bf16_f32 v58, v60, v61
    v_cvt_pk_bf16_f32 v59, v62, v63
    v_pk_mul_f32 v[168:169], v[168:169], v[182:183] op_sel_hi:[1,0]
    v_pk_mul_f32 v[170:171], v[170:171], v[182:183] op_sel_hi:[1,0]
    v_pk_mul_f32 v[172:173], v[172:173], v[182:183] op_sel_hi:[1,0]
    v_pk_mul_f32 v[174:175], v[174:175], v[182:183] op_sel_hi:[1,0]
    v_cvt_pk_bf16_f32 v168, v168, v169
    v_cvt_pk_bf16_f32 v169, v170, v171
    v_cvt_pk_bf16_f32 v170, v172, v173
    v_cvt_pk_bf16_f32 v171, v174, v175
    v_pk_mul_f32 v[80:81], v[80:81], v[190:191] op_sel_hi:[1,0]
    v_pk_mul_f32 v[82:83], v[82:83], v[190:191] op_sel_hi:[1,0]
    v_pk_mul_f32 v[84:85], v[84:85], v[190:191] op_sel_hi:[1,0]
    v_pk_mul_f32 v[86:87], v[86:87], v[190:191] op_sel_hi:[1,0]
    v_cvt_pk_bf16_f32 v80, v80, v81
    v_cvt_pk_bf16_f32 v81, v82, v83
    v_cvt_pk_bf16_f32 v82, v84, v85
    v_cvt_pk_bf16_f32 v83, v86, v87
    s_lshl_b32 s3, s38, 1
    s_lshr_b32 s28, s39, 2
    s_add_u32 s3, s3, s28
    s_lshl_b32 s69, s3, 4
    s_lshl_b32 s3, s34, 7
    s_add_u32 s3, s3, s69
    v_and_b32 v2, 15, v1
    v_add_u32 v4, s3, v2
    v_lshlrev_b32 v4, 11, v4
    v_lshrrev_b32 v2, 4, v1
    v_lshl_add_u32 v4, v2, 3, v4
    s_lshl_b32 s3, s35, 7
    v_add_u32 v4, s3, v4
    buffer_load_dwordx2 v[240:241], v4, s[40:43], 0 offen offset:0
    buffer_load_dwordx2 v[242:243], v4, s[40:43], 0 offen offset:32
    buffer_load_dwordx2 v[244:245], v4, s[40:43], 0 offen offset:64
    buffer_load_dwordx2 v[246:247], v4, s[40:43], 0 offen offset:96
    v_mov_b32 v2, 162048
    ds_read_b32 v248, v2
    v_lshrrev_b32 v5, 3, v1
    v_lshlrev_b32 v6, 11, v5
    v_bfe_u32 v5, v1, 4, 2
    v_lshlrev_b32 v5, 1, v5
    v_and_b32 v7, 7, v1
    v_xor_b32 v5, v5, v7
    v_lshl_add_u32 v6, v5, 4, v6
    s_lshl_b32 s3, s35, 7
    v_add_u32 v6, s3, v6
    v_add_u32 v216, 0, v6
    v_add_u32 v217, 15360, v6
    v_add_u32 v218, 30720, v6
    v_add_u32 v219, 46080, v6
    s_lshl_b32 s72, s38, 12
    s_lshl_b32 s73, s38, 16
    v_and_b32 v2, 15, v1
    v_add_u32 v2, s69, v2
    v_lshlrev_b32_e64 v2, 2, v2
    v_add_u32 v2, 152576, v2
    ds_read_b32 v193, v2
    ds_read_b32 v192, v2 offset:1024
    s_mul_i32 s76, s67, 4224
    s_add_u32 s76, s76, 1245184
    v_lshlrev_b32 v5, 4, v1
    v_and_b32 v6, 48, v1
    v_add_u32 v6, 4096, v6
    s_lshl_b32 s3, s38, 2
    s_add_u32 s3, s3, 162112
    v_mov_b32 v3, s3
L_gw:
    ds_read_b32 v2, v3
    s_waitcnt lgkmcnt(0)
    v_readfirstlane_b32 s3, v2
    s_nop 0
    s_cmp_eq_u32 s3, 3
    s_cbranch_scc1 L_gk
    s_sleep 1
    s_branch L_gw
L_gk:
    s_sleep 6
    buffer_load_dwordx4 v[104:107], v5, s[48:51], s76 offen offset:0 sc1
    buffer_load_dwordx4 v[108:111], v5, s[48:51], s76 offen offset:1024 sc1
    buffer_load_dwordx4 v[112:115], v5, s[48:51], s76 offen offset:2048 sc1
    buffer_load_dwordx4 v[116:119], v5, s[48:51], s76 offen offset:3072 sc1
    buffer_load_dwordx4 v[120:123], v6, s[48:51], s76 offen offset:0 sc1
    buffer_load_dwordx4 v[124:127], v6, s[48:51], s76 offen offset:64 sc1
    s_waitcnt lgkmcnt(0)
    v_readfirstlane_b32 s70, v248
    s_nop 0
    s_and_b32 s68, s70, 0x7ff
    s_sub_u32 s68, 2047, s68
    s_lshl_b32 s3, s36, 3
    s_lshl_b32 s28, s64, 2
    s_add_u32 s3, s3, s28
    s_lshl_b32 s3, s3, 5
    s_add_u32 s3, s3, s67
    s_lshl_b32 s77, s3, 10
    s_add_u32 s77, s77, 4194304
    s_waitcnt vmcnt(0)
    s_mov_b32 s29, 0
L_k7:
    s_nop 0
    v_max3_u32 v2, v104, v105, v106
    v_max3_u32 v2, v2, v107, v108
    v_max3_u32 v2, v2, v109, v110
    v_max3_u32 v2, v2, v111, v112
    v_max3_u32 v2, v2, v113, v114
    v_max3_u32 v2, v2, v115, v116
    v_max3_u32 v2, v2, v117, v118
    v_max3_u32 v2, v2, v119, v120
    v_max3_u32 v2, v2, v121, v122
    v_max3_u32 v2, v2, v123, v124
    v_max3_u32 v2, v2, v125, v126
    v_max_u32 v2, v2, v127
    v_cmp_eq_u32 vcc, -1, v2
    s_cbranch_vccz L_k7k
    s_add_u32 s29, s29, 1
    s_cmp_ge_u32 s29, 200000
    s_cbranch_scc1 L_k7k
    s_sleep 1
    buffer_load_dwordx4 v[104:107], v5, s[48:51], s76 offen offset:0 sc1
    buffer_load_dwordx4 v[108:111], v5, s[48:51], s76 offen offset:1024 sc1
    buffer_load_dwordx4 v[112:115], v5, s[48:51], s76 offen offset:2048 sc1
    buffer_load_dwordx4 v[116:119], v5, s[48:51], s76 offen offset:3072 sc1
    buffer_load_dwordx4 v[120:123], v6, s[48:51], s76 offen offset:0 sc1
    buffer_load_dwordx4 v[124:127], v6, s[48:51], s76 offen offset:64 sc1
    s_waitcnt vmcnt(0)
    s_branch L_k7
L_k7k:
    s_setprio 2
    s_nop 0
    v_mfma_f32_16x16x32_bf16 v[24:27], v[120:123], v[144:147], 0
    v_mfma_f32_16x16x32_bf16 v[16:19], v[104:107], v[144:147], 0
    v_mfma_f32_16x16x32_bf16 v[20:23], v[108:111], v[144:147], 0
    v_mfma_f32_16x16x32_bf16 v[24:27], v[124:127], v[8:11], v[24:27]
    v_mfma_f32_16x16x32_bf16 v[16:19], v[112:115], v[8:11], v[16:19]
    v_mfma_f32_16x16x32_bf16 v[20:23], v[116:119], v[8:11], v[20:23]
    v_mfma_f32_16x16x32_bf16 v[48:51], v[120:123], v[152:155], 0
    v_mfma_f32_16x16x32_bf16 v[40:43], v[104:107], v[152:155], 0
    v_mfma_f32_16x16x32_bf16 v[44:47], v[108:111], v[152:155], 0
    v_mfma_f32_16x16x32_bf16 v[48:51], v[124:127], v[32:35], v[48:51]
    v_mfma_f32_16x16x32_bf16 v[40:43], v[112:115], v[32:35], v[40:43]
    v_mfma_f32_16x16x32_bf16 v[44:47], v[116:119], v[32:35], v[44:47]
    v_mfma_f32_16x16x32_bf16 v[72:75], v[120:123], v[160:163], 0
    v_mfma_f32_16x16x32_bf16 v[64:67], v[104:107], v[160:163], 0
    v_mfma_f32_16x16x32_bf16 v[68:71], v[108:111], v[160:163], 0
    v_mfma_f32_16x16x32_bf16 v[72:75], v[124:127], v[56:59], v[72:75]
    v_mfma_f32_16x16x32_bf16 v[64:67], v[112:115], v[56:59], v[64:67]
    v_mfma_f32_16x16x32_bf16 v[68:71], v[116:119], v[56:59], v[68:71]
    v_mfma_f32_16x16x32_bf16 v[96:99], v[120:123], v[168:171], 0
    v_mfma_f32_16x16x32_bf16 v[88:91], v[104:107], v[168:171], 0
    v_mfma_f32_16x16x32_bf16 v[92:95], v[108:111], v[168:171], 0
    v_mfma_f32_16x16x32_bf16 v[96:99], v[124:127], v[80:83], v[96:99]
    v_mfma_f32_16x16x32_bf16 v[88:91], v[112:115], v[80:83], v[88:91]
    v_mfma_f32_16x16x32_bf16 v[92:95], v[116:119], v[80:83], v[92:95]
    v_add_f32 v24, 0x358637bd, v24
    v_add_f32 v48, 0x358637bd, v48
    v_add_f32 v72, 0x358637bd, v72
    s_nop 2
    v_add_f32 v96, 0x358637bd, v96
    v_rcp_f32 v24, v24
    v_rcp_f32 v48, v48
    v_rcp_f32 v72, v72
    v_rcp_f32_e64 v96, v96
    v_pk_mul_f32 v[16:17], v[16:17], v[24:25] op_sel_hi:[1,0]
    v_pk_mul_f32 v[18:19], v[18:19], v[24:25] op_sel_hi:[1,0]
    v_pk_mul_f32 v[20:21], v[20:21], v[24:25] op_sel_hi:[1,0]
    v_pk_mul_f32 v[22:23], v[22:23], v[24:25] op_sel_hi:[1,0]
    v_cvt_pk_bf16_f32 v16, v16, v17
    v_cvt_pk_bf16_f32 v17, v18, v19
    v_cvt_pk_bf16_f32 v18, v20, v21
    v_cvt_pk_bf16_f32 v19, v22, v23
    buffer_store_dwordx4 v[16:19], v5, s[48:51], s77 offen sc1
    s_add_u32 s77, s77, 32768
    v_pk_mul_f32 v[40:41], v[40:41], v[48:49] op_sel_hi:[1,0]
    v_pk_mul_f32 v[42:43], v[42:43], v[48:49] op_sel_hi:[1,0]
    v_pk_mul_f32 v[44:45], v[44:45], v[48:49] op_sel_hi:[1,0]
    v_pk_mul_f32 v[46:47], v[46:47], v[48:49] op_sel_hi:[1,0]
    v_cvt_pk_bf16_f32 v40, v40, v41
    v_cvt_pk_bf16_f32 v41, v42, v43
    v_cvt_pk_bf16_f32 v42, v44, v45
    v_cvt_pk_bf16_f32 v43, v46, v47
    buffer_store_dwordx4 v[40:43], v5, s[48:51], s77 offen sc1
    s_add_u32 s77, s77, 32768
    v_pk_mul_f32 v[64:65], v[64:65], v[72:73] op_sel_hi:[1,0]
    v_pk_mul_f32 v[66:67], v[66:67], v[72:73] op_sel_hi:[1,0]
    v_pk_mul_f32 v[68:69], v[68:69], v[72:73] op_sel_hi:[1,0]
    v_pk_mul_f32 v[70:71], v[70:71], v[72:73] op_sel_hi:[1,0]
    v_cvt_pk_bf16_f32 v64, v64, v65
    v_cvt_pk_bf16_f32 v65, v66, v67
    v_cvt_pk_bf16_f32 v66, v68, v69
    v_cvt_pk_bf16_f32 v67, v70, v71
    buffer_store_dwordx4 v[64:67], v5, s[48:51], s77 offen sc1
    s_add_u32 s77, s77, 32768
    v_pk_mul_f32 v[88:89], v[88:89], v[96:97] op_sel_hi:[1,0]
    v_pk_mul_f32 v[90:91], v[90:91], v[96:97] op_sel_hi:[1,0]
    v_pk_mul_f32 v[92:93], v[92:93], v[96:97] op_sel_hi:[1,0]
    v_pk_mul_f32 v[94:95], v[94:95], v[96:97] op_sel_hi:[1,0]
    v_cvt_pk_bf16_f32 v88, v88, v89
    v_cvt_pk_bf16_f32 v89, v90, v91
    v_cvt_pk_bf16_f32 v90, v92, v93
    v_cvt_pk_bf16_f32 v91, v94, v95
    buffer_store_dwordx4 v[88:91], v5, s[48:51], s77 offen sc1
    v_mov_b32_e64 v2, 7
    ds_write_b32 v3, v2
    s_and_b32 s3, s68, 127
    s_lshl_b32 s3, s3, 2
    s_add_u32 s3, s3, 152576
    v_mov_b32 v2, s3
    ds_read_b32 v250, v2
    ds_read_b32 v251, v2 offset:1024
    s_setprio 0
    v_and_b32 v3, 3, v1
    v_lshlrev_b32_e64 v3, 2, v3
    v_add_u32 v3, 162112, v3
L_cw:
    ds_read_b32 v2, v3
    s_waitcnt lgkmcnt(0)
    v_cmp_ne_u32_e64 vcc, 7, v2
    s_cbranch_vccz L_cwk
    s_sleep 1
    s_branch L_cw
L_cwk:
    s_add_u32 m0, s72, 49152
    s_add_u32 s3, s73, 786432
    buffer_load_dwordx4 v216, s[88:91], s3 offen offset:0 lds
    buffer_load_dwordx4 v217, s[88:91], s3 offen offset:1024 lds
    buffer_load_dwordx4 v218, s[88:91], s3 offen offset:2048 lds
    buffer_load_dwordx4 v219, s[88:91], s3 offen offset:3072 lds
    s_add_u32 m0, s72, 98304
    s_add_u32 s3, s73, 1572864
    buffer_load_dwordx4 v216, s[88:91], s3 offen offset:0 lds
    buffer_load_dwordx4 v217, s[88:91], s3 offen offset:1024 lds
    buffer_load_dwordx4 v218, s[88:91], s3 offen offset:2048 lds
    buffer_load_dwordx4 v219, s[88:91], s3 offen offset:3072 lds
    s_add_u32 m0, s72, 114688
    s_add_u32 s3, s73, 1835008
    buffer_load_dwordx4 v216, s[88:91], s3 offen offset:0 lds
    buffer_load_dwordx4 v217, s[88:91], s3 offen offset:1024 lds
    buffer_load_dwordx4 v218, s[88:91], s3 offen offset:2048 lds
    buffer_load_dwordx4 v219, s[88:91], s3 offen offset:3072 lds
    v_mul_f32 v196, v193, v192
    v_mov_b32 v198, 0xbfb8aa3b
    v_lshlrev_b32 v224, 16, v240
    v_and_b32 v225, 0xffff0000, v240
    v_lshlrev_b32 v226, 16, v241
    v_and_b32 v227, 0xffff0000, v241
    v_lshlrev_b32 v228, 16, v242
    v_and_b32 v229, 0xffff0000, v242
    v_lshlrev_b32 v230, 16, v243
    v_and_b32 v231, 0xffff0000, v243
    v_lshlrev_b32 v232, 16, v244
    v_and_b32 v233, 0xffff0000, v244
    v_lshlrev_b32 v234, 16, v245
    v_and_b32 v235, 0xffff0000, v245
    v_lshlrev_b32 v236, 16, v246
    v_and_b32 v237, 0xffff0000, v246
    v_lshlrev_b32_e64 v238, 16, v247
    v_and_b32 v239, 0xffff0000, v247
    v_pk_fma_f32 v[224:225], v[224:225], v[192:193], v[196:197] op_sel_hi:[1,0,0] neg_lo:[0,0,1] neg_hi:[0,0,1]
    v_pk_fma_f32 v[226:227], v[226:227], v[192:193], v[196:197] op_sel_hi:[1,0,0] neg_lo:[0,0,1] neg_hi:[0,0,1]
    v_pk_fma_f32 v[228:229], v[228:229], v[192:193], v[196:197] op_sel_hi:[1,0,0] neg_lo:[0,0,1] neg_hi:[0,0,1]
    v_pk_fma_f32 v[230:231], v[230:231], v[192:193], v[196:197] op_sel_hi:[1,0,0] neg_lo:[0,0,1] neg_hi:[0,0,1]
    v_pk_fma_f32 v[232:233], v[232:233], v[192:193], v[196:197] op_sel_hi:[1,0,0] neg_lo:[0,0,1] neg_hi:[0,0,1]
    v_pk_fma_f32 v[234:235], v[234:235], v[192:193], v[196:197] op_sel_hi:[1,0,0] neg_lo:[0,0,1] neg_hi:[0,0,1]
    v_pk_fma_f32 v[236:237], v[236:237], v[192:193], v[196:197] op_sel_hi:[1,0,0] neg_lo:[0,0,1] neg_hi:[0,0,1]
    v_pk_fma_f32 v[238:239], v[238:239], v[192:193], v[196:197] op_sel_hi:[1,0,0] neg_lo:[0,0,1] neg_hi:[0,0,1]
    v_pk_mul_f32 v[200:201], v[224:225], v[198:199] op_sel_hi:[1,0]
    v_pk_mul_f32 v[202:203], v[226:227], v[198:199] op_sel_hi:[1,0]
    v_pk_mul_f32 v[204:205], v[228:229], v[198:199] op_sel_hi:[1,0]
    v_pk_mul_f32 v[206:207], v[230:231], v[198:199] op_sel_hi:[1,0]
    v_pk_mul_f32 v[208:209], v[232:233], v[198:199] op_sel_hi:[1,0]
    v_pk_mul_f32 v[210:211], v[234:235], v[198:199] op_sel_hi:[1,0]
    v_pk_mul_f32 v[212:213], v[236:237], v[198:199] op_sel_hi:[1,0]
    v_pk_mul_f32 v[214:215], v[238:239], v[198:199] op_sel_hi:[1,0]
    v_exp_f32 v200, v200
    v_exp_f32 v201, v201
    v_exp_f32 v202, v202
    v_exp_f32 v203, v203
    v_exp_f32 v204, v204
    v_exp_f32 v205, v205
    v_exp_f32 v206, v206
    v_exp_f32 v207, v207
    v_exp_f32 v208, v208
    v_exp_f32 v209, v209
    v_exp_f32 v210, v210
    v_exp_f32 v211, v211
    v_exp_f32 v212, v212
    v_exp_f32 v213, v213
    v_exp_f32 v214, v214
    v_exp_f32 v215, v215
    v_pk_add_f32 v[200:201], v[200:201], 1.0 op_sel_hi:[1,0]
    v_pk_add_f32 v[202:203], v[202:203], 1.0 op_sel_hi:[1,0]
    v_pk_add_f32 v[204:205], v[204:205], 1.0 op_sel_hi:[1,0]
    v_pk_add_f32 v[206:207], v[206:207], 1.0 op_sel_hi:[1,0]
    v_pk_add_f32 v[208:209], v[208:209], 1.0 op_sel_hi:[1,0]
    v_pk_add_f32 v[210:211], v[210:211], 1.0 op_sel_hi:[1,0]
    v_pk_add_f32 v[212:213], v[212:213], 1.0 op_sel_hi:[1,0]
    v_pk_add_f32 v[214:215], v[214:215], 1.0 op_sel_hi:[1,0]
    v_rcp_f32 v200, v200
    v_rcp_f32 v201, v201
    v_rcp_f32 v202, v202
    v_rcp_f32 v203, v203
    v_rcp_f32 v204, v204
    v_rcp_f32 v205, v205
    v_rcp_f32 v206, v206
    v_rcp_f32 v207, v207
    v_rcp_f32 v208, v208
    v_rcp_f32 v209, v209
    v_rcp_f32 v210, v210
    v_rcp_f32 v211, v211
    v_rcp_f32 v212, v212
    v_rcp_f32 v213, v213
    v_rcp_f32 v214, v214
    v_rcp_f32 v215, v215
    v_pk_mul_f32 v[224:225], v[224:225], v[200:201]
    v_pk_mul_f32 v[226:227], v[226:227], v[202:203]
    v_pk_mul_f32 v[228:229], v[228:229], v[204:205]
    v_pk_mul_f32 v[230:231], v[230:231], v[206:207]
    v_pk_mul_f32 v[232:233], v[232:233], v[208:209]
    v_pk_mul_f32 v[234:235], v[234:235], v[210:211]
    v_pk_mul_f32 v[236:237], v[236:237], v[212:213]
    v_pk_mul_f32 v[238:239], v[238:239], v[214:215]
L_p3:
    s_nop 3
    s_mov_b32 s56, s22
    s_mov_b32 s57, s23
    s_mov_b32 s58, 4194304
    s_mov_b32 s59, 0x00020000
    s_lshr_b32 s64, s39, 2
    s_lshl_b32 s3, s34, 2
    s_add_u32 s3, s3, s38
    s_lshl_b32 s3, s3, 16
    s_lshl_b32 s28, s64, 14
    s_add_u32 s3, s3, s28
    s_add_u32 s76, s3, 4194304
    s_lshl_b32 s3, s64, 15
    v_lshlrev_b32 v2, 4, v1
    v_add_u32 v108, s3, v2
    v_xor_b32 v109, 0x8000, v108
    v_lshrrev_b32 v2, 2, v1
    v_lshlrev_b32 v2, 7, v2
    v_bfe_u32 v3, v1, 3, 2
    v_lshl_add_u32 v2, v3, 5, v2
    v_and_b32 v3, 3, v1
    v_lshl_add_u32 v2, v3, 3, v2
    s_lshl_b32 s3, s64, 16
    v_add_u32 v104, s3, v2
    v_xor_b32 v105, 32, v104
    v_xor_b32 v106, 64, v104
    v_xor_b32 v107, 96, v104
    s_add_u32 s77, s76, 0
    buffer_load_dwordx4 v[40:43], v108, s[48:51], s77 offen offset:0 sc1
    buffer_load_dwordx4 v[44:47], v109, s[48:51], s77 offen offset:0 sc1
    buffer_load_dwordx4 v[48:51], v108, s[48:51], s77 offen offset:1024 sc1
    buffer_load_dwordx4 v[52:55], v109, s[48:51], s77 offen offset:1024 sc1
    buffer_load_dwordx4 v[56:59], v108, s[48:51], s77 offen offset:2048 sc1
    buffer_load_dwordx4 v[60:63], v109, s[48:51], s77 offen offset:2048 sc1
    s_lshr_b32 s3, s68, 7
    s_xor_b32 s83, s3, s34
    s_or_b32 s83, s83, s39
    s_nop 0
    ds_read_b64_tr_b16 v[72:73], v104 offset:0
    ds_read_b64_tr_b16 v[74:75], v104 offset:2048
    ds_read_b64_tr_b16 v[76:77], v105 offset:0
    ds_read_b64_tr_b16 v[78:79], v105 offset:2048
    ds_read_b64_tr_b16 v[80:81], v106 offset:0
    ds_read_b64_tr_b16 v[82:83], v106 offset:2048
    ds_read_b64_tr_b16 v[84:85], v107 offset:0
    ds_read_b64_tr_b16 v[86:87], v107 offset:2048
    s_mov_b32 s29, 0
    buffer_load_dwordx4 v[64:67], v108, s[48:51], s77 offen offset:3072 sc1
    buffer_load_dwordx4 v[68:71], v109, s[48:51], s77 offen offset:3072 sc1
    s_waitcnt vmcnt(6)
L_c0:
    v_max3_u32 v2, v40, v41, v42
    v_max3_u32 v2, v2, v43, v44
    v_max3_u32 v2, v2, v45, v46
    v_max_u32 v2, v2, v47
    v_cmp_eq_u32 vcc, -1, v2
    s_cbranch_vccnz L_r0
L_g0:
    s_waitcnt lgkmcnt(0)
    v_mfma_f32_16x16x32_bf16 v[8:11], v[72:75], v[40:43], 0
    ds_read_b64_tr_b16 v[88:89], v104 offset:4096
    v_mfma_f32_16x16x32_bf16 v[24:27], v[72:75], v[44:47], 0
    ds_read_b64_tr_b16 v[90:91], v104 offset:6144
    v_mfma_f32_16x16x32_bf16 v[12:15], v[76:79], v[40:43], 0
    ds_read_b64_tr_b16 v[92:93], v105 offset:4096
    v_mfma_f32_16x16x32_bf16 v[28:31], v[76:79], v[44:47], 0
    ds_read_b64_tr_b16 v[94:95], v105 offset:6144
    v_mfma_f32_16x16x32_bf16 v[16:19], v[80:83], v[40:43], 0
    ds_read_b64_tr_b16 v[96:97], v106 offset:4096
    v_mfma_f32_16x16x32_bf16 v[32:35], v[80:83], v[44:47], 0
    ds_read_b64_tr_b16 v[98:99], v106 offset:6144
    v_mfma_f32_16x16x32_bf16 v[20:23], v[84:87], v[40:43], 0
    ds_read_b64_tr_b16 v[100:101], v107 offset:4096
    v_mfma_f32_16x16x32_bf16 v[36:39], v[84:87], v[44:47], 0
    ds_read_b64_tr_b16 v[102:103], v107 offset:6144
    s_add_u32 s77, s76, 4096
    buffer_load_dwordx4 v[40:43], v108, s[48:51], s77 offen offset:0 sc1
    buffer_load_dwordx4 v[44:47], v109, s[48:51], s77 offen offset:0 sc1
    s_waitcnt vmcnt(6)
L_c1:
    v_max3_u32 v2, v48, v49, v50
    v_max3_u32 v2, v2, v51, v52
    v_max3_u32 v2, v2, v53, v54
    v_max_u32 v2, v2, v55
    v_cmp_eq_u32_e64 vcc, -1, v2
    s_cbranch_vccnz L_r1
L_g1:
    s_waitcnt lgkmcnt(0)
    v_mfma_f32_16x16x32_bf16 v[8:11], v[88:91], v[48:51], v[8:11]
    ds_read_b64_tr_b16 v[72:73], v104 offset:8192
    v_mfma_f32_16x16x32_bf16 v[24:27], v[88:91], v[52:55], v[24:27]
    ds_read_b64_tr_b16 v[74:75], v104 offset:10240
    v_mfma_f32_16x16x32_bf16 v[12:15], v[92:95], v[48:51], v[12:15]
    ds_read_b64_tr_b16 v[76:77], v105 offset:8192
    v_mfma_f32_16x16x32_bf16 v[28:31], v[92:95], v[52:55], v[28:31]
    ds_read_b64_tr_b16 v[78:79], v105 offset:10240
    v_mfma_f32_16x16x32_bf16 v[16:19], v[96:99], v[48:51], v[16:19]
    ds_read_b64_tr_b16 v[80:81], v106 offset:8192
    v_mfma_f32_16x16x32_bf16 v[32:35], v[96:99], v[52:55], v[32:35]
    ds_read_b64_tr_b16 v[82:83], v106 offset:10240
    v_mfma_f32_16x16x32_bf16 v[20:23], v[100:103], v[48:51], v[20:23]
    ds_read_b64_tr_b16 v[84:85], v107 offset:8192
    v_mfma_f32_16x16x32_bf16 v[36:39], v[100:103], v[52:55], v[36:39]
    ds_read_b64_tr_b16 v[86:87], v107 offset:10240
    buffer_load_dwordx4 v[48:51], v108, s[48:51], s77 offen offset:1024 sc1
    buffer_load_dwordx4 v[52:55], v109, s[48:51], s77 offen offset:1024 sc1
    s_waitcnt vmcnt(6)
L_c2:
    v_max3_u32 v2, v56, v57, v58
    v_max3_u32 v2, v2, v59, v60
    v_max3_u32 v2, v2, v61, v62
    v_max_u32 v2, v2, v63
    v_cmp_eq_u32_e64 vcc, -1, v2
    s_cbranch_vccnz L_r2
L_g2:
    s_waitcnt lgkmcnt(0)
    v_mfma_f32_16x16x32_bf16 v[8:11], v[72:75], v[56:59], v[8:11]
    ds_read_b64_tr_b16 v[88:89], v104 offset:12288
    v_mfma_f32_16x16x32_bf16 v[24:27], v[72:75], v[60:63], v[24:27]
    ds_read_b64_tr_b16 v[90:91], v104 offset:14336
    v_mfma_f32_16x16x32_bf16 v[12:15], v[76:79], v[56:59], v[12:15]
    ds_read_b64_tr_b16 v[92:93], v105 offset:12288
    v_mfma_f32_16x16x32_bf16 v[28:31], v[76:79], v[60:63], v[28:31]
    ds_read_b64_tr_b16 v[94:95], v105 offset:14336
    v_mfma_f32_16x16x32_bf16 v[16:19], v[80:83], v[56:59], v[16:19]
    ds_read_b64_tr_b16 v[96:97], v106 offset:12288
    v_mfma_f32_16x16x32_bf16 v[32:35], v[80:83], v[60:63], v[32:35]
    ds_read_b64_tr_b16 v[98:99], v106 offset:14336
    v_mfma_f32_16x16x32_bf16 v[20:23], v[84:87], v[56:59], v[20:23]
    ds_read_b64_tr_b16 v[100:101], v107 offset:12288
    v_mfma_f32_16x16x32_bf16 v[36:39], v[84:87], v[60:63], v[36:39]
    ds_read_b64_tr_b16 v[102:103], v107 offset:14336
    buffer_load_dwordx4 v[56:59], v108, s[48:51], s77 offen offset:2048 sc1
    buffer_load_dwordx4 v[60:63], v109, s[48:51], s77 offen offset:2048 sc1
    s_waitcnt vmcnt(6)
L_c3:
    v_max3_u32 v2, v64, v65, v66
    v_max3_u32 v2, v2, v67, v68
    v_max3_u32 v2, v2, v69, v70
    v_max_u32 v2, v2, v71
    v_cmp_eq_u32 vcc, -1, v2
    s_cbranch_vccnz L_r3
L_g3:
    s_waitcnt lgkmcnt(0)
    s_cmp_eq_u32 s64, 0
    s_cbranch_scc1 L_nb3
    s_barrier
L_nb3:
    v_mfma_f32_16x16x32_bf16 v[8:11], v[88:91], v[64:67], v[8:11]
    ds_read_b64_tr_b16 v[72:73], v104 offset:16384
    v_mfma_f32_16x16x32_bf16 v[24:27], v[88:91], v[68:71], v[24:27]
    ds_read_b64_tr_b16 v[74:75], v104 offset:18432
    v_mfma_f32_16x16x32_bf16 v[12:15], v[92:95], v[64:67], v[12:15]
    ds_read_b64_tr_b16 v[76:77], v105 offset:16384
    v_mfma_f32_16x16x32_bf16 v[28:31], v[92:95], v[68:71], v[28:31]
    ds_read_b64_tr_b16 v[78:79], v105 offset:18432
    v_mfma_f32_16x16x32_bf16 v[16:19], v[96:99], v[64:67], v[16:19]
    ds_read_b64_tr_b16 v[80:81], v106 offset:16384
    v_mfma_f32_16x16x32_bf16 v[32:35], v[96:99], v[68:71], v[32:35]
    ds_read_b64_tr_b16 v[82:83], v106 offset:18432
    v_mfma_f32_16x16x32_bf16 v[20:23], v[100:103], v[64:67], v[20:23]
    ds_read_b64_tr_b16 v[84:85], v107 offset:16384
    v_mfma_f32_16x16x32_bf16 v[36:39], v[100:103], v[68:71], v[36:39]
    ds_read_b64_tr_b16 v[86:87], v107 offset:18432
    buffer_load_dwordx4 v[64:67], v108, s[48:51], s77 offen offset:3072 sc1
    buffer_load_dwordx4 v[68:71], v109, s[48:51], s77 offen offset:3072 sc1
    s_waitcnt vmcnt(6)
L_c4:
    v_max3_u32 v2, v40, v41, v42
    v_max3_u32 v2, v2, v43, v44
    v_max3_u32 v2, v2, v45, v46
    v_max_u32 v2, v2, v47
    v_cmp_eq_u32_e64 vcc, -1, v2
    s_cbranch_vccnz L_r4
L_g4:
    s_waitcnt lgkmcnt(0)
    v_mfma_f32_16x16x32_bf16 v[8:11], v[72:75], v[40:43], v[8:11]
    ds_read_b64_tr_b16 v[88:89], v104 offset:20480
    v_mfma_f32_16x16x32_bf16 v[24:27], v[72:75], v[44:47], v[24:27]
    ds_read_b64_tr_b16 v[90:91], v104 offset:22528
    v_mfma_f32_16x16x32_bf16 v[12:15], v[76:79], v[40:43], v[12:15]
    ds_read_b64_tr_b16 v[92:93], v105 offset:20480
    v_mfma_f32_16x16x32_bf16 v[28:31], v[76:79], v[44:47], v[28:31]
    ds_read_b64_tr_b16 v[94:95], v105 offset:22528
    v_mfma_f32_16x16x32_bf16 v[16:19], v[80:83], v[40:43], v[16:19]
    ds_read_b64_tr_b16 v[96:97], v106 offset:20480
    v_mfma_f32_16x16x32_bf16 v[32:35], v[80:83], v[44:47], v[32:35]
    ds_read_b64_tr_b16 v[98:99], v106 offset:22528
    v_mfma_f32_16x16x32_bf16 v[20:23], v[84:87], v[40:43], v[20:23]
    ds_read_b64_tr_b16 v[100:101], v107 offset:20480
    v_mfma_f32_16x16x32_bf16 v[36:39], v[84:87], v[44:47], v[36:39]
    ds_read_b64_tr_b16 v[102:103], v107 offset:22528
    s_add_u32 s77, s76, 8192
    buffer_load_dwordx4 v[40:43], v108, s[48:51], s77 offen offset:0 sc1
    buffer_load_dwordx4 v[44:47], v109, s[48:51], s77 offen offset:0 sc1
    s_waitcnt vmcnt(6)
L_c5:
    v_max3_u32 v2, v48, v49, v50
    v_max3_u32 v2, v2, v51, v52
    v_max3_u32 v2, v2, v53, v54
    v_max_u32 v2, v2, v55
    v_cmp_eq_u32_e64 vcc, -1, v2
    s_cbranch_vccnz L_r5
L_g5:
    s_waitcnt lgkmcnt(0)
    v_mfma_f32_16x16x32_bf16 v[8:11], v[88:91], v[48:51], v[8:11]
    ds_read_b64_tr_b16 v[72:73], v104 offset:24576
    v_mfma_f32_16x16x32_bf16 v[24:27], v[88:91], v[52:55], v[24:27]
    ds_read_b64_tr_b16 v[74:75], v104 offset:26624
    v_mfma_f32_16x16x32_bf16 v[12:15], v[92:95], v[48:51], v[12:15]
    ds_read_b64_tr_b16 v[76:77], v105 offset:24576
    v_mfma_f32_16x16x32_bf16 v[28:31], v[92:95], v[52:55], v[28:31]
    ds_read_b64_tr_b16 v[78:79], v105 offset:26624
    v_mfma_f32_16x16x32_bf16 v[16:19], v[96:99], v[48:51], v[16:19]
    ds_read_b64_tr_b16 v[80:81], v106 offset:24576
    v_mfma_f32_16x16x32_bf16 v[32:35], v[96:99], v[52:55], v[32:35]
    ds_read_b64_tr_b16 v[82:83], v106 offset:26624
    v_mfma_f32_16x16x32_bf16 v[20:23], v[100:103], v[48:51], v[20:23]
    ds_read_b64_tr_b16 v[84:85], v107 offset:24576
    v_mfma_f32_16x16x32_bf16 v[36:39], v[100:103], v[52:55], v[36:39]
    ds_read_b64_tr_b16 v[86:87], v107 offset:26624
    buffer_load_dwordx4 v[48:51], v108, s[48:51], s77 offen offset:1024 sc1
    buffer_load_dwordx4 v[52:55], v109, s[48:51], s77 offen offset:1024 sc1
    s_waitcnt vmcnt(6)
L_c6:
    v_max3_u32 v2, v56, v57, v58
    v_max3_u32 v2, v2, v59, v60
    v_max3_u32 v2, v2, v61, v62
    v_max_u32 v2, v2, v63
    v_cmp_eq_u32_e64 vcc, -1, v2
    s_cbranch_vccnz L_r6
L_g6:
    s_waitcnt lgkmcnt(0)
    v_mfma_f32_16x16x32_bf16 v[8:11], v[72:75], v[56:59], v[8:11]
    ds_read_b64_tr_b16 v[88:89], v104 offset:28672
    v_mfma_f32_16x16x32_bf16 v[24:27], v[72:75], v[60:63], v[24:27]
    ds_read_b64_tr_b16 v[90:91], v104 offset:30720
    v_mfma_f32_16x16x32_bf16 v[12:15], v[76:79], v[56:59], v[12:15]
    ds_read_b64_tr_b16 v[92:93], v105 offset:28672
    v_mfma_f32_16x16x32_bf16 v[28:31], v[76:79], v[60:63], v[28:31]
    ds_read_b64_tr_b16 v[94:95], v105 offset:30720
    v_mfma_f32_16x16x32_bf16 v[16:19], v[80:83], v[56:59], v[16:19]
    ds_read_b64_tr_b16 v[96:97], v106 offset:28672
    v_mfma_f32_16x16x32_bf16 v[32:35], v[80:83], v[60:63], v[32:35]
    ds_read_b64_tr_b16 v[98:99], v106 offset:30720
    v_mfma_f32_16x16x32_bf16 v[20:23], v[84:87], v[56:59], v[20:23]
    ds_read_b64_tr_b16 v[100:101], v107 offset:28672
    v_mfma_f32_16x16x32_bf16 v[36:39], v[84:87], v[60:63], v[36:39]
    ds_read_b64_tr_b16 v[102:103], v107 offset:30720
    buffer_load_dwordx4 v[56:59], v108, s[48:51], s77 offen offset:2048 sc1
    buffer_load_dwordx4 v[60:63], v109, s[48:51], s77 offen offset:2048 sc1
    s_waitcnt vmcnt(6)
L_c7:
    v_max3_u32 v2, v64, v65, v66
    v_max3_u32 v2, v2, v67, v68
    v_max3_u32 v2, v2, v69, v70
    v_max_u32 v2, v2, v71
    v_cmp_eq_u32 vcc, -1, v2
    s_cbranch_vccnz L_r7
L_g7:
    s_waitcnt lgkmcnt(0)
    s_cmp_eq_u32 s64, 1
    s_cbranch_scc1 L_nb7
    s_barrier
L_nb7:
    v_mfma_f32_16x16x32_bf16 v[8:11], v[88:91], v[64:67], v[8:11]
    ds_read_b64_tr_b16 v[72:73], v104 offset:32768
    v_mfma_f32_16x16x32_bf16 v[24:27], v[88:91], v[68:71], v[24:27]
    ds_read_b64_tr_b16 v[74:75], v104 offset:34816
    v_mfma_f32_16x16x32_bf16 v[12:15], v[92:95], v[64:67], v[12:15]
    ds_read_b64_tr_b16 v[76:77], v105 offset:32768
    v_mfma_f32_16x16x32_bf16 v[28:31], v[92:95], v[68:71], v[28:31]
    ds_read_b64_tr_b16 v[78:79], v105 offset:34816
    v_mfma_f32_16x16x32_bf16 v[16:19], v[96:99], v[64:67], v[16:19]
    ds_read_b64_tr_b16 v[80:81], v106 offset:32768
    v_mfma_f32_16x16x32_bf16 v[32:35], v[96:99], v[68:71], v[32:35]
    ds_read_b64_tr_b16 v[82:83], v106 offset:34816
    v_mfma_f32_16x16x32_bf16 v[20:23], v[100:103], v[64:67], v[20:23]
    ds_read_b64_tr_b16 v[84:85], v107 offset:32768
    v_mfma_f32_16x16x32_bf16 v[36:39], v[100:103], v[68:71], v[36:39]
    ds_read_b64_tr_b16 v[86:87], v107 offset:34816
    buffer_load_dwordx4 v[64:67], v108, s[48:51], s77 offen offset:3072 sc1
    buffer_load_dwordx4 v[68:71], v109, s[48:51], s77 offen offset:3072 sc1
    s_waitcnt vmcnt(6)
L_c8:
    v_max3_u32 v2, v40, v41, v42
    v_max3_u32 v2, v2, v43, v44
    v_max3_u32 v2, v2, v45, v46
    v_max_u32 v2, v2, v47
    v_cmp_eq_u32_e64 vcc, -1, v2
    s_cbranch_vccnz L_r8
L_g8:
    s_waitcnt lgkmcnt(0)
    v_mfma_f32_16x16x32_bf16 v[8:11], v[72:75], v[40:43], v[8:11]
    ds_read_b64_tr_b16 v[88:89], v104 offset:36864
    v_mfma_f32_16x16x32_bf16 v[24:27], v[72:75], v[44:47], v[24:27]
    ds_read_b64_tr_b16 v[90:91], v104 offset:38912
    v_mfma_f32_16x16x32_bf16 v[12:15], v[76:79], v[40:43], v[12:15]
    ds_read_b64_tr_b16 v[92:93], v105 offset:36864
    v_mfma_f32_16x16x32_bf16 v[28:31], v[76:79], v[44:47], v[28:31]
    ds_read_b64_tr_b16 v[94:95], v105 offset:38912
    v_mfma_f32_16x16x32_bf16 v[16:19], v[80:83], v[40:43], v[16:19]
    ds_read_b64_tr_b16 v[96:97], v106 offset:36864
    v_mfma_f32_16x16x32_bf16 v[32:35], v[80:83], v[44:47], v[32:35]
    ds_read_b64_tr_b16 v[98:99], v106 offset:38912
    v_mfma_f32_16x16x32_bf16 v[20:23], v[84:87], v[40:43], v[20:23]
    ds_read_b64_tr_b16 v[100:101], v107 offset:36864
    v_mfma_f32_16x16x32_bf16 v[36:39], v[84:87], v[44:47], v[36:39]
    ds_read_b64_tr_b16 v[102:103], v107 offset:38912
    s_add_u32 s77, s76, 12288
    buffer_load_dwordx4 v[40:43], v108, s[48:51], s77 offen offset:0 sc1
    buffer_load_dwordx4 v[44:47], v109, s[48:51], s77 offen offset:0 sc1
    s_waitcnt vmcnt(6)
L_c9:
    v_max3_u32 v2, v48, v49, v50
    v_max3_u32 v2, v2, v51, v52
    v_max3_u32 v2, v2, v53, v54
    v_max_u32 v2, v2, v55
    v_cmp_eq_u32_e64 vcc, -1, v2
    s_cbranch_vccnz L_r9
L_g9:
    s_waitcnt lgkmcnt(0)
    v_mfma_f32_16x16x32_bf16 v[8:11], v[88:91], v[48:51], v[8:11]
    ds_read_b64_tr_b16 v[72:73], v104 offset:40960
    v_mfma_f32_16x16x32_bf16 v[24:27], v[88:91], v[52:55], v[24:27]
    ds_read_b64_tr_b16 v[74:75], v104 offset:43008
    v_mfma_f32_16x16x32_bf16 v[12:15], v[92:95], v[48:51], v[12:15]
    ds_read_b64_tr_b16 v[76:77], v105 offset:40960
    v_mfma_f32_16x16x32_bf16 v[28:31], v[92:95], v[52:55], v[28:31]
    ds_read_b64_tr_b16 v[78:79], v105 offset:43008
    v_mfma_f32_16x16x32_bf16 v[16:19], v[96:99], v[48:51], v[16:19]
    ds_read_b64_tr_b16 v[80:81], v106 offset:40960
    v_mfma_f32_16x16x32_bf16 v[32:35], v[96:99], v[52:55], v[32:35]
    ds_read_b64_tr_b16 v[82:83], v106 offset:43008
    v_mfma_f32_16x16x32_bf16 v[20:23], v[100:103], v[48:51], v[20:23]
    ds_read_b64_tr_b16 v[84:85], v107 offset:40960
    v_mfma_f32_16x16x32_bf16 v[36:39], v[100:103], v[52:55], v[36:39]
    ds_read_b64_tr_b16 v[86:87], v107 offset:43008
    buffer_load_dwordx4 v[48:51], v108, s[48:51], s77 offen offset:1024 sc1
    buffer_load_dwordx4 v[52:55], v109, s[48:51], s77 offen offset:1024 sc1
    s_waitcnt vmcnt(6)
L_c10:
    v_max3_u32 v2, v56, v57, v58
    v_max3_u32 v2, v2, v59, v60
    v_max3_u32 v2, v2, v61, v62
    v_max_u32 v2, v2, v63
    v_cmp_eq_u32_e64 vcc, -1, v2
    s_cbranch_vccnz L_r10
L_g10:
    s_waitcnt lgkmcnt(0)
    v_mfma_f32_16x16x32_bf16 v[8:11], v[72:75], v[56:59], v[8:11]
    ds_read_b64_tr_b16 v[88:89], v104 offset:45056
    v_mfma_f32_16x16x32_bf16 v[24:27], v[72:75], v[60:63], v[24:27]
    ds_read_b64_tr_b16 v[90:91], v104 offset:47104
    v_mfma_f32_16x16x32_bf16 v[12:15], v[76:79], v[56:59], v[12:15]
    ds_read_b64_tr_b16 v[92:93], v105 offset:45056
    v_mfma_f32_16x16x32_bf16 v[28:31], v[76:79], v[60:63], v[28:31]
    ds_read_b64_tr_b16 v[94:95], v105 offset:47104
    v_mfma_f32_16x16x32_bf16 v[16:19], v[80:83], v[56:59], v[16:19]
    ds_read_b64_tr_b16 v[96:97], v106 offset:45056
    v_mfma_f32_16x16x32_bf16 v[32:35], v[80:83], v[60:63], v[32:35]
    ds_read_b64_tr_b16 v[98:99], v106 offset:47104
    v_mfma_f32_16x16x32_bf16 v[20:23], v[84:87], v[56:59], v[20:23]
    ds_read_b64_tr_b16 v[100:101], v107 offset:45056
    v_mfma_f32_16x16x32_bf16 v[36:39], v[84:87], v[60:63], v[36:39]
    ds_read_b64_tr_b16 v[102:103], v107 offset:47104
    buffer_load_dwordx4 v[56:59], v108, s[48:51], s77 offen offset:2048 sc1
    buffer_load_dwordx4 v[60:63], v109, s[48:51], s77 offen offset:2048 sc1
    s_waitcnt vmcnt(6)
L_c11:
    v_max3_u32 v2, v64, v65, v66
    v_max3_u32 v2, v2, v67, v68
    v_max3_u32 v2, v2, v69, v70
    v_max_u32 v2, v2, v71
    v_cmp_eq_u32_e64 vcc, -1, v2
    s_cbranch_vccnz L_r11
L_g11:
    s_waitcnt lgkmcnt(0)
    v_mfma_f32_16x16x32_bf16 v[8:11], v[88:91], v[64:67], v[8:11]
    ds_read_b64_tr_b16 v[72:73], v104 offset:49152
    v_mfma_f32_16x16x32_bf16 v[24:27], v[88:91], v[68:71], v[24:27]
    ds_read_b64_tr_b16 v[74:75], v104 offset:51200
    v_mfma_f32_16x16x32_bf16 v[12:15], v[92:95], v[64:67], v[12:15]
    ds_read_b64_tr_b16 v[76:77], v105 offset:49152
    v_mfma_f32_16x16x32_bf16 v[28:31], v[92:95], v[68:71], v[28:31]
    ds_read_b64_tr_b16 v[78:79], v105 offset:51200
    v_mfma_f32_16x16x32_bf16 v[16:19], v[96:99], v[64:67], v[16:19]
    ds_read_b64_tr_b16 v[80:81], v106 offset:49152
    v_mfma_f32_16x16x32_bf16 v[32:35], v[96:99], v[68:71], v[32:35]
    ds_read_b64_tr_b16 v[82:83], v106 offset:51200
    v_mfma_f32_16x16x32_bf16 v[20:23], v[100:103], v[64:67], v[20:23]
    ds_read_b64_tr_b16 v[84:85], v107 offset:49152
    v_mfma_f32_16x16x32_bf16 v[36:39], v[100:103], v[68:71], v[36:39]
    ds_read_b64_tr_b16 v[86:87], v107 offset:51200
    buffer_load_dwordx4 v[64:67], v108, s[48:51], s77 offen offset:3072 sc1
    buffer_load_dwordx4 v[68:71], v109, s[48:51], s77 offen offset:3072 sc1
    s_waitcnt vmcnt(6)
L_c12:
    v_max3_u32 v2, v40, v41, v42
    v_max3_u32 v2, v2, v43, v44
    v_max3_u32 v2, v2, v45, v46
    v_max_u32 v2, v2, v47
    v_cmp_eq_u32_e64 vcc, -1, v2
    s_cbranch_vccnz L_r12
L_g12:
    s_waitcnt lgkmcnt(0)
    v_mfma_f32_16x16x32_bf16 v[8:11], v[72:75], v[40:43], v[8:11]
    ds_read_b64_tr_b16 v[88:89], v104 offset:53248
    v_mfma_f32_16x16x32_bf16 v[24:27], v[72:75], v[44:47], v[24:27]
    ds_read_b64_tr_b16 v[90:91], v104 offset:55296
    v_mfma_f32_16x16x32_bf16 v[12:15], v[76:79], v[40:43], v[12:15]
    ds_read_b64_tr_b16 v[92:93], v105 offset:53248
    v_mfma_f32_16x16x32_bf16 v[28:31], v[76:79], v[44:47], v[28:31]
    ds_read_b64_tr_b16 v[94:95], v105 offset:55296
    v_mfma_f32_16x16x32_bf16 v[16:19], v[80:83], v[40:43], v[16:19]
    ds_read_b64_tr_b16 v[96:97], v106 offset:53248
    v_mfma_f32_16x16x32_bf16 v[32:35], v[80:83], v[44:47], v[32:35]
    ds_read_b64_tr_b16 v[98:99], v106 offset:55296
    v_mfma_f32_16x16x32_bf16 v[20:23], v[84:87], v[40:43], v[20:23]
    ds_read_b64_tr_b16 v[100:101], v107 offset:53248
    v_mfma_f32_16x16x32_bf16 v[36:39], v[84:87], v[44:47], v[36:39]
    ds_read_b64_tr_b16 v[102:103], v107 offset:55296
    s_waitcnt vmcnt(4)
L_c13:
    v_max3_u32 v2, v48, v49, v50
    v_max3_u32 v2, v2, v51, v52
    v_max3_u32 v2, v2, v53, v54
    v_max_u32 v2, v2, v55
    v_cmp_eq_u32_e64 vcc, -1, v2
    s_cbranch_vccnz L_r13
L_g13:
    s_waitcnt lgkmcnt(0)
    v_mfma_f32_16x16x32_bf16 v[8:11], v[88:91], v[48:51], v[8:11]
    ds_read_b64_tr_b16 v[72:73], v104 offset:57344
    v_mfma_f32_16x16x32_bf16 v[24:27], v[88:91], v[52:55], v[24:27]
    ds_read_b64_tr_b16 v[74:75], v104 offset:59392
    v_mfma_f32_16x16x32_bf16 v[12:15], v[92:95], v[48:51], v[12:15]
    ds_read_b64_tr_b16 v[76:77], v105 offset:57344
    v_mfma_f32_16x16x32_bf16 v[28:31], v[92:95], v[52:55], v[28:31]
    ds_read_b64_tr_b16 v[78:79], v105 offset:59392
    v_mfma_f32_16x16x32_bf16 v[16:19], v[96:99], v[48:51], v[16:19]
    ds_read_b64_tr_b16 v[80:81], v106 offset:57344
    v_mfma_f32_16x16x32_bf16 v[32:35], v[96:99], v[52:55], v[32:35]
    ds_read_b64_tr_b16 v[82:83], v106 offset:59392
    v_mfma_f32_16x16x32_bf16 v[20:23], v[100:103], v[48:51], v[20:23]
    ds_read_b64_tr_b16 v[84:85], v107 offset:57344
    v_mfma_f32_16x16x32_bf16 v[36:39], v[100:103], v[52:55], v[36:39]
    ds_read_b64_tr_b16 v[86:87], v107 offset:59392
    s_waitcnt vmcnt(2)
    s_cmp_eq_u32 s83, 0
    s_cbranch_scc1 L_fx1
L_fx1r:
L_c14:
    v_max3_u32 v2, v56, v57, v58
    v_max3_u32 v2, v2, v59, v60
    v_max3_u32 v2, v2, v61, v62
    v_max_u32 v2, v2, v63
    v_cmp_eq_u32_e64 vcc, -1, v2
    s_cbranch_vccnz L_r14
L_g14:
    s_waitcnt lgkmcnt(0)
    v_mfma_f32_16x16x32_bf16 v[8:11], v[72:75], v[56:59], v[8:11]
    ds_read_b64_tr_b16 v[88:89], v104 offset:61440
    v_mfma_f32_16x16x32_bf16 v[24:27], v[72:75], v[60:63], v[24:27]
    ds_read_b64_tr_b16 v[90:91], v104 offset:63488
    v_mfma_f32_16x16x32_bf16 v[12:15], v[76:79], v[56:59], v[12:15]
    ds_read_b64_tr_b16 v[92:93], v105 offset:61440
    v_mfma_f32_16x16x32_bf16 v[28:31], v[76:79], v[60:63], v[28:31]
    ds_read_b64_tr_b16 v[94:95], v105 offset:63488
    v_mfma_f32_16x16x32_bf16 v[16:19], v[80:83], v[56:59], v[16:19]
    ds_read_b64_tr_b16 v[96:97], v106 offset:61440
    v_mfma_f32_16x16x32_bf16 v[32:35], v[80:83], v[60:63], v[32:35]
    ds_read_b64_tr_b16 v[98:99], v106 offset:63488
    v_mfma_f32_16x16x32_bf16 v[20:23], v[84:87], v[56:59], v[20:23]
    ds_read_b64_tr_b16 v[100:101], v107 offset:61440
    v_mfma_f32_16x16x32_bf16 v[36:39], v[84:87], v[60:63], v[36:39]
    ds_read_b64_tr_b16 v[102:103], v107 offset:63488
    s_waitcnt vmcnt(0)
L_c15:
    v_max3_u32 v2, v64, v65, v66
    v_max3_u32 v2, v2, v67, v68
    v_max3_u32 v2, v2, v69, v70
    v_max_u32 v2, v2, v71
    v_cmp_eq_u32_e64 vcc, -1, v2
    s_cbranch_vccnz L_r15
L_g15:
    s_waitcnt lgkmcnt(0)
    v_mfma_f32_16x16x32_bf16 v[8:11], v[88:91], v[64:67], v[8:11]
    v_mfma_f32_16x16x32_bf16 v[24:27], v[88:91], v[68:71], v[24:27]
    v_mfma_f32_16x16x32_bf16 v[12:15], v[92:95], v[64:67], v[12:15]
    v_mfma_f32_16x16x32_bf16 v[28:31], v[92:95], v[68:71], v[28:31]
    v_mfma_f32_16x16x32_bf16 v[16:19], v[96:99], v[64:67], v[16:19]
    v_mfma_f32_16x16x32_bf16 v[32:35], v[96:99], v[68:71], v[32:35]
    v_mfma_f32_16x16x32_bf16 v[20:23], v[100:103], v[64:67], v[20:23]
    v_mfma_f32_16x16x32_bf16 v[36:39], v[100:103], v[68:71], v[36:39]
    s_cmp_eq_u32 s83, 0
    s_cbranch_scc1 L_fx2
L_fx2r:
    s_lshl_b32 s3, s39, 12
    s_add_u32 s3, s3, 131072
    v_lshlrev_b32 v2, 4, v1
    v_add_u32_e64 v2, s3, v2
    v_xor_b32 v3, 0x4000, v2
    s_xor_b32 s28, s3, 0x4000
    ds_write_b128 v2, v[24:27] offset:0
    ds_write_b128 v2, v[28:31] offset:1024
    ds_write_b128 v2, v[32:35] offset:2048
    ds_write_b128 v2, v[36:39] offset:3072
    v_lshlrev_b32 v40, 16, v240
    v_and_b32 v41, 0xffff0000, v240
    v_lshlrev_b32 v42, 16, v241
    v_and_b32 v43, 0xffff0000, v241
    v_lshlrev_b32 v44, 16, v242
    v_and_b32 v45, 0xffff0000, v242
    v_lshlrev_b32 v46, 16, v243
    v_and_b32 v47, 0xffff0000, v243
    v_lshlrev_b32 v48, 16, v244
    v_and_b32 v49, 0xffff0000, v244
    v_lshlrev_b32 v50, 16, v245
    v_and_b32 v51, 0xffff0000, v245
    v_lshlrev_b32 v52, 16, v246
    v_and_b32 v53, 0xffff0000, v246
    v_lshlrev_b32 v54, 16, v247
    v_and_b32 v55, 0xffff0000, v247
    v_and_b32 v4, 15, v1
    v_lshrrev_b32 v5, 4, v1
    v_lshlrev_b32 v6, 1, v4
    v_and_b32 v6, 14, v6
    v_xor_b32_e64 v5, v5, v6
    v_lshl_add_u32 v4, v4, 7, s28
    v_lshl_add_u32 v4, v5, 3, v4
    v_lshrrev_b32 v5, 3, v1
    v_and_b32 v6, 7, v1
    v_xor_b32_e64 v7, v6, v5
    v_lshl_add_u32 v7, v7, 4, s28
    v_lshl_add_u32 v7, v5, 7, v7
    s_lshl_b32 s3, s34, 7
    s_add_u32 s3, s3, s69
    v_add_u32 v5, s3, v5
    v_lshlrev_b32 v5, 11, v5
    v_lshl_add_u32 v5, v6, 4, v5
    s_lshl_b32 s3, s35, 7
    s_add_u32 s28, s3, 16384
    s_lshl_b32 s29, s34, 7
    s_add_u32 s29, s29, s69
    s_andn2_b32 s77, s68, 15
    s_cmp_lg_u32 s29, s77
    s_waitcnt lgkmcnt(0)
    s_barrier
    s_cbranch_scc1 L_nov
    v_and_b32 v2, 48, v1
    s_and_b32 s29, s68, 15
    s_lshl_b32 exec_lo, 0x00010001, s29
    s_mov_b32 exec_hi, exec_lo
    ds_read_b128 v[224:227], v2 offset:0
    ds_read_b128 v[228:231], v2 offset:64
    ds_read_b128 v[232:235], v2 offset:128
    ds_read_b128 v[236:239], v2 offset:192
    s_mov_b64 exec, -1
L_nov:
    ds_read_b128 v[24:27], v3 offset:0
    ds_read_b128 v[28:31], v3 offset:1024
    ds_read_b128 v[32:35], v3 offset:2048
    ds_read_b128 v[36:39], v3 offset:3072
    s_waitcnt lgkmcnt(3)
    s_nop 0
    v_pk_add_f32 v[8:9], v[8:9], v[24:25]
    v_pk_add_f32 v[10:11], v[10:11], v[26:27]
    v_pk_fma_f32 v[40:41], v[8:9], v[224:225], v[40:41]
    v_pk_fma_f32 v[42:43], v[10:11], v[226:227], v[42:43]
    v_cvt_pk_bf16_f32 v8, v40, v41
    v_cvt_pk_bf16_f32 v9, v42, v43
    s_waitcnt lgkmcnt(2)
    s_nop 0
    v_pk_add_f32 v[12:13], v[12:13], v[28:29]
    v_pk_add_f32 v[14:15], v[14:15], v[30:31]
    v_pk_fma_f32 v[44:45], v[12:13], v[228:229], v[44:45]
    v_pk_fma_f32 v[46:47], v[14:15], v[230:231], v[46:47]
    v_cvt_pk_bf16_f32 v10, v44, v45
    v_cvt_pk_bf16_f32 v11, v46, v47
    s_waitcnt lgkmcnt(1)
    s_nop 0
    v_pk_add_f32 v[16:17], v[16:17], v[32:33]
    v_pk_add_f32 v[18:19], v[18:19], v[34:35]
    v_pk_fma_f32 v[48:49], v[16:17], v[232:233], v[48:49]
    v_pk_fma_f32 v[50:51], v[18:19], v[234:235], v[50:51]
    v_cvt_pk_bf16_f32 v12, v48, v49
    v_cvt_pk_bf16_f32 v13, v50, v51
    s_waitcnt lgkmcnt(0)
    s_nop 0
    v_pk_add_f32 v[20:21], v[20:21], v[36:37]
    v_pk_add_f32 v[22:23], v[22:23], v[38:39]
    v_pk_fma_f32 v[52:53], v[20:21], v[236:237], v[52:53]
    v_pk_fma_f32 v[54:55], v[22:23], v[238:239], v[54:55]
    v_cvt_pk_bf16_f32 v14, v52, v53
    v_cvt_pk_bf16_f32 v15, v54, v55
    ds_write_b64 v4, v[8:9]
    v_xor_b32 v6, 32, v4
    ds_write_b64 v6, v[10:11]
    v_xor_b32 v6, 64, v4
    ds_write_b64 v6, v[12:13]
    v_xor_b32 v6, 96, v4
    ds_write_b64 v6, v[14:15]
    ds_read_b128 v[24:27], v7 offset:0
    ds_read_b128 v[28:31], v7 offset:1024
    s_waitcnt lgkmcnt(1)
    buffer_store_dwordx4 v[24:27], v5, s[56:59], s3 offen nt
    s_waitcnt lgkmcnt(0)
    buffer_store_dwordx4 v[28:31], v5, s[56:59], s28 offen nt
L_done:
    s_endpgm
L_ln:
    s_lshl_b32 s3, s38, 12
    s_add_u32 s3, s3, 131072
    v_lshlrev_b32 v2, 4, v1
    v_add_u32 v3, s3, v2
    v_add_u32 v2, 122880, v2
    s_barrier
    s_nop 0
    ds_read_b128 v[120:123], v2 offset:0
    ds_read_b128 v[124:127], v2 offset:1024
    ds_read_b128 v[104:107], v3 offset:0
    ds_read_b128 v[108:111], v3 offset:1024
    ds_read_b128 v[112:115], v3 offset:2048
    ds_read_b128 v[116:119], v3 offset:3072
    v_mov_b32 v2, 0x3f803f80
    v_mov_b32 v192, 0
    v_mov_b32 v194, 0
    v_mov_b32 v196, 0
    v_mov_b32 v198, 0
    v_mov_b32 v200, 0
    v_mov_b32 v202, 0
    v_mov_b32 v204, 0
    v_mov_b32 v206, 0
    s_waitcnt lgkmcnt(2)
    v_dot2c_f32_bf16 v192, v104, v2
    v_dot2c_f32_bf16 v196, v104, v104
    v_dot2c_f32_bf16 v200, v104, v120
    v_dot2c_f32_bf16 v204, v120, v2
    v_dot2c_f32_bf16 v192, v105, v2
    v_dot2c_f32_bf16 v196, v105, v105
    v_dot2c_f32_bf16 v200, v105, v121
    v_dot2c_f32_bf16 v204, v121, v2
    v_dot2c_f32_bf16 v192, v106, v2
    v_dot2c_f32_bf16 v196, v106, v106
    v_dot2c_f32_bf16 v200, v106, v122
    v_dot2c_f32_bf16 v204, v122, v2
    v_dot2c_f32_bf16 v192, v107, v2
    v_dot2c_f32_bf16 v196, v107, v107
    v_dot2c_f32_bf16 v200, v107, v123
    v_dot2c_f32_bf16 v204, v123, v2
    v_dot2c_f32_bf16 v192, v108, v2
    v_dot2c_f32_bf16 v196, v108, v108
    v_dot2c_f32_bf16 v200, v108, v124
    v_dot2c_f32_bf16 v204, v124, v2
    v_dot2c_f32_bf16 v192, v109, v2
    v_dot2c_f32_bf16 v196, v109, v109
    v_dot2c_f32_bf16 v200, v109, v125
    v_dot2c_f32_bf16 v204, v125, v2
    v_dot2c_f32_bf16 v192, v110, v2
    v_dot2c_f32_bf16 v196, v110, v110
    v_dot2c_f32_bf16 v200, v110, v126
    v_dot2c_f32_bf16 v204, v126, v2
    v_dot2c_f32_bf16 v192, v111, v2
    v_dot2c_f32_bf16 v196, v111, v111
    v_dot2c_f32_bf16 v200, v111, v127
    v_dot2c_f32_bf16 v204, v127, v2
    s_waitcnt lgkmcnt(0)
    v_dot2c_f32_bf16 v194, v112, v2
    v_dot2c_f32_bf16 v198, v112, v112
    v_dot2c_f32_bf16 v202, v112, v120
    v_dot2c_f32_bf16 v206, v120, v2
    v_dot2c_f32_bf16 v194, v113, v2
    v_dot2c_f32_bf16 v198, v113, v113
    v_dot2c_f32_bf16 v202, v113, v121
    v_dot2c_f32_bf16 v206, v121, v2
    v_dot2c_f32_bf16 v194, v114, v2
    v_dot2c_f32_bf16 v198, v114, v114
    v_dot2c_f32_bf16 v202, v114, v122
    v_dot2c_f32_bf16 v206, v122, v2
    v_dot2c_f32_bf16 v194, v115, v2
    v_dot2c_f32_bf16 v198, v115, v115
    v_dot2c_f32_bf16 v202, v115, v123
    v_dot2c_f32_bf16 v206, v123, v2
    v_dot2c_f32_bf16 v194, v116, v2
    v_dot2c_f32_bf16 v198, v116, v116
    v_dot2c_f32_bf16 v202, v116, v124
    v_dot2c_f32_bf16 v206, v124, v2
    v_dot2c_f32_bf16 v194, v117, v2
    v_dot2c_f32_bf16 v198, v117, v117
    v_dot2c_f32_bf16 v202, v117, v125
    v_dot2c_f32_bf16 v206, v125, v2
    v_dot2c_f32_bf16 v194, v118, v2
    v_dot2c_f32_bf16 v198, v118, v118
    v_dot2c_f32_bf16 v202, v118, v126
    v_dot2c_f32_bf16 v206, v126, v2
    v_dot2c_f32_bf16 v194, v119, v2
    v_dot2c_f32_bf16 v198, v119, v119
    v_dot2c_f32_bf16 v202, v119, v127
    v_dot2c_f32_bf16 v206, v127, v2
    v_permlane32_swap_b32 v192, v194
    v_permlane32_swap_b32 v196, v198
    v_permlane32_swap_b32 v200, v202
    v_permlane32_swap_b32 v204, v206
    v_add_f32 v192, v192, v194
    v_add_f32 v196, v196, v198
    v_add_f32 v200, v200, v202
    v_add_f32 v204, v204, v206
    v_add_f32 v192, v192, v192 quad_perm:[1,0,3,2] row_mask:0xf bank_mask:0xf
    v_add_f32 v196, v196, v196 quad_perm:[1,0,3,2] row_mask:0xf bank_mask:0xf
    v_add_f32 v200, v200, v200 quad_perm:[1,0,3,2] row_mask:0xf bank_mask:0xf
    v_add_f32 v204, v204, v204 quad_perm:[1,0,3,2] row_mask:0xf bank_mask:0xf
    v_add_f32 v192, v192, v192 quad_perm:[2,3,0,1] row_mask:0xf bank_mask:0xf
    v_add_f32 v196, v196, v196 quad_perm:[2,3,0,1] row_mask:0xf bank_mask:0xf
    v_add_f32 v200, v200, v200 quad_perm:[2,3,0,1] row_mask:0xf bank_mask:0xf
    v_add_f32 v204, v204, v204 quad_perm:[2,3,0,1] row_mask:0xf bank_mask:0xf
    v_add_f32 v192, v192, v192 row_half_mirror row_mask:0xf bank_mask:0xf
    v_add_f32 v196, v196, v196 row_half_mirror row_mask:0xf bank_mask:0xf
    v_add_f32 v200, v200, v200 row_half_mirror row_mask:0xf bank_mask:0xf
    v_add_f32 v204, v204, v204 row_half_mirror row_mask:0xf bank_mask:0xf
    v_add_f32 v192, v192, v192 row_mirror row_mask:0xf bank_mask:0xf
    v_add_f32 v196, v196, v196 row_mirror row_mask:0xf bank_mask:0xf
    v_add_f32 v200, v200, v200 row_mirror row_mask:0xf bank_mask:0xf
    v_add_f32 v204, v204, v204 row_mirror row_mask:0xf bank_mask:0xf
    v_mov_b32 v193, v192
    v_mov_b32 v197, v196
    v_mov_b32 v201, v200
    v_mov_b32 v205, v204
    v_permlane16_swap_b32 v192, v193
    v_permlane16_swap_b32 v196, v197
    v_permlane16_swap_b32 v200, v201
    v_permlane16_swap_b32 v204, v205
    v_add_f32 v192, v192, v193
    v_add_f32 v196, v196, v197
    v_add_f32 v200, v200, v201
    v_add_f32 v204, v204, v205
    v_mul_f32 v192, 0x3a800000, v192
    v_mul_f32 v196, 0x3a800000, v196
    v_cvt_pk_bf16_f32 v193, v192, v192
    v_lshlrev_b32 v193, 16, v193
    v_fma_f32 v196, -v192, v192, v196
    v_max_f32 v196, 0, v196
    v_fma_f32 v200, -v193, v204, v200
    s_waitcnt vmcnt(0)
    v_cvt_pk_bf16_f32 v196, v196, v196
    v_lshlrev_b32 v196, 16, v196
    v_add_f32 v196, 0x3727c5ac, v196
    v_cvt_pk_bf16_f32 v196, v196, v196
    v_lshlrev_b32 v196, 16, v196
    v_sqrt_f32 v196, v196
    s_nop 0
    v_cvt_pk_bf16_f32 v196, v196, v196
    v_lshlrev_b32 v196, 16, v196
    v_rcp_f32 v2, v196
    v_lshrrev_b32 v3, 16, v193
    v_or_b32 v4, v3, v196
    v_mul_f32 v200, v200, v2
    v_cvt_pk_bf16_f32 v200, v200, v200
    v_lshlrev_b32 v200, 16, v200
    v_ashrrev_i32 v2, 31, v200
    v_or_b32 v2, 0x80000000, v2
    v_xor_b32 v2, v200, v2
    v_and_b32 v2, 0xffff0000, v2
    v_lshrrev_b32 v3, 5, v1
    v_add_u32 v5, s69, v3
    v_sub_u32 v5, 2047, v5
    v_or_b32 v6, v2, v5
    v_mov_b32 v2, v6
    v_mov_b32 v5, v4
    v_add_u32 v7, 1, v248
    v_mov_b32 v3, 0
    v_readfirstlane_b32 s86, v7
    v_permlane32_swap_b32 v6, v2
    v_permlane32_swap_b32 v4, v5
    v_max_u32 v6, v6, v2
    s_lshl_b32 s3, s69, 3
    s_mov_b64 exec, 1
    buffer_store_dwordx4 v[4:7], v3, s[48:51], s3 offen sc1
    s_mov_b64 exec, -1
    s_branch L_lnr
L_fx1:
    v_lshlrev_b32 v192, 4, v1
    s_lshl_b32 s78, s35, 14
    s_add_u32 s78, s78, 1609728
    v_and_b32 v2, 15, v1
    v_lshrrev_b32 v3, 4, v1
    v_lshl_add_u32 v193, v2, 2, v3
    v_and_b32 v2, 7, v193
    v_lshrrev_b32 v193, 3, v193
    v_lshl_add_u32 v193, v2, 3, v193
    v_lshlrev_b32 v2, 1, v193
    s_lshl_b32 s3, s68, 11
    s_lshl_b32 s28, s35, 7
    s_add_u32 s3, s3, s28
    buffer_load_ushort v194, v2, s[40:43], s3 offen
    s_add_u32 s3, s78, 0
    s_nop 0
    buffer_load_dwordx4 v[128:131], v192, s[48:51], s3 offen offset:0 sc1
    buffer_load_dwordx4 v[132:135], v192, s[48:51], s3 offen offset:1024 sc1
    buffer_load_dwordx4 v[136:139], v192, s[48:51], s3 offen offset:2048 sc1
    buffer_load_dwordx4 v[140:143], v192, s[48:51], s3 offen offset:3072 sc1
    s_add_u32 s3, s78, 4096
    buffer_load_dwordx4 v[144:147], v192, s[48:51], s3 offen offset:0 sc1
    buffer_load_dwordx4 v[148:151], v192, s[48:51], s3 offen offset:1024 sc1
    buffer_load_dwordx4 v[152:155], v192, s[48:51], s3 offen offset:2048 sc1
    buffer_load_dwordx4 v[156:159], v192, s[48:51], s3 offen offset:3072 sc1
    s_add_u32 s3, s78, 8192
    buffer_load_dwordx4 v[160:163], v192, s[48:51], s3 offen offset:0 sc1
    buffer_load_dwordx4 v[164:167], v192, s[48:51], s3 offen offset:1024 sc1
    buffer_load_dwordx4 v[168:171], v192, s[48:51], s3 offen offset:2048 sc1
    buffer_load_dwordx4 v[172:175], v192, s[48:51], s3 offen offset:3072 sc1
    s_add_u32 s3, s78, 12288
    buffer_load_dwordx4 v[176:179], v192, s[48:51], s3 offen offset:0 sc1
    buffer_load_dwordx4 v[180:183], v192, s[48:51], s3 offen offset:1024 sc1
    buffer_load_dwordx4 v[184:187], v192, s[48:51], s3 offen offset:2048 sc1
    buffer_load_dwordx4 v[188:191], v192, s[48:51], s3 offen offset:3072 sc1
    s_branch L_fx1r
L_fx2:
    s_and_b32 s3, s70, 0xffff0000
    s_xor_b32 s28, s3, 0x80000000
    s_not_b32 s29, s3
    s_and_b32 s29, s29, 0xffff0000
    s_bitcmp1_b32 s3, 31
    s_cselect_b32 s3, s28, s29
    v_mov_b32 v195, s3
    v_mul_f32 v195, 0xbfb8aa3b, v195
    v_exp_f32 v195, v195
    s_nop 0
    v_add_f32 v195, 1.0, v195
    v_rcp_f32 v195, v195
    s_nop 0
    v_cvt_pk_bf16_f32 v195, v195, v195
    v_lshlrev_b32 v195, 16, v195
    s_mov_b32 s29, 0
L_k6:
    v_max3_u32 v2, v128, v129, v130
    v_max3_u32 v2, v2, v131, v132
    v_max3_u32 v2, v2, v133, v134
    v_max3_u32 v2, v2, v135, v136
    v_max3_u32 v2, v2, v137, v138
    v_max3_u32 v2, v2, v139, v140
    v_max3_u32 v2, v2, v141, v142
    v_max3_u32 v2, v2, v143, v144
    v_max3_u32 v2, v2, v145, v146
    v_max3_u32 v2, v2, v147, v148
    v_max3_u32 v2, v2, v149, v150
    v_max3_u32 v2, v2, v151, v152
    v_max3_u32 v2, v2, v153, v154
    v_max3_u32 v2, v2, v155, v156
    v_max3_u32 v2, v2, v157, v158
    v_max3_u32 v2, v2, v159, v160
    v_max3_u32 v2, v2, v161, v162
    v_max3_u32 v2, v2, v163, v164
    v_max3_u32 v2, v2, v165, v166
    v_max3_u32 v2, v2, v167, v168
    v_max3_u32 v2, v2, v169, v170
    v_max3_u32 v2, v2, v171, v172
    v_max3_u32 v2, v2, v173, v174
    v_max3_u32 v2, v2, v175, v176
    v_max3_u32 v2, v2, v177, v178
    v_max3_u32 v2, v2, v179, v180
    v_max3_u32 v2, v2, v181, v182
    v_max3_u32 v2, v2, v183, v184
    v_max3_u32 v2, v2, v185, v186
    v_max3_u32 v2, v2, v187, v188
    v_max3_u32 v2, v2, v189, v190
    v_max_u32 v2, v2, v191
    v_cmp_eq_u32 vcc, -1, v2
    s_cbranch_vccz L_k6k
    s_add_u32 s29, s29, 1
    s_cmp_ge_u32 s29, 200000
    s_cbranch_scc1 L_k6k
    s_sleep 4
    s_add_u32 s3, s78, 0
    s_nop 0
    buffer_load_dwordx4 v[128:131], v192, s[48:51], s3 offen offset:0 sc1
    buffer_load_dwordx4 v[132:135], v192, s[48:51], s3 offen offset:1024 sc1
    buffer_load_dwordx4 v[136:139], v192, s[48:51], s3 offen offset:2048 sc1
    buffer_load_dwordx4 v[140:143], v192, s[48:51], s3 offen offset:3072 sc1
    s_add_u32 s3, s78, 4096
    buffer_load_dwordx4 v[144:147], v192, s[48:51], s3 offen offset:0 sc1
    buffer_load_dwordx4 v[148:151], v192, s[48:51], s3 offen offset:1024 sc1
    buffer_load_dwordx4 v[152:155], v192, s[48:51], s3 offen offset:2048 sc1
    buffer_load_dwordx4 v[156:159], v192, s[48:51], s3 offen offset:3072 sc1
    s_add_u32 s3, s78, 8192
    buffer_load_dwordx4 v[160:163], v192, s[48:51], s3 offen offset:0 sc1
    buffer_load_dwordx4 v[164:167], v192, s[48:51], s3 offen offset:1024 sc1
    buffer_load_dwordx4 v[168:171], v192, s[48:51], s3 offen offset:2048 sc1
    buffer_load_dwordx4 v[172:175], v192, s[48:51], s3 offen offset:3072 sc1
    s_add_u32 s3, s78, 12288
    buffer_load_dwordx4 v[176:179], v192, s[48:51], s3 offen offset:0 sc1
    buffer_load_dwordx4 v[180:183], v192, s[48:51], s3 offen offset:1024 sc1
    buffer_load_dwordx4 v[184:187], v192, s[48:51], s3 offen offset:2048 sc1
    buffer_load_dwordx4 v[188:191], v192, s[48:51], s3 offen offset:3072 sc1
    s_waitcnt vmcnt(0)
    s_branch L_k6
L_k6k:
    v_pk_add_f32 v[128:129], v[128:129], v[160:161]
    v_pk_add_f32 v[130:131], v[130:131], v[162:163]
    v_pk_add_f32 v[132:133], v[132:133], v[164:165]
    v_pk_add_f32 v[134:135], v[134:135], v[166:167]
    v_pk_add_f32 v[136:137], v[136:137], v[168:169]
    v_pk_add_f32 v[138:139], v[138:139], v[170:171]
    v_pk_add_f32 v[140:141], v[140:141], v[172:173]
    v_pk_add_f32 v[142:143], v[142:143], v[174:175]
    v_pk_add_f32 v[144:145], v[144:145], v[176:177]
    v_pk_add_f32 v[146:147], v[146:147], v[178:179]
    v_pk_add_f32 v[148:149], v[148:149], v[180:181]
    v_pk_add_f32 v[150:151], v[150:151], v[182:183]
    v_pk_add_f32 v[152:153], v[152:153], v[184:185]
    v_pk_add_f32 v[154:155], v[154:155], v[186:187]
    v_pk_add_f32 v[156:157], v[156:157], v[188:189]
    v_pk_add_f32 v[158:159], v[158:159], v[190:191]
    v_pk_add_f32 v[128:129], v[128:129], v[144:145]
    v_pk_add_f32 v[130:131], v[130:131], v[146:147]
    v_pk_add_f32 v[132:133], v[132:133], v[148:149]
    v_pk_add_f32 v[134:135], v[134:135], v[150:151]
    v_pk_add_f32 v[136:137], v[136:137], v[152:153]
    v_pk_add_f32 v[138:139], v[138:139], v[154:155]
    v_pk_add_f32 v[140:141], v[140:141], v[156:157]
    v_pk_add_f32 v[142:143], v[142:143], v[158:159]
    v_pk_add_f32 v[128:129], v[128:129], v[136:137]
    v_pk_add_f32 v[130:131], v[130:131], v[138:139]
    v_pk_add_f32 v[132:133], v[132:133], v[140:141]
    v_pk_add_f32 v[134:135], v[134:135], v[142:143]
    v_pk_add_f32 v[128:129], v[128:129], v[132:133]
    v_pk_add_f32 v[130:131], v[130:131], v[134:135]
    s_nop 1
    v_permlane32_swap_b32 v128, v130
    v_permlane32_swap_b32 v129, v131
    v_add_f32 v128, v128, v130
    v_add_f32 v129, v129, v131
    s_nop 1
    v_permlane16_swap_b32 v128, v129
    v_add_f32 v128, v128, v129
    v_cvt_pk_bf16_f32 v128, v128, v128
    v_lshlrev_b32 v128, 16, v128
    v_mul_f32 v128, v128, v195
    v_lshlrev_b32 v194, 16, v194
    v_sub_f32 v194, v194, v250
    v_cvt_pk_bf16_f32 v128, v128, v128
    v_lshlrev_b32 v128, 16, v128
    v_cvt_pk_bf16_f32 v194, v194, v194
    v_lshlrev_b32 v194, 16, v194
    v_mul_f32 v194, v194, v251
    v_cvt_pk_bf16_f32 v194, v194, v194
    v_lshlrev_b32 v194, 16, v194
    v_add_f32 v128, v128, v194
    v_cvt_pk_bf16_f32 v128, v128, v128
    v_lshlrev_b32 v128, 16, v128
    v_mul_f32 v2, 0xbfb8aa3b, v128
    v_exp_f32 v2, v2
    s_nop 0
    v_add_f32 v2, 1.0, v2
    v_rcp_f32 v2, v2
    s_nop 0
    v_mul_f32 v2, v128, v2
    v_lshlrev_b32 v3, 2, v193
    ds_write_b32 v3, v2
    s_branch L_fx2r
L_r0:
    s_add_u32 s29, s29, 1
    s_cmp_ge_u32 s29, 200000
    s_cbranch_scc1 L_g0
    s_add_u32 s3, s76, 0
    buffer_load_dwordx4 v[40:43], v108, s[48:51], s3 offen sc1
    buffer_load_dwordx4 v[44:47], v109, s[48:51], s3 offen sc1
    s_waitcnt vmcnt(0)
    s_branch L_c0
L_r1:
    s_add_u32 s29, s29, 1
    s_cmp_ge_u32 s29, 200000
    s_cbranch_scc1 L_g1
    s_add_u32 s3, s76, 1024
    buffer_load_dwordx4 v[48:51], v108, s[48:51], s3 offen sc1
    buffer_load_dwordx4 v[52:55], v109, s[48:51], s3 offen sc1
    s_waitcnt vmcnt(0)
    s_branch L_c1
L_r2:
    s_add_u32 s29, s29, 1
    s_cmp_ge_u32 s29, 200000
    s_cbranch_scc1 L_g2
    s_add_u32 s3, s76, 2048
    buffer_load_dwordx4 v[56:59], v108, s[48:51], s3 offen sc1
    buffer_load_dwordx4 v[60:63], v109, s[48:51], s3 offen sc1
    s_waitcnt vmcnt(0)
    s_branch L_c2
L_r3:
    s_add_u32 s29, s29, 1
    s_cmp_ge_u32 s29, 200000
    s_cbranch_scc1 L_g3
    s_add_u32 s3, s76, 3072
    buffer_load_dwordx4 v[64:67], v108, s[48:51], s3 offen sc1
    buffer_load_dwordx4 v[68:71], v109, s[48:51], s3 offen sc1
    s_waitcnt vmcnt(0)
    s_branch L_c3
L_r4:
    s_add_u32 s29, s29, 1
    s_cmp_ge_u32 s29, 200000
    s_cbranch_scc1 L_g4
    s_add_u32 s3, s76, 4096
    buffer_load_dwordx4 v[40:43], v108, s[48:51], s3 offen sc1
    buffer_load_dwordx4 v[44:47], v109, s[48:51], s3 offen sc1
    s_waitcnt vmcnt(0)
    s_branch L_c4
L_r5:
    s_add_u32 s29, s29, 1
    s_cmp_ge_u32 s29, 200000
    s_cbranch_scc1 L_g5
    s_add_u32 s3, s76, 5120
    buffer_load_dwordx4 v[48:51], v108, s[48:51], s3 offen sc1
    buffer_load_dwordx4 v[52:55], v109, s[48:51], s3 offen sc1
    s_waitcnt vmcnt(0)
    s_branch L_c5
L_r6:
    s_add_u32 s29, s29, 1
    s_cmp_ge_u32 s29, 200000
    s_cbranch_scc1 L_g6
    s_add_u32 s3, s76, 6144
    buffer_load_dwordx4 v[56:59], v108, s[48:51], s3 offen sc1
    buffer_load_dwordx4 v[60:63], v109, s[48:51], s3 offen sc1
    s_waitcnt vmcnt(0)
    s_branch L_c6
L_r7:
    s_add_u32 s29, s29, 1
    s_cmp_ge_u32 s29, 200000
    s_cbranch_scc1 L_g7
    s_add_u32 s3, s76, 7168
    buffer_load_dwordx4 v[64:67], v108, s[48:51], s3 offen sc1
    buffer_load_dwordx4 v[68:71], v109, s[48:51], s3 offen sc1
    s_waitcnt vmcnt(0)
    s_branch L_c7
L_r8:
    s_add_u32 s29, s29, 1
    s_cmp_ge_u32 s29, 200000
    s_cbranch_scc1 L_g8
    s_add_u32 s3, s76, 8192
    buffer_load_dwordx4 v[40:43], v108, s[48:51], s3 offen sc1
    buffer_load_dwordx4 v[44:47], v109, s[48:51], s3 offen sc1
    s_waitcnt vmcnt(0)
    s_branch L_c8
L_r9:
    s_add_u32 s29, s29, 1
    s_cmp_ge_u32 s29, 200000
    s_cbranch_scc1 L_g9
    s_add_u32 s3, s76, 9216
    buffer_load_dwordx4 v[48:51], v108, s[48:51], s3 offen sc1
    buffer_load_dwordx4 v[52:55], v109, s[48:51], s3 offen sc1
    s_waitcnt vmcnt(0)
    s_branch L_c9
L_r10:
    s_add_u32 s29, s29, 1
    s_cmp_ge_u32 s29, 200000
    s_cbranch_scc1 L_g10
    s_add_u32 s3, s76, 10240
    buffer_load_dwordx4 v[56:59], v108, s[48:51], s3 offen sc1
    buffer_load_dwordx4 v[60:63], v109, s[48:51], s3 offen sc1
    s_waitcnt vmcnt(0)
    s_branch L_c10
L_r11:
    s_add_u32 s29, s29, 1
    s_cmp_ge_u32 s29, 200000
    s_cbranch_scc1 L_g11
    s_add_u32 s3, s76, 11264
    buffer_load_dwordx4 v[64:67], v108, s[48:51], s3 offen sc1
    buffer_load_dwordx4 v[68:71], v109, s[48:51], s3 offen sc1
    s_waitcnt vmcnt(0)
    s_branch L_c11
L_r12:
    s_add_u32 s29, s29, 1
    s_cmp_ge_u32 s29, 200000
    s_cbranch_scc1 L_g12
    s_add_u32 s3, s76, 12288
    buffer_load_dwordx4 v[40:43], v108, s[48:51], s3 offen sc1
    buffer_load_dwordx4 v[44:47], v109, s[48:51], s3 offen sc1
    s_waitcnt vmcnt(0)
    s_branch L_c12
L_r13:
    s_add_u32 s29, s29, 1
    s_cmp_ge_u32 s29, 200000
    s_cbranch_scc1 L_g13
    s_add_u32 s3, s76, 13312
    buffer_load_dwordx4 v[48:51], v108, s[48:51], s3 offen sc1
    buffer_load_dwordx4 v[52:55], v109, s[48:51], s3 offen sc1
    s_waitcnt vmcnt(0)
    s_branch L_c13
L_r14:
    s_add_u32 s29, s29, 1
    s_cmp_ge_u32 s29, 200000
    s_cbranch_scc1 L_g14
    s_add_u32 s3, s76, 14336
    buffer_load_dwordx4 v[56:59], v108, s[48:51], s3 offen sc1
    buffer_load_dwordx4 v[60:63], v109, s[48:51], s3 offen sc1
    s_waitcnt vmcnt(0)
    s_branch L_c14
L_r15:
    s_add_u32 s29, s29, 1
    s_cmp_ge_u32 s29, 200000
    s_cbranch_scc1 L_g15
    s_add_u32 s3, s76, 15360
    buffer_load_dwordx4 v[64:67], v108, s[48:51], s3 offen sc1
    buffer_load_dwordx4 v[68:71], v109, s[48:51], s3 offen sc1
    s_waitcnt vmcnt(0)
    s_branch L_c15
.p2align 8
.fill 4096, 4, 0xbf800000
.section .rodata,"a"
.p2align 6
.amdhsa_kernel recurrent_scan__linear_kernel_hedgehog__moe_arch_mod__prompt_kernel
  .amdhsa_next_free_vgpr 256
  .amdhsa_next_free_sgpr 102
  .amdhsa_accum_offset 256
  .amdhsa_group_segment_fixed_size 0
  .amdhsa_kernarg_size 96
  .amdhsa_user_sgpr_count 2
  .amdhsa_user_sgpr_kernarg_segment_ptr 1
  .amdhsa_system_sgpr_workgroup_id_x 1
.end_amdhsa_kernel
```

```asm
; @launch grid=(256,1,1) block=(512,1,1) lds=163840
.amdgcn_target "amdgcn-amd-amdhsa--gfx950"
.text
.globl recurrent_scan__linear_kernel_hedgehog__moe_arch_mod__prompt_kernel
.p2align 8
.type recurrent_scan__linear_kernel_hedgehog__moe_arch_mod__prompt_kernel,@function
recurrent_scan__linear_kernel_hedgehog__moe_arch_mod__prompt_kernel:
    s_cmp_ge_u32 s2, 256
    s_cbranch_scc1 L_done
    s_load_dwordx16 s[4:19], s[0:1], 0
    s_load_dwordx8 s[20:27], s[0:1], 64
    v_and_b32 v1, 63, v0
    v_lshrrev_b32 v2, 6, v0
    s_nop 0
    v_readfirstlane_b32 s39, v2
    s_and_b32 s34, s2, 1
    s_lshl_b32 s34, s34, 3
    s_bfe_u32 s3, s2, 0x30003
    s_add_u32 s36, s34, s3
    s_bfe_u32 s37, s2, 0x20001
    s_lshl_b32 s37, s37, 2
    s_lshr_b32 s28, s2, 6
    s_add_u32 s37, s37, s28
    s_mov_b32 s34, s36
    s_xor_b32 s35, s37, 1
    s_and_b32 s38, s39, 3
    s_cmp_lt_u32 s39, 4
    s_cbranch_scc1 L_C
L_H:
    v_and_b32 v4, 7, v1
    s_lshl_b32 s33, s37, 7
    s_add_u32 s85, s36, s37
    s_and_b32 s85, s85, 3
    s_lshl_b32 s87, s85, 7
    s_and_b32 s66, s36, 8
    s_lshl_b32 s66, s66, 7
    s_lshl_b32 s3, s36, 7
    s_lshl_b32 s28, s38, 5
    s_add_u32 s3, s3, s28
    v_lshrrev_b32 v7, 3, v1
    v_add_u32 v3, s3, v7
    v_lshlrev_b32 v3, 11, v3
    v_lshrrev_b32 v5, 4, v1
    v_xor_b32 v6, v4, v5
    v_xor_b32 v5, 4, v6
    v_lshl_add_u32 v6, v6, 4, v3
    v_lshl_add_u32 v5, v5, 4, v3
    v_add_u32_e64 v8, 0, v6
    v_add_u32 v9, 15360, v5
    v_add_u32 v10, 30720, v6
    v_add_u32 v11, 46080, v5
    s_lshr_b32 s32, s36, 1
    s_and_b32 s32, s32, 2
    s_xor_b32 s32, s32, s38
    s_lshl_b32 s3, s32, 4
    v_add_u32_e64 v7, s3, v7
    v_mul_u32_u24 v7, 6144, v7
    v_bfe_u32 v6, v1, 4, 1
    v_lshlrev_b32 v6, 1, v6
    v_xor_b32 v5, v4, v6
    v_add_u32 v7, s33, v7
    v_xor_b32 v6, 4, v5
    v_lshl_add_u32 v6, v6, 4, v7
    v_lshl_add_u32 v7, v5, 4, v7
    v_add_u32_e64 v12, 0, v7
    v_add_u32 v13, 48128, v6
    v_add_u32 v14, 2048, v7
    v_add_u32 v15, 50176, v6
    v_add_u32 v16, 4096, v7
    v_add_u32 v17, 52224, v6
    v_xor_b32 v12, 512, v12
    v_xor_b32 v13, 512, v13
    s_lshl_b32 s30, s38, 12
    s_lshl_b32 s31, s32, 11
    s_add_u32 s31, s31, 16384
    s_waitcnt lgkmcnt(0)
    s_mov_b32 s44, s6
    s_mov_b32 s45, s7
    s_mov_b32 s46, 6291456
    s_mov_b32 s47, 0x00020000
    s_mov_b32 s40, s4
    s_mov_b32 s41, s5
    s_mov_b32 s42, 4194304
    s_mov_b32 s43, 0x00020000
    v_lshlrev_b32 v252, 4, v1
    s_mov_b32 s48, s26
    s_mov_b32 s49, s27
    s_mov_b32 s50, 268435456
    s_mov_b32 s51, 0x00020000
    v_mov_b32 v19, 16384
    buffer_load_dword v19, v19, s[48:51], 0 offen sc1
    s_lshl_b32 s3, s36, 7
    s_lshl_b32 s28, s37, 3
    s_add_u32 s3, s3, s28
    s_lshl_b32 s3, s3, 11
    s_add_u32 s3, s3, s30
    s_add_u32 m0, s30, 131072
    s_nop 0
    buffer_load_dwordx4 v252, s[40:43], s3 offen offset:0 lds
    buffer_load_dwordx4 v252, s[40:43], s3 offen offset:2048 lds
    s_lshl_b32 s3, s36, 7
    s_lshl_b32 s28, s37, 3
    s_add_u32 s3, s3, s28
    s_lshl_b32 s3, s3, 11
    s_add_u32 s3, s3, s30
    s_add_u32 m0, s30, 131072
    s_nop 0
    buffer_load_dwordx4 v252, s[40:43], s3 offen offset:1024 lds
    buffer_load_dwordx4 v252, s[40:43], s3 offen offset:3072 lds
    s_mov_b32 s60, s14
    s_mov_b32 s61, s15
    s_mov_b32 s62, 2048
    s_mov_b32 s63, 0x00020000
    s_lshl_b32 s3, s38, 9
    s_add_u32 m0, s3, 122880
    s_mov_b32 exec_hi, 0
    buffer_load_dwordx4 v252, s[60:63], s3 offen lds
    s_mov_b64 exec, -1
    s_add_u32 s64, s87, 0
    s_and_b32 s64, s64, 511
    s_or_b32 s64, s64, 0
    s_xor_b32 s64, s64, s66
    s_mul_i32 s65, s64, 3072
    s_add_u32 m0, s31, 0
    s_nop 0
    buffer_load_dwordx4 v12, s[44:47], s65 offen offset:0 lds
    buffer_load_dwordx4 v13, s[44:47], s65 offen offset:1024 lds
    s_add_u32 m0, s31, 8192
    s_nop 0
    buffer_load_dwordx4 v14, s[44:47], s65 offen offset:0 lds
    buffer_load_dwordx4 v15, s[44:47], s65 offen offset:1024 lds
    s_add_u32 m0, s31, 16384
    s_nop 0
    buffer_load_dwordx4 v16, s[44:47], s65 offen offset:0 lds
    buffer_load_dwordx4 v17, s[44:47], s65 offen offset:1024 lds
    v_mov_b32 v248, -1
    v_mov_b32 v249, -1
    v_mov_b32 v250, -1
    v_mov_b32 v251, -1
    v_lshlrev_b32 v252, 4, v1
    s_and_b32 s85, s85, 0
    s_lshl_b32 s3, s37, 4
    s_add_u32 s3, s3, s36
    s_mul_i32 s67, s3, 768
    s_add_u32 s67, s67, 1048576
    s_lshl_b32 s3, s38, 8
    s_add_u32 s67, s67, s3
    s_cmp_eq_u32 s38, 3
    s_cselect_b32 s67, 268435456, s67
    v_mov_b32 v24, 0
    v_mov_b32 v25, 0
    v_mov_b32 v26, 0
    v_mov_b32 v27, 0
    v_mov_b32 v28, 0
    v_mov_b32 v29, 0
    v_mov_b32 v30, 0
    v_mov_b32 v31, 0
    v_lshlrev_b32 v253, 2, v1
    s_cmp_gt_u32 s37, 3
    s_subb_u32 s77, s37, 0
    s_cmp_gt_u32 s37, 11
    s_subb_u32 s77, s77, 0
    s_lshl_b32 s77, s77, 4
    s_add_u32 s77, s77, s36
    s_and_b32 s3, s37, 7
    s_cmp_eq_u32 s3, 3
    s_cselect_b32 s77, 224, s77
    s_bitcmp1_b32 s38, 0
    s_cselect_b32 s52, s18, s16
    s_cselect_b32 s53, s19, s17
    s_cmp_lt_u32 s77, 224
    s_cselect_b32 s54, 7340032, 0
    s_mov_b32 s55, 0x00020000
    s_mov_b32 s56, s20
    s_mov_b32 s57, s21
    s_mov_b32 s58, 7340032
    s_mov_b32 s59, 0x00020000
    s_and_b32 s3, s77, 3
    s_lshl_b32 s3, s3, 8
    s_lshr_b32 s28, s38, 1
    s_lshl_b32 s28, s28, 7
    s_add_u32 s3, s3, s28
    v_lshrrev_b32_e64 v5, 3, v1
    v_lshl_add_u32 v6, v5, 4, s3
    v_mul_u32_u24 v6, 7168, v6
    v_lshl_add_u32 v6, v4, 4, v6
    s_lshr_b32 s3, s77, 2
    s_lshl_b32 s3, s3, 7
    v_add_u32 v21, s3, v6
    s_lshr_b32 s3, s2, 4
    s_mul_i32 s3, s3, 224
    s_mul_i32 s28, s38, 56
    s_add_u32 s71, s3, s28
    v_lshlrev_b32 v6, 14, v5
    v_lshl_add_u32 v6, v4, 4, v6
    s_and_b32 s3, s2, 15
    s_lshl_b32 s3, s3, 7
    v_add_u32 v22, s3, v6
    v_add_u32 v232, 131080, v252
    v_lshrrev_b32 v2, 5, v1
    v_and_b32 v3, 31, v1
    v_lshl_add_u32 v2, v2, 7, v3
    s_lshl_b32 s3, s38, 7
    s_add_u32 s3, s3, 152064
    v_lshl_add_u32 v230, v2, 2, s3
    v_bfe_u32 v4, v1, 2, 2
    v_lshlrev_b32 v4, 3, v4
    v_bfe_u32 v7, v1, 4, 1
    v_lshl_add_u32 v4, v7, 2, v4
    v_and_b32 v7, 3, v1
    v_add_u32_e64 v4, v4, v7
    s_lshl_b32 s3, s38, 6
    s_add_u32 s3, s3, 154624
    v_lshl_add_u32 v231, v4, 1, s3
    s_lshl_b32 s3, s36, 7
    s_lshl_b32 s28, s34, 7
    v_mov_b32 v2, s3
    v_mov_b32 v4, s28
    v_cmp_gt_u32 vcc, 32, v1
    s_lshl_b32 s3, s38, 5
    v_and_b32 v3, 30, v1
    v_cndmask_b32 v2, v4, v2, vcc
    v_add3_u32 v2, v2, v3, s3
    v_and_b32 v3, 1, v1
    v_lshl_add_u32 v2, v2, 1, v3
    v_lshlrev_b32 v2, 2, v2
    v_add_u32 v237, 131072, v2
    s_mul_i32 s3, s38, 48
    v_and_b32 v2, 15, v1
    v_min_u32 v2, 11, v2
    v_lshrrev_b32 v3, 4, v1
    v_lshlrev_b32 v4, 4, v2
    v_lshl_add_u32 v2, v2, 2, v3
    v_add_u32 v2, s3, v2
    v_and_b32_e64 v5, 7, v2
    v_bfe_u32 v6, v2, 3, 3
    v_lshl_add_u32 v5, v5, 3, v6
    v_and_b32 v2, 0xc0, v2
    v_add_u32 v2, v2, v5
    v_lshlrev_b32 v2, 2, v2
    v_add_u32 v233, 154880, v2
    v_mul_u32_u24 v3, 768, v3
    v_add_u32 v235, v3, v4
    v_mov_b32 v234, 162048
    v_lshrrev_b32 v5, 3, v1
    v_lshlrev_b32 v6, 11, v5
    v_bfe_u32 v5, v1, 4, 2
    v_lshlrev_b32 v5, 1, v5
    v_and_b32 v7, 7, v1
    v_xor_b32 v5, v5, v7
    v_lshl_add_u32 v6, v5, 4, v6
    s_lshl_b32 s3, s35, 7
    v_add_u32 v6, s3, v6
    v_add_u32_e64 v220, 0, v6
    v_add_u32 v221, 15360, v6
    v_add_u32 v222, 30720, v6
    v_add_u32 v223, 46080, v6
    s_lshl_b32 s72, s38, 12
    s_lshl_b32 s73, s38, 16
    s_lshl_b32 s3, s36, 2
    s_add_u32 s3, s3, s38
    s_lshr_b32 s28, s3, 5
    s_and_b32 s3, s3, 31
    s_lshl_b32 s74, s3, 7
    s_lshl_b32 s3, s37, 1
    s_add_u32 s75, s3, s28
    v_lshrrev_b32 v5, 3, v1
    v_mul_u32_u24 v5, 4224, v5
    v_and_b32_e64 v7, 7, v1
    v_lshl_add_u32 v112, v7, 4, v5
    s_mul_i32 s76, s75, 67584
    s_add_u32 s76, s76, s74
    s_add_u32 s76, s76, 8388608
    s_mul_i32 s3, s75, 4224
    s_add_u32 s3, s3, s74
    s_add_u32 s74, s3, 1245184
    s_lshl_b32 s75, s37, 1
    s_add_u32 s75, s75, s36
    s_mul_i32 s81, s75, 67584
    s_add_u32 s81, s81, 8392704
    s_mul_i32 s82, s75, 4224
    s_add_u32 s82, s82, 1249280
    s_lshr_b32 s3, s36, 1
    s_or_b32 s83, s3, s38
    s_and_b32 s3, s38, 1
    s_lshl_b32 s3, s3, 3
    s_and_b32 s28, s77, 3
    s_lshl_b32 s28, s28, 1
    s_add_u32 s3, s3, s28
    s_lshr_b32 s28, s38, 1
    s_add_u32 s3, s3, s28
    s_mul_i32 s3, s3, 14336
    s_lshr_b32 s28, s77, 2
    s_lshl_b32 s28, s28, 8
    s_add_u32 s3, s3, s28
    s_add_u32 s3, s3, 1380352
    s_cmp_lt_u32 s77, 224
    s_cselect_b32 s84, s3, 268435456
    v_and_b32 v2, 15, v1
    v_bfe_u32 v3, v1, 4, 1
    v_mul_u32_u24 v3, 4, v3
    v_xor_b32_e64 v3, s37, v3
    v_lshl_add_u32 v3, v3, 4, v2
    v_lshl_add_u32 v2, v2, 4, s34
    v_cmp_gt_u32 vcc, 32, v1
    s_nop 1
    v_cndmask_b32 v2, v2, v3, vcc
    v_lshlrev_b32 v113, 7, v2
    v_bfe_u32 v5, v1, 4, 1
    v_lshlrev_b32 v5, 5, v5
    v_xor_b32 v5, v5, v252
    s_min_u32 s3, s38, 2
    s_lshl_b32 s3, s3, 13
    s_and_b32 s28, s36, 4
    s_lshl_b32 s28, s28, 10
    s_add_u32 s3, s3, s28
    s_add_u32 s3, s3, 16384
    v_add_u32 v18, s3, v5
    s_lshr_b32 s3, s38, 1
    s_lshl_b32 s28, s37, 1
    s_add_u32 s28, s28, s3
    s_and_b32 s29, s38, 1
    s_lshl_b32 s3, s28, 4
    s_add_u32 s3, s3, s36
    s_mul_i32 s3, s3, 4224
    s_mul_i32 s78, s29, 2112
    s_add_u32 s78, s78, s3
    s_add_u32 s78, s78, 8388608
    s_lshl_b32 s3, s36, 1
    s_add_u32 s29, s29, s3
    s_xor_b32 s28, s28, 8
    s_lshl_b32 s3, s29, 7
    s_add_u32 s3, s3, s28
    s_lshl_b32 s3, s3, 10
    s_add_u32 s79, s3, 4194304
    s_mov_b32 s88, s10
    s_mov_b32 s89, s11
    s_mov_b32 s90, 2097152
    s_mov_b32 s91, 0x00020000
    s_add_u32 s64, s87, 0
    s_and_b32 s64, s64, 511
    s_or_b32 s64, s64, 0
    s_xor_b32 s64, s64, s66
    s_mul_i32 s65, s64, 3072
    s_add_u32 m0, s30, 0
    s_nop 0
    buffer_load_dwordx4 v8, s[40:43], s64 offen offset:0 lds
    buffer_load_dwordx4 v9, s[40:43], s64 offen offset:1024 lds
    buffer_load_dwordx4 v10, s[40:43], s64 offen offset:2048 lds
    buffer_load_dwordx4 v11, s[40:43], s64 offen offset:3072 lds
    s_waitcnt vmcnt(10)
    s_barrier
    s_add_u32 s64, s87, 128
    s_and_b32 s64, s64, 511
    s_or_b32 s64, s64, 0
    s_xor_b32 s64, s64, s66
    s_mul_i32 s65, s64, 3072
    s_add_u32 m0, s30, 40960
    s_nop 0
    buffer_load_dwordx4 v8, s[40:43], s64 offen offset:0 lds
    buffer_load_dwordx4 v9, s[40:43], s64 offen offset:1024 lds
    buffer_load_dwordx4 v10, s[40:43], s64 offen offset:2048 lds
    buffer_load_dwordx4 v11, s[40:43], s64 offen offset:3072 lds
    s_add_u32 m0, s31, 40960
    s_nop 0
    buffer_load_dwordx4 v12, s[44:47], s65 offen offset:0 lds
    buffer_load_dwordx4 v13, s[44:47], s65 offen offset:1024 lds
    s_add_u32 m0, s31, 49152
    s_nop 0
    buffer_load_dwordx4 v14, s[44:47], s65 offen offset:0 lds
    buffer_load_dwordx4 v15, s[44:47], s65 offen offset:1024 lds
    s_add_u32 m0, s31, 57344
    s_nop 0
    buffer_load_dwordx4 v16, s[44:47], s65 offen offset:0 lds
    buffer_load_dwordx4 v17, s[44:47], s65 offen offset:1024 lds
    v_readfirstlane_b32 s86, v19
    s_nop 0
    s_add_u32 s86, s86, 1
    s_waitcnt vmcnt(10)
    s_waitcnt lgkmcnt(0)
    s_barrier
    v_add_u32 v2, 0, v18
    v_xor_b32 v3, 64, v2
    ds_read_b128 v[32:35], v2 offset:0
    ds_read_b128 v[36:39], v3 offset:1024
    ds_read_b128 v[40:43], v2 offset:2048
    ds_read_b128 v[44:47], v3 offset:3072
    s_add_u32 s64, s87, 256
    s_and_b32 s64, s64, 511
    s_or_b32 s64, s64, 0
    s_xor_b32 s64, s64, s66
    s_mul_i32 s65, s64, 3072
    s_add_u32 m0, s30, 81920
    s_nop 0
    buffer_load_dwordx4 v8, s[40:43], s64 offen offset:0 lds
    buffer_load_dwordx4 v9, s[40:43], s64 offen offset:1024 lds
    buffer_load_dwordx4 v10, s[40:43], s64 offen offset:2048 lds
    buffer_load_dwordx4 v11, s[40:43], s64 offen offset:3072 lds
    s_add_u32 m0, s31, 81920
    s_nop 0
    buffer_load_dwordx4 v12, s[44:47], s65 offen offset:0 lds
    buffer_load_dwordx4 v13, s[44:47], s65 offen offset:1024 lds
    s_add_u32 m0, s31, 90112
    s_nop 0
    buffer_load_dwordx4 v14, s[44:47], s65 offen offset:0 lds
    buffer_load_dwordx4 v15, s[44:47], s65 offen offset:1024 lds
    s_add_u32 m0, s31, 98304
    s_nop 0
    buffer_load_dwordx4 v16, s[44:47], s65 offen offset:0 lds
    buffer_load_dwordx4 v17, s[44:47], s65 offen offset:1024 lds
    buffer_store_dwordx4 v[248:251], v252, s[48:51], s78 offen offset:0 sc1
    buffer_store_dwordx4 v[248:251], v252, s[48:51], s78 offen offset:1024 sc1
    s_mov_b64 exec, 15
    buffer_store_dwordx4 v[248:251], v252, s[48:51], s78 offen offset:2048 sc1
    s_mov_b64 exec, -1
    s_waitcnt vmcnt(13)
    s_waitcnt lgkmcnt(0)
    s_barrier
    s_add_u32 s64, s87, 384
    s_and_b32 s64, s64, 511
    s_or_b32 s64, s64, 0
    s_xor_b32 s64, s64, s66
    s_mul_i32 s65, s64, 3072
    s_add_u32 m0, s30, 0
    s_nop 0
    buffer_load_dwordx4 v8, s[40:43], s64 offen offset:0 lds
    buffer_load_dwordx4 v9, s[40:43], s64 offen offset:1024 lds
    v_lshlrev_b32 v2, 16, v32
    v_and_b32 v3, 0xffff0000, v32
    v_add_f32 v24, v24, v2
    v_add_f32 v25, v25, v3
    buffer_load_dwordx4 v10, s[40:43], s64 offen offset:2048 lds
    v_lshlrev_b32 v4, 16, v33
    v_and_b32 v5, 0xffff0000, v33
    v_add_f32 v26, v26, v4
    v_add_f32 v27, v27, v5
    buffer_load_dwordx4 v11, s[40:43], s64 offen offset:3072 lds
    v_lshlrev_b32 v2, 16, v34
    v_and_b32 v3, 0xffff0000, v34
    v_add_f32 v28, v28, v2
    v_add_f32 v29, v29, v3
    s_add_u32 m0, s31, 0
    s_nop 0
    buffer_load_dwordx4 v12, s[44:47], s65 offen offset:0 lds
    v_lshlrev_b32 v4, 16, v35
    v_and_b32 v5, 0xffff0000, v35
    v_add_f32 v30, v30, v4
    v_add_f32 v31, v31, v5
    buffer_load_dwordx4 v13, s[44:47], s65 offen offset:1024 lds
    v_lshlrev_b32 v2, 16, v36
    v_and_b32 v3, 0xffff0000, v36
    v_add_f32 v24, v24, v2
    v_add_f32 v25, v25, v3
    s_add_u32 m0, s31, 8192
    s_nop 0
    buffer_load_dwordx4 v14, s[44:47], s65 offen offset:0 lds
    v_lshlrev_b32 v4, 16, v37
    v_and_b32 v5, 0xffff0000, v37
    v_add_f32 v26, v26, v4
    v_add_f32 v27, v27, v5
    buffer_load_dwordx4 v15, s[44:47], s65 offen offset:1024 lds
    v_lshlrev_b32 v2, 16, v38
    v_and_b32 v3, 0xffff0000, v38
    v_add_f32 v28, v28, v2
    v_add_f32 v29, v29, v3
    s_add_u32 m0, s31, 16384
    s_nop 0
    buffer_load_dwordx4 v16, s[44:47], s65 offen offset:0 lds
    v_lshlrev_b32 v4, 16, v39
    v_and_b32 v5, 0xffff0000, v39
    v_add_f32 v30, v30, v4
    v_add_f32 v31, v31, v5
    buffer_load_dwordx4 v17, s[44:47], s65 offen offset:1024 lds
    s_add_u32 s3, s79, 0
    buffer_store_dwordx4 v[248:251], v252, s[48:51], s3 offen sc1
    s_waitcnt vmcnt(14)
    s_waitcnt lgkmcnt(0)
    s_barrier
    s_add_u32 s64, s87, 0
    s_and_b32 s64, s64, 511
    s_or_b32 s64, s64, 512
    s_xor_b32 s64, s64, s66
    s_mul_i32 s65, s64, 3072
    s_add_u32 m0, s30, 40960
    s_nop 0
    buffer_load_dwordx4 v8, s[40:43], s64 offen offset:0 lds
    buffer_load_dwordx4 v9, s[40:43], s64 offen offset:1024 lds
    v_lshlrev_b32 v2, 16, v40
    v_and_b32 v3, 0xffff0000, v40
    v_add_f32 v24, v24, v2
    v_add_f32 v25, v25, v3
    buffer_load_dwordx4 v10, s[40:43], s64 offen offset:2048 lds
    v_lshlrev_b32 v4, 16, v41
    v_and_b32 v5, 0xffff0000, v41
    v_add_f32 v26, v26, v4
    v_add_f32 v27, v27, v5
    buffer_load_dwordx4 v11, s[40:43], s64 offen offset:3072 lds
    v_lshlrev_b32 v2, 16, v42
    v_and_b32 v3, 0xffff0000, v42
    v_add_f32 v28, v28, v2
    v_add_f32 v29, v29, v3
    s_add_u32 m0, s31, 40960
    s_nop 0
    buffer_load_dwordx4 v12, s[44:47], s65 offen offset:0 lds
    v_lshlrev_b32 v4, 16, v43
    v_and_b32 v5, 0xffff0000, v43
    v_add_f32 v30, v30, v4
    v_add_f32 v31, v31, v5
    buffer_load_dwordx4 v13, s[44:47], s65 offen offset:1024 lds
    v_lshlrev_b32 v2, 16, v44
    v_and_b32 v3, 0xffff0000, v44
    v_add_f32 v24, v24, v2
    v_add_f32 v25, v25, v3
    s_add_u32 m0, s31, 49152
    s_nop 0
    buffer_load_dwordx4 v14, s[44:47], s65 offen offset:0 lds
    v_lshlrev_b32 v4, 16, v45
    v_and_b32 v5, 0xffff0000, v45
    v_add_f32 v26, v26, v4
    v_add_f32 v27, v27, v5
    buffer_load_dwordx4 v15, s[44:47], s65 offen offset:1024 lds
    v_lshlrev_b32 v2, 16, v46
    v_and_b32 v3, 0xffff0000, v46
    v_add_f32 v28, v28, v2
    v_add_f32 v29, v29, v3
    s_add_u32 m0, s31, 57344
    s_nop 0
    buffer_load_dwordx4 v16, s[44:47], s65 offen offset:0 lds
    v_lshlrev_b32 v4, 16, v47
    v_and_b32 v5, 0xffff0000, v47
    v_add_f32 v30, v30, v4
    v_add_f32 v31, v31, v5
    buffer_load_dwordx4 v17, s[44:47], s65 offen offset:1024 lds
    s_waitcnt vmcnt(11)
    s_waitcnt lgkmcnt(0)
    s_barrier
    s_add_u32 s64, s87, 128
    s_and_b32 s64, s64, 511
    s_or_b32 s64, s64, 512
    s_xor_b32 s64, s64, s66
    s_mul_i32 s65, s64, 3072
    s_add_u32 m0, s30, 81920
    s_nop 0
    buffer_load_dwordx4 v8, s[40:43], s64 offen offset:0 lds
    buffer_load_dwordx4 v9, s[40:43], s64 offen offset:1024 lds
    buffer_load_dwordx4 v10, s[40:43], s64 offen offset:2048 lds
    buffer_load_dwordx4 v11, s[40:43], s64 offen offset:3072 lds
    s_add_u32 m0, s31, 81920
    s_nop 0
    buffer_load_dwordx4 v12, s[44:47], s65 offen offset:0 lds
    buffer_load_dwordx4 v13, s[44:47], s65 offen offset:1024 lds
    s_add_u32 m0, s31, 90112
    s_nop 0
    buffer_load_dwordx4 v14, s[44:47], s65 offen offset:0 lds
    buffer_load_dwordx4 v15, s[44:47], s65 offen offset:1024 lds
    s_add_u32 m0, s31, 98304
    s_nop 0
    buffer_load_dwordx4 v16, s[44:47], s65 offen offset:0 lds
    buffer_load_dwordx4 v17, s[44:47], s65 offen offset:1024 lds
    s_lshl_b32 s3, s38, 12
    s_add_u32 m0, s3, 131072
    s_nop 0
    buffer_load_dwordx4 v252, s[48:51], s3 offen offset:0 sc1 lds
    buffer_load_dwordx4 v252, s[48:51], s3 offen offset:1024 sc1 lds
    s_waitcnt vmcnt(12)
    s_waitcnt lgkmcnt(0)
    s_barrier
    v_add_u32 v2, 40960, v18
    v_xor_b32_e64 v3, 64, v2
    ds_read_b128 v[48:51], v2 offset:0
    ds_read_b128 v[52:55], v3 offset:1024
    ds_read_b128 v[56:59], v2 offset:2048
    ds_read_b128 v[60:63], v3 offset:3072
    s_add_u32 s64, s87, 256
    s_and_b32 s64, s64, 511
    s_or_b32 s64, s64, 512
    s_xor_b32 s64, s64, s66
    s_mul_i32 s65, s64, 3072
    s_add_u32 m0, s30, 0
    s_nop 0
    buffer_load_dwordx4 v8, s[40:43], s64 offen offset:0 lds
    buffer_load_dwordx4 v9, s[40:43], s64 offen offset:1024 lds
    buffer_load_dwordx4 v10, s[40:43], s64 offen offset:2048 lds
    buffer_load_dwordx4 v11, s[40:43], s64 offen offset:3072 lds
    s_add_u32 m0, s31, 0
    s_nop 0
    buffer_load_dwordx4 v12, s[44:47], s65 offen offset:0 lds
    buffer_load_dwordx4 v13, s[44:47], s65 offen offset:1024 lds
    s_add_u32 m0, s31, 8192
    s_nop 0
    buffer_load_dwordx4 v14, s[44:47], s65 offen offset:0 lds
    buffer_load_dwordx4 v15, s[44:47], s65 offen offset:1024 lds
    s_add_u32 m0, s31, 16384
    s_nop 0
    buffer_load_dwordx4 v16, s[44:47], s65 offen offset:0 lds
    buffer_load_dwordx4 v17, s[44:47], s65 offen offset:1024 lds
    s_lshl_b32 s3, s38, 12
    s_add_u32 m0, s3, 131072
    s_nop 0
    buffer_load_dwordx4 v252, s[48:51], s3 offen offset:2048 sc1 lds
    buffer_load_dwordx4 v252, s[48:51], s3 offen offset:3072 sc1 lds
    s_waitcnt vmcnt(14)
    s_waitcnt lgkmcnt(0)
    s_barrier
    s_add_u32 s64, s87, 384
    s_and_b32 s64, s64, 511
    s_or_b32 s64, s64, 512
    s_xor_b32 s64, s64, s66
    s_mul_i32 s65, s64, 3072
    s_add_u32 m0, s30, 40960
    s_nop 0
    buffer_load_dwordx4 v8, s[40:43], s64 offen offset:0 lds
    buffer_load_dwordx4 v9, s[40:43], s64 offen offset:1024 lds
    v_lshlrev_b32 v2, 16, v48
    v_and_b32 v3, 0xffff0000, v48
    v_add_f32 v24, v24, v2
    v_add_f32 v25, v25, v3
    buffer_load_dwordx4 v10, s[40:43], s64 offen offset:2048 lds
    v_lshlrev_b32 v4, 16, v49
    v_and_b32 v5, 0xffff0000, v49
    v_add_f32 v26, v26, v4
    v_add_f32 v27, v27, v5
    buffer_load_dwordx4 v11, s[40:43], s64 offen offset:3072 lds
    v_lshlrev_b32 v2, 16, v50
    v_and_b32 v3, 0xffff0000, v50
    v_add_f32 v28, v28, v2
    v_add_f32 v29, v29, v3
    s_add_u32 m0, s31, 40960
    s_nop 0
    buffer_load_dwordx4 v12, s[44:47], s65 offen offset:0 lds
    v_lshlrev_b32 v4, 16, v51
    v_and_b32 v5, 0xffff0000, v51
    v_add_f32 v30, v30, v4
    v_add_f32 v31, v31, v5
    buffer_load_dwordx4 v13, s[44:47], s65 offen offset:1024 lds
    v_lshlrev_b32 v2, 16, v52
    v_and_b32 v3, 0xffff0000, v52
    v_add_f32 v24, v24, v2
    v_add_f32 v25, v25, v3
    s_add_u32 m0, s31, 49152
    s_nop 0
    buffer_load_dwordx4 v14, s[44:47], s65 offen offset:0 lds
    v_lshlrev_b32 v4, 16, v53
    v_and_b32 v5, 0xffff0000, v53
    v_add_f32 v26, v26, v4
    v_add_f32 v27, v27, v5
    buffer_load_dwordx4 v15, s[44:47], s65 offen offset:1024 lds
    v_lshlrev_b32 v2, 16, v54
    v_and_b32 v3, 0xffff0000, v54
    v_add_f32 v28, v28, v2
    v_add_f32 v29, v29, v3
    s_add_u32 m0, s31, 57344
    s_nop 0
    buffer_load_dwordx4 v16, s[44:47], s65 offen offset:0 lds
    v_lshlrev_b32 v4, 16, v55
    v_and_b32 v5, 0xffff0000, v55
    v_add_f32 v30, v30, v4
    v_add_f32 v31, v31, v5
    buffer_load_dwordx4 v17, s[44:47], s65 offen offset:1024 lds
    s_waitcnt vmcnt(10)
    s_add_u32 s3, s79, 32768
    buffer_store_dwordx4 v[248:251], v252, s[48:51], s3 offen sc1
    s_add_u32 s3, s79, 65536
    buffer_store_dwordx4 v[248:251], v252, s[48:51], s3 offen sc1
    s_waitcnt lgkmcnt(0)
    s_barrier
    ds_read_b64 v[80:81], v232 offset:0
    ds_read_b64 v[82:83], v232 offset:1024
    ds_read_b64 v[84:85], v232 offset:2048
    ds_read_b64 v[86:87], v232 offset:3072
    ds_read_b64 v[88:89], v232 offset:4096
    ds_read_b64 v[90:91], v232 offset:5120
    ds_read_b64 v[92:93], v232 offset:6144
    ds_read_b64 v[94:95], v232 offset:7168
    s_add_u32 s64, s87, 0
    s_and_b32 s64, s64, 511
    s_or_b32 s64, s64, 1024
    s_xor_b32 s64, s64, s66
    s_mul_i32 s65, s64, 3072
    s_add_u32 m0, s30, 81920
    s_nop 0
    buffer_load_dwordx4 v8, s[40:43], s64 offen offset:0 lds
    buffer_load_dwordx4 v9, s[40:43], s64 offen offset:1024 lds
    v_lshlrev_b32 v2, 16, v56
    v_and_b32 v3, 0xffff0000, v56
    v_add_f32 v24, v24, v2
    v_add_f32 v25, v25, v3
    buffer_load_dwordx4 v10, s[40:43], s64 offen offset:2048 lds
    v_lshlrev_b32 v4, 16, v57
    v_and_b32 v5, 0xffff0000, v57
    v_add_f32 v26, v26, v4
    v_add_f32 v27, v27, v5
    buffer_load_dwordx4 v11, s[40:43], s64 offen offset:3072 lds
    v_lshlrev_b32 v2, 16, v58
    v_and_b32 v3, 0xffff0000, v58
    v_add_f32 v28, v28, v2
    v_add_f32 v29, v29, v3
    s_add_u32 m0, s31, 81920
    s_nop 0
    buffer_load_dwordx4 v12, s[44:47], s65 offen offset:0 lds
    v_lshlrev_b32 v4, 16, v59
    v_and_b32 v5, 0xffff0000, v59
    v_add_f32 v30, v30, v4
    v_add_f32 v31, v31, v5
    buffer_load_dwordx4 v13, s[44:47], s65 offen offset:1024 lds
    v_lshlrev_b32 v2, 16, v60
    v_and_b32 v3, 0xffff0000, v60
    v_add_f32 v24, v24, v2
    v_add_f32 v25, v25, v3
    s_add_u32 m0, s31, 90112
    s_nop 0
    buffer_load_dwordx4 v14, s[44:47], s65 offen offset:0 lds
    v_lshlrev_b32 v4, 16, v61
    v_and_b32 v5, 0xffff0000, v61
    v_add_f32 v26, v26, v4
    v_add_f32 v27, v27, v5
    buffer_load_dwordx4 v15, s[44:47], s65 offen offset:1024 lds
    v_lshlrev_b32 v2, 16, v62
    v_and_b32 v3, 0xffff0000, v62
    v_add_f32 v28, v28, v2
    v_add_f32 v29, v29, v3
    s_add_u32 m0, s31, 98304
    s_nop 0
    buffer_load_dwordx4 v16, s[44:47], s65 offen offset:0 lds
    v_lshlrev_b32 v4, 16, v63
    v_and_b32 v5, 0xffff0000, v63
    v_add_f32 v30, v30, v4
    v_add_f32 v31, v31, v5
    buffer_load_dwordx4 v17, s[44:47], s65 offen offset:1024 lds
    s_waitcnt vmcnt(12)
    s_waitcnt lgkmcnt(0)
    s_barrier
    s_nop 0
    ds_read_b64 v[96:97], v232 offset:8192
    ds_read_b64 v[98:99], v232 offset:9216
    ds_read_b64 v[100:101], v232 offset:10240
    ds_read_b64 v[102:103], v232 offset:11264
    ds_read_b64 v[104:105], v232 offset:12288
    ds_read_b64 v[106:107], v232 offset:13312
    ds_read_b64 v[108:109], v232 offset:14336
    ds_read_b64 v[110:111], v232 offset:15360
    ds_read_b32 v72, v237
    v_permlane32_swap_b32 v24, v28
    v_permlane32_swap_b32 v25, v29
    v_permlane32_swap_b32 v26, v30
    v_permlane32_swap_b32 v27, v31
    v_add_f32 v24, v24, v28
    v_add_f32 v25, v25, v29
    v_add_f32 v26, v26, v30
    v_add_f32 v27, v27, v31
    s_nop 0
    v_permlane16_swap_b32 v24, v26
    v_permlane16_swap_b32 v25, v27
    v_add_f32 v24, v24, v26
    v_add_f32 v25, v25, v27
    s_nop 0
    v_add_f32 v24, v24, v24 row_ror:8 row_mask:0xf bank_mask:0xf
    v_add_f32 v25, v25, v25 row_ror:8 row_mask:0xf bank_mask:0xf
    s_add_u32 s64, s87, 128
    s_and_b32 s64, s64, 511
    s_or_b32 s64, s64, 1024
    s_xor_b32 s64, s64, s66
    s_mul_i32 s65, s64, 3072
    s_add_u32 m0, s30, 0
    s_nop 0
    buffer_load_dwordx4 v8, s[40:43], s64 offen offset:0 lds
    buffer_load_dwordx4 v9, s[40:43], s64 offen offset:1024 lds
    buffer_load_dwordx4 v10, s[40:43], s64 offen offset:2048 lds
    buffer_load_dwordx4 v11, s[40:43], s64 offen offset:3072 lds
    s_add_u32 m0, s31, 0
    s_nop 0
    buffer_load_dwordx4 v12, s[44:47], s65 offen offset:0 lds
    buffer_load_dwordx4 v13, s[44:47], s65 offen offset:1024 lds
    s_add_u32 m0, s31, 8192
    s_nop 0
    buffer_load_dwordx4 v14, s[44:47], s65 offen offset:0 lds
    buffer_load_dwordx4 v15, s[44:47], s65 offen offset:1024 lds
    s_add_u32 m0, s31, 16384
    s_nop 0
    buffer_load_dwordx4 v16, s[44:47], s65 offen offset:0 lds
    buffer_load_dwordx4 v17, s[44:47], s65 offen offset:1024 lds
    s_waitcnt vmcnt(10)
    s_waitcnt lgkmcnt(0)
    s_barrier
    v_min3_u32 v4, v81, v83, v85
    v_max3_u32 v5, v81, v83, v85
    v_min3_u32 v4, v4, v87, v89
    v_max3_u32 v5, v5, v87, v89
    v_min3_u32 v4, v4, v91, v93
    v_max3_u32 v5, v5, v91, v93
    v_min3_u32 v4, v4, v95, v97
    v_max3_u32 v5, v5, v95, v97
    v_min3_u32 v4, v4, v99, v101
    v_max3_u32 v5, v5, v99, v101
    v_min3_u32 v4, v4, v103, v105
    v_max3_u32 v5, v5, v103, v105
    v_min3_u32 v4, v4, v107, v109
    v_max3_u32 v5, v5, v107, v109
    s_mov_b32 s29, 0
L_k1:
    v_cmp_ne_u32 vcc, s86, v4
    v_cmp_ne_u32 s[92:93], s86, v5
    s_nop 0
    s_or_b64 vcc, vcc, s[92:93]
    v_cmp_ne_u32 s[92:93], s86, v111
    s_nop 0
    s_or_b64 vcc, vcc, s[92:93]
    s_cbranch_vccz L_k1k
    s_add_u32 s29, s29, 1
    s_cmp_ge_u32 s29, 200000
    s_cbranch_scc1 L_k1k
    s_sleep 2
    s_mov_b32 m0, 131072
    s_movk_i32 s3, 0
    buffer_load_dwordx4 v252, s[48:51], s3 offen offset:0 sc1 lds
    buffer_load_dwordx4 v252, s[48:51], s3 offen offset:1024 sc1 lds
    buffer_load_dwordx4 v252, s[48:51], s3 offen offset:2048 sc1 lds
    buffer_load_dwordx4 v252, s[48:51], s3 offen offset:3072 sc1 lds
    s_mov_b32 m0, 135168
    s_movk_i32 s3, 4096
    buffer_load_dwordx4 v252, s[48:51], s3 offen offset:0 sc1 lds
    buffer_load_dwordx4 v252, s[48:51], s3 offen offset:1024 sc1 lds
    buffer_load_dwordx4 v252, s[48:51], s3 offen offset:2048 sc1 lds
    buffer_load_dwordx4 v252, s[48:51], s3 offen offset:3072 sc1 lds
    s_mov_b32 m0, 139264
    s_movk_i32 s3, 8192
    buffer_load_dwordx4 v252, s[48:51], s3 offen offset:0 sc1 lds
    buffer_load_dwordx4 v252, s[48:51], s3 offen offset:1024 sc1 lds
    buffer_load_dwordx4 v252, s[48:51], s3 offen offset:2048 sc1 lds
    buffer_load_dwordx4 v252, s[48:51], s3 offen offset:3072 sc1 lds
    s_mov_b32 m0, 143360
    s_movk_i32 s3, 12288
    buffer_load_dwordx4 v252, s[48:51], s3 offen offset:0 sc1 lds
    buffer_load_dwordx4 v252, s[48:51], s3 offen offset:1024 sc1 lds
    buffer_load_dwordx4 v252, s[48:51], s3 offen offset:2048 sc1 lds
    buffer_load_dwordx4 v252, s[48:51], s3 offen offset:3072 sc1 lds
    s_waitcnt vmcnt(0)
    s_nop 0
    ds_read_b64 v[80:81], v232 offset:0
    ds_read_b64 v[82:83], v232 offset:1024
    ds_read_b64 v[84:85], v232 offset:2048
    ds_read_b64 v[86:87], v232 offset:3072
    ds_read_b64 v[88:89], v232 offset:4096
    ds_read_b64 v[90:91], v232 offset:5120
    ds_read_b64 v[92:93], v232 offset:6144
    ds_read_b64 v[94:95], v232 offset:7168
    ds_read_b64 v[96:97], v232 offset:8192
    ds_read_b64 v[98:99], v232 offset:9216
    ds_read_b64 v[100:101], v232 offset:10240
    ds_read_b64 v[102:103], v232 offset:11264
    ds_read_b64 v[104:105], v232 offset:12288
    ds_read_b64 v[106:107], v232 offset:13312
    ds_read_b64 v[108:109], v232 offset:14336
    ds_read_b64 v[110:111], v232 offset:15360
    ds_read_b32 v72, v237
    s_waitcnt lgkmcnt(0)
    s_nop 0
    v_min3_u32 v4, v81, v83, v85
    v_max3_u32 v5, v81, v83, v85
    v_min3_u32 v4, v4, v87, v89
    v_max3_u32 v5, v5, v87, v89
    v_min3_u32 v4, v4, v91, v93
    v_max3_u32 v5, v5, v91, v93
    v_min3_u32 v4, v4, v95, v97
    v_max3_u32 v5, v5, v95, v97
    v_min3_u32 v4, v4, v99, v101
    v_max3_u32 v5, v5, v99, v101
    v_min3_u32 v4, v4, v103, v105
    v_max3_u32 v5, v5, v103, v105
    v_min3_u32 v4, v4, v107, v109
    v_max3_u32 v5, v5, v107, v109
    s_branch L_k1
L_k1k:
    v_and_b32 v2, 8, v1
    v_cmp_eq_u32_e64 vcc, 0, v2
    s_nop 1
    v_cndmask_b32 v24, v25, v24, vcc
    buffer_store_dword v24, v253, s[48:51], s67 offen sc1
    s_add_u32 s64, s87, 256
    s_and_b32 s64, s64, 511
    s_or_b32 s64, s64, 1024
    s_xor_b32 s64, s64, s66
    s_mul_i32 s65, s64, 3072
    s_add_u32 m0, s30, 40960
    s_nop 0
    buffer_load_dwordx4 v8, s[40:43], s64 offen offset:0 lds
    buffer_load_dwordx4 v9, s[40:43], s64 offen offset:1024 lds
    buffer_load_dwordx4 v10, s[40:43], s64 offen offset:2048 lds
    buffer_load_dwordx4 v11, s[40:43], s64 offen offset:3072 lds
    s_add_u32 m0, s31, 40960
    s_nop 0
    buffer_load_dwordx4 v12, s[44:47], s65 offen offset:0 lds
    buffer_load_dwordx4 v13, s[44:47], s65 offen offset:1024 lds
    s_add_u32 m0, s31, 49152
    s_nop 0
    buffer_load_dwordx4 v14, s[44:47], s65 offen offset:0 lds
    buffer_load_dwordx4 v15, s[44:47], s65 offen offset:1024 lds
    s_add_u32 m0, s31, 57344
    s_nop 0
    buffer_load_dwordx4 v16, s[44:47], s65 offen offset:0 lds
    buffer_load_dwordx4 v17, s[44:47], s65 offen offset:1024 lds
    s_add_u32 s3, s79, 98304
    buffer_store_dwordx4 v[248:251], v252, s[48:51], s3 offen sc1
    s_waitcnt vmcnt(12)
    s_waitcnt lgkmcnt(0)
    s_barrier
    s_add_u32 s64, s87, 384
    s_and_b32 s64, s64, 511
    s_or_b32 s64, s64, 1024
    s_xor_b32 s64, s64, s66
    s_mul_i32 s65, s64, 3072
    s_add_u32 m0, s30, 81920
    s_nop 0
    buffer_load_dwordx4 v8, s[40:43], s64 offen offset:0 lds
    buffer_load_dwordx4 v9, s[40:43], s64 offen offset:1024 lds
    v_max3_u32 v2, v80, v82, v84
    v_max3_u32 v2, v2, v86, v88
    v_max3_u32 v2, v2, v90, v92
    v_max3_u32 v2, v2, v94, v96
    buffer_load_dwordx4 v10, s[40:43], s64 offen offset:2048 lds
    v_max3_u32 v2, v2, v98, v100
    v_max3_u32 v2, v2, v102, v104
    v_max3_u32 v2, v2, v106, v108
    v_max_u32 v2, v2, v110
    buffer_load_dwordx4 v11, s[40:43], s64 offen offset:3072 lds
    s_nop 0
    v_max_u32 v2, v2, v2 quad_perm:[1,0,3,2] row_mask:0xf bank_mask:0xf
    s_nop 1
    v_max_u32 v2, v2, v2 quad_perm:[2,3,0,1] row_mask:0xf bank_mask:0xf
    s_nop 1
    v_max_u32 v2, v2, v2 row_half_mirror row_mask:0xf bank_mask:0xf
    s_nop 1
    v_max_u32 v2, v2, v2 row_mirror row_mask:0xf bank_mask:0xf
    s_add_u32 m0, s31, 81920
    s_nop 0
    buffer_load_dwordx4 v12, s[44:47], s65 offen offset:0 lds
    v_readlane_b32 s70, v2, 0
    v_readlane_b32 s3, v2, 16
    v_readlane_b32 s28, v2, 32
    v_readlane_b32 s29, v2, 48
    buffer_load_dwordx4 v13, s[44:47], s65 offen offset:1024 lds
    s_max_u32 s70, s70, s3
    s_max_u32 s28, s28, s29
    s_max_u32 s70, s70, s28
    s_and_b32 s68, s70, 0x7ff
    s_add_u32 m0, s31, 90112
    s_nop 0
    buffer_load_dwordx4 v14, s[44:47], s65 offen offset:0 lds
    s_sub_u32 s68, 2047, s68
    s_lshl_b32 s3, s68, 11
    s_and_b32 s28, s77, 3
    s_lshl_b32 s28, s28, 9
    buffer_load_dwordx4 v15, s[44:47], s65 offen offset:1024 lds
    s_add_u32 s3, s3, s28
    s_lshr_b32 s28, s38, 1
    s_lshl_b32 s28, s28, 8
    s_add_u32 s3, s3, s28
    s_add_u32 m0, s31, 98304
    s_nop 0
    buffer_load_dwordx4 v16, s[44:47], s65 offen offset:0 lds
    buffer_load_dwordx4 v17, s[44:47], s65 offen offset:1024 lds
    v_lshrrev_b32 v3, 3, v1
    v_lshlrev_b32 v3, 5, v3
    buffer_load_dwordx4 v[64:67], v3, s[40:43], s3 offen
    buffer_load_dwordx4 v[68:71], v3, s[40:43], s3 offen offset:16
    s_lshr_b32 s3, s68, 1
    s_lshl_b32 s3, s3, 4
    s_and_b32 s28, s68, 1
    s_lshl_b32 s28, s28, 2
    s_add_u32 s3, s3, s28
    s_add_u32 s3, s3, 131072
    v_mov_b32 v3, s3
    ds_read_b32 v116, v3
    s_waitcnt vmcnt(13)
    s_waitcnt lgkmcnt(0)
    s_barrier
    s_add_u32 s64, s87, 0
    s_and_b32 s64, s64, 511
    s_or_b32 s64, s64, 1536
    s_xor_b32 s64, s64, s66
    s_mul_i32 s65, s64, 3072
    s_add_u32 m0, s30, 0
    s_nop 0
    buffer_load_dwordx4 v8, s[40:43], s64 offen offset:0 lds
    buffer_load_dwordx4 v9, s[40:43], s64 offen offset:1024 lds
    v_and_b32 v228, 0xffff0000, v72
    buffer_load_dwordx4 v10, s[40:43], s64 offen offset:2048 lds
    v_lshlrev_b32 v225, 16, v72
    buffer_load_dwordx4 v11, s[40:43], s64 offen offset:3072 lds
    v_rcp_f32 v226, v228
    s_add_u32 m0, s31, 0
    s_nop 0
    buffer_load_dwordx4 v12, s[44:47], s65 offen offset:0 lds
    v_mov_b32 v224, s70
    buffer_load_dwordx4 v13, s[44:47], s65 offen offset:1024 lds
    v_mul_f32 v227, 1069066811, v226
    s_add_u32 m0, s31, 8192
    s_nop 0
    buffer_load_dwordx4 v14, s[44:47], s65 offen offset:0 lds
    buffer_load_dwordx4 v15, s[44:47], s65 offen offset:1024 lds
    s_add_u32 m0, s31, 16384
    s_nop 0
    buffer_load_dwordx4 v16, s[44:47], s65 offen offset:0 lds
    buffer_load_dwordx4 v17, s[44:47], s65 offen offset:1024 lds
    s_or_b32 s3, s2, s38
    s_mov_b32 s28, 16384
    s_cmp_lg_u32 s3, 0
    s_cselect_b32 s3, 268435456, s28
    v_mov_b32 v2, s86
    s_mov_b64 exec, 1
    buffer_store_dword v2, v252, s[48:51], s3 offen sc1
    s_mov_b64 exec, -1
    s_waitcnt vmcnt(13)
    s_waitcnt lgkmcnt(0)
    s_barrier
    s_waitcnt vmcnt(11)
    v_and_b32 v5, 0xffff0000, v116
    v_lshlrev_b32 v116, 16, v116
    v_rcp_f32 v117, v5
    v_lshlrev_b32 v96, 16, v64
    v_and_b32 v97, 0xffff0000, v64
    v_lshlrev_b32 v98, 16, v65
    v_and_b32 v99, 0xffff0000, v65
    v_lshlrev_b32 v100, 16, v66
    v_and_b32 v101, 0xffff0000, v66
    v_lshlrev_b32 v102, 16, v67
    v_and_b32 v103, 0xffff0000, v67
    v_lshlrev_b32 v104, 16, v68
    v_and_b32 v105, 0xffff0000, v68
    v_lshlrev_b32 v106, 16, v69
    v_and_b32 v107, 0xffff0000, v69
    v_lshlrev_b32 v108, 16, v70
    v_and_b32 v109, 0xffff0000, v70
    v_lshlrev_b32 v110, 16, v71
    v_and_b32 v111, 0xffff0000, v71
    v_mul_f32 v119, v116, v117
    s_add_u32 s64, s87, 128
    s_and_b32 s64, s64, 511
    s_or_b32 s64, s64, 1536
    s_xor_b32 s64, s64, s66
    s_mul_i32 s65, s64, 3072
    s_add_u32 m0, s30, 40960
    s_nop 0
    buffer_load_dwordx4 v8, s[40:43], s64 offen offset:0 lds
    buffer_load_dwordx4 v9, s[40:43], s64 offen offset:1024 lds
    v_fma_f32 v96, v96, v117, -v119
    v_fma_f32 v97, v97, v117, -v119
    v_fma_f32 v98, v98, v117, -v119
    buffer_load_dwordx4 v10, s[40:43], s64 offen offset:2048 lds
    v_fma_f32 v99, v99, v117, -v119
    v_fma_f32 v100, v100, v117, -v119
    v_fma_f32 v101, v101, v117, -v119
    buffer_load_dwordx4 v11, s[40:43], s64 offen offset:3072 lds
    v_fma_f32 v102, v102, v117, -v119
    v_fma_f32 v103, v103, v117, -v119
    v_fma_f32 v104, v104, v117, -v119
    s_add_u32 m0, s31, 40960
    s_nop 0
    s_nop 0
    buffer_load_dwordx4 v12, s[44:47], s65 offen offset:0 lds
    v_fma_f32 v105, v105, v117, -v119
    v_fma_f32 v106, v106, v117, -v119
    v_fma_f32 v107, v107, v117, -v119
    buffer_load_dwordx4 v13, s[44:47], s65 offen offset:1024 lds
    v_fma_f32 v108, v108, v117, -v119
    v_fma_f32 v109, v109, v117, -v119
    v_fma_f32 v110, v110, v117, -v119
    s_add_u32 m0, s31, 49152
    s_nop 0
    buffer_load_dwordx4 v14, s[44:47], s65 offen offset:0 lds
    v_fma_f32 v111, v111, v117, -v119
    v_mov_b32 v120, 0
    v_mov_b32 v121, 0
    buffer_load_dwordx4 v15, s[44:47], s65 offen offset:1024 lds
    v_mov_b32 v122, 0
    v_mov_b32 v123, 0
    v_mov_b32 v124, 0
    s_add_u32 m0, s31, 57344
    s_nop 0
    buffer_load_dwordx4 v16, s[44:47], s65 offen offset:0 lds
    v_mov_b32 v125, 0
    v_mov_b32 v126, 0
    v_mov_b32 v127, 0
    buffer_load_dwordx4 v17, s[44:47], s65 offen offset:1024 lds
    s_mul_i32 s3, s37, 12288
    s_mul_i32 s28, s38, 192
    s_add_u32 s3, s3, s28
    s_add_u32 s3, s3, 1048576
    s_add_u32 s28, s3, 6144
    buffer_load_dwordx4 v[80:83], v235, s[48:51], s3 offen offset:0 sc1
    buffer_load_dwordx4 v[84:87], v235, s[48:51], s3 offen offset:3072 sc1
    s_waitcnt vmcnt(13)
    s_waitcnt lgkmcnt(0)
    s_barrier
    s_add_u32 s64, s87, 256
    s_and_b32 s64, s64, 511
    s_or_b32 s64, s64, 1536
    s_xor_b32 s64, s64, s66
    s_mul_i32 s65, s64, 3072
    s_add_u32 m0, s30, 81920
    s_nop 0
    buffer_load_dwordx4 v8, s[40:43], s64 offen offset:0 lds
    buffer_load_dwordx4 v9, s[40:43], s64 offen offset:1024 lds
    buffer_load_dwordx4 v10, s[40:43], s64 offen offset:2048 lds
    buffer_load_dwordx4 v11, s[40:43], s64 offen offset:3072 lds
    s_add_u32 m0, s31, 81920
    s_nop 0
    buffer_load_dwordx4 v12, s[44:47], s65 offen offset:0 lds
    buffer_load_dwordx4 v13, s[44:47], s65 offen offset:1024 lds
    s_add_u32 m0, s31, 90112
    s_nop 0
    buffer_load_dwordx4 v14, s[44:47], s65 offen offset:0 lds
    buffer_load_dwordx4 v15, s[44:47], s65 offen offset:1024 lds
    s_add_u32 m0, s31, 98304
    s_nop 0
    buffer_load_dwordx4 v16, s[44:47], s65 offen offset:0 lds
    buffer_load_dwordx4 v17, s[44:47], s65 offen offset:1024 lds
    s_mul_i32 s3, s37, 12288
    s_mul_i32 s28, s38, 192
    s_add_u32 s3, s3, s28
    s_add_u32 s3, s3, 1048576
    s_add_u32 s28, s3, 6144
    buffer_load_dwordx4 v[88:91], v235, s[48:51], s28 offen offset:0 sc1
    buffer_load_dwordx4 v[92:95], v235, s[48:51], s28 offen offset:3072 sc1
    s_waitcnt vmcnt(14)
    s_waitcnt lgkmcnt(0)
    s_barrier
    s_add_u32 s64, s87, 384
    s_and_b32 s64, s64, 511
    s_or_b32 s64, s64, 1536
    s_xor_b32 s64, s64, s66
    s_mul_i32 s65, s64, 3072
    s_add_u32 m0, s30, 0
    s_nop 0
    buffer_load_dwordx4 v8, s[40:43], s64 offen offset:0 lds
    buffer_load_dwordx4 v9, s[40:43], s64 offen offset:1024 lds
    buffer_load_dwordx4 v10, s[40:43], s64 offen offset:2048 lds
    buffer_load_dwordx4 v11, s[40:43], s64 offen offset:3072 lds
    s_add_u32 m0, s31, 0
    s_nop 0
    buffer_load_dwordx4 v12, s[44:47], s65 offen offset:0 lds
    buffer_load_dwordx4 v13, s[44:47], s65 offen offset:1024 lds
    s_add_u32 m0, s31, 8192
    s_nop 0
    buffer_load_dwordx4 v14, s[44:47], s65 offen offset:0 lds
    buffer_load_dwordx4 v15, s[44:47], s65 offen offset:1024 lds
    s_add_u32 m0, s31, 16384
    s_nop 0
    buffer_load_dwordx4 v16, s[44:47], s65 offen offset:0 lds
    buffer_load_dwordx4 v17, s[44:47], s65 offen offset:1024 lds
    s_waitcnt vmcnt(10)
    s_mov_b32 s29, 0
L_k2:
    v_max3_u32 v2, v80, v81, v82
    v_max3_u32 v2, v2, v83, v84
    v_max3_u32 v2, v2, v85, v86
    v_max3_u32 v2, v2, v87, v88
    v_max3_u32 v2, v2, v89, v90
    v_max3_u32 v2, v2, v91, v92
    v_max3_u32 v2, v2, v93, v94
    v_max_u32 v2, v2, v95
    v_cmp_eq_u32 vcc, -1, v2
    s_cbranch_vccz L_k2k
    s_add_u32 s29, s29, 1
    s_cmp_ge_u32 s29, 200000
    s_cbranch_scc1 L_k2k
    s_sleep 1
    s_mul_i32 s3, s37, 12288
    s_mul_i32 s28, s38, 192
    s_add_u32 s3, s3, s28
    s_nop 0
    s_add_u32 s3, s3, 1048576
    s_add_u32 s28, s3, 6144
    buffer_load_dwordx4 v[80:83], v235, s[48:51], s3 offen offset:0 sc1
    buffer_load_dwordx4 v[84:87], v235, s[48:51], s3 offen offset:3072 sc1
    buffer_load_dwordx4 v[88:91], v235, s[48:51], s28 offen offset:0 sc1
    buffer_load_dwordx4 v[92:95], v235, s[48:51], s28 offen offset:3072 sc1
    s_waitcnt vmcnt(0)
    s_branch L_k2
L_k2k:
    v_add_f32 v80, v80, v88
    v_add_f32 v81, v81, v89
    v_add_f32 v82, v82, v90
    v_add_f32 v83, v83, v91
    v_add_f32 v84, v84, v92
    v_add_f32 v85, v85, v93
    v_add_f32 v86, v86, v94
    v_add_f32 v87, v87, v95
    v_add_f32 v80, v80, v84
    v_add_f32 v81, v81, v85
    v_add_f32 v82, v82, v86
    v_add_f32 v83, v83, v87
    s_nop 0
    v_permlane32_swap_b32 v80, v82
    v_permlane32_swap_b32 v81, v83
    v_add_f32 v80, v80, v82
    v_add_f32 v81, v81, v83
    s_nop 1
    v_permlane16_swap_b32 v80, v81
    v_add_f32 v80, v80, v81
    s_mov_b32 s60, s8
    s_mov_b32 s61, s9
    s_mov_b32 s62, 65536
    s_mov_b32 s63, 0x00020000
    s_lshl_b32 s3, s38, 10
    s_add_u32 m0, s3, 147712
    s_lshl_b32 s28, s37, 12
    s_add_u32 s3, s3, s28
    buffer_load_dwordx4 v252, s[60:63], s3 offen lds
    s_add_u32 m0, m0, 8192
    s_xor_b32 s3, s3, 16384
    buffer_load_dwordx4 v252, s[60:63], s3 offen lds
    s_lshl_b32 s3, s2, 13
    s_lshl_b32 s28, s38, 11
    s_add_u32 s3, s3, s28
    v_lshlrev_b32_e64 v3, 7, v1
    s_mov_b64 exec, 0xffff
    buffer_load_dword v20, v3, s[88:91], s3 offen
    s_mov_b64 exec, -1
    s_waitcnt lgkmcnt(0)
    s_barrier
    s_mov_b32 s3, 0
    buffer_load_dwordx4 v[128:131], v21, s[52:55], s3 offen nt
    s_mov_b32 s3, 7168
    buffer_load_dwordx4 v[132:135], v21, s[52:55], s3 offen nt
    s_mov_b32 s3, 14336
    buffer_load_dwordx4 v[136:139], v21, s[52:55], s3 offen nt
    s_mov_b32 s3, 21504
    buffer_load_dwordx4 v[140:143], v21, s[52:55], s3 offen nt
    s_mov_b32 s3, 28672
    buffer_load_dwordx4 v[144:147], v21, s[52:55], s3 offen nt
    s_mov_b32 s3, 35840
    buffer_load_dwordx4 v[148:151], v21, s[52:55], s3 offen nt
    s_mov_b32 s3, 43008
    buffer_load_dwordx4 v[152:155], v21, s[52:55], s3 offen nt
    s_mov_b32 s3, 50176
    buffer_load_dwordx4 v[156:159], v21, s[52:55], s3 offen nt
    ds_write_b32 v234, v224
    ds_write_b32 v230, v225
    ds_write_b32 v230, v226 offset:1024
    ds_write_b32 v233, v80
    s_mov_b32 exec_hi, 0
    ds_write_b32 v230, v227 offset:2048
    ds_write_b16_d16_hi v231, v228
    s_mov_b64 exec, -1
    s_waitcnt vmcnt(11)
    s_waitcnt lgkmcnt(0)
    s_barrier
    s_waitcnt vmcnt(9)
    s_barrier
    v_and_b32 v2, 15, v1
    v_min_u32 v2, 13, v2
    v_lshrrev_b32 v3, 4, v1
    v_mul_u32_u24 v3, 14336, v3
    v_lshl_add_u32 v13, v2, 4, v3
    s_lshl_b32 s75, s71, 2
    s_add_u32 s75, s75, 1380352
    s_add_u32 m0, s72, 0
    s_add_u32 s3, s73, 0
    s_nop 0
    buffer_load_dwordx4 v220, s[88:91], s3 offen offset:0 lds
    buffer_load_dwordx4 v221, s[88:91], s3 offen offset:1024 lds
    buffer_load_dwordx4 v222, s[88:91], s3 offen offset:2048 lds
    buffer_load_dwordx4 v223, s[88:91], s3 offen offset:3072 lds
    s_add_u32 m0, s72, 16384
    s_add_u32 s3, s73, 262144
    buffer_load_dwordx4 v220, s[88:91], s3 offen offset:0 lds
    buffer_load_dwordx4 v221, s[88:91], s3 offen offset:1024 lds
    buffer_load_dwordx4 v222, s[88:91], s3 offen offset:2048 lds
    buffer_load_dwordx4 v223, s[88:91], s3 offen offset:3072 lds
    s_add_u32 m0, s72, 65536
    s_add_u32 s3, s73, 1048576
    buffer_load_dwordx4 v220, s[88:91], s3 offen offset:0 lds
    buffer_load_dwordx4 v221, s[88:91], s3 offen offset:1024 lds
    buffer_load_dwordx4 v222, s[88:91], s3 offen offset:2048 lds
    buffer_load_dwordx4 v223, s[88:91], s3 offen offset:3072 lds
    s_lshl_b32 s3, s38, 1
    s_lshr_b32 s28, s39, 2
    s_add_u32 s3, s3, s28
    s_lshl_b32 s69, s3, 4
    s_lshl_b32 s3, s34, 7
    s_add_u32 s3, s3, s69
    v_and_b32 v2, 15, v1
    v_add_u32 v23, s3, v2
    v_lshlrev_b32 v23, 11, v23
    v_lshrrev_b32 v2, 4, v1
    v_lshl_add_u32 v23, v2, 3, v23
    s_lshl_b32 s3, s35, 7
    v_add_u32 v23, s3, v23
    buffer_load_dwordx2 v[240:241], v23, s[40:43], 0 offen offset:0
    buffer_load_dwordx2 v[242:243], v23, s[40:43], 0 offen offset:32
    buffer_load_dwordx2 v[244:245], v23, s[40:43], 0 offen offset:64
    buffer_load_dwordx2 v[246:247], v23, s[40:43], 0 offen offset:96
    s_mov_b32 s3, 57344
    buffer_load_dwordx4 v[160:163], v21, s[52:55], s3 offen nt
    s_mov_b32 s3, 64512
    buffer_load_dwordx4 v[164:167], v21, s[52:55], s3 offen nt
    s_mov_b32 s3, 71680
    buffer_load_dwordx4 v[168:171], v21, s[52:55], s3 offen nt
    s_mov_b32 s3, 78848
    buffer_load_dwordx4 v[172:175], v21, s[52:55], s3 offen nt
    s_mov_b32 s3, 86016
    buffer_load_dwordx4 v[176:179], v21, s[52:55], s3 offen nt
    s_mov_b32 s3, 93184
    buffer_load_dwordx4 v[180:183], v21, s[52:55], s3 offen nt
    s_mov_b32 s3, 100352
    buffer_load_dwordx4 v[184:187], v21, s[52:55], s3 offen nt
    s_mov_b32 s3, 107520
    buffer_load_dwordx4 v[188:191], v21, s[52:55], s3 offen nt
    s_waitcnt vmcnt(26)
    v_lshlrev_b32 v2, 16, v128
    v_and_b32 v3, 0xffff0000, v128
    v_pk_fma_f32 v[120:121], v[2:3], v[96:97], v[120:121] op_sel_hi:[1,0,1]
    v_lshlrev_b32_e64 v4, 16, v129
    v_and_b32 v5, 0xffff0000, v129
    v_pk_fma_f32 v[122:123], v[4:5], v[96:97], v[122:123] op_sel_hi:[1,0,1]
    v_lshlrev_b32_e64 v2, 16, v130
    v_and_b32 v3, 0xffff0000, v130
    v_pk_fma_f32 v[124:125], v[2:3], v[96:97], v[124:125] op_sel_hi:[1,0,1]
    v_lshlrev_b32_e64 v4, 16, v131
    v_and_b32 v5, 0xffff0000, v131
    v_pk_fma_f32 v[126:127], v[4:5], v[96:97], v[126:127] op_sel_hi:[1,0,1]
    v_lshlrev_b32 v2, 16, v132
    v_and_b32 v3, 0xffff0000, v132
    v_mov_b32 v96, v97
    v_pk_fma_f32 v[120:121], v[2:3], v[96:97], v[120:121] op_sel_hi:[1,0,1]
    v_lshlrev_b32_e64 v4, 16, v133
    v_and_b32 v5, 0xffff0000, v133
    v_pk_fma_f32 v[122:123], v[4:5], v[96:97], v[122:123] op_sel_hi:[1,0,1]
    v_lshlrev_b32_e64 v2, 16, v134
    v_and_b32 v3, 0xffff0000, v134
    v_pk_fma_f32 v[124:125], v[2:3], v[96:97], v[124:125] op_sel_hi:[1,0,1]
    v_lshlrev_b32_e64 v4, 16, v135
    v_and_b32 v5, 0xffff0000, v135
    v_pk_fma_f32 v[126:127], v[4:5], v[96:97], v[126:127] op_sel_hi:[1,0,1]
    v_lshlrev_b32_e64 v2, 16, v136
    v_and_b32 v3, 0xffff0000, v136
    v_pk_fma_f32 v[120:121], v[2:3], v[98:99], v[120:121] op_sel_hi:[1,0,1]
    v_lshlrev_b32_e64 v4, 16, v137
    v_and_b32 v5, 0xffff0000, v137
    v_pk_fma_f32 v[122:123], v[4:5], v[98:99], v[122:123] op_sel_hi:[1,0,1]
    v_lshlrev_b32_e64 v2, 16, v138
    v_and_b32 v3, 0xffff0000, v138
    v_pk_fma_f32 v[124:125], v[2:3], v[98:99], v[124:125] op_sel_hi:[1,0,1]
    v_lshlrev_b32_e64 v4, 16, v139
    v_and_b32 v5, 0xffff0000, v139
    v_pk_fma_f32 v[126:127], v[4:5], v[98:99], v[126:127] op_sel_hi:[1,0,1]
    v_lshlrev_b32 v2, 16, v140
    v_and_b32 v3, 0xffff0000, v140
    v_mov_b32 v98, v99
    v_pk_fma_f32 v[120:121], v[2:3], v[98:99], v[120:121] op_sel_hi:[1,0,1]
    v_lshlrev_b32_e64 v4, 16, v141
    v_and_b32 v5, 0xffff0000, v141
    v_pk_fma_f32 v[122:123], v[4:5], v[98:99], v[122:123] op_sel_hi:[1,0,1]
    v_lshlrev_b32_e64 v2, 16, v142
    v_and_b32 v3, 0xffff0000, v142
    v_pk_fma_f32 v[124:125], v[2:3], v[98:99], v[124:125] op_sel_hi:[1,0,1]
    v_lshlrev_b32_e64 v4, 16, v143
    v_and_b32 v5, 0xffff0000, v143
    v_pk_fma_f32 v[126:127], v[4:5], v[98:99], v[126:127] op_sel_hi:[1,0,1]
    v_lshlrev_b32_e64 v2, 16, v144
    v_and_b32 v3, 0xffff0000, v144
    v_pk_fma_f32 v[120:121], v[2:3], v[100:101], v[120:121] op_sel_hi:[1,0,1]
    v_lshlrev_b32_e64 v4, 16, v145
    v_and_b32 v5, 0xffff0000, v145
    v_pk_fma_f32 v[122:123], v[4:5], v[100:101], v[122:123] op_sel_hi:[1,0,1]
    v_lshlrev_b32_e64 v2, 16, v146
    v_and_b32 v3, 0xffff0000, v146
    v_pk_fma_f32 v[124:125], v[2:3], v[100:101], v[124:125] op_sel_hi:[1,0,1]
    v_lshlrev_b32_e64 v4, 16, v147
    v_and_b32 v5, 0xffff0000, v147
    v_pk_fma_f32 v[126:127], v[4:5], v[100:101], v[126:127] op_sel_hi:[1,0,1]
    v_lshlrev_b32 v2, 16, v148
    v_and_b32 v3, 0xffff0000, v148
    v_mov_b32 v100, v101
    v_pk_fma_f32 v[120:121], v[2:3], v[100:101], v[120:121] op_sel_hi:[1,0,1]
    v_lshlrev_b32_e64 v4, 16, v149
    v_and_b32 v5, 0xffff0000, v149
    v_pk_fma_f32 v[122:123], v[4:5], v[100:101], v[122:123] op_sel_hi:[1,0,1]
    v_lshlrev_b32_e64 v2, 16, v150
    v_and_b32 v3, 0xffff0000, v150
    v_pk_fma_f32 v[124:125], v[2:3], v[100:101], v[124:125] op_sel_hi:[1,0,1]
    v_lshlrev_b32_e64 v4, 16, v151
    v_and_b32 v5, 0xffff0000, v151
    v_pk_fma_f32 v[126:127], v[4:5], v[100:101], v[126:127] op_sel_hi:[1,0,1]
    s_waitcnt vmcnt(20)
    s_waitcnt vmcnt(16)
    s_waitcnt vmcnt(12)
    s_barrier
    s_lshr_b32 s3, s71, 3
    s_add_u32 s3, s3, 0
    s_and_b32 s28, s3, 7
    s_lshr_b32 s3, s3, 3
    s_lshl_b32 s3, s3, 6
    s_add_u32 s3, s3, s28
    s_lshl_b32 s3, s3, 11
    buffer_load_dwordx4 v[192:195], v22, s[56:59], s3 offen nt
    s_lshr_b32 s3, s71, 3
    s_add_u32 s3, s3, 1
    s_and_b32 s28, s3, 7
    s_lshr_b32 s3, s3, 3
    s_lshl_b32 s3, s3, 6
    s_add_u32 s3, s3, s28
    s_lshl_b32 s3, s3, 11
    buffer_load_dwordx4 v[196:199], v22, s[56:59], s3 offen nt
    s_lshr_b32 s3, s71, 3
    s_add_u32 s3, s3, 2
    s_and_b32 s28, s3, 7
    s_lshr_b32 s3, s3, 3
    s_lshl_b32 s3, s3, 6
    s_add_u32 s3, s3, s28
    s_lshl_b32 s3, s3, 11
    buffer_load_dwordx4 v[200:203], v22, s[56:59], s3 offen nt
    s_lshr_b32 s3, s71, 3
    s_add_u32 s3, s3, 3
    s_and_b32 s28, s3, 7
    s_lshr_b32 s3, s3, 3
    s_lshl_b32 s3, s3, 6
    s_add_u32 s3, s3, s28
    s_lshl_b32 s3, s3, 11
    buffer_load_dwordx4 v[204:207], v22, s[56:59], s3 offen nt
    s_lshr_b32 s3, s71, 3
    s_add_u32 s3, s3, 4
    s_and_b32 s28, s3, 7
    s_lshr_b32 s3, s3, 3
    s_lshl_b32 s3, s3, 6
    s_add_u32 s3, s3, s28
    s_lshl_b32 s3, s3, 11
    buffer_load_dwordx4 v[208:211], v22, s[56:59], s3 offen nt
    s_lshr_b32 s3, s71, 3
    s_add_u32 s3, s3, 5
    s_and_b32 s28, s3, 7
    s_lshr_b32 s3, s3, 3
    s_lshl_b32 s3, s3, 6
    s_add_u32 s3, s3, s28
    s_lshl_b32 s3, s3, 11
    buffer_load_dwordx4 v[212:215], v22, s[56:59], s3 offen nt
    s_lshr_b32 s3, s71, 3
    s_add_u32 s3, s3, 6
    s_and_b32 s28, s3, 7
    s_lshr_b32 s3, s3, 3
    s_lshl_b32 s3, s3, 6
    s_add_u32 s3, s3, s28
    s_lshl_b32 s3, s3, 11
    buffer_load_dwordx4 v[216:219], v22, s[56:59], s3 offen nt
    s_setprio 3
    s_cmp_lg_u32 s38, 3
    s_cbranch_scc1 L_npl
    s_mov_b32 s3, 32768
    s_mov_b32 s29, 0
    s_mov_b32 exec_lo, -1
    s_mov_b32 exec_hi, 65535
L_rp:
    buffer_load_dword v118, v113, s[48:51], s3 offen sc1
    s_waitcnt vmcnt(0)
    v_cmp_ne_u32 vcc, s86, v118
    s_cbranch_vccz L_rpk
    s_mov_b64 exec, vcc
    s_add_u32 s29, s29, 1
    s_cmp_lt_u32 s29, 200000
    s_cbranch_scc1 L_rp
L_rpk:
    s_mov_b64 exec, -1
    v_mov_b32 v4, 162128
    v_mov_b32 v5, 1
    ds_write_b32 v4, v5
L_npl:
    v_min_u32 v3, 4, v1
    v_lshlrev_b32 v3, 2, v3
    v_add_u32 v3, 162112, v3
L_fw:
    ds_read_b32 v4, v3
    s_waitcnt lgkmcnt(0)
    v_cmp_eq_u32 vcc, 0, v4
    s_cbranch_vccz L_fk
    s_sleep 1
    s_branch L_fw
L_fk:
    s_waitcnt vmcnt(7)
    v_lshlrev_b32_e64 v2, 16, v152
    v_and_b32 v3, 0xffff0000, v152
    v_pk_fma_f32 v[120:121], v[2:3], v[102:103], v[120:121] op_sel_hi:[1,0,1]
    v_lshlrev_b32_e64 v4, 16, v153
    v_and_b32 v5, 0xffff0000, v153
    v_pk_fma_f32 v[122:123], v[4:5], v[102:103], v[122:123] op_sel_hi:[1,0,1]
    v_lshlrev_b32_e64 v2, 16, v154
    v_and_b32 v3, 0xffff0000, v154
    v_pk_fma_f32 v[124:125], v[2:3], v[102:103], v[124:125] op_sel_hi:[1,0,1]
    v_lshlrev_b32_e64 v4, 16, v155
    v_and_b32 v5, 0xffff0000, v155
    v_pk_fma_f32 v[126:127], v[4:5], v[102:103], v[126:127] op_sel_hi:[1,0,1]
    v_lshlrev_b32 v2, 16, v156
    v_and_b32 v3, 0xffff0000, v156
    v_mov_b32 v102, v103
    v_pk_fma_f32 v[120:121], v[2:3], v[102:103], v[120:121] op_sel_hi:[1,0,1]
    v_lshlrev_b32_e64 v4, 16, v157
    v_and_b32 v5, 0xffff0000, v157
    v_pk_fma_f32 v[122:123], v[4:5], v[102:103], v[122:123] op_sel_hi:[1,0,1]
    v_lshlrev_b32_e64 v2, 16, v158
    v_and_b32 v3, 0xffff0000, v158
    v_pk_fma_f32 v[124:125], v[2:3], v[102:103], v[124:125] op_sel_hi:[1,0,1]
    v_lshlrev_b32_e64 v4, 16, v159
    v_and_b32 v5, 0xffff0000, v159
    v_pk_fma_f32 v[126:127], v[4:5], v[102:103], v[126:127] op_sel_hi:[1,0,1]
    v_lshlrev_b32_e64 v2, 16, v160
    v_and_b32 v3, 0xffff0000, v160
    v_pk_fma_f32 v[120:121], v[2:3], v[104:105], v[120:121] op_sel_hi:[1,0,1]
    v_lshlrev_b32_e64 v4, 16, v161
    v_and_b32 v5, 0xffff0000, v161
    v_pk_fma_f32 v[122:123], v[4:5], v[104:105], v[122:123] op_sel_hi:[1,0,1]
    v_lshlrev_b32_e64 v2, 16, v162
    v_and_b32 v3, 0xffff0000, v162
    v_pk_fma_f32 v[124:125], v[2:3], v[104:105], v[124:125] op_sel_hi:[1,0,1]
    v_lshlrev_b32_e64 v4, 16, v163
    v_and_b32 v5, 0xffff0000, v163
    v_pk_fma_f32 v[126:127], v[4:5], v[104:105], v[126:127] op_sel_hi:[1,0,1]
    s_add_u32 s3, s76, 0
    buffer_load_dwordx4 v[48:51], v112, s[48:51], s3 offen sc1
    s_add_u32 s3, s76, 33792
    buffer_load_dwordx4 v[52:55], v112, s[48:51], s3 offen sc1
    s_cmp_lg_u32 s83, 0
    s_cbranch_scc1 L_nz
    s_add_u32 s3, s81, 0
    buffer_load_dwordx4 v[32:35], v112, s[48:51], s3 offen sc1
    s_add_u32 s3, s81, 33792
    buffer_load_dwordx4 v[36:39], v112, s[48:51], s3 offen sc1
L_nz:
    v_lshlrev_b32 v2, 16, v164
    v_and_b32 v3, 0xffff0000, v164
    v_mov_b32 v104, v105
    v_pk_fma_f32 v[120:121], v[2:3], v[104:105], v[120:121] op_sel_hi:[1,0,1]
    v_lshlrev_b32_e64 v4, 16, v165
    v_and_b32 v5, 0xffff0000, v165
    v_pk_fma_f32 v[122:123], v[4:5], v[104:105], v[122:123] op_sel_hi:[1,0,1]
    v_lshlrev_b32_e64 v2, 16, v166
    v_and_b32 v3, 0xffff0000, v166
    v_pk_fma_f32 v[124:125], v[2:3], v[104:105], v[124:125] op_sel_hi:[1,0,1]
    v_lshlrev_b32_e64 v4, 16, v167
    v_and_b32 v5, 0xffff0000, v167
    v_pk_fma_f32 v[126:127], v[4:5], v[104:105], v[126:127] op_sel_hi:[1,0,1]
    v_lshlrev_b32_e64 v2, 16, v168
    v_and_b32 v3, 0xffff0000, v168
    v_pk_fma_f32 v[120:121], v[2:3], v[106:107], v[120:121] op_sel_hi:[1,0,1]
    v_lshlrev_b32_e64 v4, 16, v169
    v_and_b32 v5, 0xffff0000, v169
    v_pk_fma_f32 v[122:123], v[4:5], v[106:107], v[122:123] op_sel_hi:[1,0,1]
    v_lshlrev_b32_e64 v2, 16, v170
    v_and_b32 v3, 0xffff0000, v170
    v_pk_fma_f32 v[124:125], v[2:3], v[106:107], v[124:125] op_sel_hi:[1,0,1]
    v_lshlrev_b32_e64 v4, 16, v171
    v_and_b32 v5, 0xffff0000, v171
    v_pk_fma_f32 v[126:127], v[4:5], v[106:107], v[126:127] op_sel_hi:[1,0,1]
    v_lshlrev_b32 v2, 16, v172
    v_and_b32 v3, 0xffff0000, v172
    v_mov_b32 v106, v107
    v_pk_fma_f32 v[120:121], v[2:3], v[106:107], v[120:121] op_sel_hi:[1,0,1]
    v_lshlrev_b32_e64 v4, 16, v173
    v_and_b32 v5, 0xffff0000, v173
    v_pk_fma_f32 v[122:123], v[4:5], v[106:107], v[122:123] op_sel_hi:[1,0,1]
    v_lshlrev_b32_e64 v2, 16, v174
    v_and_b32 v3, 0xffff0000, v174
    v_pk_fma_f32 v[124:125], v[2:3], v[106:107], v[124:125] op_sel_hi:[1,0,1]
    v_lshlrev_b32_e64 v4, 16, v175
    v_and_b32 v5, 0xffff0000, v175
    v_pk_fma_f32 v[126:127], v[4:5], v[106:107], v[126:127] op_sel_hi:[1,0,1]
    v_lshlrev_b32_e64 v2, 16, v176
    v_and_b32 v3, 0xffff0000, v176
    v_pk_fma_f32 v[120:121], v[2:3], v[108:109], v[120:121] op_sel_hi:[1,0,1]
    v_lshlrev_b32_e64 v4, 16, v177
    v_and_b32 v5, 0xffff0000, v177
    v_pk_fma_f32 v[122:123], v[4:5], v[108:109], v[122:123] op_sel_hi:[1,0,1]
    v_lshlrev_b32_e64 v2, 16, v178
    v_and_b32 v3, 0xffff0000, v178
    v_pk_fma_f32 v[124:125], v[2:3], v[108:109], v[124:125] op_sel_hi:[1,0,1]
    v_lshlrev_b32_e64 v4, 16, v179
    v_and_b32 v5, 0xffff0000, v179
    v_pk_fma_f32 v[126:127], v[4:5], v[108:109], v[126:127] op_sel_hi:[1,0,1]
    v_lshlrev_b32 v2, 16, v180
    v_and_b32 v3, 0xffff0000, v180
    v_mov_b32 v108, v109
    v_pk_fma_f32 v[120:121], v[2:3], v[108:109], v[120:121] op_sel_hi:[1,0,1]
    v_lshlrev_b32_e64 v4, 16, v181
    v_and_b32 v5, 0xffff0000, v181
    v_pk_fma_f32 v[122:123], v[4:5], v[108:109], v[122:123] op_sel_hi:[1,0,1]
    v_lshlrev_b32_e64 v2, 16, v182
    v_and_b32 v3, 0xffff0000, v182
    v_pk_fma_f32 v[124:125], v[2:3], v[108:109], v[124:125] op_sel_hi:[1,0,1]
    v_lshlrev_b32_e64 v4, 16, v183
    v_and_b32 v5, 0xffff0000, v183
    v_pk_fma_f32 v[126:127], v[4:5], v[108:109], v[126:127] op_sel_hi:[1,0,1]
    v_lshlrev_b32_e64 v2, 16, v184
    v_and_b32 v3, 0xffff0000, v184
    v_pk_fma_f32 v[120:121], v[2:3], v[110:111], v[120:121] op_sel_hi:[1,0,1]
    v_lshlrev_b32_e64 v4, 16, v185
    v_and_b32 v5, 0xffff0000, v185
    v_pk_fma_f32 v[122:123], v[4:5], v[110:111], v[122:123] op_sel_hi:[1,0,1]
    v_lshlrev_b32_e64 v2, 16, v186
    v_and_b32 v3, 0xffff0000, v186
    v_pk_fma_f32 v[124:125], v[2:3], v[110:111], v[124:125] op_sel_hi:[1,0,1]
    v_lshlrev_b32_e64 v4, 16, v187
    v_and_b32 v5, 0xffff0000, v187
    v_pk_fma_f32 v[126:127], v[4:5], v[110:111], v[126:127] op_sel_hi:[1,0,1]
    v_lshlrev_b32 v2, 16, v188
    v_and_b32 v3, 0xffff0000, v188
    v_mov_b32 v110, v111
    v_pk_fma_f32 v[120:121], v[2:3], v[110:111], v[120:121] op_sel_hi:[1,0,1]
    v_lshlrev_b32_e64 v4, 16, v189
    v_and_b32 v5, 0xffff0000, v189
    v_pk_fma_f32 v[122:123], v[4:5], v[110:111], v[122:123] op_sel_hi:[1,0,1]
    v_lshlrev_b32_e64 v2, 16, v190
    v_and_b32 v3, 0xffff0000, v190
    v_pk_fma_f32 v[124:125], v[2:3], v[110:111], v[124:125] op_sel_hi:[1,0,1]
    v_lshlrev_b32_e64 v4, 16, v191
    v_and_b32 v5, 0xffff0000, v191
    v_pk_fma_f32 v[126:127], v[4:5], v[110:111], v[126:127] op_sel_hi:[1,0,1]
    v_permlane32_swap_b32 v120, v124
    v_permlane32_swap_b32 v121, v125
    v_permlane32_swap_b32 v122, v126
    v_permlane32_swap_b32 v123, v127
    v_add_f32 v120, v120, v124
    v_add_f32 v121, v121, v125
    v_add_f32 v122, v122, v126
    v_add_f32 v123, v123, v127
    s_nop 0
    v_permlane16_swap_b32 v120, v122
    v_permlane16_swap_b32 v121, v123
    v_add_f32 v120, v120, v122
    v_add_f32 v121, v121, v123
    s_nop 0
    v_add_f32 v120, v120, v120 row_ror:8 row_mask:0xf bank_mask:0xf
    v_add_f32 v121, v121, v121 row_ror:8 row_mask:0xf bank_mask:0xf
    v_and_b32 v2, 8, v1
    v_cmp_eq_u32 vcc, 0, v2
    s_nop 1
    v_cndmask_b32 v120, v121, v120, vcc
    buffer_store_dword v120, v253, s[48:51], s84 offen sc1
    s_waitcnt vmcnt(1)
    s_cmp_eq_u32 s83, 0
    s_cbranch_scc1 L_hz
    s_mov_b32 s29, 0
L_k4:
    v_max3_u32 v2, v48, v49, v50
    v_max3_u32 v2, v2, v51, v52
    v_max3_u32 v2, v2, v53, v54
    v_max_u32 v2, v2, v55
    v_cmp_eq_u32 vcc, -1, v2
    s_cbranch_vccz L_k4k
    s_add_u32 s29, s29, 1
    s_cmp_ge_u32 s29, 200000
    s_cbranch_scc1 L_k4k
    s_sleep 1
    s_add_u32 s3, s76, 0
    buffer_load_dwordx4 v[48:51], v112, s[48:51], s3 offen sc1
    s_add_u32 s3, s76, 33792
    buffer_load_dwordx4 v[52:55], v112, s[48:51], s3 offen sc1
    s_waitcnt vmcnt(0)
    s_branch L_k4
L_k4k:
    v_lshlrev_b32 v64, 16, v48
    v_and_b32 v65, 0xffff0000, v48
    v_lshlrev_b32 v66, 16, v49
    v_and_b32 v67, 0xffff0000, v49
    v_lshlrev_b32 v68, 16, v50
    v_and_b32 v69, 0xffff0000, v50
    v_lshlrev_b32 v70, 16, v51
    v_and_b32 v71, 0xffff0000, v51
    v_lshlrev_b32 v72, 16, v52
    v_and_b32 v73, 0xffff0000, v52
    v_pk_add_f32 v[64:65], v[64:65], v[72:73]
    v_lshlrev_b32_e64 v74, 16, v53
    v_and_b32 v75, 0xffff0000, v53
    v_pk_add_f32 v[66:67], v[66:67], v[74:75]
    v_lshlrev_b32_e64 v76, 16, v54
    v_and_b32 v77, 0xffff0000, v54
    v_pk_add_f32 v[68:69], v[68:69], v[76:77]
    v_lshlrev_b32_e64 v78, 16, v55
    v_and_b32 v79, 0xffff0000, v55
    v_pk_add_f32 v[70:71], v[70:71], v[78:79]
    v_permlane32_swap_b32 v64, v68
    v_permlane32_swap_b32 v65, v69
    v_permlane32_swap_b32 v66, v70
    v_permlane32_swap_b32 v67, v71
    v_add_f32 v64, v64, v68
    v_add_f32 v65, v65, v69
    v_add_f32 v66, v66, v70
    v_add_f32 v67, v67, v71
    s_nop 0
    v_permlane16_swap_b32 v64, v66
    v_permlane16_swap_b32 v65, v67
    v_add_f32 v64, v64, v66
    v_add_f32 v65, v65, v67
    s_nop 0
    v_add_f32 v64, v64, v64 row_ror:8 row_mask:0xf bank_mask:0xf
    v_add_f32 v65, v65, v65 row_ror:8 row_mask:0xf bank_mask:0xf
    v_cvt_pk_bf16_f32 v64, v64, v65
    v_mov_b32 v65, v64
    s_nop 1
    v_permlane16_swap_b32 v64, v65
    v_mov_b32 v66, v64
    v_mov_b32 v67, v65
    s_nop 0
    v_permlane32_swap_b32 v64, v66
    v_permlane32_swap_b32 v65, v67
    s_mov_b64 exec, 0xff
    buffer_store_dwordx4 v[64:67], v252, s[48:51], s74 offen sc1
    s_branch L_h1e
L_hz:
    s_mov_b32 s29, 0
L_k3:
    v_max3_u32 v2, v48, v49, v50
    v_max3_u32 v2, v2, v51, v52
    v_max3_u32 v2, v2, v53, v54
    v_max3_u32 v2, v2, v55, v32
    v_max3_u32 v2, v2, v33, v34
    v_max3_u32 v2, v2, v35, v36
    v_max3_u32 v2, v2, v37, v38
    v_max_u32 v2, v2, v39
    v_cmp_eq_u32 vcc, -1, v2
    s_cbranch_vccz L_k3k
    s_add_u32 s29, s29, 1
    s_cmp_ge_u32 s29, 200000
    s_cbranch_scc1 L_k3k
    s_sleep 1
    s_add_u32 s3, s76, 0
    buffer_load_dwordx4 v[48:51], v112, s[48:51], s3 offen sc1
    s_add_u32 s3, s76, 33792
    buffer_load_dwordx4 v[52:55], v112, s[48:51], s3 offen sc1
    s_add_u32 s3, s81, 0
    buffer_load_dwordx4 v[32:35], v112, s[48:51], s3 offen sc1
    s_add_u32 s3, s81, 33792
    buffer_load_dwordx4 v[36:39], v112, s[48:51], s3 offen sc1
    s_waitcnt vmcnt(0)
    s_branch L_k3
L_k3k:
    v_lshlrev_b32 v64, 16, v48
    v_lshlrev_b32 v96, 16, v32
    v_and_b32 v65, 0xffff0000, v48
    v_and_b32 v97, 0xffff0000, v32
    v_lshlrev_b32 v66, 16, v49
    v_lshlrev_b32 v98, 16, v33
    v_and_b32 v67, 0xffff0000, v49
    v_and_b32 v99, 0xffff0000, v33
    v_lshlrev_b32 v68, 16, v50
    v_lshlrev_b32 v100, 16, v34
    v_and_b32 v69, 0xffff0000, v50
    v_and_b32 v101, 0xffff0000, v34
    v_lshlrev_b32 v70, 16, v51
    v_lshlrev_b32 v102, 16, v35
    v_and_b32 v71, 0xffff0000, v51
    v_and_b32 v103, 0xffff0000, v35
    v_lshlrev_b32 v72, 16, v52
    v_lshlrev_b32 v104, 16, v36
    v_and_b32 v73, 0xffff0000, v52
    v_and_b32 v105, 0xffff0000, v36
    v_pk_add_f32 v[64:65], v[64:65], v[72:73]
    v_pk_add_f32 v[96:97], v[96:97], v[104:105]
    v_lshlrev_b32 v74, 16, v53
    v_lshlrev_b32 v106, 16, v37
    v_and_b32 v75, 0xffff0000, v53
    v_and_b32 v107, 0xffff0000, v37
    v_pk_add_f32 v[66:67], v[66:67], v[74:75]
    v_pk_add_f32 v[98:99], v[98:99], v[106:107]
    v_lshlrev_b32 v76, 16, v54
    v_lshlrev_b32 v108, 16, v38
    v_and_b32 v77, 0xffff0000, v54
    v_and_b32 v109, 0xffff0000, v38
    v_pk_add_f32 v[68:69], v[68:69], v[76:77]
    v_pk_add_f32 v[100:101], v[100:101], v[108:109]
    v_lshlrev_b32 v78, 16, v55
    v_lshlrev_b32 v110, 16, v39
    v_and_b32 v79, 0xffff0000, v55
    v_and_b32 v111, 0xffff0000, v39
    v_pk_add_f32 v[70:71], v[70:71], v[78:79]
    v_pk_add_f32 v[102:103], v[102:103], v[110:111]
    v_permlane32_swap_b32 v64, v68
    v_permlane32_swap_b32 v96, v100
    v_permlane32_swap_b32 v65, v69
    v_permlane32_swap_b32 v97, v101
    v_permlane32_swap_b32 v66, v70
    v_permlane32_swap_b32 v98, v102
    v_permlane32_swap_b32 v67, v71
    v_permlane32_swap_b32 v99, v103
    v_add_f32 v64, v64, v68
    v_add_f32 v96, v96, v100
    v_add_f32 v65, v65, v69
    v_add_f32 v97, v97, v101
    v_add_f32 v66, v66, v70
    v_add_f32 v98, v98, v102
    v_add_f32 v67, v67, v71
    v_add_f32 v99, v99, v103
    v_permlane16_swap_b32 v64, v66
    v_permlane16_swap_b32 v96, v98
    v_permlane16_swap_b32 v65, v67
    v_permlane16_swap_b32 v97, v99
    v_add_f32 v64, v64, v66
    v_add_f32 v96, v96, v98
    v_add_f32 v65, v65, v67
    v_add_f32 v97, v97, v99
    v_add_f32 v64, v64, v64 row_ror:8 row_mask:0xf bank_mask:0xf
    v_add_f32 v96, v96, v96 row_ror:8 row_mask:0xf bank_mask:0xf
    v_add_f32 v65, v65, v65 row_ror:8 row_mask:0xf bank_mask:0xf
    v_add_f32 v97, v97, v97 row_ror:8 row_mask:0xf bank_mask:0xf
    v_cvt_pk_bf16_f32 v64, v64, v65
    v_cvt_pk_bf16_f32 v96, v96, v97
    v_mov_b32 v65, v64
    v_mov_b32 v97, v96
    s_nop 0
    v_permlane16_swap_b32 v64, v65
    v_permlane16_swap_b32 v96, v97
    v_mov_b32 v66, v64
    v_mov_b32 v98, v96
    v_mov_b32 v67, v65
    v_mov_b32 v99, v97
    v_permlane32_swap_b32 v64, v66
    v_permlane32_swap_b32 v96, v98
    v_permlane32_swap_b32 v65, v67
    v_permlane32_swap_b32_e64 v97, v99
    s_mov_b64 exec, 0xff
    buffer_store_dwordx4 v[64:67], v252, s[48:51], s74 offen sc1
    buffer_store_dwordx4 v[96:99], v252, s[48:51], s82 offen sc1
L_h1e:
    s_mov_b64 exec, -1
    s_lshl_b32 s3, s38, 2
    s_add_u32 s3, s3, 162112
    v_mov_b32 v4, s3
    v_mov_b32 v5, 3
    ds_write_b32 v4, v5
    s_setprio 0
    s_waitcnt lgkmcnt(0)
    s_add_u32 m0, s72, 81920
    s_add_u32 s3, s73, 1310720
    buffer_load_dwordx4 v220, s[88:91], s3 offen offset:0 lds
    buffer_load_dwordx4 v221, s[88:91], s3 offen offset:1024 lds
    buffer_load_dwordx4 v222, s[88:91], s3 offen offset:2048 lds
    buffer_load_dwordx4 v223, s[88:91], s3 offen offset:3072 lds
    s_add_u32 m0, s72, 32768
    s_add_u32 s3, s73, 524288
    buffer_load_dwordx4 v220, s[88:91], s3 offen offset:0 lds
    buffer_load_dwordx4 v221, s[88:91], s3 offen offset:1024 lds
    buffer_load_dwordx4 v222, s[88:91], s3 offen offset:2048 lds
    buffer_load_dwordx4 v223, s[88:91], s3 offen offset:3072 lds
    v_and_b32 v2, 15, v1
    v_add_u32 v2, s69, v2
    v_lshlrev_b32_e64 v2, 2, v2
    v_add_u32 v2, 152576, v2
    ds_read_b32 v9, v2
    ds_read_b32 v8, v2 offset:1024
    s_waitcnt lgkmcnt(0)
    v_mul_f32 v28, v9, v8
    v_mov_b32 v30, 0xbfb8aa3b
    v_lshlrev_b32 v224, 16, v240
    v_and_b32 v225, 0xffff0000, v240
    v_lshlrev_b32 v226, 16, v241
    v_and_b32 v227, 0xffff0000, v241
    v_lshlrev_b32 v228, 16, v242
    v_and_b32 v229, 0xffff0000, v242
    v_lshlrev_b32 v230, 16, v243
    v_and_b32 v231, 0xffff0000, v243
    v_lshlrev_b32 v232, 16, v244
    v_and_b32 v233, 0xffff0000, v244
    v_lshlrev_b32 v234, 16, v245
    v_and_b32 v235, 0xffff0000, v245
    v_lshlrev_b32 v236, 16, v246
    v_and_b32 v237, 0xffff0000, v246
    v_lshlrev_b32 v238, 16, v247
    v_and_b32 v239, 0xffff0000, v247
    v_pk_fma_f32 v[224:225], v[224:225], v[8:9], v[28:29] op_sel_hi:[1,0,0] neg_lo:[0,0,1] neg_hi:[0,0,1]
    v_pk_fma_f32 v[226:227], v[226:227], v[8:9], v[28:29] op_sel_hi:[1,0,0] neg_lo:[0,0,1] neg_hi:[0,0,1]
    v_pk_fma_f32 v[228:229], v[228:229], v[8:9], v[28:29] op_sel_hi:[1,0,0] neg_lo:[0,0,1] neg_hi:[0,0,1]
    v_pk_fma_f32 v[230:231], v[230:231], v[8:9], v[28:29] op_sel_hi:[1,0,0] neg_lo:[0,0,1] neg_hi:[0,0,1]
    v_pk_fma_f32 v[232:233], v[232:233], v[8:9], v[28:29] op_sel_hi:[1,0,0] neg_lo:[0,0,1] neg_hi:[0,0,1]
    v_pk_fma_f32 v[234:235], v[234:235], v[8:9], v[28:29] op_sel_hi:[1,0,0] neg_lo:[0,0,1] neg_hi:[0,0,1]
    v_pk_fma_f32 v[236:237], v[236:237], v[8:9], v[28:29] op_sel_hi:[1,0,0] neg_lo:[0,0,1] neg_hi:[0,0,1]
    v_pk_fma_f32 v[238:239], v[238:239], v[8:9], v[28:29] op_sel_hi:[1,0,0] neg_lo:[0,0,1] neg_hi:[0,0,1]
    v_pk_mul_f32 v[32:33], v[224:225], v[30:31] op_sel_hi:[1,0]
    v_pk_mul_f32 v[34:35], v[226:227], v[30:31] op_sel_hi:[1,0]
    v_pk_mul_f32 v[36:37], v[228:229], v[30:31] op_sel_hi:[1,0]
    v_pk_mul_f32 v[38:39], v[230:231], v[30:31] op_sel_hi:[1,0]
    v_pk_mul_f32 v[40:41], v[232:233], v[30:31] op_sel_hi:[1,0]
    v_pk_mul_f32 v[42:43], v[234:235], v[30:31] op_sel_hi:[1,0]
    v_pk_mul_f32 v[44:45], v[236:237], v[30:31] op_sel_hi:[1,0]
    v_pk_mul_f32 v[46:47], v[238:239], v[30:31] op_sel_hi:[1,0]
    v_exp_f32 v32, v32
    v_exp_f32 v33, v33
    v_exp_f32 v34, v34
    v_exp_f32 v35, v35
    v_exp_f32 v36, v36
    v_exp_f32 v37, v37
    v_exp_f32 v38, v38
    v_exp_f32 v39, v39
    v_exp_f32 v40, v40
    v_exp_f32 v41, v41
    v_exp_f32 v42, v42
    v_exp_f32 v43, v43
    v_exp_f32 v44, v44
    v_exp_f32 v45, v45
    v_exp_f32 v46, v46
    v_exp_f32 v47, v47
    v_pk_add_f32 v[32:33], v[32:33], 1.0 op_sel_hi:[1,0]
    v_pk_add_f32 v[34:35], v[34:35], 1.0 op_sel_hi:[1,0]
    v_pk_add_f32 v[36:37], v[36:37], 1.0 op_sel_hi:[1,0]
    v_pk_add_f32 v[38:39], v[38:39], 1.0 op_sel_hi:[1,0]
    v_pk_add_f32 v[40:41], v[40:41], 1.0 op_sel_hi:[1,0]
    v_pk_add_f32 v[42:43], v[42:43], 1.0 op_sel_hi:[1,0]
    v_pk_add_f32 v[44:45], v[44:45], 1.0 op_sel_hi:[1,0]
    v_pk_add_f32 v[46:47], v[46:47], 1.0 op_sel_hi:[1,0]
    v_rcp_f32 v32, v32
    v_rcp_f32 v33, v33
    v_rcp_f32 v34, v34
    v_rcp_f32 v35, v35
    v_rcp_f32 v36, v36
    v_rcp_f32 v37, v37
    v_rcp_f32 v38, v38
    v_rcp_f32 v39, v39
    v_rcp_f32 v40, v40
    v_rcp_f32 v41, v41
    v_rcp_f32 v42, v42
    v_rcp_f32 v43, v43
    v_rcp_f32 v44, v44
    v_rcp_f32 v45, v45
    v_rcp_f32 v46, v46
    v_rcp_f32 v47, v47
    v_pk_mul_f32 v[224:225], v[224:225], v[32:33]
    v_pk_mul_f32 v[226:227], v[226:227], v[34:35]
    v_pk_mul_f32 v[228:229], v[228:229], v[36:37]
    v_pk_mul_f32 v[230:231], v[230:231], v[38:39]
    v_pk_mul_f32 v[232:233], v[232:233], v[40:41]
    v_pk_mul_f32 v[234:235], v[234:235], v[42:43]
    v_pk_mul_f32 v[236:237], v[236:237], v[44:45]
    v_pk_mul_f32 v[238:239], v[238:239], v[46:47]
    s_add_u32 s3, s75, 0
    s_nop 0
    buffer_load_dwordx4 v[80:83], v13, s[48:51], s3 offen sc1
    s_add_u32 s3, s75, 57344
    buffer_load_dwordx4 v[84:87], v13, s[48:51], s3 offen sc1
    s_add_u32 s3, s75, 114688
    buffer_load_dwordx4 v[88:91], v13, s[48:51], s3 offen sc1
    s_add_u32 s3, s75, 172032
    buffer_load_dwordx4 v[92:95], v13, s[48:51], s3 offen sc1
    s_waitcnt vmcnt(0)
    s_mov_b32 s29, 0
L_k5:
    v_max3_u32 v2, v80, v81, v82
    v_max3_u32 v2, v2, v83, v84
    v_max3_u32 v2, v2, v85, v86
    v_max3_u32 v2, v2, v87, v88
    v_max3_u32 v2, v2, v89, v90
    v_max3_u32 v2, v2, v91, v92
    v_max3_u32 v2, v2, v93, v94
    v_max_u32 v2, v2, v95
    v_cmp_eq_u32 vcc, -1, v2
    s_cbranch_vccz L_k5k
    s_add_u32 s29, s29, 1
    s_cmp_ge_u32 s29, 200000
    s_cbranch_scc1 L_k5k
    s_sleep 1
    s_add_u32 s3, s75, 0
    s_nop 0
    buffer_load_dwordx4 v[80:83], v13, s[48:51], s3 offen sc1
    s_add_u32 s3, s75, 57344
    buffer_load_dwordx4 v[84:87], v13, s[48:51], s3 offen sc1
    s_add_u32 s3, s75, 114688
    buffer_load_dwordx4 v[88:91], v13, s[48:51], s3 offen sc1
    s_add_u32 s3, s75, 172032
    buffer_load_dwordx4 v[92:95], v13, s[48:51], s3 offen sc1
    s_waitcnt vmcnt(0)
    s_branch L_k5
L_k5k:
    v_pk_add_f32 v[80:81], v[80:81], v[84:85]
    v_pk_add_f32 v[82:83], v[82:83], v[86:87]
    v_pk_add_f32 v[88:89], v[88:89], v[92:93]
    v_pk_add_f32 v[90:91], v[90:91], v[94:95]
    s_nop 0
    v_permlane32_swap_b32 v80, v88
    v_permlane32_swap_b32 v81, v89
    v_permlane32_swap_b32 v82, v90
    v_permlane32_swap_b32 v83, v91
    v_add_f32 v80, v80, v88
    v_add_f32 v81, v81, v89
    v_add_f32 v82, v82, v90
    v_add_f32 v83, v83, v91
    v_permlane16_swap_b32 v80, v81
    s_nop 0
    v_permlane16_swap_b32 v82, v83
    v_add_f32 v80, v80, v81
    v_add_f32 v82, v82, v83
    s_nop 1
    v_permlane32_swap_b32 v80, v82
    v_cvt_pk_bf16_f32 v80, v80, v80
    v_lshlrev_b32 v80, 16, v80
    v_cvt_pk_bf16_f32 v82, v82, v82
    v_lshlrev_b32 v82, 16, v82
    v_mul_f32 v2, 0xbfb8aa3b, v80
    v_exp_f32 v2, v2
    s_nop 0
    v_add_f32 v2, 1.0, v2
    v_rcp_f32 v2, v2
    s_nop 0
    v_mul_f32 v80, v80, v2
    v_cvt_pk_bf16_f32 v80, v80, v80
    v_lshlrev_b32 v80, 16, v80
    v_mul_f32 v80, v80, v82
    v_cvt_pk_bf16_f32 v80, v80, v80
    v_lshlrev_b32 v80, 16, v80
    v_bfe_u32 v2, v1, 3, 2
    v_lshlrev_b32 v2, 6, v2
    v_lshrrev_b32_e64 v3, 5, v1
    v_lshl_add_u32 v2, v3, 2, v2
    ds_bpermute_b32 v56, v2, v80 offset:0
    ds_bpermute_b32 v58, v2, v80 offset:8
    ds_bpermute_b32 v60, v2, v80 offset:16
    ds_bpermute_b32 v62, v2, v80 offset:24
    ds_bpermute_b32 v64, v2, v80 offset:32
    ds_bpermute_b32 v66, v2, v80 offset:40
    ds_bpermute_b32 v68, v2, v80 offset:48
    v_mov_b64 v[120:121], 0
    v_mov_b64 v[122:123], 0
    v_mov_b64 v[124:125], 0
    v_mov_b64 v[126:127], 0
    s_waitcnt lgkmcnt(0)
    v_lshlrev_b32 v2, 16, v192
    v_and_b32 v3, 0xffff0000, v192
    v_pk_fma_f32 v[120:121], v[2:3], v[56:57], v[120:121] op_sel_hi:[1,0,1]
    v_lshlrev_b32_e64 v4, 16, v193
    v_and_b32 v5, 0xffff0000, v193
    v_pk_fma_f32 v[122:123], v[4:5], v[56:57], v[122:123] op_sel_hi:[1,0,1]
    v_lshlrev_b32_e64 v2, 16, v194
    v_and_b32 v3, 0xffff0000, v194
    v_pk_fma_f32 v[124:125], v[2:3], v[56:57], v[124:125] op_sel_hi:[1,0,1]
    v_lshlrev_b32_e64 v4, 16, v195
    v_and_b32 v5, 0xffff0000, v195
    v_pk_fma_f32 v[126:127], v[4:5], v[56:57], v[126:127] op_sel_hi:[1,0,1]
    v_lshlrev_b32_e64 v2, 16, v196
    v_and_b32 v3, 0xffff0000, v196
    v_pk_fma_f32 v[120:121], v[2:3], v[58:59], v[120:121] op_sel_hi:[1,0,1]
    v_lshlrev_b32_e64 v4, 16, v197
    v_and_b32 v5, 0xffff0000, v197
    v_pk_fma_f32 v[122:123], v[4:5], v[58:59], v[122:123] op_sel_hi:[1,0,1]
    v_lshlrev_b32_e64 v2, 16, v198
    v_and_b32 v3, 0xffff0000, v198
    v_pk_fma_f32 v[124:125], v[2:3], v[58:59], v[124:125] op_sel_hi:[1,0,1]
    v_lshlrev_b32_e64 v4, 16, v199
    v_and_b32 v5, 0xffff0000, v199
    v_pk_fma_f32 v[126:127], v[4:5], v[58:59], v[126:127] op_sel_hi:[1,0,1]
    v_lshlrev_b32_e64 v2, 16, v200
    v_and_b32 v3, 0xffff0000, v200
    v_pk_fma_f32 v[120:121], v[2:3], v[60:61], v[120:121] op_sel_hi:[1,0,1]
    v_lshlrev_b32_e64 v4, 16, v201
    v_and_b32 v5, 0xffff0000, v201
    v_pk_fma_f32 v[122:123], v[4:5], v[60:61], v[122:123] op_sel_hi:[1,0,1]
    v_lshlrev_b32_e64 v2, 16, v202
    v_and_b32 v3, 0xffff0000, v202
    v_pk_fma_f32 v[124:125], v[2:3], v[60:61], v[124:125] op_sel_hi:[1,0,1]
    v_lshlrev_b32_e64 v4, 16, v203
    v_and_b32 v5, 0xffff0000, v203
    v_pk_fma_f32 v[126:127], v[4:5], v[60:61], v[126:127] op_sel_hi:[1,0,1]
    v_lshlrev_b32_e64 v2, 16, v204
    v_and_b32 v3, 0xffff0000, v204
    v_pk_fma_f32 v[120:121], v[2:3], v[62:63], v[120:121] op_sel_hi:[1,0,1]
    v_lshlrev_b32_e64 v4, 16, v205
    v_and_b32 v5, 0xffff0000, v205
    v_pk_fma_f32 v[122:123], v[4:5], v[62:63], v[122:123] op_sel_hi:[1,0,1]
    v_lshlrev_b32_e64 v2, 16, v206
    v_and_b32 v3, 0xffff0000, v206
    v_pk_fma_f32 v[124:125], v[2:3], v[62:63], v[124:125] op_sel_hi:[1,0,1]
    v_lshlrev_b32_e64 v4, 16, v207
    v_and_b32 v5, 0xffff0000, v207
    v_pk_fma_f32 v[126:127], v[4:5], v[62:63], v[126:127] op_sel_hi:[1,0,1]
    v_lshlrev_b32_e64 v2, 16, v208
    v_and_b32 v3, 0xffff0000, v208
    v_pk_fma_f32 v[120:121], v[2:3], v[64:65], v[120:121] op_sel_hi:[1,0,1]
    v_lshlrev_b32_e64 v4, 16, v209
    v_and_b32 v5, 0xffff0000, v209
    v_pk_fma_f32 v[122:123], v[4:5], v[64:65], v[122:123] op_sel_hi:[1,0,1]
    v_lshlrev_b32_e64 v2, 16, v210
    v_and_b32 v3, 0xffff0000, v210
    v_pk_fma_f32 v[124:125], v[2:3], v[64:65], v[124:125] op_sel_hi:[1,0,1]
    v_lshlrev_b32_e64 v4, 16, v211
    v_and_b32 v5, 0xffff0000, v211
    v_pk_fma_f32 v[126:127], v[4:5], v[64:65], v[126:127] op_sel_hi:[1,0,1]
    v_lshlrev_b32_e64 v2, 16, v212
    v_and_b32 v3, 0xffff0000, v212
    v_pk_fma_f32 v[120:121], v[2:3], v[66:67], v[120:121] op_sel_hi:[1,0,1]
    v_lshlrev_b32_e64 v4, 16, v213
    v_and_b32 v5, 0xffff0000, v213
    v_pk_fma_f32 v[122:123], v[4:5], v[66:67], v[122:123] op_sel_hi:[1,0,1]
    v_lshlrev_b32_e64 v2, 16, v214
    v_and_b32 v3, 0xffff0000, v214
    v_pk_fma_f32 v[124:125], v[2:3], v[66:67], v[124:125] op_sel_hi:[1,0,1]
    v_lshlrev_b32_e64 v4, 16, v215
    v_and_b32 v5, 0xffff0000, v215
    v_pk_fma_f32 v[126:127], v[4:5], v[66:67], v[126:127] op_sel_hi:[1,0,1]
    v_lshlrev_b32_e64 v2, 16, v216
    v_and_b32 v3, 0xffff0000, v216
    v_pk_fma_f32 v[120:121], v[2:3], v[68:69], v[120:121] op_sel_hi:[1,0,1]
    v_lshlrev_b32_e64 v4, 16, v217
    v_and_b32 v5, 0xffff0000, v217
    v_pk_fma_f32 v[122:123], v[4:5], v[68:69], v[122:123] op_sel_hi:[1,0,1]
    v_lshlrev_b32_e64 v2, 16, v218
    v_and_b32 v3, 0xffff0000, v218
    v_pk_fma_f32 v[124:125], v[2:3], v[68:69], v[124:125] op_sel_hi:[1,0,1]
    v_lshlrev_b32_e64 v4, 16, v219
    v_and_b32 v5, 0xffff0000, v219
    v_pk_fma_f32 v[126:127], v[4:5], v[68:69], v[126:127] op_sel_hi:[1,0,1]
    v_permlane32_swap_b32 v120, v124
    v_permlane32_swap_b32 v121, v125
    v_permlane32_swap_b32 v122, v126
    v_permlane32_swap_b32 v123, v127
    v_add_f32 v120, v120, v124
    v_add_f32 v121, v121, v125
    v_add_f32 v122, v122, v126
    v_add_f32 v123, v123, v127
    s_nop 0
    v_permlane16_swap_b32 v120, v122
    v_permlane16_swap_b32 v121, v123
    v_add_f32 v120, v120, v122
    v_add_f32 v121, v121, v123
    s_nop 0
    v_add_f32 v120, v120, v120 row_ror:8 row_mask:0xf bank_mask:0xf
    v_add_f32 v121, v121, v121 row_ror:8 row_mask:0xf bank_mask:0xf
    v_and_b32 v2, 8, v1
    v_cmp_eq_u32 vcc, 0, v2
    s_and_b32 s3, s2, 15
    s_lshl_b32 s3, s3, 4
    s_lshr_b32 s28, s2, 4
    s_add_u32 s3, s3, s28
    s_lshl_b32 s3, s3, 2
    s_add_u32 s3, s3, s38
    s_lshl_b32 s3, s3, 8
    s_add_u32 s3, s3, 1609728
    v_cndmask_b32 v120, v121, v120, vcc
    buffer_store_dword v120, v253, s[48:51], s3 offen sc1
    v_and_b32 v3, 3, v1
    v_lshlrev_b32 v3, 2, v3
    v_add_u32 v3, 162112, v3
L_ow:
    ds_read_b32 v2, v3
    s_waitcnt lgkmcnt(0)
    v_cmp_ne_u32 vcc, 7, v2
    s_cbranch_vccz L_owk
    s_sleep 1
    s_branch L_ow
L_owk:
    s_sleep 4
    s_branch L_p3
L_C:
    s_and_b32 s64, s38, 1
    s_lshr_b32 s65, s38, 1
    v_and_b32 v3, 15, v1
    v_lshlrev_b32 v3, 7, v3
    s_lshl_b32 s3, s64, 13
    v_add_u32 v3, s3, v3
    v_bfe_u32 v5, v1, 1, 3
    v_lshrrev_b32 v6, 4, v1
    v_xor_b32 v6, v6, v5
    v_lshl_add_u32 v184, v6, 4, v3
    v_xor_b32 v185, 64, v184
    v_lshrrev_b32 v6, 4, v1
    v_lshlrev_b32 v6, 3, v6
    v_bfe_u32 v7, v1, 2, 2
    v_add_u32 v6, v6, v7
    v_lshlrev_b32 v6, 7, v6
    v_and_b32_e64 v7, 3, v1
    v_lshl_add_u32 v6, v7, 3, v6
    v_add_u32 v6, 16384, v6
    v_bfe_u32 v7, v1, 3, 2
    s_lshl_b32 s3, s65, 1
    v_xor_b32 v7, s3, v7
    v_lshl_add_u32 v186, v7, 5, v6
    v_xor_b32_e64 v187, 32, v186
    v_add_u32 v188, 81920, v184
    v_add_u32 v189, 81920, v185
    v_add_u32 v190, 81920, v186
    v_add_u32 v191, 81920, v187
    s_waitcnt lgkmcnt(0)
    s_mov_b32 s48, s26
    s_mov_b32 s49, s27
    s_mov_b32 s50, 268435456
    s_mov_b32 s51, 0x00020000
    s_mov_b32 s40, s4
    s_mov_b32 s41, s5
    s_mov_b32 s42, 4194304
    s_mov_b32 s43, 0x00020000
    s_mov_b32 s88, s10
    s_mov_b32 s89, s11
    s_mov_b32 s90, 2097152
    s_mov_b32 s91, 0x00020000
    s_lshl_b32 s3, s36, 7
    s_lshl_b32 s28, s37, 3
    s_add_u32 s3, s3, s28
    s_lshl_b32 s28, s38, 1
    s_add_u32 s69, s3, s28
    v_lshlrev_b32 v2, 4, v1
    v_mov_b32 v248, 16384
    v_mov_b32 v4, -1
    v_mov_b32 v5, -1
    v_mov_b32 v6, -1
    v_mov_b32 v7, -1
    s_lshl_b32 s28, s2, 2
    s_add_u32 s28, s28, s38
    s_lshl_b32 s28, s28, 10
    s_add_u32 s28, s28, 1048576
    buffer_store_dwordx4 v[4:7], v2, s[48:51], s28 offen sc1
    buffer_load_dword v248, v248, s[48:51], 0 offen sc1
    s_getpc_b64 s[92:93]
L_pc:
    s_sub_u32 s92, s92, L_pc-recurrent_scan__linear_kernel_hedgehog__moe_arch_mod__prompt_kernel
    s_subb_u32 s93, s93, 0
    s_lshr_b32 s3, s2, 3
    s_lshl_b32 s3, s3, 2
    s_add_u32 s3, s3, s38
    s_lshl_b32 s3, s3, 8
    v_lshlrev_b32 v2, 7, v1
    v_add_u32 v2, s3, v2
    s_mov_b64 exec, 3
    global_load_dword v249, v2, s[92:93]
    s_mov_b64 exec, -1
    v_mov_b64 v[8:9], 0
    v_mov_b64 v[10:11], 0
    v_mov_b64 v[12:13], 0
    v_mov_b64 v[14:15], 0
    v_mov_b64 v[16:17], 0
    v_mov_b64 v[18:19], 0
    v_mov_b64 v[20:21], 0
    v_mov_b64 v[22:23], 0
    v_mov_b64 v[24:25], 0
    v_mov_b64 v[26:27], 0
    v_mov_b64 v[28:29], 0
    v_mov_b64 v[30:31], 0
    v_mov_b64 v[32:33], 0
    v_mov_b64 v[34:35], 0
    v_mov_b64 v[36:37], 0
    v_mov_b64 v[38:39], 0
    v_mov_b64 v[40:41], 0
    v_mov_b64 v[42:43], 0
    v_mov_b64 v[44:45], 0
    v_mov_b64 v[46:47], 0
    v_mov_b64 v[48:49], 0
    v_mov_b64 v[50:51], 0
    v_mov_b64 v[52:53], 0
    v_mov_b64 v[54:55], 0
    v_mov_b64 v[56:57], 0
    v_mov_b64 v[58:59], 0
    v_mov_b64 v[60:61], 0
    v_mov_b64 v[62:63], 0
    v_mov_b64 v[64:65], 0
    v_mov_b64 v[66:67], 0
    v_mov_b64 v[68:69], 0
    v_mov_b64 v[70:71], 0
    v_mov_b64 v[72:73], 0
    v_mov_b64 v[74:75], 0
    v_mov_b64 v[76:77], 0
    v_mov_b64 v[78:79], 0
    v_mov_b64 v[80:81], 0
    v_mov_b64 v[82:83], 0
    v_mov_b64 v[84:85], 0
    v_mov_b64 v[86:87], 0
    v_mov_b64 v[88:89], 0
    v_mov_b64 v[90:91], 0
    v_mov_b64 v[92:93], 0
    v_mov_b64 v[94:95], 0
    v_mov_b64 v[96:97], 0
    v_mov_b64 v[98:99], 0
    v_mov_b64 v[100:101], 0
    v_mov_b64 v[102:103], 0
    s_lshl_b32 s3, s38, 2
    s_add_u32 s3, s3, 162112
    v_mov_b32 v2, s3
    v_mov_b32_e64 v3, 0
    ds_write_b32 v2, v3
    ds_write_b32 v2, v3 offset:16
    s_mov_b32 s86, 0
    s_mov_b32 s66, 0
    s_setprio 2
    s_waitcnt lgkmcnt(0)
L_ln:
    s_lshl_b32 s3, s38, 12
    s_add_u32 s3, s3, 131072
    v_lshlrev_b32 v2, 4, v1
    v_add_u32 v3, s3, v2
    v_add_u32 v2, 122880, v2
    s_barrier
    ds_read_b128 v[120:123], v2 offset:0
    ds_read_b128 v[124:127], v2 offset:1024
    ds_read_b128 v[104:107], v3 offset:0
    ds_read_b128 v[108:111], v3 offset:1024
    ds_read_b128 v[112:115], v3 offset:2048
    ds_read_b128 v[116:119], v3 offset:3072
    v_mov_b32 v2, 0x3f803f80
    v_mov_b32 v192, 0
    v_mov_b32 v194, 0
    v_mov_b32 v196, 0
    v_mov_b32 v198, 0
    v_mov_b32 v200, 0
    v_mov_b32 v202, 0
    v_mov_b32 v204, 0
    v_mov_b32 v206, 0
    s_waitcnt lgkmcnt(2)
    v_dot2c_f32_bf16 v192, v104, v2
    v_dot2c_f32_bf16 v196, v104, v104
    v_dot2c_f32_bf16 v200, v104, v120
    v_dot2c_f32_bf16 v204, v120, v2
    v_dot2c_f32_bf16 v192, v105, v2
    v_dot2c_f32_bf16 v196, v105, v105
    v_dot2c_f32_bf16 v200, v105, v121
    v_dot2c_f32_bf16 v204, v121, v2
    v_dot2c_f32_bf16 v192, v106, v2
    v_dot2c_f32_bf16 v196, v106, v106
    v_dot2c_f32_bf16 v200, v106, v122
    v_dot2c_f32_bf16 v204, v122, v2
    v_dot2c_f32_bf16 v192, v107, v2
    v_dot2c_f32_bf16 v196, v107, v107
    v_dot2c_f32_bf16 v200, v107, v123
    v_dot2c_f32_bf16 v204, v123, v2
    v_dot2c_f32_bf16 v192, v108, v2
    v_dot2c_f32_bf16 v196, v108, v108
    v_dot2c_f32_bf16 v200, v108, v124
    v_dot2c_f32_bf16 v204, v124, v2
    v_dot2c_f32_bf16 v192, v109, v2
    v_dot2c_f32_bf16 v196, v109, v109
    v_dot2c_f32_bf16 v200, v109, v125
    v_dot2c_f32_bf16 v204, v125, v2
    v_dot2c_f32_bf16 v192, v110, v2
    v_dot2c_f32_bf16 v196, v110, v110
    v_dot2c_f32_bf16 v200, v110, v126
    v_dot2c_f32_bf16 v204, v126, v2
    v_dot2c_f32_bf16 v192, v111, v2
    v_dot2c_f32_bf16 v196, v111, v111
    v_dot2c_f32_bf16 v200, v111, v127
    v_dot2c_f32_bf16 v204, v127, v2
    s_waitcnt lgkmcnt(0)
    v_dot2c_f32_bf16 v194, v112, v2
    v_dot2c_f32_bf16 v198, v112, v112
    v_dot2c_f32_bf16 v202, v112, v120
    v_dot2c_f32_bf16 v206, v120, v2
    v_dot2c_f32_bf16 v194, v113, v2
    v_dot2c_f32_bf16 v198, v113, v113
    v_dot2c_f32_bf16 v202, v113, v121
    v_dot2c_f32_bf16 v206, v121, v2
    v_dot2c_f32_bf16 v194, v114, v2
    v_dot2c_f32_bf16 v198, v114, v114
    v_dot2c_f32_bf16 v202, v114, v122
    v_dot2c_f32_bf16 v206, v122, v2
    v_dot2c_f32_bf16 v194, v115, v2
    v_dot2c_f32_bf16 v198, v115, v115
    v_dot2c_f32_bf16 v202, v115, v123
    v_dot2c_f32_bf16 v206, v123, v2
    v_dot2c_f32_bf16 v194, v116, v2
    v_dot2c_f32_bf16 v198, v116, v116
    v_dot2c_f32_bf16 v202, v116, v124
    v_dot2c_f32_bf16 v206, v124, v2
    v_dot2c_f32_bf16 v194, v117, v2
    v_dot2c_f32_bf16 v198, v117, v117
    v_dot2c_f32_bf16 v202, v117, v125
    v_dot2c_f32_bf16 v206, v125, v2
    v_dot2c_f32_bf16 v194, v118, v2
    v_dot2c_f32_bf16 v198, v118, v118
    v_dot2c_f32_bf16 v202, v118, v126
    v_dot2c_f32_bf16 v206, v126, v2
    v_dot2c_f32_bf16 v194, v119, v2
    v_dot2c_f32_bf16 v198, v119, v119
    v_dot2c_f32_bf16 v202, v119, v127
    v_dot2c_f32_bf16 v206, v127, v2
    v_permlane32_swap_b32 v192, v194
    v_permlane32_swap_b32 v196, v198
    v_permlane32_swap_b32 v200, v202
    v_permlane32_swap_b32 v204, v206
    v_add_f32 v192, v192, v194
    v_add_f32 v196, v196, v198
    v_add_f32 v200, v200, v202
    v_add_f32 v204, v204, v206
    v_add_f32 v192, v192, v192 quad_perm:[1,0,3,2] row_mask:0xf bank_mask:0xf
    v_add_f32 v196, v196, v196 quad_perm:[1,0,3,2] row_mask:0xf bank_mask:0xf
    v_add_f32 v200, v200, v200 quad_perm:[1,0,3,2] row_mask:0xf bank_mask:0xf
    v_add_f32 v204, v204, v204 quad_perm:[1,0,3,2] row_mask:0xf bank_mask:0xf
    v_add_f32 v192, v192, v192 quad_perm:[2,3,0,1] row_mask:0xf bank_mask:0xf
    v_add_f32 v196, v196, v196 quad_perm:[2,3,0,1] row_mask:0xf bank_mask:0xf
    v_add_f32 v200, v200, v200 quad_perm:[2,3,0,1] row_mask:0xf bank_mask:0xf
    v_add_f32 v204, v204, v204 quad_perm:[2,3,0,1] row_mask:0xf bank_mask:0xf
    v_add_f32 v192, v192, v192 row_half_mirror row_mask:0xf bank_mask:0xf
    v_add_f32 v196, v196, v196 row_half_mirror row_mask:0xf bank_mask:0xf
    v_add_f32 v200, v200, v200 row_half_mirror row_mask:0xf bank_mask:0xf
    v_add_f32 v204, v204, v204 row_half_mirror row_mask:0xf bank_mask:0xf
    v_add_f32 v192, v192, v192 row_mirror row_mask:0xf bank_mask:0xf
    v_add_f32 v196, v196, v196 row_mirror row_mask:0xf bank_mask:0xf
    v_add_f32 v200, v200, v200 row_mirror row_mask:0xf bank_mask:0xf
    v_add_f32 v204, v204, v204 row_mirror row_mask:0xf bank_mask:0xf
    v_mov_b32 v193, v192
    v_mov_b32 v197, v196
    v_mov_b32 v201, v200
    v_mov_b32 v205, v204
    v_permlane16_swap_b32 v192, v193
    v_permlane16_swap_b32 v196, v197
    v_permlane16_swap_b32 v200, v201
    v_permlane16_swap_b32 v204, v205
    v_add_f32 v192, v192, v193
    v_add_f32 v196, v196, v197
    v_add_f32 v200, v200, v201
    v_add_f32 v204, v204, v205
    v_mul_f32 v192, 0x3a800000, v192
    v_mul_f32 v196, 0x3a800000, v196
    v_cvt_pk_bf16_f32 v193, v192, v192
    v_lshlrev_b32 v193, 16, v193
    v_fma_f32 v196, -v192, v192, v196
    v_max_f32 v196, 0, v196
    v_fma_f32 v200, -v193, v204, v200
    s_waitcnt vmcnt(0)
    v_cvt_pk_bf16_f32 v196, v196, v196
    v_lshlrev_b32 v196, 16, v196
    v_add_f32 v196, 0x3727c5ac, v196
    v_cvt_pk_bf16_f32 v196, v196, v196
    v_lshlrev_b32 v196, 16, v196
    v_sqrt_f32 v196, v196
    s_nop 0
    v_cvt_pk_bf16_f32 v196, v196, v196
    v_lshlrev_b32 v196, 16, v196
    v_rcp_f32 v2, v196
    v_lshrrev_b32 v3, 16, v193
    v_or_b32 v4, v3, v196
    v_mul_f32 v200, v200, v2
    v_cvt_pk_bf16_f32 v200, v200, v200
    v_lshlrev_b32 v200, 16, v200
    v_ashrrev_i32 v2, 31, v200
    v_or_b32 v2, 0x80000000, v2
    v_xor_b32 v2, v200, v2
    v_and_b32 v2, 0xffff0000, v2
    v_lshrrev_b32 v3, 5, v1
    v_add_u32 v5, s69, v3
    v_sub_u32 v5, 2047, v5
    v_or_b32 v6, v2, v5
    v_mov_b32 v2, v6
    v_mov_b32 v5, v4
    v_add_u32 v7, 1, v248
    v_mov_b32 v3, 0
    v_readfirstlane_b32 s86, v7
    v_permlane32_swap_b32 v6, v2
    v_permlane32_swap_b32 v4, v5
    v_max_u32 v6, v6, v2
    s_lshl_b32 s3, s69, 3
    s_mov_b64 exec, 1
    buffer_store_dwordx4 v[4:7], v3, s[48:51], s3 offen sc1
    s_mov_b64 exec, -1
    s_branch L_lnr
L_lnr:
    s_barrier
    s_nop 0
    ds_read_b128 v[104:107], v184 offset:0
    ds_read_b64_tr_b16 v[120:121], v186 offset:0
    ds_read_b64_tr_b16 v[122:123], v186 offset:512
    ds_read_b64_tr_b16 v[124:125], v187 offset:0
    ds_read_b64_tr_b16 v[126:127], v187 offset:512
    ds_read_b64_tr_b16 v[128:129], v186 offset:8192
    ds_read_b64_tr_b16 v[130:131], v186 offset:8704
    ds_read_b64_tr_b16 v[132:133], v187 offset:8192
    ds_read_b64_tr_b16 v[134:135], v187 offset:8704
    ds_read_b64_tr_b16 v[136:137], v186 offset:16384
    ds_read_b64_tr_b16 v[138:139], v186 offset:16896
    ds_read_b64_tr_b16 v[140:141], v187 offset:16384
    ds_read_b64_tr_b16 v[142:143], v187 offset:16896
    ds_read_b128 v[108:111], v184 offset:2048
    ds_read_b128 v[112:115], v184 offset:4096
    ds_read_b128 v[116:119], v184 offset:6144
    s_branch L_cmid
.p2align 6
L_cloop:
    s_waitcnt lgkmcnt(0)
    s_barrier
    v_mfma_f32_16x16x32_bf16 v[8:11], v[160:163], v[144:147], v[8:11]
    ds_read_b128 v[104:107], v184 offset:0
    v_mfma_f32_16x16x32_bf16 v[12:15], v[164:167], v[144:147], v[12:15]
    ds_read_b64_tr_b16 v[120:121], v186 offset:0
    v_mfma_f32_16x16x32_bf16 v[16:19], v[168:171], v[144:147], v[16:19]
    ds_read_b64_tr_b16 v[122:123], v186 offset:512
    v_mfma_f32_16x16x32_bf16 v[20:23], v[172:175], v[144:147], v[20:23]
    ds_read_b64_tr_b16 v[124:125], v187 offset:0
    v_mfma_f32_16x16x32_bf16 v[24:27], v[144:147], v[176:179], v[24:27]
    ds_read_b64_tr_b16 v[126:127], v187 offset:512
    v_mfma_f32_16x16x32_bf16 v[28:31], v[144:147], v[180:183], v[28:31]
    ds_read_b64_tr_b16 v[128:129], v186 offset:8192
    v_mfma_f32_16x16x32_bf16 v[32:35], v[160:163], v[148:151], v[32:35]
    ds_read_b64_tr_b16 v[130:131], v186 offset:8704
    v_mfma_f32_16x16x32_bf16 v[36:39], v[164:167], v[148:151], v[36:39]
    ds_read_b64_tr_b16 v[132:133], v187 offset:8192
    v_mfma_f32_16x16x32_bf16 v[40:43], v[168:171], v[148:151], v[40:43]
    ds_read_b64_tr_b16 v[134:135], v187 offset:8704
    v_mfma_f32_16x16x32_bf16 v[44:47], v[172:175], v[148:151], v[44:47]
    ds_read_b64_tr_b16 v[136:137], v186 offset:16384
    v_mfma_f32_16x16x32_bf16 v[48:51], v[148:151], v[176:179], v[48:51]
    ds_read_b64_tr_b16 v[138:139], v186 offset:16896
    v_mfma_f32_16x16x32_bf16 v[52:55], v[148:151], v[180:183], v[52:55]
    ds_read_b64_tr_b16 v[140:141], v187 offset:16384
    v_mfma_f32_16x16x32_bf16 v[56:59], v[160:163], v[152:155], v[56:59]
    ds_read_b64_tr_b16 v[142:143], v187 offset:16896
    v_mfma_f32_16x16x32_bf16 v[60:63], v[164:167], v[152:155], v[60:63]
    ds_read_b128 v[108:111], v184 offset:2048
    v_mfma_f32_16x16x32_bf16 v[64:67], v[168:171], v[152:155], v[64:67]
    ds_read_b128 v[112:115], v184 offset:4096
    v_mfma_f32_16x16x32_bf16 v[68:71], v[172:175], v[152:155], v[68:71]
    ds_read_b128 v[116:119], v184 offset:6144
    v_mfma_f32_16x16x32_bf16 v[72:75], v[152:155], v[176:179], v[72:75]
    v_mfma_f32_16x16x32_bf16 v[76:79], v[152:155], v[180:183], v[76:79]
    v_mfma_f32_16x16x32_bf16 v[80:83], v[160:163], v[156:159], v[80:83]
    v_mfma_f32_16x16x32_bf16 v[84:87], v[164:167], v[156:159], v[84:87]
    v_mfma_f32_16x16x32_bf16 v[88:91], v[168:171], v[156:159], v[88:91]
    v_mfma_f32_16x16x32_bf16 v[92:95], v[172:175], v[156:159], v[92:95]
    v_mfma_f32_16x16x32_bf16 v[96:99], v[156:159], v[176:179], v[96:99]
    v_mfma_f32_16x16x32_bf16 v[100:103], v[156:159], v[180:183], v[100:103]
L_cmid:
    s_waitcnt lgkmcnt(0)
    s_nop 0
    v_mfma_f32_16x16x32_bf16 v[8:11], v[120:123], v[104:107], v[8:11]
    ds_read_b128 v[144:147], v185 offset:0
    v_mfma_f32_16x16x32_bf16 v[12:15], v[124:127], v[104:107], v[12:15]
    ds_read_b64_tr_b16 v[160:161], v186 offset:4096
    v_mfma_f32_16x16x32_bf16 v[16:19], v[128:131], v[104:107], v[16:19]
    ds_read_b64_tr_b16 v[162:163], v186 offset:4608
    v_mfma_f32_16x16x32_bf16 v[20:23], v[132:135], v[104:107], v[20:23]
    ds_read_b64_tr_b16 v[164:165], v187 offset:4096
    v_mfma_f32_16x16x32_bf16 v[24:27], v[104:107], v[136:139], v[24:27]
    ds_read_b64_tr_b16 v[166:167], v187 offset:4608
    v_mfma_f32_16x16x32_bf16 v[28:31], v[104:107], v[140:143], v[28:31]
    ds_read_b64_tr_b16 v[168:169], v186 offset:12288
    v_mfma_f32_16x16x32_bf16 v[32:35], v[120:123], v[108:111], v[32:35]
    ds_read_b64_tr_b16 v[170:171], v186 offset:12800
    v_mfma_f32_16x16x32_bf16 v[36:39], v[124:127], v[108:111], v[36:39]
    ds_read_b64_tr_b16 v[172:173], v187 offset:12288
    v_mfma_f32_16x16x32_bf16 v[40:43], v[128:131], v[108:111], v[40:43]
    ds_read_b64_tr_b16 v[174:175], v187 offset:12800
    v_mfma_f32_16x16x32_bf16 v[44:47], v[132:135], v[108:111], v[44:47]
    ds_read_b64_tr_b16 v[176:177], v186 offset:20480
    v_mfma_f32_16x16x32_bf16 v[48:51], v[108:111], v[136:139], v[48:51]
    ds_read_b64_tr_b16 v[178:179], v186 offset:20992
    v_mfma_f32_16x16x32_bf16 v[52:55], v[108:111], v[140:143], v[52:55]
    ds_read_b64_tr_b16 v[180:181], v187 offset:20480
    v_mfma_f32_16x16x32_bf16 v[56:59], v[120:123], v[112:115], v[56:59]
    ds_read_b64_tr_b16 v[182:183], v187 offset:20992
    v_mfma_f32_16x16x32_bf16 v[60:63], v[124:127], v[112:115], v[60:63]
    ds_read_b128 v[148:151], v185 offset:2048
    v_mfma_f32_16x16x32_bf16 v[64:67], v[128:131], v[112:115], v[64:67]
    ds_read_b128 v[152:155], v185 offset:4096
    v_mfma_f32_16x16x32_bf16 v[68:71], v[132:135], v[112:115], v[68:71]
    ds_read_b128 v[156:159], v185 offset:6144
    v_mfma_f32_16x16x32_bf16 v[72:75], v[112:115], v[136:139], v[72:75]
    v_mfma_f32_16x16x32_bf16 v[76:79], v[112:115], v[140:143], v[76:79]
    v_mfma_f32_16x16x32_bf16 v[80:83], v[120:123], v[116:119], v[80:83]
    v_mfma_f32_16x16x32_bf16 v[84:87], v[124:127], v[116:119], v[84:87]
    v_mfma_f32_16x16x32_bf16 v[88:91], v[128:131], v[116:119], v[88:91]
    v_mfma_f32_16x16x32_bf16 v[92:95], v[132:135], v[116:119], v[92:95]
    v_mfma_f32_16x16x32_bf16 v[96:99], v[116:119], v[136:139], v[96:99]
    v_mfma_f32_16x16x32_bf16 v[100:103], v[116:119], v[140:143], v[100:103]
    s_waitcnt lgkmcnt(0)
    s_barrier
    v_mfma_f32_16x16x32_bf16 v[8:11], v[160:163], v[144:147], v[8:11]
    ds_read_b128 v[104:107], v184 offset:40960
    v_mfma_f32_16x16x32_bf16 v[12:15], v[164:167], v[144:147], v[12:15]
    ds_read_b64_tr_b16 v[120:121], v186 offset:40960
    v_mfma_f32_16x16x32_bf16 v[16:19], v[168:171], v[144:147], v[16:19]
    ds_read_b64_tr_b16 v[122:123], v186 offset:41472
    v_mfma_f32_16x16x32_bf16 v[20:23], v[172:175], v[144:147], v[20:23]
    ds_read_b64_tr_b16 v[124:125], v187 offset:40960
    v_mfma_f32_16x16x32_bf16 v[24:27], v[144:147], v[176:179], v[24:27]
    ds_read_b64_tr_b16 v[126:127], v187 offset:41472
    v_mfma_f32_16x16x32_bf16 v[28:31], v[144:147], v[180:183], v[28:31]
    ds_read_b64_tr_b16 v[128:129], v186 offset:49152
    v_mfma_f32_16x16x32_bf16 v[32:35], v[160:163], v[148:151], v[32:35]
    ds_read_b64_tr_b16 v[130:131], v186 offset:49664
    v_mfma_f32_16x16x32_bf16 v[36:39], v[164:167], v[148:151], v[36:39]
    ds_read_b64_tr_b16 v[132:133], v187 offset:49152
    v_mfma_f32_16x16x32_bf16 v[40:43], v[168:171], v[148:151], v[40:43]
    ds_read_b64_tr_b16 v[134:135], v187 offset:49664
    v_mfma_f32_16x16x32_bf16 v[44:47], v[172:175], v[148:151], v[44:47]
    ds_read_b64_tr_b16 v[136:137], v186 offset:57344
    v_mfma_f32_16x16x32_bf16 v[48:51], v[148:151], v[176:179], v[48:51]
    ds_read_b64_tr_b16 v[138:139], v186 offset:57856
    v_mfma_f32_16x16x32_bf16 v[52:55], v[148:151], v[180:183], v[52:55]
    ds_read_b64_tr_b16 v[140:141], v187 offset:57344
    v_mfma_f32_16x16x32_bf16 v[56:59], v[160:163], v[152:155], v[56:59]
    ds_read_b64_tr_b16 v[142:143], v187 offset:57856
    v_mfma_f32_16x16x32_bf16 v[60:63], v[164:167], v[152:155], v[60:63]
    ds_read_b128 v[108:111], v184 offset:43008
    v_mfma_f32_16x16x32_bf16 v[64:67], v[168:171], v[152:155], v[64:67]
    ds_read_b128 v[112:115], v184 offset:45056
    v_mfma_f32_16x16x32_bf16 v[68:71], v[172:175], v[152:155], v[68:71]
    ds_read_b128 v[116:119], v184 offset:47104
    v_mfma_f32_16x16x32_bf16 v[72:75], v[152:155], v[176:179], v[72:75]
    v_mfma_f32_16x16x32_bf16 v[76:79], v[152:155], v[180:183], v[76:79]
    v_mfma_f32_16x16x32_bf16 v[80:83], v[160:163], v[156:159], v[80:83]
    v_mfma_f32_16x16x32_bf16 v[84:87], v[164:167], v[156:159], v[84:87]
    v_mfma_f32_16x16x32_bf16 v[88:91], v[168:171], v[156:159], v[88:91]
    v_mfma_f32_16x16x32_bf16 v[92:95], v[172:175], v[156:159], v[92:95]
    v_mfma_f32_16x16x32_bf16 v[96:99], v[156:159], v[176:179], v[96:99]
    v_mfma_f32_16x16x32_bf16 v[100:103], v[156:159], v[180:183], v[100:103]
    s_waitcnt lgkmcnt(0)
    s_nop 0
    v_mfma_f32_16x16x32_bf16 v[8:11], v[120:123], v[104:107], v[8:11]
    ds_read_b128 v[144:147], v185 offset:40960
    v_mfma_f32_16x16x32_bf16 v[12:15], v[124:127], v[104:107], v[12:15]
    ds_read_b64_tr_b16 v[160:161], v186 offset:45056
    v_mfma_f32_16x16x32_bf16 v[16:19], v[128:131], v[104:107], v[16:19]
    ds_read_b64_tr_b16 v[162:163], v186 offset:45568
    v_mfma_f32_16x16x32_bf16 v[20:23], v[132:135], v[104:107], v[20:23]
    ds_read_b64_tr_b16 v[164:165], v187 offset:45056
    v_mfma_f32_16x16x32_bf16 v[24:27], v[104:107], v[136:139], v[24:27]
    ds_read_b64_tr_b16 v[166:167], v187 offset:45568
    v_mfma_f32_16x16x32_bf16 v[28:31], v[104:107], v[140:143], v[28:31]
    ds_read_b64_tr_b16 v[168:169], v186 offset:53248
    v_mfma_f32_16x16x32_bf16 v[32:35], v[120:123], v[108:111], v[32:35]
    ds_read_b64_tr_b16 v[170:171], v186 offset:53760
    v_mfma_f32_16x16x32_bf16 v[36:39], v[124:127], v[108:111], v[36:39]
    ds_read_b64_tr_b16 v[172:173], v187 offset:53248
    v_mfma_f32_16x16x32_bf16 v[40:43], v[128:131], v[108:111], v[40:43]
    ds_read_b64_tr_b16 v[174:175], v187 offset:53760
    v_mfma_f32_16x16x32_bf16 v[44:47], v[132:135], v[108:111], v[44:47]
    ds_read_b64_tr_b16 v[176:177], v186 offset:61440
    v_mfma_f32_16x16x32_bf16 v[48:51], v[108:111], v[136:139], v[48:51]
    ds_read_b64_tr_b16 v[178:179], v186 offset:61952
    v_mfma_f32_16x16x32_bf16 v[52:55], v[108:111], v[140:143], v[52:55]
    ds_read_b64_tr_b16 v[180:181], v187 offset:61440
    v_mfma_f32_16x16x32_bf16 v[56:59], v[120:123], v[112:115], v[56:59]
    ds_read_b64_tr_b16 v[182:183], v187 offset:61952
    v_mfma_f32_16x16x32_bf16 v[60:63], v[124:127], v[112:115], v[60:63]
    ds_read_b128 v[148:151], v185 offset:43008
    v_mfma_f32_16x16x32_bf16 v[64:67], v[128:131], v[112:115], v[64:67]
    ds_read_b128 v[152:155], v185 offset:45056
    v_mfma_f32_16x16x32_bf16 v[68:71], v[132:135], v[112:115], v[68:71]
    ds_read_b128 v[156:159], v185 offset:47104
    v_mfma_f32_16x16x32_bf16 v[72:75], v[112:115], v[136:139], v[72:75]
    v_mfma_f32_16x16x32_bf16 v[76:79], v[112:115], v[140:143], v[76:79]
    v_mfma_f32_16x16x32_bf16 v[80:83], v[120:123], v[116:119], v[80:83]
    v_mfma_f32_16x16x32_bf16 v[84:87], v[124:127], v[116:119], v[84:87]
    v_mfma_f32_16x16x32_bf16 v[88:91], v[128:131], v[116:119], v[88:91]
    v_mfma_f32_16x16x32_bf16 v[92:95], v[132:135], v[116:119], v[92:95]
    v_mfma_f32_16x16x32_bf16 v[96:99], v[116:119], v[136:139], v[96:99]
    v_mfma_f32_16x16x32_bf16 v[100:103], v[116:119], v[140:143], v[100:103]
    s_waitcnt lgkmcnt(0)
    s_barrier
    v_mfma_f32_16x16x32_bf16 v[8:11], v[160:163], v[144:147], v[8:11]
    ds_read_b128 v[104:107], v188 offset:0
    v_mfma_f32_16x16x32_bf16 v[12:15], v[164:167], v[144:147], v[12:15]
    ds_read_b64_tr_b16 v[120:121], v190 offset:0
    v_mfma_f32_16x16x32_bf16 v[16:19], v[168:171], v[144:147], v[16:19]
    ds_read_b64_tr_b16 v[122:123], v190 offset:512
    v_mfma_f32_16x16x32_bf16 v[20:23], v[172:175], v[144:147], v[20:23]
    ds_read_b64_tr_b16 v[124:125], v191 offset:0
    v_mfma_f32_16x16x32_bf16 v[24:27], v[144:147], v[176:179], v[24:27]
    ds_read_b64_tr_b16 v[126:127], v191 offset:512
    v_mfma_f32_16x16x32_bf16 v[28:31], v[144:147], v[180:183], v[28:31]
    ds_read_b64_tr_b16 v[128:129], v190 offset:8192
    v_mfma_f32_16x16x32_bf16 v[32:35], v[160:163], v[148:151], v[32:35]
    ds_read_b64_tr_b16 v[130:131], v190 offset:8704
    v_mfma_f32_16x16x32_bf16 v[36:39], v[164:167], v[148:151], v[36:39]
    ds_read_b64_tr_b16 v[132:133], v191 offset:8192
    v_mfma_f32_16x16x32_bf16 v[40:43], v[168:171], v[148:151], v[40:43]
    ds_read_b64_tr_b16 v[134:135], v191 offset:8704
    v_mfma_f32_16x16x32_bf16 v[44:47], v[172:175], v[148:151], v[44:47]
    ds_read_b64_tr_b16 v[136:137], v190 offset:16384
    v_mfma_f32_16x16x32_bf16 v[48:51], v[148:151], v[176:179], v[48:51]
    ds_read_b64_tr_b16 v[138:139], v190 offset:16896
    v_mfma_f32_16x16x32_bf16 v[52:55], v[148:151], v[180:183], v[52:55]
    ds_read_b64_tr_b16 v[140:141], v191 offset:16384
    v_mfma_f32_16x16x32_bf16 v[56:59], v[160:163], v[152:155], v[56:59]
    ds_read_b64_tr_b16 v[142:143], v191 offset:16896
    v_mfma_f32_16x16x32_bf16 v[60:63], v[164:167], v[152:155], v[60:63]
    ds_read_b128 v[108:111], v188 offset:2048
    v_mfma_f32_16x16x32_bf16 v[64:67], v[168:171], v[152:155], v[64:67]
    ds_read_b128 v[112:115], v188 offset:4096
    v_mfma_f32_16x16x32_bf16 v[68:71], v[172:175], v[152:155], v[68:71]
    ds_read_b128 v[116:119], v188 offset:6144
    v_mfma_f32_16x16x32_bf16 v[72:75], v[152:155], v[176:179], v[72:75]
    v_mfma_f32_16x16x32_bf16 v[76:79], v[152:155], v[180:183], v[76:79]
    v_mfma_f32_16x16x32_bf16 v[80:83], v[160:163], v[156:159], v[80:83]
    v_mfma_f32_16x16x32_bf16 v[84:87], v[164:167], v[156:159], v[84:87]
    v_mfma_f32_16x16x32_bf16 v[88:91], v[168:171], v[156:159], v[88:91]
    v_mfma_f32_16x16x32_bf16 v[92:95], v[172:175], v[156:159], v[92:95]
    v_mfma_f32_16x16x32_bf16 v[96:99], v[156:159], v[176:179], v[96:99]
    v_mfma_f32_16x16x32_bf16 v[100:103], v[156:159], v[180:183], v[100:103]
    s_waitcnt lgkmcnt(0)
    s_nop 0
    v_mfma_f32_16x16x32_bf16 v[8:11], v[120:123], v[104:107], v[8:11]
    ds_read_b128 v[144:147], v189 offset:0
    v_mfma_f32_16x16x32_bf16 v[12:15], v[124:127], v[104:107], v[12:15]
    ds_read_b64_tr_b16 v[160:161], v190 offset:4096
    v_mfma_f32_16x16x32_bf16 v[16:19], v[128:131], v[104:107], v[16:19]
    ds_read_b64_tr_b16 v[162:163], v190 offset:4608
    v_mfma_f32_16x16x32_bf16 v[20:23], v[132:135], v[104:107], v[20:23]
    ds_read_b64_tr_b16 v[164:165], v191 offset:4096
    v_mfma_f32_16x16x32_bf16 v[24:27], v[104:107], v[136:139], v[24:27]
    ds_read_b64_tr_b16 v[166:167], v191 offset:4608
    v_mfma_f32_16x16x32_bf16 v[28:31], v[104:107], v[140:143], v[28:31]
    ds_read_b64_tr_b16 v[168:169], v190 offset:12288
    v_mfma_f32_16x16x32_bf16 v[32:35], v[120:123], v[108:111], v[32:35]
    ds_read_b64_tr_b16 v[170:171], v190 offset:12800
    v_mfma_f32_16x16x32_bf16 v[36:39], v[124:127], v[108:111], v[36:39]
    ds_read_b64_tr_b16 v[172:173], v191 offset:12288
    v_mfma_f32_16x16x32_bf16 v[40:43], v[128:131], v[108:111], v[40:43]
    ds_read_b64_tr_b16 v[174:175], v191 offset:12800
    v_mfma_f32_16x16x32_bf16 v[44:47], v[132:135], v[108:111], v[44:47]
    ds_read_b64_tr_b16 v[176:177], v190 offset:20480
    v_mfma_f32_16x16x32_bf16 v[48:51], v[108:111], v[136:139], v[48:51]
    ds_read_b64_tr_b16 v[178:179], v190 offset:20992
    v_mfma_f32_16x16x32_bf16 v[52:55], v[108:111], v[140:143], v[52:55]
    ds_read_b64_tr_b16 v[180:181], v191 offset:20480
    v_mfma_f32_16x16x32_bf16 v[56:59], v[120:123], v[112:115], v[56:59]
    ds_read_b64_tr_b16 v[182:183], v191 offset:20992
    v_mfma_f32_16x16x32_bf16 v[60:63], v[124:127], v[112:115], v[60:63]
    ds_read_b128 v[148:151], v189 offset:2048
    v_mfma_f32_16x16x32_bf16 v[64:67], v[128:131], v[112:115], v[64:67]
    ds_read_b128 v[152:155], v189 offset:4096
    v_mfma_f32_16x16x32_bf16 v[68:71], v[132:135], v[112:115], v[68:71]
    ds_read_b128 v[156:159], v189 offset:6144
    v_mfma_f32_16x16x32_bf16 v[72:75], v[112:115], v[136:139], v[72:75]
    s_add_u32 s66, s66, 1
    s_cmp_lt_u32 s66, 5
    v_mfma_f32_16x16x32_bf16 v[76:79], v[112:115], v[140:143], v[76:79]
    v_mfma_f32_16x16x32_bf16 v[80:83], v[120:123], v[116:119], v[80:83]
    v_mfma_f32_16x16x32_bf16 v[84:87], v[124:127], v[116:119], v[84:87]
    v_mfma_f32_16x16x32_bf16 v[88:91], v[128:131], v[116:119], v[88:91]
    v_mfma_f32_16x16x32_bf16 v[92:95], v[132:135], v[116:119], v[92:95]
    v_mfma_f32_16x16x32_bf16 v[96:99], v[116:119], v[136:139], v[96:99]
    v_mfma_f32_16x16x32_bf16 v[100:103], v[116:119], v[140:143], v[100:103]
    s_cbranch_scc1 L_cloop
    s_nop 0
    s_waitcnt lgkmcnt(0)
    s_barrier
    v_mfma_f32_16x16x32_bf16 v[8:11], v[160:163], v[144:147], v[8:11]
    ds_read_b128 v[104:107], v184 offset:0
    v_and_b32_e64 v2, 15, v1
    v_mfma_f32_16x16x32_bf16 v[12:15], v[164:167], v[144:147], v[12:15]
    ds_read_b64_tr_b16 v[120:121], v186 offset:0
    v_lshrrev_b32_e64 v3, 4, v1
    v_mfma_f32_16x16x32_bf16 v[16:19], v[168:171], v[144:147], v[16:19]
    ds_read_b64_tr_b16 v[122:123], v186 offset:512
    s_lshl_b32 s3, s64, 8
    s_nop 0
    v_mfma_f32_16x16x32_bf16 v[20:23], v[172:175], v[144:147], v[20:23]
    ds_read_b64_tr_b16 v[124:125], v187 offset:0
    s_add_u32 s3, s3, 152064
    v_mfma_f32_16x16x32_bf16 v[24:27], v[144:147], v[176:179], v[24:27]
    ds_read_b64_tr_b16 v[126:127], v187 offset:512
    v_lshl_add_u32 v188, v2, 2, s3
    v_mfma_f32_16x16x32_bf16 v[28:31], v[144:147], v[180:183], v[28:31]
    ds_read_b64_tr_b16 v[128:129], v186 offset:8192
    v_lshl_add_u32 v189, v3, 4, s3
    v_mfma_f32_16x16x32_bf16 v[32:35], v[160:163], v[148:151], v[32:35]
    ds_read_b64_tr_b16 v[130:131], v186 offset:8704
    v_lshrrev_b32_e64 v7, 5, v1
    v_mfma_f32_16x16x32_bf16 v[36:39], v[164:167], v[148:151], v[36:39]
    ds_read_b64_tr_b16 v[132:133], v187 offset:8192
    v_lshl_add_u32 v190, v7, 6, v188
    v_mfma_f32_16x16x32_bf16 v[40:43], v[168:171], v[148:151], v[40:43]
    ds_read_b64_tr_b16 v[134:135], v187 offset:8704
    s_lshl_b32 s3, s65, 7
    s_nop 0
    v_mfma_f32_16x16x32_bf16 v[44:47], v[172:175], v[148:151], v[44:47]
    ds_read_b64_tr_b16 v[136:137], v186 offset:16384
    s_add_u32 s3, s3, 154880
    v_mfma_f32_16x16x32_bf16 v[48:51], v[148:151], v[176:179], v[48:51]
    ds_read_b64_tr_b16 v[138:139], v186 offset:16896
    v_lshl_add_u32 v191, v3, 4, s3
    v_mfma_f32_16x16x32_bf16 v[52:55], v[148:151], v[180:183], v[52:55]
    ds_read_b64_tr_b16 v[140:141], v187 offset:16384
    v_lshl_add_u32 v248, v2, 2, s3
    v_mfma_f32_16x16x32_bf16 v[56:59], v[160:163], v[152:155], v[56:59]
    ds_read_b64_tr_b16 v[142:143], v187 offset:16896
    s_lshl_b32 s3, s64, 7
    s_nop 0
    v_mfma_f32_16x16x32_bf16 v[60:63], v[164:167], v[152:155], v[60:63]
    ds_read_b128 v[108:111], v184 offset:2048
    s_add_u32 s3, s3, 154624
    v_mfma_f32_16x16x32_bf16 v[64:67], v[168:171], v[152:155], v[64:67]
    ds_read_b128 v[112:115], v184 offset:4096
    v_lshl_add_u32 v249, v3, 4, s3
    v_mfma_f32_16x16x32_bf16 v[68:71], v[172:175], v[152:155], v[68:71]
    ds_read_b128 v[116:119], v184 offset:6144
    v_xor_b32 v253, 128, v249
    v_mfma_f32_16x16x32_bf16 v[72:75], v[152:155], v[176:179], v[72:75]
    v_lshrrev_b32 v250, 2, v1
    v_lshlrev_b32 v250, 6, v250
    v_mfma_f32_16x16x32_bf16 v[76:79], v[152:155], v[180:183], v[76:79]
    v_and_b32_e64 v251, 3, v1
    v_lshl_add_u32 v250, v251, 3, v250
    v_mfma_f32_16x16x32_bf16 v[80:83], v[160:163], v[156:159], v[80:83]
    s_lshl_b32 s3, s65, 11
    s_add_u32 s3, s3, 147712
    v_mfma_f32_16x16x32_bf16 v[84:87], v[164:167], v[156:159], v[84:87]
    v_add_u32 v252, s3, v250
    v_bfe_u32 v5, v1, 1, 2
    v_mfma_f32_16x16x32_bf16 v[88:91], v[168:171], v[156:159], v[88:91]
    v_lshlrev_b32_e64 v5, 2, v5
    v_bfe_u32 v4, v1, 3, 1
    v_mfma_f32_16x16x32_bf16 v[92:95], v[172:175], v[156:159], v[92:95]
    v_lshl_add_u32 v5, v4, 1, v5
    v_and_b32 v4, 1, v1
    v_mfma_f32_16x16x32_bf16 v[96:99], v[156:159], v[176:179], v[96:99]
    v_add_u32 v5, v5, v4
    v_xor_b32 v5, v5, v3
    v_mfma_f32_16x16x32_bf16 v[100:103], v[156:159], v[180:183], v[100:103]
    s_lshl_b32 s3, s38, 13
    s_add_u32 s3, s3, 98304
    s_waitcnt lgkmcnt(0)
    s_nop 0
    v_mfma_f32_16x16x32_bf16 v[8:11], v[120:123], v[104:107], v[8:11]
    ds_read_b128 v[144:147], v185 offset:0
    v_lshl_add_u32 v2, v2, 7, s3
    v_mfma_f32_16x16x32_bf16 v[12:15], v[124:127], v[104:107], v[12:15]
    ds_read_b64_tr_b16 v[160:161], v186 offset:4096
    v_lshl_add_u32 v4, v5, 3, v2
    v_mfma_f32_16x16x32_bf16 v[16:19], v[128:131], v[104:107], v[16:19]
    ds_read_b64_tr_b16 v[162:163], v186 offset:4608
    v_xor_b32_e64 v5, 32, v4
    v_mfma_f32_16x16x32_bf16 v[20:23], v[132:135], v[104:107], v[20:23]
    ds_read_b64_tr_b16 v[164:165], v187 offset:4096
    v_xor_b32_e64 v6, 64, v4
    v_mfma_f32_16x16x32_bf16 v[24:27], v[104:107], v[136:139], v[24:27]
    ds_read_b64_tr_b16 v[166:167], v187 offset:4608
    v_xor_b32 v7, 96, v4
    v_mfma_f32_16x16x32_bf16 v[28:31], v[104:107], v[140:143], v[28:31]
    ds_read_b64_tr_b16 v[168:169], v186 offset:12288
    v_bfe_u32 v2, v1, 3, 2
    v_mfma_f32_16x16x32_bf16 v[32:35], v[120:123], v[108:111], v[32:35]
    ds_read_b64_tr_b16 v[170:171], v186 offset:12800
    v_lshlrev_b32_e64 v2, 2, v2
    v_mfma_f32_16x16x32_bf16 v[36:39], v[124:127], v[108:111], v[36:39]
    ds_read_b64_tr_b16 v[172:173], v187 offset:12288
    v_lshrrev_b32_e64 v3, 5, v1
    v_mfma_f32_16x16x32_bf16 v[40:43], v[128:131], v[108:111], v[40:43]
    ds_read_b64_tr_b16 v[174:175], v187 offset:12800
    v_lshl_add_u32 v2, v3, 1, v2
    v_mfma_f32_16x16x32_bf16 v[44:47], v[132:135], v[108:111], v[44:47]
    ds_read_b64_tr_b16 v[176:177], v186 offset:20480
    v_bfe_u32 v3, v1, 2, 1
    v_mfma_f32_16x16x32_bf16 v[48:51], v[108:111], v[136:139], v[48:51]
    ds_read_b64_tr_b16 v[178:179], v186 offset:20992
    v_add_u32_e64 v2, v2, v3
    v_mfma_f32_16x16x32_bf16 v[52:55], v[108:111], v[140:143], v[52:55]
    ds_read_b64_tr_b16 v[180:181], v187 offset:20480
    v_xor_b32_e64 v2, v2, v251
    v_mfma_f32_16x16x32_bf16 v[56:59], v[120:123], v[112:115], v[56:59]
    ds_read_b64_tr_b16 v[182:183], v187 offset:20992
    v_lshrrev_b32_e64 v3, 2, v1
    v_mfma_f32_16x16x32_bf16 v[60:63], v[124:127], v[112:115], v[60:63]
    ds_read_b128 v[148:151], v185 offset:2048
    v_lshl_add_u32 v3, v3, 7, s3
    v_mfma_f32_16x16x32_bf16 v[64:67], v[128:131], v[112:115], v[64:67]
    ds_read_b128 v[152:155], v185 offset:4096
    v_lshl_add_u32 v2, v2, 3, v3
    v_mfma_f32_16x16x32_bf16 v[68:71], v[132:135], v[112:115], v[68:71]
    ds_read_b128 v[156:159], v185 offset:6144
    s_lshl_b32 s28, s64, 6
    v_mfma_f32_16x16x32_bf16 v[72:75], v[112:115], v[136:139], v[72:75]
    v_xor_b32 v201, s28, v2
    v_xor_b32 v203, 32, v201
    v_mfma_f32_16x16x32_bf16 v[76:79], v[112:115], v[140:143], v[76:79]
    s_lshl_b32 s3, s38, 12
    s_add_u32 s3, s3, 131072
    v_mfma_f32_16x16x32_bf16 v[80:83], v[120:123], v[116:119], v[80:83]
    v_lshlrev_b32 v199, 4, v1
    v_add_u32 v197, s3, v199
    v_mfma_f32_16x16x32_bf16 v[84:87], v[124:127], v[116:119], v[84:87]
    s_lshl_b32 s3, s37, 1
    s_add_u32 s67, s3, s65
    v_mfma_f32_16x16x32_bf16 v[88:91], v[128:131], v[116:119], v[88:91]
    s_lshl_b32 s3, s67, 4
    s_add_u32 s3, s3, s36
    v_mfma_f32_16x16x32_bf16 v[92:95], v[132:135], v[116:119], v[92:95]
    s_mul_i32 s3, s3, 4224
    s_add_u32 s75, s3, 8388608
    v_mfma_f32_16x16x32_bf16 v[96:99], v[116:119], v[136:139], v[96:99]
    s_lshl_b32 s3, s64, 11
    s_add_u32 s74, s75, s3
    v_mfma_f32_16x16x32_bf16 v[100:103], v[116:119], v[140:143], v[100:103]
    s_lshl_b32 s3, s64, 6
    s_add_u32 s75, s75, s3
    s_add_u32 s75, s75, 4096
    s_lshl_b32 s3, s37, 4
    s_add_u32 s3, s3, s36
    s_lshl_b32 s3, s3, 7
    s_add_u32 s3, s3, 32768
    v_mov_b32 v251, s86
    s_cmp_lg_u32 s38, 0
    s_cselect_b32 s76, 268435456, s3
    s_waitcnt lgkmcnt(0)
    v_mfma_f32_16x16x32_bf16 v[16:19], v[168:171], v[144:147], v[16:19]
    s_barrier
    s_nop 0
    v_mfma_f32_16x16x32_bf16 v[20:23], v[172:175], v[144:147], v[20:23]
    ds_read_b32 v192, v188 offset:0
    ds_read_b32 v194, v188 offset:64
    v_mfma_f32_16x16x32_bf16 v[40:43], v[168:171], v[148:151], v[40:43]
    ds_read_b32 v196, v188 offset:128
    ds_read_b32 v198, v188 offset:192
    v_mfma_f32_16x16x32_bf16 v[44:47], v[172:175], v[148:151], v[44:47]
    ds_read_b128 v[204:207], v191 offset:256
    v_mfma_f32_16x16x32_bf16 v[64:67], v[168:171], v[152:155], v[64:67]
    ds_read_b128 v[208:211], v191 offset:320
    v_mfma_f32_16x16x32_bf16 v[68:71], v[172:175], v[152:155], v[68:71]
    ds_read_b64_tr_b16 v[224:225], v252 offset:0
    v_mfma_f32_16x16x32_bf16 v[88:91], v[168:171], v[156:159], v[88:91]
    ds_read_b64_tr_b16 v[226:227], v252 offset:1024
    v_mfma_f32_16x16x32_bf16 v[92:95], v[172:175], v[156:159], v[92:95]
    ds_read_b64_tr_b16 v[228:229], v252 offset:32
    v_mfma_f32_16x16x32_bf16 v[24:27], v[144:147], v[176:179], v[24:27]
    ds_read_b64_tr_b16 v[230:231], v252 offset:1056
    v_mfma_f32_16x16x32_bf16 v[28:31], v[144:147], v[180:183], v[28:31]
    ds_read_b128 v[104:107], v189 offset:0
    v_mfma_f32_16x16x32_bf16 v[48:51], v[148:151], v[176:179], v[48:51]
    ds_read_b128 v[108:111], v189 offset:64
    v_mfma_f32_16x16x32_bf16 v[52:55], v[148:151], v[180:183], v[52:55]
    ds_read_b128 v[112:115], v189 offset:128
    v_mfma_f32_16x16x32_bf16 v[72:75], v[152:155], v[176:179], v[72:75]
    ds_read_b128 v[116:119], v189 offset:192
    v_mfma_f32_16x16x32_bf16 v[76:79], v[152:155], v[180:183], v[76:79]
    ds_read_b32 v250, v248 offset:576
    ds_read_b32 v248, v248 offset:512
    v_mfma_f32_16x16x32_bf16 v[96:99], v[156:159], v[176:179], v[96:99]
    ds_read_b32 v200, v188 offset:2048
    v_mfma_f32_16x16x32_bf16 v[100:103], v[156:159], v[180:183], v[100:103]
    ds_read_b32 v202, v188 offset:2112
    v_mfma_f32_16x16x32_bf16 v[8:11], v[160:163], v[144:147], v[8:11]
    ds_read_b32 v220, v188 offset:2176
    v_mfma_f32_16x16x32_bf16 v[12:15], v[164:167], v[144:147], v[12:15]
    ds_read_b32 v222, v188 offset:2240
    v_mfma_f32_16x16x32_bf16 v[32:35], v[160:163], v[148:151], v[32:35]
    ds_read_b32 v193, v190 offset:2048
    ds_read_b32 v195, v190 offset:1024
    v_mfma_f32_16x16x32_bf16 v[36:39], v[164:167], v[148:151], v[36:39]
    ds_read_b32 v221, v190 offset:2176
    ds_read_b32 v223, v190 offset:1152
    v_mfma_f32_16x16x32_bf16 v[56:59], v[160:163], v[152:155], v[56:59]
    ds_read_b128 v[120:123], v249 offset:0
    v_mfma_f32_16x16x32_bf16 v[60:63], v[164:167], v[152:155], v[60:63]
    ds_read_b128 v[124:127], v249 offset:64
    v_mfma_f32_16x16x32_bf16 v[80:83], v[160:163], v[156:159], v[80:83]
    ds_read_b128 v[212:215], v191 offset:0
    v_mfma_f32_16x16x32_bf16 v[84:87], v[164:167], v[156:159], v[84:87]
    ds_read_b128 v[216:219], v191 offset:64
    s_waitcnt lgkmcnt(4)
    s_nop 0
    v_pk_fma_f32 v[16:17], v[192:193], v[204:205], v[16:17] op_sel_hi:[0,1,1] neg_lo:[1,0,0] neg_hi:[1,0,0]
    v_pk_fma_f32 v[18:19], v[192:193], v[206:207], v[18:19] op_sel_hi:[0,1,1] neg_lo:[1,0,0] neg_hi:[1,0,0]
    v_pk_fma_f32 v[20:21], v[192:193], v[208:209], v[20:21] op_sel_hi:[0,1,1] neg_lo:[1,0,0] neg_hi:[1,0,0]
    v_pk_fma_f32 v[22:23], v[192:193], v[210:211], v[22:23] op_sel_hi:[0,1,1] neg_lo:[1,0,0] neg_hi:[1,0,0]
    v_cvt_pk_bf16_f32 v232, v16, v17
    v_cvt_pk_bf16_f32 v233, v18, v19
    v_cvt_pk_bf16_f32 v234, v20, v21
    v_cvt_pk_bf16_f32 v235, v22, v23
    v_pk_fma_f32 v[40:41], v[194:195], v[204:205], v[40:41] op_sel_hi:[0,1,1] neg_lo:[1,0,0] neg_hi:[1,0,0]
    v_pk_fma_f32 v[42:43], v[194:195], v[206:207], v[42:43] op_sel_hi:[0,1,1] neg_lo:[1,0,0] neg_hi:[1,0,0]
    v_pk_fma_f32 v[44:45], v[194:195], v[208:209], v[44:45] op_sel_hi:[0,1,1] neg_lo:[1,0,0] neg_hi:[1,0,0]
    v_pk_fma_f32 v[46:47], v[194:195], v[210:211], v[46:47] op_sel_hi:[0,1,1] neg_lo:[1,0,0] neg_hi:[1,0,0]
    v_cvt_pk_bf16_f32 v236, v40, v41
    v_cvt_pk_bf16_f32 v237, v42, v43
    v_cvt_pk_bf16_f32 v238, v44, v45
    v_cvt_pk_bf16_f32 v239, v46, v47
    v_pk_fma_f32 v[64:65], v[196:197], v[204:205], v[64:65] op_sel_hi:[0,1,1] neg_lo:[1,0,0] neg_hi:[1,0,0]
    v_pk_fma_f32 v[66:67], v[196:197], v[206:207], v[66:67] op_sel_hi:[0,1,1] neg_lo:[1,0,0] neg_hi:[1,0,0]
    v_pk_fma_f32 v[68:69], v[196:197], v[208:209], v[68:69] op_sel_hi:[0,1,1] neg_lo:[1,0,0] neg_hi:[1,0,0]
    v_pk_fma_f32 v[70:71], v[196:197], v[210:211], v[70:71] op_sel_hi:[0,1,1] neg_lo:[1,0,0] neg_hi:[1,0,0]
    v_cvt_pk_bf16_f32 v240, v64, v65
    v_cvt_pk_bf16_f32 v241, v66, v67
    v_cvt_pk_bf16_f32 v242, v68, v69
    v_cvt_pk_bf16_f32 v243, v70, v71
    v_pk_fma_f32 v[88:89], v[198:199], v[204:205], v[88:89] op_sel_hi:[0,1,1] neg_lo:[1,0,0] neg_hi:[1,0,0]
    v_pk_fma_f32 v[90:91], v[198:199], v[206:207], v[90:91] op_sel_hi:[0,1,1] neg_lo:[1,0,0] neg_hi:[1,0,0]
    v_pk_fma_f32 v[92:93], v[198:199], v[208:209], v[92:93] op_sel_hi:[0,1,1] neg_lo:[1,0,0] neg_hi:[1,0,0]
    v_pk_fma_f32 v[94:95], v[198:199], v[210:211], v[94:95] op_sel_hi:[0,1,1] neg_lo:[1,0,0] neg_hi:[1,0,0]
    v_cvt_pk_bf16_f32 v244, v88, v89
    v_cvt_pk_bf16_f32 v245, v90, v91
    v_cvt_pk_bf16_f32 v246, v92, v93
    v_cvt_pk_bf16_f32 v247, v94, v95
    v_mfma_f32_16x16x32_bf16 v[144:147], v[224:227], v[232:235], 0
    v_mfma_f32_16x16x32_bf16 v[148:151], v[228:231], v[232:235], 0
    v_mfma_f32_16x16x32_bf16 v[152:155], v[224:227], v[236:239], 0
    v_mfma_f32_16x16x32_bf16 v[156:159], v[228:231], v[236:239], 0
    v_mfma_f32_16x16x32_bf16 v[160:163], v[224:227], v[240:243], 0
    v_mfma_f32_16x16x32_bf16 v[164:167], v[228:231], v[240:243], 0
    v_mfma_f32_16x16x32_bf16 v[168:171], v[224:227], v[244:247], 0
    v_mfma_f32_16x16x32_bf16 v[172:175], v[228:231], v[244:247], 0
    v_pk_fma_f32 v[24:25], v[104:105], v[248:249], v[24:25] op_sel_hi:[1,0,1] neg_lo:[1,0,0] neg_hi:[1,0,0]
    v_pk_fma_f32 v[26:27], v[106:107], v[248:249], v[26:27] op_sel_hi:[1,0,1] neg_lo:[1,0,0] neg_hi:[1,0,0]
    v_pk_fma_f32 v[28:29], v[104:105], v[250:251], v[28:29] op_sel_hi:[1,0,1] neg_lo:[1,0,0] neg_hi:[1,0,0]
    v_pk_fma_f32 v[30:31], v[106:107], v[250:251], v[30:31] op_sel_hi:[1,0,1] neg_lo:[1,0,0] neg_hi:[1,0,0]
    v_pk_fma_f32 v[48:49], v[108:109], v[248:249], v[48:49] op_sel_hi:[1,0,1] neg_lo:[1,0,0] neg_hi:[1,0,0]
    v_pk_fma_f32 v[50:51], v[110:111], v[248:249], v[50:51] op_sel_hi:[1,0,1] neg_lo:[1,0,0] neg_hi:[1,0,0]
    v_pk_fma_f32 v[52:53], v[108:109], v[250:251], v[52:53] op_sel_hi:[1,0,1] neg_lo:[1,0,0] neg_hi:[1,0,0]
    v_pk_fma_f32 v[54:55], v[110:111], v[250:251], v[54:55] op_sel_hi:[1,0,1] neg_lo:[1,0,0] neg_hi:[1,0,0]
    v_pk_fma_f32 v[72:73], v[112:113], v[248:249], v[72:73] op_sel_hi:[1,0,1] neg_lo:[1,0,0] neg_hi:[1,0,0]
    v_pk_fma_f32 v[74:75], v[114:115], v[248:249], v[74:75] op_sel_hi:[1,0,1] neg_lo:[1,0,0] neg_hi:[1,0,0]
    v_pk_fma_f32 v[76:77], v[112:113], v[250:251], v[76:77] op_sel_hi:[1,0,1] neg_lo:[1,0,0] neg_hi:[1,0,0]
    v_pk_fma_f32 v[78:79], v[114:115], v[250:251], v[78:79] op_sel_hi:[1,0,1] neg_lo:[1,0,0] neg_hi:[1,0,0]
    v_pk_fma_f32 v[96:97], v[116:117], v[248:249], v[96:97] op_sel_hi:[1,0,1] neg_lo:[1,0,0] neg_hi:[1,0,0]
    v_pk_fma_f32 v[98:99], v[118:119], v[248:249], v[98:99] op_sel_hi:[1,0,1] neg_lo:[1,0,0] neg_hi:[1,0,0]
    v_pk_fma_f32 v[100:101], v[116:117], v[250:251], v[100:101] op_sel_hi:[1,0,1] neg_lo:[1,0,0] neg_hi:[1,0,0]
    v_pk_fma_f32 v[102:103], v[118:119], v[250:251], v[102:103] op_sel_hi:[1,0,1] neg_lo:[1,0,0] neg_hi:[1,0,0]
    v_cvt_pk_bf16_f32 v24, v24, v25
    v_cvt_pk_bf16_f32 v25, v26, v27
    v_cvt_pk_bf16_f32 v26, v48, v49
    v_cvt_pk_bf16_f32 v27, v50, v51
    v_cvt_pk_bf16_f32 v28, v28, v29
    v_cvt_pk_bf16_f32 v29, v30, v31
    v_cvt_pk_bf16_f32 v30, v52, v53
    v_cvt_pk_bf16_f32 v31, v54, v55
    v_cvt_pk_bf16_f32 v72, v72, v73
    v_cvt_pk_bf16_f32 v73, v74, v75
    v_cvt_pk_bf16_f32 v74, v96, v97
    v_cvt_pk_bf16_f32 v75, v98, v99
    v_cvt_pk_bf16_f32 v76, v76, v77
    v_cvt_pk_bf16_f32 v77, v78, v79
    v_cvt_pk_bf16_f32 v78, v100, v101
    v_cvt_pk_bf16_f32 v79, v102, v103
    ds_read_b128 v[104:107], v253 offset:0
    ds_read_b128 v[108:111], v253 offset:64
    v_max3_f32 v176, v144, v145, v146
    v_max3_f32 v184, -v144, -v145, -v146
    v_max3_f32 v178, v152, v153, v154
    v_max3_f32 v186, -v152, -v153, -v154
    v_max3_f32 v176, v176, v147, v148
    v_max3_f32 v184, v184, -v147, -v148
    v_max3_f32 v178, v178, v155, v156
    v_max3_f32 v186, v186, -v155, -v156
    v_max3_f32 v176, v176, v149, v150
    v_max3_f32 v184, v184, -v149, -v150
    v_max3_f32 v178, v178, v157, v158
    v_max3_f32 v186, v186, -v157, -v158
    v_max_f32_e64 v176, v176, v151
    v_max_f32_e64 v184, v184, -v151
    v_max_f32_e64 v178, v178, v159
    v_max_f32_e64 v186, v186, -v159
    s_nop 0
    v_permlane32_swap_b32 v176, v178
    v_permlane32_swap_b32_e64 v184, v186
    v_max3_f32 v180, v160, v161, v162
    v_max3_f32 v188, -v160, -v161, -v162
    v_max_f32 v176, v176, v178
    v_max_f32 v184, v184, v186
    v_max3_f32 v182, v168, v169, v170
    v_max3_f32 v190, -v168, -v169, -v170
    v_permlane16_swap_b32 v176, v184
    v_max_f32 v176, v176, v184
    v_max3_f32 v180, v180, v163, v164
    v_max3_f32 v188, v188, -v163, -v164
    v_mul_f32 v184, v176, v193
    v_mul_f32 v176, v176, v193
    v_max3_f32 v182, v182, v171, v172
    v_max3_f32 v190, v190, -v171, -v172
    v_permlane16_swap_b32 v176, v184
    v_mov_b32 v178, v176
    v_max3_f32 v180, v180, v165, v166
    v_max3_f32 v188, v188, -v165, -v166
    v_mov_b32_e64 v186, v184
    v_max3_f32 v182, v182, v173, v174
    v_max3_f32 v190, v190, -v173, -v174
    v_permlane32_swap_b32 v176, v178
    v_permlane32_swap_b32 v184, v186
    v_max_f32_e64 v180, v180, v167
    v_max_f32_e64 v188, v188, -v167
    v_max_f32_e64 v182, v182, v175
    v_max_f32_e64 v190, v190, -v175
    s_nop 0
    v_permlane32_swap_b32 v180, v182
    v_permlane32_swap_b32_e64 v188, v190
    v_pk_fma_f32 v[16:17], v[144:145], v[200:201], v[184:185] op_sel_hi:[1,0,0] neg_lo:[1,0,1] neg_hi:[1,0,1]
    v_pk_fma_f32 v[144:145], v[144:145], v[200:201], v[176:177] op_sel_hi:[1,0,0] neg_lo:[0,0,1] neg_hi:[0,0,1]
    v_max_f32 v180, v180, v182
    v_max_f32 v188, v188, v190
    v_pk_fma_f32 v[18:19], v[146:147], v[200:201], v[184:185] op_sel_hi:[1,0,0] neg_lo:[1,0,1] neg_hi:[1,0,1]
    v_pk_fma_f32 v[146:147], v[146:147], v[200:201], v[176:177] op_sel_hi:[1,0,0] neg_lo:[0,0,1] neg_hi:[0,0,1]
    v_permlane16_swap_b32 v180, v188
    v_max_f32 v180, v180, v188
    v_pk_fma_f32 v[20:21], v[148:149], v[200:201], v[184:185] op_sel_hi:[1,0,0] neg_lo:[1,0,1] neg_hi:[1,0,1]
    v_pk_fma_f32 v[148:149], v[148:149], v[200:201], v[176:177] op_sel_hi:[1,0,0] neg_lo:[0,0,1] neg_hi:[0,0,1]
    v_mul_f32 v188, v180, v221
    v_mul_f32 v180, v180, v221
    v_pk_fma_f32 v[22:23], v[150:151], v[200:201], v[184:185] op_sel_hi:[1,0,0] neg_lo:[1,0,1] neg_hi:[1,0,1]
    v_pk_fma_f32 v[150:151], v[150:151], v[200:201], v[176:177] op_sel_hi:[1,0,0] neg_lo:[0,0,1] neg_hi:[0,0,1]
    v_permlane16_swap_b32 v180, v188
    v_mov_b32 v182, v180
    v_pk_fma_f32 v[40:41], v[152:153], v[202:203], v[186:187] op_sel_hi:[1,0,0] neg_lo:[1,0,1] neg_hi:[1,0,1]
    v_pk_fma_f32 v[152:153], v[152:153], v[202:203], v[178:179] op_sel_hi:[1,0,0] neg_lo:[0,0,1] neg_hi:[0,0,1]
    v_mov_b32_e64 v190, v188
    v_pk_fma_f32 v[42:43], v[154:155], v[202:203], v[186:187] op_sel_hi:[1,0,0] neg_lo:[1,0,1] neg_hi:[1,0,1]
    v_pk_fma_f32 v[154:155], v[154:155], v[202:203], v[178:179] op_sel_hi:[1,0,0] neg_lo:[0,0,1] neg_hi:[0,0,1]
    v_permlane32_swap_b32 v180, v182
    v_permlane32_swap_b32 v188, v190
    v_pk_fma_f32 v[44:45], v[156:157], v[202:203], v[186:187] op_sel_hi:[1,0,0] neg_lo:[1,0,1] neg_hi:[1,0,1]
    v_pk_fma_f32 v[156:157], v[156:157], v[202:203], v[178:179] op_sel_hi:[1,0,0] neg_lo:[0,0,1] neg_hi:[0,0,1]
    v_pk_fma_f32 v[46:47], v[158:159], v[202:203], v[186:187] op_sel_hi:[1,0,0] neg_lo:[1,0,1] neg_hi:[1,0,1]
    v_pk_fma_f32 v[158:159], v[158:159], v[202:203], v[178:179] op_sel_hi:[1,0,0] neg_lo:[0,0,1] neg_hi:[0,0,1]
    v_exp_f32 v16, v16
    v_exp_f32 v144, v144
    v_exp_f32 v17, v17
    v_exp_f32 v145, v145
    v_exp_f32 v18, v18
    v_exp_f32 v146, v146
    v_exp_f32 v19, v19
    v_exp_f32 v147, v147
    v_exp_f32 v20, v20
    v_exp_f32 v148, v148
    v_exp_f32 v21, v21
    v_exp_f32 v149, v149
    v_exp_f32 v22, v22
    v_exp_f32 v150, v150
    v_exp_f32 v23, v23
    v_exp_f32 v151, v151
    v_exp_f32 v40, v40
    v_exp_f32 v152, v152
    v_exp_f32 v41, v41
    v_exp_f32 v153, v153
    v_exp_f32 v42, v42
    v_exp_f32 v154, v154
    v_exp_f32 v43, v43
    v_exp_f32 v155, v155
    v_exp_f32 v44, v44
    v_exp_f32 v156, v156
    v_exp_f32 v45, v45
    v_exp_f32 v157, v157
    v_exp_f32 v46, v46
    v_exp_f32 v158, v158
    v_exp_f32 v47, v47
    v_exp_f32 v159, v159
    v_pk_add_f32 v[128:129], v[144:145], v[146:147]
    v_pk_add_f32 v[130:131], v[16:17], v[18:19]
    v_pk_add_f32 v[132:133], v[152:153], v[154:155]
    v_pk_add_f32 v[134:135], v[40:41], v[42:43]
    v_pk_add_f32 v[128:129], v[128:129], v[148:149]
    v_pk_add_f32 v[130:131], v[130:131], v[20:21]
    v_pk_add_f32 v[132:133], v[132:133], v[156:157]
    v_pk_add_f32 v[134:135], v[134:135], v[44:45]
    v_pk_add_f32 v[128:129], v[128:129], v[150:151]
    v_pk_add_f32 v[130:131], v[130:131], v[22:23]
    v_pk_add_f32 v[132:133], v[132:133], v[158:159]
    v_pk_add_f32 v[134:135], v[134:135], v[46:47]
    v_add_f32 v176, v128, v129
    v_add_f32 v184, v130, v131
    v_add_f32 v178, v132, v133
    v_add_f32 v186, v134, v135
    s_nop 0
    v_permlane32_swap_b32 v176, v178
    v_permlane32_swap_b32_e64 v184, v186
    v_pk_fma_f32 v[64:65], v[160:161], v[220:221], v[188:189] op_sel_hi:[1,0,0] neg_lo:[1,0,1] neg_hi:[1,0,1]
    v_pk_fma_f32 v[160:161], v[160:161], v[220:221], v[180:181] op_sel_hi:[1,0,0] neg_lo:[0,0,1] neg_hi:[0,0,1]
    v_add_f32 v176, v176, v178
    v_add_f32 v184, v184, v186
    v_pk_fma_f32 v[66:67], v[162:163], v[220:221], v[188:189] op_sel_hi:[1,0,0] neg_lo:[1,0,1] neg_hi:[1,0,1]
    v_pk_fma_f32 v[162:163], v[162:163], v[220:221], v[180:181] op_sel_hi:[1,0,0] neg_lo:[0,0,1] neg_hi:[0,0,1]
    v_permlane16_swap_b32 v176, v184
    v_add_f32 v176, v176, v184
    v_pk_fma_f32 v[68:69], v[164:165], v[220:221], v[188:189] op_sel_hi:[1,0,0] neg_lo:[1,0,1] neg_hi:[1,0,1]
    v_pk_fma_f32 v[164:165], v[164:165], v[220:221], v[180:181] op_sel_hi:[1,0,0] neg_lo:[0,0,1] neg_hi:[0,0,1]
    v_rcp_f32_e64 v176, v176
    v_pk_fma_f32 v[70:71], v[166:167], v[220:221], v[188:189] op_sel_hi:[1,0,0] neg_lo:[1,0,1] neg_hi:[1,0,1]
    v_pk_fma_f32 v[166:167], v[166:167], v[220:221], v[180:181] op_sel_hi:[1,0,0] neg_lo:[0,0,1] neg_hi:[0,0,1]
    v_mul_f32 v184, v176, v195
    v_mul_f32 v176, v176, v195
    v_pk_fma_f32 v[88:89], v[168:169], v[222:223], v[190:191] op_sel_hi:[1,0,0] neg_lo:[1,0,1] neg_hi:[1,0,1]
    v_pk_fma_f32 v[168:169], v[168:169], v[222:223], v[182:183] op_sel_hi:[1,0,0] neg_lo:[0,0,1] neg_hi:[0,0,1]
    v_permlane16_swap_b32 v176, v184
    v_mov_b32 v178, v176
    v_pk_fma_f32 v[90:91], v[170:171], v[222:223], v[190:191] op_sel_hi:[1,0,0] neg_lo:[1,0,1] neg_hi:[1,0,1]
    v_pk_fma_f32 v[170:171], v[170:171], v[222:223], v[182:183] op_sel_hi:[1,0,0] neg_lo:[0,0,1] neg_hi:[0,0,1]
    v_mov_b32_e64 v186, v184
    v_pk_fma_f32 v[92:93], v[172:173], v[222:223], v[190:191] op_sel_hi:[1,0,0] neg_lo:[1,0,1] neg_hi:[1,0,1]
    v_pk_fma_f32 v[172:173], v[172:173], v[222:223], v[182:183] op_sel_hi:[1,0,0] neg_lo:[0,0,1] neg_hi:[0,0,1]
    v_permlane32_swap_b32 v176, v178
    v_permlane32_swap_b32 v184, v186
    v_pk_fma_f32 v[94:95], v[174:175], v[222:223], v[190:191] op_sel_hi:[1,0,0] neg_lo:[1,0,1] neg_hi:[1,0,1]
    v_pk_fma_f32 v[174:175], v[174:175], v[222:223], v[182:183] op_sel_hi:[1,0,0] neg_lo:[0,0,1] neg_hi:[0,0,1]
    v_pk_mul_f32 v[144:145], v[144:145], v[176:177] op_sel_hi:[1,0]
    v_pk_mul_f32 v[146:147], v[146:147], v[176:177] op_sel_hi:[1,0]
    v_pk_mul_f32 v[148:149], v[148:149], v[176:177] op_sel_hi:[1,0]
    v_pk_mul_f32 v[150:151], v[150:151], v[176:177] op_sel_hi:[1,0]
    v_cvt_pk_bf16_f32 v144, v144, v145
    v_cvt_pk_bf16_f32 v145, v146, v147
    v_cvt_pk_bf16_f32 v146, v148, v149
    v_cvt_pk_bf16_f32 v147, v150, v151
    ds_write_b64 v4, v[144:145] offset:0
    ds_write_b64 v5, v[146:147] offset:0
    ds_write_b128 v197, v[24:27] offset:0
    v_pk_mul_f32 v[16:17], v[16:17], v[184:185] op_sel_hi:[1,0]
    v_pk_mul_f32 v[18:19], v[18:19], v[184:185] op_sel_hi:[1,0]
    v_pk_mul_f32 v[20:21], v[20:21], v[184:185] op_sel_hi:[1,0]
    v_pk_mul_f32 v[22:23], v[22:23], v[184:185] op_sel_hi:[1,0]
    v_cvt_pk_bf16_f32 v16, v16, v17
    v_cvt_pk_bf16_f32 v17, v18, v19
    v_cvt_pk_bf16_f32 v18, v20, v21
    v_cvt_pk_bf16_f32 v19, v22, v23
    ds_write_b64 v6, v[16:17] offset:0
    ds_write_b64 v7, v[18:19] offset:0
    ds_write_b128 v197, v[28:31] offset:1024
    v_pk_mul_f32 v[152:153], v[152:153], v[178:179] op_sel_hi:[1,0]
    v_pk_mul_f32 v[154:155], v[154:155], v[178:179] op_sel_hi:[1,0]
    v_pk_mul_f32 v[156:157], v[156:157], v[178:179] op_sel_hi:[1,0]
    v_pk_mul_f32 v[158:159], v[158:159], v[178:179] op_sel_hi:[1,0]
    v_cvt_pk_bf16_f32 v152, v152, v153
    v_cvt_pk_bf16_f32 v153, v154, v155
    v_cvt_pk_bf16_f32 v154, v156, v157
    v_cvt_pk_bf16_f32 v155, v158, v159
    ds_write_b64 v4, v[152:153] offset:2048
    ds_write_b64 v5, v[154:155] offset:2048
    ds_write_b128 v197, v[72:75] offset:2048
    v_pk_mul_f32 v[40:41], v[40:41], v[186:187] op_sel_hi:[1,0]
    v_pk_mul_f32 v[42:43], v[42:43], v[186:187] op_sel_hi:[1,0]
    v_pk_mul_f32 v[44:45], v[44:45], v[186:187] op_sel_hi:[1,0]
    v_pk_mul_f32 v[46:47], v[46:47], v[186:187] op_sel_hi:[1,0]
    v_cvt_pk_bf16_f32 v40, v40, v41
    v_cvt_pk_bf16_f32 v41, v42, v43
    v_cvt_pk_bf16_f32 v42, v44, v45
    v_cvt_pk_bf16_f32 v43, v46, v47
    ds_write_b64 v6, v[40:41] offset:2048
    ds_write_b64 v7, v[42:43] offset:2048
    ds_write_b128 v197, v[76:79] offset:3072
    ds_read_b64_tr_b16 v[232:233], v201 offset:0
    ds_read_b64_tr_b16 v[234:235], v201 offset:2048
    ds_read_b64_tr_b16 v[236:237], v203 offset:0
    ds_read_b64_tr_b16 v[238:239], v203 offset:2048
    v_exp_f32 v64, v64
    v_exp_f32 v160, v160
    v_exp_f32 v65, v65
    v_exp_f32 v161, v161
    v_exp_f32 v66, v66
    v_exp_f32 v162, v162
    v_exp_f32 v67, v67
    v_exp_f32 v163, v163
    v_exp_f32 v68, v68
    v_exp_f32 v164, v164
    v_exp_f32 v69, v69
    v_exp_f32 v165, v165
    v_exp_f32 v70, v70
    v_exp_f32 v166, v166
    v_exp_f32 v71, v71
    v_exp_f32 v167, v167
    v_exp_f32 v88, v88
    v_exp_f32 v168, v168
    v_exp_f32 v89, v89
    v_exp_f32 v169, v169
    v_exp_f32 v90, v90
    v_exp_f32 v170, v170
    v_exp_f32 v91, v91
    v_exp_f32 v171, v171
    v_exp_f32 v92, v92
    v_exp_f32 v172, v172
    v_exp_f32 v93, v93
    v_exp_f32 v173, v173
    v_exp_f32 v94, v94
    v_exp_f32 v174, v174
    v_exp_f32 v95, v95
    v_exp_f32 v175, v175
    s_mov_b64 exec, 1
    buffer_store_dword v251, v199, s[48:51], s76 offen sc1
    s_mov_b64 exec, -1
    v_pk_add_f32 v[136:137], v[160:161], v[162:163]
    v_pk_add_f32 v[138:139], v[64:65], v[66:67]
    v_pk_add_f32 v[140:141], v[168:169], v[170:171]
    v_pk_add_f32 v[142:143], v[88:89], v[90:91]
    v_pk_add_f32 v[136:137], v[136:137], v[164:165]
    v_pk_add_f32 v[138:139], v[138:139], v[68:69]
    v_pk_add_f32 v[140:141], v[140:141], v[172:173]
    v_pk_add_f32 v[142:143], v[142:143], v[92:93]
    v_pk_add_f32 v[136:137], v[136:137], v[166:167]
    v_pk_add_f32 v[138:139], v[138:139], v[70:71]
    v_pk_add_f32 v[140:141], v[140:141], v[174:175]
    v_pk_add_f32 v[142:143], v[142:143], v[94:95]
    v_add_f32 v180, v136, v137
    v_add_f32 v188, v138, v139
    v_add_f32 v182, v140, v141
    v_add_f32 v190, v142, v143
    s_nop 0
    v_permlane32_swap_b32 v180, v182
    v_permlane32_swap_b32 v188, v190
    s_waitcnt lgkmcnt(0)
    s_nop 0
    v_mfma_f32_16x16x32_bf16 v[144:147], v[232:235], v[24:27], 0
    v_add_f32 v180, v180, v182
    v_add_f32 v188, v188, v190
    v_mfma_f32_16x16x32_bf16 v[148:151], v[236:239], v[24:27], 0
    s_nop 0
    v_permlane16_swap_b32 v180, v188
    v_add_f32 v180, v180, v188
    v_mfma_f32_16x16x32_bf16 v[152:155], v[232:235], v[28:31], 0
    v_rcp_f32_e64 v180, v180
    v_mfma_f32_16x16x32_bf16 v[156:159], v[236:239], v[28:31], 0
    v_mul_f32 v188, v180, v223
    v_mul_f32 v180, v180, v223
    v_mfma_f32_16x16x32_bf16 v[16:19], v[232:235], v[120:123], 0
    s_nop 0
    v_permlane16_swap_b32 v180, v188
    v_mov_b32_e64 v182, v180
    v_mfma_f32_16x16x32_bf16 v[20:23], v[236:239], v[120:123], 0
    v_mov_b32_e64 v190, v188
    v_permlane32_swap_b32 v180, v182
    s_nop 0
    v_permlane32_swap_b32_e64 v188, v190
    v_pk_mul_f32 v[160:161], v[160:161], v[180:181] op_sel_hi:[1,0]
    v_pk_mul_f32 v[162:163], v[162:163], v[180:181] op_sel_hi:[1,0]
    v_pk_mul_f32 v[164:165], v[164:165], v[180:181] op_sel_hi:[1,0]
    v_pk_mul_f32 v[166:167], v[166:167], v[180:181] op_sel_hi:[1,0]
    v_cvt_pk_bf16_f32 v160, v160, v161
    v_cvt_pk_bf16_f32 v161, v162, v163
    v_cvt_pk_bf16_f32 v162, v164, v165
    v_cvt_pk_bf16_f32 v163, v166, v167
    ds_write_b64 v4, v[160:161] offset:4096
    ds_write_b64 v5, v[162:163] offset:4096
    v_pk_mul_f32 v[64:65], v[64:65], v[188:189] op_sel_hi:[1,0]
    v_pk_mul_f32 v[66:67], v[66:67], v[188:189] op_sel_hi:[1,0]
    v_pk_mul_f32 v[68:69], v[68:69], v[188:189] op_sel_hi:[1,0]
    v_pk_mul_f32 v[70:71], v[70:71], v[188:189] op_sel_hi:[1,0]
    v_cvt_pk_bf16_f32 v64, v64, v65
    v_cvt_pk_bf16_f32 v65, v66, v67
    v_cvt_pk_bf16_f32 v66, v68, v69
    v_cvt_pk_bf16_f32 v67, v70, v71
    ds_write_b64 v6, v[64:65] offset:4096
    ds_write_b64 v7, v[66:67] offset:4096
    v_pk_mul_f32 v[168:169], v[168:169], v[182:183] op_sel_hi:[1,0]
    v_pk_mul_f32 v[170:171], v[170:171], v[182:183] op_sel_hi:[1,0]
    v_pk_mul_f32 v[172:173], v[172:173], v[182:183] op_sel_hi:[1,0]
    v_pk_mul_f32 v[174:175], v[174:175], v[182:183] op_sel_hi:[1,0]
    v_cvt_pk_bf16_f32 v168, v168, v169
    v_cvt_pk_bf16_f32 v169, v170, v171
    v_cvt_pk_bf16_f32 v170, v172, v173
    v_cvt_pk_bf16_f32 v171, v174, v175
    ds_write_b64 v4, v[168:169] offset:6144
    ds_write_b64 v5, v[170:171] offset:6144
    v_pk_mul_f32 v[88:89], v[88:89], v[190:191] op_sel_hi:[1,0]
    v_pk_mul_f32 v[90:91], v[90:91], v[190:191] op_sel_hi:[1,0]
    v_pk_mul_f32 v[92:93], v[92:93], v[190:191] op_sel_hi:[1,0]
    v_pk_mul_f32 v[94:95], v[94:95], v[190:191] op_sel_hi:[1,0]
    v_cvt_pk_bf16_f32 v88, v88, v89
    v_cvt_pk_bf16_f32 v89, v90, v91
    v_cvt_pk_bf16_f32 v90, v92, v93
    v_cvt_pk_bf16_f32 v91, v94, v95
    ds_write_b64 v6, v[88:89] offset:6144
    ds_write_b64 v7, v[90:91] offset:6144
    ds_read_b64_tr_b16 v[240:241], v201 offset:4096
    ds_read_b64_tr_b16 v[242:243], v201 offset:6144
    ds_read_b64_tr_b16 v[244:245], v203 offset:4096
    ds_read_b64_tr_b16 v[246:247], v203 offset:6144
    v_xor_b32 v201, 0x2000, v201
    v_xor_b32 v203, 0x2000, v203
    v_xor_b32 v197, 0x1000, v197
    s_waitcnt lgkmcnt(4)
    s_barrier
    ds_read_b64_tr_b16 v[128:129], v201 offset:0
    ds_read_b64_tr_b16 v[130:131], v201 offset:2048
    ds_read_b64_tr_b16 v[132:133], v203 offset:0
    ds_read_b64_tr_b16 v[134:135], v203 offset:2048
    ds_read_b128 v[48:51], v197 offset:0
    ds_read_b128 v[52:55], v197 offset:1024
    ds_read_b64_tr_b16 v[136:137], v201 offset:4096
    ds_read_b64_tr_b16 v[138:139], v201 offset:6144
    ds_read_b64_tr_b16 v[140:141], v203 offset:4096
    ds_read_b64_tr_b16 v[142:143], v203 offset:6144
    ds_read_b128 v[96:99], v197 offset:2048
    ds_read_b128 v[100:103], v197 offset:3072
    s_waitcnt lgkmcnt(12)
    s_nop 0
    v_mfma_f32_16x16x32_bf16 v[144:147], v[240:243], v[72:75], v[144:147]
    v_mfma_f32_16x16x32_bf16 v[148:151], v[244:247], v[72:75], v[148:151]
    v_mfma_f32_16x16x32_bf16 v[152:155], v[240:243], v[76:79], v[152:155]
    v_mfma_f32_16x16x32_bf16 v[156:159], v[244:247], v[76:79], v[156:159]
    v_mfma_f32_16x16x32_bf16 v[16:19], v[240:243], v[124:127], v[16:19]
    v_mfma_f32_16x16x32_bf16 v[20:23], v[244:247], v[124:127], v[20:23]
    s_waitcnt lgkmcnt(6)
    s_nop 0
    v_mfma_f32_16x16x32_bf16 v[144:147], v[128:131], v[48:51], v[144:147]
    v_mfma_f32_16x16x32_bf16 v[148:151], v[132:135], v[48:51], v[148:151]
    v_mfma_f32_16x16x32_bf16 v[152:155], v[128:131], v[52:55], v[152:155]
    v_mfma_f32_16x16x32_bf16 v[156:159], v[132:135], v[52:55], v[156:159]
    v_mfma_f32_16x16x32_bf16 v[16:19], v[128:131], v[104:107], v[16:19]
    v_mfma_f32_16x16x32_bf16 v[20:23], v[132:135], v[104:107], v[20:23]
    s_waitcnt lgkmcnt(0)
    s_nop 0
    v_mfma_f32_16x16x32_bf16 v[144:147], v[136:139], v[96:99], v[144:147]
    v_mfma_f32_16x16x32_bf16 v[148:151], v[140:143], v[96:99], v[148:151]
    v_mfma_f32_16x16x32_bf16 v[152:155], v[136:139], v[100:103], v[152:155]
    v_mfma_f32_16x16x32_bf16 v[156:159], v[140:143], v[100:103], v[156:159]
    v_mfma_f32_16x16x32_bf16 v[16:19], v[136:139], v[108:111], v[16:19]
    v_mfma_f32_16x16x32_bf16 v[20:23], v[140:143], v[108:111], v[20:23]
    ds_read_b64_tr_b16 v[224:225], v252 offset:8192
    ds_read_b64_tr_b16 v[226:227], v252 offset:9216
    ds_read_b64_tr_b16 v[228:229], v252 offset:8224
    ds_read_b64_tr_b16 v[230:231], v252 offset:9248
    s_xor_b32 s67, s67, 8
    s_lshl_b32 s3, s38, 2
    s_add_u32 s3, s3, 162112
    v_mov_b32 v4, s3
    v_mov_b32 v5, 1
    v_cvt_pk_bf16_f32 v144, v144, v145
    v_cvt_pk_bf16_f32 v145, v146, v147
    v_cvt_pk_bf16_f32 v146, v148, v149
    v_cvt_pk_bf16_f32 v147, v150, v151
    buffer_store_dwordx4 v[144:147], v199, s[48:51], s74 offen offset:0 sc1
    v_cvt_pk_bf16_f32 v152, v152, v153
    v_cvt_pk_bf16_f32 v153, v154, v155
    v_cvt_pk_bf16_f32 v154, v156, v157
    v_cvt_pk_bf16_f32 v155, v158, v159
    buffer_store_dwordx4 v[152:155], v199, s[48:51], s74 offen offset:1024 sc1
    v_cvt_pk_bf16_f32 v16, v16, v17
    v_cvt_pk_bf16_f32 v17, v18, v19
    v_cvt_pk_bf16_f32 v18, v20, v21
    v_cvt_pk_bf16_f32 v19, v22, v23
    s_mov_b32 exec_lo, 0x00010001
    s_mov_b32 exec_hi, 0x00010001
    buffer_store_dwordx4 v[16:19], v1, s[48:51], s75 offen sc1
    s_mov_b64 exec, -1
    ds_write_b32 v4, v5
    s_setprio 0
    v_pk_fma_f32 v[8:9], v[192:193], v[212:213], v[8:9] op_sel_hi:[0,1,1] neg_lo:[1,0,0] neg_hi:[1,0,0]
    v_pk_fma_f32 v[10:11], v[192:193], v[214:215], v[10:11] op_sel_hi:[0,1,1] neg_lo:[1,0,0] neg_hi:[1,0,0]
    v_pk_fma_f32 v[12:13], v[192:193], v[216:217], v[12:13] op_sel_hi:[0,1,1] neg_lo:[1,0,0] neg_hi:[1,0,0]
    v_pk_fma_f32 v[14:15], v[192:193], v[218:219], v[14:15] op_sel_hi:[0,1,1] neg_lo:[1,0,0] neg_hi:[1,0,0]
    v_cvt_pk_bf16_f32 v232, v8, v9
    v_cvt_pk_bf16_f32 v233, v10, v11
    v_cvt_pk_bf16_f32 v234, v12, v13
    v_cvt_pk_bf16_f32 v235, v14, v15
    v_pk_fma_f32 v[32:33], v[194:195], v[212:213], v[32:33] op_sel_hi:[0,1,1] neg_lo:[1,0,0] neg_hi:[1,0,0]
    v_pk_fma_f32 v[34:35], v[194:195], v[214:215], v[34:35] op_sel_hi:[0,1,1] neg_lo:[1,0,0] neg_hi:[1,0,0]
    v_pk_fma_f32 v[36:37], v[194:195], v[216:217], v[36:37] op_sel_hi:[0,1,1] neg_lo:[1,0,0] neg_hi:[1,0,0]
    v_pk_fma_f32 v[38:39], v[194:195], v[218:219], v[38:39] op_sel_hi:[0,1,1] neg_lo:[1,0,0] neg_hi:[1,0,0]
    v_cvt_pk_bf16_f32 v236, v32, v33
    v_cvt_pk_bf16_f32 v237, v34, v35
    v_cvt_pk_bf16_f32 v238, v36, v37
    v_cvt_pk_bf16_f32 v239, v38, v39
    v_pk_fma_f32 v[56:57], v[196:197], v[212:213], v[56:57] op_sel_hi:[0,1,1] neg_lo:[1,0,0] neg_hi:[1,0,0]
    v_pk_fma_f32 v[58:59], v[196:197], v[214:215], v[58:59] op_sel_hi:[0,1,1] neg_lo:[1,0,0] neg_hi:[1,0,0]
    v_pk_fma_f32 v[60:61], v[196:197], v[216:217], v[60:61] op_sel_hi:[0,1,1] neg_lo:[1,0,0] neg_hi:[1,0,0]
    v_pk_fma_f32 v[62:63], v[196:197], v[218:219], v[62:63] op_sel_hi:[0,1,1] neg_lo:[1,0,0] neg_hi:[1,0,0]
    v_cvt_pk_bf16_f32 v240, v56, v57
    v_cvt_pk_bf16_f32 v241, v58, v59
    v_cvt_pk_bf16_f32 v242, v60, v61
    v_cvt_pk_bf16_f32 v243, v62, v63
    v_pk_fma_f32 v[80:81], v[198:199], v[212:213], v[80:81] op_sel_hi:[0,1,1] neg_lo:[1,0,0] neg_hi:[1,0,0]
    v_pk_fma_f32 v[82:83], v[198:199], v[214:215], v[82:83] op_sel_hi:[0,1,1] neg_lo:[1,0,0] neg_hi:[1,0,0]
    v_pk_fma_f32 v[84:85], v[198:199], v[216:217], v[84:85] op_sel_hi:[0,1,1] neg_lo:[1,0,0] neg_hi:[1,0,0]
    v_pk_fma_f32 v[86:87], v[198:199], v[218:219], v[86:87] op_sel_hi:[0,1,1] neg_lo:[1,0,0] neg_hi:[1,0,0]
    v_cvt_pk_bf16_f32 v244, v80, v81
    v_cvt_pk_bf16_f32 v245, v82, v83
    v_cvt_pk_bf16_f32 v246, v84, v85
    v_cvt_pk_bf16_f32 v247, v86, v87
    s_waitcnt lgkmcnt(1)
    s_nop 0
    v_mfma_f32_16x16x32_bf16 v[144:147], v[224:227], v[232:235], 0
    v_mfma_f32_16x16x32_bf16 v[148:151], v[228:231], v[232:235], 0
    v_mfma_f32_16x16x32_bf16 v[152:155], v[224:227], v[236:239], 0
    v_mfma_f32_16x16x32_bf16 v[156:159], v[228:231], v[236:239], 0
    v_mfma_f32_16x16x32_bf16 v[160:163], v[224:227], v[240:243], 0
    v_mfma_f32_16x16x32_bf16 v[164:167], v[228:231], v[240:243], 0
    v_mfma_f32_16x16x32_bf16 v[168:171], v[224:227], v[244:247], 0
    v_mfma_f32_16x16x32_bf16 v[172:175], v[228:231], v[244:247], 0
    s_nop 0
    s_nop 0
    v_max3_f32 v176, v144, v145, v146
    v_max3_f32 v184, -v144, -v145, -v146
    v_max3_f32 v178, v152, v153, v154
    v_max3_f32 v186, -v152, -v153, -v154
    v_max3_f32 v176, v176, v147, v148
    v_max3_f32 v184, v184, -v147, -v148
    v_max3_f32 v178, v178, v155, v156
    v_max3_f32 v186, v186, -v155, -v156
    v_max3_f32 v176, v176, v149, v150
    v_max3_f32 v184, v184, -v149, -v150
    v_max3_f32 v178, v178, v157, v158
    v_max3_f32 v186, v186, -v157, -v158
    v_max_f32_e64 v176, v176, v151
    v_max_f32_e64 v184, v184, -v151
    v_max_f32_e64 v178, v178, v159
    v_max_f32_e64 v186, v186, -v159
    s_nop 0
    v_permlane32_swap_b32 v176, v178
    v_permlane32_swap_b32_e64 v184, v186
    v_max3_f32 v180, v160, v161, v162
    v_max3_f32 v188, -v160, -v161, -v162
    v_max_f32 v176, v176, v178
    v_max_f32 v184, v184, v186
    v_max3_f32 v182, v168, v169, v170
    v_max3_f32 v190, -v168, -v169, -v170
    v_permlane16_swap_b32 v176, v184
    v_max_f32 v176, v176, v184
    v_max3_f32 v180, v180, v163, v164
    v_max3_f32 v188, v188, -v163, -v164
    v_mul_f32 v184, v176, v193
    v_mul_f32 v176, v176, v193
    v_max3_f32 v182, v182, v171, v172
    v_max3_f32 v190, v190, -v171, -v172
    v_permlane16_swap_b32 v176, v184
    v_mov_b32 v178, v176
    v_max3_f32 v180, v180, v165, v166
    v_max3_f32 v188, v188, -v165, -v166
    v_mov_b32_e64 v186, v184
    v_max3_f32 v182, v182, v173, v174
    v_max3_f32 v190, v190, -v173, -v174
    v_permlane32_swap_b32 v176, v178
    v_permlane32_swap_b32 v184, v186
    v_max_f32_e64 v180, v180, v167
    v_max_f32_e64 v188, v188, -v167
    v_max_f32_e64 v182, v182, v175
    v_max_f32_e64 v190, v190, -v175
    s_nop 0
    v_permlane32_swap_b32 v180, v182
    v_permlane32_swap_b32_e64 v188, v190
    v_pk_fma_f32 v[8:9], v[144:145], v[200:201], v[184:185] op_sel_hi:[1,0,0] neg_lo:[1,0,1] neg_hi:[1,0,1]
    v_pk_fma_f32 v[144:145], v[144:145], v[200:201], v[176:177] op_sel_hi:[1,0,0] neg_lo:[0,0,1] neg_hi:[0,0,1]
    v_max_f32 v180, v180, v182
    v_max_f32 v188, v188, v190
    v_pk_fma_f32 v[10:11], v[146:147], v[200:201], v[184:185] op_sel_hi:[1,0,0] neg_lo:[1,0,1] neg_hi:[1,0,1]
    v_pk_fma_f32 v[146:147], v[146:147], v[200:201], v[176:177] op_sel_hi:[1,0,0] neg_lo:[0,0,1] neg_hi:[0,0,1]
    v_permlane16_swap_b32 v180, v188
    v_max_f32 v180, v180, v188
    v_pk_fma_f32 v[12:13], v[148:149], v[200:201], v[184:185] op_sel_hi:[1,0,0] neg_lo:[1,0,1] neg_hi:[1,0,1]
    v_pk_fma_f32 v[148:149], v[148:149], v[200:201], v[176:177] op_sel_hi:[1,0,0] neg_lo:[0,0,1] neg_hi:[0,0,1]
    v_mul_f32 v188, v180, v221
    v_mul_f32 v180, v180, v221
    v_pk_fma_f32 v[14:15], v[150:151], v[200:201], v[184:185] op_sel_hi:[1,0,0] neg_lo:[1,0,1] neg_hi:[1,0,1]
    v_pk_fma_f32 v[150:151], v[150:151], v[200:201], v[176:177] op_sel_hi:[1,0,0] neg_lo:[0,0,1] neg_hi:[0,0,1]
    v_permlane16_swap_b32 v180, v188
    v_mov_b32 v182, v180
    v_pk_fma_f32 v[32:33], v[152:153], v[202:203], v[186:187] op_sel_hi:[1,0,0] neg_lo:[1,0,1] neg_hi:[1,0,1]
    v_pk_fma_f32 v[152:153], v[152:153], v[202:203], v[178:179] op_sel_hi:[1,0,0] neg_lo:[0,0,1] neg_hi:[0,0,1]
    v_mov_b32_e64 v190, v188
    v_pk_fma_f32 v[34:35], v[154:155], v[202:203], v[186:187] op_sel_hi:[1,0,0] neg_lo:[1,0,1] neg_hi:[1,0,1]
    v_pk_fma_f32 v[154:155], v[154:155], v[202:203], v[178:179] op_sel_hi:[1,0,0] neg_lo:[0,0,1] neg_hi:[0,0,1]
    v_permlane32_swap_b32 v180, v182
    v_permlane32_swap_b32 v188, v190
    v_pk_fma_f32 v[36:37], v[156:157], v[202:203], v[186:187] op_sel_hi:[1,0,0] neg_lo:[1,0,1] neg_hi:[1,0,1]
    v_pk_fma_f32 v[156:157], v[156:157], v[202:203], v[178:179] op_sel_hi:[1,0,0] neg_lo:[0,0,1] neg_hi:[0,0,1]
    v_pk_fma_f32 v[38:39], v[158:159], v[202:203], v[186:187] op_sel_hi:[1,0,0] neg_lo:[1,0,1] neg_hi:[1,0,1]
    v_pk_fma_f32 v[158:159], v[158:159], v[202:203], v[178:179] op_sel_hi:[1,0,0] neg_lo:[0,0,1] neg_hi:[0,0,1]
    v_exp_f32 v8, v8
    v_exp_f32 v144, v144
    v_exp_f32 v9, v9
    v_exp_f32 v145, v145
    v_exp_f32 v10, v10
    v_exp_f32 v146, v146
    v_exp_f32 v11, v11
    v_exp_f32 v147, v147
    v_exp_f32 v12, v12
    v_exp_f32 v148, v148
    v_exp_f32 v13, v13
    v_exp_f32 v149, v149
    v_exp_f32 v14, v14
    v_exp_f32 v150, v150
    v_exp_f32 v15, v15
    v_exp_f32 v151, v151
    v_exp_f32 v32, v32
    v_exp_f32 v152, v152
    v_exp_f32 v33, v33
    v_exp_f32 v153, v153
    v_exp_f32 v34, v34
    v_exp_f32 v154, v154
    v_exp_f32 v35, v35
    v_exp_f32 v155, v155
    v_exp_f32 v36, v36
    v_exp_f32 v156, v156
    v_exp_f32 v37, v37
    v_exp_f32 v157, v157
    v_exp_f32 v38, v38
    v_exp_f32 v158, v158
    v_exp_f32 v39, v39
    v_exp_f32 v159, v159
    v_pk_add_f32 v[128:129], v[144:145], v[146:147]
    v_pk_add_f32 v[130:131], v[8:9], v[10:11]
    v_pk_add_f32 v[132:133], v[152:153], v[154:155]
    v_pk_add_f32 v[134:135], v[32:33], v[34:35]
    v_pk_add_f32 v[128:129], v[128:129], v[148:149]
    v_pk_add_f32 v[130:131], v[130:131], v[12:13]
    v_pk_add_f32 v[132:133], v[132:133], v[156:157]
    v_pk_add_f32 v[134:135], v[134:135], v[36:37]
    v_pk_add_f32 v[128:129], v[128:129], v[150:151]
    v_pk_add_f32 v[130:131], v[130:131], v[14:15]
    v_pk_add_f32 v[132:133], v[132:133], v[158:159]
    v_pk_add_f32 v[134:135], v[134:135], v[38:39]
    v_add_f32 v176, v128, v129
    v_add_f32 v184, v130, v131
    v_add_f32 v178, v132, v133
    v_add_f32 v186, v134, v135
    s_nop 0
    v_permlane32_swap_b32 v176, v178
    v_permlane32_swap_b32_e64 v184, v186
    v_pk_fma_f32 v[56:57], v[160:161], v[220:221], v[188:189] op_sel_hi:[1,0,0] neg_lo:[1,0,1] neg_hi:[1,0,1]
    v_pk_fma_f32 v[160:161], v[160:161], v[220:221], v[180:181] op_sel_hi:[1,0,0] neg_lo:[0,0,1] neg_hi:[0,0,1]
    v_add_f32 v176, v176, v178
    v_add_f32 v184, v184, v186
    v_pk_fma_f32 v[58:59], v[162:163], v[220:221], v[188:189] op_sel_hi:[1,0,0] neg_lo:[1,0,1] neg_hi:[1,0,1]
    v_pk_fma_f32 v[162:163], v[162:163], v[220:221], v[180:181] op_sel_hi:[1,0,0] neg_lo:[0,0,1] neg_hi:[0,0,1]
    v_permlane16_swap_b32 v176, v184
    v_add_f32 v176, v176, v184
    v_pk_fma_f32 v[60:61], v[164:165], v[220:221], v[188:189] op_sel_hi:[1,0,0] neg_lo:[1,0,1] neg_hi:[1,0,1]
    v_pk_fma_f32 v[164:165], v[164:165], v[220:221], v[180:181] op_sel_hi:[1,0,0] neg_lo:[0,0,1] neg_hi:[0,0,1]
    v_rcp_f32_e64 v176, v176
    v_pk_fma_f32 v[62:63], v[166:167], v[220:221], v[188:189] op_sel_hi:[1,0,0] neg_lo:[1,0,1] neg_hi:[1,0,1]
    v_pk_fma_f32 v[166:167], v[166:167], v[220:221], v[180:181] op_sel_hi:[1,0,0] neg_lo:[0,0,1] neg_hi:[0,0,1]
    v_mov_b32_e64 v184, v176
    v_pk_fma_f32 v[80:81], v[168:169], v[222:223], v[190:191] op_sel_hi:[1,0,0] neg_lo:[1,0,1] neg_hi:[1,0,1]
    v_pk_fma_f32 v[168:169], v[168:169], v[222:223], v[182:183] op_sel_hi:[1,0,0] neg_lo:[0,0,1] neg_hi:[0,0,1]
    v_permlane16_swap_b32 v176, v184
    v_mov_b32 v178, v176
    v_pk_fma_f32 v[82:83], v[170:171], v[222:223], v[190:191] op_sel_hi:[1,0,0] neg_lo:[1,0,1] neg_hi:[1,0,1]
    v_pk_fma_f32 v[170:171], v[170:171], v[222:223], v[182:183] op_sel_hi:[1,0,0] neg_lo:[0,0,1] neg_hi:[0,0,1]
    v_mov_b32_e64 v186, v184
    v_pk_fma_f32 v[84:85], v[172:173], v[222:223], v[190:191] op_sel_hi:[1,0,0] neg_lo:[1,0,1] neg_hi:[1,0,1]
    v_pk_fma_f32 v[172:173], v[172:173], v[222:223], v[182:183] op_sel_hi:[1,0,0] neg_lo:[0,0,1] neg_hi:[0,0,1]
    v_permlane32_swap_b32 v176, v178
    v_permlane32_swap_b32 v184, v186
    v_pk_fma_f32 v[86:87], v[174:175], v[222:223], v[190:191] op_sel_hi:[1,0,0] neg_lo:[1,0,1] neg_hi:[1,0,1]
    v_pk_fma_f32 v[174:175], v[174:175], v[222:223], v[182:183] op_sel_hi:[1,0,0] neg_lo:[0,0,1] neg_hi:[0,0,1]
    v_pk_mul_f32 v[144:145], v[144:145], v[176:177] op_sel_hi:[1,0]
    v_pk_mul_f32 v[146:147], v[146:147], v[176:177] op_sel_hi:[1,0]
    v_pk_mul_f32 v[148:149], v[148:149], v[176:177] op_sel_hi:[1,0]
    v_pk_mul_f32 v[150:151], v[150:151], v[176:177] op_sel_hi:[1,0]
    v_cvt_pk_bf16_f32 v144, v144, v145
    v_cvt_pk_bf16_f32 v145, v146, v147
    v_cvt_pk_bf16_f32 v146, v148, v149
    v_cvt_pk_bf16_f32 v147, v150, v151
    v_pk_mul_f32 v[8:9], v[8:9], v[184:185] op_sel_hi:[1,0]
    v_pk_mul_f32 v[10:11], v[10:11], v[184:185] op_sel_hi:[1,0]
    v_pk_mul_f32 v[12:13], v[12:13], v[184:185] op_sel_hi:[1,0]
    v_pk_mul_f32 v[14:15], v[14:15], v[184:185] op_sel_hi:[1,0]
    v_cvt_pk_bf16_f32 v8, v8, v9
    v_cvt_pk_bf16_f32 v9, v10, v11
    v_cvt_pk_bf16_f32 v10, v12, v13
    v_cvt_pk_bf16_f32 v11, v14, v15
    v_pk_mul_f32 v[152:153], v[152:153], v[178:179] op_sel_hi:[1,0]
    v_pk_mul_f32 v[154:155], v[154:155], v[178:179] op_sel_hi:[1,0]
    v_pk_mul_f32 v[156:157], v[156:157], v[178:179] op_sel_hi:[1,0]
    v_pk_mul_f32 v[158:159], v[158:159], v[178:179] op_sel_hi:[1,0]
    v_cvt_pk_bf16_f32 v152, v152, v153
    v_cvt_pk_bf16_f32 v153, v154, v155
    v_cvt_pk_bf16_f32 v154, v156, v157
    v_cvt_pk_bf16_f32 v155, v158, v159
    v_pk_mul_f32 v[32:33], v[32:33], v[186:187] op_sel_hi:[1,0]
    v_pk_mul_f32 v[34:35], v[34:35], v[186:187] op_sel_hi:[1,0]
    v_pk_mul_f32 v[36:37], v[36:37], v[186:187] op_sel_hi:[1,0]
    v_pk_mul_f32 v[38:39], v[38:39], v[186:187] op_sel_hi:[1,0]
    v_cvt_pk_bf16_f32 v32, v32, v33
    v_cvt_pk_bf16_f32 v33, v34, v35
    v_cvt_pk_bf16_f32 v34, v36, v37
    v_cvt_pk_bf16_f32 v35, v38, v39
    v_exp_f32 v56, v56
    v_exp_f32 v160, v160
    v_exp_f32 v57, v57
    v_exp_f32 v161, v161
    v_exp_f32 v58, v58
    v_exp_f32 v162, v162
    v_exp_f32 v59, v59
    v_exp_f32 v163, v163
    v_exp_f32 v60, v60
    v_exp_f32 v164, v164
    v_exp_f32 v61, v61
    v_exp_f32 v165, v165
    v_exp_f32 v62, v62
    v_exp_f32 v166, v166
    v_exp_f32 v63, v63
    v_exp_f32 v167, v167
    v_exp_f32 v80, v80
    v_exp_f32 v168, v168
    v_exp_f32 v81, v81
    v_exp_f32 v169, v169
    v_exp_f32 v82, v82
    v_exp_f32 v170, v170
    v_exp_f32 v83, v83
    v_exp_f32 v171, v171
    v_exp_f32 v84, v84
    v_exp_f32 v172, v172
    v_exp_f32 v85, v85
    v_exp_f32 v173, v173
    v_exp_f32 v86, v86
    v_exp_f32 v174, v174
    v_exp_f32 v87, v87
    v_exp_f32 v175, v175
    v_pk_add_f32 v[136:137], v[160:161], v[162:163]
    v_pk_add_f32 v[138:139], v[56:57], v[58:59]
    v_pk_add_f32 v[140:141], v[168:169], v[170:171]
    v_pk_add_f32 v[142:143], v[80:81], v[82:83]
    v_pk_add_f32 v[136:137], v[136:137], v[164:165]
    v_pk_add_f32 v[138:139], v[138:139], v[60:61]
    v_pk_add_f32 v[140:141], v[140:141], v[172:173]
    v_pk_add_f32 v[142:143], v[142:143], v[84:85]
    v_pk_add_f32 v[136:137], v[136:137], v[166:167]
    v_pk_add_f32 v[138:139], v[138:139], v[62:63]
    v_pk_add_f32 v[140:141], v[140:141], v[174:175]
    v_pk_add_f32 v[142:143], v[142:143], v[86:87]
    v_add_f32 v180, v136, v137
    v_add_f32 v188, v138, v139
    v_add_f32 v182, v140, v141
    v_add_f32 v190, v142, v143
    s_nop 0
    v_permlane32_swap_b32 v180, v182
    v_permlane32_swap_b32 v188, v190
    v_add_f32 v180, v180, v182
    v_add_f32 v188, v188, v190
    s_nop 1
    v_permlane16_swap_b32 v180, v188
    v_add_f32 v180, v180, v188
    v_rcp_f32_e64 v180, v180
    s_nop 0
    v_mov_b32_e64 v188, v180
    s_nop 1
    v_permlane16_swap_b32 v180, v188
    v_mov_b32 v182, v180
    v_mov_b32_e64 v190, v188
    s_nop 0
    v_permlane32_swap_b32 v180, v182
    v_permlane32_swap_b32_e64 v188, v190
    v_pk_mul_f32 v[160:161], v[160:161], v[180:181] op_sel_hi:[1,0]
    v_pk_mul_f32 v[162:163], v[162:163], v[180:181] op_sel_hi:[1,0]
    v_pk_mul_f32 v[164:165], v[164:165], v[180:181] op_sel_hi:[1,0]
    v_pk_mul_f32 v[166:167], v[166:167], v[180:181] op_sel_hi:[1,0]
    v_cvt_pk_bf16_f32 v160, v160, v161
    v_cvt_pk_bf16_f32 v161, v162, v163
    v_cvt_pk_bf16_f32 v162, v164, v165
    v_cvt_pk_bf16_f32 v163, v166, v167
    v_pk_mul_f32 v[56:57], v[56:57], v[188:189] op_sel_hi:[1,0]
    v_pk_mul_f32 v[58:59], v[58:59], v[188:189] op_sel_hi:[1,0]
    v_pk_mul_f32 v[60:61], v[60:61], v[188:189] op_sel_hi:[1,0]
    v_pk_mul_f32 v[62:63], v[62:63], v[188:189] op_sel_hi:[1,0]
    v_cvt_pk_bf16_f32 v56, v56, v57
    v_cvt_pk_bf16_f32 v57, v58, v59
    v_cvt_pk_bf16_f32 v58, v60, v61
    v_cvt_pk_bf16_f32 v59, v62, v63
    v_pk_mul_f32 v[168:169], v[168:169], v[182:183] op_sel_hi:[1,0]
    v_pk_mul_f32 v[170:171], v[170:171], v[182:183] op_sel_hi:[1,0]
    v_pk_mul_f32 v[172:173], v[172:173], v[182:183] op_sel_hi:[1,0]
    v_pk_mul_f32 v[174:175], v[174:175], v[182:183] op_sel_hi:[1,0]
    v_cvt_pk_bf16_f32 v168, v168, v169
    v_cvt_pk_bf16_f32 v169, v170, v171
    v_cvt_pk_bf16_f32 v170, v172, v173
    v_cvt_pk_bf16_f32 v171, v174, v175
    v_pk_mul_f32 v[80:81], v[80:81], v[190:191] op_sel_hi:[1,0]
    v_pk_mul_f32 v[82:83], v[82:83], v[190:191] op_sel_hi:[1,0]
    v_pk_mul_f32 v[84:85], v[84:85], v[190:191] op_sel_hi:[1,0]
    v_pk_mul_f32 v[86:87], v[86:87], v[190:191] op_sel_hi:[1,0]
    v_cvt_pk_bf16_f32 v80, v80, v81
    v_cvt_pk_bf16_f32 v81, v82, v83
    v_cvt_pk_bf16_f32 v82, v84, v85
    v_cvt_pk_bf16_f32 v83, v86, v87
    s_lshl_b32 s3, s38, 1
    s_lshr_b32 s28, s39, 2
    s_add_u32 s3, s3, s28
    s_lshl_b32 s69, s3, 4
    s_lshl_b32 s3, s34, 7
    s_add_u32 s3, s3, s69
    v_and_b32 v2, 15, v1
    v_add_u32 v4, s3, v2
    v_lshlrev_b32 v4, 11, v4
    v_lshrrev_b32 v2, 4, v1
    v_lshl_add_u32 v4, v2, 3, v4
    s_lshl_b32 s3, s35, 7
    v_add_u32 v4, s3, v4
    buffer_load_dwordx2 v[240:241], v4, s[40:43], 0 offen offset:0
    buffer_load_dwordx2 v[242:243], v4, s[40:43], 0 offen offset:32
    buffer_load_dwordx2 v[244:245], v4, s[40:43], 0 offen offset:64
    buffer_load_dwordx2 v[246:247], v4, s[40:43], 0 offen offset:96
    v_mov_b32 v2, 162048
    ds_read_b32 v248, v2
    v_lshrrev_b32 v5, 3, v1
    v_lshlrev_b32 v6, 11, v5
    v_bfe_u32 v5, v1, 4, 2
    v_lshlrev_b32 v5, 1, v5
    v_and_b32 v7, 7, v1
    v_xor_b32 v5, v5, v7
    v_lshl_add_u32 v6, v5, 4, v6
    s_lshl_b32 s3, s35, 7
    v_add_u32 v6, s3, v6
    v_add_u32 v216, 0, v6
    v_add_u32 v217, 15360, v6
    v_add_u32 v218, 30720, v6
    v_add_u32 v219, 46080, v6
    s_lshl_b32 s72, s38, 12
    s_lshl_b32 s73, s38, 16
    v_and_b32 v2, 15, v1
    v_add_u32 v2, s69, v2
    v_lshlrev_b32_e64 v2, 2, v2
    v_add_u32 v2, 152576, v2
    ds_read_b32 v193, v2
    ds_read_b32 v192, v2 offset:1024
    s_mul_i32 s76, s67, 4224
    s_add_u32 s76, s76, 1245184
    v_lshlrev_b32 v5, 4, v1
    v_and_b32 v6, 48, v1
    v_add_u32 v6, 4096, v6
    s_lshl_b32 s3, s38, 2
    s_add_u32 s3, s3, 162112
    v_mov_b32 v3, s3
L_gw:
    ds_read_b32 v2, v3
    s_waitcnt lgkmcnt(0)
    v_readfirstlane_b32 s3, v2
    s_nop 0
    s_cmp_eq_u32 s3, 3
    s_cbranch_scc1 L_gk
    s_sleep 1
    s_branch L_gw
L_gk:
    s_sleep 6
    buffer_load_dwordx4 v[104:107], v5, s[48:51], s76 offen offset:0 sc1
    buffer_load_dwordx4 v[108:111], v5, s[48:51], s76 offen offset:1024 sc1
    buffer_load_dwordx4 v[112:115], v5, s[48:51], s76 offen offset:2048 sc1
    buffer_load_dwordx4 v[116:119], v5, s[48:51], s76 offen offset:3072 sc1
    buffer_load_dwordx4 v[120:123], v6, s[48:51], s76 offen offset:0 sc1
    buffer_load_dwordx4 v[124:127], v6, s[48:51], s76 offen offset:64 sc1
    s_waitcnt lgkmcnt(0)
    v_readfirstlane_b32 s70, v248
    s_nop 0
    s_and_b32 s68, s70, 0x7ff
    s_sub_u32 s68, 2047, s68
    s_lshl_b32 s3, s36, 3
    s_lshl_b32 s28, s64, 2
    s_add_u32 s3, s3, s28
    s_lshl_b32 s3, s3, 5
    s_add_u32 s3, s3, s67
    s_lshl_b32 s77, s3, 10
    s_add_u32 s77, s77, 4194304
    s_waitcnt vmcnt(0)
    s_mov_b32 s29, 0
L_k7:
    s_nop 0
    v_max3_u32 v2, v104, v105, v106
    v_max3_u32 v2, v2, v107, v108
    v_max3_u32 v2, v2, v109, v110
    v_max3_u32 v2, v2, v111, v112
    v_max3_u32 v2, v2, v113, v114
    v_max3_u32 v2, v2, v115, v116
    v_max3_u32 v2, v2, v117, v118
    v_max3_u32 v2, v2, v119, v120
    v_max3_u32 v2, v2, v121, v122
    v_max3_u32 v2, v2, v123, v124
    v_max3_u32 v2, v2, v125, v126
    v_max_u32 v2, v2, v127
    v_cmp_eq_u32 vcc, -1, v2
    s_cbranch_vccz L_k7k
    s_add_u32 s29, s29, 1
    s_cmp_ge_u32 s29, 200000
    s_cbranch_scc1 L_k7k
    s_sleep 1
    buffer_load_dwordx4 v[104:107], v5, s[48:51], s76 offen offset:0 sc1
    buffer_load_dwordx4 v[108:111], v5, s[48:51], s76 offen offset:1024 sc1
    buffer_load_dwordx4 v[112:115], v5, s[48:51], s76 offen offset:2048 sc1
    buffer_load_dwordx4 v[116:119], v5, s[48:51], s76 offen offset:3072 sc1
    buffer_load_dwordx4 v[120:123], v6, s[48:51], s76 offen offset:0 sc1
    buffer_load_dwordx4 v[124:127], v6, s[48:51], s76 offen offset:64 sc1
    s_waitcnt vmcnt(0)
    s_branch L_k7
L_k7k:
    s_setprio 2
    s_nop 0
    v_mfma_f32_16x16x32_bf16 v[24:27], v[120:123], v[144:147], 0
    v_mfma_f32_16x16x32_bf16 v[16:19], v[104:107], v[144:147], 0
    v_mfma_f32_16x16x32_bf16 v[20:23], v[108:111], v[144:147], 0
    v_mfma_f32_16x16x32_bf16 v[24:27], v[124:127], v[8:11], v[24:27]
    v_mfma_f32_16x16x32_bf16 v[16:19], v[112:115], v[8:11], v[16:19]
    v_mfma_f32_16x16x32_bf16 v[20:23], v[116:119], v[8:11], v[20:23]
    v_mfma_f32_16x16x32_bf16 v[48:51], v[120:123], v[152:155], 0
    v_mfma_f32_16x16x32_bf16 v[40:43], v[104:107], v[152:155], 0
    v_mfma_f32_16x16x32_bf16 v[44:47], v[108:111], v[152:155], 0
    v_mfma_f32_16x16x32_bf16 v[48:51], v[124:127], v[32:35], v[48:51]
    v_mfma_f32_16x16x32_bf16 v[40:43], v[112:115], v[32:35], v[40:43]
    v_mfma_f32_16x16x32_bf16 v[44:47], v[116:119], v[32:35], v[44:47]
    v_mfma_f32_16x16x32_bf16 v[72:75], v[120:123], v[160:163], 0
    v_mfma_f32_16x16x32_bf16 v[64:67], v[104:107], v[160:163], 0
    v_mfma_f32_16x16x32_bf16 v[68:71], v[108:111], v[160:163], 0
    v_mfma_f32_16x16x32_bf16 v[72:75], v[124:127], v[56:59], v[72:75]
    v_mfma_f32_16x16x32_bf16 v[64:67], v[112:115], v[56:59], v[64:67]
    v_mfma_f32_16x16x32_bf16 v[68:71], v[116:119], v[56:59], v[68:71]
    v_mfma_f32_16x16x32_bf16 v[96:99], v[120:123], v[168:171], 0
    v_mfma_f32_16x16x32_bf16 v[88:91], v[104:107], v[168:171], 0
    v_mfma_f32_16x16x32_bf16 v[92:95], v[108:111], v[168:171], 0
    v_mfma_f32_16x16x32_bf16 v[96:99], v[124:127], v[80:83], v[96:99]
    v_mfma_f32_16x16x32_bf16 v[88:91], v[112:115], v[80:83], v[88:91]
    v_mfma_f32_16x16x32_bf16 v[92:95], v[116:119], v[80:83], v[92:95]
    v_add_f32 v24, 0x358637bd, v24
    v_add_f32 v48, 0x358637bd, v48
    v_add_f32 v72, 0x358637bd, v72
    s_nop 2
    v_add_f32 v96, 0x358637bd, v96
    v_rcp_f32 v24, v24
    v_rcp_f32 v48, v48
    v_rcp_f32 v72, v72
    v_rcp_f32_e64 v96, v96
    v_pk_mul_f32 v[16:17], v[16:17], v[24:25] op_sel_hi:[1,0]
    v_pk_mul_f32 v[18:19], v[18:19], v[24:25] op_sel_hi:[1,0]
    v_pk_mul_f32 v[20:21], v[20:21], v[24:25] op_sel_hi:[1,0]
    v_pk_mul_f32 v[22:23], v[22:23], v[24:25] op_sel_hi:[1,0]
    v_cvt_pk_bf16_f32 v16, v16, v17
    v_cvt_pk_bf16_f32 v17, v18, v19
    v_cvt_pk_bf16_f32 v18, v20, v21
    v_cvt_pk_bf16_f32 v19, v22, v23
    buffer_store_dwordx4 v[16:19], v5, s[48:51], s77 offen sc1
    s_add_u32 s77, s77, 32768
    v_pk_mul_f32 v[40:41], v[40:41], v[48:49] op_sel_hi:[1,0]
    v_pk_mul_f32 v[42:43], v[42:43], v[48:49] op_sel_hi:[1,0]
    v_pk_mul_f32 v[44:45], v[44:45], v[48:49] op_sel_hi:[1,0]
    v_pk_mul_f32 v[46:47], v[46:47], v[48:49] op_sel_hi:[1,0]
    v_cvt_pk_bf16_f32 v40, v40, v41
    v_cvt_pk_bf16_f32 v41, v42, v43
    v_cvt_pk_bf16_f32 v42, v44, v45
    v_cvt_pk_bf16_f32 v43, v46, v47
    buffer_store_dwordx4 v[40:43], v5, s[48:51], s77 offen sc1
    s_add_u32 s77, s77, 32768
    v_pk_mul_f32 v[64:65], v[64:65], v[72:73] op_sel_hi:[1,0]
    v_pk_mul_f32 v[66:67], v[66:67], v[72:73] op_sel_hi:[1,0]
    v_pk_mul_f32 v[68:69], v[68:69], v[72:73] op_sel_hi:[1,0]
    v_pk_mul_f32 v[70:71], v[70:71], v[72:73] op_sel_hi:[1,0]
    v_cvt_pk_bf16_f32 v64, v64, v65
    v_cvt_pk_bf16_f32 v65, v66, v67
    v_cvt_pk_bf16_f32 v66, v68, v69
    v_cvt_pk_bf16_f32 v67, v70, v71
    buffer_store_dwordx4 v[64:67], v5, s[48:51], s77 offen sc1
    s_add_u32 s77, s77, 32768
    v_pk_mul_f32 v[88:89], v[88:89], v[96:97] op_sel_hi:[1,0]
    v_pk_mul_f32 v[90:91], v[90:91], v[96:97] op_sel_hi:[1,0]
    v_pk_mul_f32 v[92:93], v[92:93], v[96:97] op_sel_hi:[1,0]
    v_pk_mul_f32 v[94:95], v[94:95], v[96:97] op_sel_hi:[1,0]
    v_cvt_pk_bf16_f32 v88, v88, v89
    v_cvt_pk_bf16_f32 v89, v90, v91
    v_cvt_pk_bf16_f32 v90, v92, v93
    v_cvt_pk_bf16_f32 v91, v94, v95
    buffer_store_dwordx4 v[88:91], v5, s[48:51], s77 offen sc1
    v_mov_b32_e64 v2, 7
    ds_write_b32 v3, v2
    s_and_b32 s3, s68, 127
    s_lshl_b32 s3, s3, 2
    s_add_u32 s3, s3, 152576
    v_mov_b32 v2, s3
    ds_read_b32 v250, v2
    ds_read_b32 v251, v2 offset:1024
    s_setprio 0
    v_and_b32 v3, 3, v1
    v_lshlrev_b32_e64 v3, 2, v3
    v_add_u32 v3, 162112, v3
L_cw:
    ds_read_b32 v2, v3
    s_waitcnt lgkmcnt(0)
    v_cmp_ne_u32_e64 vcc, 7, v2
    s_cbranch_vccz L_cwk
    s_sleep 1
    s_branch L_cw
L_cwk:
    s_add_u32 m0, s72, 49152
    s_add_u32 s3, s73, 786432
    buffer_load_dwordx4 v216, s[88:91], s3 offen offset:0 lds
    buffer_load_dwordx4 v217, s[88:91], s3 offen offset:1024 lds
    buffer_load_dwordx4 v218, s[88:91], s3 offen offset:2048 lds
    buffer_load_dwordx4 v219, s[88:91], s3 offen offset:3072 lds
    s_add_u32 m0, s72, 98304
    s_add_u32 s3, s73, 1572864
    buffer_load_dwordx4 v216, s[88:91], s3 offen offset:0 lds
    buffer_load_dwordx4 v217, s[88:91], s3 offen offset:1024 lds
    buffer_load_dwordx4 v218, s[88:91], s3 offen offset:2048 lds
    buffer_load_dwordx4 v219, s[88:91], s3 offen offset:3072 lds
    s_add_u32 m0, s72, 114688
    s_add_u32 s3, s73, 1835008
    buffer_load_dwordx4 v216, s[88:91], s3 offen offset:0 lds
    buffer_load_dwordx4 v217, s[88:91], s3 offen offset:1024 lds
    buffer_load_dwordx4 v218, s[88:91], s3 offen offset:2048 lds
    buffer_load_dwordx4 v219, s[88:91], s3 offen offset:3072 lds
    v_mul_f32 v196, v193, v192
    v_mov_b32 v198, 0xbfb8aa3b
    v_lshlrev_b32 v224, 16, v240
    v_and_b32 v225, 0xffff0000, v240
    v_lshlrev_b32 v226, 16, v241
    v_and_b32 v227, 0xffff0000, v241
    v_lshlrev_b32 v228, 16, v242
    v_and_b32 v229, 0xffff0000, v242
    v_lshlrev_b32 v230, 16, v243
    v_and_b32 v231, 0xffff0000, v243
    v_lshlrev_b32 v232, 16, v244
    v_and_b32 v233, 0xffff0000, v244
    v_lshlrev_b32 v234, 16, v245
    v_and_b32 v235, 0xffff0000, v245
    v_lshlrev_b32 v236, 16, v246
    v_and_b32 v237, 0xffff0000, v246
    v_lshlrev_b32_e64 v238, 16, v247
    v_and_b32 v239, 0xffff0000, v247
    v_pk_fma_f32 v[224:225], v[224:225], v[192:193], v[196:197] op_sel_hi:[1,0,0] neg_lo:[0,0,1] neg_hi:[0,0,1]
    v_pk_fma_f32 v[226:227], v[226:227], v[192:193], v[196:197] op_sel_hi:[1,0,0] neg_lo:[0,0,1] neg_hi:[0,0,1]
    v_pk_fma_f32 v[228:229], v[228:229], v[192:193], v[196:197] op_sel_hi:[1,0,0] neg_lo:[0,0,1] neg_hi:[0,0,1]
    v_pk_fma_f32 v[230:231], v[230:231], v[192:193], v[196:197] op_sel_hi:[1,0,0] neg_lo:[0,0,1] neg_hi:[0,0,1]
    v_pk_fma_f32 v[232:233], v[232:233], v[192:193], v[196:197] op_sel_hi:[1,0,0] neg_lo:[0,0,1] neg_hi:[0,0,1]
    v_pk_fma_f32 v[234:235], v[234:235], v[192:193], v[196:197] op_sel_hi:[1,0,0] neg_lo:[0,0,1] neg_hi:[0,0,1]
    v_pk_fma_f32 v[236:237], v[236:237], v[192:193], v[196:197] op_sel_hi:[1,0,0] neg_lo:[0,0,1] neg_hi:[0,0,1]
    v_pk_fma_f32 v[238:239], v[238:239], v[192:193], v[196:197] op_sel_hi:[1,0,0] neg_lo:[0,0,1] neg_hi:[0,0,1]
    v_pk_mul_f32 v[200:201], v[224:225], v[198:199] op_sel_hi:[1,0]
    v_pk_mul_f32 v[202:203], v[226:227], v[198:199] op_sel_hi:[1,0]
    v_pk_mul_f32 v[204:205], v[228:229], v[198:199] op_sel_hi:[1,0]
    v_pk_mul_f32 v[206:207], v[230:231], v[198:199] op_sel_hi:[1,0]
    v_pk_mul_f32 v[208:209], v[232:233], v[198:199] op_sel_hi:[1,0]
    v_pk_mul_f32 v[210:211], v[234:235], v[198:199] op_sel_hi:[1,0]
    v_pk_mul_f32 v[212:213], v[236:237], v[198:199] op_sel_hi:[1,0]
    v_pk_mul_f32 v[214:215], v[238:239], v[198:199] op_sel_hi:[1,0]
    v_exp_f32 v200, v200
    v_exp_f32 v201, v201
    v_exp_f32 v202, v202
    v_exp_f32 v203, v203
    v_exp_f32 v204, v204
    v_exp_f32 v205, v205
    v_exp_f32 v206, v206
    v_exp_f32 v207, v207
    v_exp_f32 v208, v208
    v_exp_f32 v209, v209
    v_exp_f32 v210, v210
    v_exp_f32 v211, v211
    v_exp_f32 v212, v212
    v_exp_f32 v213, v213
    v_exp_f32 v214, v214
    v_exp_f32 v215, v215
    v_pk_add_f32 v[200:201], v[200:201], 1.0 op_sel_hi:[1,0]
    v_pk_add_f32 v[202:203], v[202:203], 1.0 op_sel_hi:[1,0]
    v_pk_add_f32 v[204:205], v[204:205], 1.0 op_sel_hi:[1,0]
    v_pk_add_f32 v[206:207], v[206:207], 1.0 op_sel_hi:[1,0]
    v_pk_add_f32 v[208:209], v[208:209], 1.0 op_sel_hi:[1,0]
    v_pk_add_f32 v[210:211], v[210:211], 1.0 op_sel_hi:[1,0]
    v_pk_add_f32 v[212:213], v[212:213], 1.0 op_sel_hi:[1,0]
    v_pk_add_f32 v[214:215], v[214:215], 1.0 op_sel_hi:[1,0]
    v_rcp_f32 v200, v200
    v_rcp_f32 v201, v201
    v_rcp_f32 v202, v202
    v_rcp_f32 v203, v203
    v_rcp_f32 v204, v204
    v_rcp_f32 v205, v205
    v_rcp_f32 v206, v206
    v_rcp_f32 v207, v207
    v_rcp_f32 v208, v208
    v_rcp_f32 v209, v209
    v_rcp_f32 v210, v210
    v_rcp_f32 v211, v211
    v_rcp_f32 v212, v212
    v_rcp_f32 v213, v213
    v_rcp_f32 v214, v214
    v_rcp_f32 v215, v215
    v_pk_mul_f32 v[224:225], v[224:225], v[200:201]
    v_pk_mul_f32 v[226:227], v[226:227], v[202:203]
    v_pk_mul_f32 v[228:229], v[228:229], v[204:205]
    v_pk_mul_f32 v[230:231], v[230:231], v[206:207]
    v_pk_mul_f32 v[232:233], v[232:233], v[208:209]
    v_pk_mul_f32 v[234:235], v[234:235], v[210:211]
    v_pk_mul_f32 v[236:237], v[236:237], v[212:213]
    v_pk_mul_f32 v[238:239], v[238:239], v[214:215]
L_p3:
    s_nop 3
    s_mov_b32 s56, s22
    s_mov_b32 s57, s23
    s_mov_b32 s58, 4194304
    s_mov_b32 s59, 0x00020000
    s_lshr_b32 s64, s39, 2
    s_lshl_b32 s3, s34, 2
    s_add_u32 s3, s3, s38
    s_lshl_b32 s3, s3, 16
    s_lshl_b32 s28, s64, 14
    s_add_u32 s3, s3, s28
    s_add_u32 s76, s3, 4194304
    s_lshl_b32 s3, s64, 15
    v_lshlrev_b32 v2, 4, v1
    v_add_u32 v108, s3, v2
    v_xor_b32 v109, 0x8000, v108
    v_lshrrev_b32 v2, 2, v1
    v_lshlrev_b32 v2, 7, v2
    v_bfe_u32 v3, v1, 3, 2
    v_lshl_add_u32 v2, v3, 5, v2
    v_and_b32 v3, 3, v1
    v_lshl_add_u32 v2, v3, 3, v2
    s_lshl_b32 s3, s64, 16
    v_add_u32 v104, s3, v2
    v_xor_b32 v105, 32, v104
    v_xor_b32 v106, 64, v104
    v_xor_b32 v107, 96, v104
    s_add_u32 s77, s76, 0
    buffer_load_dwordx4 v[40:43], v108, s[48:51], s77 offen offset:0 sc1
    buffer_load_dwordx4 v[44:47], v109, s[48:51], s77 offen offset:0 sc1
    buffer_load_dwordx4 v[48:51], v108, s[48:51], s77 offen offset:1024 sc1
    buffer_load_dwordx4 v[52:55], v109, s[48:51], s77 offen offset:1024 sc1
    buffer_load_dwordx4 v[56:59], v108, s[48:51], s77 offen offset:2048 sc1
    buffer_load_dwordx4 v[60:63], v109, s[48:51], s77 offen offset:2048 sc1
    s_lshr_b32 s3, s68, 7
    s_xor_b32 s83, s3, s34
    s_or_b32 s83, s83, s39
    s_nop 0
    ds_read_b64_tr_b16 v[72:73], v104 offset:0
    ds_read_b64_tr_b16 v[74:75], v104 offset:2048
    ds_read_b64_tr_b16 v[76:77], v105 offset:0
    ds_read_b64_tr_b16 v[78:79], v105 offset:2048
    ds_read_b64_tr_b16 v[80:81], v106 offset:0
    ds_read_b64_tr_b16 v[82:83], v106 offset:2048
    ds_read_b64_tr_b16 v[84:85], v107 offset:0
    ds_read_b64_tr_b16 v[86:87], v107 offset:2048
    s_mov_b32 s29, 0
    buffer_load_dwordx4 v[64:67], v108, s[48:51], s77 offen offset:3072 sc1
    buffer_load_dwordx4 v[68:71], v109, s[48:51], s77 offen offset:3072 sc1
    s_waitcnt vmcnt(6)
L_c0:
    v_max3_u32 v2, v40, v41, v42
    v_max3_u32 v2, v2, v43, v44
    v_max3_u32 v2, v2, v45, v46
    v_max_u32 v2, v2, v47
    v_cmp_eq_u32 vcc, -1, v2
    s_cbranch_vccnz L_r0
L_g0:
    s_waitcnt lgkmcnt(0)
    v_mfma_f32_16x16x32_bf16 v[8:11], v[72:75], v[40:43], 0
    ds_read_b64_tr_b16 v[88:89], v104 offset:4096
    v_mfma_f32_16x16x32_bf16 v[24:27], v[72:75], v[44:47], 0
    ds_read_b64_tr_b16 v[90:91], v104 offset:6144
    v_mfma_f32_16x16x32_bf16 v[12:15], v[76:79], v[40:43], 0
    ds_read_b64_tr_b16 v[92:93], v105 offset:4096
    v_mfma_f32_16x16x32_bf16 v[28:31], v[76:79], v[44:47], 0
    ds_read_b64_tr_b16 v[94:95], v105 offset:6144
    v_mfma_f32_16x16x32_bf16 v[16:19], v[80:83], v[40:43], 0
    ds_read_b64_tr_b16 v[96:97], v106 offset:4096
    v_mfma_f32_16x16x32_bf16 v[32:35], v[80:83], v[44:47], 0
    ds_read_b64_tr_b16 v[98:99], v106 offset:6144
    v_mfma_f32_16x16x32_bf16 v[20:23], v[84:87], v[40:43], 0
    ds_read_b64_tr_b16 v[100:101], v107 offset:4096
    v_mfma_f32_16x16x32_bf16 v[36:39], v[84:87], v[44:47], 0
    ds_read_b64_tr_b16 v[102:103], v107 offset:6144
    s_add_u32 s77, s76, 4096
    buffer_load_dwordx4 v[40:43], v108, s[48:51], s77 offen offset:0 sc1
    buffer_load_dwordx4 v[44:47], v109, s[48:51], s77 offen offset:0 sc1
    s_waitcnt vmcnt(6)
L_c1:
    v_max3_u32 v2, v48, v49, v50
    v_max3_u32 v2, v2, v51, v52
    v_max3_u32 v2, v2, v53, v54
    v_max_u32 v2, v2, v55
    v_cmp_eq_u32_e64 vcc, -1, v2
    s_cbranch_vccnz L_r1
L_g1:
    s_waitcnt lgkmcnt(0)
    v_mfma_f32_16x16x32_bf16 v[8:11], v[88:91], v[48:51], v[8:11]
    ds_read_b64_tr_b16 v[72:73], v104 offset:8192
    v_mfma_f32_16x16x32_bf16 v[24:27], v[88:91], v[52:55], v[24:27]
    ds_read_b64_tr_b16 v[74:75], v104 offset:10240
    v_mfma_f32_16x16x32_bf16 v[12:15], v[92:95], v[48:51], v[12:15]
    ds_read_b64_tr_b16 v[76:77], v105 offset:8192
    v_mfma_f32_16x16x32_bf16 v[28:31], v[92:95], v[52:55], v[28:31]
    ds_read_b64_tr_b16 v[78:79], v105 offset:10240
    v_mfma_f32_16x16x32_bf16 v[16:19], v[96:99], v[48:51], v[16:19]
    ds_read_b64_tr_b16 v[80:81], v106 offset:8192
    v_mfma_f32_16x16x32_bf16 v[32:35], v[96:99], v[52:55], v[32:35]
    ds_read_b64_tr_b16 v[82:83], v106 offset:10240
    v_mfma_f32_16x16x32_bf16 v[20:23], v[100:103], v[48:51], v[20:23]
    ds_read_b64_tr_b16 v[84:85], v107 offset:8192
    v_mfma_f32_16x16x32_bf16 v[36:39], v[100:103], v[52:55], v[36:39]
    ds_read_b64_tr_b16 v[86:87], v107 offset:10240
    buffer_load_dwordx4 v[48:51], v108, s[48:51], s77 offen offset:1024 sc1
    buffer_load_dwordx4 v[52:55], v109, s[48:51], s77 offen offset:1024 sc1
    s_waitcnt vmcnt(6)
L_c2:
    v_max3_u32 v2, v56, v57, v58
    v_max3_u32 v2, v2, v59, v60
    v_max3_u32 v2, v2, v61, v62
    v_max_u32 v2, v2, v63
    v_cmp_eq_u32_e64 vcc, -1, v2
    s_cbranch_vccnz L_r2
L_g2:
    s_waitcnt lgkmcnt(0)
    v_mfma_f32_16x16x32_bf16 v[8:11], v[72:75], v[56:59], v[8:11]
    ds_read_b64_tr_b16 v[88:89], v104 offset:12288
    v_mfma_f32_16x16x32_bf16 v[24:27], v[72:75], v[60:63], v[24:27]
    ds_read_b64_tr_b16 v[90:91], v104 offset:14336
    v_mfma_f32_16x16x32_bf16 v[12:15], v[76:79], v[56:59], v[12:15]
    ds_read_b64_tr_b16 v[92:93], v105 offset:12288
    v_mfma_f32_16x16x32_bf16 v[28:31], v[76:79], v[60:63], v[28:31]
    ds_read_b64_tr_b16 v[94:95], v105 offset:14336
    v_mfma_f32_16x16x32_bf16 v[16:19], v[80:83], v[56:59], v[16:19]
    ds_read_b64_tr_b16 v[96:97], v106 offset:12288
    v_mfma_f32_16x16x32_bf16 v[32:35], v[80:83], v[60:63], v[32:35]
    ds_read_b64_tr_b16 v[98:99], v106 offset:14336
    v_mfma_f32_16x16x32_bf16 v[20:23], v[84:87], v[56:59], v[20:23]
    ds_read_b64_tr_b16 v[100:101], v107 offset:12288
    v_mfma_f32_16x16x32_bf16 v[36:39], v[84:87], v[60:63], v[36:39]
    ds_read_b64_tr_b16 v[102:103], v107 offset:14336
    buffer_load_dwordx4 v[56:59], v108, s[48:51], s77 offen offset:2048 sc1
    buffer_load_dwordx4 v[60:63], v109, s[48:51], s77 offen offset:2048 sc1
    s_waitcnt vmcnt(6)
L_c3:
    v_max3_u32 v2, v64, v65, v66
    v_max3_u32 v2, v2, v67, v68
    v_max3_u32 v2, v2, v69, v70
    v_max_u32 v2, v2, v71
    v_cmp_eq_u32 vcc, -1, v2
    s_cbranch_vccnz L_r3
L_g3:
    s_waitcnt lgkmcnt(0)
    s_cmp_eq_u32 s64, 0
    s_cbranch_scc1 L_nb3
    s_barrier
L_nb3:
    v_mfma_f32_16x16x32_bf16 v[8:11], v[88:91], v[64:67], v[8:11]
    ds_read_b64_tr_b16 v[72:73], v104 offset:16384
    v_mfma_f32_16x16x32_bf16 v[24:27], v[88:91], v[68:71], v[24:27]
    ds_read_b64_tr_b16 v[74:75], v104 offset:18432
    v_mfma_f32_16x16x32_bf16 v[12:15], v[92:95], v[64:67], v[12:15]
    ds_read_b64_tr_b16 v[76:77], v105 offset:16384
    v_mfma_f32_16x16x32_bf16 v[28:31], v[92:95], v[68:71], v[28:31]
    ds_read_b64_tr_b16 v[78:79], v105 offset:18432
    v_mfma_f32_16x16x32_bf16 v[16:19], v[96:99], v[64:67], v[16:19]
    ds_read_b64_tr_b16 v[80:81], v106 offset:16384
    v_mfma_f32_16x16x32_bf16 v[32:35], v[96:99], v[68:71], v[32:35]
    ds_read_b64_tr_b16 v[82:83], v106 offset:18432
    v_mfma_f32_16x16x32_bf16 v[20:23], v[100:103], v[64:67], v[20:23]
    ds_read_b64_tr_b16 v[84:85], v107 offset:16384
    v_mfma_f32_16x16x32_bf16 v[36:39], v[100:103], v[68:71], v[36:39]
    ds_read_b64_tr_b16 v[86:87], v107 offset:18432
    buffer_load_dwordx4 v[64:67], v108, s[48:51], s77 offen offset:3072 sc1
    buffer_load_dwordx4 v[68:71], v109, s[48:51], s77 offen offset:3072 sc1
    s_waitcnt vmcnt(6)
L_c4:
    v_max3_u32 v2, v40, v41, v42
    v_max3_u32 v2, v2, v43, v44
    v_max3_u32 v2, v2, v45, v46
    v_max_u32 v2, v2, v47
    v_cmp_eq_u32_e64 vcc, -1, v2
    s_cbranch_vccnz L_r4
L_g4:
    s_waitcnt lgkmcnt(0)
    v_mfma_f32_16x16x32_bf16 v[8:11], v[72:75], v[40:43], v[8:11]
    ds_read_b64_tr_b16 v[88:89], v104 offset:20480
    v_mfma_f32_16x16x32_bf16 v[24:27], v[72:75], v[44:47], v[24:27]
    ds_read_b64_tr_b16 v[90:91], v104 offset:22528
    v_mfma_f32_16x16x32_bf16 v[12:15], v[76:79], v[40:43], v[12:15]
    ds_read_b64_tr_b16 v[92:93], v105 offset:20480
    v_mfma_f32_16x16x32_bf16 v[28:31], v[76:79], v[44:47], v[28:31]
    ds_read_b64_tr_b16 v[94:95], v105 offset:22528
    v_mfma_f32_16x16x32_bf16 v[16:19], v[80:83], v[40:43], v[16:19]
    ds_read_b64_tr_b16 v[96:97], v106 offset:20480
    v_mfma_f32_16x16x32_bf16 v[32:35], v[80:83], v[44:47], v[32:35]
    ds_read_b64_tr_b16 v[98:99], v106 offset:22528
    v_mfma_f32_16x16x32_bf16 v[20:23], v[84:87], v[40:43], v[20:23]
    ds_read_b64_tr_b16 v[100:101], v107 offset:20480
    v_mfma_f32_16x16x32_bf16 v[36:39], v[84:87], v[44:47], v[36:39]
    ds_read_b64_tr_b16 v[102:103], v107 offset:22528
    s_add_u32 s77, s76, 8192
    buffer_load_dwordx4 v[40:43], v108, s[48:51], s77 offen offset:0 sc1
    buffer_load_dwordx4 v[44:47], v109, s[48:51], s77 offen offset:0 sc1
    s_waitcnt vmcnt(6)
L_c5:
    v_max3_u32 v2, v48, v49, v50
    v_max3_u32 v2, v2, v51, v52
    v_max3_u32 v2, v2, v53, v54
    v_max_u32 v2, v2, v55
    v_cmp_eq_u32_e64 vcc, -1, v2
    s_cbranch_vccnz L_r5
L_g5:
    s_waitcnt lgkmcnt(0)
    v_mfma_f32_16x16x32_bf16 v[8:11], v[88:91], v[48:51], v[8:11]
    ds_read_b64_tr_b16 v[72:73], v104 offset:24576
    v_mfma_f32_16x16x32_bf16 v[24:27], v[88:91], v[52:55], v[24:27]
    ds_read_b64_tr_b16 v[74:75], v104 offset:26624
    v_mfma_f32_16x16x32_bf16 v[12:15], v[92:95], v[48:51], v[12:15]
    ds_read_b64_tr_b16 v[76:77], v105 offset:24576
    v_mfma_f32_16x16x32_bf16 v[28:31], v[92:95], v[52:55], v[28:31]
    ds_read_b64_tr_b16 v[78:79], v105 offset:26624
    v_mfma_f32_16x16x32_bf16 v[16:19], v[96:99], v[48:51], v[16:19]
    ds_read_b64_tr_b16 v[80:81], v106 offset:24576
    v_mfma_f32_16x16x32_bf16 v[32:35], v[96:99], v[52:55], v[32:35]
    ds_read_b64_tr_b16 v[82:83], v106 offset:26624
    v_mfma_f32_16x16x32_bf16 v[20:23], v[100:103], v[48:51], v[20:23]
    ds_read_b64_tr_b16 v[84:85], v107 offset:24576
    v_mfma_f32_16x16x32_bf16 v[36:39], v[100:103], v[52:55], v[36:39]
    ds_read_b64_tr_b16 v[86:87], v107 offset:26624
    buffer_load_dwordx4 v[48:51], v108, s[48:51], s77 offen offset:1024 sc1
    buffer_load_dwordx4 v[52:55], v109, s[48:51], s77 offen offset:1024 sc1
    s_waitcnt vmcnt(6)
L_c6:
    v_max3_u32 v2, v56, v57, v58
    v_max3_u32 v2, v2, v59, v60
    v_max3_u32 v2, v2, v61, v62
    v_max_u32 v2, v2, v63
    v_cmp_eq_u32_e64 vcc, -1, v2
    s_cbranch_vccnz L_r6
L_g6:
    s_waitcnt lgkmcnt(0)
    v_mfma_f32_16x16x32_bf16 v[8:11], v[72:75], v[56:59], v[8:11]
    ds_read_b64_tr_b16 v[88:89], v104 offset:28672
    v_mfma_f32_16x16x32_bf16 v[24:27], v[72:75], v[60:63], v[24:27]
    ds_read_b64_tr_b16 v[90:91], v104 offset:30720
    v_mfma_f32_16x16x32_bf16 v[12:15], v[76:79], v[56:59], v[12:15]
    ds_read_b64_tr_b16 v[92:93], v105 offset:28672
    v_mfma_f32_16x16x32_bf16 v[28:31], v[76:79], v[60:63], v[28:31]
    ds_read_b64_tr_b16 v[94:95], v105 offset:30720
    v_mfma_f32_16x16x32_bf16 v[16:19], v[80:83], v[56:59], v[16:19]
    ds_read_b64_tr_b16 v[96:97], v106 offset:28672
    v_mfma_f32_16x16x32_bf16 v[32:35], v[80:83], v[60:63], v[32:35]
    ds_read_b64_tr_b16 v[98:99], v106 offset:30720
    v_mfma_f32_16x16x32_bf16 v[20:23], v[84:87], v[56:59], v[20:23]
    ds_read_b64_tr_b16 v[100:101], v107 offset:28672
    v_mfma_f32_16x16x32_bf16 v[36:39], v[84:87], v[60:63], v[36:39]
    ds_read_b64_tr_b16 v[102:103], v107 offset:30720
    buffer_load_dwordx4 v[56:59], v108, s[48:51], s77 offen offset:2048 sc1
    buffer_load_dwordx4 v[60:63], v109, s[48:51], s77 offen offset:2048 sc1
    s_waitcnt vmcnt(6)
L_c7:
    v_max3_u32 v2, v64, v65, v66
    v_max3_u32 v2, v2, v67, v68
    v_max3_u32 v2, v2, v69, v70
    v_max_u32 v2, v2, v71
    v_cmp_eq_u32 vcc, -1, v2
    s_cbranch_vccnz L_r7
L_g7:
    s_waitcnt lgkmcnt(0)
    s_cmp_eq_u32 s64, 1
    s_cbranch_scc1 L_nb7
    s_barrier
L_nb7:
    v_mfma_f32_16x16x32_bf16 v[8:11], v[88:91], v[64:67], v[8:11]
    ds_read_b64_tr_b16 v[72:73], v104 offset:32768
    v_mfma_f32_16x16x32_bf16 v[24:27], v[88:91], v[68:71], v[24:27]
    ds_read_b64_tr_b16 v[74:75], v104 offset:34816
    v_mfma_f32_16x16x32_bf16 v[12:15], v[92:95], v[64:67], v[12:15]
    ds_read_b64_tr_b16 v[76:77], v105 offset:32768
    v_mfma_f32_16x16x32_bf16 v[28:31], v[92:95], v[68:71], v[28:31]
    ds_read_b64_tr_b16 v[78:79], v105 offset:34816
    v_mfma_f32_16x16x32_bf16 v[16:19], v[96:99], v[64:67], v[16:19]
    ds_read_b64_tr_b16 v[80:81], v106 offset:32768
    v_mfma_f32_16x16x32_bf16 v[32:35], v[96:99], v[68:71], v[32:35]
    ds_read_b64_tr_b16 v[82:83], v106 offset:34816
    v_mfma_f32_16x16x32_bf16 v[20:23], v[100:103], v[64:67], v[20:23]
    ds_read_b64_tr_b16 v[84:85], v107 offset:32768
    v_mfma_f32_16x16x32_bf16 v[36:39], v[100:103], v[68:71], v[36:39]
    ds_read_b64_tr_b16 v[86:87], v107 offset:34816
    buffer_load_dwordx4 v[64:67], v108, s[48:51], s77 offen offset:3072 sc1
    buffer_load_dwordx4 v[68:71], v109, s[48:51], s77 offen offset:3072 sc1
    s_waitcnt vmcnt(6)
L_c8:
    v_max3_u32 v2, v40, v41, v42
    v_max3_u32 v2, v2, v43, v44
    v_max3_u32 v2, v2, v45, v46
    v_max_u32 v2, v2, v47
    v_cmp_eq_u32_e64 vcc, -1, v2
    s_cbranch_vccnz L_r8
L_g8:
    s_waitcnt lgkmcnt(0)
    v_mfma_f32_16x16x32_bf16 v[8:11], v[72:75], v[40:43], v[8:11]
    ds_read_b64_tr_b16 v[88:89], v104 offset:36864
    v_mfma_f32_16x16x32_bf16 v[24:27], v[72:75], v[44:47], v[24:27]
    ds_read_b64_tr_b16 v[90:91], v104 offset:38912
    v_mfma_f32_16x16x32_bf16 v[12:15], v[76:79], v[40:43], v[12:15]
    ds_read_b64_tr_b16 v[92:93], v105 offset:36864
    v_mfma_f32_16x16x32_bf16 v[28:31], v[76:79], v[44:47], v[28:31]
    ds_read_b64_tr_b16 v[94:95], v105 offset:38912
    v_mfma_f32_16x16x32_bf16 v[16:19], v[80:83], v[40:43], v[16:19]
    ds_read_b64_tr_b16 v[96:97], v106 offset:36864
    v_mfma_f32_16x16x32_bf16 v[32:35], v[80:83], v[44:47], v[32:35]
    ds_read_b64_tr_b16 v[98:99], v106 offset:38912
    v_mfma_f32_16x16x32_bf16 v[20:23], v[84:87], v[40:43], v[20:23]
    ds_read_b64_tr_b16 v[100:101], v107 offset:36864
    v_mfma_f32_16x16x32_bf16 v[36:39], v[84:87], v[44:47], v[36:39]
    ds_read_b64_tr_b16 v[102:103], v107 offset:38912
    s_add_u32 s77, s76, 12288
    buffer_load_dwordx4 v[40:43], v108, s[48:51], s77 offen offset:0 sc1
    buffer_load_dwordx4 v[44:47], v109, s[48:51], s77 offen offset:0 sc1
    s_waitcnt vmcnt(6)
L_c9:
    v_max3_u32 v2, v48, v49, v50
    v_max3_u32 v2, v2, v51, v52
    v_max3_u32 v2, v2, v53, v54
    v_max_u32 v2, v2, v55
    v_cmp_eq_u32_e64 vcc, -1, v2
    s_cbranch_vccnz L_r9
L_g9:
    s_waitcnt lgkmcnt(0)
    v_mfma_f32_16x16x32_bf16 v[8:11], v[88:91], v[48:51], v[8:11]
    ds_read_b64_tr_b16 v[72:73], v104 offset:40960
    v_mfma_f32_16x16x32_bf16 v[24:27], v[88:91], v[52:55], v[24:27]
    ds_read_b64_tr_b16 v[74:75], v104 offset:43008
    v_mfma_f32_16x16x32_bf16 v[12:15], v[92:95], v[48:51], v[12:15]
    ds_read_b64_tr_b16 v[76:77], v105 offset:40960
    v_mfma_f32_16x16x32_bf16 v[28:31], v[92:95], v[52:55], v[28:31]
    ds_read_b64_tr_b16 v[78:79], v105 offset:43008
    v_mfma_f32_16x16x32_bf16 v[16:19], v[96:99], v[48:51], v[16:19]
    ds_read_b64_tr_b16 v[80:81], v106 offset:40960
    v_mfma_f32_16x16x32_bf16 v[32:35], v[96:99], v[52:55], v[32:35]
    ds_read_b64_tr_b16 v[82:83], v106 offset:43008
    v_mfma_f32_16x16x32_bf16 v[20:23], v[100:103], v[48:51], v[20:23]
    ds_read_b64_tr_b16 v[84:85], v107 offset:40960
    v_mfma_f32_16x16x32_bf16 v[36:39], v[100:103], v[52:55], v[36:39]
    ds_read_b64_tr_b16 v[86:87], v107 offset:43008
    buffer_load_dwordx4 v[48:51], v108, s[48:51], s77 offen offset:1024 sc1
    buffer_load_dwordx4 v[52:55], v109, s[48:51], s77 offen offset:1024 sc1
    s_waitcnt vmcnt(6)
L_c10:
    v_max3_u32 v2, v56, v57, v58
    v_max3_u32 v2, v2, v59, v60
    v_max3_u32 v2, v2, v61, v62
    v_max_u32 v2, v2, v63
    v_cmp_eq_u32_e64 vcc, -1, v2
    s_cbranch_vccnz L_r10
L_g10:
    s_waitcnt lgkmcnt(0)
    v_mfma_f32_16x16x32_bf16 v[8:11], v[72:75], v[56:59], v[8:11]
    ds_read_b64_tr_b16 v[88:89], v104 offset:45056
    v_mfma_f32_16x16x32_bf16 v[24:27], v[72:75], v[60:63], v[24:27]
    ds_read_b64_tr_b16 v[90:91], v104 offset:47104
    v_mfma_f32_16x16x32_bf16 v[12:15], v[76:79], v[56:59], v[12:15]
    ds_read_b64_tr_b16 v[92:93], v105 offset:45056
    v_mfma_f32_16x16x32_bf16 v[28:31], v[76:79], v[60:63], v[28:31]
    ds_read_b64_tr_b16 v[94:95], v105 offset:47104
    v_mfma_f32_16x16x32_bf16 v[16:19], v[80:83], v[56:59], v[16:19]
    ds_read_b64_tr_b16 v[96:97], v106 offset:45056
    v_mfma_f32_16x16x32_bf16 v[32:35], v[80:83], v[60:63], v[32:35]
    ds_read_b64_tr_b16 v[98:99], v106 offset:47104
    v_mfma_f32_16x16x32_bf16 v[20:23], v[84:87], v[56:59], v[20:23]
    ds_read_b64_tr_b16 v[100:101], v107 offset:45056
    v_mfma_f32_16x16x32_bf16 v[36:39], v[84:87], v[60:63], v[36:39]
    ds_read_b64_tr_b16 v[102:103], v107 offset:47104
    buffer_load_dwordx4 v[56:59], v108, s[48:51], s77 offen offset:2048 sc1
    buffer_load_dwordx4 v[60:63], v109, s[48:51], s77 offen offset:2048 sc1
    s_waitcnt vmcnt(6)
L_c11:
    v_max3_u32 v2, v64, v65, v66
    v_max3_u32 v2, v2, v67, v68
    v_max3_u32 v2, v2, v69, v70
    v_max_u32 v2, v2, v71
    v_cmp_eq_u32_e64 vcc, -1, v2
    s_cbranch_vccnz L_r11
L_g11:
    s_waitcnt lgkmcnt(0)
    v_mfma_f32_16x16x32_bf16 v[8:11], v[88:91], v[64:67], v[8:11]
    ds_read_b64_tr_b16 v[72:73], v104 offset:49152
    v_mfma_f32_16x16x32_bf16 v[24:27], v[88:91], v[68:71], v[24:27]
    ds_read_b64_tr_b16 v[74:75], v104 offset:51200
    v_mfma_f32_16x16x32_bf16 v[12:15], v[92:95], v[64:67], v[12:15]
    ds_read_b64_tr_b16 v[76:77], v105 offset:49152
    v_mfma_f32_16x16x32_bf16 v[28:31], v[92:95], v[68:71], v[28:31]
    ds_read_b64_tr_b16 v[78:79], v105 offset:51200
    v_mfma_f32_16x16x32_bf16 v[16:19], v[96:99], v[64:67], v[16:19]
    ds_read_b64_tr_b16 v[80:81], v106 offset:49152
    v_mfma_f32_16x16x32_bf16 v[32:35], v[96:99], v[68:71], v[32:35]
    ds_read_b64_tr_b16 v[82:83], v106 offset:51200
    v_mfma_f32_16x16x32_bf16 v[20:23], v[100:103], v[64:67], v[20:23]
    ds_read_b64_tr_b16 v[84:85], v107 offset:49152
    v_mfma_f32_16x16x32_bf16 v[36:39], v[100:103], v[68:71], v[36:39]
    ds_read_b64_tr_b16 v[86:87], v107 offset:51200
    buffer_load_dwordx4 v[64:67], v108, s[48:51], s77 offen offset:3072 sc1
    buffer_load_dwordx4 v[68:71], v109, s[48:51], s77 offen offset:3072 sc1
    s_waitcnt vmcnt(6)
L_c12:
    v_max3_u32 v2, v40, v41, v42
    v_max3_u32 v2, v2, v43, v44
    v_max3_u32 v2, v2, v45, v46
    v_max_u32 v2, v2, v47
    v_cmp_eq_u32_e64 vcc, -1, v2
    s_cbranch_vccnz L_r12
L_g12:
    s_waitcnt lgkmcnt(0)
    v_mfma_f32_16x16x32_bf16 v[8:11], v[72:75], v[40:43], v[8:11]
    ds_read_b64_tr_b16 v[88:89], v104 offset:53248
    v_mfma_f32_16x16x32_bf16 v[24:27], v[72:75], v[44:47], v[24:27]
    ds_read_b64_tr_b16 v[90:91], v104 offset:55296
    v_mfma_f32_16x16x32_bf16 v[12:15], v[76:79], v[40:43], v[12:15]
    ds_read_b64_tr_b16 v[92:93], v105 offset:53248
    v_mfma_f32_16x16x32_bf16 v[28:31], v[76:79], v[44:47], v[28:31]
    ds_read_b64_tr_b16 v[94:95], v105 offset:55296
    v_mfma_f32_16x16x32_bf16 v[16:19], v[80:83], v[40:43], v[16:19]
    ds_read_b64_tr_b16 v[96:97], v106 offset:53248
    v_mfma_f32_16x16x32_bf16 v[32:35], v[80:83], v[44:47], v[32:35]
    ds_read_b64_tr_b16 v[98:99], v106 offset:55296
    v_mfma_f32_16x16x32_bf16 v[20:23], v[84:87], v[40:43], v[20:23]
    ds_read_b64_tr_b16 v[100:101], v107 offset:53248
    v_mfma_f32_16x16x32_bf16 v[36:39], v[84:87], v[44:47], v[36:39]
    ds_read_b64_tr_b16 v[102:103], v107 offset:55296
    s_waitcnt vmcnt(4)
L_c13:
    v_max3_u32 v2, v48, v49, v50
    v_max3_u32 v2, v2, v51, v52
    v_max3_u32 v2, v2, v53, v54
    v_max_u32 v2, v2, v55
    v_cmp_eq_u32_e64 vcc, -1, v2
    s_cbranch_vccnz L_r13
L_g13:
    s_waitcnt lgkmcnt(0)
    v_mfma_f32_16x16x32_bf16 v[8:11], v[88:91], v[48:51], v[8:11]
    ds_read_b64_tr_b16 v[72:73], v104 offset:57344
    v_mfma_f32_16x16x32_bf16 v[24:27], v[88:91], v[52:55], v[24:27]
    ds_read_b64_tr_b16 v[74:75], v104 offset:59392
    v_mfma_f32_16x16x32_bf16 v[12:15], v[92:95], v[48:51], v[12:15]
    ds_read_b64_tr_b16 v[76:77], v105 offset:57344
    v_mfma_f32_16x16x32_bf16 v[28:31], v[92:95], v[52:55], v[28:31]
    ds_read_b64_tr_b16 v[78:79], v105 offset:59392
    v_mfma_f32_16x16x32_bf16 v[16:19], v[96:99], v[48:51], v[16:19]
    ds_read_b64_tr_b16 v[80:81], v106 offset:57344
    v_mfma_f32_16x16x32_bf16 v[32:35], v[96:99], v[52:55], v[32:35]
    ds_read_b64_tr_b16 v[82:83], v106 offset:59392
    v_mfma_f32_16x16x32_bf16 v[20:23], v[100:103], v[48:51], v[20:23]
    ds_read_b64_tr_b16 v[84:85], v107 offset:57344
    v_mfma_f32_16x16x32_bf16 v[36:39], v[100:103], v[52:55], v[36:39]
    ds_read_b64_tr_b16 v[86:87], v107 offset:59392
    s_waitcnt vmcnt(2)
    s_cmp_eq_u32 s83, 0
    s_cbranch_scc1 L_fx1
L_fx1r:
L_c14:
    v_max3_u32 v2, v56, v57, v58
    v_max3_u32 v2, v2, v59, v60
    v_max3_u32 v2, v2, v61, v62
    v_max_u32 v2, v2, v63
    v_cmp_eq_u32_e64 vcc, -1, v2
    s_cbranch_vccnz L_r14
L_g14:
    s_waitcnt lgkmcnt(0)
    v_mfma_f32_16x16x32_bf16 v[8:11], v[72:75], v[56:59], v[8:11]
    ds_read_b64_tr_b16 v[88:89], v104 offset:61440
    v_mfma_f32_16x16x32_bf16 v[24:27], v[72:75], v[60:63], v[24:27]
    ds_read_b64_tr_b16 v[90:91], v104 offset:63488
    v_mfma_f32_16x16x32_bf16 v[12:15], v[76:79], v[56:59], v[12:15]
    ds_read_b64_tr_b16 v[92:93], v105 offset:61440
    v_mfma_f32_16x16x32_bf16 v[28:31], v[76:79], v[60:63], v[28:31]
    ds_read_b64_tr_b16 v[94:95], v105 offset:63488
    v_mfma_f32_16x16x32_bf16 v[16:19], v[80:83], v[56:59], v[16:19]
    ds_read_b64_tr_b16 v[96:97], v106 offset:61440
    v_mfma_f32_16x16x32_bf16 v[32:35], v[80:83], v[60:63], v[32:35]
    ds_read_b64_tr_b16 v[98:99], v106 offset:63488
    v_mfma_f32_16x16x32_bf16 v[20:23], v[84:87], v[56:59], v[20:23]
    ds_read_b64_tr_b16 v[100:101], v107 offset:61440
    v_mfma_f32_16x16x32_bf16 v[36:39], v[84:87], v[60:63], v[36:39]
    ds_read_b64_tr_b16 v[102:103], v107 offset:63488
    s_waitcnt vmcnt(0)
L_c15:
    v_max3_u32 v2, v64, v65, v66
    v_max3_u32 v2, v2, v67, v68
    v_max3_u32 v2, v2, v69, v70
    v_max_u32 v2, v2, v71
    v_cmp_eq_u32_e64 vcc, -1, v2
    s_cbranch_vccnz L_r15
L_g15:
    s_waitcnt lgkmcnt(0)
    v_mfma_f32_16x16x32_bf16 v[8:11], v[88:91], v[64:67], v[8:11]
    v_mfma_f32_16x16x32_bf16 v[24:27], v[88:91], v[68:71], v[24:27]
    v_mfma_f32_16x16x32_bf16 v[12:15], v[92:95], v[64:67], v[12:15]
    v_mfma_f32_16x16x32_bf16 v[28:31], v[92:95], v[68:71], v[28:31]
    v_mfma_f32_16x16x32_bf16 v[16:19], v[96:99], v[64:67], v[16:19]
    v_mfma_f32_16x16x32_bf16 v[32:35], v[96:99], v[68:71], v[32:35]
    v_mfma_f32_16x16x32_bf16 v[20:23], v[100:103], v[64:67], v[20:23]
    v_mfma_f32_16x16x32_bf16 v[36:39], v[100:103], v[68:71], v[36:39]
    s_cmp_eq_u32 s83, 0
    s_cbranch_scc1 L_fx2
L_fx2r:
    s_lshl_b32 s3, s39, 12
    s_add_u32 s3, s3, 131072
    v_lshlrev_b32 v2, 4, v1
    v_add_u32_e64 v2, s3, v2
    v_xor_b32 v3, 0x4000, v2
    s_xor_b32 s28, s3, 0x4000
    ds_write_b128 v2, v[24:27] offset:0
    ds_write_b128 v2, v[28:31] offset:1024
    ds_write_b128 v2, v[32:35] offset:2048
    ds_write_b128 v2, v[36:39] offset:3072
    v_lshlrev_b32 v40, 16, v240
    v_and_b32 v41, 0xffff0000, v240
    v_lshlrev_b32 v42, 16, v241
    v_and_b32 v43, 0xffff0000, v241
    v_lshlrev_b32 v44, 16, v242
    v_and_b32 v45, 0xffff0000, v242
    v_lshlrev_b32 v46, 16, v243
    v_and_b32 v47, 0xffff0000, v243
    v_lshlrev_b32 v48, 16, v244
    v_and_b32 v49, 0xffff0000, v244
    v_lshlrev_b32 v50, 16, v245
    v_and_b32 v51, 0xffff0000, v245
    v_lshlrev_b32 v52, 16, v246
    v_and_b32 v53, 0xffff0000, v246
    v_lshlrev_b32 v54, 16, v247
    v_and_b32 v55, 0xffff0000, v247
    v_and_b32 v4, 15, v1
    v_lshrrev_b32 v5, 4, v1
    v_lshlrev_b32 v6, 1, v4
    v_and_b32 v6, 14, v6
    v_xor_b32_e64 v5, v5, v6
    v_lshl_add_u32 v4, v4, 7, s28
    v_lshl_add_u32 v4, v5, 3, v4
    v_lshrrev_b32 v5, 3, v1
    v_and_b32 v6, 7, v1
    v_xor_b32_e64 v7, v6, v5
    v_lshl_add_u32 v7, v7, 4, s28
    v_lshl_add_u32 v7, v5, 7, v7
    s_lshl_b32 s3, s34, 7
    s_add_u32 s3, s3, s69
    v_add_u32 v5, s3, v5
    v_lshlrev_b32 v5, 11, v5
    v_lshl_add_u32 v5, v6, 4, v5
    s_lshl_b32 s3, s35, 7
    s_add_u32 s28, s3, 16384
    s_lshl_b32 s29, s34, 7
    s_add_u32 s29, s29, s69
    s_andn2_b32 s77, s68, 15
    s_cmp_lg_u32 s29, s77
    s_waitcnt lgkmcnt(0)
    s_barrier
    s_cbranch_scc1 L_nov
    v_and_b32 v2, 48, v1
    s_and_b32 s29, s68, 15
    s_lshl_b32 exec_lo, 0x00010001, s29
    s_mov_b32 exec_hi, exec_lo
    ds_read_b128 v[224:227], v2 offset:0
    ds_read_b128 v[228:231], v2 offset:64
    ds_read_b128 v[232:235], v2 offset:128
    ds_read_b128 v[236:239], v2 offset:192
    s_mov_b64 exec, -1
L_nov:
    ds_read_b128 v[24:27], v3 offset:0
    ds_read_b128 v[28:31], v3 offset:1024
    ds_read_b128 v[32:35], v3 offset:2048
    ds_read_b128 v[36:39], v3 offset:3072
    s_waitcnt lgkmcnt(3)
    s_nop 0
    v_pk_add_f32 v[8:9], v[8:9], v[24:25]
    v_pk_add_f32 v[10:11], v[10:11], v[26:27]
    v_pk_fma_f32 v[40:41], v[8:9], v[224:225], v[40:41]
    v_pk_fma_f32 v[42:43], v[10:11], v[226:227], v[42:43]
    v_cvt_pk_bf16_f32 v8, v40, v41
    v_cvt_pk_bf16_f32 v9, v42, v43
    s_waitcnt lgkmcnt(2)
    s_nop 0
    v_pk_add_f32 v[12:13], v[12:13], v[28:29]
    v_pk_add_f32 v[14:15], v[14:15], v[30:31]
    v_pk_fma_f32 v[44:45], v[12:13], v[228:229], v[44:45]
    v_pk_fma_f32 v[46:47], v[14:15], v[230:231], v[46:47]
    v_cvt_pk_bf16_f32 v10, v44, v45
    v_cvt_pk_bf16_f32 v11, v46, v47
    s_waitcnt lgkmcnt(1)
    s_nop 0
    v_pk_add_f32 v[16:17], v[16:17], v[32:33]
    v_pk_add_f32 v[18:19], v[18:19], v[34:35]
    v_pk_fma_f32 v[48:49], v[16:17], v[232:233], v[48:49]
    v_pk_fma_f32 v[50:51], v[18:19], v[234:235], v[50:51]
    v_cvt_pk_bf16_f32 v12, v48, v49
    v_cvt_pk_bf16_f32 v13, v50, v51
    s_waitcnt lgkmcnt(0)
    s_nop 0
    v_pk_add_f32 v[20:21], v[20:21], v[36:37]
    v_pk_add_f32 v[22:23], v[22:23], v[38:39]
    v_pk_fma_f32 v[52:53], v[20:21], v[236:237], v[52:53]
    v_pk_fma_f32 v[54:55], v[22:23], v[238:239], v[54:55]
    v_cvt_pk_bf16_f32 v14, v52, v53
    v_cvt_pk_bf16_f32 v15, v54, v55
    ds_write_b64 v4, v[8:9]
    v_xor_b32 v6, 32, v4
    ds_write_b64 v6, v[10:11]
    v_xor_b32 v6, 64, v4
    ds_write_b64 v6, v[12:13]
    v_xor_b32 v6, 96, v4
    ds_write_b64 v6, v[14:15]
    ds_read_b128 v[24:27], v7 offset:0
    ds_read_b128 v[28:31], v7 offset:1024
    s_waitcnt lgkmcnt(1)
    buffer_store_dwordx4 v[24:27], v5, s[56:59], s3 offen sc1
    s_waitcnt lgkmcnt(0)
    buffer_store_dwordx4 v[28:31], v5, s[56:59], s28 offen sc1
L_done:
    s_endpgm
L_fx1:
    v_lshlrev_b32 v192, 4, v1
    s_lshl_b32 s78, s35, 14
    s_add_u32 s78, s78, 1609728
    v_and_b32 v2, 15, v1
    v_lshrrev_b32 v3, 4, v1
    v_lshl_add_u32 v193, v2, 2, v3
    v_and_b32 v2, 7, v193
    v_lshrrev_b32 v193, 3, v193
    v_lshl_add_u32 v193, v2, 3, v193
    v_lshlrev_b32 v2, 1, v193
    s_lshl_b32 s3, s68, 11
    s_lshl_b32 s28, s35, 7
    s_add_u32 s3, s3, s28
    buffer_load_ushort v194, v2, s[40:43], s3 offen
    s_add_u32 s3, s78, 0
    buffer_load_dwordx4 v[128:131], v192, s[48:51], s3 offen offset:0 sc1
    buffer_load_dwordx4 v[132:135], v192, s[48:51], s3 offen offset:1024 sc1
    buffer_load_dwordx4 v[136:139], v192, s[48:51], s3 offen offset:2048 sc1
    buffer_load_dwordx4 v[140:143], v192, s[48:51], s3 offen offset:3072 sc1
    s_add_u32 s3, s78, 4096
    buffer_load_dwordx4 v[144:147], v192, s[48:51], s3 offen offset:0 sc1
    buffer_load_dwordx4 v[148:151], v192, s[48:51], s3 offen offset:1024 sc1
    buffer_load_dwordx4 v[152:155], v192, s[48:51], s3 offen offset:2048 sc1
    buffer_load_dwordx4 v[156:159], v192, s[48:51], s3 offen offset:3072 sc1
    s_add_u32 s3, s78, 8192
    buffer_load_dwordx4 v[160:163], v192, s[48:51], s3 offen offset:0 sc1
    buffer_load_dwordx4 v[164:167], v192, s[48:51], s3 offen offset:1024 sc1
    buffer_load_dwordx4 v[168:171], v192, s[48:51], s3 offen offset:2048 sc1
    buffer_load_dwordx4 v[172:175], v192, s[48:51], s3 offen offset:3072 sc1
    s_add_u32 s3, s78, 12288
    buffer_load_dwordx4 v[176:179], v192, s[48:51], s3 offen offset:0 sc1
    buffer_load_dwordx4 v[180:183], v192, s[48:51], s3 offen offset:1024 sc1
    buffer_load_dwordx4 v[184:187], v192, s[48:51], s3 offen offset:2048 sc1
    buffer_load_dwordx4 v[188:191], v192, s[48:51], s3 offen offset:3072 sc1
    s_branch L_fx1r
L_fx2:
    s_and_b32 s3, s70, 0xffff0000
    s_xor_b32 s28, s3, 0x80000000
    s_not_b32 s29, s3
    s_and_b32 s29, s29, 0xffff0000
    s_bitcmp1_b32 s3, 31
    s_cselect_b32 s3, s28, s29
    v_mov_b32 v195, s3
    v_mul_f32 v195, 0xbfb8aa3b, v195
    v_exp_f32 v195, v195
    s_nop 0
    v_add_f32 v195, 1.0, v195
    v_rcp_f32 v195, v195
    s_nop 0
    v_cvt_pk_bf16_f32 v195, v195, v195
    v_lshlrev_b32 v195, 16, v195
    s_mov_b32 s29, 0
L_k6:
    v_max3_u32 v2, v128, v129, v130
    v_max3_u32 v2, v2, v131, v132
    v_max3_u32 v2, v2, v133, v134
    v_max3_u32 v2, v2, v135, v136
    v_max3_u32 v2, v2, v137, v138
    v_max3_u32 v2, v2, v139, v140
    v_max3_u32 v2, v2, v141, v142
    v_max3_u32 v2, v2, v143, v144
    v_max3_u32 v2, v2, v145, v146
    v_max3_u32 v2, v2, v147, v148
    v_max3_u32 v2, v2, v149, v150
    v_max3_u32 v2, v2, v151, v152
    v_max3_u32 v2, v2, v153, v154
    v_max3_u32 v2, v2, v155, v156
    v_max3_u32 v2, v2, v157, v158
    v_max3_u32 v2, v2, v159, v160
    v_max3_u32 v2, v2, v161, v162
    v_max3_u32 v2, v2, v163, v164
    v_max3_u32 v2, v2, v165, v166
    v_max3_u32 v2, v2, v167, v168
    v_max3_u32 v2, v2, v169, v170
    v_max3_u32 v2, v2, v171, v172
    v_max3_u32 v2, v2, v173, v174
    v_max3_u32 v2, v2, v175, v176
    v_max3_u32 v2, v2, v177, v178
    v_max3_u32 v2, v2, v179, v180
    v_max3_u32 v2, v2, v181, v182
    v_max3_u32 v2, v2, v183, v184
    v_max3_u32 v2, v2, v185, v186
    v_max3_u32 v2, v2, v187, v188
    v_max3_u32 v2, v2, v189, v190
    v_max_u32 v2, v2, v191
    v_cmp_eq_u32 vcc, -1, v2
    s_cbranch_vccz L_k6k
    s_add_u32 s29, s29, 1
    s_cmp_ge_u32 s29, 200000
    s_cbranch_scc1 L_k6k
    s_sleep 4
    s_add_u32 s3, s78, 0
    s_nop 0
    buffer_load_dwordx4 v[128:131], v192, s[48:51], s3 offen offset:0 sc1
    buffer_load_dwordx4 v[132:135], v192, s[48:51], s3 offen offset:1024 sc1
    buffer_load_dwordx4 v[136:139], v192, s[48:51], s3 offen offset:2048 sc1
    buffer_load_dwordx4 v[140:143], v192, s[48:51], s3 offen offset:3072 sc1
    s_add_u32 s3, s78, 4096
    buffer_load_dwordx4 v[144:147], v192, s[48:51], s3 offen offset:0 sc1
    buffer_load_dwordx4 v[148:151], v192, s[48:51], s3 offen offset:1024 sc1
    buffer_load_dwordx4 v[152:155], v192, s[48:51], s3 offen offset:2048 sc1
    buffer_load_dwordx4 v[156:159], v192, s[48:51], s3 offen offset:3072 sc1
    s_add_u32 s3, s78, 8192
    buffer_load_dwordx4 v[160:163], v192, s[48:51], s3 offen offset:0 sc1
    buffer_load_dwordx4 v[164:167], v192, s[48:51], s3 offen offset:1024 sc1
    buffer_load_dwordx4 v[168:171], v192, s[48:51], s3 offen offset:2048 sc1
    buffer_load_dwordx4 v[172:175], v192, s[48:51], s3 offen offset:3072 sc1
    s_add_u32 s3, s78, 12288
    buffer_load_dwordx4 v[176:179], v192, s[48:51], s3 offen offset:0 sc1
    buffer_load_dwordx4 v[180:183], v192, s[48:51], s3 offen offset:1024 sc1
    buffer_load_dwordx4 v[184:187], v192, s[48:51], s3 offen offset:2048 sc1
    buffer_load_dwordx4 v[188:191], v192, s[48:51], s3 offen offset:3072 sc1
    s_waitcnt vmcnt(0)
    s_branch L_k6
L_k6k:
    v_pk_add_f32 v[128:129], v[128:129], v[160:161]
    v_pk_add_f32 v[130:131], v[130:131], v[162:163]
    v_pk_add_f32 v[132:133], v[132:133], v[164:165]
    v_pk_add_f32 v[134:135], v[134:135], v[166:167]
    v_pk_add_f32 v[136:137], v[136:137], v[168:169]
    v_pk_add_f32 v[138:139], v[138:139], v[170:171]
    v_pk_add_f32 v[140:141], v[140:141], v[172:173]
    v_pk_add_f32 v[142:143], v[142:143], v[174:175]
    v_pk_add_f32 v[144:145], v[144:145], v[176:177]
    v_pk_add_f32 v[146:147], v[146:147], v[178:179]
    v_pk_add_f32 v[148:149], v[148:149], v[180:181]
    v_pk_add_f32 v[150:151], v[150:151], v[182:183]
    v_pk_add_f32 v[152:153], v[152:153], v[184:185]
    v_pk_add_f32 v[154:155], v[154:155], v[186:187]
    v_pk_add_f32 v[156:157], v[156:157], v[188:189]
    v_pk_add_f32 v[158:159], v[158:159], v[190:191]
    v_pk_add_f32 v[128:129], v[128:129], v[144:145]
    v_pk_add_f32 v[130:131], v[130:131], v[146:147]
    v_pk_add_f32 v[132:133], v[132:133], v[148:149]
    v_pk_add_f32 v[134:135], v[134:135], v[150:151]
    v_pk_add_f32 v[136:137], v[136:137], v[152:153]
    v_pk_add_f32 v[138:139], v[138:139], v[154:155]
    v_pk_add_f32 v[140:141], v[140:141], v[156:157]
    v_pk_add_f32 v[142:143], v[142:143], v[158:159]
    v_pk_add_f32 v[128:129], v[128:129], v[136:137]
    v_pk_add_f32 v[130:131], v[130:131], v[138:139]
    v_pk_add_f32 v[132:133], v[132:133], v[140:141]
    v_pk_add_f32 v[134:135], v[134:135], v[142:143]
    v_pk_add_f32 v[128:129], v[128:129], v[132:133]
    v_pk_add_f32 v[130:131], v[130:131], v[134:135]
    s_nop 1
    v_permlane32_swap_b32 v128, v130
    v_permlane32_swap_b32 v129, v131
    v_add_f32 v128, v128, v130
    v_add_f32 v129, v129, v131
    s_nop 1
    v_permlane16_swap_b32 v128, v129
    v_add_f32 v128, v128, v129
    v_cvt_pk_bf16_f32 v128, v128, v128
    v_lshlrev_b32 v128, 16, v128
    v_mul_f32 v128, v128, v195
    v_lshlrev_b32 v194, 16, v194
    v_sub_f32 v194, v194, v250
    v_cvt_pk_bf16_f32 v128, v128, v128
    v_lshlrev_b32 v128, 16, v128
    v_cvt_pk_bf16_f32 v194, v194, v194
    v_lshlrev_b32 v194, 16, v194
    v_mul_f32 v194, v194, v251
    v_cvt_pk_bf16_f32 v194, v194, v194
    v_lshlrev_b32 v194, 16, v194
    v_add_f32 v128, v128, v194
    v_cvt_pk_bf16_f32 v128, v128, v128
    v_lshlrev_b32 v128, 16, v128
    v_mul_f32 v2, 0xbfb8aa3b, v128
    v_exp_f32 v2, v2
    s_nop 0
    v_add_f32 v2, 1.0, v2
    v_rcp_f32 v2, v2
    s_nop 0
    v_mul_f32 v2, v128, v2
    v_lshlrev_b32 v3, 2, v193
    ds_write_b32 v3, v2
    s_branch L_fx2r
L_r0:
    s_add_u32 s29, s29, 1
    s_cmp_ge_u32 s29, 200000
    s_cbranch_scc1 L_g0
    s_add_u32 s3, s76, 0
    buffer_load_dwordx4 v[40:43], v108, s[48:51], s3 offen offset:0 sc1
    buffer_load_dwordx4 v[44:47], v109, s[48:51], s3 offen offset:0 sc1
    s_waitcnt vmcnt(0)
    s_branch L_c0
L_r1:
    s_add_u32 s29, s29, 1
    s_cmp_ge_u32 s29, 200000
    s_cbranch_scc1 L_g1
    s_add_u32 s3, s76, 0
    buffer_load_dwordx4 v[48:51], v108, s[48:51], s3 offen offset:1024 sc1
    buffer_load_dwordx4 v[52:55], v109, s[48:51], s3 offen offset:1024 sc1
    s_waitcnt vmcnt(0)
    s_branch L_c1
L_r2:
    s_add_u32 s29, s29, 1
    s_cmp_ge_u32 s29, 200000
    s_cbranch_scc1 L_g2
    s_add_u32 s3, s76, 0
    buffer_load_dwordx4 v[56:59], v108, s[48:51], s3 offen offset:2048 sc1
    buffer_load_dwordx4 v[60:63], v109, s[48:51], s3 offen offset:2048 sc1
    s_waitcnt vmcnt(0)
    s_branch L_c2
L_r3:
    s_add_u32 s29, s29, 1
    s_cmp_ge_u32 s29, 200000
    s_cbranch_scc1 L_g3
    s_add_u32 s3, s76, 0
    buffer_load_dwordx4 v[64:67], v108, s[48:51], s3 offen offset:3072 sc1
    buffer_load_dwordx4 v[68:71], v109, s[48:51], s3 offen offset:3072 sc1
    s_waitcnt vmcnt(0)
    s_branch L_c3
L_r4:
    s_add_u32 s29, s29, 1
    s_cmp_ge_u32 s29, 200000
    s_cbranch_scc1 L_g4
    s_add_u32 s3, s76, 4096
    buffer_load_dwordx4 v[40:43], v108, s[48:51], s3 offen offset:0 sc1
    buffer_load_dwordx4 v[44:47], v109, s[48:51], s3 offen offset:0 sc1
    s_waitcnt vmcnt(0)
    s_branch L_c4
L_r5:
    s_add_u32 s29, s29, 1
    s_cmp_ge_u32 s29, 200000
    s_cbranch_scc1 L_g5
    s_add_u32 s3, s76, 4096
    buffer_load_dwordx4 v[48:51], v108, s[48:51], s3 offen offset:1024 sc1
    buffer_load_dwordx4 v[52:55], v109, s[48:51], s3 offen offset:1024 sc1
    s_waitcnt vmcnt(0)
    s_branch L_c5
L_r6:
    s_add_u32 s29, s29, 1
    s_cmp_ge_u32 s29, 200000
    s_cbranch_scc1 L_g6
    s_add_u32 s3, s76, 4096
    buffer_load_dwordx4 v[56:59], v108, s[48:51], s3 offen offset:2048 sc1
    buffer_load_dwordx4 v[60:63], v109, s[48:51], s3 offen offset:2048 sc1
    s_waitcnt vmcnt(0)
    s_branch L_c6
L_r7:
    s_add_u32 s29, s29, 1
    s_cmp_ge_u32 s29, 200000
    s_cbranch_scc1 L_g7
    s_add_u32 s3, s76, 4096
    buffer_load_dwordx4 v[64:67], v108, s[48:51], s3 offen offset:3072 sc1
    buffer_load_dwordx4 v[68:71], v109, s[48:51], s3 offen offset:3072 sc1
    s_waitcnt vmcnt(0)
    s_branch L_c7
L_r8:
    s_add_u32 s29, s29, 1
    s_cmp_ge_u32 s29, 200000
    s_cbranch_scc1 L_g8
    s_add_u32 s3, s76, 8192
    buffer_load_dwordx4 v[40:43], v108, s[48:51], s3 offen offset:0 sc1
    buffer_load_dwordx4 v[44:47], v109, s[48:51], s3 offen offset:0 sc1
    s_waitcnt vmcnt(0)
    s_branch L_c8
L_r9:
    s_add_u32 s29, s29, 1
    s_cmp_ge_u32 s29, 200000
    s_cbranch_scc1 L_g9
    s_add_u32 s3, s76, 8192
    buffer_load_dwordx4 v[48:51], v108, s[48:51], s3 offen offset:1024 sc1
    buffer_load_dwordx4 v[52:55], v109, s[48:51], s3 offen offset:1024 sc1
    s_waitcnt vmcnt(0)
    s_branch L_c9
L_r10:
    s_add_u32 s29, s29, 1
    s_cmp_ge_u32 s29, 200000
    s_cbranch_scc1 L_g10
    s_add_u32 s3, s76, 8192
    buffer_load_dwordx4 v[56:59], v108, s[48:51], s3 offen offset:2048 sc1
    buffer_load_dwordx4 v[60:63], v109, s[48:51], s3 offen offset:2048 sc1
    s_waitcnt vmcnt(0)
    s_branch L_c10
L_r11:
    s_add_u32 s29, s29, 1
    s_cmp_ge_u32 s29, 200000
    s_cbranch_scc1 L_g11
    s_add_u32 s3, s76, 8192
    buffer_load_dwordx4 v[64:67], v108, s[48:51], s3 offen offset:3072 sc1
    buffer_load_dwordx4 v[68:71], v109, s[48:51], s3 offen offset:3072 sc1
    s_waitcnt vmcnt(0)
    s_branch L_c11
L_r12:
    s_add_u32 s29, s29, 1
    s_cmp_ge_u32 s29, 200000
    s_cbranch_scc1 L_g12
    s_add_u32 s3, s76, 12288
    buffer_load_dwordx4 v[40:43], v108, s[48:51], s3 offen offset:0 sc1
    buffer_load_dwordx4 v[44:47], v109, s[48:51], s3 offen offset:0 sc1
    s_waitcnt vmcnt(0)
    s_branch L_c12
L_r13:
    s_add_u32 s29, s29, 1
    s_cmp_ge_u32 s29, 200000
    s_cbranch_scc1 L_g13
    s_add_u32 s3, s76, 12288
    buffer_load_dwordx4 v[48:51], v108, s[48:51], s3 offen offset:1024 sc1
    buffer_load_dwordx4 v[52:55], v109, s[48:51], s3 offen offset:1024 sc1
    s_waitcnt vmcnt(0)
    s_branch L_c13
L_r14:
    s_add_u32 s29, s29, 1
    s_cmp_ge_u32 s29, 200000
    s_cbranch_scc1 L_g14
    s_add_u32 s3, s76, 12288
    buffer_load_dwordx4 v[56:59], v108, s[48:51], s3 offen offset:2048 sc1
    buffer_load_dwordx4 v[60:63], v109, s[48:51], s3 offen offset:2048 sc1
    s_waitcnt vmcnt(0)
    s_branch L_c14
L_r15:
    s_add_u32 s29, s29, 1
    s_cmp_ge_u32 s29, 200000
    s_cbranch_scc1 L_g15
    s_add_u32 s3, s76, 12288
    buffer_load_dwordx4 v[64:67], v108, s[48:51], s3 offen offset:3072 sc1
    buffer_load_dwordx4 v[68:71], v109, s[48:51], s3 offen offset:3072 sc1
    s_waitcnt vmcnt(0)
    s_branch L_c15
.p2align 8
.fill 4096, 4, 0xbf800000
.section .rodata,"a"
.p2align 6
.amdhsa_kernel recurrent_scan__linear_kernel_hedgehog__moe_arch_mod__prompt_kernel
  .amdhsa_next_free_vgpr 256
  .amdhsa_next_free_sgpr 102
  .amdhsa_accum_offset 256
  .amdhsa_group_segment_fixed_size 0
  .amdhsa_kernarg_size 96
  .amdhsa_user_sgpr_count 2
  .amdhsa_user_sgpr_kernarg_segment_ptr 1
  .amdhsa_system_sgpr_workgroup_id_x 1
.end_amdhsa_kernel
```

```asm
; @launch grid=(256,1,1) block=(512,1,1) lds=163840
.amdgcn_target "amdgcn-amd-amdhsa--gfx950"
.text
.globl recurrent_scan__linear_kernel_hedgehog__moe_arch_mod__prompt_kernel
.p2align 8
.type recurrent_scan__linear_kernel_hedgehog__moe_arch_mod__prompt_kernel,@function
recurrent_scan__linear_kernel_hedgehog__moe_arch_mod__prompt_kernel:
    s_cmp_ge_u32 s2, 256
    s_cbranch_scc1 L_done
    s_load_dwordx16 s[4:19], s[0:1], 0
    s_load_dwordx8 s[20:27], s[0:1], 64
    v_and_b32 v1, 63, v0
    v_lshrrev_b32 v2, 6, v0
    s_nop 0
    v_readfirstlane_b32 s39, v2
    s_and_b32 s34, s2, 1
    s_lshl_b32 s34, s34, 3
    s_bfe_u32 s3, s2, 0x30003
    s_add_u32 s36, s34, s3
    s_bfe_u32 s37, s2, 0x20001
    s_lshl_b32 s37, s37, 2
    s_lshr_b32 s28, s2, 6
    s_add_u32 s37, s37, s28
    s_and_b32 s80, s37, 12
    s_xor_b32 s80, s80, s34
    s_add_u32 s85, s36, s37
    s_and_b32 s85, s85, 3
    s_add_u32 s3, s85, 3
    s_and_b32 s3, s3, 3
    s_xor_b32 s35, s80, 12
    s_or_b32 s35, s35, s3
    s_mov_b32 s34, s36
    s_and_b32 s38, s39, 3
    s_cmp_lt_u32 s39, 4
    s_cbranch_scc1 L_C
L_H:
    v_and_b32 v4, 7, v1
    s_lshl_b32 s33, s37, 7
    s_lshl_b32 s87, s85, 7
    s_lshl_b32 s66, s80, 7
    s_lshl_b32 s3, s36, 7
    s_lshl_b32 s28, s38, 5
    s_add_u32 s3, s3, s28
    v_lshrrev_b32 v7, 3, v1
    v_add_u32 v3, s3, v7
    v_lshlrev_b32 v3, 11, v3
    v_lshrrev_b32 v5, 4, v1
    v_xor_b32 v6, v4, v5
    v_xor_b32 v5, 4, v6
    v_lshl_add_u32 v6, v6, 4, v3
    v_lshl_add_u32 v5, v5, 4, v3
    v_add_u32_e64 v8, 0, v6
    v_add_u32 v9, 15360, v5
    v_add_u32 v10, 30720, v6
    v_add_u32 v11, 46080, v5
    s_lshr_b32 s32, s36, 1
    s_and_b32 s32, s32, 2
    s_xor_b32 s32, s32, s38
    s_lshl_b32 s3, s32, 4
    v_add_u32_e64 v7, s3, v7
    v_mul_u32_u24 v7, 6144, v7
    v_bfe_u32 v6, v1, 4, 1
    v_lshlrev_b32 v6, 1, v6
    v_xor_b32 v5, v4, v6
    v_add_u32 v7, s33, v7
    v_xor_b32 v6, 4, v5
    v_lshl_add_u32 v6, v6, 4, v7
    v_lshl_add_u32 v7, v5, 4, v7
    v_add_u32_e64 v12, 0, v7
    v_add_u32 v13, 48128, v6
    v_add_u32 v14, 2048, v7
    v_add_u32 v15, 50176, v6
    v_add_u32 v16, 4096, v7
    v_add_u32 v17, 52224, v6
    v_xor_b32 v12, 512, v12
    v_xor_b32 v13, 512, v13
    s_lshl_b32 s30, s38, 12
    s_lshl_b32 s31, s32, 11
    s_add_u32 s31, s31, 16384
    s_waitcnt lgkmcnt(0)
    s_mov_b32 s44, s6
    s_mov_b32 s45, s7
    s_mov_b32 s46, 6291456
    s_mov_b32 s47, 0x00020000
    s_mov_b32 s40, s4
    s_mov_b32 s41, s5
    s_mov_b32 s42, 4194304
    s_mov_b32 s43, 0x00020000
    v_lshlrev_b32 v252, 4, v1
    s_mov_b32 s48, s26
    s_mov_b32 s49, s27
    s_mov_b32 s50, 268435456
    s_mov_b32 s51, 0x00020000
    v_mov_b32 v19, 16384
    buffer_load_dword v19, v19, s[48:51], 0 offen sc1
    s_lshl_b32 s3, s36, 7
    s_lshl_b32 s28, s37, 3
    s_add_u32 s3, s3, s28
    s_lshl_b32 s3, s3, 11
    s_add_u32 s3, s3, s30
    s_add_u32 m0, s30, 131072
    s_nop 0
    buffer_load_dwordx4 v252, s[40:43], s3 offen offset:0 lds
    buffer_load_dwordx4 v252, s[40:43], s3 offen offset:2048 lds
    s_lshl_b32 s3, s36, 7
    s_lshl_b32 s28, s37, 3
    s_add_u32 s3, s3, s28
    s_lshl_b32 s3, s3, 11
    s_add_u32 s3, s3, s30
    s_add_u32 m0, s30, 131072
    s_nop 0
    buffer_load_dwordx4 v252, s[40:43], s3 offen offset:1024 lds
    buffer_load_dwordx4 v252, s[40:43], s3 offen offset:3072 lds
    s_mov_b32 s60, s14
    s_mov_b32 s61, s15
    s_mov_b32 s62, 2048
    s_mov_b32 s63, 0x00020000
    s_lshl_b32 s3, s38, 9
    s_add_u32 m0, s3, 122880
    s_mov_b32 exec_hi, 0
    buffer_load_dwordx4 v252, s[60:63], s3 offen lds
    s_mov_b64 exec, -1
    s_add_u32 s64, s87, 0
    s_and_b32 s64, s64, 511
    s_or_b32 s64, s64, 0
    s_xor_b32 s64, s64, s66
    s_mul_i32 s65, s64, 3072
    s_add_u32 m0, s31, 0
    s_nop 0
    buffer_load_dwordx4 v12, s[44:47], s65 offen offset:0 lds
    buffer_load_dwordx4 v13, s[44:47], s65 offen offset:1024 lds
    s_add_u32 m0, s31, 8192
    s_nop 0
    buffer_load_dwordx4 v14, s[44:47], s65 offen offset:0 lds
    buffer_load_dwordx4 v15, s[44:47], s65 offen offset:1024 lds
    s_add_u32 m0, s31, 16384
    s_nop 0
    buffer_load_dwordx4 v16, s[44:47], s65 offen offset:0 lds
    buffer_load_dwordx4 v17, s[44:47], s65 offen offset:1024 lds
    v_mov_b32 v248, -1
    v_mov_b32 v249, -1
    v_mov_b32 v250, -1
    v_mov_b32 v251, -1
    v_lshlrev_b32 v252, 4, v1
    s_and_b32 s85, s85, 0
    s_lshl_b32 s3, s37, 4
    s_add_u32 s3, s3, s36
    s_lshl_b32 s67, s3, 10
    s_add_u32 s67, s67, 524288
    s_lshl_b32 s3, s38, 8
    s_add_u32 s67, s67, s3
    v_mov_b32 v24, 0
    v_mov_b32 v25, 0
    v_mov_b32 v26, 0
    v_mov_b32 v27, 0
    v_mov_b32 v28, 0
    v_mov_b32 v29, 0
    v_mov_b32 v30, 0
    v_mov_b32 v31, 0
    v_lshlrev_b32 v253, 2, v1
    s_cmp_gt_u32 s37, 3
    s_subb_u32 s77, s37, 0
    s_cmp_gt_u32 s37, 11
    s_subb_u32 s77, s77, 0
    s_lshl_b32 s77, s77, 4
    s_add_u32 s77, s77, s36
    s_and_b32 s3, s37, 7
    s_cmp_eq_u32 s3, 3
    s_cselect_b32 s77, 224, s77
    s_bitcmp1_b32 s38, 0
    s_cselect_b32 s52, s18, s16
    s_cselect_b32 s53, s19, s17
    s_cmp_lt_u32 s77, 224
    s_cselect_b32 s54, 7340032, 0
    s_mov_b32 s55, 0x00020000
    s_mov_b32 s56, s20
    s_mov_b32 s57, s21
    s_mov_b32 s58, 7340032
    s_mov_b32 s59, 0x00020000
    s_and_b32 s3, s77, 3
    s_lshl_b32 s3, s3, 8
    s_lshr_b32 s28, s38, 1
    s_lshl_b32 s28, s28, 7
    s_add_u32 s3, s3, s28
    v_lshrrev_b32_e64 v5, 3, v1
    v_lshl_add_u32 v6, v5, 4, s3
    v_mul_u32_u24 v6, 7168, v6
    v_lshl_add_u32 v6, v4, 4, v6
    s_lshr_b32 s3, s77, 2
    s_lshl_b32 s3, s3, 7
    v_add_u32 v21, s3, v6
    s_lshr_b32 s3, s2, 4
    s_mul_i32 s3, s3, 224
    s_mul_i32 s28, s38, 56
    s_add_u32 s71, s3, s28
    v_lshlrev_b32 v6, 14, v5
    v_lshl_add_u32 v6, v4, 4, v6
    s_and_b32 s3, s2, 15
    s_lshl_b32 s3, s3, 7
    v_add_u32 v22, s3, v6
    v_lshrrev_b32 v2, 2, v1
    v_and_b32 v3, 3, v1
    v_lshlrev_b32 v3, 4, v3
    v_lshl_add_u32 v232, v2, 10, v3
    v_lshlrev_b32 v2, 3, v1
    v_add_u32 v230, 152064, v2
    v_and_b32_e64 v4, 49, v1
    v_bfe_u32 v7, v1, 1, 2
    v_lshl_add_u32 v4, v7, 2, v4
    v_bfe_u32 v7, v1, 3, 1
    v_lshl_add_u32 v4, v7, 1, v4
    v_lshlrev_b32 v4, 2, v4
    v_add_u32 v231, 154624, v4
    s_mul_i32 s3, s38, 48
    v_and_b32 v2, 15, v1
    v_lshrrev_b32 v3, 4, v1
    v_cmp_gt_u32 vcc, 12, v2
    v_lshl_add_u32 v4, v2, 2, s3
    v_add_u32 v2, v4, v3
    v_mov_b32 v5, 192
    v_cndmask_b32 v4, v5, v4, vcc
    v_lshlrev_b32 v4, 2, v4
    v_lshl_add_u32 v235, v3, 10, v4
    v_and_b32_e64 v5, 7, v2
    v_bfe_u32 v6, v2, 3, 3
    v_lshl_add_u32 v5, v5, 3, v6
    v_and_b32 v2, 0xc0, v2
    v_add_u32 v2, v2, v5
    v_lshlrev_b32 v2, 2, v2
    v_add_u32 v2, 154880, v2
    v_mov_b32 v5, 162048
    v_cndmask_b32 v233, v5, v2, vcc
    v_lshrrev_b32 v5, 3, v1
    v_lshlrev_b32 v6, 11, v5
    v_bfe_u32 v5, v1, 4, 2
    v_lshlrev_b32 v5, 1, v5
    v_and_b32 v7, 7, v1
    v_xor_b32 v5, v5, v7
    v_lshl_add_u32 v6, v5, 4, v6
    s_lshl_b32 s3, s35, 7
    v_add_u32 v6, s3, v6
    v_add_u32_e64 v220, 0, v6
    v_add_u32 v221, 15360, v6
    v_add_u32 v222, 30720, v6
    v_add_u32 v223, 46080, v6
    s_lshl_b32 s72, s38, 12
    s_lshl_b32 s73, s38, 16
    s_lshl_b32 s3, s36, 2
    s_add_u32 s3, s3, s38
    s_lshr_b32 s28, s3, 5
    s_and_b32 s3, s3, 31
    s_lshl_b32 s74, s3, 7
    s_lshl_b32 s3, s37, 1
    s_add_u32 s75, s3, s28
    v_lshrrev_b32 v5, 3, v1
    v_mul_u32_u24 v5, 4224, v5
    v_and_b32_e64 v7, 7, v1
    v_lshl_add_u32 v112, v7, 4, v5
    s_mul_i32 s76, s75, 67584
    s_add_u32 s76, s76, s74
    s_add_u32 s76, s76, 8388608
    s_mul_i32 s3, s75, 4224
    s_add_u32 s3, s3, s74
    s_add_u32 s74, s3, 1048576
    s_lshl_b32 s75, s37, 1
    s_add_u32 s75, s75, s36
    s_mul_i32 s81, s75, 67584
    s_add_u32 s81, s81, 8392704
    s_mul_i32 s82, s75, 4224
    s_add_u32 s82, s82, 1052672
    s_lshr_b32 s3, s36, 1
    s_or_b32 s83, s3, s38
    s_and_b32 s3, s38, 1
    s_lshl_b32 s3, s3, 3
    s_and_b32 s28, s77, 3
    s_lshl_b32 s28, s28, 1
    s_add_u32 s3, s3, s28
    s_lshr_b32 s28, s38, 1
    s_add_u32 s3, s3, s28
    s_mul_i32 s3, s3, 14336
    s_lshr_b32 s28, s77, 2
    s_lshl_b32 s28, s28, 8
    s_add_u32 s3, s3, s28
    s_add_u32 s3, s3, 1183744
    s_cmp_lt_u32 s77, 224
    s_cselect_b32 s84, s3, 268435456
    v_and_b32 v2, 15, v1
    v_bfe_u32 v3, v1, 4, 1
    v_mul_u32_u24 v3, 4, v3
    v_xor_b32_e64 v3, s37, v3
    v_lshl_add_u32 v3, v3, 4, v2
    v_lshl_add_u32 v2, v2, 4, s34
    v_cmp_gt_u32 vcc, 32, v1
    s_nop 1
    v_cndmask_b32 v2, v2, v3, vcc
    v_lshlrev_b32 v113, 7, v2
    s_lshl_b32 s3, s38, 1
    s_lshr_b32 s28, s39, 2
    s_add_u32 s3, s3, s28
    s_lshl_b32 s69, s3, 4
    v_and_b32 v2, 15, v1
    v_add_u32 v23, s69, v2
    v_lshlrev_b32 v23, 7, v23
    v_lshrrev_b32 v2, 1, v2
    v_lshrrev_b32 v3, 5, v1
    v_xor_b32 v2, v2, v3
    v_lshl_add_u32 v23, v2, 4, v23
    v_bfe_u32 v3, v1, 4, 1
    v_lshl_add_u32 v23, v3, 3, v23
    v_bfe_u32 v5, v1, 4, 1
    v_lshlrev_b32 v5, 5, v5
    v_xor_b32 v5, v5, v252
    s_min_u32 s3, s38, 2
    s_lshl_b32 s3, s3, 13
    s_and_b32 s28, s36, 4
    s_lshl_b32 s28, s28, 10
    s_add_u32 s3, s3, s28
    s_add_u32 s3, s3, 16384
    v_add_u32 v18, s3, v5
    s_lshr_b32 s3, s38, 1
    s_lshl_b32 s28, s37, 1
    s_add_u32 s28, s28, s3
    s_and_b32 s29, s38, 1
    s_lshl_b32 s3, s28, 4
    s_add_u32 s3, s3, s36
    s_mul_i32 s3, s3, 4224
    s_mul_i32 s78, s29, 2112
    s_add_u32 s78, s78, s3
    s_add_u32 s78, s78, 8388608
    s_lshl_b32 s3, s36, 1
    s_add_u32 s29, s29, s3
    s_xor_b32 s28, s28, 8
    s_lshl_b32 s3, s29, 7
    s_add_u32 s3, s3, s28
    s_lshl_b32 s3, s3, 10
    s_add_u32 s79, s3, 4194304
    s_mov_b32 s88, s10
    s_mov_b32 s89, s11
    s_mov_b32 s90, 2097152
    s_mov_b32 s91, 0x00020000
    s_add_u32 s64, s87, 0
    s_and_b32 s64, s64, 511
    s_or_b32 s64, s64, 0
    s_xor_b32 s64, s64, s66
    s_mul_i32 s65, s64, 3072
    s_add_u32 m0, s30, 0
    s_nop 0
    buffer_load_dwordx4 v8, s[40:43], s64 offen offset:0 lds
    buffer_load_dwordx4 v9, s[40:43], s64 offen offset:1024 lds
    buffer_load_dwordx4 v10, s[40:43], s64 offen offset:2048 lds
    buffer_load_dwordx4 v11, s[40:43], s64 offen offset:3072 lds
    s_waitcnt vmcnt(10)
    s_barrier
    s_add_u32 s64, s87, 128
    s_and_b32 s64, s64, 511
    s_or_b32 s64, s64, 0
    s_xor_b32 s64, s64, s66
    s_mul_i32 s65, s64, 3072
    s_add_u32 m0, s30, 40960
    s_nop 0
    buffer_load_dwordx4 v8, s[40:43], s64 offen offset:0 lds
    buffer_load_dwordx4 v9, s[40:43], s64 offen offset:1024 lds
    buffer_load_dwordx4 v10, s[40:43], s64 offen offset:2048 lds
    buffer_load_dwordx4 v11, s[40:43], s64 offen offset:3072 lds
    s_add_u32 m0, s31, 40960
    s_nop 0
    buffer_load_dwordx4 v12, s[44:47], s65 offen offset:0 lds
    buffer_load_dwordx4 v13, s[44:47], s65 offen offset:1024 lds
    s_add_u32 m0, s31, 49152
    s_nop 0
    buffer_load_dwordx4 v14, s[44:47], s65 offen offset:0 lds
    buffer_load_dwordx4 v15, s[44:47], s65 offen offset:1024 lds
    s_add_u32 m0, s31, 57344
    s_nop 0
    buffer_load_dwordx4 v16, s[44:47], s65 offen offset:0 lds
    buffer_load_dwordx4 v17, s[44:47], s65 offen offset:1024 lds
    v_readfirstlane_b32 s86, v19
    s_nop 0
    s_add_u32 s86, s86, 1
    s_waitcnt vmcnt(10)
    s_waitcnt lgkmcnt(0)
    s_barrier
    v_add_u32 v2, 0, v18
    v_xor_b32 v3, 64, v2
    ds_read_b128 v[32:35], v2 offset:0
    ds_read_b128 v[36:39], v3 offset:1024
    ds_read_b128 v[40:43], v2 offset:2048
    ds_read_b128 v[44:47], v3 offset:3072
    s_add_u32 s64, s87, 256
    s_and_b32 s64, s64, 511
    s_or_b32 s64, s64, 0
    s_xor_b32 s64, s64, s66
    s_mul_i32 s65, s64, 3072
    s_add_u32 m0, s30, 81920
    s_nop 0
    buffer_load_dwordx4 v8, s[40:43], s64 offen offset:0 lds
    buffer_load_dwordx4 v9, s[40:43], s64 offen offset:1024 lds
    buffer_load_dwordx4 v10, s[40:43], s64 offen offset:2048 lds
    buffer_load_dwordx4 v11, s[40:43], s64 offen offset:3072 lds
    s_add_u32 m0, s31, 81920
    s_nop 0
    buffer_load_dwordx4 v12, s[44:47], s65 offen offset:0 lds
    buffer_load_dwordx4 v13, s[44:47], s65 offen offset:1024 lds
    s_add_u32 m0, s31, 90112
    s_nop 0
    buffer_load_dwordx4 v14, s[44:47], s65 offen offset:0 lds
    buffer_load_dwordx4 v15, s[44:47], s65 offen offset:1024 lds
    s_add_u32 m0, s31, 98304
    s_nop 0
    buffer_load_dwordx4 v16, s[44:47], s65 offen offset:0 lds
    buffer_load_dwordx4 v17, s[44:47], s65 offen offset:1024 lds
    buffer_store_dwordx4 v[248:251], v252, s[48:51], s78 offen offset:0 sc1
    s_waitcnt vmcnt(11)
    s_waitcnt lgkmcnt(0)
    s_barrier
    s_add_u32 s64, s87, 384
    s_and_b32 s64, s64, 511
    s_or_b32 s64, s64, 0
    s_xor_b32 s64, s64, s66
    s_mul_i32 s65, s64, 3072
    s_add_u32 m0, s30, 0
    s_nop 0
    buffer_load_dwordx4 v8, s[40:43], s64 offen offset:0 lds
    buffer_load_dwordx4 v9, s[40:43], s64 offen offset:1024 lds
    v_lshlrev_b32 v2, 16, v32
    v_and_b32 v3, 0xffff0000, v32
    v_add_f32 v24, v24, v2
    v_add_f32 v25, v25, v3
    buffer_load_dwordx4 v10, s[40:43], s64 offen offset:2048 lds
    v_lshlrev_b32 v4, 16, v33
    v_and_b32 v5, 0xffff0000, v33
    v_add_f32 v26, v26, v4
    v_add_f32 v27, v27, v5
    buffer_load_dwordx4 v11, s[40:43], s64 offen offset:3072 lds
    v_lshlrev_b32 v2, 16, v34
    v_and_b32 v3, 0xffff0000, v34
    v_add_f32 v28, v28, v2
    v_add_f32 v29, v29, v3
    s_add_u32 m0, s31, 0
    s_nop 0
    buffer_load_dwordx4 v12, s[44:47], s65 offen offset:0 lds
    v_lshlrev_b32 v4, 16, v35
    v_and_b32 v5, 0xffff0000, v35
    v_add_f32 v30, v30, v4
    v_add_f32 v31, v31, v5
    buffer_load_dwordx4 v13, s[44:47], s65 offen offset:1024 lds
    v_lshlrev_b32 v2, 16, v36
    v_and_b32 v3, 0xffff0000, v36
    v_add_f32 v24, v24, v2
    v_add_f32 v25, v25, v3
    s_add_u32 m0, s31, 8192
    s_nop 0
    buffer_load_dwordx4 v14, s[44:47], s65 offen offset:0 lds
    v_lshlrev_b32 v4, 16, v37
    v_and_b32 v5, 0xffff0000, v37
    v_add_f32 v26, v26, v4
    v_add_f32 v27, v27, v5
    buffer_load_dwordx4 v15, s[44:47], s65 offen offset:1024 lds
    v_lshlrev_b32 v2, 16, v38
    v_and_b32 v3, 0xffff0000, v38
    v_add_f32 v28, v28, v2
    v_add_f32 v29, v29, v3
    s_add_u32 m0, s31, 16384
    s_nop 0
    buffer_load_dwordx4 v16, s[44:47], s65 offen offset:0 lds
    v_lshlrev_b32 v4, 16, v39
    v_and_b32 v5, 0xffff0000, v39
    v_add_f32 v30, v30, v4
    v_add_f32_e64 v31, v31, v5
    buffer_load_dwordx4 v17, s[44:47], s65 offen offset:1024 lds
    buffer_store_dwordx4 v[248:251], v252, s[48:51], s78 offen offset:1024 sc1
    s_mov_b64 exec, 15
    buffer_store_dwordx4 v[248:251], v252, s[48:51], s78 offen offset:2048 sc1
    s_mov_b64 exec, -1
    s_waitcnt vmcnt(13)
    s_waitcnt lgkmcnt(0)
    s_barrier
    s_add_u32 s64, s87, 0
    s_and_b32 s64, s64, 511
    s_or_b32 s64, s64, 512
    s_xor_b32 s64, s64, s66
    s_mul_i32 s65, s64, 3072
    s_add_u32 m0, s30, 40960
    s_nop 0
    buffer_load_dwordx4 v8, s[40:43], s64 offen offset:0 lds
    buffer_load_dwordx4 v9, s[40:43], s64 offen offset:1024 lds
    v_lshlrev_b32 v2, 16, v40
    v_and_b32 v3, 0xffff0000, v40
    v_add_f32 v24, v24, v2
    v_add_f32 v25, v25, v3
    buffer_load_dwordx4 v10, s[40:43], s64 offen offset:2048 lds
    v_lshlrev_b32 v4, 16, v41
    v_and_b32 v5, 0xffff0000, v41
    v_add_f32 v26, v26, v4
    v_add_f32 v27, v27, v5
    buffer_load_dwordx4 v11, s[40:43], s64 offen offset:3072 lds
    v_lshlrev_b32 v2, 16, v42
    v_and_b32 v3, 0xffff0000, v42
    v_add_f32 v28, v28, v2
    v_add_f32 v29, v29, v3
    s_add_u32 m0, s31, 40960
    s_nop 0
    buffer_load_dwordx4 v12, s[44:47], s65 offen offset:0 lds
    v_lshlrev_b32 v4, 16, v43
    v_and_b32 v5, 0xffff0000, v43
    v_add_f32 v30, v30, v4
    v_add_f32 v31, v31, v5
    buffer_load_dwordx4 v13, s[44:47], s65 offen offset:1024 lds
    v_lshlrev_b32 v2, 16, v44
    v_and_b32 v3, 0xffff0000, v44
    v_add_f32 v24, v24, v2
    v_add_f32 v25, v25, v3
    s_add_u32 m0, s31, 49152
    s_nop 0
    buffer_load_dwordx4 v14, s[44:47], s65 offen offset:0 lds
    v_lshlrev_b32 v4, 16, v45
    v_and_b32 v5, 0xffff0000, v45
    v_add_f32 v26, v26, v4
    v_add_f32 v27, v27, v5
    buffer_load_dwordx4 v15, s[44:47], s65 offen offset:1024 lds
    v_lshlrev_b32 v2, 16, v46
    v_and_b32 v3, 0xffff0000, v46
    v_add_f32 v28, v28, v2
    v_add_f32 v29, v29, v3
    s_add_u32 m0, s31, 57344
    s_nop 0
    buffer_load_dwordx4 v16, s[44:47], s65 offen offset:0 lds
    v_lshlrev_b32 v4, 16, v47
    v_and_b32 v5, 0xffff0000, v47
    v_add_f32 v30, v30, v4
    v_add_f32 v31, v31, v5
    buffer_load_dwordx4 v17, s[44:47], s65 offen offset:1024 lds
    s_waitcnt vmcnt(12)
    s_waitcnt lgkmcnt(0)
    s_barrier
    s_add_u32 s64, s87, 128
    s_and_b32 s64, s64, 511
    s_or_b32 s64, s64, 512
    s_xor_b32 s64, s64, s66
    s_mul_i32 s65, s64, 3072
    s_add_u32 m0, s30, 81920
    s_nop 0
    buffer_load_dwordx4 v8, s[40:43], s64 offen offset:0 lds
    buffer_load_dwordx4 v9, s[40:43], s64 offen offset:1024 lds
    buffer_load_dwordx4 v10, s[40:43], s64 offen offset:2048 lds
    buffer_load_dwordx4 v11, s[40:43], s64 offen offset:3072 lds
    s_add_u32 m0, s31, 81920
    s_nop 0
    buffer_load_dwordx4 v12, s[44:47], s65 offen offset:0 lds
    buffer_load_dwordx4 v13, s[44:47], s65 offen offset:1024 lds
    s_add_u32 m0, s31, 90112
    s_nop 0
    buffer_load_dwordx4 v14, s[44:47], s65 offen offset:0 lds
    buffer_load_dwordx4 v15, s[44:47], s65 offen offset:1024 lds
    s_add_u32 m0, s31, 98304
    s_nop 0
    buffer_load_dwordx4 v16, s[44:47], s65 offen offset:0 lds
    buffer_load_dwordx4 v17, s[44:47], s65 offen offset:1024 lds
    s_waitcnt vmcnt(10)
    s_waitcnt lgkmcnt(0)
    s_barrier
    v_add_u32 v2, 40960, v18
    v_xor_b32_e64 v3, 64, v2
    ds_read_b128 v[48:51], v2 offset:0
    ds_read_b128 v[52:55], v3 offset:1024
    ds_read_b128 v[56:59], v2 offset:2048
    ds_read_b128 v[60:63], v3 offset:3072
    s_add_u32 s64, s87, 256
    s_and_b32 s64, s64, 511
    s_or_b32 s64, s64, 512
    s_xor_b32 s64, s64, s66
    s_mul_i32 s65, s64, 3072
    s_add_u32 m0, s30, 0
    s_nop 0
    buffer_load_dwordx4 v8, s[40:43], s64 offen offset:0 lds
    buffer_load_dwordx4 v9, s[40:43], s64 offen offset:1024 lds
    buffer_load_dwordx4 v10, s[40:43], s64 offen offset:2048 lds
    buffer_load_dwordx4 v11, s[40:43], s64 offen offset:3072 lds
    s_add_u32 m0, s31, 0
    s_nop 0
    buffer_load_dwordx4 v12, s[44:47], s65 offen offset:0 lds
    buffer_load_dwordx4 v13, s[44:47], s65 offen offset:1024 lds
    s_add_u32 m0, s31, 8192
    s_nop 0
    buffer_load_dwordx4 v14, s[44:47], s65 offen offset:0 lds
    buffer_load_dwordx4 v15, s[44:47], s65 offen offset:1024 lds
    s_add_u32 m0, s31, 16384
    s_nop 0
    buffer_load_dwordx4 v16, s[44:47], s65 offen offset:0 lds
    buffer_load_dwordx4 v17, s[44:47], s65 offen offset:1024 lds
    s_lshl_b32 s3, s36, 10
    buffer_load_dwordx4 v[72:75], v252, s[48:51], s3 offen sc1
    s_lshl_b32 s3, s37, 6
    buffer_load_dword v76, v232, s[48:51], s3 offen offset:12 sc1
    s_waitcnt vmcnt(12)
    s_waitcnt lgkmcnt(0)
    s_barrier
    s_add_u32 s64, s87, 384
    s_and_b32 s64, s64, 511
    s_or_b32 s64, s64, 512
    s_xor_b32 s64, s64, s66
    s_mul_i32 s65, s64, 3072
    s_add_u32 m0, s30, 40960
    s_nop 0
    buffer_load_dwordx4 v8, s[40:43], s64 offen offset:0 lds
    buffer_load_dwordx4 v9, s[40:43], s64 offen offset:1024 lds
    v_lshlrev_b32 v2, 16, v48
    v_and_b32 v3, 0xffff0000, v48
    v_add_f32 v24, v24, v2
    v_add_f32 v25, v25, v3
    buffer_load_dwordx4 v10, s[40:43], s64 offen offset:2048 lds
    v_lshlrev_b32 v4, 16, v49
    v_and_b32 v5, 0xffff0000, v49
    v_add_f32 v26, v26, v4
    v_add_f32 v27, v27, v5
    buffer_load_dwordx4 v11, s[40:43], s64 offen offset:3072 lds
    v_lshlrev_b32 v2, 16, v50
    v_and_b32 v3, 0xffff0000, v50
    v_add_f32 v28, v28, v2
    v_add_f32 v29, v29, v3
    s_add_u32 m0, s31, 40960
    s_nop 0
    buffer_load_dwordx4 v12, s[44:47], s65 offen offset:0 lds
    v_lshlrev_b32 v4, 16, v51
    v_and_b32 v5, 0xffff0000, v51
    v_add_f32 v30, v30, v4
    v_add_f32 v31, v31, v5
    buffer_load_dwordx4 v13, s[44:47], s65 offen offset:1024 lds
    v_lshlrev_b32 v2, 16, v52
    v_and_b32 v3, 0xffff0000, v52
    v_add_f32 v24, v24, v2
    v_add_f32 v25, v25, v3
    s_add_u32 m0, s31, 49152
    s_nop 0
    buffer_load_dwordx4 v14, s[44:47], s65 offen offset:0 lds
    v_lshlrev_b32 v4, 16, v53
    v_and_b32 v5, 0xffff0000, v53
    v_add_f32 v26, v26, v4
    v_add_f32 v27, v27, v5
    buffer_load_dwordx4 v15, s[44:47], s65 offen offset:1024 lds
    v_lshlrev_b32 v2, 16, v54
    v_and_b32 v3, 0xffff0000, v54
    v_add_f32 v28, v28, v2
    v_add_f32 v29, v29, v3
    s_add_u32 m0, s31, 57344
    s_nop 0
    buffer_load_dwordx4 v16, s[44:47], s65 offen offset:0 lds
    v_lshlrev_b32 v4, 16, v55
    v_and_b32 v5, 0xffff0000, v55
    v_add_f32 v30, v30, v4
    v_add_f32 v31, v31, v5
    buffer_load_dwordx4 v17, s[44:47], s65 offen offset:1024 lds
    s_add_u32 s3, s79, 0
    buffer_store_dwordx4 v[248:251], v252, s[48:51], s3 offen sc1
    s_add_u32 s3, s79, 32768
    buffer_store_dwordx4 v[248:251], v252, s[48:51], s3 offen sc1
    s_waitcnt vmcnt(14)
    s_waitcnt lgkmcnt(0)
    s_barrier
    s_waitcnt vmcnt(12)
    s_mov_b32 s29, 0
L_k1:
    v_cmp_ne_u32 vcc, s86, v75
    v_cmp_ne_u32 s[92:93], s86, v76
    s_nop 0
    s_or_b64 vcc, vcc, s[92:93]
    s_cbranch_vccz L_k1k
    s_add_u32 s29, s29, 1
    s_cmp_ge_u32 s29, 200000
    s_cbranch_scc1 L_k1k
    s_sleep 2
    s_lshl_b32 s3, s36, 10
    buffer_load_dwordx4 v[72:75], v252, s[48:51], s3 offen sc1
    s_lshl_b32 s3, s37, 6
    buffer_load_dword v76, v232, s[48:51], s3 offen offset:12 sc1
    s_waitcnt vmcnt(0)
    s_branch L_k1
L_k1k:
    s_add_u32 s64, s87, 0
    s_and_b32 s64, s64, 511
    s_or_b32 s64, s64, 1024
    s_xor_b32 s64, s64, s66
    s_mul_i32 s65, s64, 3072
    s_add_u32 m0, s30, 81920
    s_nop 0
    buffer_load_dwordx4 v8, s[40:43], s64 offen offset:0 lds
    buffer_load_dwordx4 v9, s[40:43], s64 offen offset:1024 lds
    v_lshlrev_b32 v2, 16, v56
    v_and_b32 v3, 0xffff0000, v56
    v_add_f32 v24, v24, v2
    v_add_f32 v25, v25, v3
    buffer_load_dwordx4 v10, s[40:43], s64 offen offset:2048 lds
    v_lshlrev_b32 v4, 16, v57
    v_and_b32 v5, 0xffff0000, v57
    v_add_f32 v26, v26, v4
    v_add_f32 v27, v27, v5
    buffer_load_dwordx4 v11, s[40:43], s64 offen offset:3072 lds
    v_lshlrev_b32 v2, 16, v58
    v_and_b32 v3, 0xffff0000, v58
    v_add_f32 v28, v28, v2
    v_add_f32 v29, v29, v3
    s_add_u32 m0, s31, 81920
    s_nop 0
    buffer_load_dwordx4 v12, s[44:47], s65 offen offset:0 lds
    v_lshlrev_b32 v4, 16, v59
    v_and_b32 v5, 0xffff0000, v59
    v_add_f32 v30, v30, v4
    v_add_f32 v31, v31, v5
    buffer_load_dwordx4 v13, s[44:47], s65 offen offset:1024 lds
    v_lshlrev_b32 v2, 16, v60
    v_and_b32 v3, 0xffff0000, v60
    v_add_f32 v24, v24, v2
    v_add_f32 v25, v25, v3
    s_add_u32 m0, s31, 90112
    s_nop 0
    buffer_load_dwordx4 v14, s[44:47], s65 offen offset:0 lds
    v_lshlrev_b32 v4, 16, v61
    v_and_b32 v5, 0xffff0000, v61
    v_add_f32 v26, v26, v4
    v_add_f32 v27, v27, v5
    buffer_load_dwordx4 v15, s[44:47], s65 offen offset:1024 lds
    v_lshlrev_b32 v2, 16, v62
    v_and_b32 v3, 0xffff0000, v62
    v_add_f32 v28, v28, v2
    v_add_f32 v29, v29, v3
    s_add_u32 m0, s31, 98304
    s_nop 0
    buffer_load_dwordx4 v16, s[44:47], s65 offen offset:0 lds
    v_lshlrev_b32 v4, 16, v63
    v_and_b32 v5, 0xffff0000, v63
    v_add_f32 v30, v30, v4
    v_add_f32 v31, v31, v5
    buffer_load_dwordx4 v17, s[44:47], s65 offen offset:1024 lds
    s_waitcnt vmcnt(12)
    s_waitcnt lgkmcnt(0)
    s_barrier
    v_max_u32 v74, v74, v74 quad_perm:[1,0,3,2] row_mask:0xf bank_mask:0xf
    s_nop 1
    v_max_u32 v74, v74, v74 quad_perm:[2,3,0,1] row_mask:0xf bank_mask:0xf
    s_nop 1
    v_max_u32 v74, v74, v74 row_half_mirror row_mask:0xf bank_mask:0xf
    s_nop 1
    v_max_u32 v74, v74, v74 row_mirror row_mask:0xf bank_mask:0xf
    v_and_b32 v2, 0xffff0000, v72
    v_lshlrev_b32 v224, 16, v72
    v_and_b32 v3, 0xffff0000, v73
    v_lshlrev_b32 v225, 16, v73
    v_rcp_f32 v226, v2
    v_rcp_f32 v227, v3
    v_lshrrev_b32 v2, 16, v2
    v_or_b32 v236, v2, v3
    v_mul_f32 v228, 1069066811, v226
    v_mul_f32 v229, 1069066811, v227
    v_readlane_b32 s70, v74, 0
    v_readlane_b32 s3, v74, 16
    v_readlane_b32 s28, v74, 32
    v_readlane_b32 s29, v74, 48
    s_max_u32 s70, s70, s3
    s_max_u32 s28, s28, s29
    s_max_u32 s70, s70, s28
    v_permlane32_swap_b32 v24, v28
    v_permlane32_swap_b32 v25, v29
    v_permlane32_swap_b32 v26, v30
    v_permlane32_swap_b32 v27, v31
    v_add_f32 v24, v24, v28
    v_add_f32 v25, v25, v29
    v_add_f32 v26, v26, v30
    v_add_f32 v27, v27, v31
    s_nop 0
    v_permlane16_swap_b32 v24, v26
    v_permlane16_swap_b32 v25, v27
    v_add_f32 v24, v24, v26
    v_add_f32_e64 v25, v25, v27
    s_nop 0
    v_add_f32 v24, v24, v24 row_ror:8 row_mask:0xf bank_mask:0xf
    v_add_f32 v25, v25, v25 row_ror:8 row_mask:0xf bank_mask:0xf
    v_and_b32 v2, 8, v1
    v_cmp_eq_u32 vcc, 0, v2
    s_nop 1
    v_cndmask_b32 v24, v25, v24, vcc
    s_cmp_eq_u32 s38, 3
    s_cselect_b64 exec, -1, 0
    v_mov_b32 v24, s70
    s_mov_b64 exec, -1
    buffer_store_dword v24, v253, s[48:51], s67 offen sc1
    s_add_u32 s64, s87, 128
    s_and_b32 s64, s64, 511
    s_or_b32 s64, s64, 1024
    s_xor_b32 s64, s64, s66
    s_mul_i32 s65, s64, 3072
    s_add_u32 m0, s30, 0
    s_nop 0
    buffer_load_dwordx4 v8, s[40:43], s64 offen offset:0 lds
    buffer_load_dwordx4 v9, s[40:43], s64 offen offset:1024 lds
    buffer_load_dwordx4 v10, s[40:43], s64 offen offset:2048 lds
    buffer_load_dwordx4 v11, s[40:43], s64 offen offset:3072 lds
    s_add_u32 m0, s31, 0
    s_nop 0
    buffer_load_dwordx4 v12, s[44:47], s65 offen offset:0 lds
    buffer_load_dwordx4 v13, s[44:47], s65 offen offset:1024 lds
    s_add_u32 m0, s31, 8192
    s_nop 0
    buffer_load_dwordx4 v14, s[44:47], s65 offen offset:0 lds
    buffer_load_dwordx4 v15, s[44:47], s65 offen offset:1024 lds
    s_add_u32 m0, s31, 16384
    s_nop 0
    buffer_load_dwordx4 v16, s[44:47], s65 offen offset:0 lds
    buffer_load_dwordx4 v17, s[44:47], s65 offen offset:1024 lds
    s_waitcnt vmcnt(11)
    s_waitcnt lgkmcnt(0)
    s_barrier
    s_add_u32 s64, s87, 256
    s_and_b32 s64, s64, 511
    s_or_b32 s64, s64, 1024
    s_xor_b32 s64, s64, s66
    s_mul_i32 s65, s64, 3072
    s_add_u32 m0, s30, 40960
    s_nop 0
    buffer_load_dwordx4 v8, s[40:43], s64 offen offset:0 lds
    buffer_load_dwordx4 v9, s[40:43], s64 offen offset:1024 lds
    buffer_load_dwordx4 v10, s[40:43], s64 offen offset:2048 lds
    buffer_load_dwordx4 v11, s[40:43], s64 offen offset:3072 lds
    s_add_u32 m0, s31, 40960
    s_nop 0
    buffer_load_dwordx4 v12, s[44:47], s65 offen offset:0 lds
    buffer_load_dwordx4 v13, s[44:47], s65 offen offset:1024 lds
    s_add_u32 m0, s31, 49152
    s_nop 0
    buffer_load_dwordx4 v14, s[44:47], s65 offen offset:0 lds
    buffer_load_dwordx4 v15, s[44:47], s65 offen offset:1024 lds
    s_add_u32 m0, s31, 57344
    s_nop 0
    buffer_load_dwordx4 v16, s[44:47], s65 offen offset:0 lds
    buffer_load_dwordx4 v17, s[44:47], s65 offen offset:1024 lds
    s_mov_b32 s60, s8
    s_mov_b32 s61, s9
    s_mov_b32 s62, 65536
    s_mov_b32 s63, 0x00020000
    s_lshl_b32 s3, s38, 10
    s_add_u32 m0, s3, 147712
    s_lshl_b32 s28, s37, 12
    s_add_u32 s3, s3, s28
    buffer_load_dwordx4 v252, s[60:63], s3 offen lds
    s_add_u32 m0, m0, 8192
    s_xor_b32 s3, s3, 16384
    buffer_load_dwordx4 v252, s[60:63], s3 offen lds
    s_lshl_b32 s3, s2, 13
    s_lshl_b32 s28, s38, 11
    s_add_u32 s3, s3, s28
    v_lshlrev_b32 v3, 7, v1
    s_mov_b64 exec, 0xffff
    buffer_load_dword v20, v3, s[88:91], s3 offen
    s_mov_b64 exec, -1
    s_mov_b32 s3, 0
    buffer_load_dwordx4 v[128:131], v21, s[52:55], s3 offen nt
    s_mov_b32 s3, 7168
    buffer_load_dwordx4 v[132:135], v21, s[52:55], s3 offen nt
    s_mov_b32 s3, 14336
    buffer_load_dwordx4 v[136:139], v21, s[52:55], s3 offen nt
    s_mov_b32 s3, 21504
    buffer_load_dwordx4 v[140:143], v21, s[52:55], s3 offen nt
    s_mov_b32 s3, 28672
    buffer_load_dwordx4 v[144:147], v21, s[52:55], s3 offen nt
    s_mov_b32 s3, 35840
    buffer_load_dwordx4 v[148:151], v21, s[52:55], s3 offen nt
    s_waitcnt vmcnt(19)
    s_waitcnt lgkmcnt(0)
    s_barrier
    s_add_u32 s64, s87, 384
    s_and_b32 s64, s64, 511
    s_or_b32 s64, s64, 1024
    s_xor_b32 s64, s64, s66
    s_mul_i32 s65, s64, 3072
    s_add_u32 m0, s30, 81920
    s_nop 0
    buffer_load_dwordx4 v8, s[40:43], s64 offen offset:0 lds
    buffer_load_dwordx4 v9, s[40:43], s64 offen offset:1024 lds
    buffer_load_dwordx4 v10, s[40:43], s64 offen offset:2048 lds
    buffer_load_dwordx4 v11, s[40:43], s64 offen offset:3072 lds
    s_add_u32 m0, s31, 81920
    s_nop 0
    buffer_load_dwordx4 v12, s[44:47], s65 offen offset:0 lds
    buffer_load_dwordx4 v13, s[44:47], s65 offen offset:1024 lds
    s_add_u32 m0, s31, 90112
    s_nop 0
    buffer_load_dwordx4 v14, s[44:47], s65 offen offset:0 lds
    buffer_load_dwordx4 v15, s[44:47], s65 offen offset:1024 lds
    s_add_u32 m0, s31, 98304
    s_nop 0
    buffer_load_dwordx4 v16, s[44:47], s65 offen offset:0 lds
    buffer_load_dwordx4 v17, s[44:47], s65 offen offset:1024 lds
    s_lshl_b32 s3, s37, 14
    s_add_u32 s3, s3, 524288
    s_add_u32 s28, s3, 0
    buffer_load_dwordx4 v[80:83], v235, s[48:51], s28 offen sc1
    s_add_u32 s28, s3, 4096
    buffer_load_dwordx4 v[84:87], v235, s[48:51], s28 offen sc1
    s_waitcnt vmcnt(21)
    s_waitcnt lgkmcnt(0)
    s_barrier
    s_lshl_b32 s3, s37, 14
    s_add_u32 s3, s3, 524288
    s_add_u32 s28, s3, 8192
    buffer_load_dwordx4 v[88:91], v235, s[48:51], s28 offen sc1
    s_add_u32 s28, s3, 12288
    buffer_load_dwordx4 v[92:95], v235, s[48:51], s28 offen sc1
    s_add_u32 s64, s87, 0
    s_and_b32 s64, s64, 511
    s_or_b32 s64, s64, 1536
    s_xor_b32 s64, s64, s66
    s_mul_i32 s65, s64, 3072
    s_add_u32 m0, s30, 0
    s_nop 0
    buffer_load_dwordx4 v8, s[40:43], s64 offen offset:0 lds
    buffer_load_dwordx4 v9, s[40:43], s64 offen offset:1024 lds
    buffer_load_dwordx4 v10, s[40:43], s64 offen offset:2048 lds
    buffer_load_dwordx4 v11, s[40:43], s64 offen offset:3072 lds
    s_add_u32 m0, s31, 0
    s_nop 0
    buffer_load_dwordx4 v12, s[44:47], s65 offen offset:0 lds
    buffer_load_dwordx4 v13, s[44:47], s65 offen offset:1024 lds
    s_add_u32 m0, s31, 8192
    s_nop 0
    buffer_load_dwordx4 v14, s[44:47], s65 offen offset:0 lds
    buffer_load_dwordx4 v15, s[44:47], s65 offen offset:1024 lds
    s_add_u32 m0, s31, 16384
    s_nop 0
    buffer_load_dwordx4 v16, s[44:47], s65 offen offset:0 lds
    buffer_load_dwordx4 v17, s[44:47], s65 offen offset:1024 lds
    s_waitcnt vmcnt(14)
    s_waitcnt lgkmcnt(0)
    s_barrier
    s_waitcnt vmcnt(10)
    s_mov_b32 s29, 0
L_k2:
    s_nop 0
    v_max3_u32 v2, v80, v81, v82
    v_max3_u32 v2, v2, v83, v84
    v_max3_u32 v2, v2, v85, v86
    v_max3_u32 v2, v2, v87, v88
    v_max3_u32 v2, v2, v89, v90
    v_max3_u32 v2, v2, v91, v92
    v_max3_u32 v2, v2, v93, v94
    v_max_u32 v2, v2, v95
    v_cmp_eq_u32 vcc, -1, v2
    s_cbranch_vccz L_k2k
    s_add_u32 s29, s29, 1
    s_cmp_ge_u32 s29, 200000
    s_cbranch_scc1 L_k2k
    s_sleep 1
    s_lshl_b32 s3, s37, 14
    s_add_u32 s3, s3, 524288
    s_add_u32 s28, s3, 0
    buffer_load_dwordx4 v[80:83], v235, s[48:51], s28 offen sc1
    s_add_u32 s28, s3, 4096
    buffer_load_dwordx4 v[84:87], v235, s[48:51], s28 offen sc1
    s_add_u32 s28, s3, 8192
    buffer_load_dwordx4 v[88:91], v235, s[48:51], s28 offen sc1
    s_add_u32 s28, s3, 12288
    buffer_load_dwordx4 v[92:95], v235, s[48:51], s28 offen sc1
    s_waitcnt vmcnt(0)
    s_branch L_k2
L_k2k:
    v_max3_u32 v2, v80, v84, v88
    v_max_u32 v2, v2, v92
    v_add_f32 v80, v80, v88
    v_add_f32 v81, v81, v89
    v_add_f32 v82, v82, v90
    v_add_f32 v83, v83, v91
    v_add_f32 v84, v84, v92
    v_add_f32 v85, v85, v93
    v_add_f32 v86, v86, v94
    v_add_f32 v87, v87, v95
    v_add_f32 v80, v80, v84
    v_add_f32 v81, v81, v85
    v_add_f32 v82, v82, v86
    v_add_f32_e64 v83, v83, v87
    v_readlane_b32 s70, v2, 12
    v_readlane_b32 s3, v2, 28
    v_readlane_b32 s28, v2, 44
    v_readlane_b32 s29, v2, 60
    s_max_u32 s70, s70, s3
    s_max_u32 s28, s28, s29
    s_max_u32 s70, s70, s28
    v_permlane32_swap_b32 v80, v82
    v_permlane32_swap_b32 v81, v83
    v_add_f32 v80, v80, v82
    v_add_f32 v81, v81, v83
    s_nop 1
    v_permlane16_swap_b32 v80, v81
    v_add_f32 v80, v80, v81
    s_mov_b32 exec_lo, 0xf000f000
    s_mov_b32 exec_hi, 0xf000f000
    v_mov_b32 v80, s70
    s_mov_b64 exec, -1
    s_and_b32 s68, s70, 0x7ff
    s_sub_u32 s68, 2047, s68
    s_lshl_b32 s3, s68, 11
    s_and_b32 s28, s77, 3
    s_lshl_b32 s28, s28, 9
    s_add_u32 s3, s3, s28
    s_lshr_b32 s28, s38, 1
    s_lshl_b32 s28, s28, 8
    s_add_u32 s3, s3, s28
    v_lshrrev_b32 v3, 3, v1
    v_lshlrev_b32_e64 v3, 5, v3
    buffer_load_dwordx4 v[64:67], v3, s[40:43], s3 offen
    buffer_load_dwordx4 v[68:71], v3, s[40:43], s3 offen offset:16
    s_lshr_b32 s3, s68, 1
    s_lshl_b32 s3, s3, 4
    s_and_b32 s28, s68, 1
    s_lshl_b32 s28, s28, 2
    s_add_u32 s3, s3, s28
    v_mov_b32 v3, 0
    buffer_load_dword v116, v3, s[48:51], s3 offen sc1
    s_add_u32 s64, s87, 128
    s_and_b32 s64, s64, 511
    s_or_b32 s64, s64, 1536
    s_xor_b32 s64, s64, s66
    s_mul_i32 s65, s64, 3072
    s_add_u32 m0, s30, 40960
    s_nop 0
    buffer_load_dwordx4 v8, s[40:43], s64 offen offset:0 lds
    buffer_load_dwordx4 v9, s[40:43], s64 offen offset:1024 lds
    buffer_load_dwordx4 v10, s[40:43], s64 offen offset:2048 lds
    buffer_load_dwordx4 v11, s[40:43], s64 offen offset:3072 lds
    s_add_u32 m0, s31, 40960
    s_nop 0
    buffer_load_dwordx4 v12, s[44:47], s65 offen offset:0 lds
    buffer_load_dwordx4 v13, s[44:47], s65 offen offset:1024 lds
    s_add_u32 m0, s31, 49152
    s_nop 0
    buffer_load_dwordx4 v14, s[44:47], s65 offen offset:0 lds
    buffer_load_dwordx4 v15, s[44:47], s65 offen offset:1024 lds
    s_add_u32 m0, s31, 57344
    s_nop 0
    buffer_load_dwordx4 v16, s[44:47], s65 offen offset:0 lds
    buffer_load_dwordx4 v17, s[44:47], s65 offen offset:1024 lds
    s_waitcnt vmcnt(13)
    s_waitcnt lgkmcnt(0)
    s_barrier
    s_add_u32 s64, s87, 256
    s_and_b32 s64, s64, 511
    s_or_b32 s64, s64, 1536
    s_xor_b32 s64, s64, s66
    s_mul_i32 s65, s64, 3072
    s_add_u32 m0, s30, 81920
    s_nop 0
    buffer_load_dwordx4 v8, s[40:43], s64 offen offset:0 lds
    buffer_load_dwordx4 v9, s[40:43], s64 offen offset:1024 lds
    buffer_load_dwordx4 v10, s[40:43], s64 offen offset:2048 lds
    buffer_load_dwordx4 v11, s[40:43], s64 offen offset:3072 lds
    s_add_u32 m0, s31, 81920
    s_nop 0
    buffer_load_dwordx4 v12, s[44:47], s65 offen offset:0 lds
    buffer_load_dwordx4 v13, s[44:47], s65 offen offset:1024 lds
    s_add_u32 m0, s31, 90112
    s_nop 0
    buffer_load_dwordx4 v14, s[44:47], s65 offen offset:0 lds
    buffer_load_dwordx4 v15, s[44:47], s65 offen offset:1024 lds
    s_add_u32 m0, s31, 98304
    s_nop 0
    buffer_load_dwordx4 v16, s[44:47], s65 offen offset:0 lds
    buffer_load_dwordx4 v17, s[44:47], s65 offen offset:1024 lds
    s_or_b32 s3, s2, s38
    s_mov_b32 s28, 16384
    s_cmp_lg_u32 s3, 0
    s_cselect_b32 s3, 268435456, s28
    v_mov_b32 v2, s86
    s_mov_b64 exec, 1
    buffer_store_dword v2, v252, s[48:51], s3 offen sc1
    s_mov_b64 exec, -1
    s_add_u32 s3, s79, 65536
    buffer_store_dwordx4 v[248:251], v252, s[48:51], s3 offen sc1
    s_add_u32 s3, s79, 98304
    buffer_store_dwordx4 v[248:251], v252, s[48:51], s3 offen sc1
    s_waitcnt vmcnt(13)
    s_waitcnt lgkmcnt(0)
    s_barrier
    s_add_u32 s64, s87, 384
    s_and_b32 s64, s64, 511
    s_or_b32 s64, s64, 1536
    s_xor_b32 s64, s64, s66
    s_mul_i32 s65, s64, 3072
    s_add_u32 m0, s30, 0
    s_nop 0
    buffer_load_dwordx4 v8, s[40:43], s64 offen offset:0 lds
    buffer_load_dwordx4 v9, s[40:43], s64 offen offset:1024 lds
    v_and_b32 v5, 0xffff0000, v116
    v_lshlrev_b32 v116, 16, v116
    v_rcp_f32 v117, v5
    v_lshlrev_b32_e64 v96, 16, v64
    v_and_b32 v97, 0xffff0000, v64
    buffer_load_dwordx4 v10, s[40:43], s64 offen offset:2048 lds
    v_lshlrev_b32 v98, 16, v65
    v_and_b32 v99, 0xffff0000, v65
    v_lshlrev_b32 v100, 16, v66
    v_and_b32 v101, 0xffff0000, v66
    v_lshlrev_b32_e64 v102, 16, v67
    buffer_load_dwordx4 v11, s[40:43], s64 offen offset:3072 lds
    v_and_b32 v103, 0xffff0000, v67
    v_lshlrev_b32 v104, 16, v68
    v_and_b32 v105, 0xffff0000, v68
    v_lshlrev_b32 v106, 16, v69
    v_and_b32 v107, 0xffff0000, v69
    s_add_u32 m0, s31, 0
    s_nop 0
    buffer_load_dwordx4 v12, s[44:47], s65 offen offset:0 lds
    v_lshlrev_b32 v108, 16, v70
    v_and_b32 v109, 0xffff0000, v70
    v_lshlrev_b32 v110, 16, v71
    v_and_b32 v111, 0xffff0000, v71
    v_mul_f32_e64 v119, v116, v117
    buffer_load_dwordx4 v13, s[44:47], s65 offen offset:1024 lds
    v_fma_f32 v96, v96, v117, -v119
    v_fma_f32 v97, v97, v117, -v119
    v_fma_f32 v98, v98, v117, -v119
    v_fma_f32 v99, v99, v117, -v119
    v_fma_f32 v100, v100, v117, -v119
    s_add_u32 m0, s31, 8192
    s_nop 0
    s_nop 0
    buffer_load_dwordx4 v14, s[44:47], s65 offen offset:0 lds
    v_fma_f32 v101, v101, v117, -v119
    v_fma_f32 v102, v102, v117, -v119
    v_fma_f32 v103, v103, v117, -v119
    v_fma_f32 v104, v104, v117, -v119
    v_fma_f32 v105, v105, v117, -v119
    buffer_load_dwordx4 v15, s[44:47], s65 offen offset:1024 lds
    v_fma_f32 v106, v106, v117, -v119
    v_fma_f32 v107, v107, v117, -v119
    v_fma_f32 v108, v108, v117, -v119
    v_fma_f32 v109, v109, v117, -v119
    v_fma_f32 v110, v110, v117, -v119
    s_add_u32 m0, s31, 16384
    s_nop 0
    buffer_load_dwordx4 v16, s[44:47], s65 offen offset:0 lds
    v_fma_f32 v111, v111, v117, -v119
    v_mov_b32 v120, 0
    v_mov_b32 v121, 0
    v_mov_b32 v122, 0
    v_mov_b32 v123, 0
    buffer_load_dwordx4 v17, s[44:47], s65 offen offset:1024 lds
    v_mov_b32 v124, 0
    v_mov_b32 v125, 0
    v_mov_b32 v126, 0
    v_mov_b32 v127, 0
    s_waitcnt vmcnt(13)
    s_waitcnt lgkmcnt(0)
    s_barrier
    s_mov_b32 s3, 43008
    buffer_load_dwordx4 v[152:155], v21, s[52:55], s3 offen nt
    s_mov_b32 s3, 50176
    buffer_load_dwordx4 v[156:159], v21, s[52:55], s3 offen nt
    s_mov_b32 s3, 57344
    buffer_load_dwordx4 v[160:163], v21, s[52:55], s3 offen nt
    s_mov_b32 s3, 64512
    buffer_load_dwordx4 v[164:167], v21, s[52:55], s3 offen nt
    s_mov_b32 s3, 71680
    buffer_load_dwordx4 v[168:171], v21, s[52:55], s3 offen nt
    s_mov_b32 s3, 78848
    buffer_load_dwordx4 v[172:175], v21, s[52:55], s3 offen nt
    s_mov_b32 s3, 86016
    buffer_load_dwordx4 v[176:179], v21, s[52:55], s3 offen nt
    s_mov_b32 s3, 93184
    buffer_load_dwordx4 v[180:183], v21, s[52:55], s3 offen nt
    ds_write_b32 v233, v80
    s_lshl_b32 s3, s38, 4
    s_lshl_b64 exec, 0xffff, s3
    ds_write_b64 v230, v[224:225]
    ds_write_b64 v230, v[226:227] offset:1024
    ds_write_b64 v230, v[228:229] offset:2048
    ds_write_b32 v231, v236
    s_mov_b64 exec, -1
    s_waitcnt vmcnt(8)
    s_waitcnt lgkmcnt(0)
    s_barrier
    v_xor_b32 v2, 0, v23
    ds_read_b64 v[240:241], v2
    v_xor_b32 v2, 32, v23
    ds_read_b64 v[242:243], v2
    v_xor_b32 v2, 64, v23
    ds_read_b64 v[244:245], v2
    v_xor_b32 v2, 96, v23
    ds_read_b64 v[246:247], v2
    v_lshlrev_b32 v2, 16, v128
    v_and_b32 v3, 0xffff0000, v128
    v_fmac_f32 v120, v2, v96
    v_fmac_f32 v121, v3, v96
    v_lshlrev_b32 v4, 16, v129
    v_and_b32 v5, 0xffff0000, v129
    v_fmac_f32 v122, v4, v96
    v_fmac_f32 v123, v5, v96
    v_lshlrev_b32 v2, 16, v130
    v_and_b32 v3, 0xffff0000, v130
    v_fmac_f32 v124, v2, v96
    v_fmac_f32 v125, v3, v96
    v_lshlrev_b32 v4, 16, v131
    v_and_b32 v5, 0xffff0000, v131
    v_fmac_f32 v126, v4, v96
    v_fmac_f32 v127, v5, v96
    v_lshlrev_b32 v2, 16, v132
    v_and_b32 v3, 0xffff0000, v132
    v_fmac_f32 v120, v2, v97
    v_fmac_f32 v121, v3, v97
    v_lshlrev_b32 v4, 16, v133
    v_and_b32 v5, 0xffff0000, v133
    v_fmac_f32 v122, v4, v97
    v_fmac_f32 v123, v5, v97
    v_lshlrev_b32 v2, 16, v134
    v_and_b32 v3, 0xffff0000, v134
    v_fmac_f32 v124, v2, v97
    v_fmac_f32 v125, v3, v97
    v_lshlrev_b32 v4, 16, v135
    v_and_b32 v5, 0xffff0000, v135
    v_fmac_f32 v126, v4, v97
    v_fmac_f32 v127, v5, v97
    v_lshlrev_b32 v2, 16, v136
    v_and_b32 v3, 0xffff0000, v136
    v_fmac_f32 v120, v2, v98
    v_fmac_f32 v121, v3, v98
    v_lshlrev_b32 v4, 16, v137
    v_and_b32 v5, 0xffff0000, v137
    v_fmac_f32 v122, v4, v98
    v_fmac_f32 v123, v5, v98
    v_lshlrev_b32 v2, 16, v138
    v_and_b32 v3, 0xffff0000, v138
    v_fmac_f32 v124, v2, v98
    v_fmac_f32 v125, v3, v98
    v_lshlrev_b32 v4, 16, v139
    v_and_b32 v5, 0xffff0000, v139
    v_fmac_f32 v126, v4, v98
    v_fmac_f32 v127, v5, v98
    v_lshlrev_b32 v2, 16, v140
    v_and_b32 v3, 0xffff0000, v140
    v_fmac_f32 v120, v2, v99
    v_fmac_f32 v121, v3, v99
    v_lshlrev_b32 v4, 16, v141
    v_and_b32 v5, 0xffff0000, v141
    v_fmac_f32 v122, v4, v99
    v_fmac_f32 v123, v5, v99
    v_lshlrev_b32 v2, 16, v142
    v_and_b32 v3, 0xffff0000, v142
    v_fmac_f32 v124, v2, v99
    v_fmac_f32 v125, v3, v99
    v_lshlrev_b32 v4, 16, v143
    v_and_b32 v5, 0xffff0000, v143
    v_fmac_f32 v126, v4, v99
    v_fmac_f32 v127, v5, v99
    v_lshlrev_b32 v2, 16, v144
    v_and_b32 v3, 0xffff0000, v144
    v_fmac_f32 v120, v2, v100
    v_fmac_f32 v121, v3, v100
    v_lshlrev_b32 v4, 16, v145
    v_and_b32 v5, 0xffff0000, v145
    v_fmac_f32 v122, v4, v100
    v_fmac_f32 v123, v5, v100
    v_lshlrev_b32 v2, 16, v146
    v_and_b32 v3, 0xffff0000, v146
    v_fmac_f32 v124, v2, v100
    v_fmac_f32 v125, v3, v100
    v_lshlrev_b32 v4, 16, v147
    v_and_b32 v5, 0xffff0000, v147
    v_fmac_f32 v126, v4, v100
    v_fmac_f32 v127, v5, v100
    s_waitcnt lgkmcnt(0)
    s_barrier
    v_and_b32 v2, 15, v1
    v_min_u32 v2, 13, v2
    v_lshrrev_b32_e64 v3, 4, v1
    v_mul_u32_u24 v3, 14336, v3
    v_lshl_add_u32 v13, v2, 4, v3
    s_lshl_b32 s75, s71, 2
    s_add_u32 s75, s75, 1183744
    s_add_u32 m0, s72, 0
    s_add_u32 s3, s73, 0
    s_nop 0
    buffer_load_dwordx4 v220, s[88:91], s3 offen offset:0 lds
    buffer_load_dwordx4 v221, s[88:91], s3 offen offset:1024 lds
    buffer_load_dwordx4 v222, s[88:91], s3 offen offset:2048 lds
    buffer_load_dwordx4 v223, s[88:91], s3 offen offset:3072 lds
    s_add_u32 m0, s72, 16384
    s_add_u32 s3, s73, 262144
    buffer_load_dwordx4 v220, s[88:91], s3 offen offset:0 lds
    buffer_load_dwordx4 v221, s[88:91], s3 offen offset:1024 lds
    buffer_load_dwordx4 v222, s[88:91], s3 offen offset:2048 lds
    buffer_load_dwordx4 v223, s[88:91], s3 offen offset:3072 lds
    s_add_u32 m0, s72, 65536
    s_add_u32 s3, s73, 1048576
    buffer_load_dwordx4 v220, s[88:91], s3 offen offset:0 lds
    buffer_load_dwordx4 v221, s[88:91], s3 offen offset:1024 lds
    buffer_load_dwordx4 v222, s[88:91], s3 offen offset:2048 lds
    buffer_load_dwordx4 v223, s[88:91], s3 offen offset:3072 lds
    s_mov_b32 s3, 100352
    buffer_load_dwordx4 v[184:187], v21, s[52:55], s3 offen nt
    s_mov_b32 s3, 107520
    buffer_load_dwordx4 v[188:191], v21, s[52:55], s3 offen nt
    s_lshr_b32 s3, s71, 3
    s_add_u32 s3, s3, 0
    s_and_b32 s28, s3, 7
    s_lshr_b32 s3, s3, 3
    s_lshl_b32 s3, s3, 6
    s_add_u32 s3, s3, s28
    s_lshl_b32 s3, s3, 11
    buffer_load_dwordx4 v[192:195], v22, s[56:59], s3 offen nt
    s_lshr_b32 s3, s71, 3
    s_add_u32 s3, s3, 1
    s_and_b32 s28, s3, 7
    s_lshr_b32 s3, s3, 3
    s_lshl_b32 s3, s3, 6
    s_add_u32 s3, s3, s28
    s_lshl_b32 s3, s3, 11
    buffer_load_dwordx4 v[196:199], v22, s[56:59], s3 offen nt
    s_lshr_b32 s3, s71, 3
    s_add_u32 s3, s3, 2
    s_and_b32 s28, s3, 7
    s_lshr_b32 s3, s3, 3
    s_lshl_b32 s3, s3, 6
    s_add_u32 s3, s3, s28
    s_lshl_b32 s3, s3, 11
    buffer_load_dwordx4 v[200:203], v22, s[56:59], s3 offen nt
    s_lshr_b32 s3, s71, 3
    s_add_u32 s3, s3, 3
    s_and_b32 s28, s3, 7
    s_lshr_b32 s3, s3, 3
    s_lshl_b32 s3, s3, 6
    s_add_u32 s3, s3, s28
    s_lshl_b32 s3, s3, 11
    buffer_load_dwordx4 v[204:207], v22, s[56:59], s3 offen nt
    s_lshr_b32 s3, s71, 3
    s_add_u32 s3, s3, 4
    s_and_b32 s28, s3, 7
    s_lshr_b32 s3, s3, 3
    s_lshl_b32 s3, s3, 6
    s_add_u32 s3, s3, s28
    s_lshl_b32 s3, s3, 11
    buffer_load_dwordx4 v[208:211], v22, s[56:59], s3 offen nt
    s_waitcnt vmcnt(23)
    v_lshlrev_b32 v2, 16, v148
    v_and_b32 v3, 0xffff0000, v148
    v_mov_b32 v100, v101
    v_pk_fma_f32 v[120:121], v[2:3], v[100:101], v[120:121] op_sel_hi:[1,0,1]
    v_lshlrev_b32_e64 v4, 16, v149
    v_and_b32 v5, 0xffff0000, v149
    v_pk_fma_f32 v[122:123], v[4:5], v[100:101], v[122:123] op_sel_hi:[1,0,1]
    v_lshlrev_b32_e64 v2, 16, v150
    v_and_b32 v3, 0xffff0000, v150
    v_pk_fma_f32 v[124:125], v[2:3], v[100:101], v[124:125] op_sel_hi:[1,0,1]
    v_lshlrev_b32_e64 v4, 16, v151
    v_and_b32 v5, 0xffff0000, v151
    v_pk_fma_f32 v[126:127], v[4:5], v[100:101], v[126:127] op_sel_hi:[1,0,1]
    v_lshlrev_b32_e64 v2, 16, v152
    v_and_b32 v3, 0xffff0000, v152
    v_pk_fma_f32 v[120:121], v[2:3], v[102:103], v[120:121] op_sel_hi:[1,0,1]
    v_lshlrev_b32_e64 v4, 16, v153
    v_and_b32 v5, 0xffff0000, v153
    v_pk_fma_f32 v[122:123], v[4:5], v[102:103], v[122:123] op_sel_hi:[1,0,1]
    v_lshlrev_b32_e64 v2, 16, v154
    v_and_b32 v3, 0xffff0000, v154
    v_pk_fma_f32 v[124:125], v[2:3], v[102:103], v[124:125] op_sel_hi:[1,0,1]
    v_lshlrev_b32_e64 v4, 16, v155
    v_and_b32 v5, 0xffff0000, v155
    v_pk_fma_f32 v[126:127], v[4:5], v[102:103], v[126:127] op_sel_hi:[1,0,1]
    v_lshlrev_b32 v2, 16, v156
    v_and_b32 v3, 0xffff0000, v156
    v_mov_b32 v102, v103
    v_pk_fma_f32 v[120:121], v[2:3], v[102:103], v[120:121] op_sel_hi:[1,0,1]
    v_lshlrev_b32_e64 v4, 16, v157
    v_and_b32 v5, 0xffff0000, v157
    v_pk_fma_f32 v[122:123], v[4:5], v[102:103], v[122:123] op_sel_hi:[1,0,1]
    v_lshlrev_b32_e64 v2, 16, v158
    v_and_b32 v3, 0xffff0000, v158
    v_pk_fma_f32 v[124:125], v[2:3], v[102:103], v[124:125] op_sel_hi:[1,0,1]
    v_lshlrev_b32_e64 v4, 16, v159
    v_and_b32 v5, 0xffff0000, v159
    v_pk_fma_f32 v[126:127], v[4:5], v[102:103], v[126:127] op_sel_hi:[1,0,1]
    v_lshlrev_b32_e64 v2, 16, v160
    v_and_b32 v3, 0xffff0000, v160
    v_pk_fma_f32 v[120:121], v[2:3], v[104:105], v[120:121] op_sel_hi:[1,0,1]
    v_lshlrev_b32_e64 v4, 16, v161
    v_and_b32 v5, 0xffff0000, v161
    v_pk_fma_f32 v[122:123], v[4:5], v[104:105], v[122:123] op_sel_hi:[1,0,1]
    v_lshlrev_b32_e64 v2, 16, v162
    v_and_b32 v3, 0xffff0000, v162
    v_pk_fma_f32 v[124:125], v[2:3], v[104:105], v[124:125] op_sel_hi:[1,0,1]
    v_lshlrev_b32_e64 v4, 16, v163
    v_and_b32 v5, 0xffff0000, v163
    v_pk_fma_f32 v[126:127], v[4:5], v[104:105], v[126:127] op_sel_hi:[1,0,1]
    v_lshlrev_b32 v2, 16, v164
    v_and_b32 v3, 0xffff0000, v164
    v_mov_b32 v104, v105
    v_pk_fma_f32 v[120:121], v[2:3], v[104:105], v[120:121] op_sel_hi:[1,0,1]
    v_lshlrev_b32_e64 v4, 16, v165
    v_and_b32 v5, 0xffff0000, v165
    v_pk_fma_f32 v[122:123], v[4:5], v[104:105], v[122:123] op_sel_hi:[1,0,1]
    v_lshlrev_b32_e64 v2, 16, v166
    v_and_b32 v3, 0xffff0000, v166
    v_pk_fma_f32 v[124:125], v[2:3], v[104:105], v[124:125] op_sel_hi:[1,0,1]
    v_lshlrev_b32_e64 v4, 16, v167
    v_and_b32 v5, 0xffff0000, v167
    v_pk_fma_f32 v[126:127], v[4:5], v[104:105], v[126:127] op_sel_hi:[1,0,1]
    s_waitcnt vmcnt(15)
    s_waitcnt vmcnt(11)
    s_waitcnt vmcnt(7)
    s_barrier
    s_add_u32 m0, s72, 32768
    s_add_u32 s3, s73, 524288
    buffer_load_dwordx4 v220, s[88:91], s3 offen offset:0 lds
    buffer_load_dwordx4 v221, s[88:91], s3 offen offset:1024 lds
    buffer_load_dwordx4 v222, s[88:91], s3 offen offset:2048 lds
    buffer_load_dwordx4 v223, s[88:91], s3 offen offset:3072 lds
    s_add_u32 m0, s72, 49152
    s_add_u32 s3, s73, 786432
    buffer_load_dwordx4 v220, s[88:91], s3 offen offset:0 lds
    buffer_load_dwordx4 v221, s[88:91], s3 offen offset:1024 lds
    buffer_load_dwordx4 v222, s[88:91], s3 offen offset:2048 lds
    buffer_load_dwordx4 v223, s[88:91], s3 offen offset:3072 lds
    s_add_u32 m0, s72, 81920
    s_add_u32 s3, s73, 1310720
    buffer_load_dwordx4 v220, s[88:91], s3 offen offset:0 lds
    buffer_load_dwordx4 v221, s[88:91], s3 offen offset:1024 lds
    buffer_load_dwordx4 v222, s[88:91], s3 offen offset:2048 lds
    buffer_load_dwordx4 v223, s[88:91], s3 offen offset:3072 lds
    s_setprio 3
    s_cmp_lg_u32 s38, 3
    s_cbranch_scc1 L_npl
    s_mov_b32 s3, 32768
    s_mov_b32 s29, 0
    s_mov_b32 exec_lo, -1
    s_mov_b32 exec_hi, 65535
L_rp:
    buffer_load_dword v118, v113, s[48:51], s3 offen sc1
    s_waitcnt vmcnt(0)
    v_cmp_ne_u32 vcc, s86, v118
    s_cbranch_vccz L_rpk
    s_mov_b64 exec, vcc
    s_add_u32 s29, s29, 1
    s_cmp_lt_u32 s29, 200000
    s_cbranch_scc1 L_rp
L_rpk:
    s_mov_b64 exec, -1
    v_mov_b32 v4, 162128
    v_mov_b32 v5, 1
    ds_write_b32 v4, v5
L_npl:
    v_min_u32 v3, 4, v1
    v_lshlrev_b32_e64 v3, 2, v3
    v_add_u32 v3, 162112, v3
L_fw:
    ds_read_b32 v4, v3
    s_waitcnt lgkmcnt(0)
    v_cmp_eq_u32 vcc, 0, v4
    s_cbranch_vccz L_fk
    s_sleep 1
    s_branch L_fw
L_fk:
    s_waitcnt vmcnt(17)
    v_lshlrev_b32_e64 v2, 16, v168
    v_and_b32 v3, 0xffff0000, v168
    v_pk_fma_f32 v[120:121], v[2:3], v[106:107], v[120:121] op_sel_hi:[1,0,1]
    v_lshlrev_b32_e64 v4, 16, v169
    v_and_b32 v5, 0xffff0000, v169
    v_pk_fma_f32 v[122:123], v[4:5], v[106:107], v[122:123] op_sel_hi:[1,0,1]
    v_lshlrev_b32_e64 v2, 16, v170
    v_and_b32 v3, 0xffff0000, v170
    v_pk_fma_f32 v[124:125], v[2:3], v[106:107], v[124:125] op_sel_hi:[1,0,1]
    v_lshlrev_b32_e64 v4, 16, v171
    v_and_b32 v5, 0xffff0000, v171
    v_pk_fma_f32 v[126:127], v[4:5], v[106:107], v[126:127] op_sel_hi:[1,0,1]
    v_lshlrev_b32 v2, 16, v172
    v_and_b32 v3, 0xffff0000, v172
    v_mov_b32 v106, v107
    v_pk_fma_f32 v[120:121], v[2:3], v[106:107], v[120:121] op_sel_hi:[1,0,1]
    v_lshlrev_b32_e64 v4, 16, v173
    v_and_b32 v5, 0xffff0000, v173
    v_pk_fma_f32 v[122:123], v[4:5], v[106:107], v[122:123] op_sel_hi:[1,0,1]
    v_lshlrev_b32_e64 v2, 16, v174
    v_and_b32 v3, 0xffff0000, v174
    v_pk_fma_f32 v[124:125], v[2:3], v[106:107], v[124:125] op_sel_hi:[1,0,1]
    v_lshlrev_b32_e64 v4, 16, v175
    v_and_b32 v5, 0xffff0000, v175
    v_pk_fma_f32 v[126:127], v[4:5], v[106:107], v[126:127] op_sel_hi:[1,0,1]
    s_add_u32 s3, s76, 0
    buffer_load_dwordx4 v[48:51], v112, s[48:51], s3 offen sc1
    s_add_u32 s3, s76, 33792
    buffer_load_dwordx4 v[52:55], v112, s[48:51], s3 offen sc1
    s_cmp_lg_u32 s83, 0
    s_cbranch_scc1 L_nz
    s_add_u32 s3, s81, 0
    buffer_load_dwordx4 v[32:35], v112, s[48:51], s3 offen sc1
    s_add_u32 s3, s81, 33792
    buffer_load_dwordx4 v[36:39], v112, s[48:51], s3 offen sc1
L_nz:
    v_lshlrev_b32_e64 v2, 16, v176
    v_and_b32 v3, 0xffff0000, v176
    v_pk_fma_f32 v[120:121], v[2:3], v[108:109], v[120:121] op_sel_hi:[1,0,1]
    v_lshlrev_b32_e64 v4, 16, v177
    v_and_b32 v5, 0xffff0000, v177
    v_pk_fma_f32 v[122:123], v[4:5], v[108:109], v[122:123] op_sel_hi:[1,0,1]
    v_lshlrev_b32_e64 v2, 16, v178
    v_and_b32 v3, 0xffff0000, v178
    v_pk_fma_f32 v[124:125], v[2:3], v[108:109], v[124:125] op_sel_hi:[1,0,1]
    v_lshlrev_b32_e64 v4, 16, v179
    v_and_b32 v5, 0xffff0000, v179
    v_pk_fma_f32 v[126:127], v[4:5], v[108:109], v[126:127] op_sel_hi:[1,0,1]
    v_lshlrev_b32 v2, 16, v180
    v_and_b32 v3, 0xffff0000, v180
    v_mov_b32 v108, v109
    v_pk_fma_f32 v[120:121], v[2:3], v[108:109], v[120:121] op_sel_hi:[1,0,1]
    v_lshlrev_b32_e64 v4, 16, v181
    v_and_b32 v5, 0xffff0000, v181
    v_pk_fma_f32 v[122:123], v[4:5], v[108:109], v[122:123] op_sel_hi:[1,0,1]
    v_lshlrev_b32_e64 v2, 16, v182
    v_and_b32 v3, 0xffff0000, v182
    v_pk_fma_f32 v[124:125], v[2:3], v[108:109], v[124:125] op_sel_hi:[1,0,1]
    v_lshlrev_b32_e64 v4, 16, v183
    v_and_b32 v5, 0xffff0000, v183
    v_pk_fma_f32 v[126:127], v[4:5], v[108:109], v[126:127] op_sel_hi:[1,0,1]
    s_lshr_b32 s3, s71, 3
    s_add_u32 s3, s3, 5
    s_and_b32 s28, s3, 7
    s_lshr_b32 s3, s3, 3
    s_lshl_b32 s3, s3, 6
    s_add_u32 s3, s3, s28
    s_lshl_b32 s3, s3, 11
    buffer_load_dwordx4 v[212:215], v22, s[56:59], s3 offen nt
    s_lshr_b32 s3, s71, 3
    s_add_u32 s3, s3, 6
    s_and_b32 s28, s3, 7
    s_lshr_b32 s3, s3, 3
    s_lshl_b32 s3, s3, 6
    s_add_u32 s3, s3, s28
    s_lshl_b32 s3, s3, 11
    buffer_load_dwordx4 v[216:219], v22, s[56:59], s3 offen nt
    v_lshlrev_b32_e64 v2, 16, v184
    v_and_b32 v3, 0xffff0000, v184
    v_pk_fma_f32 v[120:121], v[2:3], v[110:111], v[120:121] op_sel_hi:[1,0,1]
    v_lshlrev_b32_e64 v4, 16, v185
    v_and_b32 v5, 0xffff0000, v185
    v_pk_fma_f32 v[122:123], v[4:5], v[110:111], v[122:123] op_sel_hi:[1,0,1]
    v_lshlrev_b32_e64 v2, 16, v186
    v_and_b32 v3, 0xffff0000, v186
    v_pk_fma_f32 v[124:125], v[2:3], v[110:111], v[124:125] op_sel_hi:[1,0,1]
    v_lshlrev_b32_e64 v4, 16, v187
    v_and_b32 v5, 0xffff0000, v187
    v_pk_fma_f32 v[126:127], v[4:5], v[110:111], v[126:127] op_sel_hi:[1,0,1]
    v_lshlrev_b32 v2, 16, v188
    v_and_b32 v3, 0xffff0000, v188
    v_mov_b32 v110, v111
    v_pk_fma_f32 v[120:121], v[2:3], v[110:111], v[120:121] op_sel_hi:[1,0,1]
    v_lshlrev_b32_e64 v4, 16, v189
    v_and_b32 v5, 0xffff0000, v189
    v_pk_fma_f32 v[122:123], v[4:5], v[110:111], v[122:123] op_sel_hi:[1,0,1]
    v_lshlrev_b32_e64 v2, 16, v190
    v_and_b32 v3, 0xffff0000, v190
    v_pk_fma_f32 v[124:125], v[2:3], v[110:111], v[124:125] op_sel_hi:[1,0,1]
    v_lshlrev_b32_e64 v4, 16, v191
    v_and_b32 v5, 0xffff0000, v191
    v_pk_fma_f32 v[126:127], v[4:5], v[110:111], v[126:127] op_sel_hi:[1,0,1]
    v_permlane32_swap_b32 v120, v124
    v_permlane32_swap_b32 v121, v125
    v_permlane32_swap_b32 v122, v126
    v_permlane32_swap_b32 v123, v127
    v_add_f32 v120, v120, v124
    v_add_f32 v121, v121, v125
    v_add_f32 v122, v122, v126
    v_add_f32 v123, v123, v127
    s_nop 0
    v_permlane16_swap_b32 v120, v122
    v_permlane16_swap_b32 v121, v123
    v_add_f32 v120, v120, v122
    v_add_f32 v121, v121, v123
    s_nop 0
    v_add_f32 v120, v120, v120 row_ror:8 row_mask:0xf bank_mask:0xf
    v_add_f32 v121, v121, v121 row_ror:8 row_mask:0xf bank_mask:0xf
    v_and_b32 v2, 8, v1
    v_cmp_eq_u32 vcc, 0, v2
    s_nop 1
    v_cndmask_b32 v120, v121, v120, vcc
    buffer_store_dword v120, v253, s[48:51], s84 offen sc1
    s_waitcnt vmcnt(3)
    s_cmp_eq_u32 s83, 0
    s_cbranch_scc1 L_hz
    s_mov_b32 s29, 0
L_k4:
    v_max3_u32 v2, v48, v49, v50
    v_max3_u32 v2, v2, v51, v52
    v_max3_u32 v2, v2, v53, v54
    v_max_u32 v2, v2, v55
    v_cmp_eq_u32 vcc, -1, v2
    s_cbranch_vccz L_k4k
    s_add_u32 s29, s29, 1
    s_cmp_ge_u32 s29, 200000
    s_cbranch_scc1 L_k4k
    s_sleep 1
    s_add_u32 s3, s76, 0
    buffer_load_dwordx4 v[48:51], v112, s[48:51], s3 offen sc1
    s_add_u32 s3, s76, 33792
    buffer_load_dwordx4 v[52:55], v112, s[48:51], s3 offen sc1
    s_waitcnt vmcnt(0)
    s_branch L_k4
L_k4k:
    v_lshlrev_b32 v64, 16, v48
    v_and_b32 v65, 0xffff0000, v48
    v_lshlrev_b32 v66, 16, v49
    v_and_b32 v67, 0xffff0000, v49
    v_lshlrev_b32 v68, 16, v50
    v_and_b32 v69, 0xffff0000, v50
    v_lshlrev_b32 v70, 16, v51
    v_and_b32 v71, 0xffff0000, v51
    v_lshlrev_b32 v72, 16, v52
    v_and_b32 v73, 0xffff0000, v52
    v_pk_add_f32 v[64:65], v[64:65], v[72:73]
    v_lshlrev_b32_e64 v74, 16, v53
    v_and_b32 v75, 0xffff0000, v53
    v_pk_add_f32 v[66:67], v[66:67], v[74:75]
    v_lshlrev_b32_e64 v76, 16, v54
    v_and_b32 v77, 0xffff0000, v54
    v_pk_add_f32 v[68:69], v[68:69], v[76:77]
    v_lshlrev_b32_e64 v78, 16, v55
    v_and_b32 v79, 0xffff0000, v55
    v_pk_add_f32 v[70:71], v[70:71], v[78:79]
    v_permlane32_swap_b32 v64, v68
    v_permlane32_swap_b32 v65, v69
    v_permlane32_swap_b32 v66, v70
    v_permlane32_swap_b32 v67, v71
    v_add_f32 v64, v64, v68
    v_add_f32 v65, v65, v69
    v_add_f32 v66, v66, v70
    v_add_f32 v67, v67, v71
    s_nop 0
    v_permlane16_swap_b32 v64, v66
    v_permlane16_swap_b32 v65, v67
    v_add_f32 v64, v64, v66
    v_add_f32 v65, v65, v67
    s_nop 0
    v_add_f32 v64, v64, v64 row_ror:8 row_mask:0xf bank_mask:0xf
    v_add_f32 v65, v65, v65 row_ror:8 row_mask:0xf bank_mask:0xf
    v_cvt_pk_bf16_f32 v64, v64, v65
    v_mov_b32 v65, v64
    s_nop 1
    v_permlane16_swap_b32 v64, v65
    v_mov_b32 v66, v64
    v_mov_b32 v67, v65
    s_nop 0
    v_permlane32_swap_b32 v64, v66
    v_permlane32_swap_b32 v65, v67
    s_mov_b64 exec, 0xff
    buffer_store_dwordx4 v[64:67], v252, s[48:51], s74 offen sc1
    s_branch L_h1e
L_hz:
    s_mov_b32 s29, 0
L_k3:
    v_max3_u32 v2, v48, v49, v50
    v_max3_u32 v2, v2, v51, v52
    v_max3_u32 v2, v2, v53, v54
    v_max3_u32 v2, v2, v55, v32
    v_max3_u32 v2, v2, v33, v34
    v_max3_u32 v2, v2, v35, v36
    v_max3_u32 v2, v2, v37, v38
    v_max_u32 v2, v2, v39
    v_cmp_eq_u32 vcc, -1, v2
    s_cbranch_vccz L_k3k
    s_add_u32 s29, s29, 1
    s_cmp_ge_u32 s29, 200000
    s_cbranch_scc1 L_k3k
    s_sleep 1
    s_add_u32 s3, s76, 0
    buffer_load_dwordx4 v[48:51], v112, s[48:51], s3 offen sc1
    s_add_u32 s3, s76, 33792
    buffer_load_dwordx4 v[52:55], v112, s[48:51], s3 offen sc1
    s_add_u32 s3, s81, 0
    buffer_load_dwordx4 v[32:35], v112, s[48:51], s3 offen sc1
    s_add_u32 s3, s81, 33792
    buffer_load_dwordx4 v[36:39], v112, s[48:51], s3 offen sc1
    s_waitcnt vmcnt(0)
    s_branch L_k3
L_k3k:
    v_lshlrev_b32 v64, 16, v48
    v_lshlrev_b32 v96, 16, v32
    v_and_b32 v65, 0xffff0000, v48
    v_and_b32 v97, 0xffff0000, v32
    v_lshlrev_b32 v66, 16, v49
    v_lshlrev_b32 v98, 16, v33
    v_and_b32 v67, 0xffff0000, v49
    v_and_b32 v99, 0xffff0000, v33
    v_lshlrev_b32 v68, 16, v50
    v_lshlrev_b32 v100, 16, v34
    v_and_b32 v69, 0xffff0000, v50
    v_and_b32 v101, 0xffff0000, v34
    v_lshlrev_b32 v70, 16, v51
    v_lshlrev_b32 v102, 16, v35
    v_and_b32 v71, 0xffff0000, v51
    v_and_b32 v103, 0xffff0000, v35
    v_lshlrev_b32 v72, 16, v52
    v_lshlrev_b32 v104, 16, v36
    v_and_b32 v73, 0xffff0000, v52
    v_and_b32 v105, 0xffff0000, v36
    v_pk_add_f32 v[64:65], v[64:65], v[72:73]
    v_pk_add_f32 v[96:97], v[96:97], v[104:105]
    v_lshlrev_b32 v74, 16, v53
    v_lshlrev_b32 v106, 16, v37
    v_and_b32 v75, 0xffff0000, v53
    v_and_b32 v107, 0xffff0000, v37
    v_pk_add_f32 v[66:67], v[66:67], v[74:75]
    v_pk_add_f32 v[98:99], v[98:99], v[106:107]
    v_lshlrev_b32 v76, 16, v54
    v_lshlrev_b32 v108, 16, v38
    v_and_b32 v77, 0xffff0000, v54
    v_and_b32 v109, 0xffff0000, v38
    v_pk_add_f32 v[68:69], v[68:69], v[76:77]
    v_pk_add_f32 v[100:101], v[100:101], v[108:109]
    v_lshlrev_b32 v78, 16, v55
    v_lshlrev_b32 v110, 16, v39
    v_and_b32 v79, 0xffff0000, v55
    v_and_b32 v111, 0xffff0000, v39
    v_pk_add_f32 v[70:71], v[70:71], v[78:79]
    v_pk_add_f32 v[102:103], v[102:103], v[110:111]
    v_permlane32_swap_b32 v64, v68
    v_permlane32_swap_b32 v96, v100
    v_permlane32_swap_b32 v65, v69
    v_permlane32_swap_b32 v97, v101
    v_permlane32_swap_b32 v66, v70
    v_permlane32_swap_b32 v98, v102
    v_permlane32_swap_b32 v67, v71
    v_permlane32_swap_b32 v99, v103
    v_add_f32 v64, v64, v68
    v_add_f32 v96, v96, v100
    v_add_f32 v65, v65, v69
    v_add_f32 v97, v97, v101
    v_add_f32 v66, v66, v70
    v_add_f32 v98, v98, v102
    v_add_f32 v67, v67, v71
    v_add_f32 v99, v99, v103
    v_permlane16_swap_b32 v64, v66
    v_permlane16_swap_b32 v96, v98
    v_permlane16_swap_b32 v65, v67
    v_permlane16_swap_b32 v97, v99
    v_add_f32 v64, v64, v66
    v_add_f32 v96, v96, v98
    v_add_f32 v65, v65, v67
    v_add_f32 v97, v97, v99
    v_add_f32 v64, v64, v64 row_ror:8 row_mask:0xf bank_mask:0xf
    v_add_f32 v96, v96, v96 row_ror:8 row_mask:0xf bank_mask:0xf
    v_add_f32 v65, v65, v65 row_ror:8 row_mask:0xf bank_mask:0xf
    v_add_f32 v97, v97, v97 row_ror:8 row_mask:0xf bank_mask:0xf
    v_cvt_pk_bf16_f32 v64, v64, v65
    v_cvt_pk_bf16_f32 v96, v96, v97
    v_mov_b32 v65, v64
    v_mov_b32 v97, v96
    s_nop 0
    v_permlane16_swap_b32 v64, v65
    v_permlane16_swap_b32 v96, v97
    v_mov_b32 v66, v64
    v_mov_b32 v98, v96
    v_mov_b32 v67, v65
    v_mov_b32 v99, v97
    v_permlane32_swap_b32 v64, v66
    v_permlane32_swap_b32 v96, v98
    v_permlane32_swap_b32 v65, v67
    v_permlane32_swap_b32_e64 v97, v99
    s_mov_b64 exec, 0xff
    buffer_store_dwordx4 v[64:67], v252, s[48:51], s74 offen sc1
    buffer_store_dwordx4 v[96:99], v252, s[48:51], s82 offen sc1
L_h1e:
    s_mov_b64 exec, -1
    s_lshl_b32 s3, s38, 2
    s_add_u32 s3, s3, 162112
    v_mov_b32 v4, s3
    v_mov_b32 v5, 3
    ds_write_b32 v4, v5
    s_setprio 0
    v_and_b32 v2, 15, v1
    v_add_u32 v2, s69, v2
    v_lshlrev_b32 v2, 2, v2
    v_add_u32 v2, 152064, v2
    ds_read_b32 v9, v2
    ds_read_b32 v8, v2 offset:1024
    s_waitcnt lgkmcnt(0)
    v_mul_f32 v28, v9, v8
    v_mov_b32 v30, 0xbfb8aa3b
    v_lshlrev_b32 v224, 16, v240
    v_and_b32 v225, 0xffff0000, v240
    v_lshlrev_b32 v226, 16, v241
    v_and_b32 v227, 0xffff0000, v241
    v_lshlrev_b32 v228, 16, v242
    v_and_b32 v229, 0xffff0000, v242
    v_lshlrev_b32 v230, 16, v243
    v_and_b32 v231, 0xffff0000, v243
    v_lshlrev_b32 v232, 16, v244
    v_and_b32 v233, 0xffff0000, v244
    v_lshlrev_b32 v234, 16, v245
    v_and_b32 v235, 0xffff0000, v245
    v_lshlrev_b32 v236, 16, v246
    v_and_b32 v237, 0xffff0000, v246
    v_lshlrev_b32 v238, 16, v247
    v_and_b32 v239, 0xffff0000, v247
    v_pk_fma_f32 v[224:225], v[224:225], v[8:9], v[28:29] op_sel_hi:[1,0,0] neg_lo:[0,0,1] neg_hi:[0,0,1]
    v_pk_fma_f32 v[226:227], v[226:227], v[8:9], v[28:29] op_sel_hi:[1,0,0] neg_lo:[0,0,1] neg_hi:[0,0,1]
    v_pk_fma_f32 v[228:229], v[228:229], v[8:9], v[28:29] op_sel_hi:[1,0,0] neg_lo:[0,0,1] neg_hi:[0,0,1]
    v_pk_fma_f32 v[230:231], v[230:231], v[8:9], v[28:29] op_sel_hi:[1,0,0] neg_lo:[0,0,1] neg_hi:[0,0,1]
    v_pk_fma_f32 v[232:233], v[232:233], v[8:9], v[28:29] op_sel_hi:[1,0,0] neg_lo:[0,0,1] neg_hi:[0,0,1]
    v_pk_fma_f32 v[234:235], v[234:235], v[8:9], v[28:29] op_sel_hi:[1,0,0] neg_lo:[0,0,1] neg_hi:[0,0,1]
    v_pk_fma_f32 v[236:237], v[236:237], v[8:9], v[28:29] op_sel_hi:[1,0,0] neg_lo:[0,0,1] neg_hi:[0,0,1]
    v_pk_fma_f32 v[238:239], v[238:239], v[8:9], v[28:29] op_sel_hi:[1,0,0] neg_lo:[0,0,1] neg_hi:[0,0,1]
    v_pk_mul_f32 v[32:33], v[224:225], v[30:31] op_sel_hi:[1,0]
    v_pk_mul_f32 v[34:35], v[226:227], v[30:31] op_sel_hi:[1,0]
    v_pk_mul_f32 v[36:37], v[228:229], v[30:31] op_sel_hi:[1,0]
    v_pk_mul_f32 v[38:39], v[230:231], v[30:31] op_sel_hi:[1,0]
    v_pk_mul_f32 v[40:41], v[232:233], v[30:31] op_sel_hi:[1,0]
    v_pk_mul_f32 v[42:43], v[234:235], v[30:31] op_sel_hi:[1,0]
    v_pk_mul_f32 v[44:45], v[236:237], v[30:31] op_sel_hi:[1,0]
    v_pk_mul_f32 v[46:47], v[238:239], v[30:31] op_sel_hi:[1,0]
    v_exp_f32 v32, v32
    v_exp_f32 v33, v33
    v_exp_f32 v34, v34
    v_exp_f32 v35, v35
    v_exp_f32 v36, v36
    v_exp_f32 v37, v37
    v_exp_f32 v38, v38
    v_exp_f32 v39, v39
    v_exp_f32 v40, v40
    v_exp_f32 v41, v41
    v_exp_f32 v42, v42
    v_exp_f32 v43, v43
    v_exp_f32 v44, v44
    v_exp_f32 v45, v45
    v_exp_f32 v46, v46
    v_exp_f32 v47, v47
    v_pk_add_f32 v[32:33], v[32:33], 1.0 op_sel_hi:[1,0]
    v_pk_add_f32 v[34:35], v[34:35], 1.0 op_sel_hi:[1,0]
    v_pk_add_f32 v[36:37], v[36:37], 1.0 op_sel_hi:[1,0]
    v_pk_add_f32 v[38:39], v[38:39], 1.0 op_sel_hi:[1,0]
    v_pk_add_f32 v[40:41], v[40:41], 1.0 op_sel_hi:[1,0]
    v_pk_add_f32 v[42:43], v[42:43], 1.0 op_sel_hi:[1,0]
    v_pk_add_f32 v[44:45], v[44:45], 1.0 op_sel_hi:[1,0]
    v_pk_add_f32 v[46:47], v[46:47], 1.0 op_sel_hi:[1,0]
    v_rcp_f32 v32, v32
    v_rcp_f32 v33, v33
    v_rcp_f32 v34, v34
    v_rcp_f32 v35, v35
    v_rcp_f32 v36, v36
    v_rcp_f32 v37, v37
    v_rcp_f32 v38, v38
    v_rcp_f32 v39, v39
    v_rcp_f32 v40, v40
    v_rcp_f32 v41, v41
    v_rcp_f32 v42, v42
    v_rcp_f32 v43, v43
    v_rcp_f32 v44, v44
    v_rcp_f32 v45, v45
    v_rcp_f32 v46, v46
    v_rcp_f32 v47, v47
    v_pk_mul_f32 v[224:225], v[224:225], v[32:33]
    v_pk_mul_f32 v[226:227], v[226:227], v[34:35]
    v_pk_mul_f32 v[228:229], v[228:229], v[36:37]
    v_pk_mul_f32 v[230:231], v[230:231], v[38:39]
    v_pk_mul_f32 v[232:233], v[232:233], v[40:41]
    v_pk_mul_f32 v[234:235], v[234:235], v[42:43]
    v_pk_mul_f32 v[236:237], v[236:237], v[44:45]
    v_pk_mul_f32 v[238:239], v[238:239], v[46:47]
    s_add_u32 s3, s75, 0
    s_nop 0
    buffer_load_dwordx4 v[80:83], v13, s[48:51], s3 offen sc1
    s_add_u32 s3, s75, 57344
    buffer_load_dwordx4 v[84:87], v13, s[48:51], s3 offen sc1
    s_add_u32 s3, s75, 114688
    buffer_load_dwordx4 v[88:91], v13, s[48:51], s3 offen sc1
    s_add_u32 s3, s75, 172032
    buffer_load_dwordx4 v[92:95], v13, s[48:51], s3 offen sc1
    s_waitcnt vmcnt(0)
    s_mov_b32 s29, 0
L_k5:
    v_max3_u32 v2, v80, v81, v82
    v_max3_u32 v2, v2, v83, v84
    v_max3_u32 v2, v2, v85, v86
    v_max3_u32 v2, v2, v87, v88
    v_max3_u32 v2, v2, v89, v90
    v_max3_u32 v2, v2, v91, v92
    v_max3_u32 v2, v2, v93, v94
    v_max_u32 v2, v2, v95
    v_cmp_eq_u32 vcc, -1, v2
    s_cbranch_vccz L_k5k
    s_add_u32 s29, s29, 1
    s_cmp_ge_u32 s29, 200000
    s_cbranch_scc1 L_k5k
    s_sleep 1
    s_add_u32 s3, s75, 0
    s_nop 0
    buffer_load_dwordx4 v[80:83], v13, s[48:51], s3 offen sc1
    s_add_u32 s3, s75, 57344
    buffer_load_dwordx4 v[84:87], v13, s[48:51], s3 offen sc1
    s_add_u32 s3, s75, 114688
    buffer_load_dwordx4 v[88:91], v13, s[48:51], s3 offen sc1
    s_add_u32 s3, s75, 172032
    buffer_load_dwordx4 v[92:95], v13, s[48:51], s3 offen sc1
    s_waitcnt vmcnt(0)
    s_branch L_k5
L_k5k:
    v_pk_add_f32 v[80:81], v[80:81], v[84:85]
    v_pk_add_f32 v[82:83], v[82:83], v[86:87]
    v_pk_add_f32 v[88:89], v[88:89], v[92:93]
    v_pk_add_f32 v[90:91], v[90:91], v[94:95]
    s_nop 0
    v_permlane32_swap_b32 v80, v88
    v_permlane32_swap_b32 v81, v89
    v_permlane32_swap_b32 v82, v90
    v_permlane32_swap_b32 v83, v91
    v_add_f32 v80, v80, v88
    v_add_f32 v81, v81, v89
    v_add_f32 v82, v82, v90
    v_add_f32 v83, v83, v91
    v_permlane16_swap_b32 v80, v81
    s_nop 0
    v_permlane16_swap_b32 v82, v83
    v_add_f32 v80, v80, v81
    v_add_f32 v82, v82, v83
    s_nop 1
    v_permlane32_swap_b32 v80, v82
    v_cvt_pk_bf16_f32 v80, v80, v80
    v_lshlrev_b32 v80, 16, v80
    v_cvt_pk_bf16_f32 v82, v82, v82
    v_lshlrev_b32 v82, 16, v82
    v_mul_f32 v2, 0xbfb8aa3b, v80
    v_exp_f32 v2, v2
    s_nop 0
    v_add_f32 v2, 1.0, v2
    v_rcp_f32 v2, v2
    s_nop 0
    v_mul_f32 v80, v80, v2
    v_cvt_pk_bf16_f32 v80, v80, v80
    v_lshlrev_b32 v80, 16, v80
    v_mul_f32 v80, v80, v82
    v_cvt_pk_bf16_f32 v80, v80, v80
    v_lshlrev_b32 v80, 16, v80
    v_bfe_u32 v2, v1, 3, 2
    v_lshlrev_b32 v2, 6, v2
    v_lshrrev_b32_e64 v3, 5, v1
    v_lshl_add_u32 v2, v3, 2, v2
    ds_bpermute_b32 v128, v2, v80 offset:0
    ds_bpermute_b32 v130, v2, v80 offset:8
    ds_bpermute_b32 v132, v2, v80 offset:16
    ds_bpermute_b32 v134, v2, v80 offset:24
    ds_bpermute_b32 v136, v2, v80 offset:32
    ds_bpermute_b32 v138, v2, v80 offset:40
    ds_bpermute_b32 v140, v2, v80 offset:48
    v_mov_b64 v[120:121], 0
    v_mov_b64 v[122:123], 0
    v_mov_b64 v[124:125], 0
    v_mov_b64 v[126:127], 0
    s_waitcnt lgkmcnt(0)
    v_lshlrev_b32 v2, 16, v192
    v_and_b32 v3, 0xffff0000, v192
    v_pk_fma_f32 v[120:121], v[2:3], v[128:129], v[120:121] op_sel_hi:[1,0,1]
    v_lshlrev_b32_e64 v4, 16, v193
    v_and_b32 v5, 0xffff0000, v193
    v_pk_fma_f32 v[122:123], v[4:5], v[128:129], v[122:123] op_sel_hi:[1,0,1]
    v_lshlrev_b32_e64 v2, 16, v194
    v_and_b32 v3, 0xffff0000, v194
    v_pk_fma_f32 v[124:125], v[2:3], v[128:129], v[124:125] op_sel_hi:[1,0,1]
    v_lshlrev_b32_e64 v4, 16, v195
    v_and_b32 v5, 0xffff0000, v195
    v_pk_fma_f32 v[126:127], v[4:5], v[128:129], v[126:127] op_sel_hi:[1,0,1]
    v_lshlrev_b32_e64 v2, 16, v196
    v_and_b32 v3, 0xffff0000, v196
    v_pk_fma_f32 v[120:121], v[2:3], v[130:131], v[120:121] op_sel_hi:[1,0,1]
    v_lshlrev_b32_e64 v4, 16, v197
    v_and_b32 v5, 0xffff0000, v197
    v_pk_fma_f32 v[122:123], v[4:5], v[130:131], v[122:123] op_sel_hi:[1,0,1]
    v_lshlrev_b32_e64 v2, 16, v198
    v_and_b32 v3, 0xffff0000, v198
    v_pk_fma_f32 v[124:125], v[2:3], v[130:131], v[124:125] op_sel_hi:[1,0,1]
    v_lshlrev_b32_e64 v4, 16, v199
    v_and_b32 v5, 0xffff0000, v199
    v_pk_fma_f32 v[126:127], v[4:5], v[130:131], v[126:127] op_sel_hi:[1,0,1]
    v_lshlrev_b32_e64 v2, 16, v200
    v_and_b32 v3, 0xffff0000, v200
    v_pk_fma_f32 v[120:121], v[2:3], v[132:133], v[120:121] op_sel_hi:[1,0,1]
    v_lshlrev_b32_e64 v4, 16, v201
    v_and_b32 v5, 0xffff0000, v201
    v_pk_fma_f32 v[122:123], v[4:5], v[132:133], v[122:123] op_sel_hi:[1,0,1]
    v_lshlrev_b32_e64 v2, 16, v202
    v_and_b32 v3, 0xffff0000, v202
    v_pk_fma_f32 v[124:125], v[2:3], v[132:133], v[124:125] op_sel_hi:[1,0,1]
    v_lshlrev_b32_e64 v4, 16, v203
    v_and_b32 v5, 0xffff0000, v203
    v_pk_fma_f32 v[126:127], v[4:5], v[132:133], v[126:127] op_sel_hi:[1,0,1]
    v_lshlrev_b32_e64 v2, 16, v204
    v_and_b32 v3, 0xffff0000, v204
    v_pk_fma_f32 v[120:121], v[2:3], v[134:135], v[120:121] op_sel_hi:[1,0,1]
    v_lshlrev_b32_e64 v4, 16, v205
    v_and_b32 v5, 0xffff0000, v205
    v_pk_fma_f32 v[122:123], v[4:5], v[134:135], v[122:123] op_sel_hi:[1,0,1]
    v_lshlrev_b32_e64 v2, 16, v206
    v_and_b32 v3, 0xffff0000, v206
    v_pk_fma_f32 v[124:125], v[2:3], v[134:135], v[124:125] op_sel_hi:[1,0,1]
    v_lshlrev_b32_e64 v4, 16, v207
    v_and_b32 v5, 0xffff0000, v207
    v_pk_fma_f32 v[126:127], v[4:5], v[134:135], v[126:127] op_sel_hi:[1,0,1]
    v_lshlrev_b32_e64 v2, 16, v208
    v_and_b32 v3, 0xffff0000, v208
    v_pk_fma_f32 v[120:121], v[2:3], v[136:137], v[120:121] op_sel_hi:[1,0,1]
    v_lshlrev_b32_e64 v4, 16, v209
    v_and_b32 v5, 0xffff0000, v209
    v_pk_fma_f32 v[122:123], v[4:5], v[136:137], v[122:123] op_sel_hi:[1,0,1]
    v_lshlrev_b32_e64 v2, 16, v210
    v_and_b32 v3, 0xffff0000, v210
    v_pk_fma_f32 v[124:125], v[2:3], v[136:137], v[124:125] op_sel_hi:[1,0,1]
    v_lshlrev_b32_e64 v4, 16, v211
    v_and_b32 v5, 0xffff0000, v211
    v_pk_fma_f32 v[126:127], v[4:5], v[136:137], v[126:127] op_sel_hi:[1,0,1]
    v_lshlrev_b32_e64 v2, 16, v212
    v_and_b32 v3, 0xffff0000, v212
    v_pk_fma_f32 v[120:121], v[2:3], v[138:139], v[120:121] op_sel_hi:[1,0,1]
    v_lshlrev_b32_e64 v4, 16, v213
    v_and_b32 v5, 0xffff0000, v213
    v_pk_fma_f32 v[122:123], v[4:5], v[138:139], v[122:123] op_sel_hi:[1,0,1]
    v_lshlrev_b32_e64 v2, 16, v214
    v_and_b32 v3, 0xffff0000, v214
    v_pk_fma_f32 v[124:125], v[2:3], v[138:139], v[124:125] op_sel_hi:[1,0,1]
    v_lshlrev_b32_e64 v4, 16, v215
    v_and_b32 v5, 0xffff0000, v215
    v_pk_fma_f32 v[126:127], v[4:5], v[138:139], v[126:127] op_sel_hi:[1,0,1]
    v_lshlrev_b32_e64 v2, 16, v216
    v_and_b32 v3, 0xffff0000, v216
    v_pk_fma_f32 v[120:121], v[2:3], v[140:141], v[120:121] op_sel_hi:[1,0,1]
    v_lshlrev_b32_e64 v4, 16, v217
    v_and_b32 v5, 0xffff0000, v217
    v_pk_fma_f32 v[122:123], v[4:5], v[140:141], v[122:123] op_sel_hi:[1,0,1]
    v_lshlrev_b32_e64 v2, 16, v218
    v_and_b32 v3, 0xffff0000, v218
    v_pk_fma_f32 v[124:125], v[2:3], v[140:141], v[124:125] op_sel_hi:[1,0,1]
    v_lshlrev_b32_e64 v4, 16, v219
    v_and_b32 v5, 0xffff0000, v219
    v_pk_fma_f32 v[126:127], v[4:5], v[140:141], v[126:127] op_sel_hi:[1,0,1]
    v_permlane32_swap_b32 v120, v124
    v_permlane32_swap_b32 v121, v125
    v_permlane32_swap_b32 v122, v126
    v_permlane32_swap_b32 v123, v127
    v_add_f32 v120, v120, v124
    v_add_f32 v121, v121, v125
    v_add_f32 v122, v122, v126
    v_add_f32 v123, v123, v127
    s_nop 0
    v_permlane16_swap_b32 v120, v122
    v_permlane16_swap_b32 v121, v123
    v_add_f32 v120, v120, v122
    v_add_f32 v121, v121, v123
    s_nop 0
    v_add_f32 v120, v120, v120 row_ror:8 row_mask:0xf bank_mask:0xf
    v_add_f32 v121, v121, v121 row_ror:8 row_mask:0xf bank_mask:0xf
    v_and_b32 v2, 8, v1
    v_cmp_eq_u32 vcc, 0, v2
    s_and_b32 s3, s2, 15
    s_lshl_b32 s3, s3, 4
    s_lshr_b32 s28, s2, 4
    s_add_u32 s3, s3, s28
    s_lshl_b32 s3, s3, 2
    s_add_u32 s3, s3, s38
    s_lshl_b32 s3, s3, 8
    s_add_u32 s3, s3, 1413120
    v_cndmask_b32 v120, v121, v120, vcc
    buffer_store_dword v120, v253, s[48:51], s3 offen sc1
    v_and_b32 v3, 3, v1
    v_lshlrev_b32 v3, 2, v3
    v_add_u32 v3, 162112, v3
L_ow:
    ds_read_b32 v2, v3
    s_waitcnt lgkmcnt(0)
    v_cmp_ne_u32 vcc, 7, v2
    s_cbranch_vccz L_owk
    s_sleep 1
    s_branch L_ow
L_owk:
    s_sleep 4
    s_branch L_p3
L_C:
    s_and_b32 s64, s38, 1
    s_lshr_b32 s65, s38, 1
    v_and_b32 v3, 15, v1
    v_lshlrev_b32 v3, 7, v3
    s_lshl_b32 s3, s64, 13
    v_add_u32 v3, s3, v3
    v_bfe_u32 v5, v1, 1, 3
    v_lshrrev_b32 v6, 4, v1
    v_xor_b32 v6, v6, v5
    v_lshl_add_u32 v184, v6, 4, v3
    v_xor_b32 v185, 64, v184
    v_lshrrev_b32 v6, 4, v1
    v_lshlrev_b32 v6, 3, v6
    v_bfe_u32 v7, v1, 2, 2
    v_add_u32 v6, v6, v7
    v_lshlrev_b32 v6, 7, v6
    v_and_b32_e64 v7, 3, v1
    v_lshl_add_u32 v6, v7, 3, v6
    v_add_u32 v6, 16384, v6
    v_bfe_u32 v7, v1, 3, 2
    s_lshl_b32 s3, s65, 1
    v_xor_b32 v7, s3, v7
    v_lshl_add_u32 v186, v7, 5, v6
    v_xor_b32_e64 v187, 32, v186
    v_add_u32 v188, 81920, v184
    v_add_u32 v189, 81920, v185
    v_add_u32 v190, 81920, v186
    v_add_u32 v191, 81920, v187
    s_waitcnt lgkmcnt(0)
    s_mov_b32 s48, s26
    s_mov_b32 s49, s27
    s_mov_b32 s50, 268435456
    s_mov_b32 s51, 0x00020000
    s_mov_b32 s40, s4
    s_mov_b32 s41, s5
    s_mov_b32 s42, 4194304
    s_mov_b32 s43, 0x00020000
    s_mov_b32 s88, s10
    s_mov_b32 s89, s11
    s_mov_b32 s90, 2097152
    s_mov_b32 s91, 0x00020000
    s_lshl_b32 s3, s36, 7
    s_lshl_b32 s28, s37, 3
    s_add_u32 s3, s3, s28
    s_lshl_b32 s28, s38, 1
    s_add_u32 s69, s3, s28
    v_lshlrev_b32 v2, 4, v1
    v_mov_b32 v248, 16384
    v_mov_b32 v4, -1
    v_mov_b32 v5, -1
    v_mov_b32 v6, -1
    v_mov_b32_e64 v7, -1
    s_lshl_b32 s28, s2, 2
    s_add_u32 s28, s28, s38
    s_mul_i32 s28, s28, 768
    s_add_u32 s28, s28, 1048320
    s_lshl_b32 s3, s37, 4
    s_add_u32 s3, s3, s36
    s_lshl_b32 s3, s3, 2
    s_add_u32 s3, s3, s38
    s_lshl_b32 s3, s3, 8
    s_add_u32 s3, s3, 524288
    v_cmp_gt_u32 vcc, 16, v1
    v_add_u32 v3, s3, v2
    v_add_u32_e64 v2, s28, v2
    v_cndmask_b32 v2, v2, v3, vcc
    buffer_store_dwordx4 v[4:7], v2, s[48:51], 0 offen sc1
    buffer_load_dword v248, v248, s[48:51], 0 offen sc1
    s_getpc_b64 s[92:93]
L_pc:
    s_sub_u32 s92, s92, L_pc-recurrent_scan__linear_kernel_hedgehog__moe_arch_mod__prompt_kernel
    s_subb_u32 s93, s93, 0
    s_lshr_b32 s3, s2, 3
    s_lshl_b32 s3, s3, 2
    s_add_u32 s3, s3, s38
    s_lshl_b32 s3, s3, 8
    v_lshlrev_b32 v2, 7, v1
    v_add_u32 v2, s3, v2
    s_mov_b64 exec, 3
    global_load_dword v249, v2, s[92:93]
    s_mov_b64 exec, -1
    v_mov_b64 v[8:9], 0
    v_mov_b64 v[10:11], 0
    v_mov_b64 v[12:13], 0
    v_mov_b64 v[14:15], 0
    v_mov_b64 v[16:17], 0
    v_mov_b64 v[18:19], 0
    v_mov_b64 v[20:21], 0
    v_mov_b64 v[22:23], 0
    v_mov_b64 v[24:25], 0
    v_mov_b64 v[26:27], 0
    v_mov_b64 v[28:29], 0
    v_mov_b64 v[30:31], 0
    v_mov_b64 v[32:33], 0
    v_mov_b64 v[34:35], 0
    v_mov_b64 v[36:37], 0
    v_mov_b64 v[38:39], 0
    v_mov_b64 v[40:41], 0
    v_mov_b64 v[42:43], 0
    v_mov_b64 v[44:45], 0
    v_mov_b64 v[46:47], 0
    v_mov_b64 v[48:49], 0
    v_mov_b64 v[50:51], 0
    v_mov_b64 v[52:53], 0
    v_mov_b64 v[54:55], 0
    v_mov_b64 v[56:57], 0
    v_mov_b64 v[58:59], 0
    v_mov_b64 v[60:61], 0
    v_mov_b64 v[62:63], 0
    v_mov_b64 v[64:65], 0
    v_mov_b64 v[66:67], 0
    v_mov_b64 v[68:69], 0
    v_mov_b64 v[70:71], 0
    v_mov_b64 v[72:73], 0
    v_mov_b64 v[74:75], 0
    v_mov_b64 v[76:77], 0
    v_mov_b64 v[78:79], 0
    v_mov_b64 v[80:81], 0
    v_mov_b64 v[82:83], 0
    v_mov_b64 v[84:85], 0
    v_mov_b64 v[86:87], 0
    v_mov_b64 v[88:89], 0
    v_mov_b64 v[90:91], 0
    v_mov_b64 v[92:93], 0
    v_mov_b64 v[94:95], 0
    v_mov_b64 v[96:97], 0
    v_mov_b64 v[98:99], 0
    v_mov_b64 v[100:101], 0
    v_mov_b64 v[102:103], 0
    s_lshl_b32 s3, s38, 2
    s_add_u32 s3, s3, 162112
    v_mov_b32 v2, s3
    v_mov_b32_e64 v3, 0
    ds_write_b32 v2, v3
    ds_write_b32 v2, v3 offset:16
    s_mov_b32 s86, 0
    s_mov_b32 s66, 0
    s_setprio 2
    s_waitcnt lgkmcnt(0)
L_ln:
    s_lshl_b32 s3, s38, 12
    s_add_u32 s3, s3, 131072
    v_lshlrev_b32 v2, 4, v1
    v_add_u32 v3, s3, v2
    v_add_u32 v2, 122880, v2
    s_barrier
    ds_read_b128 v[120:123], v2 offset:0
    ds_read_b128 v[124:127], v2 offset:1024
    ds_read_b128 v[104:107], v3 offset:0
    ds_read_b128 v[108:111], v3 offset:1024
    ds_read_b128 v[112:115], v3 offset:2048
    ds_read_b128 v[116:119], v3 offset:3072
    v_mov_b32 v2, 0x3f803f80
    v_mov_b32 v192, 0
    v_mov_b32 v194, 0
    v_mov_b32 v196, 0
    v_mov_b32 v198, 0
    v_mov_b32 v200, 0
    v_mov_b32 v202, 0
    v_mov_b32 v204, 0
    v_mov_b32 v206, 0
    s_waitcnt lgkmcnt(2)
    v_dot2c_f32_bf16 v192, v104, v2
    v_dot2c_f32_bf16 v196, v104, v104
    v_dot2c_f32_bf16 v200, v104, v120
    v_dot2c_f32_bf16 v204, v120, v2
    v_dot2c_f32_bf16 v192, v105, v2
    v_dot2c_f32_bf16 v196, v105, v105
    v_dot2c_f32_bf16 v200, v105, v121
    v_dot2c_f32_bf16 v204, v121, v2
    v_dot2c_f32_bf16 v192, v106, v2
    v_dot2c_f32_bf16 v196, v106, v106
    v_dot2c_f32_bf16 v200, v106, v122
    v_dot2c_f32_bf16 v204, v122, v2
    v_dot2c_f32_bf16 v192, v107, v2
    v_dot2c_f32_bf16 v196, v107, v107
    v_dot2c_f32_bf16 v200, v107, v123
    v_dot2c_f32_bf16 v204, v123, v2
    v_dot2c_f32_bf16 v192, v108, v2
    v_dot2c_f32_bf16 v196, v108, v108
    v_dot2c_f32_bf16 v200, v108, v124
    v_dot2c_f32_bf16 v204, v124, v2
    v_dot2c_f32_bf16 v192, v109, v2
    v_dot2c_f32_bf16 v196, v109, v109
    v_dot2c_f32_bf16 v200, v109, v125
    v_dot2c_f32_bf16 v204, v125, v2
    v_dot2c_f32_bf16 v192, v110, v2
    v_dot2c_f32_bf16 v196, v110, v110
    v_dot2c_f32_bf16 v200, v110, v126
    v_dot2c_f32_bf16 v204, v126, v2
    v_dot2c_f32_bf16 v192, v111, v2
    v_dot2c_f32_bf16 v196, v111, v111
    v_dot2c_f32_bf16 v200, v111, v127
    v_dot2c_f32_bf16 v204, v127, v2
    s_waitcnt lgkmcnt(0)
    v_dot2c_f32_bf16 v194, v112, v2
    v_dot2c_f32_bf16 v198, v112, v112
    v_dot2c_f32_bf16 v202, v112, v120
    v_dot2c_f32_bf16 v206, v120, v2
    v_dot2c_f32_bf16 v194, v113, v2
    v_dot2c_f32_bf16 v198, v113, v113
    v_dot2c_f32_bf16 v202, v113, v121
    v_dot2c_f32_bf16 v206, v121, v2
    v_dot2c_f32_bf16 v194, v114, v2
    v_dot2c_f32_bf16 v198, v114, v114
    v_dot2c_f32_bf16 v202, v114, v122
    v_dot2c_f32_bf16 v206, v122, v2
    v_dot2c_f32_bf16 v194, v115, v2
    v_dot2c_f32_bf16 v198, v115, v115
    v_dot2c_f32_bf16 v202, v115, v123
    v_dot2c_f32_bf16 v206, v123, v2
    v_dot2c_f32_bf16 v194, v116, v2
    v_dot2c_f32_bf16 v198, v116, v116
    v_dot2c_f32_bf16 v202, v116, v124
    v_dot2c_f32_bf16 v206, v124, v2
    v_dot2c_f32_bf16 v194, v117, v2
    v_dot2c_f32_bf16 v198, v117, v117
    v_dot2c_f32_bf16 v202, v117, v125
    v_dot2c_f32_bf16 v206, v125, v2
    v_dot2c_f32_bf16 v194, v118, v2
    v_dot2c_f32_bf16 v198, v118, v118
    v_dot2c_f32_bf16 v202, v118, v126
    v_dot2c_f32_bf16 v206, v126, v2
    v_dot2c_f32_bf16 v194, v119, v2
    v_dot2c_f32_bf16 v198, v119, v119
    v_dot2c_f32_bf16 v202, v119, v127
    v_dot2c_f32_bf16 v206, v127, v2
    v_permlane32_swap_b32 v192, v194
    v_permlane32_swap_b32 v196, v198
    v_permlane32_swap_b32 v200, v202
    v_permlane32_swap_b32 v204, v206
    v_add_f32 v192, v192, v194
    v_add_f32 v196, v196, v198
    v_add_f32 v200, v200, v202
    v_add_f32 v204, v204, v206
    v_add_f32 v192, v192, v192 quad_perm:[1,0,3,2] row_mask:0xf bank_mask:0xf
    v_add_f32 v196, v196, v196 quad_perm:[1,0,3,2] row_mask:0xf bank_mask:0xf
    v_add_f32 v200, v200, v200 quad_perm:[1,0,3,2] row_mask:0xf bank_mask:0xf
    v_add_f32 v204, v204, v204 quad_perm:[1,0,3,2] row_mask:0xf bank_mask:0xf
    v_add_f32 v192, v192, v192 quad_perm:[2,3,0,1] row_mask:0xf bank_mask:0xf
    v_add_f32 v196, v196, v196 quad_perm:[2,3,0,1] row_mask:0xf bank_mask:0xf
    v_add_f32 v200, v200, v200 quad_perm:[2,3,0,1] row_mask:0xf bank_mask:0xf
    v_add_f32 v204, v204, v204 quad_perm:[2,3,0,1] row_mask:0xf bank_mask:0xf
    v_add_f32 v192, v192, v192 row_half_mirror row_mask:0xf bank_mask:0xf
    v_add_f32 v196, v196, v196 row_half_mirror row_mask:0xf bank_mask:0xf
    v_add_f32 v200, v200, v200 row_half_mirror row_mask:0xf bank_mask:0xf
    v_add_f32 v204, v204, v204 row_half_mirror row_mask:0xf bank_mask:0xf
    v_add_f32 v192, v192, v192 row_mirror row_mask:0xf bank_mask:0xf
    v_add_f32 v196, v196, v196 row_mirror row_mask:0xf bank_mask:0xf
    v_add_f32 v200, v200, v200 row_mirror row_mask:0xf bank_mask:0xf
    v_add_f32 v204, v204, v204 row_mirror row_mask:0xf bank_mask:0xf
    v_mov_b32 v193, v192
    v_mov_b32 v197, v196
    v_mov_b32 v201, v200
    v_mov_b32 v205, v204
    v_permlane16_swap_b32 v192, v193
    v_permlane16_swap_b32 v196, v197
    v_permlane16_swap_b32 v200, v201
    v_permlane16_swap_b32 v204, v205
    v_add_f32 v192, v192, v193
    v_add_f32 v196, v196, v197
    v_add_f32 v200, v200, v201
    v_add_f32 v204, v204, v205
    v_mul_f32 v192, 0x3a800000, v192
    v_mul_f32 v196, 0x3a800000, v196
    v_cvt_pk_bf16_f32 v193, v192, v192
    v_lshlrev_b32 v193, 16, v193
    v_fma_f32 v196, -v192, v192, v196
    v_max_f32 v196, 0, v196
    v_fma_f32 v200, -v193, v204, v200
    s_waitcnt vmcnt(0)
    v_cvt_pk_bf16_f32 v196, v196, v196
    v_lshlrev_b32 v196, 16, v196
    v_add_f32 v196, 0x3727c5ac, v196
    v_cvt_pk_bf16_f32 v196, v196, v196
    v_lshlrev_b32 v196, 16, v196
    v_sqrt_f32 v196, v196
    s_nop 0
    v_cvt_pk_bf16_f32 v196, v196, v196
    v_lshlrev_b32 v196, 16, v196
    v_rcp_f32 v2, v196
    v_lshrrev_b32 v3, 16, v193
    v_or_b32 v4, v3, v196
    v_mul_f32 v200, v200, v2
    v_cvt_pk_bf16_f32 v200, v200, v200
    v_lshlrev_b32 v200, 16, v200
    v_ashrrev_i32 v2, 31, v200
    v_or_b32 v2, 0x80000000, v2
    v_xor_b32 v2, v200, v2
    v_and_b32 v2, 0xffff0000, v2
    v_lshrrev_b32 v3, 5, v1
    v_add_u32 v5, s69, v3
    v_sub_u32 v5, 2047, v5
    v_or_b32 v6, v2, v5
    v_mov_b32 v2, v6
    v_mov_b32 v5, v4
    v_add_u32 v7, 1, v248
    v_mov_b32 v3, 0
    v_readfirstlane_b32 s86, v7
    v_permlane32_swap_b32 v6, v2
    v_permlane32_swap_b32 v4, v5
    v_max_u32 v6, v6, v2
    s_lshl_b32 s3, s69, 3
    s_mov_b64 exec, 1
    buffer_store_dwordx4 v[4:7], v3, s[48:51], s3 offen sc1
    s_mov_b64 exec, -1
    s_branch L_lnr
L_lnr:
    s_barrier
    s_nop 0
    ds_read_b128 v[104:107], v184 offset:0
    ds_read_b64_tr_b16 v[120:121], v186 offset:0
    ds_read_b64_tr_b16 v[122:123], v186 offset:512
    ds_read_b64_tr_b16 v[124:125], v187 offset:0
    ds_read_b64_tr_b16 v[126:127], v187 offset:512
    ds_read_b64_tr_b16 v[128:129], v186 offset:8192
    ds_read_b64_tr_b16 v[130:131], v186 offset:8704
    ds_read_b64_tr_b16 v[132:133], v187 offset:8192
    ds_read_b64_tr_b16 v[134:135], v187 offset:8704
    ds_read_b64_tr_b16 v[136:137], v186 offset:16384
    ds_read_b64_tr_b16 v[138:139], v186 offset:16896
    ds_read_b64_tr_b16 v[140:141], v187 offset:16384
    ds_read_b64_tr_b16 v[142:143], v187 offset:16896
    ds_read_b128 v[108:111], v184 offset:2048
    ds_read_b128 v[112:115], v184 offset:4096
    ds_read_b128 v[116:119], v184 offset:6144
    s_branch L_cmid
.p2align 6
L_cloop:
    s_waitcnt lgkmcnt(0)
    s_barrier
    v_mfma_f32_16x16x32_bf16 v[8:11], v[160:163], v[144:147], v[8:11]
    ds_read_b128 v[104:107], v184 offset:0
    v_mfma_f32_16x16x32_bf16 v[12:15], v[164:167], v[144:147], v[12:15]
    ds_read_b64_tr_b16 v[120:121], v186 offset:0
    v_mfma_f32_16x16x32_bf16 v[16:19], v[168:171], v[144:147], v[16:19]
    ds_read_b64_tr_b16 v[122:123], v186 offset:512
    v_mfma_f32_16x16x32_bf16 v[20:23], v[172:175], v[144:147], v[20:23]
    ds_read_b64_tr_b16 v[124:125], v187 offset:0
    v_mfma_f32_16x16x32_bf16 v[24:27], v[144:147], v[176:179], v[24:27]
    ds_read_b64_tr_b16 v[126:127], v187 offset:512
    v_mfma_f32_16x16x32_bf16 v[28:31], v[144:147], v[180:183], v[28:31]
    ds_read_b64_tr_b16 v[128:129], v186 offset:8192
    v_mfma_f32_16x16x32_bf16 v[32:35], v[160:163], v[148:151], v[32:35]
    ds_read_b64_tr_b16 v[130:131], v186 offset:8704
    v_mfma_f32_16x16x32_bf16 v[36:39], v[164:167], v[148:151], v[36:39]
    ds_read_b64_tr_b16 v[132:133], v187 offset:8192
    v_mfma_f32_16x16x32_bf16 v[40:43], v[168:171], v[148:151], v[40:43]
    ds_read_b64_tr_b16 v[134:135], v187 offset:8704
    v_mfma_f32_16x16x32_bf16 v[44:47], v[172:175], v[148:151], v[44:47]
    ds_read_b64_tr_b16 v[136:137], v186 offset:16384
    v_mfma_f32_16x16x32_bf16 v[48:51], v[148:151], v[176:179], v[48:51]
    ds_read_b64_tr_b16 v[138:139], v186 offset:16896
    v_mfma_f32_16x16x32_bf16 v[52:55], v[148:151], v[180:183], v[52:55]
    ds_read_b64_tr_b16 v[140:141], v187 offset:16384
    v_mfma_f32_16x16x32_bf16 v[56:59], v[160:163], v[152:155], v[56:59]
    ds_read_b64_tr_b16 v[142:143], v187 offset:16896
    v_mfma_f32_16x16x32_bf16 v[60:63], v[164:167], v[152:155], v[60:63]
    ds_read_b128 v[108:111], v184 offset:2048
    v_mfma_f32_16x16x32_bf16 v[64:67], v[168:171], v[152:155], v[64:67]
    ds_read_b128 v[112:115], v184 offset:4096
    v_mfma_f32_16x16x32_bf16 v[68:71], v[172:175], v[152:155], v[68:71]
    ds_read_b128 v[116:119], v184 offset:6144
    v_mfma_f32_16x16x32_bf16 v[72:75], v[152:155], v[176:179], v[72:75]
    v_mfma_f32_16x16x32_bf16 v[76:79], v[152:155], v[180:183], v[76:79]
    v_mfma_f32_16x16x32_bf16 v[80:83], v[160:163], v[156:159], v[80:83]
    v_mfma_f32_16x16x32_bf16 v[84:87], v[164:167], v[156:159], v[84:87]
    v_mfma_f32_16x16x32_bf16 v[88:91], v[168:171], v[156:159], v[88:91]
    v_mfma_f32_16x16x32_bf16 v[92:95], v[172:175], v[156:159], v[92:95]
    v_mfma_f32_16x16x32_bf16 v[96:99], v[156:159], v[176:179], v[96:99]
    v_mfma_f32_16x16x32_bf16 v[100:103], v[156:159], v[180:183], v[100:103]
L_cmid:
    s_waitcnt lgkmcnt(0)
    s_nop 0
    v_mfma_f32_16x16x32_bf16 v[8:11], v[120:123], v[104:107], v[8:11]
    ds_read_b128 v[144:147], v185 offset:0
    v_mfma_f32_16x16x32_bf16 v[12:15], v[124:127], v[104:107], v[12:15]
    ds_read_b64_tr_b16 v[160:161], v186 offset:4096
    v_mfma_f32_16x16x32_bf16 v[16:19], v[128:131], v[104:107], v[16:19]
    ds_read_b64_tr_b16 v[162:163], v186 offset:4608
    v_mfma_f32_16x16x32_bf16 v[20:23], v[132:135], v[104:107], v[20:23]
    ds_read_b64_tr_b16 v[164:165], v187 offset:4096
    v_mfma_f32_16x16x32_bf16 v[24:27], v[104:107], v[136:139], v[24:27]
    ds_read_b64_tr_b16 v[166:167], v187 offset:4608
    v_mfma_f32_16x16x32_bf16 v[28:31], v[104:107], v[140:143], v[28:31]
    ds_read_b64_tr_b16 v[168:169], v186 offset:12288
    v_mfma_f32_16x16x32_bf16 v[32:35], v[120:123], v[108:111], v[32:35]
    ds_read_b64_tr_b16 v[170:171], v186 offset:12800
    v_mfma_f32_16x16x32_bf16 v[36:39], v[124:127], v[108:111], v[36:39]
    ds_read_b64_tr_b16 v[172:173], v187 offset:12288
    v_mfma_f32_16x16x32_bf16 v[40:43], v[128:131], v[108:111], v[40:43]
    ds_read_b64_tr_b16 v[174:175], v187 offset:12800
    v_mfma_f32_16x16x32_bf16 v[44:47], v[132:135], v[108:111], v[44:47]
    ds_read_b64_tr_b16 v[176:177], v186 offset:20480
    v_mfma_f32_16x16x32_bf16 v[48:51], v[108:111], v[136:139], v[48:51]
    ds_read_b64_tr_b16 v[178:179], v186 offset:20992
    v_mfma_f32_16x16x32_bf16 v[52:55], v[108:111], v[140:143], v[52:55]
    ds_read_b64_tr_b16 v[180:181], v187 offset:20480
    v_mfma_f32_16x16x32_bf16 v[56:59], v[120:123], v[112:115], v[56:59]
    ds_read_b64_tr_b16 v[182:183], v187 offset:20992
    v_mfma_f32_16x16x32_bf16 v[60:63], v[124:127], v[112:115], v[60:63]
    ds_read_b128 v[148:151], v185 offset:2048
    v_mfma_f32_16x16x32_bf16 v[64:67], v[128:131], v[112:115], v[64:67]
    ds_read_b128 v[152:155], v185 offset:4096
    v_mfma_f32_16x16x32_bf16 v[68:71], v[132:135], v[112:115], v[68:71]
    ds_read_b128 v[156:159], v185 offset:6144
    v_mfma_f32_16x16x32_bf16 v[72:75], v[112:115], v[136:139], v[72:75]
    v_mfma_f32_16x16x32_bf16 v[76:79], v[112:115], v[140:143], v[76:79]
    v_mfma_f32_16x16x32_bf16 v[80:83], v[120:123], v[116:119], v[80:83]
    v_mfma_f32_16x16x32_bf16 v[84:87], v[124:127], v[116:119], v[84:87]
    v_mfma_f32_16x16x32_bf16 v[88:91], v[128:131], v[116:119], v[88:91]
    v_mfma_f32_16x16x32_bf16 v[92:95], v[132:135], v[116:119], v[92:95]
    v_mfma_f32_16x16x32_bf16 v[96:99], v[116:119], v[136:139], v[96:99]
    v_mfma_f32_16x16x32_bf16 v[100:103], v[116:119], v[140:143], v[100:103]
    s_waitcnt lgkmcnt(0)
    s_barrier
    v_mfma_f32_16x16x32_bf16 v[8:11], v[160:163], v[144:147], v[8:11]
    ds_read_b128 v[104:107], v184 offset:40960
    v_mfma_f32_16x16x32_bf16 v[12:15], v[164:167], v[144:147], v[12:15]
    ds_read_b64_tr_b16 v[120:121], v186 offset:40960
    v_mfma_f32_16x16x32_bf16 v[16:19], v[168:171], v[144:147], v[16:19]
    ds_read_b64_tr_b16 v[122:123], v186 offset:41472
    v_mfma_f32_16x16x32_bf16 v[20:23], v[172:175], v[144:147], v[20:23]
    ds_read_b64_tr_b16 v[124:125], v187 offset:40960
    v_mfma_f32_16x16x32_bf16 v[24:27], v[144:147], v[176:179], v[24:27]
    ds_read_b64_tr_b16 v[126:127], v187 offset:41472
    v_mfma_f32_16x16x32_bf16 v[28:31], v[144:147], v[180:183], v[28:31]
    ds_read_b64_tr_b16 v[128:129], v186 offset:49152
    v_mfma_f32_16x16x32_bf16 v[32:35], v[160:163], v[148:151], v[32:35]
    ds_read_b64_tr_b16 v[130:131], v186 offset:49664
    v_mfma_f32_16x16x32_bf16 v[36:39], v[164:167], v[148:151], v[36:39]
    ds_read_b64_tr_b16 v[132:133], v187 offset:49152
    v_mfma_f32_16x16x32_bf16 v[40:43], v[168:171], v[148:151], v[40:43]
    ds_read_b64_tr_b16 v[134:135], v187 offset:49664
    v_mfma_f32_16x16x32_bf16 v[44:47], v[172:175], v[148:151], v[44:47]
    ds_read_b64_tr_b16 v[136:137], v186 offset:57344
    v_mfma_f32_16x16x32_bf16 v[48:51], v[148:151], v[176:179], v[48:51]
    ds_read_b64_tr_b16 v[138:139], v186 offset:57856
    v_mfma_f32_16x16x32_bf16 v[52:55], v[148:151], v[180:183], v[52:55]
    ds_read_b64_tr_b16 v[140:141], v187 offset:57344
    v_mfma_f32_16x16x32_bf16 v[56:59], v[160:163], v[152:155], v[56:59]
    ds_read_b64_tr_b16 v[142:143], v187 offset:57856
    v_mfma_f32_16x16x32_bf16 v[60:63], v[164:167], v[152:155], v[60:63]
    ds_read_b128 v[108:111], v184 offset:43008
    v_mfma_f32_16x16x32_bf16 v[64:67], v[168:171], v[152:155], v[64:67]
    ds_read_b128 v[112:115], v184 offset:45056
    v_mfma_f32_16x16x32_bf16 v[68:71], v[172:175], v[152:155], v[68:71]
    ds_read_b128 v[116:119], v184 offset:47104
    v_mfma_f32_16x16x32_bf16 v[72:75], v[152:155], v[176:179], v[72:75]
    v_mfma_f32_16x16x32_bf16 v[76:79], v[152:155], v[180:183], v[76:79]
    v_mfma_f32_16x16x32_bf16 v[80:83], v[160:163], v[156:159], v[80:83]
    v_mfma_f32_16x16x32_bf16 v[84:87], v[164:167], v[156:159], v[84:87]
    v_mfma_f32_16x16x32_bf16 v[88:91], v[168:171], v[156:159], v[88:91]
    v_mfma_f32_16x16x32_bf16 v[92:95], v[172:175], v[156:159], v[92:95]
    v_mfma_f32_16x16x32_bf16 v[96:99], v[156:159], v[176:179], v[96:99]
    v_mfma_f32_16x16x32_bf16 v[100:103], v[156:159], v[180:183], v[100:103]
    s_waitcnt lgkmcnt(0)
    s_nop 0
    v_mfma_f32_16x16x32_bf16 v[8:11], v[120:123], v[104:107], v[8:11]
    ds_read_b128 v[144:147], v185 offset:40960
    v_mfma_f32_16x16x32_bf16 v[12:15], v[124:127], v[104:107], v[12:15]
    ds_read_b64_tr_b16 v[160:161], v186 offset:45056
    v_mfma_f32_16x16x32_bf16 v[16:19], v[128:131], v[104:107], v[16:19]
    ds_read_b64_tr_b16 v[162:163], v186 offset:45568
    v_mfma_f32_16x16x32_bf16 v[20:23], v[132:135], v[104:107], v[20:23]
    ds_read_b64_tr_b16 v[164:165], v187 offset:45056
    v_mfma_f32_16x16x32_bf16 v[24:27], v[104:107], v[136:139], v[24:27]
    ds_read_b64_tr_b16 v[166:167], v187 offset:45568
    v_mfma_f32_16x16x32_bf16 v[28:31], v[104:107], v[140:143], v[28:31]
    ds_read_b64_tr_b16 v[168:169], v186 offset:53248
    v_mfma_f32_16x16x32_bf16 v[32:35], v[120:123], v[108:111], v[32:35]
    ds_read_b64_tr_b16 v[170:171], v186 offset:53760
    v_mfma_f32_16x16x32_bf16 v[36:39], v[124:127], v[108:111], v[36:39]
    ds_read_b64_tr_b16 v[172:173], v187 offset:53248
    v_mfma_f32_16x16x32_bf16 v[40:43], v[128:131], v[108:111], v[40:43]
    ds_read_b64_tr_b16 v[174:175], v187 offset:53760
    v_mfma_f32_16x16x32_bf16 v[44:47], v[132:135], v[108:111], v[44:47]
    ds_read_b64_tr_b16 v[176:177], v186 offset:61440
    v_mfma_f32_16x16x32_bf16 v[48:51], v[108:111], v[136:139], v[48:51]
    ds_read_b64_tr_b16 v[178:179], v186 offset:61952
    v_mfma_f32_16x16x32_bf16 v[52:55], v[108:111], v[140:143], v[52:55]
    ds_read_b64_tr_b16 v[180:181], v187 offset:61440
    v_mfma_f32_16x16x32_bf16 v[56:59], v[120:123], v[112:115], v[56:59]
    ds_read_b64_tr_b16 v[182:183], v187 offset:61952
    v_mfma_f32_16x16x32_bf16 v[60:63], v[124:127], v[112:115], v[60:63]
    ds_read_b128 v[148:151], v185 offset:43008
    v_mfma_f32_16x16x32_bf16 v[64:67], v[128:131], v[112:115], v[64:67]
    ds_read_b128 v[152:155], v185 offset:45056
    v_mfma_f32_16x16x32_bf16 v[68:71], v[132:135], v[112:115], v[68:71]
    ds_read_b128 v[156:159], v185 offset:47104
    v_mfma_f32_16x16x32_bf16 v[72:75], v[112:115], v[136:139], v[72:75]
    v_mfma_f32_16x16x32_bf16 v[76:79], v[112:115], v[140:143], v[76:79]
    v_mfma_f32_16x16x32_bf16 v[80:83], v[120:123], v[116:119], v[80:83]
    v_mfma_f32_16x16x32_bf16 v[84:87], v[124:127], v[116:119], v[84:87]
    v_mfma_f32_16x16x32_bf16 v[88:91], v[128:131], v[116:119], v[88:91]
    v_mfma_f32_16x16x32_bf16 v[92:95], v[132:135], v[116:119], v[92:95]
    v_mfma_f32_16x16x32_bf16 v[96:99], v[116:119], v[136:139], v[96:99]
    v_mfma_f32_16x16x32_bf16 v[100:103], v[116:119], v[140:143], v[100:103]
    s_waitcnt lgkmcnt(0)
    s_barrier
    v_mfma_f32_16x16x32_bf16 v[8:11], v[160:163], v[144:147], v[8:11]
    ds_read_b128 v[104:107], v188 offset:0
    v_mfma_f32_16x16x32_bf16 v[12:15], v[164:167], v[144:147], v[12:15]
    ds_read_b64_tr_b16 v[120:121], v190 offset:0
    v_mfma_f32_16x16x32_bf16 v[16:19], v[168:171], v[144:147], v[16:19]
    ds_read_b64_tr_b16 v[122:123], v190 offset:512
    v_mfma_f32_16x16x32_bf16 v[20:23], v[172:175], v[144:147], v[20:23]
    ds_read_b64_tr_b16 v[124:125], v191 offset:0
    v_mfma_f32_16x16x32_bf16 v[24:27], v[144:147], v[176:179], v[24:27]
    ds_read_b64_tr_b16 v[126:127], v191 offset:512
    v_mfma_f32_16x16x32_bf16 v[28:31], v[144:147], v[180:183], v[28:31]
    ds_read_b64_tr_b16 v[128:129], v190 offset:8192
    v_mfma_f32_16x16x32_bf16 v[32:35], v[160:163], v[148:151], v[32:35]
    ds_read_b64_tr_b16 v[130:131], v190 offset:8704
    v_mfma_f32_16x16x32_bf16 v[36:39], v[164:167], v[148:151], v[36:39]
    ds_read_b64_tr_b16 v[132:133], v191 offset:8192
    v_mfma_f32_16x16x32_bf16 v[40:43], v[168:171], v[148:151], v[40:43]
    ds_read_b64_tr_b16 v[134:135], v191 offset:8704
    v_mfma_f32_16x16x32_bf16 v[44:47], v[172:175], v[148:151], v[44:47]
    ds_read_b64_tr_b16 v[136:137], v190 offset:16384
    v_mfma_f32_16x16x32_bf16 v[48:51], v[148:151], v[176:179], v[48:51]
    ds_read_b64_tr_b16 v[138:139], v190 offset:16896
    v_mfma_f32_16x16x32_bf16 v[52:55], v[148:151], v[180:183], v[52:55]
    ds_read_b64_tr_b16 v[140:141], v191 offset:16384
    v_mfma_f32_16x16x32_bf16 v[56:59], v[160:163], v[152:155], v[56:59]
    ds_read_b64_tr_b16 v[142:143], v191 offset:16896
    v_mfma_f32_16x16x32_bf16 v[60:63], v[164:167], v[152:155], v[60:63]
    ds_read_b128 v[108:111], v188 offset:2048
    v_mfma_f32_16x16x32_bf16 v[64:67], v[168:171], v[152:155], v[64:67]
    ds_read_b128 v[112:115], v188 offset:4096
    v_mfma_f32_16x16x32_bf16 v[68:71], v[172:175], v[152:155], v[68:71]
    ds_read_b128 v[116:119], v188 offset:6144
    v_mfma_f32_16x16x32_bf16 v[72:75], v[152:155], v[176:179], v[72:75]
    v_mfma_f32_16x16x32_bf16 v[76:79], v[152:155], v[180:183], v[76:79]
    v_mfma_f32_16x16x32_bf16 v[80:83], v[160:163], v[156:159], v[80:83]
    v_mfma_f32_16x16x32_bf16 v[84:87], v[164:167], v[156:159], v[84:87]
    v_mfma_f32_16x16x32_bf16 v[88:91], v[168:171], v[156:159], v[88:91]
    v_mfma_f32_16x16x32_bf16 v[92:95], v[172:175], v[156:159], v[92:95]
    v_mfma_f32_16x16x32_bf16 v[96:99], v[156:159], v[176:179], v[96:99]
    v_mfma_f32_16x16x32_bf16 v[100:103], v[156:159], v[180:183], v[100:103]
    s_waitcnt lgkmcnt(0)
    s_nop 0
    v_mfma_f32_16x16x32_bf16 v[8:11], v[120:123], v[104:107], v[8:11]
    ds_read_b128 v[144:147], v189 offset:0
    v_mfma_f32_16x16x32_bf16 v[12:15], v[124:127], v[104:107], v[12:15]
    ds_read_b64_tr_b16 v[160:161], v190 offset:4096
    v_mfma_f32_16x16x32_bf16 v[16:19], v[128:131], v[104:107], v[16:19]
    ds_read_b64_tr_b16 v[162:163], v190 offset:4608
    v_mfma_f32_16x16x32_bf16 v[20:23], v[132:135], v[104:107], v[20:23]
    ds_read_b64_tr_b16 v[164:165], v191 offset:4096
    v_mfma_f32_16x16x32_bf16 v[24:27], v[104:107], v[136:139], v[24:27]
    ds_read_b64_tr_b16 v[166:167], v191 offset:4608
    v_mfma_f32_16x16x32_bf16 v[28:31], v[104:107], v[140:143], v[28:31]
    ds_read_b64_tr_b16 v[168:169], v190 offset:12288
    v_mfma_f32_16x16x32_bf16 v[32:35], v[120:123], v[108:111], v[32:35]
    ds_read_b64_tr_b16 v[170:171], v190 offset:12800
    v_mfma_f32_16x16x32_bf16 v[36:39], v[124:127], v[108:111], v[36:39]
    ds_read_b64_tr_b16 v[172:173], v191 offset:12288
    v_mfma_f32_16x16x32_bf16 v[40:43], v[128:131], v[108:111], v[40:43]
    ds_read_b64_tr_b16 v[174:175], v191 offset:12800
    v_mfma_f32_16x16x32_bf16 v[44:47], v[132:135], v[108:111], v[44:47]
    ds_read_b64_tr_b16 v[176:177], v190 offset:20480
    v_mfma_f32_16x16x32_bf16 v[48:51], v[108:111], v[136:139], v[48:51]
    ds_read_b64_tr_b16 v[178:179], v190 offset:20992
    v_mfma_f32_16x16x32_bf16 v[52:55], v[108:111], v[140:143], v[52:55]
    ds_read_b64_tr_b16 v[180:181], v191 offset:20480
    v_mfma_f32_16x16x32_bf16 v[56:59], v[120:123], v[112:115], v[56:59]
    ds_read_b64_tr_b16 v[182:183], v191 offset:20992
    v_mfma_f32_16x16x32_bf16 v[60:63], v[124:127], v[112:115], v[60:63]
    ds_read_b128 v[148:151], v189 offset:2048
    v_mfma_f32_16x16x32_bf16 v[64:67], v[128:131], v[112:115], v[64:67]
    ds_read_b128 v[152:155], v189 offset:4096
    v_mfma_f32_16x16x32_bf16 v[68:71], v[132:135], v[112:115], v[68:71]
    ds_read_b128 v[156:159], v189 offset:6144
    v_mfma_f32_16x16x32_bf16 v[72:75], v[112:115], v[136:139], v[72:75]
    s_add_u32 s66, s66, 1
    s_cmp_lt_u32 s66, 5
    v_mfma_f32_16x16x32_bf16 v[76:79], v[112:115], v[140:143], v[76:79]
    v_mfma_f32_16x16x32_bf16 v[80:83], v[120:123], v[116:119], v[80:83]
    v_mfma_f32_16x16x32_bf16 v[84:87], v[124:127], v[116:119], v[84:87]
    v_mfma_f32_16x16x32_bf16 v[88:91], v[128:131], v[116:119], v[88:91]
    v_mfma_f32_16x16x32_bf16 v[92:95], v[132:135], v[116:119], v[92:95]
    v_mfma_f32_16x16x32_bf16 v[96:99], v[116:119], v[136:139], v[96:99]
    v_mfma_f32_16x16x32_bf16 v[100:103], v[116:119], v[140:143], v[100:103]
    s_cbranch_scc1 L_cloop
    s_nop 0
    s_waitcnt lgkmcnt(0)
    s_barrier
    v_mfma_f32_16x16x32_bf16 v[8:11], v[160:163], v[144:147], v[8:11]
    ds_read_b128 v[104:107], v184 offset:0
    s_lshl_b32 s3, s38, 1
    s_lshr_b32 s28, s39, 2
    v_mfma_f32_16x16x32_bf16 v[12:15], v[164:167], v[144:147], v[12:15]
    ds_read_b64_tr_b16 v[120:121], v186 offset:0
    s_add_u32 s3, s3, s28
    s_lshl_b32 s69, s3, 4
    v_mfma_f32_16x16x32_bf16 v[16:19], v[168:171], v[144:147], v[16:19]
    ds_read_b64_tr_b16 v[122:123], v186 offset:512
    v_and_b32 v241, 15, v1
    v_add_u32 v240, s69, v241
    v_mfma_f32_16x16x32_bf16 v[20:23], v[172:175], v[144:147], v[20:23]
    ds_read_b64_tr_b16 v[124:125], v187 offset:0
    v_lshlrev_b32 v240, 7, v240
    v_lshrrev_b32 v241, 1, v241
    v_mfma_f32_16x16x32_bf16 v[24:27], v[144:147], v[176:179], v[24:27]
    ds_read_b64_tr_b16 v[126:127], v187 offset:512
    v_lshrrev_b32 v242, 5, v1
    v_xor_b32 v241, v241, v242
    v_mfma_f32_16x16x32_bf16 v[28:31], v[144:147], v[180:183], v[28:31]
    ds_read_b64_tr_b16 v[128:129], v186 offset:8192
    v_lshl_add_u32 v240, v241, 4, v240
    v_bfe_u32 v242, v1, 4, 1
    v_mfma_f32_16x16x32_bf16 v[32:35], v[160:163], v[148:151], v[32:35]
    ds_read_b64_tr_b16 v[130:131], v186 offset:8704
    v_lshl_add_u32 v240, v242, 3, v240
    v_xor_b32_e64 v241, 32, v240
    v_mfma_f32_16x16x32_bf16 v[36:39], v[164:167], v[148:151], v[36:39]
    ds_read_b64_tr_b16 v[132:133], v187 offset:8192
    v_xor_b32_e64 v242, 64, v240
    v_xor_b32 v243, 96, v240
    v_mfma_f32_16x16x32_bf16 v[40:43], v[168:171], v[148:151], v[40:43]
    ds_read_b64_tr_b16 v[134:135], v187 offset:8704
    v_and_b32 v2, 15, v1
    v_lshrrev_b32 v3, 4, v1
    v_mfma_f32_16x16x32_bf16 v[44:47], v[172:175], v[148:151], v[44:47]
    ds_read_b64_tr_b16 v[136:137], v186 offset:16384
    s_lshl_b32 s3, s64, 8
    s_nop 0
    s_add_u32 s3, s3, 152064
    v_mfma_f32_16x16x32_bf16 v[48:51], v[148:151], v[176:179], v[48:51]
    ds_read_b64_tr_b16 v[138:139], v186 offset:16896
    v_lshl_add_u32 v188, v2, 2, s3
    v_lshl_add_u32 v189, v3, 4, s3
    v_mfma_f32_16x16x32_bf16 v[52:55], v[148:151], v[180:183], v[52:55]
    ds_read_b64_tr_b16 v[140:141], v187 offset:16384
    v_lshrrev_b32_e64 v7, 5, v1
    v_lshl_add_u32 v190, v7, 6, v188
    v_mfma_f32_16x16x32_bf16 v[56:59], v[160:163], v[152:155], v[56:59]
    ds_read_b64_tr_b16 v[142:143], v187 offset:16896
    s_lshl_b32 s3, s65, 7
    s_nop 0
    s_add_u32 s3, s3, 154880
    v_mfma_f32_16x16x32_bf16 v[60:63], v[164:167], v[152:155], v[60:63]
    ds_read_b128 v[108:111], v184 offset:2048
    v_lshl_add_u32 v191, v3, 4, s3
    v_lshl_add_u32 v248, v2, 2, s3
    v_mfma_f32_16x16x32_bf16 v[64:67], v[168:171], v[152:155], v[64:67]
    ds_read_b128 v[112:115], v184 offset:4096
    s_lshl_b32 s3, s64, 7
    s_nop 0
    s_add_u32 s3, s3, 154624
    v_mfma_f32_16x16x32_bf16 v[68:71], v[172:175], v[152:155], v[68:71]
    ds_read_b128 v[116:119], v184 offset:6144
    v_lshl_add_u32 v249, v3, 4, s3
    v_xor_b32 v253, 128, v249
    v_mfma_f32_16x16x32_bf16 v[72:75], v[152:155], v[176:179], v[72:75]
    v_lshrrev_b32 v250, 2, v1
    v_lshlrev_b32 v250, 6, v250
    v_mfma_f32_16x16x32_bf16 v[76:79], v[152:155], v[180:183], v[76:79]
    v_and_b32_e64 v251, 3, v1
    v_lshl_add_u32 v250, v251, 3, v250
    v_mfma_f32_16x16x32_bf16 v[80:83], v[160:163], v[156:159], v[80:83]
    s_lshl_b32 s3, s65, 11
    s_add_u32 s3, s3, 147712
    v_mfma_f32_16x16x32_bf16 v[84:87], v[164:167], v[156:159], v[84:87]
    v_add_u32 v252, s3, v250
    v_bfe_u32 v5, v1, 1, 2
    v_mfma_f32_16x16x32_bf16 v[88:91], v[168:171], v[156:159], v[88:91]
    v_lshlrev_b32_e64 v5, 2, v5
    v_bfe_u32 v4, v1, 3, 1
    v_mfma_f32_16x16x32_bf16 v[92:95], v[172:175], v[156:159], v[92:95]
    v_lshl_add_u32 v5, v4, 1, v5
    v_and_b32 v4, 1, v1
    v_mfma_f32_16x16x32_bf16 v[96:99], v[156:159], v[176:179], v[96:99]
    v_add_u32 v5, v5, v4
    v_xor_b32 v5, v5, v3
    v_mfma_f32_16x16x32_bf16 v[100:103], v[156:159], v[180:183], v[100:103]
    s_lshl_b32 s3, s38, 13
    s_add_u32 s3, s3, 98304
    s_waitcnt lgkmcnt(0)
    s_nop 0
    v_mfma_f32_16x16x32_bf16 v[8:11], v[120:123], v[104:107], v[8:11]
    ds_read_b128 v[144:147], v185 offset:0
    v_lshl_add_u32 v2, v2, 7, s3
    v_lshl_add_u32 v4, v5, 3, v2
    v_mfma_f32_16x16x32_bf16 v[12:15], v[124:127], v[104:107], v[12:15]
    ds_read_b64_tr_b16 v[160:161], v186 offset:4096
    v_xor_b32 v5, 32, v4
    v_xor_b32 v6, 64, v4
    v_mfma_f32_16x16x32_bf16 v[16:19], v[128:131], v[104:107], v[16:19]
    ds_read_b64_tr_b16 v[162:163], v186 offset:4608
    v_xor_b32 v7, 96, v4
    v_bfe_u32 v2, v1, 3, 2
    v_mfma_f32_16x16x32_bf16 v[20:23], v[132:135], v[104:107], v[20:23]
    ds_read_b64_tr_b16 v[164:165], v187 offset:4096
    v_lshlrev_b32 v2, 2, v2
    v_lshrrev_b32 v3, 5, v1
    v_mfma_f32_16x16x32_bf16 v[24:27], v[104:107], v[136:139], v[24:27]
    ds_read_b64_tr_b16 v[166:167], v187 offset:4608
    v_lshl_add_u32 v2, v3, 1, v2
    v_bfe_u32 v3, v1, 2, 1
    v_mfma_f32_16x16x32_bf16 v[28:31], v[104:107], v[140:143], v[28:31]
    ds_read_b64_tr_b16 v[168:169], v186 offset:12288
    v_add_u32 v2, v2, v3
    v_xor_b32 v2, v2, v251
    v_mfma_f32_16x16x32_bf16 v[32:35], v[120:123], v[108:111], v[32:35]
    ds_read_b64_tr_b16 v[170:171], v186 offset:12800
    v_lshrrev_b32_e64 v3, 2, v1
    v_lshl_add_u32 v3, v3, 7, s3
    v_mfma_f32_16x16x32_bf16 v[36:39], v[124:127], v[108:111], v[36:39]
    ds_read_b64_tr_b16 v[172:173], v187 offset:12288
    v_lshl_add_u32 v2, v2, 3, v3
    s_lshl_b32 s28, s64, 6
    v_mfma_f32_16x16x32_bf16 v[40:43], v[128:131], v[108:111], v[40:43]
    ds_read_b64_tr_b16 v[174:175], v187 offset:12800
    v_xor_b32 v201, s28, v2
    v_xor_b32_e64 v203, 32, v201
    v_mfma_f32_16x16x32_bf16 v[44:47], v[132:135], v[108:111], v[44:47]
    ds_read_b64_tr_b16 v[176:177], v186 offset:20480
    s_lshl_b32 s3, s38, 12
    s_add_u32 s3, s3, 131072
    v_mfma_f32_16x16x32_bf16 v[48:51], v[108:111], v[136:139], v[48:51]
    ds_read_b64_tr_b16 v[178:179], v186 offset:20992
    v_lshlrev_b32 v199, 4, v1
    v_add_u32_e64 v197, s3, v199
    v_mfma_f32_16x16x32_bf16 v[52:55], v[108:111], v[140:143], v[52:55]
    ds_read_b64_tr_b16 v[180:181], v187 offset:20480
    s_lshl_b32 s3, s37, 1
    s_add_u32 s67, s3, s65
    v_mfma_f32_16x16x32_bf16 v[56:59], v[120:123], v[112:115], v[56:59]
    ds_read_b64_tr_b16 v[182:183], v187 offset:20992
    s_lshl_b32 s3, s67, 4
    s_add_u32 s3, s3, s36
    v_mfma_f32_16x16x32_bf16 v[60:63], v[124:127], v[112:115], v[60:63]
    ds_read_b128 v[148:151], v185 offset:2048
    s_mul_i32 s3, s3, 4224
    s_add_u32 s75, s3, 8388608
    v_mfma_f32_16x16x32_bf16 v[64:67], v[128:131], v[112:115], v[64:67]
    ds_read_b128 v[152:155], v185 offset:4096
    s_lshl_b32 s3, s64, 11
    s_add_u32 s74, s75, s3
    v_mfma_f32_16x16x32_bf16 v[68:71], v[132:135], v[112:115], v[68:71]
    ds_read_b128 v[156:159], v185 offset:6144
    s_lshl_b32 s3, s64, 6
    s_add_u32 s75, s75, s3
    v_mfma_f32_16x16x32_bf16 v[72:75], v[112:115], v[136:139], v[72:75]
    ds_read_b64 v[232:233], v240
    s_add_u32 s75, s75, 4096
    s_lshl_b32 s3, s37, 4
    v_mfma_f32_16x16x32_bf16 v[76:79], v[112:115], v[140:143], v[76:79]
    ds_read_b64 v[234:235], v241
    s_add_u32 s3, s3, s36
    s_lshl_b32 s3, s3, 7
    v_mfma_f32_16x16x32_bf16 v[80:83], v[120:123], v[116:119], v[80:83]
    ds_read_b64 v[236:237], v242
    s_add_u32 s3, s3, 32768
    v_mov_b32 v251, s86
    v_mfma_f32_16x16x32_bf16 v[84:87], v[124:127], v[116:119], v[84:87]
    ds_read_b64 v[238:239], v243
    s_cmp_lg_u32 s38, 0
    s_cselect_b32 s76, 268435456, s3
    v_mfma_f32_16x16x32_bf16 v[88:91], v[128:131], v[116:119], v[88:91]
    s_nop 0
    v_mfma_f32_16x16x32_bf16 v[92:95], v[132:135], v[116:119], v[92:95]
    s_nop 0
    v_mfma_f32_16x16x32_bf16 v[96:99], v[116:119], v[136:139], v[96:99]
    s_nop 0
    v_mfma_f32_16x16x32_bf16 v[100:103], v[116:119], v[140:143], v[100:103]
    s_nop 0
    s_waitcnt lgkmcnt(0)
    v_mfma_f32_16x16x32_bf16 v[16:19], v[168:171], v[144:147], v[16:19]
    s_barrier
    s_nop 0
    v_mfma_f32_16x16x32_bf16 v[20:23], v[172:175], v[144:147], v[20:23]
    ds_read_b32 v192, v188 offset:0
    ds_read_b32 v194, v188 offset:64
    v_mfma_f32_16x16x32_bf16 v[40:43], v[168:171], v[148:151], v[40:43]
    ds_read_b32 v196, v188 offset:128
    ds_read_b32 v198, v188 offset:192
    v_mfma_f32_16x16x32_bf16 v[44:47], v[172:175], v[148:151], v[44:47]
    ds_read_b128 v[204:207], v191 offset:256
    v_mfma_f32_16x16x32_bf16 v[64:67], v[168:171], v[152:155], v[64:67]
    ds_read_b128 v[208:211], v191 offset:320
    v_mfma_f32_16x16x32_bf16 v[68:71], v[172:175], v[152:155], v[68:71]
    ds_read_b64_tr_b16 v[224:225], v252 offset:0
    v_mfma_f32_16x16x32_bf16 v[88:91], v[168:171], v[156:159], v[88:91]
    ds_read_b64_tr_b16 v[226:227], v252 offset:1024
    v_mfma_f32_16x16x32_bf16 v[92:95], v[172:175], v[156:159], v[92:95]
    ds_read_b64_tr_b16 v[228:229], v252 offset:32
    v_mfma_f32_16x16x32_bf16 v[24:27], v[144:147], v[176:179], v[24:27]
    ds_read_b64_tr_b16 v[230:231], v252 offset:1056
    v_mfma_f32_16x16x32_bf16 v[28:31], v[144:147], v[180:183], v[28:31]
    ds_read_b128 v[104:107], v189 offset:0
    v_mfma_f32_16x16x32_bf16 v[48:51], v[148:151], v[176:179], v[48:51]
    ds_read_b128 v[108:111], v189 offset:64
    v_mfma_f32_16x16x32_bf16 v[52:55], v[148:151], v[180:183], v[52:55]
    ds_read_b128 v[112:115], v189 offset:128
    v_mfma_f32_16x16x32_bf16 v[72:75], v[152:155], v[176:179], v[72:75]
    ds_read_b128 v[116:119], v189 offset:192
    v_mfma_f32_16x16x32_bf16 v[76:79], v[152:155], v[180:183], v[76:79]
    ds_read_b32 v250, v248 offset:576
    ds_read_b32 v248, v248 offset:512
    v_mfma_f32_16x16x32_bf16 v[96:99], v[156:159], v[176:179], v[96:99]
    ds_read_b32 v200, v188 offset:2048
    v_mfma_f32_16x16x32_bf16 v[100:103], v[156:159], v[180:183], v[100:103]
    ds_read_b32 v202, v188 offset:2112
    v_mfma_f32_16x16x32_bf16 v[8:11], v[160:163], v[144:147], v[8:11]
    ds_read_b32 v220, v188 offset:2176
    v_mfma_f32_16x16x32_bf16 v[12:15], v[164:167], v[144:147], v[12:15]
    ds_read_b32 v222, v188 offset:2240
    v_mfma_f32_16x16x32_bf16 v[32:35], v[160:163], v[148:151], v[32:35]
    ds_read_b32 v193, v190 offset:2048
    ds_read_b32 v195, v190 offset:1024
    v_mfma_f32_16x16x32_bf16 v[36:39], v[164:167], v[148:151], v[36:39]
    ds_read_b32 v221, v190 offset:2176
    ds_read_b32 v223, v190 offset:1152
    v_mfma_f32_16x16x32_bf16 v[56:59], v[160:163], v[152:155], v[56:59]
    ds_read_b128 v[120:123], v249 offset:0
    v_mfma_f32_16x16x32_bf16 v[60:63], v[164:167], v[152:155], v[60:63]
    ds_read_b128 v[124:127], v249 offset:64
    v_mfma_f32_16x16x32_bf16 v[80:83], v[160:163], v[156:159], v[80:83]
    ds_read_b128 v[212:215], v191 offset:0
    v_mfma_f32_16x16x32_bf16 v[84:87], v[164:167], v[156:159], v[84:87]
    ds_read_b128 v[216:219], v191 offset:64
    s_waitcnt lgkmcnt(4)
    v_mov_b32 v177, v232
    v_mov_b32 v179, v233
    v_mov_b32 v181, v234
    v_mov_b32 v183, v235
    v_mov_b32 v185, v236
    v_mov_b32 v187, v237
    v_mov_b32 v189, v238
    v_mov_b32_e64 v191, v239
    v_pk_fma_f32 v[16:17], v[192:193], v[204:205], v[16:17] op_sel_hi:[0,1,1] neg_lo:[1,0,0] neg_hi:[1,0,0]
    v_pk_fma_f32 v[18:19], v[192:193], v[206:207], v[18:19] op_sel_hi:[0,1,1] neg_lo:[1,0,0] neg_hi:[1,0,0]
    v_pk_fma_f32 v[20:21], v[192:193], v[208:209], v[20:21] op_sel_hi:[0,1,1] neg_lo:[1,0,0] neg_hi:[1,0,0]
    v_pk_fma_f32 v[22:23], v[192:193], v[210:211], v[22:23] op_sel_hi:[0,1,1] neg_lo:[1,0,0] neg_hi:[1,0,0]
    v_cvt_pk_bf16_f32 v232, v16, v17
    v_cvt_pk_bf16_f32 v233, v18, v19
    v_cvt_pk_bf16_f32 v234, v20, v21
    v_cvt_pk_bf16_f32 v235, v22, v23
    v_pk_fma_f32 v[40:41], v[194:195], v[204:205], v[40:41] op_sel_hi:[0,1,1] neg_lo:[1,0,0] neg_hi:[1,0,0]
    v_pk_fma_f32 v[42:43], v[194:195], v[206:207], v[42:43] op_sel_hi:[0,1,1] neg_lo:[1,0,0] neg_hi:[1,0,0]
    v_pk_fma_f32 v[44:45], v[194:195], v[208:209], v[44:45] op_sel_hi:[0,1,1] neg_lo:[1,0,0] neg_hi:[1,0,0]
    v_pk_fma_f32 v[46:47], v[194:195], v[210:211], v[46:47] op_sel_hi:[0,1,1] neg_lo:[1,0,0] neg_hi:[1,0,0]
    v_cvt_pk_bf16_f32 v236, v40, v41
    v_cvt_pk_bf16_f32 v237, v42, v43
    v_cvt_pk_bf16_f32 v238, v44, v45
    v_cvt_pk_bf16_f32 v239, v46, v47
    v_pk_fma_f32 v[64:65], v[196:197], v[204:205], v[64:65] op_sel_hi:[0,1,1] neg_lo:[1,0,0] neg_hi:[1,0,0]
    v_pk_fma_f32 v[66:67], v[196:197], v[206:207], v[66:67] op_sel_hi:[0,1,1] neg_lo:[1,0,0] neg_hi:[1,0,0]
    v_pk_fma_f32 v[68:69], v[196:197], v[208:209], v[68:69] op_sel_hi:[0,1,1] neg_lo:[1,0,0] neg_hi:[1,0,0]
    v_pk_fma_f32 v[70:71], v[196:197], v[210:211], v[70:71] op_sel_hi:[0,1,1] neg_lo:[1,0,0] neg_hi:[1,0,0]
    v_cvt_pk_bf16_f32 v240, v64, v65
    v_cvt_pk_bf16_f32 v241, v66, v67
    v_cvt_pk_bf16_f32 v242, v68, v69
    v_cvt_pk_bf16_f32 v243, v70, v71
    v_pk_fma_f32 v[88:89], v[198:199], v[204:205], v[88:89] op_sel_hi:[0,1,1] neg_lo:[1,0,0] neg_hi:[1,0,0]
    v_pk_fma_f32 v[90:91], v[198:199], v[206:207], v[90:91] op_sel_hi:[0,1,1] neg_lo:[1,0,0] neg_hi:[1,0,0]
    v_pk_fma_f32 v[92:93], v[198:199], v[208:209], v[92:93] op_sel_hi:[0,1,1] neg_lo:[1,0,0] neg_hi:[1,0,0]
    v_pk_fma_f32 v[94:95], v[198:199], v[210:211], v[94:95] op_sel_hi:[0,1,1] neg_lo:[1,0,0] neg_hi:[1,0,0]
    v_cvt_pk_bf16_f32 v244, v88, v89
    v_cvt_pk_bf16_f32 v245, v90, v91
    v_cvt_pk_bf16_f32 v246, v92, v93
    v_cvt_pk_bf16_f32 v247, v94, v95
    v_mfma_f32_16x16x32_bf16 v[144:147], v[224:227], v[232:235], 0
    v_mfma_f32_16x16x32_bf16 v[148:151], v[228:231], v[232:235], 0
    v_mfma_f32_16x16x32_bf16 v[152:155], v[224:227], v[236:239], 0
    v_mfma_f32_16x16x32_bf16 v[156:159], v[228:231], v[236:239], 0
    v_mfma_f32_16x16x32_bf16 v[160:163], v[224:227], v[240:243], 0
    v_mfma_f32_16x16x32_bf16 v[164:167], v[228:231], v[240:243], 0
    v_mfma_f32_16x16x32_bf16 v[168:171], v[224:227], v[244:247], 0
    v_mfma_f32_16x16x32_bf16 v[172:175], v[228:231], v[244:247], 0
    v_pk_fma_f32 v[24:25], v[104:105], v[248:249], v[24:25] op_sel_hi:[1,0,1] neg_lo:[1,0,0] neg_hi:[1,0,0]
    v_pk_fma_f32 v[26:27], v[106:107], v[248:249], v[26:27] op_sel_hi:[1,0,1] neg_lo:[1,0,0] neg_hi:[1,0,0]
    v_pk_fma_f32 v[28:29], v[104:105], v[250:251], v[28:29] op_sel_hi:[1,0,1] neg_lo:[1,0,0] neg_hi:[1,0,0]
    v_pk_fma_f32 v[30:31], v[106:107], v[250:251], v[30:31] op_sel_hi:[1,0,1] neg_lo:[1,0,0] neg_hi:[1,0,0]
    v_pk_fma_f32 v[48:49], v[108:109], v[248:249], v[48:49] op_sel_hi:[1,0,1] neg_lo:[1,0,0] neg_hi:[1,0,0]
    v_pk_fma_f32 v[50:51], v[110:111], v[248:249], v[50:51] op_sel_hi:[1,0,1] neg_lo:[1,0,0] neg_hi:[1,0,0]
    v_pk_fma_f32 v[52:53], v[108:109], v[250:251], v[52:53] op_sel_hi:[1,0,1] neg_lo:[1,0,0] neg_hi:[1,0,0]
    v_pk_fma_f32 v[54:55], v[110:111], v[250:251], v[54:55] op_sel_hi:[1,0,1] neg_lo:[1,0,0] neg_hi:[1,0,0]
    v_pk_fma_f32 v[72:73], v[112:113], v[248:249], v[72:73] op_sel_hi:[1,0,1] neg_lo:[1,0,0] neg_hi:[1,0,0]
    v_pk_fma_f32 v[74:75], v[114:115], v[248:249], v[74:75] op_sel_hi:[1,0,1] neg_lo:[1,0,0] neg_hi:[1,0,0]
    v_pk_fma_f32 v[76:77], v[112:113], v[250:251], v[76:77] op_sel_hi:[1,0,1] neg_lo:[1,0,0] neg_hi:[1,0,0]
    v_pk_fma_f32 v[78:79], v[114:115], v[250:251], v[78:79] op_sel_hi:[1,0,1] neg_lo:[1,0,0] neg_hi:[1,0,0]
    v_pk_fma_f32 v[96:97], v[116:117], v[248:249], v[96:97] op_sel_hi:[1,0,1] neg_lo:[1,0,0] neg_hi:[1,0,0]
    v_pk_fma_f32 v[98:99], v[118:119], v[248:249], v[98:99] op_sel_hi:[1,0,1] neg_lo:[1,0,0] neg_hi:[1,0,0]
    v_pk_fma_f32 v[100:101], v[116:117], v[250:251], v[100:101] op_sel_hi:[1,0,1] neg_lo:[1,0,0] neg_hi:[1,0,0]
    v_pk_fma_f32 v[102:103], v[118:119], v[250:251], v[102:103] op_sel_hi:[1,0,1] neg_lo:[1,0,0] neg_hi:[1,0,0]
    v_cvt_pk_bf16_f32 v24, v24, v25
    v_cvt_pk_bf16_f32 v25, v26, v27
    v_cvt_pk_bf16_f32 v26, v48, v49
    v_cvt_pk_bf16_f32 v27, v50, v51
    v_cvt_pk_bf16_f32 v28, v28, v29
    v_cvt_pk_bf16_f32 v29, v30, v31
    v_cvt_pk_bf16_f32 v30, v52, v53
    v_cvt_pk_bf16_f32 v31, v54, v55
    v_cvt_pk_bf16_f32 v72, v72, v73
    v_cvt_pk_bf16_f32 v73, v74, v75
    v_cvt_pk_bf16_f32 v74, v96, v97
    v_cvt_pk_bf16_f32 v75, v98, v99
    v_cvt_pk_bf16_f32 v76, v76, v77
    v_cvt_pk_bf16_f32 v77, v78, v79
    v_cvt_pk_bf16_f32 v78, v100, v101
    v_cvt_pk_bf16_f32 v79, v102, v103
    ds_read_b128 v[104:107], v253 offset:0
    ds_read_b128 v[108:111], v253 offset:64
    v_max3_f32 v176, v144, v145, v146
    v_max3_f32 v184, -v144, -v145, -v146
    v_max3_f32 v178, v152, v153, v154
    v_max3_f32 v186, -v152, -v153, -v154
    v_max3_f32 v176, v176, v147, v148
    v_max3_f32 v184, v184, -v147, -v148
    v_max3_f32 v178, v178, v155, v156
    v_max3_f32 v186, v186, -v155, -v156
    v_max3_f32 v176, v176, v149, v150
    v_max3_f32 v184, v184, -v149, -v150
    v_max3_f32 v178, v178, v157, v158
    v_max3_f32 v186, v186, -v157, -v158
    v_max_f32_e64 v176, v176, v151
    v_max_f32_e64 v184, v184, -v151
    v_max_f32_e64 v178, v178, v159
    v_max_f32_e64 v186, v186, -v159
    s_nop 0
    v_permlane32_swap_b32 v176, v178
    v_permlane32_swap_b32_e64 v184, v186
    v_max3_f32 v180, v160, v161, v162
    v_max3_f32 v188, -v160, -v161, -v162
    v_max_f32 v176, v176, v178
    v_max_f32 v184, v184, v186
    v_max3_f32 v182, v168, v169, v170
    v_max3_f32 v190, -v168, -v169, -v170
    v_permlane16_swap_b32 v176, v184
    v_max_f32 v176, v176, v184
    v_max3_f32 v180, v180, v163, v164
    v_max3_f32 v188, v188, -v163, -v164
    v_mul_f32 v184, v176, v193
    v_mul_f32 v176, v176, v193
    v_max3_f32 v182, v182, v171, v172
    v_max3_f32 v190, v190, -v171, -v172
    v_permlane16_swap_b32 v176, v184
    v_mov_b32 v178, v176
    v_max3_f32 v180, v180, v165, v166
    v_max3_f32 v188, v188, -v165, -v166
    v_mov_b32_e64 v186, v184
    v_max3_f32 v182, v182, v173, v174
    v_max3_f32 v190, v190, -v173, -v174
    v_permlane32_swap_b32 v176, v178
    v_permlane32_swap_b32 v184, v186
    v_max_f32_e64 v180, v180, v167
    v_max_f32_e64 v188, v188, -v167
    v_max_f32_e64 v182, v182, v175
    v_max_f32_e64 v190, v190, -v175
    s_nop 0
    v_permlane32_swap_b32 v180, v182
    v_permlane32_swap_b32_e64 v188, v190
    v_pk_fma_f32 v[16:17], v[144:145], v[200:201], v[184:185] op_sel_hi:[1,0,0] neg_lo:[1,0,1] neg_hi:[1,0,1]
    v_pk_fma_f32 v[144:145], v[144:145], v[200:201], v[176:177] op_sel_hi:[1,0,0] neg_lo:[0,0,1] neg_hi:[0,0,1]
    v_max_f32 v180, v180, v182
    v_max_f32 v188, v188, v190
    v_pk_fma_f32 v[18:19], v[146:147], v[200:201], v[184:185] op_sel_hi:[1,0,0] neg_lo:[1,0,1] neg_hi:[1,0,1]
    v_pk_fma_f32 v[146:147], v[146:147], v[200:201], v[176:177] op_sel_hi:[1,0,0] neg_lo:[0,0,1] neg_hi:[0,0,1]
    v_permlane16_swap_b32 v180, v188
    v_max_f32 v180, v180, v188
    v_pk_fma_f32 v[20:21], v[148:149], v[200:201], v[184:185] op_sel_hi:[1,0,0] neg_lo:[1,0,1] neg_hi:[1,0,1]
    v_pk_fma_f32 v[148:149], v[148:149], v[200:201], v[176:177] op_sel_hi:[1,0,0] neg_lo:[0,0,1] neg_hi:[0,0,1]
    v_mul_f32 v188, v180, v221
    v_mul_f32 v180, v180, v221
    v_pk_fma_f32 v[22:23], v[150:151], v[200:201], v[184:185] op_sel_hi:[1,0,0] neg_lo:[1,0,1] neg_hi:[1,0,1]
    v_pk_fma_f32 v[150:151], v[150:151], v[200:201], v[176:177] op_sel_hi:[1,0,0] neg_lo:[0,0,1] neg_hi:[0,0,1]
    v_permlane16_swap_b32 v180, v188
    v_mov_b32 v182, v180
    v_pk_fma_f32 v[40:41], v[152:153], v[202:203], v[186:187] op_sel_hi:[1,0,0] neg_lo:[1,0,1] neg_hi:[1,0,1]
    v_pk_fma_f32 v[152:153], v[152:153], v[202:203], v[178:179] op_sel_hi:[1,0,0] neg_lo:[0,0,1] neg_hi:[0,0,1]
    v_mov_b32_e64 v190, v188
    v_pk_fma_f32 v[42:43], v[154:155], v[202:203], v[186:187] op_sel_hi:[1,0,0] neg_lo:[1,0,1] neg_hi:[1,0,1]
    v_pk_fma_f32 v[154:155], v[154:155], v[202:203], v[178:179] op_sel_hi:[1,0,0] neg_lo:[0,0,1] neg_hi:[0,0,1]
    v_permlane32_swap_b32 v180, v182
    v_permlane32_swap_b32 v188, v190
    v_pk_fma_f32 v[44:45], v[156:157], v[202:203], v[186:187] op_sel_hi:[1,0,0] neg_lo:[1,0,1] neg_hi:[1,0,1]
    v_pk_fma_f32 v[156:157], v[156:157], v[202:203], v[178:179] op_sel_hi:[1,0,0] neg_lo:[0,0,1] neg_hi:[0,0,1]
    v_pk_fma_f32 v[46:47], v[158:159], v[202:203], v[186:187] op_sel_hi:[1,0,0] neg_lo:[1,0,1] neg_hi:[1,0,1]
    v_pk_fma_f32 v[158:159], v[158:159], v[202:203], v[178:179] op_sel_hi:[1,0,0] neg_lo:[0,0,1] neg_hi:[0,0,1]
    v_exp_f32 v16, v16
    v_exp_f32 v144, v144
    v_exp_f32 v17, v17
    v_exp_f32 v145, v145
    v_exp_f32 v18, v18
    v_exp_f32 v146, v146
    v_exp_f32 v19, v19
    v_exp_f32 v147, v147
    v_exp_f32 v20, v20
    v_exp_f32 v148, v148
    v_exp_f32 v21, v21
    v_exp_f32 v149, v149
    v_exp_f32 v22, v22
    v_exp_f32 v150, v150
    v_exp_f32 v23, v23
    v_exp_f32 v151, v151
    v_exp_f32 v40, v40
    v_exp_f32 v152, v152
    v_exp_f32 v41, v41
    v_exp_f32 v153, v153
    v_exp_f32 v42, v42
    v_exp_f32 v154, v154
    v_exp_f32 v43, v43
    v_exp_f32 v155, v155
    v_exp_f32 v44, v44
    v_exp_f32 v156, v156
    v_exp_f32 v45, v45
    v_exp_f32 v157, v157
    v_exp_f32 v46, v46
    v_exp_f32 v158, v158
    v_exp_f32 v47, v47
    v_exp_f32 v159, v159
    v_pk_add_f32 v[128:129], v[144:145], v[146:147]
    v_pk_add_f32 v[130:131], v[16:17], v[18:19]
    v_pk_add_f32 v[132:133], v[152:153], v[154:155]
    v_pk_add_f32 v[134:135], v[40:41], v[42:43]
    v_pk_add_f32 v[128:129], v[128:129], v[148:149]
    v_pk_add_f32 v[130:131], v[130:131], v[20:21]
    v_pk_add_f32 v[132:133], v[132:133], v[156:157]
    v_pk_add_f32 v[134:135], v[134:135], v[44:45]
    v_pk_add_f32 v[128:129], v[128:129], v[150:151]
    v_pk_add_f32 v[130:131], v[130:131], v[22:23]
    v_pk_add_f32 v[132:133], v[132:133], v[158:159]
    v_pk_add_f32 v[134:135], v[134:135], v[46:47]
    v_add_f32 v176, v128, v129
    v_add_f32 v184, v130, v131
    v_add_f32 v178, v132, v133
    v_add_f32 v186, v134, v135
    s_nop 0
    v_permlane32_swap_b32 v176, v178
    v_permlane32_swap_b32_e64 v184, v186
    v_pk_fma_f32 v[64:65], v[160:161], v[220:221], v[188:189] op_sel_hi:[1,0,0] neg_lo:[1,0,1] neg_hi:[1,0,1]
    v_pk_fma_f32 v[160:161], v[160:161], v[220:221], v[180:181] op_sel_hi:[1,0,0] neg_lo:[0,0,1] neg_hi:[0,0,1]
    v_add_f32 v176, v176, v178
    v_add_f32 v184, v184, v186
    v_pk_fma_f32 v[66:67], v[162:163], v[220:221], v[188:189] op_sel_hi:[1,0,0] neg_lo:[1,0,1] neg_hi:[1,0,1]
    v_pk_fma_f32 v[162:163], v[162:163], v[220:221], v[180:181] op_sel_hi:[1,0,0] neg_lo:[0,0,1] neg_hi:[0,0,1]
    v_permlane16_swap_b32 v176, v184
    v_add_f32 v176, v176, v184
    v_pk_fma_f32 v[68:69], v[164:165], v[220:221], v[188:189] op_sel_hi:[1,0,0] neg_lo:[1,0,1] neg_hi:[1,0,1]
    v_pk_fma_f32 v[164:165], v[164:165], v[220:221], v[180:181] op_sel_hi:[1,0,0] neg_lo:[0,0,1] neg_hi:[0,0,1]
    v_rcp_f32_e64 v176, v176
    v_pk_fma_f32 v[70:71], v[166:167], v[220:221], v[188:189] op_sel_hi:[1,0,0] neg_lo:[1,0,1] neg_hi:[1,0,1]
    v_pk_fma_f32 v[166:167], v[166:167], v[220:221], v[180:181] op_sel_hi:[1,0,0] neg_lo:[0,0,1] neg_hi:[0,0,1]
    v_mul_f32 v184, v176, v195
    v_mul_f32 v176, v176, v195
    v_pk_fma_f32 v[88:89], v[168:169], v[222:223], v[190:191] op_sel_hi:[1,0,0] neg_lo:[1,0,1] neg_hi:[1,0,1]
    v_pk_fma_f32 v[168:169], v[168:169], v[222:223], v[182:183] op_sel_hi:[1,0,0] neg_lo:[0,0,1] neg_hi:[0,0,1]
    v_permlane16_swap_b32 v176, v184
    v_mov_b32 v178, v176
    v_pk_fma_f32 v[90:91], v[170:171], v[222:223], v[190:191] op_sel_hi:[1,0,0] neg_lo:[1,0,1] neg_hi:[1,0,1]
    v_pk_fma_f32 v[170:171], v[170:171], v[222:223], v[182:183] op_sel_hi:[1,0,0] neg_lo:[0,0,1] neg_hi:[0,0,1]
    v_mov_b32_e64 v186, v184
    v_pk_fma_f32 v[92:93], v[172:173], v[222:223], v[190:191] op_sel_hi:[1,0,0] neg_lo:[1,0,1] neg_hi:[1,0,1]
    v_pk_fma_f32 v[172:173], v[172:173], v[222:223], v[182:183] op_sel_hi:[1,0,0] neg_lo:[0,0,1] neg_hi:[0,0,1]
    v_permlane32_swap_b32 v176, v178
    v_permlane32_swap_b32 v184, v186
    v_pk_fma_f32 v[94:95], v[174:175], v[222:223], v[190:191] op_sel_hi:[1,0,0] neg_lo:[1,0,1] neg_hi:[1,0,1]
    v_pk_fma_f32 v[174:175], v[174:175], v[222:223], v[182:183] op_sel_hi:[1,0,0] neg_lo:[0,0,1] neg_hi:[0,0,1]
    v_pk_mul_f32 v[144:145], v[144:145], v[176:177] op_sel_hi:[1,0]
    v_pk_mul_f32 v[146:147], v[146:147], v[176:177] op_sel_hi:[1,0]
    v_pk_mul_f32 v[148:149], v[148:149], v[176:177] op_sel_hi:[1,0]
    v_pk_mul_f32 v[150:151], v[150:151], v[176:177] op_sel_hi:[1,0]
    v_cvt_pk_bf16_f32 v144, v144, v145
    v_cvt_pk_bf16_f32 v145, v146, v147
    v_cvt_pk_bf16_f32 v146, v148, v149
    v_cvt_pk_bf16_f32 v147, v150, v151
    ds_write_b64 v4, v[144:145] offset:0
    ds_write_b64 v5, v[146:147] offset:0
    ds_write_b128 v197, v[24:27] offset:0
    v_pk_mul_f32 v[16:17], v[16:17], v[184:185] op_sel_hi:[1,0]
    v_pk_mul_f32 v[18:19], v[18:19], v[184:185] op_sel_hi:[1,0]
    v_pk_mul_f32 v[20:21], v[20:21], v[184:185] op_sel_hi:[1,0]
    v_pk_mul_f32 v[22:23], v[22:23], v[184:185] op_sel_hi:[1,0]
    v_cvt_pk_bf16_f32 v16, v16, v17
    v_cvt_pk_bf16_f32 v17, v18, v19
    v_cvt_pk_bf16_f32 v18, v20, v21
    v_cvt_pk_bf16_f32 v19, v22, v23
    ds_write_b64 v6, v[16:17] offset:0
    ds_write_b64 v7, v[18:19] offset:0
    ds_write_b128 v197, v[28:31] offset:1024
    v_pk_mul_f32 v[152:153], v[152:153], v[178:179] op_sel_hi:[1,0]
    v_pk_mul_f32 v[154:155], v[154:155], v[178:179] op_sel_hi:[1,0]
    v_pk_mul_f32 v[156:157], v[156:157], v[178:179] op_sel_hi:[1,0]
    v_pk_mul_f32 v[158:159], v[158:159], v[178:179] op_sel_hi:[1,0]
    v_cvt_pk_bf16_f32 v152, v152, v153
    v_cvt_pk_bf16_f32 v153, v154, v155
    v_cvt_pk_bf16_f32 v154, v156, v157
    v_cvt_pk_bf16_f32 v155, v158, v159
    ds_write_b64 v4, v[152:153] offset:2048
    ds_write_b64 v5, v[154:155] offset:2048
    ds_write_b128 v197, v[72:75] offset:2048
    v_pk_mul_f32 v[40:41], v[40:41], v[186:187] op_sel_hi:[1,0]
    v_pk_mul_f32 v[42:43], v[42:43], v[186:187] op_sel_hi:[1,0]
    v_pk_mul_f32 v[44:45], v[44:45], v[186:187] op_sel_hi:[1,0]
    v_pk_mul_f32 v[46:47], v[46:47], v[186:187] op_sel_hi:[1,0]
    v_cvt_pk_bf16_f32 v40, v40, v41
    v_cvt_pk_bf16_f32 v41, v42, v43
    v_cvt_pk_bf16_f32 v42, v44, v45
    v_cvt_pk_bf16_f32 v43, v46, v47
    ds_write_b64 v6, v[40:41] offset:2048
    ds_write_b64 v7, v[42:43] offset:2048
    ds_write_b128 v197, v[76:79] offset:3072
    ds_read_b64_tr_b16 v[232:233], v201 offset:0
    ds_read_b64_tr_b16 v[234:235], v201 offset:2048
    ds_read_b64_tr_b16 v[236:237], v203 offset:0
    ds_read_b64_tr_b16 v[238:239], v203 offset:2048
    v_exp_f32 v64, v64
    v_exp_f32 v160, v160
    v_exp_f32 v65, v65
    v_exp_f32 v161, v161
    v_exp_f32 v66, v66
    v_exp_f32 v162, v162
    v_exp_f32 v67, v67
    v_exp_f32 v163, v163
    v_exp_f32 v68, v68
    v_exp_f32 v164, v164
    v_exp_f32 v69, v69
    v_exp_f32 v165, v165
    v_exp_f32 v70, v70
    v_exp_f32 v166, v166
    v_exp_f32 v71, v71
    v_exp_f32 v167, v167
    v_exp_f32 v88, v88
    v_exp_f32 v168, v168
    v_exp_f32 v89, v89
    v_exp_f32 v169, v169
    v_exp_f32 v90, v90
    v_exp_f32 v170, v170
    v_exp_f32 v91, v91
    v_exp_f32 v171, v171
    v_exp_f32 v92, v92
    v_exp_f32 v172, v172
    v_exp_f32 v93, v93
    v_exp_f32 v173, v173
    v_exp_f32 v94, v94
    v_exp_f32 v174, v174
    v_exp_f32 v95, v95
    v_exp_f32 v175, v175
    s_mov_b64 exec, 1
    buffer_store_dword v251, v199, s[48:51], s76 offen sc1
    s_mov_b64 exec, -1
    v_pk_add_f32 v[136:137], v[160:161], v[162:163]
    v_pk_add_f32 v[138:139], v[64:65], v[66:67]
    v_pk_add_f32 v[140:141], v[168:169], v[170:171]
    v_pk_add_f32 v[142:143], v[88:89], v[90:91]
    v_pk_add_f32 v[136:137], v[136:137], v[164:165]
    v_pk_add_f32 v[138:139], v[138:139], v[68:69]
    v_pk_add_f32 v[140:141], v[140:141], v[172:173]
    v_pk_add_f32 v[142:143], v[142:143], v[92:93]
    v_pk_add_f32 v[136:137], v[136:137], v[166:167]
    v_pk_add_f32 v[138:139], v[138:139], v[70:71]
    v_pk_add_f32 v[140:141], v[140:141], v[174:175]
    v_pk_add_f32 v[142:143], v[142:143], v[94:95]
    v_add_f32 v180, v136, v137
    v_add_f32 v188, v138, v139
    v_add_f32 v182, v140, v141
    v_add_f32 v190, v142, v143
    s_nop 0
    v_permlane32_swap_b32 v180, v182
    v_permlane32_swap_b32 v188, v190
    s_waitcnt lgkmcnt(0)
    s_nop 0
    v_mfma_f32_16x16x32_bf16 v[144:147], v[232:235], v[24:27], 0
    v_add_f32 v180, v180, v182
    v_add_f32 v188, v188, v190
    v_mfma_f32_16x16x32_bf16 v[148:151], v[236:239], v[24:27], 0
    s_nop 0
    v_permlane16_swap_b32 v180, v188
    v_add_f32 v180, v180, v188
    v_mfma_f32_16x16x32_bf16 v[152:155], v[232:235], v[28:31], 0
    v_rcp_f32_e64 v180, v180
    v_mfma_f32_16x16x32_bf16 v[156:159], v[236:239], v[28:31], 0
    v_mul_f32 v188, v180, v223
    v_mul_f32 v180, v180, v223
    v_mfma_f32_16x16x32_bf16 v[16:19], v[232:235], v[120:123], 0
    s_nop 0
    v_permlane16_swap_b32 v180, v188
    v_mov_b32_e64 v182, v180
    v_mfma_f32_16x16x32_bf16 v[20:23], v[236:239], v[120:123], 0
    v_mov_b32_e64 v190, v188
    v_permlane32_swap_b32 v180, v182
    s_nop 0
    v_permlane32_swap_b32_e64 v188, v190
    v_pk_mul_f32 v[160:161], v[160:161], v[180:181] op_sel_hi:[1,0]
    v_pk_mul_f32 v[162:163], v[162:163], v[180:181] op_sel_hi:[1,0]
    v_pk_mul_f32 v[164:165], v[164:165], v[180:181] op_sel_hi:[1,0]
    v_pk_mul_f32 v[166:167], v[166:167], v[180:181] op_sel_hi:[1,0]
    v_cvt_pk_bf16_f32 v160, v160, v161
    v_cvt_pk_bf16_f32 v161, v162, v163
    v_cvt_pk_bf16_f32 v162, v164, v165
    v_cvt_pk_bf16_f32 v163, v166, v167
    ds_write_b64 v4, v[160:161] offset:4096
    ds_write_b64 v5, v[162:163] offset:4096
    v_pk_mul_f32 v[64:65], v[64:65], v[188:189] op_sel_hi:[1,0]
    v_pk_mul_f32 v[66:67], v[66:67], v[188:189] op_sel_hi:[1,0]
    v_pk_mul_f32 v[68:69], v[68:69], v[188:189] op_sel_hi:[1,0]
    v_pk_mul_f32 v[70:71], v[70:71], v[188:189] op_sel_hi:[1,0]
    v_cvt_pk_bf16_f32 v64, v64, v65
    v_cvt_pk_bf16_f32 v65, v66, v67
    v_cvt_pk_bf16_f32 v66, v68, v69
    v_cvt_pk_bf16_f32 v67, v70, v71
    ds_write_b64 v6, v[64:65] offset:4096
    ds_write_b64 v7, v[66:67] offset:4096
    v_pk_mul_f32 v[168:169], v[168:169], v[182:183] op_sel_hi:[1,0]
    v_pk_mul_f32 v[170:171], v[170:171], v[182:183] op_sel_hi:[1,0]
    v_pk_mul_f32 v[172:173], v[172:173], v[182:183] op_sel_hi:[1,0]
    v_pk_mul_f32 v[174:175], v[174:175], v[182:183] op_sel_hi:[1,0]
    v_cvt_pk_bf16_f32 v168, v168, v169
    v_cvt_pk_bf16_f32 v169, v170, v171
    v_cvt_pk_bf16_f32 v170, v172, v173
    v_cvt_pk_bf16_f32 v171, v174, v175
    ds_write_b64 v4, v[168:169] offset:6144
    ds_write_b64 v5, v[170:171] offset:6144
    v_pk_mul_f32 v[88:89], v[88:89], v[190:191] op_sel_hi:[1,0]
    v_pk_mul_f32 v[90:91], v[90:91], v[190:191] op_sel_hi:[1,0]
    v_pk_mul_f32 v[92:93], v[92:93], v[190:191] op_sel_hi:[1,0]
    v_pk_mul_f32 v[94:95], v[94:95], v[190:191] op_sel_hi:[1,0]
    v_cvt_pk_bf16_f32 v88, v88, v89
    v_cvt_pk_bf16_f32 v89, v90, v91
    v_cvt_pk_bf16_f32 v90, v92, v93
    v_cvt_pk_bf16_f32 v91, v94, v95
    ds_write_b64 v6, v[88:89] offset:6144
    ds_write_b64 v7, v[90:91] offset:6144
    ds_read_b64_tr_b16 v[240:241], v201 offset:4096
    ds_read_b64_tr_b16 v[242:243], v201 offset:6144
    ds_read_b64_tr_b16 v[244:245], v203 offset:4096
    ds_read_b64_tr_b16 v[246:247], v203 offset:6144
    v_xor_b32 v201, 0x2000, v201
    v_xor_b32 v203, 0x2000, v203
    v_xor_b32 v197, 0x1000, v197
    s_waitcnt lgkmcnt(4)
    s_barrier
    ds_read_b64_tr_b16 v[128:129], v201 offset:0
    ds_read_b64_tr_b16 v[130:131], v201 offset:2048
    ds_read_b64_tr_b16 v[132:133], v203 offset:0
    ds_read_b64_tr_b16 v[134:135], v203 offset:2048
    ds_read_b128 v[48:51], v197 offset:0
    ds_read_b128 v[52:55], v197 offset:1024
    ds_read_b64_tr_b16 v[136:137], v201 offset:4096
    ds_read_b64_tr_b16 v[138:139], v201 offset:6144
    ds_read_b64_tr_b16 v[140:141], v203 offset:4096
    ds_read_b64_tr_b16 v[142:143], v203 offset:6144
    ds_read_b128 v[96:99], v197 offset:2048
    ds_read_b128 v[100:103], v197 offset:3072
    s_waitcnt lgkmcnt(12)
    s_nop 0
    v_mfma_f32_16x16x32_bf16 v[144:147], v[240:243], v[72:75], v[144:147]
    v_mfma_f32_16x16x32_bf16 v[148:151], v[244:247], v[72:75], v[148:151]
    v_mfma_f32_16x16x32_bf16 v[152:155], v[240:243], v[76:79], v[152:155]
    v_mfma_f32_16x16x32_bf16 v[156:159], v[244:247], v[76:79], v[156:159]
    v_mfma_f32_16x16x32_bf16 v[16:19], v[240:243], v[124:127], v[16:19]
    v_mfma_f32_16x16x32_bf16 v[20:23], v[244:247], v[124:127], v[20:23]
    s_waitcnt lgkmcnt(6)
    s_nop 0
    v_mfma_f32_16x16x32_bf16 v[144:147], v[128:131], v[48:51], v[144:147]
    v_mfma_f32_16x16x32_bf16 v[148:151], v[132:135], v[48:51], v[148:151]
    v_mfma_f32_16x16x32_bf16 v[152:155], v[128:131], v[52:55], v[152:155]
    v_mfma_f32_16x16x32_bf16 v[156:159], v[132:135], v[52:55], v[156:159]
    v_mfma_f32_16x16x32_bf16 v[16:19], v[128:131], v[104:107], v[16:19]
    v_mfma_f32_16x16x32_bf16 v[20:23], v[132:135], v[104:107], v[20:23]
    s_waitcnt lgkmcnt(0)
    s_nop 0
    v_mfma_f32_16x16x32_bf16 v[144:147], v[136:139], v[96:99], v[144:147]
    v_mfma_f32_16x16x32_bf16 v[148:151], v[140:143], v[96:99], v[148:151]
    v_mfma_f32_16x16x32_bf16 v[152:155], v[136:139], v[100:103], v[152:155]
    v_mfma_f32_16x16x32_bf16 v[156:159], v[140:143], v[100:103], v[156:159]
    v_mfma_f32_16x16x32_bf16 v[16:19], v[136:139], v[108:111], v[16:19]
    v_mfma_f32_16x16x32_bf16 v[20:23], v[140:143], v[108:111], v[20:23]
    ds_read_b64_tr_b16 v[224:225], v252 offset:8192
    ds_read_b64_tr_b16 v[226:227], v252 offset:9216
    ds_read_b64_tr_b16 v[228:229], v252 offset:8224
    ds_read_b64_tr_b16 v[230:231], v252 offset:9248
    s_xor_b32 s67, s67, 8
    s_lshl_b32 s3, s38, 2
    s_add_u32 s3, s3, 162112
    v_mov_b32 v4, s3
    v_mov_b32 v5, 1
    v_cvt_pk_bf16_f32 v144, v144, v145
    v_cvt_pk_bf16_f32 v145, v146, v147
    v_cvt_pk_bf16_f32 v146, v148, v149
    v_cvt_pk_bf16_f32 v147, v150, v151
    buffer_store_dwordx4 v[144:147], v199, s[48:51], s74 offen offset:0 sc1
    v_cvt_pk_bf16_f32 v152, v152, v153
    v_cvt_pk_bf16_f32 v153, v154, v155
    v_cvt_pk_bf16_f32 v154, v156, v157
    v_cvt_pk_bf16_f32 v155, v158, v159
    buffer_store_dwordx4 v[152:155], v199, s[48:51], s74 offen offset:1024 sc1
    v_cvt_pk_bf16_f32 v16, v16, v17
    v_cvt_pk_bf16_f32 v17, v18, v19
    v_cvt_pk_bf16_f32 v18, v20, v21
    v_cvt_pk_bf16_f32 v19, v22, v23
    s_mov_b32 exec_lo, 0x00010001
    s_mov_b32 exec_hi, 0x00010001
    buffer_store_dwordx4 v[16:19], v1, s[48:51], s75 offen sc1
    s_mov_b64 exec, -1
    ds_write_b32 v4, v5
    s_setprio 0
    v_pk_fma_f32 v[8:9], v[192:193], v[212:213], v[8:9] op_sel_hi:[0,1,1] neg_lo:[1,0,0] neg_hi:[1,0,0]
    v_pk_fma_f32 v[10:11], v[192:193], v[214:215], v[10:11] op_sel_hi:[0,1,1] neg_lo:[1,0,0] neg_hi:[1,0,0]
    v_pk_fma_f32 v[12:13], v[192:193], v[216:217], v[12:13] op_sel_hi:[0,1,1] neg_lo:[1,0,0] neg_hi:[1,0,0]
    v_pk_fma_f32 v[14:15], v[192:193], v[218:219], v[14:15] op_sel_hi:[0,1,1] neg_lo:[1,0,0] neg_hi:[1,0,0]
    v_cvt_pk_bf16_f32 v232, v8, v9
    v_cvt_pk_bf16_f32 v233, v10, v11
    v_cvt_pk_bf16_f32 v234, v12, v13
    v_cvt_pk_bf16_f32 v235, v14, v15
    v_pk_fma_f32 v[32:33], v[194:195], v[212:213], v[32:33] op_sel_hi:[0,1,1] neg_lo:[1,0,0] neg_hi:[1,0,0]
    v_pk_fma_f32 v[34:35], v[194:195], v[214:215], v[34:35] op_sel_hi:[0,1,1] neg_lo:[1,0,0] neg_hi:[1,0,0]
    v_pk_fma_f32 v[36:37], v[194:195], v[216:217], v[36:37] op_sel_hi:[0,1,1] neg_lo:[1,0,0] neg_hi:[1,0,0]
    v_pk_fma_f32 v[38:39], v[194:195], v[218:219], v[38:39] op_sel_hi:[0,1,1] neg_lo:[1,0,0] neg_hi:[1,0,0]
    v_cvt_pk_bf16_f32 v236, v32, v33
    v_cvt_pk_bf16_f32 v237, v34, v35
    v_cvt_pk_bf16_f32 v238, v36, v37
    v_cvt_pk_bf16_f32 v239, v38, v39
    v_pk_fma_f32 v[56:57], v[196:197], v[212:213], v[56:57] op_sel_hi:[0,1,1] neg_lo:[1,0,0] neg_hi:[1,0,0]
    v_pk_fma_f32 v[58:59], v[196:197], v[214:215], v[58:59] op_sel_hi:[0,1,1] neg_lo:[1,0,0] neg_hi:[1,0,0]
    v_pk_fma_f32 v[60:61], v[196:197], v[216:217], v[60:61] op_sel_hi:[0,1,1] neg_lo:[1,0,0] neg_hi:[1,0,0]
    v_pk_fma_f32 v[62:63], v[196:197], v[218:219], v[62:63] op_sel_hi:[0,1,1] neg_lo:[1,0,0] neg_hi:[1,0,0]
    v_cvt_pk_bf16_f32 v240, v56, v57
    v_cvt_pk_bf16_f32 v241, v58, v59
    v_cvt_pk_bf16_f32 v242, v60, v61
    v_cvt_pk_bf16_f32 v243, v62, v63
    v_pk_fma_f32 v[80:81], v[198:199], v[212:213], v[80:81] op_sel_hi:[0,1,1] neg_lo:[1,0,0] neg_hi:[1,0,0]
    v_pk_fma_f32 v[82:83], v[198:199], v[214:215], v[82:83] op_sel_hi:[0,1,1] neg_lo:[1,0,0] neg_hi:[1,0,0]
    v_pk_fma_f32 v[84:85], v[198:199], v[216:217], v[84:85] op_sel_hi:[0,1,1] neg_lo:[1,0,0] neg_hi:[1,0,0]
    v_pk_fma_f32 v[86:87], v[198:199], v[218:219], v[86:87] op_sel_hi:[0,1,1] neg_lo:[1,0,0] neg_hi:[1,0,0]
    v_cvt_pk_bf16_f32 v244, v80, v81
    v_cvt_pk_bf16_f32 v245, v82, v83
    v_cvt_pk_bf16_f32 v246, v84, v85
    v_cvt_pk_bf16_f32 v247, v86, v87
    s_waitcnt lgkmcnt(1)
    s_nop 0
    v_mfma_f32_16x16x32_bf16 v[144:147], v[224:227], v[232:235], 0
    v_mfma_f32_16x16x32_bf16 v[148:151], v[228:231], v[232:235], 0
    v_mfma_f32_16x16x32_bf16 v[152:155], v[224:227], v[236:239], 0
    v_mfma_f32_16x16x32_bf16 v[156:159], v[228:231], v[236:239], 0
    v_mfma_f32_16x16x32_bf16 v[160:163], v[224:227], v[240:243], 0
    v_mfma_f32_16x16x32_bf16 v[164:167], v[228:231], v[240:243], 0
    v_mfma_f32_16x16x32_bf16 v[168:171], v[224:227], v[244:247], 0
    v_mfma_f32_16x16x32_bf16 v[172:175], v[228:231], v[244:247], 0
    s_nop 0
    s_nop 0
    v_max3_f32 v176, v144, v145, v146
    v_max3_f32 v184, -v144, -v145, -v146
    v_max3_f32 v178, v152, v153, v154
    v_max3_f32 v186, -v152, -v153, -v154
    v_max3_f32 v176, v176, v147, v148
    v_max3_f32 v184, v184, -v147, -v148
    v_max3_f32 v178, v178, v155, v156
    v_max3_f32 v186, v186, -v155, -v156
    v_max3_f32 v176, v176, v149, v150
    v_max3_f32 v184, v184, -v149, -v150
    v_max3_f32 v178, v178, v157, v158
    v_max3_f32 v186, v186, -v157, -v158
    v_max_f32_e64 v176, v176, v151
    v_max_f32_e64 v184, v184, -v151
    v_max_f32_e64 v178, v178, v159
    v_max_f32_e64 v186, v186, -v159
    s_nop 0
    v_permlane32_swap_b32 v176, v178
    v_permlane32_swap_b32_e64 v184, v186
    v_max3_f32 v180, v160, v161, v162
    v_max3_f32 v188, -v160, -v161, -v162
    v_max_f32 v176, v176, v178
    v_max_f32 v184, v184, v186
    v_max3_f32 v182, v168, v169, v170
    v_max3_f32 v190, -v168, -v169, -v170
    v_permlane16_swap_b32 v176, v184
    v_max_f32 v176, v176, v184
    v_max3_f32 v180, v180, v163, v164
    v_max3_f32 v188, v188, -v163, -v164
    v_mul_f32 v184, v176, v193
    v_mul_f32 v176, v176, v193
    v_max3_f32 v182, v182, v171, v172
    v_max3_f32 v190, v190, -v171, -v172
    v_permlane16_swap_b32 v176, v184
    v_mov_b32 v178, v176
    v_max3_f32 v180, v180, v165, v166
    v_max3_f32 v188, v188, -v165, -v166
    v_mov_b32_e64 v186, v184
    v_max3_f32 v182, v182, v173, v174
    v_max3_f32 v190, v190, -v173, -v174
    v_permlane32_swap_b32 v176, v178
    v_permlane32_swap_b32 v184, v186
    v_max_f32_e64 v180, v180, v167
    v_max_f32_e64 v188, v188, -v167
    v_max_f32_e64 v182, v182, v175
    v_max_f32_e64 v190, v190, -v175
    s_nop 0
    v_permlane32_swap_b32 v180, v182
    v_permlane32_swap_b32_e64 v188, v190
    v_pk_fma_f32 v[8:9], v[144:145], v[200:201], v[184:185] op_sel_hi:[1,0,0] neg_lo:[1,0,1] neg_hi:[1,0,1]
    v_pk_fma_f32 v[144:145], v[144:145], v[200:201], v[176:177] op_sel_hi:[1,0,0] neg_lo:[0,0,1] neg_hi:[0,0,1]
    v_max_f32 v180, v180, v182
    v_max_f32 v188, v188, v190
    v_pk_fma_f32 v[10:11], v[146:147], v[200:201], v[184:185] op_sel_hi:[1,0,0] neg_lo:[1,0,1] neg_hi:[1,0,1]
    v_pk_fma_f32 v[146:147], v[146:147], v[200:201], v[176:177] op_sel_hi:[1,0,0] neg_lo:[0,0,1] neg_hi:[0,0,1]
    v_permlane16_swap_b32 v180, v188
    v_max_f32 v180, v180, v188
    v_pk_fma_f32 v[12:13], v[148:149], v[200:201], v[184:185] op_sel_hi:[1,0,0] neg_lo:[1,0,1] neg_hi:[1,0,1]
    v_pk_fma_f32 v[148:149], v[148:149], v[200:201], v[176:177] op_sel_hi:[1,0,0] neg_lo:[0,0,1] neg_hi:[0,0,1]
    v_mul_f32 v188, v180, v221
    v_mul_f32 v180, v180, v221
    v_pk_fma_f32 v[14:15], v[150:151], v[200:201], v[184:185] op_sel_hi:[1,0,0] neg_lo:[1,0,1] neg_hi:[1,0,1]
    v_pk_fma_f32 v[150:151], v[150:151], v[200:201], v[176:177] op_sel_hi:[1,0,0] neg_lo:[0,0,1] neg_hi:[0,0,1]
    v_permlane16_swap_b32 v180, v188
    v_mov_b32 v182, v180
    v_pk_fma_f32 v[32:33], v[152:153], v[202:203], v[186:187] op_sel_hi:[1,0,0] neg_lo:[1,0,1] neg_hi:[1,0,1]
    v_pk_fma_f32 v[152:153], v[152:153], v[202:203], v[178:179] op_sel_hi:[1,0,0] neg_lo:[0,0,1] neg_hi:[0,0,1]
    v_mov_b32_e64 v190, v188
    v_pk_fma_f32 v[34:35], v[154:155], v[202:203], v[186:187] op_sel_hi:[1,0,0] neg_lo:[1,0,1] neg_hi:[1,0,1]
    v_pk_fma_f32 v[154:155], v[154:155], v[202:203], v[178:179] op_sel_hi:[1,0,0] neg_lo:[0,0,1] neg_hi:[0,0,1]
    v_permlane32_swap_b32 v180, v182
    v_permlane32_swap_b32 v188, v190
    v_pk_fma_f32 v[36:37], v[156:157], v[202:203], v[186:187] op_sel_hi:[1,0,0] neg_lo:[1,0,1] neg_hi:[1,0,1]
    v_pk_fma_f32 v[156:157], v[156:157], v[202:203], v[178:179] op_sel_hi:[1,0,0] neg_lo:[0,0,1] neg_hi:[0,0,1]
    v_pk_fma_f32 v[38:39], v[158:159], v[202:203], v[186:187] op_sel_hi:[1,0,0] neg_lo:[1,0,1] neg_hi:[1,0,1]
    v_pk_fma_f32 v[158:159], v[158:159], v[202:203], v[178:179] op_sel_hi:[1,0,0] neg_lo:[0,0,1] neg_hi:[0,0,1]
    v_exp_f32 v8, v8
    v_exp_f32 v144, v144
    v_exp_f32 v9, v9
    v_exp_f32 v145, v145
    v_exp_f32 v10, v10
    v_exp_f32 v146, v146
    v_exp_f32 v11, v11
    v_exp_f32 v147, v147
    v_exp_f32 v12, v12
    v_exp_f32 v148, v148
    v_exp_f32 v13, v13
    v_exp_f32 v149, v149
    v_exp_f32 v14, v14
    v_exp_f32 v150, v150
    v_exp_f32 v15, v15
    v_exp_f32 v151, v151
    v_exp_f32 v32, v32
    v_exp_f32 v152, v152
    v_exp_f32 v33, v33
    v_exp_f32 v153, v153
    v_exp_f32 v34, v34
    v_exp_f32 v154, v154
    v_exp_f32 v35, v35
    v_exp_f32 v155, v155
    v_exp_f32 v36, v36
    v_exp_f32 v156, v156
    v_exp_f32 v37, v37
    v_exp_f32 v157, v157
    v_exp_f32 v38, v38
    v_exp_f32 v158, v158
    v_exp_f32 v39, v39
    v_exp_f32 v159, v159
    v_pk_add_f32 v[128:129], v[144:145], v[146:147]
    v_pk_add_f32 v[130:131], v[8:9], v[10:11]
    v_pk_add_f32 v[132:133], v[152:153], v[154:155]
    v_pk_add_f32 v[134:135], v[32:33], v[34:35]
    v_pk_add_f32 v[128:129], v[128:129], v[148:149]
    v_pk_add_f32 v[130:131], v[130:131], v[12:13]
    v_pk_add_f32 v[132:133], v[132:133], v[156:157]
    v_pk_add_f32 v[134:135], v[134:135], v[36:37]
    v_pk_add_f32 v[128:129], v[128:129], v[150:151]
    v_pk_add_f32 v[130:131], v[130:131], v[14:15]
    v_pk_add_f32 v[132:133], v[132:133], v[158:159]
    v_pk_add_f32 v[134:135], v[134:135], v[38:39]
    v_add_f32 v176, v128, v129
    v_add_f32 v184, v130, v131
    v_add_f32 v178, v132, v133
    v_add_f32 v186, v134, v135
    s_nop 0
    v_permlane32_swap_b32 v176, v178
    v_permlane32_swap_b32_e64 v184, v186
    v_pk_fma_f32 v[56:57], v[160:161], v[220:221], v[188:189] op_sel_hi:[1,0,0] neg_lo:[1,0,1] neg_hi:[1,0,1]
    v_pk_fma_f32 v[160:161], v[160:161], v[220:221], v[180:181] op_sel_hi:[1,0,0] neg_lo:[0,0,1] neg_hi:[0,0,1]
    v_add_f32 v176, v176, v178
    v_add_f32 v184, v184, v186
    v_pk_fma_f32 v[58:59], v[162:163], v[220:221], v[188:189] op_sel_hi:[1,0,0] neg_lo:[1,0,1] neg_hi:[1,0,1]
    v_pk_fma_f32 v[162:163], v[162:163], v[220:221], v[180:181] op_sel_hi:[1,0,0] neg_lo:[0,0,1] neg_hi:[0,0,1]
    v_permlane16_swap_b32 v176, v184
    v_add_f32 v176, v176, v184
    v_pk_fma_f32 v[60:61], v[164:165], v[220:221], v[188:189] op_sel_hi:[1,0,0] neg_lo:[1,0,1] neg_hi:[1,0,1]
    v_pk_fma_f32 v[164:165], v[164:165], v[220:221], v[180:181] op_sel_hi:[1,0,0] neg_lo:[0,0,1] neg_hi:[0,0,1]
    v_rcp_f32_e64 v176, v176
    v_pk_fma_f32 v[62:63], v[166:167], v[220:221], v[188:189] op_sel_hi:[1,0,0] neg_lo:[1,0,1] neg_hi:[1,0,1]
    v_pk_fma_f32 v[166:167], v[166:167], v[220:221], v[180:181] op_sel_hi:[1,0,0] neg_lo:[0,0,1] neg_hi:[0,0,1]
    v_mov_b32_e64 v184, v176
    v_pk_fma_f32 v[80:81], v[168:169], v[222:223], v[190:191] op_sel_hi:[1,0,0] neg_lo:[1,0,1] neg_hi:[1,0,1]
    v_pk_fma_f32 v[168:169], v[168:169], v[222:223], v[182:183] op_sel_hi:[1,0,0] neg_lo:[0,0,1] neg_hi:[0,0,1]
    v_permlane16_swap_b32 v176, v184
    v_mov_b32 v178, v176
    v_pk_fma_f32 v[82:83], v[170:171], v[222:223], v[190:191] op_sel_hi:[1,0,0] neg_lo:[1,0,1] neg_hi:[1,0,1]
    v_pk_fma_f32 v[170:171], v[170:171], v[222:223], v[182:183] op_sel_hi:[1,0,0] neg_lo:[0,0,1] neg_hi:[0,0,1]
    v_mov_b32_e64 v186, v184
    v_pk_fma_f32 v[84:85], v[172:173], v[222:223], v[190:191] op_sel_hi:[1,0,0] neg_lo:[1,0,1] neg_hi:[1,0,1]
    v_pk_fma_f32 v[172:173], v[172:173], v[222:223], v[182:183] op_sel_hi:[1,0,0] neg_lo:[0,0,1] neg_hi:[0,0,1]
    v_permlane32_swap_b32 v176, v178
    v_permlane32_swap_b32 v184, v186
    v_pk_fma_f32 v[86:87], v[174:175], v[222:223], v[190:191] op_sel_hi:[1,0,0] neg_lo:[1,0,1] neg_hi:[1,0,1]
    v_pk_fma_f32 v[174:175], v[174:175], v[222:223], v[182:183] op_sel_hi:[1,0,0] neg_lo:[0,0,1] neg_hi:[0,0,1]
    v_pk_mul_f32 v[144:145], v[144:145], v[176:177] op_sel_hi:[1,0]
    v_pk_mul_f32 v[146:147], v[146:147], v[176:177] op_sel_hi:[1,0]
    v_pk_mul_f32 v[148:149], v[148:149], v[176:177] op_sel_hi:[1,0]
    v_pk_mul_f32 v[150:151], v[150:151], v[176:177] op_sel_hi:[1,0]
    v_cvt_pk_bf16_f32 v144, v144, v145
    v_cvt_pk_bf16_f32 v145, v146, v147
    v_cvt_pk_bf16_f32 v146, v148, v149
    v_cvt_pk_bf16_f32 v147, v150, v151
    v_pk_mul_f32 v[8:9], v[8:9], v[184:185] op_sel_hi:[1,0]
    v_pk_mul_f32 v[10:11], v[10:11], v[184:185] op_sel_hi:[1,0]
    v_pk_mul_f32 v[12:13], v[12:13], v[184:185] op_sel_hi:[1,0]
    v_pk_mul_f32 v[14:15], v[14:15], v[184:185] op_sel_hi:[1,0]
    v_cvt_pk_bf16_f32 v8, v8, v9
    v_cvt_pk_bf16_f32 v9, v10, v11
    v_cvt_pk_bf16_f32 v10, v12, v13
    v_cvt_pk_bf16_f32 v11, v14, v15
    v_pk_mul_f32 v[152:153], v[152:153], v[178:179] op_sel_hi:[1,0]
    v_pk_mul_f32 v[154:155], v[154:155], v[178:179] op_sel_hi:[1,0]
    v_pk_mul_f32 v[156:157], v[156:157], v[178:179] op_sel_hi:[1,0]
    v_pk_mul_f32 v[158:159], v[158:159], v[178:179] op_sel_hi:[1,0]
    v_cvt_pk_bf16_f32 v152, v152, v153
    v_cvt_pk_bf16_f32 v153, v154, v155
    v_cvt_pk_bf16_f32 v154, v156, v157
    v_cvt_pk_bf16_f32 v155, v158, v159
    v_pk_mul_f32 v[32:33], v[32:33], v[186:187] op_sel_hi:[1,0]
    v_pk_mul_f32 v[34:35], v[34:35], v[186:187] op_sel_hi:[1,0]
    v_pk_mul_f32 v[36:37], v[36:37], v[186:187] op_sel_hi:[1,0]
    v_pk_mul_f32 v[38:39], v[38:39], v[186:187] op_sel_hi:[1,0]
    v_cvt_pk_bf16_f32 v32, v32, v33
    v_cvt_pk_bf16_f32 v33, v34, v35
    v_cvt_pk_bf16_f32 v34, v36, v37
    v_cvt_pk_bf16_f32 v35, v38, v39
    v_exp_f32 v56, v56
    v_exp_f32 v160, v160
    v_exp_f32 v57, v57
    v_exp_f32 v161, v161
    v_exp_f32 v58, v58
    v_exp_f32 v162, v162
    v_exp_f32 v59, v59
    v_exp_f32 v163, v163
    v_exp_f32 v60, v60
    v_exp_f32 v164, v164
    v_exp_f32 v61, v61
    v_exp_f32 v165, v165
    v_exp_f32 v62, v62
    v_exp_f32 v166, v166
    v_exp_f32 v63, v63
    v_exp_f32 v167, v167
    v_exp_f32 v80, v80
    v_exp_f32 v168, v168
    v_exp_f32 v81, v81
    v_exp_f32 v169, v169
    v_exp_f32 v82, v82
    v_exp_f32 v170, v170
    v_exp_f32 v83, v83
    v_exp_f32 v171, v171
    v_exp_f32 v84, v84
    v_exp_f32 v172, v172
    v_exp_f32 v85, v85
    v_exp_f32 v173, v173
    v_exp_f32 v86, v86
    v_exp_f32 v174, v174
    v_exp_f32 v87, v87
    v_exp_f32 v175, v175
    v_pk_add_f32 v[136:137], v[160:161], v[162:163]
    v_pk_add_f32 v[138:139], v[56:57], v[58:59]
    v_pk_add_f32 v[140:141], v[168:169], v[170:171]
    v_pk_add_f32 v[142:143], v[80:81], v[82:83]
    v_pk_add_f32 v[136:137], v[136:137], v[164:165]
    v_pk_add_f32 v[138:139], v[138:139], v[60:61]
    v_pk_add_f32 v[140:141], v[140:141], v[172:173]
    v_pk_add_f32 v[142:143], v[142:143], v[84:85]
    v_pk_add_f32 v[136:137], v[136:137], v[166:167]
    v_pk_add_f32 v[138:139], v[138:139], v[62:63]
    v_pk_add_f32 v[140:141], v[140:141], v[174:175]
    v_pk_add_f32 v[142:143], v[142:143], v[86:87]
    v_add_f32 v180, v136, v137
    v_add_f32 v188, v138, v139
    v_add_f32 v182, v140, v141
    v_add_f32 v190, v142, v143
    s_nop 0
    v_permlane32_swap_b32 v180, v182
    v_permlane32_swap_b32 v188, v190
    v_add_f32 v180, v180, v182
    v_add_f32 v188, v188, v190
    s_nop 1
    v_permlane16_swap_b32 v180, v188
    v_add_f32 v180, v180, v188
    v_rcp_f32_e64 v180, v180
    s_nop 0
    v_mov_b32_e64 v188, v180
    s_nop 1
    v_permlane16_swap_b32 v180, v188
    v_mov_b32 v182, v180
    v_mov_b32_e64 v190, v188
    s_nop 0
    v_permlane32_swap_b32 v180, v182
    v_permlane32_swap_b32_e64 v188, v190
    v_pk_mul_f32 v[160:161], v[160:161], v[180:181] op_sel_hi:[1,0]
    v_pk_mul_f32 v[162:163], v[162:163], v[180:181] op_sel_hi:[1,0]
    v_pk_mul_f32 v[164:165], v[164:165], v[180:181] op_sel_hi:[1,0]
    v_pk_mul_f32 v[166:167], v[166:167], v[180:181] op_sel_hi:[1,0]
    v_cvt_pk_bf16_f32 v160, v160, v161
    v_cvt_pk_bf16_f32 v161, v162, v163
    v_cvt_pk_bf16_f32 v162, v164, v165
    v_cvt_pk_bf16_f32 v163, v166, v167
    v_pk_mul_f32 v[56:57], v[56:57], v[188:189] op_sel_hi:[1,0]
    v_pk_mul_f32 v[58:59], v[58:59], v[188:189] op_sel_hi:[1,0]
    v_pk_mul_f32 v[60:61], v[60:61], v[188:189] op_sel_hi:[1,0]
    v_pk_mul_f32 v[62:63], v[62:63], v[188:189] op_sel_hi:[1,0]
    v_cvt_pk_bf16_f32 v56, v56, v57
    v_cvt_pk_bf16_f32 v57, v58, v59
    v_cvt_pk_bf16_f32 v58, v60, v61
    v_cvt_pk_bf16_f32 v59, v62, v63
    v_pk_mul_f32 v[168:169], v[168:169], v[182:183] op_sel_hi:[1,0]
    v_pk_mul_f32 v[170:171], v[170:171], v[182:183] op_sel_hi:[1,0]
    v_pk_mul_f32 v[172:173], v[172:173], v[182:183] op_sel_hi:[1,0]
    v_pk_mul_f32 v[174:175], v[174:175], v[182:183] op_sel_hi:[1,0]
    v_cvt_pk_bf16_f32 v168, v168, v169
    v_cvt_pk_bf16_f32 v169, v170, v171
    v_cvt_pk_bf16_f32 v170, v172, v173
    v_cvt_pk_bf16_f32 v171, v174, v175
    v_pk_mul_f32 v[80:81], v[80:81], v[190:191] op_sel_hi:[1,0]
    v_pk_mul_f32 v[82:83], v[82:83], v[190:191] op_sel_hi:[1,0]
    v_pk_mul_f32 v[84:85], v[84:85], v[190:191] op_sel_hi:[1,0]
    v_pk_mul_f32 v[86:87], v[86:87], v[190:191] op_sel_hi:[1,0]
    v_cvt_pk_bf16_f32 v80, v80, v81
    v_cvt_pk_bf16_f32 v81, v82, v83
    v_cvt_pk_bf16_f32 v82, v84, v85
    v_cvt_pk_bf16_f32 v83, v86, v87
    v_mov_b32 v240, v177
    v_mov_b32 v241, v179
    v_mov_b32 v242, v181
    v_mov_b32 v243, v183
    v_mov_b32 v244, v185
    v_mov_b32 v245, v187
    v_mov_b32 v246, v189
    v_mov_b32 v247, v191
    v_mov_b32 v2, 162048
    ds_read_b32 v248, v2
    v_lshrrev_b32 v5, 3, v1
    v_lshlrev_b32 v6, 11, v5
    v_bfe_u32 v5, v1, 4, 2
    v_lshlrev_b32 v5, 1, v5
    v_and_b32 v7, 7, v1
    v_xor_b32 v5, v5, v7
    v_lshl_add_u32 v6, v5, 4, v6
    s_lshl_b32 s3, s35, 7
    v_add_u32 v6, s3, v6
    v_add_u32 v216, 0, v6
    v_add_u32 v217, 15360, v6
    v_add_u32 v218, 30720, v6
    v_add_u32 v219, 46080, v6
    s_lshl_b32 s72, s38, 12
    s_lshl_b32 s73, s38, 16
    v_and_b32 v2, 15, v1
    v_add_u32 v2, s69, v2
    v_lshlrev_b32_e64 v2, 2, v2
    v_add_u32 v2, 152064, v2
    ds_read_b32 v193, v2
    ds_read_b32 v192, v2 offset:1024
    s_mul_i32 s76, s67, 4224
    s_add_u32 s76, s76, 1048576
    v_lshlrev_b32 v5, 4, v1
    v_and_b32 v6, 48, v1
    v_add_u32 v6, 4096, v6
    s_lshl_b32 s3, s38, 2
    s_add_u32 s3, s3, 162112
    v_mov_b32 v3, s3
L_gw:
    ds_read_b32 v2, v3
    s_waitcnt lgkmcnt(0)
    v_readfirstlane_b32 s3, v2
    s_nop 0
    s_cmp_eq_u32 s3, 3
    s_cbranch_scc1 L_gk
    s_sleep 1
    s_branch L_gw
L_gk:
    s_sleep 6
    buffer_load_dwordx4 v[104:107], v5, s[48:51], s76 offen offset:0 sc1
    buffer_load_dwordx4 v[108:111], v5, s[48:51], s76 offen offset:1024 sc1
    buffer_load_dwordx4 v[112:115], v5, s[48:51], s76 offen offset:2048 sc1
    buffer_load_dwordx4 v[116:119], v5, s[48:51], s76 offen offset:3072 sc1
    buffer_load_dwordx4 v[120:123], v6, s[48:51], s76 offen offset:0 sc1
    buffer_load_dwordx4 v[124:127], v6, s[48:51], s76 offen offset:64 sc1
    s_waitcnt lgkmcnt(0)
    v_readfirstlane_b32 s70, v248
    s_nop 0
    s_and_b32 s68, s70, 0x7ff
    s_sub_u32 s68, 2047, s68
    s_lshl_b32 s3, s36, 3
    s_lshl_b32 s28, s64, 2
    s_add_u32 s3, s3, s28
    s_lshl_b32 s3, s3, 5
    s_add_u32 s3, s3, s67
    s_lshl_b32 s77, s3, 10
    s_add_u32 s77, s77, 4194304
    s_waitcnt vmcnt(0)
    s_mov_b32 s29, 0
L_k7:
    s_nop 0
    v_max3_u32 v2, v104, v105, v106
    v_max3_u32 v2, v2, v107, v108
    v_max3_u32 v2, v2, v109, v110
    v_max3_u32 v2, v2, v111, v112
    v_max3_u32 v2, v2, v113, v114
    v_max3_u32 v2, v2, v115, v116
    v_max3_u32 v2, v2, v117, v118
    v_max3_u32 v2, v2, v119, v120
    v_max3_u32 v2, v2, v121, v122
    v_max3_u32 v2, v2, v123, v124
    v_max3_u32 v2, v2, v125, v126
    v_max_u32 v2, v2, v127
    v_cmp_eq_u32 vcc, -1, v2
    s_cbranch_vccz L_k7k
    s_add_u32 s29, s29, 1
    s_cmp_ge_u32 s29, 200000
    s_cbranch_scc1 L_k7k
    s_sleep 1
    buffer_load_dwordx4 v[104:107], v5, s[48:51], s76 offen offset:0 sc1
    buffer_load_dwordx4 v[108:111], v5, s[48:51], s76 offen offset:1024 sc1
    buffer_load_dwordx4 v[112:115], v5, s[48:51], s76 offen offset:2048 sc1
    buffer_load_dwordx4 v[116:119], v5, s[48:51], s76 offen offset:3072 sc1
    buffer_load_dwordx4 v[120:123], v6, s[48:51], s76 offen offset:0 sc1
    buffer_load_dwordx4 v[124:127], v6, s[48:51], s76 offen offset:64 sc1
    s_waitcnt vmcnt(0)
    s_branch L_k7
L_k7k:
    s_setprio 2
    s_nop 0
    v_mfma_f32_16x16x32_bf16 v[24:27], v[120:123], v[144:147], 0
    v_mfma_f32_16x16x32_bf16 v[16:19], v[104:107], v[144:147], 0
    v_mfma_f32_16x16x32_bf16 v[20:23], v[108:111], v[144:147], 0
    v_mfma_f32_16x16x32_bf16 v[24:27], v[124:127], v[8:11], v[24:27]
    v_mfma_f32_16x16x32_bf16 v[16:19], v[112:115], v[8:11], v[16:19]
    v_mfma_f32_16x16x32_bf16 v[20:23], v[116:119], v[8:11], v[20:23]
    v_mfma_f32_16x16x32_bf16 v[48:51], v[120:123], v[152:155], 0
    v_mfma_f32_16x16x32_bf16 v[40:43], v[104:107], v[152:155], 0
    v_mfma_f32_16x16x32_bf16 v[44:47], v[108:111], v[152:155], 0
    v_mfma_f32_16x16x32_bf16 v[48:51], v[124:127], v[32:35], v[48:51]
    v_mfma_f32_16x16x32_bf16 v[40:43], v[112:115], v[32:35], v[40:43]
    v_mfma_f32_16x16x32_bf16 v[44:47], v[116:119], v[32:35], v[44:47]
    v_mfma_f32_16x16x32_bf16 v[72:75], v[120:123], v[160:163], 0
    v_mfma_f32_16x16x32_bf16 v[64:67], v[104:107], v[160:163], 0
    v_mfma_f32_16x16x32_bf16 v[68:71], v[108:111], v[160:163], 0
    v_mfma_f32_16x16x32_bf16 v[72:75], v[124:127], v[56:59], v[72:75]
    v_mfma_f32_16x16x32_bf16 v[64:67], v[112:115], v[56:59], v[64:67]
    v_mfma_f32_16x16x32_bf16 v[68:71], v[116:119], v[56:59], v[68:71]
    v_mfma_f32_16x16x32_bf16 v[96:99], v[120:123], v[168:171], 0
    v_mfma_f32_16x16x32_bf16 v[88:91], v[104:107], v[168:171], 0
    v_mfma_f32_16x16x32_bf16 v[92:95], v[108:111], v[168:171], 0
    v_mfma_f32_16x16x32_bf16 v[96:99], v[124:127], v[80:83], v[96:99]
    v_mfma_f32_16x16x32_bf16 v[88:91], v[112:115], v[80:83], v[88:91]
    v_mfma_f32_16x16x32_bf16 v[92:95], v[116:119], v[80:83], v[92:95]
    v_add_f32 v24, 0x358637bd, v24
    v_add_f32 v48, 0x358637bd, v48
    v_add_f32 v72, 0x358637bd, v72
    s_nop 2
    v_add_f32 v96, 0x358637bd, v96
    v_rcp_f32 v24, v24
    v_rcp_f32 v48, v48
    v_rcp_f32 v72, v72
    v_rcp_f32_e64 v96, v96
    v_pk_mul_f32 v[16:17], v[16:17], v[24:25] op_sel_hi:[1,0]
    v_pk_mul_f32 v[18:19], v[18:19], v[24:25] op_sel_hi:[1,0]
    v_pk_mul_f32 v[20:21], v[20:21], v[24:25] op_sel_hi:[1,0]
    v_pk_mul_f32 v[22:23], v[22:23], v[24:25] op_sel_hi:[1,0]
    v_cvt_pk_bf16_f32 v16, v16, v17
    v_cvt_pk_bf16_f32 v17, v18, v19
    v_cvt_pk_bf16_f32 v18, v20, v21
    v_cvt_pk_bf16_f32 v19, v22, v23
    buffer_store_dwordx4 v[16:19], v5, s[48:51], s77 offen sc1
    s_add_u32 s77, s77, 32768
    v_pk_mul_f32 v[40:41], v[40:41], v[48:49] op_sel_hi:[1,0]
    v_pk_mul_f32 v[42:43], v[42:43], v[48:49] op_sel_hi:[1,0]
    v_pk_mul_f32 v[44:45], v[44:45], v[48:49] op_sel_hi:[1,0]
    v_pk_mul_f32 v[46:47], v[46:47], v[48:49] op_sel_hi:[1,0]
    v_cvt_pk_bf16_f32 v40, v40, v41
    v_cvt_pk_bf16_f32 v41, v42, v43
    v_cvt_pk_bf16_f32 v42, v44, v45
    v_cvt_pk_bf16_f32 v43, v46, v47
    buffer_store_dwordx4 v[40:43], v5, s[48:51], s77 offen sc1
    s_add_u32 s77, s77, 32768
    v_pk_mul_f32 v[64:65], v[64:65], v[72:73] op_sel_hi:[1,0]
    v_pk_mul_f32 v[66:67], v[66:67], v[72:73] op_sel_hi:[1,0]
    v_pk_mul_f32 v[68:69], v[68:69], v[72:73] op_sel_hi:[1,0]
    v_pk_mul_f32 v[70:71], v[70:71], v[72:73] op_sel_hi:[1,0]
    v_cvt_pk_bf16_f32 v64, v64, v65
    v_cvt_pk_bf16_f32 v65, v66, v67
    v_cvt_pk_bf16_f32 v66, v68, v69
    v_cvt_pk_bf16_f32 v67, v70, v71
    buffer_store_dwordx4 v[64:67], v5, s[48:51], s77 offen sc1
    s_add_u32 s77, s77, 32768
    v_pk_mul_f32 v[88:89], v[88:89], v[96:97] op_sel_hi:[1,0]
    v_pk_mul_f32 v[90:91], v[90:91], v[96:97] op_sel_hi:[1,0]
    v_pk_mul_f32 v[92:93], v[92:93], v[96:97] op_sel_hi:[1,0]
    v_pk_mul_f32 v[94:95], v[94:95], v[96:97] op_sel_hi:[1,0]
    v_cvt_pk_bf16_f32 v88, v88, v89
    v_cvt_pk_bf16_f32 v89, v90, v91
    v_cvt_pk_bf16_f32 v90, v92, v93
    v_cvt_pk_bf16_f32 v91, v94, v95
    buffer_store_dwordx4 v[88:91], v5, s[48:51], s77 offen sc1
    v_mov_b32_e64 v2, 7
    ds_write_b32 v3, v2
    s_and_b32 s3, s68, 127
    s_lshl_b32 s3, s3, 2
    s_add_u32 s3, s3, 152064
    v_mov_b32 v2, s3
    ds_read_b32 v250, v2
    ds_read_b32 v251, v2 offset:1024
    s_setprio 0
    v_and_b32 v3, 3, v1
    v_lshlrev_b32_e64 v3, 2, v3
    v_add_u32 v3, 162112, v3
L_cw:
    ds_read_b32 v2, v3
    s_waitcnt lgkmcnt(0)
    v_cmp_ne_u32_e64 vcc, 7, v2
    s_cbranch_vccz L_cwk
    s_sleep 1
    s_branch L_cw
L_cwk:
    s_add_u32 m0, s72, 98304
    s_add_u32 s3, s73, 1572864
    buffer_load_dwordx4 v216, s[88:91], s3 offen offset:0 lds
    buffer_load_dwordx4 v217, s[88:91], s3 offen offset:1024 lds
    buffer_load_dwordx4 v218, s[88:91], s3 offen offset:2048 lds
    buffer_load_dwordx4 v219, s[88:91], s3 offen offset:3072 lds
    s_add_u32 m0, s72, 114688
    s_add_u32 s3, s73, 1835008
    buffer_load_dwordx4 v216, s[88:91], s3 offen offset:0 lds
    buffer_load_dwordx4 v217, s[88:91], s3 offen offset:1024 lds
    buffer_load_dwordx4 v218, s[88:91], s3 offen offset:2048 lds
    buffer_load_dwordx4 v219, s[88:91], s3 offen offset:3072 lds
    v_mul_f32 v196, v193, v192
    v_mov_b32 v198, 0xbfb8aa3b
    v_lshlrev_b32 v224, 16, v240
    v_and_b32 v225, 0xffff0000, v240
    v_lshlrev_b32 v226, 16, v241
    v_and_b32 v227, 0xffff0000, v241
    v_lshlrev_b32 v228, 16, v242
    v_and_b32 v229, 0xffff0000, v242
    v_lshlrev_b32 v230, 16, v243
    v_and_b32 v231, 0xffff0000, v243
    v_lshlrev_b32 v232, 16, v244
    v_and_b32 v233, 0xffff0000, v244
    v_lshlrev_b32 v234, 16, v245
    v_and_b32 v235, 0xffff0000, v245
    v_lshlrev_b32 v236, 16, v246
    v_and_b32 v237, 0xffff0000, v246
    v_lshlrev_b32_e64 v238, 16, v247
    v_and_b32 v239, 0xffff0000, v247
    v_pk_fma_f32 v[224:225], v[224:225], v[192:193], v[196:197] op_sel_hi:[1,0,0] neg_lo:[0,0,1] neg_hi:[0,0,1]
    v_pk_fma_f32 v[226:227], v[226:227], v[192:193], v[196:197] op_sel_hi:[1,0,0] neg_lo:[0,0,1] neg_hi:[0,0,1]
    v_pk_fma_f32 v[228:229], v[228:229], v[192:193], v[196:197] op_sel_hi:[1,0,0] neg_lo:[0,0,1] neg_hi:[0,0,1]
    v_pk_fma_f32 v[230:231], v[230:231], v[192:193], v[196:197] op_sel_hi:[1,0,0] neg_lo:[0,0,1] neg_hi:[0,0,1]
    v_pk_fma_f32 v[232:233], v[232:233], v[192:193], v[196:197] op_sel_hi:[1,0,0] neg_lo:[0,0,1] neg_hi:[0,0,1]
    v_pk_fma_f32 v[234:235], v[234:235], v[192:193], v[196:197] op_sel_hi:[1,0,0] neg_lo:[0,0,1] neg_hi:[0,0,1]
    v_pk_fma_f32 v[236:237], v[236:237], v[192:193], v[196:197] op_sel_hi:[1,0,0] neg_lo:[0,0,1] neg_hi:[0,0,1]
    v_pk_fma_f32 v[238:239], v[238:239], v[192:193], v[196:197] op_sel_hi:[1,0,0] neg_lo:[0,0,1] neg_hi:[0,0,1]
    v_pk_mul_f32 v[200:201], v[224:225], v[198:199] op_sel_hi:[1,0]
    v_pk_mul_f32 v[202:203], v[226:227], v[198:199] op_sel_hi:[1,0]
    v_pk_mul_f32 v[204:205], v[228:229], v[198:199] op_sel_hi:[1,0]
    v_pk_mul_f32 v[206:207], v[230:231], v[198:199] op_sel_hi:[1,0]
    v_pk_mul_f32 v[208:209], v[232:233], v[198:199] op_sel_hi:[1,0]
    v_pk_mul_f32 v[210:211], v[234:235], v[198:199] op_sel_hi:[1,0]
    v_pk_mul_f32 v[212:213], v[236:237], v[198:199] op_sel_hi:[1,0]
    v_pk_mul_f32 v[214:215], v[238:239], v[198:199] op_sel_hi:[1,0]
    v_exp_f32 v200, v200
    v_exp_f32 v201, v201
    v_exp_f32 v202, v202
    v_exp_f32 v203, v203
    v_exp_f32 v204, v204
    v_exp_f32 v205, v205
    v_exp_f32 v206, v206
    v_exp_f32 v207, v207
    v_exp_f32 v208, v208
    v_exp_f32 v209, v209
    v_exp_f32 v210, v210
    v_exp_f32 v211, v211
    v_exp_f32 v212, v212
    v_exp_f32 v213, v213
    v_exp_f32 v214, v214
    v_exp_f32 v215, v215
    v_pk_add_f32 v[200:201], v[200:201], 1.0 op_sel_hi:[1,0]
    v_pk_add_f32 v[202:203], v[202:203], 1.0 op_sel_hi:[1,0]
    v_pk_add_f32 v[204:205], v[204:205], 1.0 op_sel_hi:[1,0]
    v_pk_add_f32 v[206:207], v[206:207], 1.0 op_sel_hi:[1,0]
    v_pk_add_f32 v[208:209], v[208:209], 1.0 op_sel_hi:[1,0]
    v_pk_add_f32 v[210:211], v[210:211], 1.0 op_sel_hi:[1,0]
    v_pk_add_f32 v[212:213], v[212:213], 1.0 op_sel_hi:[1,0]
    v_pk_add_f32 v[214:215], v[214:215], 1.0 op_sel_hi:[1,0]
    v_rcp_f32 v200, v200
    v_rcp_f32 v201, v201
    v_rcp_f32 v202, v202
    v_rcp_f32 v203, v203
    v_rcp_f32 v204, v204
    v_rcp_f32 v205, v205
    v_rcp_f32 v206, v206
    v_rcp_f32 v207, v207
    v_rcp_f32 v208, v208
    v_rcp_f32 v209, v209
    v_rcp_f32 v210, v210
    v_rcp_f32 v211, v211
    v_rcp_f32 v212, v212
    v_rcp_f32 v213, v213
    v_rcp_f32 v214, v214
    v_rcp_f32 v215, v215
    v_pk_mul_f32 v[224:225], v[224:225], v[200:201]
    v_pk_mul_f32 v[226:227], v[226:227], v[202:203]
    v_pk_mul_f32 v[228:229], v[228:229], v[204:205]
    v_pk_mul_f32 v[230:231], v[230:231], v[206:207]
    v_pk_mul_f32 v[232:233], v[232:233], v[208:209]
    v_pk_mul_f32 v[234:235], v[234:235], v[210:211]
    v_pk_mul_f32 v[236:237], v[236:237], v[212:213]
    v_pk_mul_f32 v[238:239], v[238:239], v[214:215]
L_p3:
    s_nop 3
    s_mov_b32 s56, s22
    s_mov_b32 s57, s23
    s_mov_b32 s58, 4194304
    s_mov_b32 s59, 0x00020000
    s_lshr_b32 s64, s39, 2
    s_lshl_b32 s3, s34, 2
    s_add_u32 s3, s3, s38
    s_lshl_b32 s3, s3, 16
    s_lshl_b32 s28, s64, 14
    s_add_u32 s3, s3, s28
    s_add_u32 s76, s3, 4194304
    s_lshl_b32 s3, s64, 15
    v_lshlrev_b32 v2, 4, v1
    v_add_u32 v116, s3, v2
    v_xor_b32 v117, 0x8000, v116
    v_lshrrev_b32 v2, 2, v1
    v_lshlrev_b32 v2, 7, v2
    v_bfe_u32 v3, v1, 3, 2
    v_lshl_add_u32 v2, v3, 5, v2
    v_and_b32 v3, 3, v1
    v_lshl_add_u32 v2, v3, 3, v2
    s_lshl_b32 s3, s64, 16
    v_add_u32 v112, s3, v2
    v_xor_b32 v113, 32, v112
    v_xor_b32 v114, 64, v112
    v_xor_b32 v115, 96, v112
    s_add_u32 s77, s76, 0
    buffer_load_dwordx4 v[40:43], v116, s[48:51], s77 offen offset:0 sc1
    buffer_load_dwordx4 v[44:47], v117, s[48:51], s77 offen offset:0 sc1
    buffer_load_dwordx4 v[48:51], v116, s[48:51], s77 offen offset:1024 sc1
    buffer_load_dwordx4 v[52:55], v117, s[48:51], s77 offen offset:1024 sc1
    buffer_load_dwordx4 v[56:59], v116, s[48:51], s77 offen offset:2048 sc1
    buffer_load_dwordx4 v[60:63], v117, s[48:51], s77 offen offset:2048 sc1
    buffer_load_dwordx4 v[64:67], v116, s[48:51], s77 offen offset:3072 sc1
    buffer_load_dwordx4 v[68:71], v117, s[48:51], s77 offen offset:3072 sc1
    s_lshr_b32 s3, s68, 7
    s_xor_b32 s83, s3, s34
    s_or_b32 s83, s83, s39
    v_lshlrev_b32 v222, 4, v1
    ds_read_b64_tr_b16 v[80:81], v112 offset:0
    ds_read_b64_tr_b16 v[82:83], v112 offset:2048
    ds_read_b64_tr_b16 v[84:85], v113 offset:0
    ds_read_b64_tr_b16 v[86:87], v113 offset:2048
    ds_read_b64_tr_b16 v[88:89], v114 offset:0
    ds_read_b64_tr_b16 v[90:91], v114 offset:2048
    ds_read_b64_tr_b16 v[92:93], v115 offset:0
    ds_read_b64_tr_b16 v[94:95], v115 offset:2048
    s_mov_b32 s29, 0
    s_waitcnt vmcnt(6)
    v_max3_u32 v2, v40, v41, v42
    v_max3_u32 v2, v2, v43, v44
    v_max3_u32 v2, v2, v45, v46
    v_max_u32 v2, v2, v47
    v_cmp_eq_u32 vcc, -1, v2
    s_cbranch_vccnz L_r0
L_g0:
    s_waitcnt lgkmcnt(0)
    v_mfma_f32_16x16x32_bf16 v[8:11], v[80:83], v[40:43], 0
    ds_read_b64_tr_b16 v[96:97], v112 offset:4096
    ds_read_b64_tr_b16 v[98:99], v112 offset:6144
    v_mfma_f32_16x16x32_bf16 v[24:27], v[80:83], v[44:47], 0
    ds_read_b64_tr_b16 v[100:101], v113 offset:4096
    ds_read_b64_tr_b16 v[102:103], v113 offset:6144
    v_mfma_f32_16x16x32_bf16 v[12:15], v[84:87], v[40:43], 0
    ds_read_b64_tr_b16 v[104:105], v114 offset:4096
    ds_read_b64_tr_b16 v[106:107], v114 offset:6144
    v_mfma_f32_16x16x32_bf16 v[28:31], v[84:87], v[44:47], 0
    ds_read_b64_tr_b16 v[108:109], v115 offset:4096
    ds_read_b64_tr_b16 v[110:111], v115 offset:6144
    v_mfma_f32_16x16x32_bf16 v[16:19], v[88:91], v[40:43], 0
    s_add_u32 s77, s76, 4096
    buffer_load_dwordx4 v[72:75], v116, s[48:51], s77 offen offset:0 sc1
    buffer_load_dwordx4 v[76:79], v117, s[48:51], s77 offen offset:0 sc1
    v_mfma_f32_16x16x32_bf16 v[32:35], v[88:91], v[44:47], 0
    s_waitcnt vmcnt(6)
    v_max3_u32 v2, v48, v49, v50
    v_mfma_f32_16x16x32_bf16 v[20:23], v[92:95], v[40:43], 0
    v_max3_u32 v2, v2, v51, v52
    v_max3_u32 v2, v2, v53, v54
    v_mfma_f32_16x16x32_bf16 v[36:39], v[92:95], v[44:47], 0
    v_max_u32 v2, v2, v55
    v_cmp_eq_u32_e64 vcc, -1, v2
    s_cbranch_vccnz L_r1
L_g1:
    s_waitcnt lgkmcnt(0)
    v_mfma_f32_16x16x32_bf16 v[8:11], v[96:99], v[48:51], v[8:11]
    ds_read_b64_tr_b16 v[80:81], v112 offset:8192
    ds_read_b64_tr_b16 v[82:83], v112 offset:10240
    v_mfma_f32_16x16x32_bf16 v[24:27], v[96:99], v[52:55], v[24:27]
    ds_read_b64_tr_b16 v[84:85], v113 offset:8192
    ds_read_b64_tr_b16 v[86:87], v113 offset:10240
    v_mfma_f32_16x16x32_bf16 v[12:15], v[100:103], v[48:51], v[12:15]
    ds_read_b64_tr_b16 v[88:89], v114 offset:8192
    ds_read_b64_tr_b16 v[90:91], v114 offset:10240
    v_mfma_f32_16x16x32_bf16 v[28:31], v[100:103], v[52:55], v[28:31]
    ds_read_b64_tr_b16 v[92:93], v115 offset:8192
    ds_read_b64_tr_b16 v[94:95], v115 offset:10240
    v_mfma_f32_16x16x32_bf16 v[16:19], v[104:107], v[48:51], v[16:19]
    buffer_load_dwordx4 v[40:43], v116, s[48:51], s77 offen offset:1024 sc1
    buffer_load_dwordx4 v[44:47], v117, s[48:51], s77 offen offset:1024 sc1
    v_mfma_f32_16x16x32_bf16 v[32:35], v[104:107], v[52:55], v[32:35]
    s_waitcnt vmcnt(6)
    v_max3_u32 v2, v56, v57, v58
    v_mfma_f32_16x16x32_bf16 v[20:23], v[108:111], v[48:51], v[20:23]
    v_max3_u32 v2, v2, v59, v60
    v_max3_u32 v2, v2, v61, v62
    v_mfma_f32_16x16x32_bf16 v[36:39], v[108:111], v[52:55], v[36:39]
    v_max_u32 v2, v2, v63
    v_cmp_eq_u32_e64 vcc, -1, v2
    s_cbranch_vccnz L_r2
L_g2:
    s_waitcnt lgkmcnt(0)
    v_mfma_f32_16x16x32_bf16 v[8:11], v[80:83], v[56:59], v[8:11]
    ds_read_b64_tr_b16 v[96:97], v112 offset:12288
    ds_read_b64_tr_b16 v[98:99], v112 offset:14336
    v_mfma_f32_16x16x32_bf16 v[24:27], v[80:83], v[60:63], v[24:27]
    ds_read_b64_tr_b16 v[100:101], v113 offset:12288
    ds_read_b64_tr_b16 v[102:103], v113 offset:14336
    v_mfma_f32_16x16x32_bf16 v[12:15], v[84:87], v[56:59], v[12:15]
    ds_read_b64_tr_b16 v[104:105], v114 offset:12288
    ds_read_b64_tr_b16 v[106:107], v114 offset:14336
    v_mfma_f32_16x16x32_bf16 v[28:31], v[84:87], v[60:63], v[28:31]
    ds_read_b64_tr_b16 v[108:109], v115 offset:12288
    ds_read_b64_tr_b16 v[110:111], v115 offset:14336
    v_mfma_f32_16x16x32_bf16 v[16:19], v[88:91], v[56:59], v[16:19]
    buffer_load_dwordx4 v[48:51], v116, s[48:51], s77 offen offset:2048 sc1
    buffer_load_dwordx4 v[52:55], v117, s[48:51], s77 offen offset:2048 sc1
    v_mfma_f32_16x16x32_bf16 v[32:35], v[88:91], v[60:63], v[32:35]
    s_waitcnt vmcnt(6)
    v_max3_u32 v2, v64, v65, v66
    v_mfma_f32_16x16x32_bf16 v[20:23], v[92:95], v[56:59], v[20:23]
    v_max3_u32 v2, v2, v67, v68
    v_max3_u32 v2, v2, v69, v70
    v_mfma_f32_16x16x32_bf16 v[36:39], v[92:95], v[60:63], v[36:39]
    v_max_u32 v2, v2, v71
    v_cmp_eq_u32 vcc, -1, v2
    s_cbranch_vccnz L_r3
L_g3:
    s_waitcnt lgkmcnt(0)
    s_cmp_eq_u32 s64, 0
    s_cbranch_scc1 L_nb3
    s_barrier
L_nb3:
    v_mfma_f32_16x16x32_bf16 v[8:11], v[96:99], v[64:67], v[8:11]
    ds_read_b64_tr_b16 v[80:81], v112 offset:16384
    ds_read_b64_tr_b16 v[82:83], v112 offset:18432
    v_mfma_f32_16x16x32_bf16 v[24:27], v[96:99], v[68:71], v[24:27]
    ds_read_b64_tr_b16 v[84:85], v113 offset:16384
    ds_read_b64_tr_b16 v[86:87], v113 offset:18432
    v_mfma_f32_16x16x32_bf16 v[12:15], v[100:103], v[64:67], v[12:15]
    ds_read_b64_tr_b16 v[88:89], v114 offset:16384
    ds_read_b64_tr_b16 v[90:91], v114 offset:18432
    v_mfma_f32_16x16x32_bf16 v[28:31], v[100:103], v[68:71], v[28:31]
    ds_read_b64_tr_b16 v[92:93], v115 offset:16384
    ds_read_b64_tr_b16 v[94:95], v115 offset:18432
    v_mfma_f32_16x16x32_bf16 v[16:19], v[104:107], v[64:67], v[16:19]
    buffer_load_dwordx4 v[56:59], v116, s[48:51], s77 offen offset:3072 sc1
    buffer_load_dwordx4 v[60:63], v117, s[48:51], s77 offen offset:3072 sc1
    v_mfma_f32_16x16x32_bf16 v[32:35], v[104:107], v[68:71], v[32:35]
    s_waitcnt vmcnt(6)
    v_max3_u32 v2, v72, v73, v74
    v_mfma_f32_16x16x32_bf16 v[20:23], v[108:111], v[64:67], v[20:23]
    v_max3_u32 v2, v2, v75, v76
    v_max3_u32 v2, v2, v77, v78
    v_mfma_f32_16x16x32_bf16 v[36:39], v[108:111], v[68:71], v[36:39]
    v_max_u32 v2, v2, v79
    v_cmp_eq_u32_e64 vcc, -1, v2
    s_cbranch_vccnz L_r4
L_g4:
    s_waitcnt lgkmcnt(0)
    v_mfma_f32_16x16x32_bf16 v[8:11], v[80:83], v[72:75], v[8:11]
    ds_read_b64_tr_b16 v[96:97], v112 offset:20480
    ds_read_b64_tr_b16 v[98:99], v112 offset:22528
    v_mfma_f32_16x16x32_bf16 v[24:27], v[80:83], v[76:79], v[24:27]
    ds_read_b64_tr_b16 v[100:101], v113 offset:20480
    ds_read_b64_tr_b16 v[102:103], v113 offset:22528
    v_mfma_f32_16x16x32_bf16 v[12:15], v[84:87], v[72:75], v[12:15]
    ds_read_b64_tr_b16 v[104:105], v114 offset:20480
    ds_read_b64_tr_b16 v[106:107], v114 offset:22528
    v_mfma_f32_16x16x32_bf16 v[28:31], v[84:87], v[76:79], v[28:31]
    ds_read_b64_tr_b16 v[108:109], v115 offset:20480
    ds_read_b64_tr_b16 v[110:111], v115 offset:22528
    v_mfma_f32_16x16x32_bf16 v[16:19], v[88:91], v[72:75], v[16:19]
    s_add_u32 s77, s76, 8192
    buffer_load_dwordx4 v[64:67], v116, s[48:51], s77 offen offset:0 sc1
    buffer_load_dwordx4 v[68:71], v117, s[48:51], s77 offen offset:0 sc1
    v_mfma_f32_16x16x32_bf16 v[32:35], v[88:91], v[76:79], v[32:35]
    s_waitcnt vmcnt(6)
    v_max3_u32 v2, v40, v41, v42
    v_mfma_f32_16x16x32_bf16 v[20:23], v[92:95], v[72:75], v[20:23]
    v_max3_u32 v2, v2, v43, v44
    v_max3_u32 v2, v2, v45, v46
    v_mfma_f32_16x16x32_bf16 v[36:39], v[92:95], v[76:79], v[36:39]
    v_max_u32 v2, v2, v47
    v_cmp_eq_u32_e64 vcc, -1, v2
    s_cbranch_vccnz L_r5
L_g5:
    s_waitcnt lgkmcnt(0)
    v_mfma_f32_16x16x32_bf16 v[8:11], v[96:99], v[40:43], v[8:11]
    ds_read_b64_tr_b16 v[80:81], v112 offset:24576
    ds_read_b64_tr_b16 v[82:83], v112 offset:26624
    v_mfma_f32_16x16x32_bf16 v[24:27], v[96:99], v[44:47], v[24:27]
    ds_read_b64_tr_b16 v[84:85], v113 offset:24576
    ds_read_b64_tr_b16 v[86:87], v113 offset:26624
    v_mfma_f32_16x16x32_bf16 v[12:15], v[100:103], v[40:43], v[12:15]
    ds_read_b64_tr_b16 v[88:89], v114 offset:24576
    ds_read_b64_tr_b16 v[90:91], v114 offset:26624
    v_mfma_f32_16x16x32_bf16 v[28:31], v[100:103], v[44:47], v[28:31]
    ds_read_b64_tr_b16 v[92:93], v115 offset:24576
    ds_read_b64_tr_b16 v[94:95], v115 offset:26624
    v_mfma_f32_16x16x32_bf16 v[16:19], v[104:107], v[40:43], v[16:19]
    buffer_load_dwordx4 v[72:75], v116, s[48:51], s77 offen offset:1024 sc1
    buffer_load_dwordx4 v[76:79], v117, s[48:51], s77 offen offset:1024 sc1
    v_mfma_f32_16x16x32_bf16 v[32:35], v[104:107], v[44:47], v[32:35]
    s_waitcnt vmcnt(6)
    v_max3_u32 v2, v48, v49, v50
    v_mfma_f32_16x16x32_bf16 v[20:23], v[108:111], v[40:43], v[20:23]
    v_max3_u32 v2, v2, v51, v52
    v_max3_u32 v2, v2, v53, v54
    v_mfma_f32_16x16x32_bf16 v[36:39], v[108:111], v[44:47], v[36:39]
    v_max_u32 v2, v2, v55
    v_cmp_eq_u32_e64 vcc, -1, v2
    s_cbranch_vccnz L_r6
L_g6:
    s_waitcnt lgkmcnt(0)
    v_mfma_f32_16x16x32_bf16 v[8:11], v[80:83], v[48:51], v[8:11]
    ds_read_b64_tr_b16 v[96:97], v112 offset:28672
    ds_read_b64_tr_b16 v[98:99], v112 offset:30720
    v_mfma_f32_16x16x32_bf16 v[24:27], v[80:83], v[52:55], v[24:27]
    ds_read_b64_tr_b16 v[100:101], v113 offset:28672
    ds_read_b64_tr_b16 v[102:103], v113 offset:30720
    v_mfma_f32_16x16x32_bf16 v[12:15], v[84:87], v[48:51], v[12:15]
    ds_read_b64_tr_b16 v[104:105], v114 offset:28672
    ds_read_b64_tr_b16 v[106:107], v114 offset:30720
    v_mfma_f32_16x16x32_bf16 v[28:31], v[84:87], v[52:55], v[28:31]
    ds_read_b64_tr_b16 v[108:109], v115 offset:28672
    ds_read_b64_tr_b16 v[110:111], v115 offset:30720
    v_mfma_f32_16x16x32_bf16 v[16:19], v[88:91], v[48:51], v[16:19]
    buffer_load_dwordx4 v[40:43], v116, s[48:51], s77 offen offset:2048 sc1
    buffer_load_dwordx4 v[44:47], v117, s[48:51], s77 offen offset:2048 sc1
    v_mfma_f32_16x16x32_bf16 v[32:35], v[88:91], v[52:55], v[32:35]
    s_waitcnt vmcnt(6)
    v_max3_u32 v2, v56, v57, v58
    v_mfma_f32_16x16x32_bf16 v[20:23], v[92:95], v[48:51], v[20:23]
    v_max3_u32 v2, v2, v59, v60
    v_max3_u32 v2, v2, v61, v62
    v_mfma_f32_16x16x32_bf16 v[36:39], v[92:95], v[52:55], v[36:39]
    v_max_u32 v2, v2, v63
    v_cmp_eq_u32 vcc, -1, v2
    s_cbranch_vccnz L_r7
L_g7:
    s_waitcnt lgkmcnt(0)
    s_cmp_eq_u32 s64, 1
    s_cbranch_scc1 L_nb7
    s_barrier
L_nb7:
    v_mfma_f32_16x16x32_bf16 v[8:11], v[96:99], v[56:59], v[8:11]
    ds_read_b64_tr_b16 v[80:81], v112 offset:32768
    ds_read_b64_tr_b16 v[82:83], v112 offset:34816
    v_mfma_f32_16x16x32_bf16 v[24:27], v[96:99], v[60:63], v[24:27]
    ds_read_b64_tr_b16 v[84:85], v113 offset:32768
    ds_read_b64_tr_b16 v[86:87], v113 offset:34816
    v_mfma_f32_16x16x32_bf16 v[12:15], v[100:103], v[56:59], v[12:15]
    ds_read_b64_tr_b16 v[88:89], v114 offset:32768
    ds_read_b64_tr_b16 v[90:91], v114 offset:34816
    v_mfma_f32_16x16x32_bf16 v[28:31], v[100:103], v[60:63], v[28:31]
    ds_read_b64_tr_b16 v[92:93], v115 offset:32768
    ds_read_b64_tr_b16 v[94:95], v115 offset:34816
    v_mfma_f32_16x16x32_bf16 v[16:19], v[104:107], v[56:59], v[16:19]
    buffer_load_dwordx4 v[48:51], v116, s[48:51], s77 offen offset:3072 sc1
    buffer_load_dwordx4 v[52:55], v117, s[48:51], s77 offen offset:3072 sc1
    v_mfma_f32_16x16x32_bf16 v[32:35], v[104:107], v[60:63], v[32:35]
    s_waitcnt vmcnt(6)
    v_max3_u32 v2, v64, v65, v66
    v_mfma_f32_16x16x32_bf16 v[20:23], v[108:111], v[56:59], v[20:23]
    v_max3_u32 v2, v2, v67, v68
    v_max3_u32 v2, v2, v69, v70
    v_mfma_f32_16x16x32_bf16 v[36:39], v[108:111], v[60:63], v[36:39]
    v_max_u32 v2, v2, v71
    v_cmp_eq_u32_e64 vcc, -1, v2
    s_cbranch_vccnz L_r8
L_g8:
    s_waitcnt lgkmcnt(0)
    v_mfma_f32_16x16x32_bf16 v[8:11], v[80:83], v[64:67], v[8:11]
    ds_read_b64_tr_b16 v[96:97], v112 offset:36864
    ds_read_b64_tr_b16 v[98:99], v112 offset:38912
    v_mfma_f32_16x16x32_bf16 v[24:27], v[80:83], v[68:71], v[24:27]
    ds_read_b64_tr_b16 v[100:101], v113 offset:36864
    ds_read_b64_tr_b16 v[102:103], v113 offset:38912
    v_mfma_f32_16x16x32_bf16 v[12:15], v[84:87], v[64:67], v[12:15]
    ds_read_b64_tr_b16 v[104:105], v114 offset:36864
    ds_read_b64_tr_b16 v[106:107], v114 offset:38912
    v_mfma_f32_16x16x32_bf16 v[28:31], v[84:87], v[68:71], v[28:31]
    ds_read_b64_tr_b16 v[108:109], v115 offset:36864
    ds_read_b64_tr_b16 v[110:111], v115 offset:38912
    v_mfma_f32_16x16x32_bf16 v[16:19], v[88:91], v[64:67], v[16:19]
    s_add_u32 s77, s76, 12288
    buffer_load_dwordx4 v[56:59], v116, s[48:51], s77 offen offset:0 sc1
    buffer_load_dwordx4 v[60:63], v117, s[48:51], s77 offen offset:0 sc1
    v_mfma_f32_16x16x32_bf16 v[32:35], v[88:91], v[68:71], v[32:35]
    s_waitcnt vmcnt(6)
    v_max3_u32 v2, v72, v73, v74
    v_mfma_f32_16x16x32_bf16 v[20:23], v[92:95], v[64:67], v[20:23]
    v_max3_u32 v2, v2, v75, v76
    v_max3_u32 v2, v2, v77, v78
    v_mfma_f32_16x16x32_bf16 v[36:39], v[92:95], v[68:71], v[36:39]
    v_max_u32 v2, v2, v79
    v_cmp_eq_u32_e64 vcc, -1, v2
    s_cbranch_vccnz L_r9
L_g9:
    s_waitcnt lgkmcnt(0)
    v_mfma_f32_16x16x32_bf16 v[8:11], v[96:99], v[72:75], v[8:11]
    ds_read_b64_tr_b16 v[80:81], v112 offset:40960
    ds_read_b64_tr_b16 v[82:83], v112 offset:43008
    v_mfma_f32_16x16x32_bf16 v[24:27], v[96:99], v[76:79], v[24:27]
    ds_read_b64_tr_b16 v[84:85], v113 offset:40960
    ds_read_b64_tr_b16 v[86:87], v113 offset:43008
    v_mfma_f32_16x16x32_bf16 v[12:15], v[100:103], v[72:75], v[12:15]
    ds_read_b64_tr_b16 v[88:89], v114 offset:40960
    ds_read_b64_tr_b16 v[90:91], v114 offset:43008
    v_mfma_f32_16x16x32_bf16 v[28:31], v[100:103], v[76:79], v[28:31]
    ds_read_b64_tr_b16 v[92:93], v115 offset:40960
    ds_read_b64_tr_b16 v[94:95], v115 offset:43008
    v_mfma_f32_16x16x32_bf16 v[16:19], v[104:107], v[72:75], v[16:19]
    buffer_load_dwordx4 v[64:67], v116, s[48:51], s77 offen offset:1024 sc1
    buffer_load_dwordx4 v[68:71], v117, s[48:51], s77 offen offset:1024 sc1
    v_mfma_f32_16x16x32_bf16 v[32:35], v[104:107], v[76:79], v[32:35]
    s_waitcnt vmcnt(6)
    v_max3_u32 v2, v40, v41, v42
    v_mfma_f32_16x16x32_bf16 v[20:23], v[108:111], v[72:75], v[20:23]
    v_max3_u32 v2, v2, v43, v44
    v_max3_u32 v2, v2, v45, v46
    v_mfma_f32_16x16x32_bf16 v[36:39], v[108:111], v[76:79], v[36:39]
    v_max_u32 v2, v2, v47
    v_cmp_eq_u32_e64 vcc, -1, v2
    s_cbranch_vccnz L_r10
L_g10:
    s_waitcnt lgkmcnt(0)
    v_mfma_f32_16x16x32_bf16 v[8:11], v[80:83], v[40:43], v[8:11]
    ds_read_b64_tr_b16 v[96:97], v112 offset:45056
    ds_read_b64_tr_b16 v[98:99], v112 offset:47104
    v_mfma_f32_16x16x32_bf16 v[24:27], v[80:83], v[44:47], v[24:27]
    ds_read_b64_tr_b16 v[100:101], v113 offset:45056
    ds_read_b64_tr_b16 v[102:103], v113 offset:47104
    v_mfma_f32_16x16x32_bf16 v[12:15], v[84:87], v[40:43], v[12:15]
    ds_read_b64_tr_b16 v[104:105], v114 offset:45056
    ds_read_b64_tr_b16 v[106:107], v114 offset:47104
    v_mfma_f32_16x16x32_bf16 v[28:31], v[84:87], v[44:47], v[28:31]
    ds_read_b64_tr_b16 v[108:109], v115 offset:45056
    ds_read_b64_tr_b16 v[110:111], v115 offset:47104
    v_mfma_f32_16x16x32_bf16 v[16:19], v[88:91], v[40:43], v[16:19]
    buffer_load_dwordx4 v[72:75], v116, s[48:51], s77 offen offset:2048 sc1
    buffer_load_dwordx4 v[76:79], v117, s[48:51], s77 offen offset:2048 sc1
    v_mfma_f32_16x16x32_bf16 v[32:35], v[88:91], v[44:47], v[32:35]
    s_waitcnt vmcnt(6)
    v_max3_u32 v2, v48, v49, v50
    v_mfma_f32_16x16x32_bf16 v[20:23], v[92:95], v[40:43], v[20:23]
    v_max3_u32 v2, v2, v51, v52
    v_max3_u32 v2, v2, v53, v54
    v_mfma_f32_16x16x32_bf16 v[36:39], v[92:95], v[44:47], v[36:39]
    v_max_u32 v2, v2, v55
    v_cmp_eq_u32_e64 vcc, -1, v2
    s_cbranch_vccnz L_r11
L_g11:
    s_waitcnt lgkmcnt(0)
    v_mfma_f32_16x16x32_bf16 v[8:11], v[96:99], v[48:51], v[8:11]
    ds_read_b64_tr_b16 v[80:81], v112 offset:49152
    ds_read_b64_tr_b16 v[82:83], v112 offset:51200
    v_mfma_f32_16x16x32_bf16 v[24:27], v[96:99], v[52:55], v[24:27]
    ds_read_b64_tr_b16 v[84:85], v113 offset:49152
    ds_read_b64_tr_b16 v[86:87], v113 offset:51200
    v_mfma_f32_16x16x32_bf16 v[12:15], v[100:103], v[48:51], v[12:15]
    ds_read_b64_tr_b16 v[88:89], v114 offset:49152
    ds_read_b64_tr_b16 v[90:91], v114 offset:51200
    v_mfma_f32_16x16x32_bf16 v[28:31], v[100:103], v[52:55], v[28:31]
    ds_read_b64_tr_b16 v[92:93], v115 offset:49152
    ds_read_b64_tr_b16 v[94:95], v115 offset:51200
    v_mfma_f32_16x16x32_bf16 v[16:19], v[104:107], v[48:51], v[16:19]
    buffer_load_dwordx4 v[40:43], v116, s[48:51], s77 offen offset:3072 sc1
    buffer_load_dwordx4 v[44:47], v117, s[48:51], s77 offen offset:3072 sc1
    v_mfma_f32_16x16x32_bf16 v[32:35], v[104:107], v[52:55], v[32:35]
    s_waitcnt vmcnt(6)
    v_max3_u32 v2, v56, v57, v58
    v_mfma_f32_16x16x32_bf16 v[20:23], v[108:111], v[48:51], v[20:23]
    v_max3_u32 v2, v2, v59, v60
    v_max3_u32 v2, v2, v61, v62
    v_mfma_f32_16x16x32_bf16 v[36:39], v[108:111], v[52:55], v[36:39]
    v_max_u32 v2, v2, v63
    v_cmp_eq_u32_e64 vcc, -1, v2
    s_cbranch_vccnz L_r12
L_g12:
    s_waitcnt lgkmcnt(0)
    v_mfma_f32_16x16x32_bf16 v[8:11], v[80:83], v[56:59], v[8:11]
    ds_read_b64_tr_b16 v[96:97], v112 offset:53248
    ds_read_b64_tr_b16 v[98:99], v112 offset:55296
    v_mfma_f32_16x16x32_bf16 v[24:27], v[80:83], v[60:63], v[24:27]
    ds_read_b64_tr_b16 v[100:101], v113 offset:53248
    ds_read_b64_tr_b16 v[102:103], v113 offset:55296
    v_mfma_f32_16x16x32_bf16 v[12:15], v[84:87], v[56:59], v[12:15]
    ds_read_b64_tr_b16 v[104:105], v114 offset:53248
    ds_read_b64_tr_b16 v[106:107], v114 offset:55296
    v_mfma_f32_16x16x32_bf16 v[28:31], v[84:87], v[60:63], v[28:31]
    ds_read_b64_tr_b16 v[108:109], v115 offset:53248
    ds_read_b64_tr_b16 v[110:111], v115 offset:55296
    v_mfma_f32_16x16x32_bf16 v[16:19], v[88:91], v[56:59], v[16:19]
    v_mfma_f32_16x16x32_bf16 v[32:35], v[88:91], v[60:63], v[32:35]
    s_waitcnt vmcnt(4)
    v_max3_u32 v2, v64, v65, v66
    v_mfma_f32_16x16x32_bf16 v[20:23], v[92:95], v[56:59], v[20:23]
    v_max3_u32 v2, v2, v67, v68
    v_max3_u32 v2, v2, v69, v70
    v_mfma_f32_16x16x32_bf16 v[36:39], v[92:95], v[60:63], v[36:39]
    v_max_u32 v2, v2, v71
    v_cmp_eq_u32_e64 vcc, -1, v2
    s_cbranch_vccnz L_r13
L_g13:
    s_waitcnt lgkmcnt(0)
    v_mfma_f32_16x16x32_bf16 v[8:11], v[96:99], v[64:67], v[8:11]
    ds_read_b64_tr_b16 v[80:81], v112 offset:57344
    ds_read_b64_tr_b16 v[82:83], v112 offset:59392
    v_mfma_f32_16x16x32_bf16 v[24:27], v[96:99], v[68:71], v[24:27]
    ds_read_b64_tr_b16 v[84:85], v113 offset:57344
    ds_read_b64_tr_b16 v[86:87], v113 offset:59392
    v_mfma_f32_16x16x32_bf16 v[12:15], v[100:103], v[64:67], v[12:15]
    ds_read_b64_tr_b16 v[88:89], v114 offset:57344
    ds_read_b64_tr_b16 v[90:91], v114 offset:59392
    v_mfma_f32_16x16x32_bf16 v[28:31], v[100:103], v[68:71], v[28:31]
    ds_read_b64_tr_b16 v[92:93], v115 offset:57344
    ds_read_b64_tr_b16 v[94:95], v115 offset:59392
    v_mfma_f32_16x16x32_bf16 v[16:19], v[104:107], v[64:67], v[16:19]
    v_mfma_f32_16x16x32_bf16 v[32:35], v[104:107], v[68:71], v[32:35]
    s_waitcnt vmcnt(2)
    v_max3_u32 v2, v72, v73, v74
    v_mfma_f32_16x16x32_bf16 v[20:23], v[108:111], v[64:67], v[20:23]
    v_max3_u32 v2, v2, v75, v76
    v_max3_u32 v2, v2, v77, v78
    v_mfma_f32_16x16x32_bf16 v[36:39], v[108:111], v[68:71], v[36:39]
    v_max_u32 v2, v2, v79
    v_cmp_eq_u32_e64 vcc, -1, v2
    s_cbranch_vccnz L_r14
L_g14:
    s_cmp_eq_u32 s83, 0
    s_cbranch_scc1 L_fx1
L_fx1r:
    s_waitcnt lgkmcnt(0)
    v_mfma_f32_16x16x32_bf16 v[8:11], v[80:83], v[72:75], v[8:11]
    ds_read_b64_tr_b16 v[96:97], v112 offset:61440
    ds_read_b64_tr_b16 v[98:99], v112 offset:63488
    v_mfma_f32_16x16x32_bf16 v[24:27], v[80:83], v[76:79], v[24:27]
    ds_read_b64_tr_b16 v[100:101], v113 offset:61440
    ds_read_b64_tr_b16 v[102:103], v113 offset:63488
    v_mfma_f32_16x16x32_bf16 v[12:15], v[84:87], v[72:75], v[12:15]
    ds_read_b64_tr_b16 v[104:105], v114 offset:61440
    ds_read_b64_tr_b16 v[106:107], v114 offset:63488
    v_mfma_f32_16x16x32_bf16 v[28:31], v[84:87], v[76:79], v[28:31]
    ds_read_b64_tr_b16 v[108:109], v115 offset:61440
    ds_read_b64_tr_b16 v[110:111], v115 offset:63488
    v_mfma_f32_16x16x32_bf16 v[16:19], v[88:91], v[72:75], v[16:19]
    v_mfma_f32_16x16x32_bf16 v[32:35], v[88:91], v[76:79], v[32:35]
    s_waitcnt vmcnt(0)
    v_max3_u32 v2, v40, v41, v42
    v_mfma_f32_16x16x32_bf16 v[20:23], v[92:95], v[72:75], v[20:23]
    v_max3_u32 v2, v2, v43, v44
    v_max3_u32 v2, v2, v45, v46
    v_mfma_f32_16x16x32_bf16 v[36:39], v[92:95], v[76:79], v[36:39]
    v_max_u32 v2, v2, v47
    v_cmp_eq_u32_e64 vcc, -1, v2
    s_cbranch_vccnz L_r15
L_g15:
    s_waitcnt lgkmcnt(0)
    v_mfma_f32_16x16x32_bf16 v[8:11], v[96:99], v[40:43], v[8:11]
    v_mfma_f32_16x16x32_bf16 v[24:27], v[96:99], v[44:47], v[24:27]
    v_mfma_f32_16x16x32_bf16 v[12:15], v[100:103], v[40:43], v[12:15]
    v_mfma_f32_16x16x32_bf16 v[28:31], v[100:103], v[44:47], v[28:31]
    v_mfma_f32_16x16x32_bf16 v[16:19], v[104:107], v[40:43], v[16:19]
    v_mfma_f32_16x16x32_bf16 v[32:35], v[104:107], v[44:47], v[32:35]
    v_mfma_f32_16x16x32_bf16 v[20:23], v[108:111], v[40:43], v[20:23]
    v_mfma_f32_16x16x32_bf16 v[36:39], v[108:111], v[44:47], v[36:39]
    s_cmp_eq_u32 s83, 0
    s_cbranch_scc1 L_fx2
L_fx2r:
    s_lshl_b32 s3, s39, 12
    s_add_u32 s3, s3, 131072
    v_lshlrev_b32 v2, 4, v1
    v_add_u32_e64 v2, s3, v2
    v_xor_b32 v3, 0x4000, v2
    s_xor_b32 s28, s3, 0x4000
    ds_write_b128 v2, v[24:27] offset:0
    ds_write_b128 v2, v[28:31] offset:1024
    ds_write_b128 v2, v[32:35] offset:2048
    ds_write_b128 v2, v[36:39] offset:3072
    v_lshlrev_b32 v40, 16, v240
    v_and_b32 v41, 0xffff0000, v240
    v_lshlrev_b32 v42, 16, v241
    v_and_b32 v43, 0xffff0000, v241
    v_lshlrev_b32 v44, 16, v242
    v_and_b32 v45, 0xffff0000, v242
    v_lshlrev_b32 v46, 16, v243
    v_and_b32 v47, 0xffff0000, v243
    v_lshlrev_b32 v48, 16, v244
    v_and_b32 v49, 0xffff0000, v244
    v_lshlrev_b32 v50, 16, v245
    v_and_b32 v51, 0xffff0000, v245
    v_lshlrev_b32 v52, 16, v246
    v_and_b32 v53, 0xffff0000, v246
    v_lshlrev_b32 v54, 16, v247
    v_and_b32 v55, 0xffff0000, v247
    v_and_b32 v4, 15, v1
    v_lshrrev_b32 v5, 4, v1
    v_lshlrev_b32 v6, 1, v4
    v_and_b32 v6, 14, v6
    v_xor_b32_e64 v5, v5, v6
    v_lshl_add_u32 v4, v4, 7, s28
    v_lshl_add_u32 v4, v5, 3, v4
    v_lshrrev_b32 v5, 3, v1
    v_and_b32 v6, 7, v1
    v_xor_b32_e64 v7, v6, v5
    v_lshl_add_u32 v7, v7, 4, s28
    v_lshl_add_u32 v7, v5, 7, v7
    s_lshl_b32 s3, s34, 7
    s_add_u32 s3, s3, s69
    v_add_u32 v5, s3, v5
    v_lshlrev_b32 v5, 11, v5
    v_lshl_add_u32 v5, v6, 4, v5
    s_lshl_b32 s3, s35, 7
    s_add_u32 s28, s3, 16384
    s_lshl_b32 s29, s34, 7
    s_add_u32 s29, s29, s69
    s_andn2_b32 s77, s68, 15
    s_cmp_lg_u32 s29, s77
    s_waitcnt lgkmcnt(0)
    s_barrier
    s_cbranch_scc1 L_nov
    v_and_b32 v2, 48, v1
    s_and_b32 s29, s68, 15
    s_lshl_b32 exec_lo, 0x00010001, s29
    s_mov_b32 exec_hi, exec_lo
    ds_read_b128 v[224:227], v2 offset:0
    ds_read_b128 v[228:231], v2 offset:64
    ds_read_b128 v[232:235], v2 offset:128
    ds_read_b128 v[236:239], v2 offset:192
    s_mov_b64 exec, -1
L_nov:
    ds_read_b128 v[24:27], v3 offset:0
    ds_read_b128 v[28:31], v3 offset:1024
    ds_read_b128 v[32:35], v3 offset:2048
    ds_read_b128 v[36:39], v3 offset:3072
    s_waitcnt lgkmcnt(3)
    s_nop 0
    v_pk_add_f32 v[8:9], v[8:9], v[24:25]
    v_pk_add_f32 v[10:11], v[10:11], v[26:27]
    v_pk_fma_f32 v[40:41], v[8:9], v[224:225], v[40:41]
    v_pk_fma_f32 v[42:43], v[10:11], v[226:227], v[42:43]
    v_cvt_pk_bf16_f32 v8, v40, v41
    v_cvt_pk_bf16_f32 v9, v42, v43
    s_waitcnt lgkmcnt(2)
    s_nop 0
    v_pk_add_f32 v[12:13], v[12:13], v[28:29]
    v_pk_add_f32 v[14:15], v[14:15], v[30:31]
    v_pk_fma_f32 v[44:45], v[12:13], v[228:229], v[44:45]
    v_pk_fma_f32 v[46:47], v[14:15], v[230:231], v[46:47]
    v_cvt_pk_bf16_f32 v10, v44, v45
    v_cvt_pk_bf16_f32 v11, v46, v47
    s_waitcnt lgkmcnt(1)
    s_nop 0
    v_pk_add_f32 v[16:17], v[16:17], v[32:33]
    v_pk_add_f32 v[18:19], v[18:19], v[34:35]
    v_pk_fma_f32 v[48:49], v[16:17], v[232:233], v[48:49]
    v_pk_fma_f32 v[50:51], v[18:19], v[234:235], v[50:51]
    v_cvt_pk_bf16_f32 v12, v48, v49
    v_cvt_pk_bf16_f32 v13, v50, v51
    s_waitcnt lgkmcnt(0)
    s_nop 0
    v_pk_add_f32 v[20:21], v[20:21], v[36:37]
    v_pk_add_f32 v[22:23], v[22:23], v[38:39]
    v_pk_fma_f32 v[52:53], v[20:21], v[236:237], v[52:53]
    v_pk_fma_f32 v[54:55], v[22:23], v[238:239], v[54:55]
    v_cvt_pk_bf16_f32 v14, v52, v53
    v_cvt_pk_bf16_f32 v15, v54, v55
    ds_write_b64 v4, v[8:9]
    v_xor_b32 v6, 32, v4
    ds_write_b64 v6, v[10:11]
    v_xor_b32 v6, 64, v4
    ds_write_b64 v6, v[12:13]
    v_xor_b32 v6, 96, v4
    ds_write_b64 v6, v[14:15]
    ds_read_b128 v[24:27], v7 offset:0
    ds_read_b128 v[28:31], v7 offset:1024
    s_waitcnt lgkmcnt(1)
    buffer_store_dwordx4 v[24:27], v5, s[56:59], s3 offen sc1
    s_waitcnt lgkmcnt(0)
    buffer_store_dwordx4 v[28:31], v5, s[56:59], s28 offen sc1
L_done:
    s_endpgm
L_fx1:
    s_lshl_b32 s78, s35, 14
    s_add_u32 s78, s78, 1413120
    v_and_b32 v2, 15, v1
    v_lshrrev_b32 v3, 4, v1
    v_lshl_add_u32 v193, v2, 2, v3
    v_and_b32 v2, 7, v193
    v_lshrrev_b32 v193, 3, v193
    v_lshl_add_u32 v193, v2, 3, v193
    v_lshlrev_b32 v2, 1, v193
    s_lshl_b32 s3, s68, 11
    s_lshl_b32 s28, s35, 7
    s_add_u32 s3, s3, s28
    buffer_load_ushort v194, v2, s[40:43], s3 offen
    s_add_u32 s3, s78, 0
    s_nop 0
    buffer_load_dwordx4 v[128:131], v222, s[48:51], s3 offen offset:0 sc1
    buffer_load_dwordx4 v[132:135], v222, s[48:51], s3 offen offset:1024 sc1
    buffer_load_dwordx4 v[136:139], v222, s[48:51], s3 offen offset:2048 sc1
    buffer_load_dwordx4 v[140:143], v222, s[48:51], s3 offen offset:3072 sc1
    s_add_u32 s3, s78, 4096
    buffer_load_dwordx4 v[144:147], v222, s[48:51], s3 offen offset:0 sc1
    buffer_load_dwordx4 v[148:151], v222, s[48:51], s3 offen offset:1024 sc1
    buffer_load_dwordx4 v[152:155], v222, s[48:51], s3 offen offset:2048 sc1
    buffer_load_dwordx4 v[156:159], v222, s[48:51], s3 offen offset:3072 sc1
    s_add_u32 s3, s78, 8192
    buffer_load_dwordx4 v[160:163], v222, s[48:51], s3 offen offset:0 sc1
    buffer_load_dwordx4 v[164:167], v222, s[48:51], s3 offen offset:1024 sc1
    buffer_load_dwordx4 v[168:171], v222, s[48:51], s3 offen offset:2048 sc1
    buffer_load_dwordx4 v[172:175], v222, s[48:51], s3 offen offset:3072 sc1
    s_add_u32 s3, s78, 12288
    buffer_load_dwordx4 v[176:179], v222, s[48:51], s3 offen offset:0 sc1
    buffer_load_dwordx4 v[180:183], v222, s[48:51], s3 offen offset:1024 sc1
    buffer_load_dwordx4 v[184:187], v222, s[48:51], s3 offen offset:2048 sc1
    buffer_load_dwordx4 v[188:191], v222, s[48:51], s3 offen offset:3072 sc1
    s_branch L_fx1r
L_fx2:
    s_and_b32 s3, s70, 0xffff0000
    s_xor_b32 s28, s3, 0x80000000
    s_not_b32 s29, s3
    s_and_b32 s29, s29, 0xffff0000
    s_bitcmp1_b32 s3, 31
    s_cselect_b32 s3, s28, s29
    v_mov_b32 v195, s3
    v_mul_f32 v195, 0xbfb8aa3b, v195
    v_exp_f32 v195, v195
    s_nop 0
    v_add_f32 v195, 1.0, v195
    v_rcp_f32 v195, v195
    s_nop 0
    v_cvt_pk_bf16_f32 v195, v195, v195
    v_lshlrev_b32 v195, 16, v195
    s_mov_b32 s29, 0
L_k6:
    v_max3_u32 v2, v128, v129, v130
    v_max3_u32 v2, v2, v131, v132
    v_max3_u32 v2, v2, v133, v134
    v_max3_u32 v2, v2, v135, v136
    v_max3_u32 v2, v2, v137, v138
    v_max3_u32 v2, v2, v139, v140
    v_max3_u32 v2, v2, v141, v142
    v_max3_u32 v2, v2, v143, v144
    v_max3_u32 v2, v2, v145, v146
    v_max3_u32 v2, v2, v147, v148
    v_max3_u32 v2, v2, v149, v150
    v_max3_u32 v2, v2, v151, v152
    v_max3_u32 v2, v2, v153, v154
    v_max3_u32 v2, v2, v155, v156
    v_max3_u32 v2, v2, v157, v158
    v_max3_u32 v2, v2, v159, v160
    v_max3_u32 v2, v2, v161, v162
    v_max3_u32 v2, v2, v163, v164
    v_max3_u32 v2, v2, v165, v166
    v_max3_u32 v2, v2, v167, v168
    v_max3_u32 v2, v2, v169, v170
    v_max3_u32 v2, v2, v171, v172
    v_max3_u32 v2, v2, v173, v174
    v_max3_u32 v2, v2, v175, v176
    v_max3_u32 v2, v2, v177, v178
    v_max3_u32 v2, v2, v179, v180
    v_max3_u32 v2, v2, v181, v182
    v_max3_u32 v2, v2, v183, v184
    v_max3_u32 v2, v2, v185, v186
    v_max3_u32 v2, v2, v187, v188
    v_max3_u32 v2, v2, v189, v190
    v_max_u32 v2, v2, v191
    v_cmp_eq_u32 vcc, -1, v2
    s_cbranch_vccz L_k6k
    s_add_u32 s29, s29, 1
    s_cmp_ge_u32 s29, 200000
    s_cbranch_scc1 L_k6k
    s_sleep 4
    s_add_u32 s3, s78, 0
    s_nop 0
    buffer_load_dwordx4 v[128:131], v222, s[48:51], s3 offen offset:0 sc1
    buffer_load_dwordx4 v[132:135], v222, s[48:51], s3 offen offset:1024 sc1
    buffer_load_dwordx4 v[136:139], v222, s[48:51], s3 offen offset:2048 sc1
    buffer_load_dwordx4 v[140:143], v222, s[48:51], s3 offen offset:3072 sc1
    s_add_u32 s3, s78, 4096
    buffer_load_dwordx4 v[144:147], v222, s[48:51], s3 offen offset:0 sc1
    buffer_load_dwordx4 v[148:151], v222, s[48:51], s3 offen offset:1024 sc1
    buffer_load_dwordx4 v[152:155], v222, s[48:51], s3 offen offset:2048 sc1
    buffer_load_dwordx4 v[156:159], v222, s[48:51], s3 offen offset:3072 sc1
    s_add_u32 s3, s78, 8192
    buffer_load_dwordx4 v[160:163], v222, s[48:51], s3 offen offset:0 sc1
    buffer_load_dwordx4 v[164:167], v222, s[48:51], s3 offen offset:1024 sc1
    buffer_load_dwordx4 v[168:171], v222, s[48:51], s3 offen offset:2048 sc1
    buffer_load_dwordx4 v[172:175], v222, s[48:51], s3 offen offset:3072 sc1
    s_add_u32 s3, s78, 12288
    buffer_load_dwordx4 v[176:179], v222, s[48:51], s3 offen offset:0 sc1
    buffer_load_dwordx4 v[180:183], v222, s[48:51], s3 offen offset:1024 sc1
    buffer_load_dwordx4 v[184:187], v222, s[48:51], s3 offen offset:2048 sc1
    buffer_load_dwordx4 v[188:191], v222, s[48:51], s3 offen offset:3072 sc1
    s_waitcnt vmcnt(0)
    s_branch L_k6
L_k6k:
    v_pk_add_f32 v[128:129], v[128:129], v[160:161]
    v_pk_add_f32 v[130:131], v[130:131], v[162:163]
    v_pk_add_f32 v[132:133], v[132:133], v[164:165]
    v_pk_add_f32 v[134:135], v[134:135], v[166:167]
    v_pk_add_f32 v[136:137], v[136:137], v[168:169]
    v_pk_add_f32 v[138:139], v[138:139], v[170:171]
    v_pk_add_f32 v[140:141], v[140:141], v[172:173]
    v_pk_add_f32 v[142:143], v[142:143], v[174:175]
    v_pk_add_f32 v[144:145], v[144:145], v[176:177]
    v_pk_add_f32 v[146:147], v[146:147], v[178:179]
    v_pk_add_f32 v[148:149], v[148:149], v[180:181]
    v_pk_add_f32 v[150:151], v[150:151], v[182:183]
    v_pk_add_f32 v[152:153], v[152:153], v[184:185]
    v_pk_add_f32 v[154:155], v[154:155], v[186:187]
    v_pk_add_f32 v[156:157], v[156:157], v[188:189]
    v_pk_add_f32 v[158:159], v[158:159], v[190:191]
    v_pk_add_f32 v[128:129], v[128:129], v[144:145]
    v_pk_add_f32 v[130:131], v[130:131], v[146:147]
    v_pk_add_f32 v[132:133], v[132:133], v[148:149]
    v_pk_add_f32 v[134:135], v[134:135], v[150:151]
    v_pk_add_f32 v[136:137], v[136:137], v[152:153]
    v_pk_add_f32 v[138:139], v[138:139], v[154:155]
    v_pk_add_f32 v[140:141], v[140:141], v[156:157]
    v_pk_add_f32 v[142:143], v[142:143], v[158:159]
    v_pk_add_f32 v[128:129], v[128:129], v[136:137]
    v_pk_add_f32 v[130:131], v[130:131], v[138:139]
    v_pk_add_f32 v[132:133], v[132:133], v[140:141]
    v_pk_add_f32 v[134:135], v[134:135], v[142:143]
    v_pk_add_f32 v[128:129], v[128:129], v[132:133]
    v_pk_add_f32 v[130:131], v[130:131], v[134:135]
    s_nop 1
    v_permlane32_swap_b32 v128, v130
    v_permlane32_swap_b32 v129, v131
    v_add_f32 v128, v128, v130
    v_add_f32 v129, v129, v131
    s_nop 1
    v_permlane16_swap_b32 v128, v129
    v_add_f32 v128, v128, v129
    v_cvt_pk_bf16_f32 v128, v128, v128
    v_lshlrev_b32 v128, 16, v128
    v_mul_f32 v128, v128, v195
    v_lshlrev_b32 v194, 16, v194
    v_sub_f32 v194, v194, v250
    v_cvt_pk_bf16_f32 v128, v128, v128
    v_lshlrev_b32 v128, 16, v128
    v_cvt_pk_bf16_f32 v194, v194, v194
    v_lshlrev_b32 v194, 16, v194
    v_mul_f32 v194, v194, v251
    v_cvt_pk_bf16_f32 v194, v194, v194
    v_lshlrev_b32 v194, 16, v194
    v_add_f32 v128, v128, v194
    v_cvt_pk_bf16_f32 v128, v128, v128
    v_lshlrev_b32 v128, 16, v128
    v_mul_f32 v2, 0xbfb8aa3b, v128
    v_exp_f32 v2, v2
    s_nop 0
    v_add_f32 v2, 1.0, v2
    v_rcp_f32 v2, v2
    s_nop 0
    v_mul_f32 v2, v128, v2
    v_lshlrev_b32 v3, 2, v193
    ds_write_b32 v3, v2
    s_branch L_fx2r
L_r0:
    s_add_u32 s29, s29, 1
    s_cmp_ge_u32 s29, 200000
    s_cbranch_scc1 L_g0
    s_add_u32 s3, s76, 0
    buffer_load_dwordx4 v[40:43], v116, s[48:51], s3 offen offset:0 sc1
    buffer_load_dwordx4 v[44:47], v117, s[48:51], s3 offen offset:0 sc1
    s_waitcnt vmcnt(0)
    v_max3_u32 v2, v40, v41, v42
    v_max3_u32 v2, v2, v43, v44
    v_max3_u32 v2, v2, v45, v46
    v_max_u32 v2, v2, v47
    v_cmp_eq_u32 vcc, -1, v2
    s_cbranch_vccnz L_r0
    s_branch L_g0
L_r1:
    s_add_u32 s29, s29, 1
    s_cmp_ge_u32 s29, 200000
    s_cbranch_scc1 L_g1
    s_add_u32 s3, s76, 0
    buffer_load_dwordx4 v[48:51], v116, s[48:51], s3 offen offset:1024 sc1
    buffer_load_dwordx4 v[52:55], v117, s[48:51], s3 offen offset:1024 sc1
    s_waitcnt vmcnt(0)
    v_max3_u32 v2, v48, v49, v50
    v_max3_u32 v2, v2, v51, v52
    v_max3_u32 v2, v2, v53, v54
    v_max_u32 v2, v2, v55
    v_cmp_eq_u32 vcc, -1, v2
    s_cbranch_vccnz L_r1
    s_branch L_g1
L_r2:
    s_add_u32 s29, s29, 1
    s_cmp_ge_u32 s29, 200000
    s_cbranch_scc1 L_g2
    s_add_u32 s3, s76, 0
    buffer_load_dwordx4 v[56:59], v116, s[48:51], s3 offen offset:2048 sc1
    buffer_load_dwordx4 v[60:63], v117, s[48:51], s3 offen offset:2048 sc1
    s_waitcnt vmcnt(0)
    v_max3_u32 v2, v56, v57, v58
    v_max3_u32 v2, v2, v59, v60
    v_max3_u32 v2, v2, v61, v62
    v_max_u32 v2, v2, v63
    v_cmp_eq_u32 vcc, -1, v2
    s_cbranch_vccnz L_r2
    s_branch L_g2
L_r3:
    s_add_u32 s29, s29, 1
    s_cmp_ge_u32 s29, 200000
    s_cbranch_scc1 L_g3
    s_add_u32 s3, s76, 0
    buffer_load_dwordx4 v[64:67], v116, s[48:51], s3 offen offset:3072 sc1
    buffer_load_dwordx4 v[68:71], v117, s[48:51], s3 offen offset:3072 sc1
    s_waitcnt vmcnt(0)
    v_max3_u32 v2, v64, v65, v66
    v_max3_u32 v2, v2, v67, v68
    v_max3_u32 v2, v2, v69, v70
    v_max_u32 v2, v2, v71
    v_cmp_eq_u32 vcc, -1, v2
    s_cbranch_vccnz L_r3
    s_branch L_g3
L_r4:
    s_add_u32 s29, s29, 1
    s_cmp_ge_u32 s29, 200000
    s_cbranch_scc1 L_g4
    s_add_u32 s3, s76, 4096
    buffer_load_dwordx4 v[72:75], v116, s[48:51], s3 offen offset:0 sc1
    buffer_load_dwordx4 v[76:79], v117, s[48:51], s3 offen offset:0 sc1
    s_waitcnt vmcnt(0)
    v_max3_u32 v2, v72, v73, v74
    v_max3_u32 v2, v2, v75, v76
    v_max3_u32 v2, v2, v77, v78
    v_max_u32 v2, v2, v79
    v_cmp_eq_u32 vcc, -1, v2
    s_cbranch_vccnz L_r4
    s_branch L_g4
L_r5:
    s_add_u32 s29, s29, 1
    s_cmp_ge_u32 s29, 200000
    s_cbranch_scc1 L_g5
    s_add_u32 s3, s76, 4096
    buffer_load_dwordx4 v[40:43], v116, s[48:51], s3 offen offset:1024 sc1
    buffer_load_dwordx4 v[44:47], v117, s[48:51], s3 offen offset:1024 sc1
    s_waitcnt vmcnt(0)
    v_max3_u32 v2, v40, v41, v42
    v_max3_u32 v2, v2, v43, v44
    v_max3_u32 v2, v2, v45, v46
    v_max_u32 v2, v2, v47
    v_cmp_eq_u32 vcc, -1, v2
    s_cbranch_vccnz L_r5
    s_branch L_g5
L_r6:
    s_add_u32 s29, s29, 1
    s_cmp_ge_u32 s29, 200000
    s_cbranch_scc1 L_g6
    s_add_u32 s3, s76, 4096
    buffer_load_dwordx4 v[48:51], v116, s[48:51], s3 offen offset:2048 sc1
    buffer_load_dwordx4 v[52:55], v117, s[48:51], s3 offen offset:2048 sc1
    s_waitcnt vmcnt(0)
    v_max3_u32 v2, v48, v49, v50
    v_max3_u32 v2, v2, v51, v52
    v_max3_u32 v2, v2, v53, v54
    v_max_u32 v2, v2, v55
    v_cmp_eq_u32 vcc, -1, v2
    s_cbranch_vccnz L_r6
    s_branch L_g6
L_r7:
    s_add_u32 s29, s29, 1
    s_cmp_ge_u32 s29, 200000
    s_cbranch_scc1 L_g7
    s_add_u32 s3, s76, 4096
    buffer_load_dwordx4 v[56:59], v116, s[48:51], s3 offen offset:3072 sc1
    buffer_load_dwordx4 v[60:63], v117, s[48:51], s3 offen offset:3072 sc1
    s_waitcnt vmcnt(0)
    v_max3_u32 v2, v56, v57, v58
    v_max3_u32 v2, v2, v59, v60
    v_max3_u32 v2, v2, v61, v62
    v_max_u32 v2, v2, v63
    v_cmp_eq_u32 vcc, -1, v2
    s_cbranch_vccnz L_r7
    s_branch L_g7
L_r8:
    s_add_u32 s29, s29, 1
    s_cmp_ge_u32 s29, 200000
    s_cbranch_scc1 L_g8
    s_add_u32 s3, s76, 8192
    buffer_load_dwordx4 v[64:67], v116, s[48:51], s3 offen offset:0 sc1
    buffer_load_dwordx4 v[68:71], v117, s[48:51], s3 offen offset:0 sc1
    s_waitcnt vmcnt(0)
    v_max3_u32 v2, v64, v65, v66
    v_max3_u32 v2, v2, v67, v68
    v_max3_u32 v2, v2, v69, v70
    v_max_u32 v2, v2, v71
    v_cmp_eq_u32 vcc, -1, v2
    s_cbranch_vccnz L_r8
    s_branch L_g8
L_r9:
    s_add_u32 s29, s29, 1
    s_cmp_ge_u32 s29, 200000
    s_cbranch_scc1 L_g9
    s_add_u32 s3, s76, 8192
    buffer_load_dwordx4 v[72:75], v116, s[48:51], s3 offen offset:1024 sc1
    buffer_load_dwordx4 v[76:79], v117, s[48:51], s3 offen offset:1024 sc1
    s_waitcnt vmcnt(0)
    v_max3_u32 v2, v72, v73, v74
    v_max3_u32 v2, v2, v75, v76
    v_max3_u32 v2, v2, v77, v78
    v_max_u32 v2, v2, v79
    v_cmp_eq_u32 vcc, -1, v2
    s_cbranch_vccnz L_r9
    s_branch L_g9
L_r10:
    s_add_u32 s29, s29, 1
    s_cmp_ge_u32 s29, 200000
    s_cbranch_scc1 L_g10
    s_add_u32 s3, s76, 8192
    buffer_load_dwordx4 v[40:43], v116, s[48:51], s3 offen offset:2048 sc1
    buffer_load_dwordx4 v[44:47], v117, s[48:51], s3 offen offset:2048 sc1
    s_waitcnt vmcnt(0)
    v_max3_u32 v2, v40, v41, v42
    v_max3_u32 v2, v2, v43, v44
    v_max3_u32 v2, v2, v45, v46
    v_max_u32 v2, v2, v47
    v_cmp_eq_u32 vcc, -1, v2
    s_cbranch_vccnz L_r10
    s_branch L_g10
L_r11:
    s_add_u32 s29, s29, 1
    s_cmp_ge_u32 s29, 200000
    s_cbranch_scc1 L_g11
    s_add_u32 s3, s76, 8192
    buffer_load_dwordx4 v[48:51], v116, s[48:51], s3 offen offset:3072 sc1
    buffer_load_dwordx4 v[52:55], v117, s[48:51], s3 offen offset:3072 sc1
    s_waitcnt vmcnt(0)
    v_max3_u32 v2, v48, v49, v50
    v_max3_u32 v2, v2, v51, v52
    v_max3_u32 v2, v2, v53, v54
    v_max_u32 v2, v2, v55
    v_cmp_eq_u32 vcc, -1, v2
    s_cbranch_vccnz L_r11
    s_branch L_g11
L_r12:
    s_add_u32 s29, s29, 1
    s_cmp_ge_u32 s29, 200000
    s_cbranch_scc1 L_g12
    s_add_u32 s3, s76, 12288
    buffer_load_dwordx4 v[56:59], v116, s[48:51], s3 offen offset:0 sc1
    buffer_load_dwordx4 v[60:63], v117, s[48:51], s3 offen offset:0 sc1
    s_waitcnt vmcnt(0)
    v_max3_u32 v2, v56, v57, v58
    v_max3_u32 v2, v2, v59, v60
    v_max3_u32 v2, v2, v61, v62
    v_max_u32 v2, v2, v63
    v_cmp_eq_u32 vcc, -1, v2
    s_cbranch_vccnz L_r12
    s_branch L_g12
L_r13:
    s_add_u32 s29, s29, 1
    s_cmp_ge_u32 s29, 200000
    s_cbranch_scc1 L_g13
    s_add_u32 s3, s76, 12288
    buffer_load_dwordx4 v[64:67], v116, s[48:51], s3 offen offset:1024 sc1
    buffer_load_dwordx4 v[68:71], v117, s[48:51], s3 offen offset:1024 sc1
    s_waitcnt vmcnt(0)
    v_max3_u32 v2, v64, v65, v66
    v_max3_u32 v2, v2, v67, v68
    v_max3_u32 v2, v2, v69, v70
    v_max_u32 v2, v2, v71
    v_cmp_eq_u32 vcc, -1, v2
    s_cbranch_vccnz L_r13
    s_branch L_g13
L_r14:
    s_add_u32 s29, s29, 1
    s_cmp_ge_u32 s29, 200000
    s_cbranch_scc1 L_g14
    s_add_u32 s3, s76, 12288
    buffer_load_dwordx4 v[72:75], v116, s[48:51], s3 offen offset:2048 sc1
    buffer_load_dwordx4 v[76:79], v117, s[48:51], s3 offen offset:2048 sc1
    s_waitcnt vmcnt(0)
    v_max3_u32 v2, v72, v73, v74
    v_max3_u32 v2, v2, v75, v76
    v_max3_u32 v2, v2, v77, v78
    v_max_u32 v2, v2, v79
    v_cmp_eq_u32 vcc, -1, v2
    s_cbranch_vccnz L_r14
    s_branch L_g14
L_r15:
    s_add_u32 s29, s29, 1
    s_cmp_ge_u32 s29, 200000
    s_cbranch_scc1 L_g15
    s_add_u32 s3, s76, 12288
    buffer_load_dwordx4 v[40:43], v116, s[48:51], s3 offen offset:3072 sc1
    buffer_load_dwordx4 v[44:47], v117, s[48:51], s3 offen offset:3072 sc1
    s_waitcnt vmcnt(0)
    v_max3_u32 v2, v40, v41, v42
    v_max3_u32 v2, v2, v43, v44
    v_max3_u32 v2, v2, v45, v46
    v_max_u32 v2, v2, v47
    v_cmp_eq_u32 vcc, -1, v2
    s_cbranch_vccnz L_r15
    s_branch L_g15
.p2align 8
.fill 4096, 4, 0xbf800000
.section .rodata,"a"
.p2align 6
.amdhsa_kernel recurrent_scan__linear_kernel_hedgehog__moe_arch_mod__prompt_kernel
  .amdhsa_next_free_vgpr 256
  .amdhsa_next_free_sgpr 102
  .amdhsa_accum_offset 256
  .amdhsa_group_segment_fixed_size 0
  .amdhsa_kernarg_size 96
  .amdhsa_user_sgpr_count 2
  .amdhsa_user_sgpr_kernarg_segment_ptr 1
  .amdhsa_system_sgpr_workgroup_id_x 1
.end_amdhsa_kernel
```

```asm
; @launch grid=(256,1,1) block=(512,1,1) lds=163840
.amdgcn_target "amdgcn-amd-amdhsa--gfx950"
.text
.globl recurrent_scan__linear_kernel_hedgehog__moe_arch_mod__prompt_kernel
.p2align 8
.type recurrent_scan__linear_kernel_hedgehog__moe_arch_mod__prompt_kernel,@function
recurrent_scan__linear_kernel_hedgehog__moe_arch_mod__prompt_kernel:
    s_cmp_ge_u32 s2, 256
    s_cbranch_scc1 L_done
    s_load_dwordx16 s[4:19], s[0:1], 0
    s_load_dwordx8 s[20:27], s[0:1], 64
    v_and_b32 v1, 63, v0
    v_lshrrev_b32 v2, 6, v0
    s_nop 0
    v_readfirstlane_b32 s39, v2
    s_and_b32 s34, s2, 1
    s_lshl_b32 s34, s34, 3
    s_bfe_u32 s3, s2, 0x30003
    s_add_u32 s36, s34, s3
    s_bfe_u32 s37, s2, 0x20001
    s_lshl_b32 s37, s37, 2
    s_lshr_b32 s28, s2, 6
    s_add_u32 s37, s37, s28
    s_and_b32 s80, s37, 12
    s_xor_b32 s80, s80, s34
    s_add_u32 s85, s36, s37
    s_and_b32 s85, s85, 3
    s_add_u32 s3, s85, 3
    s_and_b32 s3, s3, 3
    s_xor_b32 s35, s80, 12
    s_or_b32 s35, s35, s3
    s_mov_b32 s34, s36
    s_and_b32 s38, s39, 3
    s_cmp_lt_u32 s39, 4
    s_cbranch_scc1 L_C
L_H:
    v_and_b32 v4, 7, v1
    s_lshl_b32 s33, s37, 7
    s_lshl_b32 s87, s85, 7
    s_lshl_b32 s66, s80, 7
    s_lshl_b32 s3, s36, 7
    s_lshl_b32 s28, s38, 5
    s_add_u32 s3, s3, s28
    v_lshrrev_b32 v7, 3, v1
    v_add_u32 v3, s3, v7
    v_lshlrev_b32 v3, 11, v3
    v_lshrrev_b32 v5, 4, v1
    v_xor_b32 v6, v4, v5
    v_xor_b32 v5, 4, v6
    v_lshl_add_u32 v6, v6, 4, v3
    v_lshl_add_u32 v5, v5, 4, v3
    v_add_u32_e64 v8, 0, v6
    v_add_u32 v9, 15360, v5
    v_add_u32 v10, 30720, v6
    v_add_u32 v11, 46080, v5
    s_lshr_b32 s32, s36, 1
    s_and_b32 s32, s32, 2
    s_xor_b32 s32, s32, s38
    s_lshl_b32 s3, s32, 4
    v_add_u32_e64 v7, s3, v7
    v_mul_u32_u24 v7, 6144, v7
    v_bfe_u32 v6, v1, 4, 1
    v_lshlrev_b32 v6, 1, v6
    v_xor_b32 v5, v4, v6
    v_add_u32 v7, s33, v7
    v_xor_b32 v6, 4, v5
    v_lshl_add_u32 v6, v6, 4, v7
    v_lshl_add_u32 v7, v5, 4, v7
    v_add_u32_e64 v12, 0, v7
    v_add_u32 v13, 48128, v6
    v_add_u32 v14, 2048, v7
    v_add_u32 v15, 50176, v6
    v_add_u32 v16, 4096, v7
    v_add_u32 v17, 52224, v6
    v_xor_b32 v12, 512, v12
    v_xor_b32 v13, 512, v13
    s_lshl_b32 s30, s38, 12
    s_lshl_b32 s31, s32, 11
    s_add_u32 s31, s31, 16384
    s_waitcnt lgkmcnt(0)
    s_mov_b32 s44, s6
    s_mov_b32 s45, s7
    s_mov_b32 s46, 6291456
    s_mov_b32 s47, 0x00020000
    s_mov_b32 s40, s4
    s_mov_b32 s41, s5
    s_mov_b32 s42, 4194304
    s_mov_b32 s43, 0x00020000
    v_lshlrev_b32 v252, 4, v1
    s_mov_b32 s48, s26
    s_mov_b32 s49, s27
    s_mov_b32 s50, 268435456
    s_mov_b32 s51, 0x00020000
    v_mov_b32 v19, 16384
    buffer_load_dword v19, v19, s[48:51], 0 offen sc1
    s_lshl_b32 s3, s36, 7
    s_lshl_b32 s28, s37, 3
    s_add_u32 s3, s3, s28
    s_lshl_b32 s3, s3, 11
    s_add_u32 s3, s3, s30
    s_add_u32 m0, s30, 131072
    s_nop 0
    buffer_load_dwordx4 v252, s[40:43], s3 offen offset:0 lds
    buffer_load_dwordx4 v252, s[40:43], s3 offen offset:2048 lds
    s_lshl_b32 s3, s36, 7
    s_lshl_b32 s28, s37, 3
    s_add_u32 s3, s3, s28
    s_lshl_b32 s3, s3, 11
    s_add_u32 s3, s3, s30
    s_add_u32 m0, s30, 131072
    s_nop 0
    buffer_load_dwordx4 v252, s[40:43], s3 offen offset:1024 lds
    buffer_load_dwordx4 v252, s[40:43], s3 offen offset:3072 lds
    s_mov_b32 s60, s14
    s_mov_b32 s61, s15
    s_mov_b32 s62, 2048
    s_mov_b32 s63, 0x00020000
    s_lshl_b32 s3, s38, 9
    s_add_u32 m0, s3, 122880
    s_mov_b32 exec_hi, 0
    buffer_load_dwordx4 v252, s[60:63], s3 offen lds
    s_mov_b64 exec, -1
    s_add_u32 s64, s87, 0
    s_and_b32 s64, s64, 511
    s_or_b32 s64, s64, 0
    s_xor_b32 s64, s64, s66
    s_mul_i32 s65, s64, 3072
    s_add_u32 m0, s31, 0
    s_nop 0
    buffer_load_dwordx4 v12, s[44:47], s65 offen offset:0 lds
    buffer_load_dwordx4 v13, s[44:47], s65 offen offset:1024 lds
    s_add_u32 m0, s31, 8192
    s_nop 0
    buffer_load_dwordx4 v14, s[44:47], s65 offen offset:0 lds
    buffer_load_dwordx4 v15, s[44:47], s65 offen offset:1024 lds
    s_add_u32 m0, s31, 16384
    s_nop 0
    buffer_load_dwordx4 v16, s[44:47], s65 offen offset:0 lds
    buffer_load_dwordx4 v17, s[44:47], s65 offen offset:1024 lds
    v_mov_b32 v248, -1
    v_mov_b32 v249, -1
    v_mov_b32 v250, -1
    v_mov_b32 v251, -1
    v_lshlrev_b32 v252, 4, v1
    s_and_b32 s85, s85, 0
    s_lshl_b32 s3, s37, 4
    s_add_u32 s3, s3, s36
    s_lshl_b32 s67, s3, 10
    s_add_u32 s67, s67, 524288
    s_lshl_b32 s3, s38, 8
    s_add_u32 s67, s67, s3
    v_mov_b32 v24, 0
    v_mov_b32 v25, 0
    v_mov_b32 v26, 0
    v_mov_b32 v27, 0
    v_mov_b32 v28, 0
    v_mov_b32 v29, 0
    v_mov_b32 v30, 0
    v_mov_b32 v31, 0
    v_lshlrev_b32 v253, 2, v1
    s_cmp_gt_u32 s37, 3
    s_subb_u32 s77, s37, 0
    s_cmp_gt_u32 s37, 11
    s_subb_u32 s77, s77, 0
    s_lshl_b32 s77, s77, 4
    s_add_u32 s77, s77, s36
    s_and_b32 s3, s37, 7
    s_cmp_eq_u32 s3, 3
    s_cselect_b32 s77, 224, s77
    s_bitcmp1_b32 s38, 0
    s_cselect_b32 s52, s18, s16
    s_cselect_b32 s53, s19, s17
    s_cmp_lt_u32 s77, 224
    s_cselect_b32 s54, 7340032, 0
    s_mov_b32 s55, 0x00020000
    s_mov_b32 s56, s20
    s_mov_b32 s57, s21
    s_mov_b32 s58, 7340032
    s_mov_b32 s59, 0x00020000
    s_and_b32 s3, s77, 3
    s_lshl_b32 s3, s3, 8
    s_lshr_b32 s28, s38, 1
    s_lshl_b32 s28, s28, 7
    s_add_u32 s3, s3, s28
    v_lshrrev_b32_e64 v5, 3, v1
    v_lshl_add_u32 v6, v5, 4, s3
    v_mul_u32_u24 v6, 7168, v6
    v_lshl_add_u32 v6, v4, 4, v6
    s_lshr_b32 s3, s77, 2
    s_lshl_b32 s3, s3, 7
    v_add_u32 v21, s3, v6
    s_lshr_b32 s3, s2, 4
    s_mul_i32 s3, s3, 224
    s_mul_i32 s28, s38, 56
    s_add_u32 s71, s3, s28
    v_lshlrev_b32 v6, 14, v5
    v_lshl_add_u32 v6, v4, 4, v6
    s_and_b32 s3, s2, 15
    s_lshl_b32 s3, s3, 7
    v_add_u32 v22, s3, v6
    v_lshrrev_b32 v2, 2, v1
    v_and_b32 v3, 3, v1
    v_lshlrev_b32 v3, 4, v3
    v_lshl_add_u32 v232, v2, 10, v3
    v_lshlrev_b32 v2, 3, v1
    v_add_u32 v230, 152064, v2
    v_and_b32_e64 v4, 49, v1
    v_bfe_u32 v7, v1, 1, 2
    v_lshl_add_u32 v4, v7, 2, v4
    v_bfe_u32 v7, v1, 3, 1
    v_lshl_add_u32 v4, v7, 1, v4
    v_lshlrev_b32 v4, 2, v4
    v_add_u32 v231, 154624, v4
    s_mul_i32 s3, s38, 48
    v_and_b32 v2, 15, v1
    v_lshrrev_b32 v3, 4, v1
    v_cmp_gt_u32 vcc, 12, v2
    v_lshl_add_u32 v4, v2, 2, s3
    v_add_u32 v2, v4, v3
    v_mov_b32 v5, 192
    v_cndmask_b32 v4, v5, v4, vcc
    v_lshlrev_b32 v4, 2, v4
    v_lshl_add_u32 v235, v3, 10, v4
    v_and_b32_e64 v5, 7, v2
    v_bfe_u32 v6, v2, 3, 3
    v_lshl_add_u32 v5, v5, 3, v6
    v_and_b32 v2, 0xc0, v2
    v_add_u32 v2, v2, v5
    v_lshlrev_b32 v2, 2, v2
    v_add_u32 v2, 154880, v2
    v_mov_b32 v5, 162048
    v_cndmask_b32 v233, v5, v2, vcc
    v_lshrrev_b32 v5, 3, v1
    v_lshlrev_b32 v6, 11, v5
    v_bfe_u32 v5, v1, 4, 2
    v_lshlrev_b32 v5, 1, v5
    v_and_b32 v7, 7, v1
    v_xor_b32 v5, v5, v7
    v_lshl_add_u32 v6, v5, 4, v6
    s_lshl_b32 s3, s35, 7
    v_add_u32 v6, s3, v6
    v_add_u32_e64 v220, 0, v6
    v_add_u32 v221, 15360, v6
    v_add_u32 v222, 30720, v6
    v_add_u32 v223, 46080, v6
    s_lshl_b32 s72, s38, 12
    s_lshl_b32 s73, s38, 16
    s_lshl_b32 s3, s36, 2
    s_add_u32 s3, s3, s38
    s_lshr_b32 s28, s3, 5
    s_and_b32 s3, s3, 31
    s_lshl_b32 s74, s3, 7
    s_lshl_b32 s3, s37, 1
    s_add_u32 s75, s3, s28
    v_lshrrev_b32 v5, 3, v1
    v_mul_u32_u24 v5, 4224, v5
    v_and_b32_e64 v7, 7, v1
    v_lshl_add_u32 v112, v7, 4, v5
    s_mul_i32 s76, s75, 67584
    s_add_u32 s76, s76, s74
    s_add_u32 s76, s76, 8388608
    s_mul_i32 s3, s75, 4224
    s_add_u32 s3, s3, s74
    s_add_u32 s74, s3, 1048576
    s_lshl_b32 s75, s37, 1
    s_add_u32 s75, s75, s36
    s_mul_i32 s81, s75, 67584
    s_add_u32 s81, s81, 8392704
    s_mul_i32 s82, s75, 4224
    s_add_u32 s82, s82, 1052672
    s_lshr_b32 s3, s36, 1
    s_or_b32 s83, s3, s38
    s_and_b32 s3, s38, 1
    s_lshl_b32 s3, s3, 3
    s_and_b32 s28, s77, 3
    s_lshl_b32 s28, s28, 1
    s_add_u32 s3, s3, s28
    s_lshr_b32 s28, s38, 1
    s_add_u32 s3, s3, s28
    s_mul_i32 s3, s3, 14336
    s_lshr_b32 s28, s77, 2
    s_lshl_b32 s28, s28, 8
    s_add_u32 s3, s3, s28
    s_add_u32 s3, s3, 1183744
    s_cmp_lt_u32 s77, 224
    s_cselect_b32 s84, s3, 268435456
    v_and_b32 v2, 15, v1
    v_bfe_u32 v3, v1, 4, 1
    v_mul_u32_u24 v3, 4, v3
    v_xor_b32_e64 v3, s37, v3
    v_lshl_add_u32 v3, v3, 4, v2
    v_lshl_add_u32 v2, v2, 4, s34
    v_cmp_gt_u32 vcc, 32, v1
    s_nop 1
    v_cndmask_b32 v2, v2, v3, vcc
    v_lshlrev_b32 v113, 7, v2
    s_lshl_b32 s3, s38, 1
    s_lshr_b32 s28, s39, 2
    s_add_u32 s3, s3, s28
    s_lshl_b32 s69, s3, 4
    v_and_b32 v2, 15, v1
    v_add_u32 v23, s69, v2
    v_lshlrev_b32 v23, 7, v23
    v_lshrrev_b32 v2, 1, v2
    v_lshrrev_b32 v3, 5, v1
    v_xor_b32 v2, v2, v3
    v_lshl_add_u32 v23, v2, 4, v23
    v_bfe_u32 v3, v1, 4, 1
    v_lshl_add_u32 v23, v3, 3, v23
    v_bfe_u32 v5, v1, 4, 1
    v_lshlrev_b32 v5, 5, v5
    v_xor_b32 v5, v5, v252
    s_min_u32 s3, s38, 2
    s_lshl_b32 s3, s3, 13
    s_and_b32 s28, s36, 4
    s_lshl_b32 s28, s28, 10
    s_add_u32 s3, s3, s28
    s_add_u32 s3, s3, 16384
    v_add_u32 v18, s3, v5
    s_lshr_b32 s3, s38, 1
    s_lshl_b32 s28, s37, 1
    s_add_u32 s28, s28, s3
    s_and_b32 s29, s38, 1
    s_lshl_b32 s3, s28, 4
    s_add_u32 s3, s3, s36
    s_mul_i32 s3, s3, 4224
    s_mul_i32 s78, s29, 2112
    s_add_u32 s78, s78, s3
    s_add_u32 s78, s78, 8388608
    s_lshl_b32 s3, s36, 1
    s_add_u32 s29, s29, s3
    s_xor_b32 s28, s28, 8
    s_lshl_b32 s3, s29, 7
    s_add_u32 s3, s3, s28
    s_lshl_b32 s3, s3, 10
    s_add_u32 s79, s3, 4194304
    s_mov_b32 s88, s10
    s_mov_b32 s89, s11
    s_mov_b32 s90, 2097152
    s_mov_b32 s91, 0x00020000
    s_add_u32 s64, s87, 0
    s_and_b32 s64, s64, 511
    s_or_b32 s64, s64, 0
    s_xor_b32 s64, s64, s66
    s_mul_i32 s65, s64, 3072
    s_add_u32 m0, s30, 0
    s_nop 0
    buffer_load_dwordx4 v8, s[40:43], s64 offen offset:0 lds
    buffer_load_dwordx4 v9, s[40:43], s64 offen offset:1024 lds
    buffer_load_dwordx4 v10, s[40:43], s64 offen offset:2048 lds
    buffer_load_dwordx4 v11, s[40:43], s64 offen offset:3072 lds
    s_waitcnt vmcnt(10)
    s_barrier
    s_add_u32 s64, s87, 128
    s_and_b32 s64, s64, 511
    s_or_b32 s64, s64, 0
    s_xor_b32 s64, s64, s66
    s_mul_i32 s65, s64, 3072
    s_add_u32 m0, s30, 40960
    s_nop 0
    buffer_load_dwordx4 v8, s[40:43], s64 offen offset:0 lds
    buffer_load_dwordx4 v9, s[40:43], s64 offen offset:1024 lds
    buffer_load_dwordx4 v10, s[40:43], s64 offen offset:2048 lds
    buffer_load_dwordx4 v11, s[40:43], s64 offen offset:3072 lds
    s_add_u32 m0, s31, 40960
    s_nop 0
    buffer_load_dwordx4 v12, s[44:47], s65 offen offset:0 lds
    buffer_load_dwordx4 v13, s[44:47], s65 offen offset:1024 lds
    s_add_u32 m0, s31, 49152
    s_nop 0
    buffer_load_dwordx4 v14, s[44:47], s65 offen offset:0 lds
    buffer_load_dwordx4 v15, s[44:47], s65 offen offset:1024 lds
    s_add_u32 m0, s31, 57344
    s_nop 0
    buffer_load_dwordx4 v16, s[44:47], s65 offen offset:0 lds
    buffer_load_dwordx4 v17, s[44:47], s65 offen offset:1024 lds
    v_readfirstlane_b32 s86, v19
    s_nop 0
    s_mul_i32 s86, s86, 1664525
    s_add_u32 s86, s86, 1013904223
    s_waitcnt vmcnt(10)
    s_waitcnt lgkmcnt(0)
    s_barrier
    v_add_u32 v2, 0, v18
    v_xor_b32_e64 v3, 64, v2
    ds_read_b128 v[32:35], v2 offset:0
    ds_read_b128 v[36:39], v3 offset:1024
    ds_read_b128 v[40:43], v2 offset:2048
    ds_read_b128 v[44:47], v3 offset:3072
    s_add_u32 s64, s87, 256
    s_and_b32 s64, s64, 511
    s_or_b32 s64, s64, 0
    s_xor_b32 s64, s64, s66
    s_mul_i32 s65, s64, 3072
    s_add_u32 m0, s30, 81920
    s_nop 0
    buffer_load_dwordx4 v8, s[40:43], s64 offen offset:0 lds
    buffer_load_dwordx4 v9, s[40:43], s64 offen offset:1024 lds
    buffer_load_dwordx4 v10, s[40:43], s64 offen offset:2048 lds
    buffer_load_dwordx4 v11, s[40:43], s64 offen offset:3072 lds
    s_add_u32 m0, s31, 81920
    s_nop 0
    buffer_load_dwordx4 v12, s[44:47], s65 offen offset:0 lds
    buffer_load_dwordx4 v13, s[44:47], s65 offen offset:1024 lds
    s_add_u32 m0, s31, 90112
    s_nop 0
    buffer_load_dwordx4 v14, s[44:47], s65 offen offset:0 lds
    buffer_load_dwordx4 v15, s[44:47], s65 offen offset:1024 lds
    s_add_u32 m0, s31, 98304
    s_nop 0
    buffer_load_dwordx4 v16, s[44:47], s65 offen offset:0 lds
    buffer_load_dwordx4 v17, s[44:47], s65 offen offset:1024 lds
    buffer_store_dwordx4 v[248:251], v252, s[48:51], s78 offen offset:0 sc1
    s_waitcnt vmcnt(11)
    s_waitcnt lgkmcnt(0)
    s_barrier
    s_add_u32 s64, s87, 384
    s_and_b32 s64, s64, 511
    s_or_b32 s64, s64, 0
    s_xor_b32 s64, s64, s66
    s_mul_i32 s65, s64, 3072
    s_add_u32 m0, s30, 0
    s_nop 0
    buffer_load_dwordx4 v8, s[40:43], s64 offen offset:0 lds
    buffer_load_dwordx4 v9, s[40:43], s64 offen offset:1024 lds
    v_lshlrev_b32 v2, 16, v32
    v_and_b32 v3, 0xffff0000, v32
    v_add_f32 v24, v24, v2
    v_add_f32 v25, v25, v3
    buffer_load_dwordx4 v10, s[40:43], s64 offen offset:2048 lds
    v_lshlrev_b32 v4, 16, v33
    v_and_b32 v5, 0xffff0000, v33
    v_add_f32 v26, v26, v4
    v_add_f32 v27, v27, v5
    buffer_load_dwordx4 v11, s[40:43], s64 offen offset:3072 lds
    v_lshlrev_b32 v2, 16, v34
    v_and_b32 v3, 0xffff0000, v34
    v_add_f32 v28, v28, v2
    v_add_f32 v29, v29, v3
    s_add_u32 m0, s31, 0
    s_nop 0
    buffer_load_dwordx4 v12, s[44:47], s65 offen offset:0 lds
    v_lshlrev_b32 v4, 16, v35
    v_and_b32 v5, 0xffff0000, v35
    v_add_f32 v30, v30, v4
    v_add_f32 v31, v31, v5
    buffer_load_dwordx4 v13, s[44:47], s65 offen offset:1024 lds
    v_lshlrev_b32 v2, 16, v36
    v_and_b32 v3, 0xffff0000, v36
    v_add_f32 v24, v24, v2
    v_add_f32 v25, v25, v3
    s_add_u32 m0, s31, 8192
    s_nop 0
    buffer_load_dwordx4 v14, s[44:47], s65 offen offset:0 lds
    v_lshlrev_b32 v4, 16, v37
    v_and_b32 v5, 0xffff0000, v37
    v_add_f32 v26, v26, v4
    v_add_f32 v27, v27, v5
    buffer_load_dwordx4 v15, s[44:47], s65 offen offset:1024 lds
    v_lshlrev_b32 v2, 16, v38
    v_and_b32 v3, 0xffff0000, v38
    v_add_f32 v28, v28, v2
    v_add_f32 v29, v29, v3
    s_add_u32 m0, s31, 16384
    s_nop 0
    buffer_load_dwordx4 v16, s[44:47], s65 offen offset:0 lds
    v_lshlrev_b32 v4, 16, v39
    v_and_b32 v5, 0xffff0000, v39
    v_add_f32 v30, v30, v4
    v_add_f32_e64 v31, v31, v5
    buffer_load_dwordx4 v17, s[44:47], s65 offen offset:1024 lds
    buffer_store_dwordx4 v[248:251], v252, s[48:51], s78 offen offset:1024 sc1
    s_mov_b64 exec, 15
    buffer_store_dwordx4 v[248:251], v252, s[48:51], s78 offen offset:2048 sc1
    s_mov_b64 exec, -1
    s_waitcnt vmcnt(13)
    s_waitcnt lgkmcnt(0)
    s_barrier
    s_add_u32 s64, s87, 0
    s_and_b32 s64, s64, 511
    s_or_b32 s64, s64, 512
    s_xor_b32 s64, s64, s66
    s_mul_i32 s65, s64, 3072
    s_add_u32 m0, s30, 40960
    s_nop 0
    buffer_load_dwordx4 v8, s[40:43], s64 offen offset:0 lds
    buffer_load_dwordx4 v9, s[40:43], s64 offen offset:1024 lds
    v_lshlrev_b32 v2, 16, v40
    v_and_b32 v3, 0xffff0000, v40
    v_add_f32 v24, v24, v2
    v_add_f32 v25, v25, v3
    buffer_load_dwordx4 v10, s[40:43], s64 offen offset:2048 lds
    v_lshlrev_b32 v4, 16, v41
    v_and_b32 v5, 0xffff0000, v41
    v_add_f32 v26, v26, v4
    v_add_f32 v27, v27, v5
    buffer_load_dwordx4 v11, s[40:43], s64 offen offset:3072 lds
    v_lshlrev_b32 v2, 16, v42
    v_and_b32 v3, 0xffff0000, v42
    v_add_f32 v28, v28, v2
    v_add_f32 v29, v29, v3
    s_add_u32 m0, s31, 40960
    s_nop 0
    buffer_load_dwordx4 v12, s[44:47], s65 offen offset:0 lds
    v_lshlrev_b32 v4, 16, v43
    v_and_b32 v5, 0xffff0000, v43
    v_add_f32 v30, v30, v4
    v_add_f32 v31, v31, v5
    buffer_load_dwordx4 v13, s[44:47], s65 offen offset:1024 lds
    v_lshlrev_b32 v2, 16, v44
    v_and_b32 v3, 0xffff0000, v44
    v_add_f32 v24, v24, v2
    v_add_f32 v25, v25, v3
    s_add_u32 m0, s31, 49152
    s_nop 0
    buffer_load_dwordx4 v14, s[44:47], s65 offen offset:0 lds
    v_lshlrev_b32 v4, 16, v45
    v_and_b32 v5, 0xffff0000, v45
    v_add_f32 v26, v26, v4
    v_add_f32 v27, v27, v5
    buffer_load_dwordx4 v15, s[44:47], s65 offen offset:1024 lds
    v_lshlrev_b32 v2, 16, v46
    v_and_b32 v3, 0xffff0000, v46
    v_add_f32 v28, v28, v2
    v_add_f32 v29, v29, v3
    s_add_u32 m0, s31, 57344
    s_nop 0
    buffer_load_dwordx4 v16, s[44:47], s65 offen offset:0 lds
    v_lshlrev_b32 v4, 16, v47
    v_and_b32 v5, 0xffff0000, v47
    v_add_f32 v30, v30, v4
    v_add_f32 v31, v31, v5
    buffer_load_dwordx4 v17, s[44:47], s65 offen offset:1024 lds
    s_waitcnt vmcnt(12)
    s_waitcnt lgkmcnt(0)
    s_barrier
    s_add_u32 s64, s87, 128
    s_and_b32 s64, s64, 511
    s_or_b32 s64, s64, 512
    s_xor_b32 s64, s64, s66
    s_mul_i32 s65, s64, 3072
    s_add_u32 m0, s30, 81920
    s_nop 0
    buffer_load_dwordx4 v8, s[40:43], s64 offen offset:0 lds
    buffer_load_dwordx4 v9, s[40:43], s64 offen offset:1024 lds
    buffer_load_dwordx4 v10, s[40:43], s64 offen offset:2048 lds
    buffer_load_dwordx4 v11, s[40:43], s64 offen offset:3072 lds
    s_add_u32 m0, s31, 81920
    s_nop 0
    buffer_load_dwordx4 v12, s[44:47], s65 offen offset:0 lds
    buffer_load_dwordx4 v13, s[44:47], s65 offen offset:1024 lds
    s_add_u32 m0, s31, 90112
    s_nop 0
    buffer_load_dwordx4 v14, s[44:47], s65 offen offset:0 lds
    buffer_load_dwordx4 v15, s[44:47], s65 offen offset:1024 lds
    s_add_u32 m0, s31, 98304
    s_nop 0
    buffer_load_dwordx4 v16, s[44:47], s65 offen offset:0 lds
    buffer_load_dwordx4 v17, s[44:47], s65 offen offset:1024 lds
    s_mov_b32 s60, s8
    s_mov_b32 s61, s9
    s_mov_b32 s62, 65536
    s_mov_b32 s63, 0x00020000
    s_lshl_b32 s3, s38, 10
    s_add_u32 m0, s3, 147712
    s_lshl_b32 s28, s37, 12
    s_add_u32 s3, s3, s28
    buffer_load_dwordx4 v252, s[60:63], s3 offen lds
    s_add_u32 m0, m0, 8192
    s_xor_b32 s3, s3, 16384
    buffer_load_dwordx4 v252, s[60:63], s3 offen lds
    s_lshl_b32 s3, s2, 13
    s_lshl_b32 s28, s38, 11
    s_add_u32 s3, s3, s28
    v_lshlrev_b32 v3, 7, v1
    s_mov_b64 exec, 0xffff
    buffer_load_dword v20, v3, s[88:91], s3 offen
    s_mov_b64 exec, -1
    s_mov_b32 s3, 0
    buffer_load_dwordx4 v[128:131], v21, s[52:55], s3 offen nt
    s_mov_b32 s3, 7168
    buffer_load_dwordx4 v[132:135], v21, s[52:55], s3 offen nt
    s_mov_b32 s3, 14336
    buffer_load_dwordx4 v[136:139], v21, s[52:55], s3 offen nt
    s_mov_b32 s3, 21504
    buffer_load_dwordx4 v[140:143], v21, s[52:55], s3 offen nt
    s_waitcnt vmcnt(17)
    s_waitcnt lgkmcnt(0)
    s_barrier
    v_add_u32 v2, 40960, v18
    v_xor_b32 v3, 64, v2
    ds_read_b128 v[48:51], v2 offset:0
    ds_read_b128 v[52:55], v3 offset:1024
    ds_read_b128 v[56:59], v2 offset:2048
    ds_read_b128 v[60:63], v3 offset:3072
    s_add_u32 s64, s87, 256
    s_and_b32 s64, s64, 511
    s_or_b32 s64, s64, 512
    s_xor_b32 s64, s64, s66
    s_mul_i32 s65, s64, 3072
    s_add_u32 m0, s30, 0
    s_nop 0
    buffer_load_dwordx4 v8, s[40:43], s64 offen offset:0 lds
    buffer_load_dwordx4 v9, s[40:43], s64 offen offset:1024 lds
    buffer_load_dwordx4 v10, s[40:43], s64 offen offset:2048 lds
    buffer_load_dwordx4 v11, s[40:43], s64 offen offset:3072 lds
    s_add_u32 m0, s31, 0
    s_nop 0
    buffer_load_dwordx4 v12, s[44:47], s65 offen offset:0 lds
    buffer_load_dwordx4 v13, s[44:47], s65 offen offset:1024 lds
    s_add_u32 m0, s31, 8192
    s_nop 0
    buffer_load_dwordx4 v14, s[44:47], s65 offen offset:0 lds
    buffer_load_dwordx4 v15, s[44:47], s65 offen offset:1024 lds
    s_add_u32 m0, s31, 16384
    s_nop 0
    buffer_load_dwordx4 v16, s[44:47], s65 offen offset:0 lds
    buffer_load_dwordx4 v17, s[44:47], s65 offen offset:1024 lds
    s_lshl_b32 s3, s36, 10
    buffer_load_dwordx4 v[72:75], v252, s[48:51], s3 offen sc1
    s_lshl_b32 s3, s37, 6
    buffer_load_dword v76, v232, s[48:51], s3 offen offset:12 sc1
    s_waitcnt vmcnt(19)
    s_waitcnt lgkmcnt(0)
    s_barrier
    s_add_u32 s64, s87, 384
    s_and_b32 s64, s64, 511
    s_or_b32 s64, s64, 512
    s_xor_b32 s64, s64, s66
    s_mul_i32 s65, s64, 3072
    s_add_u32 m0, s30, 40960
    s_nop 0
    buffer_load_dwordx4 v8, s[40:43], s64 offen offset:0 lds
    buffer_load_dwordx4 v9, s[40:43], s64 offen offset:1024 lds
    v_lshlrev_b32 v2, 16, v48
    v_and_b32 v3, 0xffff0000, v48
    v_add_f32 v24, v24, v2
    v_add_f32 v25, v25, v3
    buffer_load_dwordx4 v10, s[40:43], s64 offen offset:2048 lds
    v_lshlrev_b32 v4, 16, v49
    v_and_b32 v5, 0xffff0000, v49
    v_add_f32 v26, v26, v4
    v_add_f32 v27, v27, v5
    buffer_load_dwordx4 v11, s[40:43], s64 offen offset:3072 lds
    v_lshlrev_b32 v2, 16, v50
    v_and_b32 v3, 0xffff0000, v50
    v_add_f32 v28, v28, v2
    v_add_f32 v29, v29, v3
    s_add_u32 m0, s31, 40960
    s_nop 0
    buffer_load_dwordx4 v12, s[44:47], s65 offen offset:0 lds
    v_lshlrev_b32 v4, 16, v51
    v_and_b32 v5, 0xffff0000, v51
    v_add_f32 v30, v30, v4
    v_add_f32 v31, v31, v5
    buffer_load_dwordx4 v13, s[44:47], s65 offen offset:1024 lds
    v_lshlrev_b32 v2, 16, v52
    v_and_b32 v3, 0xffff0000, v52
    v_add_f32 v24, v24, v2
    v_add_f32 v25, v25, v3
    s_add_u32 m0, s31, 49152
    s_nop 0
    buffer_load_dwordx4 v14, s[44:47], s65 offen offset:0 lds
    v_lshlrev_b32 v4, 16, v53
    v_and_b32 v5, 0xffff0000, v53
    v_add_f32 v26, v26, v4
    v_add_f32 v27, v27, v5
    buffer_load_dwordx4 v15, s[44:47], s65 offen offset:1024 lds
    v_lshlrev_b32 v2, 16, v54
    v_and_b32 v3, 0xffff0000, v54
    v_add_f32 v28, v28, v2
    v_add_f32 v29, v29, v3
    s_add_u32 m0, s31, 57344
    s_nop 0
    buffer_load_dwordx4 v16, s[44:47], s65 offen offset:0 lds
    v_lshlrev_b32 v4, 16, v55
    v_and_b32 v5, 0xffff0000, v55
    v_add_f32 v30, v30, v4
    v_add_f32 v31, v31, v5
    buffer_load_dwordx4 v17, s[44:47], s65 offen offset:1024 lds
    s_add_u32 s3, s79, 0
    buffer_store_dwordx4 v[248:251], v252, s[48:51], s3 offen sc1
    s_add_u32 s3, s79, 32768
    buffer_store_dwordx4 v[248:251], v252, s[48:51], s3 offen sc1
    s_waitcnt vmcnt(14)
    s_waitcnt lgkmcnt(0)
    s_barrier
    s_waitcnt vmcnt(12)
    s_mov_b32 s29, 0
L_k1:
    v_cmp_ne_u32 vcc, s86, v75
    v_cmp_ne_u32 s[92:93], s86, v76
    s_nop 0
    s_or_b64 vcc, vcc, s[92:93]
    s_cbranch_vccz L_k1k
    s_add_u32 s29, s29, 1
    s_cmp_ge_u32 s29, 200000
    s_cbranch_scc1 L_k1k
    s_sleep 2
    s_lshl_b32 s3, s36, 10
    buffer_load_dwordx4 v[72:75], v252, s[48:51], s3 offen sc1
    s_lshl_b32 s3, s37, 6
    buffer_load_dword v76, v232, s[48:51], s3 offen offset:12 sc1
    s_waitcnt vmcnt(0)
    s_branch L_k1
L_k1k:
    s_add_u32 s64, s87, 0
    s_and_b32 s64, s64, 511
    s_or_b32 s64, s64, 1024
    s_xor_b32 s64, s64, s66
    s_mul_i32 s65, s64, 3072
    s_add_u32 m0, s30, 81920
    s_nop 0
    buffer_load_dwordx4 v8, s[40:43], s64 offen offset:0 lds
    buffer_load_dwordx4 v9, s[40:43], s64 offen offset:1024 lds
    v_lshlrev_b32 v2, 16, v56
    v_and_b32 v3, 0xffff0000, v56
    v_add_f32 v24, v24, v2
    v_add_f32 v25, v25, v3
    buffer_load_dwordx4 v10, s[40:43], s64 offen offset:2048 lds
    v_lshlrev_b32 v4, 16, v57
    v_and_b32 v5, 0xffff0000, v57
    v_add_f32 v26, v26, v4
    v_add_f32 v27, v27, v5
    buffer_load_dwordx4 v11, s[40:43], s64 offen offset:3072 lds
    v_lshlrev_b32 v2, 16, v58
    v_and_b32 v3, 0xffff0000, v58
    v_add_f32 v28, v28, v2
    v_add_f32 v29, v29, v3
    s_add_u32 m0, s31, 81920
    s_nop 0
    buffer_load_dwordx4 v12, s[44:47], s65 offen offset:0 lds
    v_lshlrev_b32 v4, 16, v59
    v_and_b32 v5, 0xffff0000, v59
    v_add_f32 v30, v30, v4
    v_add_f32 v31, v31, v5
    buffer_load_dwordx4 v13, s[44:47], s65 offen offset:1024 lds
    v_lshlrev_b32 v2, 16, v60
    v_and_b32 v3, 0xffff0000, v60
    v_add_f32 v24, v24, v2
    v_add_f32 v25, v25, v3
    s_add_u32 m0, s31, 90112
    s_nop 0
    buffer_load_dwordx4 v14, s[44:47], s65 offen offset:0 lds
    v_lshlrev_b32 v4, 16, v61
    v_and_b32 v5, 0xffff0000, v61
    v_add_f32 v26, v26, v4
    v_add_f32 v27, v27, v5
    buffer_load_dwordx4 v15, s[44:47], s65 offen offset:1024 lds
    v_lshlrev_b32 v2, 16, v62
    v_and_b32 v3, 0xffff0000, v62
    v_add_f32 v28, v28, v2
    v_add_f32 v29, v29, v3
    s_add_u32 m0, s31, 98304
    s_nop 0
    buffer_load_dwordx4 v16, s[44:47], s65 offen offset:0 lds
    v_lshlrev_b32 v4, 16, v63
    v_and_b32 v5, 0xffff0000, v63
    v_add_f32 v30, v30, v4
    v_add_f32 v31, v31, v5
    buffer_load_dwordx4 v17, s[44:47], s65 offen offset:1024 lds
    s_waitcnt vmcnt(12)
    s_waitcnt lgkmcnt(0)
    s_barrier
    v_max_u32 v74, v74, v74 quad_perm:[1,0,3,2] row_mask:0xf bank_mask:0xf
    s_nop 1
    v_max_u32 v74, v74, v74 quad_perm:[2,3,0,1] row_mask:0xf bank_mask:0xf
    s_nop 1
    v_max_u32 v74, v74, v74 row_half_mirror row_mask:0xf bank_mask:0xf
    s_nop 1
    v_max_u32 v74, v74, v74 row_mirror row_mask:0xf bank_mask:0xf
    v_and_b32 v2, 0xffff0000, v72
    v_lshlrev_b32 v224, 16, v72
    v_and_b32 v3, 0xffff0000, v73
    v_lshlrev_b32 v225, 16, v73
    v_rcp_f32 v226, v2
    v_rcp_f32 v227, v3
    v_lshrrev_b32 v2, 16, v2
    v_or_b32 v236, v2, v3
    v_mul_f32 v228, 1069066811, v226
    v_mul_f32 v229, 1069066811, v227
    v_readlane_b32 s70, v74, 0
    v_readlane_b32 s3, v74, 16
    v_readlane_b32 s28, v74, 32
    v_readlane_b32 s29, v74, 48
    s_max_u32 s70, s70, s3
    s_max_u32 s28, s28, s29
    s_max_u32 s70, s70, s28
    v_permlane32_swap_b32 v24, v28
    v_permlane32_swap_b32 v25, v29
    v_permlane32_swap_b32 v26, v30
    v_permlane32_swap_b32 v27, v31
    v_add_f32 v24, v24, v28
    v_add_f32 v25, v25, v29
    v_add_f32 v26, v26, v30
    v_add_f32 v27, v27, v31
    s_nop 0
    v_permlane16_swap_b32 v24, v26
    v_permlane16_swap_b32 v25, v27
    v_add_f32 v24, v24, v26
    v_add_f32_e64 v25, v25, v27
    s_nop 0
    v_add_f32 v24, v24, v24 row_ror:8 row_mask:0xf bank_mask:0xf
    v_add_f32 v25, v25, v25 row_ror:8 row_mask:0xf bank_mask:0xf
    v_and_b32 v2, 8, v1
    v_cmp_eq_u32 vcc, 0, v2
    s_nop 1
    v_cndmask_b32 v24, v25, v24, vcc
    s_cmp_eq_u32 s38, 3
    s_cselect_b64 exec, -1, 0
    v_mov_b32 v24, s70
    s_mov_b64 exec, -1
    buffer_store_dword v24, v253, s[48:51], s67 offen sc1
    s_add_u32 s64, s87, 128
    s_and_b32 s64, s64, 511
    s_or_b32 s64, s64, 1024
    s_xor_b32 s64, s64, s66
    s_mul_i32 s65, s64, 3072
    s_add_u32 m0, s30, 0
    s_nop 0
    buffer_load_dwordx4 v8, s[40:43], s64 offen offset:0 lds
    buffer_load_dwordx4 v9, s[40:43], s64 offen offset:1024 lds
    buffer_load_dwordx4 v10, s[40:43], s64 offen offset:2048 lds
    buffer_load_dwordx4 v11, s[40:43], s64 offen offset:3072 lds
    s_add_u32 m0, s31, 0
    s_nop 0
    buffer_load_dwordx4 v12, s[44:47], s65 offen offset:0 lds
    buffer_load_dwordx4 v13, s[44:47], s65 offen offset:1024 lds
    s_add_u32 m0, s31, 8192
    s_nop 0
    buffer_load_dwordx4 v14, s[44:47], s65 offen offset:0 lds
    buffer_load_dwordx4 v15, s[44:47], s65 offen offset:1024 lds
    s_add_u32 m0, s31, 16384
    s_nop 0
    buffer_load_dwordx4 v16, s[44:47], s65 offen offset:0 lds
    buffer_load_dwordx4 v17, s[44:47], s65 offen offset:1024 lds
    s_waitcnt vmcnt(11)
    s_waitcnt lgkmcnt(0)
    s_barrier
    s_add_u32 s64, s87, 256
    s_and_b32 s64, s64, 511
    s_or_b32 s64, s64, 1024
    s_xor_b32 s64, s64, s66
    s_mul_i32 s65, s64, 3072
    s_add_u32 m0, s30, 40960
    s_nop 0
    buffer_load_dwordx4 v8, s[40:43], s64 offen offset:0 lds
    buffer_load_dwordx4 v9, s[40:43], s64 offen offset:1024 lds
    buffer_load_dwordx4 v10, s[40:43], s64 offen offset:2048 lds
    buffer_load_dwordx4 v11, s[40:43], s64 offen offset:3072 lds
    s_add_u32 m0, s31, 40960
    s_nop 0
    buffer_load_dwordx4 v12, s[44:47], s65 offen offset:0 lds
    buffer_load_dwordx4 v13, s[44:47], s65 offen offset:1024 lds
    s_add_u32 m0, s31, 49152
    s_nop 0
    buffer_load_dwordx4 v14, s[44:47], s65 offen offset:0 lds
    buffer_load_dwordx4 v15, s[44:47], s65 offen offset:1024 lds
    s_add_u32 m0, s31, 57344
    s_nop 0
    s_nop 0
    buffer_load_dwordx4 v16, s[44:47], s65 offen offset:0 lds
    buffer_load_dwordx4 v17, s[44:47], s65 offen offset:1024 lds
    s_add_u32 s3, s79, 65536
    buffer_store_dwordx4 v[248:251], v252, s[48:51], s3 offen sc1
    s_add_u32 s3, s79, 98304
    buffer_store_dwordx4 v[248:251], v252, s[48:51], s3 offen sc1
    s_waitcnt vmcnt(12)
    s_waitcnt lgkmcnt(0)
    s_barrier
    s_add_u32 s64, s87, 384
    s_and_b32 s64, s64, 511
    s_or_b32 s64, s64, 1024
    s_xor_b32 s64, s64, s66
    s_mul_i32 s65, s64, 3072
    s_add_u32 m0, s30, 81920
    s_nop 0
    buffer_load_dwordx4 v8, s[40:43], s64 offen offset:0 lds
    buffer_load_dwordx4 v9, s[40:43], s64 offen offset:1024 lds
    buffer_load_dwordx4 v10, s[40:43], s64 offen offset:2048 lds
    buffer_load_dwordx4 v11, s[40:43], s64 offen offset:3072 lds
    s_add_u32 m0, s31, 81920
    s_nop 0
    buffer_load_dwordx4 v12, s[44:47], s65 offen offset:0 lds
    buffer_load_dwordx4 v13, s[44:47], s65 offen offset:1024 lds
    s_add_u32 m0, s31, 90112
    s_nop 0
    buffer_load_dwordx4 v14, s[44:47], s65 offen offset:0 lds
    buffer_load_dwordx4 v15, s[44:47], s65 offen offset:1024 lds
    s_add_u32 m0, s31, 98304
    s_nop 0
    buffer_load_dwordx4 v16, s[44:47], s65 offen offset:0 lds
    buffer_load_dwordx4 v17, s[44:47], s65 offen offset:1024 lds
    s_lshl_b32 s3, s37, 14
    s_add_u32 s3, s3, 524288
    s_add_u32 s28, s3, 0
    buffer_load_dwordx4 v[80:83], v235, s[48:51], s28 offen sc1
    s_add_u32 s28, s3, 4096
    buffer_load_dwordx4 v[84:87], v235, s[48:51], s28 offen sc1
    s_waitcnt vmcnt(14)
    s_waitcnt lgkmcnt(0)
    s_barrier
    s_lshl_b32 s3, s37, 14
    s_add_u32 s3, s3, 524288
    s_add_u32 s28, s3, 8192
    buffer_load_dwordx4 v[88:91], v235, s[48:51], s28 offen sc1
    s_add_u32 s28, s3, 12288
    buffer_load_dwordx4 v[92:95], v235, s[48:51], s28 offen sc1
    s_add_u32 s64, s87, 0
    s_and_b32 s64, s64, 511
    s_or_b32 s64, s64, 1536
    s_xor_b32 s64, s64, s66
    s_mul_i32 s65, s64, 3072
    s_add_u32 m0, s30, 0
    s_nop 0
    buffer_load_dwordx4 v8, s[40:43], s64 offen offset:0 lds
    buffer_load_dwordx4 v9, s[40:43], s64 offen offset:1024 lds
    buffer_load_dwordx4 v10, s[40:43], s64 offen offset:2048 lds
    buffer_load_dwordx4 v11, s[40:43], s64 offen offset:3072 lds
    s_add_u32 m0, s31, 0
    s_nop 0
    buffer_load_dwordx4 v12, s[44:47], s65 offen offset:0 lds
    buffer_load_dwordx4 v13, s[44:47], s65 offen offset:1024 lds
    s_add_u32 m0, s31, 8192
    s_nop 0
    buffer_load_dwordx4 v14, s[44:47], s65 offen offset:0 lds
    buffer_load_dwordx4 v15, s[44:47], s65 offen offset:1024 lds
    s_add_u32 m0, s31, 16384
    s_nop 0
    buffer_load_dwordx4 v16, s[44:47], s65 offen offset:0 lds
    buffer_load_dwordx4 v17, s[44:47], s65 offen offset:1024 lds
    s_waitcnt vmcnt(14)
    s_waitcnt lgkmcnt(0)
    s_barrier
    s_waitcnt vmcnt(10)
    s_mov_b32 s29, 0
L_k2:
    s_nop 0
    v_max3_u32 v2, v80, v81, v82
    v_max3_u32 v2, v2, v83, v84
    v_max3_u32 v2, v2, v85, v86
    v_max3_u32 v2, v2, v87, v88
    v_max3_u32 v2, v2, v89, v90
    v_max3_u32 v2, v2, v91, v92
    v_max3_u32 v2, v2, v93, v94
    v_max_u32 v2, v2, v95
    v_cmp_eq_u32 vcc, -1, v2
    s_cbranch_vccz L_k2k
    s_add_u32 s29, s29, 1
    s_cmp_ge_u32 s29, 200000
    s_cbranch_scc1 L_k2k
    s_sleep 1
    s_lshl_b32 s3, s37, 14
    s_add_u32 s3, s3, 524288
    s_add_u32 s28, s3, 0
    buffer_load_dwordx4 v[80:83], v235, s[48:51], s28 offen sc1
    s_add_u32 s28, s3, 4096
    buffer_load_dwordx4 v[84:87], v235, s[48:51], s28 offen sc1
    s_add_u32 s28, s3, 8192
    buffer_load_dwordx4 v[88:91], v235, s[48:51], s28 offen sc1
    s_add_u32 s28, s3, 12288
    buffer_load_dwordx4 v[92:95], v235, s[48:51], s28 offen sc1
    s_waitcnt vmcnt(0)
    s_branch L_k2
L_k2k:
    v_max3_u32 v2, v80, v84, v88
    v_max_u32 v2, v2, v92
    v_add_f32 v80, v80, v88
    v_add_f32 v81, v81, v89
    v_add_f32 v82, v82, v90
    v_add_f32 v83, v83, v91
    v_add_f32 v84, v84, v92
    v_add_f32 v85, v85, v93
    v_add_f32 v86, v86, v94
    v_add_f32 v87, v87, v95
    v_add_f32 v80, v80, v84
    v_add_f32 v81, v81, v85
    v_add_f32 v82, v82, v86
    v_add_f32_e64 v83, v83, v87
    v_readlane_b32 s70, v2, 12
    v_readlane_b32 s3, v2, 28
    v_readlane_b32 s28, v2, 44
    v_readlane_b32 s29, v2, 60
    s_max_u32 s70, s70, s3
    s_max_u32 s28, s28, s29
    s_max_u32 s70, s70, s28
    v_permlane32_swap_b32 v80, v82
    v_permlane32_swap_b32 v81, v83
    v_add_f32 v80, v80, v82
    v_add_f32 v81, v81, v83
    s_nop 1
    v_permlane16_swap_b32 v80, v81
    v_add_f32 v80, v80, v81
    s_mov_b32 exec_lo, 0xf000f000
    s_mov_b32 exec_hi, 0xf000f000
    v_mov_b32 v80, s70
    s_mov_b64 exec, -1
    s_and_b32 s68, s70, 0x7ff
    s_sub_u32 s68, 2047, s68
    s_lshl_b32 s3, s68, 11
    s_and_b32 s28, s77, 3
    s_lshl_b32 s28, s28, 9
    s_add_u32 s3, s3, s28
    s_lshr_b32 s28, s38, 1
    s_lshl_b32 s28, s28, 8
    s_add_u32 s3, s3, s28
    v_lshrrev_b32 v3, 3, v1
    v_lshlrev_b32_e64 v3, 5, v3
    buffer_load_dwordx4 v[64:67], v3, s[40:43], s3 offen
    buffer_load_dwordx4 v[68:71], v3, s[40:43], s3 offen offset:16
    s_lshr_b32 s3, s68, 1
    s_lshl_b32 s3, s3, 4
    s_and_b32 s28, s68, 1
    s_lshl_b32 s28, s28, 2
    s_add_u32 s3, s3, s28
    v_mov_b32 v3, 0
    buffer_load_dword v116, v3, s[48:51], s3 offen sc1
    s_add_u32 s64, s87, 128
    s_and_b32 s64, s64, 511
    s_or_b32 s64, s64, 1536
    s_xor_b32 s64, s64, s66
    s_mul_i32 s65, s64, 3072
    s_add_u32 m0, s30, 40960
    s_nop 0
    buffer_load_dwordx4 v8, s[40:43], s64 offen offset:0 lds
    buffer_load_dwordx4 v9, s[40:43], s64 offen offset:1024 lds
    buffer_load_dwordx4 v10, s[40:43], s64 offen offset:2048 lds
    buffer_load_dwordx4 v11, s[40:43], s64 offen offset:3072 lds
    s_add_u32 m0, s31, 40960
    s_nop 0
    buffer_load_dwordx4 v12, s[44:47], s65 offen offset:0 lds
    buffer_load_dwordx4 v13, s[44:47], s65 offen offset:1024 lds
    s_add_u32 m0, s31, 49152
    s_nop 0
    buffer_load_dwordx4 v14, s[44:47], s65 offen offset:0 lds
    buffer_load_dwordx4 v15, s[44:47], s65 offen offset:1024 lds
    s_add_u32 m0, s31, 57344
    s_nop 0
    buffer_load_dwordx4 v16, s[44:47], s65 offen offset:0 lds
    buffer_load_dwordx4 v17, s[44:47], s65 offen offset:1024 lds
    s_waitcnt vmcnt(13)
    s_waitcnt lgkmcnt(0)
    s_barrier
    s_add_u32 s64, s87, 256
    s_and_b32 s64, s64, 511
    s_or_b32 s64, s64, 1536
    s_xor_b32 s64, s64, s66
    s_mul_i32 s65, s64, 3072
    s_add_u32 m0, s30, 81920
    s_nop 0
    buffer_load_dwordx4 v8, s[40:43], s64 offen offset:0 lds
    buffer_load_dwordx4 v9, s[40:43], s64 offen offset:1024 lds
    buffer_load_dwordx4 v10, s[40:43], s64 offen offset:2048 lds
    buffer_load_dwordx4 v11, s[40:43], s64 offen offset:3072 lds
    s_add_u32 m0, s31, 81920
    s_nop 0
    buffer_load_dwordx4 v12, s[44:47], s65 offen offset:0 lds
    buffer_load_dwordx4 v13, s[44:47], s65 offen offset:1024 lds
    s_add_u32 m0, s31, 90112
    s_nop 0
    buffer_load_dwordx4 v14, s[44:47], s65 offen offset:0 lds
    buffer_load_dwordx4 v15, s[44:47], s65 offen offset:1024 lds
    s_add_u32 m0, s31, 98304
    s_nop 0
    buffer_load_dwordx4 v16, s[44:47], s65 offen offset:0 lds
    buffer_load_dwordx4 v17, s[44:47], s65 offen offset:1024 lds
    s_or_b32 s3, s2, s38
    s_mov_b32 s28, 16384
    s_cmp_lg_u32 s3, 0
    s_cselect_b32 s3, 268435456, s28
    v_mov_b32 v2, s86
    s_mov_b64 exec, 1
    buffer_store_dword v2, v252, s[48:51], s3 offen sc1
    s_mov_b64 exec, -1
    s_waitcnt vmcnt(11)
    s_waitcnt lgkmcnt(0)
    s_barrier
    s_add_u32 s64, s87, 384
    s_and_b32 s64, s64, 511
    s_or_b32 s64, s64, 1536
    s_xor_b32 s64, s64, s66
    s_mul_i32 s65, s64, 3072
    s_add_u32 m0, s30, 0
    s_nop 0
    buffer_load_dwordx4 v8, s[40:43], s64 offen offset:0 lds
    buffer_load_dwordx4 v9, s[40:43], s64 offen offset:1024 lds
    v_and_b32 v5, 0xffff0000, v116
    v_lshlrev_b32 v116, 16, v116
    v_rcp_f32 v117, v5
    v_lshlrev_b32_e64 v96, 16, v64
    v_and_b32 v97, 0xffff0000, v64
    buffer_load_dwordx4 v10, s[40:43], s64 offen offset:2048 lds
    v_lshlrev_b32 v98, 16, v65
    v_and_b32 v99, 0xffff0000, v65
    v_lshlrev_b32 v100, 16, v66
    v_and_b32 v101, 0xffff0000, v66
    v_lshlrev_b32_e64 v102, 16, v67
    buffer_load_dwordx4 v11, s[40:43], s64 offen offset:3072 lds
    v_and_b32 v103, 0xffff0000, v67
    v_lshlrev_b32 v104, 16, v68
    v_and_b32 v105, 0xffff0000, v68
    v_lshlrev_b32 v106, 16, v69
    v_and_b32 v107, 0xffff0000, v69
    s_add_u32 m0, s31, 0
    s_nop 0
    buffer_load_dwordx4 v12, s[44:47], s65 offen offset:0 lds
    v_lshlrev_b32 v108, 16, v70
    v_and_b32 v109, 0xffff0000, v70
    v_lshlrev_b32 v110, 16, v71
    v_and_b32 v111, 0xffff0000, v71
    v_mul_f32_e64 v119, v116, v117
    buffer_load_dwordx4 v13, s[44:47], s65 offen offset:1024 lds
    v_fma_f32 v96, v96, v117, -v119
    v_fma_f32 v97, v97, v117, -v119
    v_fma_f32 v98, v98, v117, -v119
    v_fma_f32 v99, v99, v117, -v119
    v_fma_f32 v100, v100, v117, -v119
    s_add_u32 m0, s31, 8192
    s_nop 0
    s_nop 0
    buffer_load_dwordx4 v14, s[44:47], s65 offen offset:0 lds
    v_fma_f32 v101, v101, v117, -v119
    v_fma_f32 v102, v102, v117, -v119
    v_fma_f32 v103, v103, v117, -v119
    v_fma_f32 v104, v104, v117, -v119
    v_fma_f32 v105, v105, v117, -v119
    buffer_load_dwordx4 v15, s[44:47], s65 offen offset:1024 lds
    v_fma_f32 v106, v106, v117, -v119
    v_fma_f32 v107, v107, v117, -v119
    v_fma_f32 v108, v108, v117, -v119
    v_fma_f32 v109, v109, v117, -v119
    v_fma_f32 v110, v110, v117, -v119
    s_add_u32 m0, s31, 16384
    s_nop 0
    buffer_load_dwordx4 v16, s[44:47], s65 offen offset:0 lds
    v_fma_f32 v111, v111, v117, -v119
    v_mov_b32 v120, 0
    v_mov_b32 v121, 0
    v_mov_b32 v122, 0
    v_mov_b32 v123, 0
    buffer_load_dwordx4 v17, s[44:47], s65 offen offset:1024 lds
    v_mov_b32 v124, 0
    v_mov_b32 v125, 0
    v_mov_b32 v126, 0
    v_mov_b32 v127, 0
    s_waitcnt vmcnt(11)
    s_waitcnt lgkmcnt(0)
    s_barrier
    s_mov_b32 s3, 28672
    buffer_load_dwordx4 v[144:147], v21, s[52:55], s3 offen nt
    s_mov_b32 s3, 35840
    buffer_load_dwordx4 v[148:151], v21, s[52:55], s3 offen nt
    s_mov_b32 s3, 43008
    buffer_load_dwordx4 v[152:155], v21, s[52:55], s3 offen nt
    s_mov_b32 s3, 50176
    buffer_load_dwordx4 v[156:159], v21, s[52:55], s3 offen nt
    s_mov_b32 s3, 57344
    buffer_load_dwordx4 v[160:163], v21, s[52:55], s3 offen nt
    s_mov_b32 s3, 64512
    buffer_load_dwordx4 v[164:167], v21, s[52:55], s3 offen nt
    s_mov_b32 s3, 71680
    buffer_load_dwordx4 v[168:171], v21, s[52:55], s3 offen nt
    s_mov_b32 s3, 78848
    buffer_load_dwordx4 v[172:175], v21, s[52:55], s3 offen nt
    ds_write_b32 v233, v80
    s_lshl_b32 s3, s38, 4
    s_lshl_b64 exec, 0xffff, s3
    ds_write_b64 v230, v[224:225]
    ds_write_b64 v230, v[226:227] offset:1024
    ds_write_b64 v230, v[228:229] offset:2048
    ds_write_b32 v231, v236
    s_mov_b64 exec, -1
    v_lshlrev_b32 v2, 16, v128
    v_and_b32 v3, 0xffff0000, v128
    v_fmac_f32 v120, v2, v96
    v_fmac_f32 v121, v3, v96
    v_lshlrev_b32 v4, 16, v129
    v_and_b32 v5, 0xffff0000, v129
    v_fmac_f32 v122, v4, v96
    v_fmac_f32 v123, v5, v96
    v_lshlrev_b32 v2, 16, v130
    v_and_b32 v3, 0xffff0000, v130
    v_fmac_f32 v124, v2, v96
    v_fmac_f32 v125, v3, v96
    v_lshlrev_b32 v4, 16, v131
    v_and_b32 v5, 0xffff0000, v131
    v_fmac_f32 v126, v4, v96
    v_fmac_f32 v127, v5, v96
    v_lshlrev_b32 v2, 16, v132
    v_and_b32 v3, 0xffff0000, v132
    v_fmac_f32 v120, v2, v97
    v_fmac_f32 v121, v3, v97
    v_lshlrev_b32 v4, 16, v133
    v_and_b32 v5, 0xffff0000, v133
    v_fmac_f32 v122, v4, v97
    v_fmac_f32 v123, v5, v97
    v_lshlrev_b32 v2, 16, v134
    v_and_b32 v3, 0xffff0000, v134
    v_fmac_f32 v124, v2, v97
    v_fmac_f32 v125, v3, v97
    v_lshlrev_b32 v4, 16, v135
    v_and_b32 v5, 0xffff0000, v135
    v_fmac_f32 v126, v4, v97
    v_fmac_f32 v127, v5, v97
    v_lshlrev_b32 v2, 16, v136
    v_and_b32 v3, 0xffff0000, v136
    v_fmac_f32 v120, v2, v98
    v_fmac_f32 v121, v3, v98
    v_lshlrev_b32 v4, 16, v137
    v_and_b32 v5, 0xffff0000, v137
    v_fmac_f32 v122, v4, v98
    v_fmac_f32 v123, v5, v98
    v_lshlrev_b32 v2, 16, v138
    v_and_b32 v3, 0xffff0000, v138
    v_fmac_f32 v124, v2, v98
    v_fmac_f32 v125, v3, v98
    v_lshlrev_b32 v4, 16, v139
    v_and_b32 v5, 0xffff0000, v139
    v_fmac_f32 v126, v4, v98
    v_fmac_f32 v127, v5, v98
    v_lshlrev_b32 v2, 16, v140
    v_and_b32 v3, 0xffff0000, v140
    v_fmac_f32 v120, v2, v99
    v_fmac_f32 v121, v3, v99
    v_lshlrev_b32 v4, 16, v141
    v_and_b32 v5, 0xffff0000, v141
    v_fmac_f32 v122, v4, v99
    v_fmac_f32 v123, v5, v99
    v_lshlrev_b32 v2, 16, v142
    v_and_b32 v3, 0xffff0000, v142
    v_fmac_f32 v124, v2, v99
    v_fmac_f32 v125, v3, v99
    v_lshlrev_b32 v4, 16, v143
    v_and_b32 v5, 0xffff0000, v143
    v_fmac_f32 v126, v4, v99
    v_fmac_f32 v127, v5, v99
    s_waitcnt vmcnt(8)
    s_waitcnt lgkmcnt(0)
    s_barrier
    v_xor_b32 v2, 0, v23
    ds_read_b64 v[240:241], v2
    v_xor_b32 v2, 32, v23
    ds_read_b64 v[242:243], v2
    v_xor_b32 v2, 64, v23
    ds_read_b64 v[244:245], v2
    v_xor_b32 v2, 96, v23
    ds_read_b64 v[246:247], v2
    s_waitcnt lgkmcnt(0)
    s_barrier
    v_and_b32 v2, 15, v1
    v_min_u32 v2, 13, v2
    v_lshrrev_b32_e64 v3, 4, v1
    v_mul_u32_u24 v3, 14336, v3
    v_lshl_add_u32 v13, v2, 4, v3
    s_lshl_b32 s75, s71, 2
    s_add_u32 s75, s75, 1183744
    s_add_u32 m0, s72, 0
    s_add_u32 s3, s73, 0
    s_nop 0
    buffer_load_dwordx4 v220, s[88:91], s3 offen offset:0 lds
    buffer_load_dwordx4 v221, s[88:91], s3 offen offset:1024 lds
    buffer_load_dwordx4 v222, s[88:91], s3 offen offset:2048 lds
    buffer_load_dwordx4 v223, s[88:91], s3 offen offset:3072 lds
    s_add_u32 m0, s72, 16384
    s_add_u32 s3, s73, 262144
    buffer_load_dwordx4 v220, s[88:91], s3 offen offset:0 lds
    buffer_load_dwordx4 v221, s[88:91], s3 offen offset:1024 lds
    buffer_load_dwordx4 v222, s[88:91], s3 offen offset:2048 lds
    buffer_load_dwordx4 v223, s[88:91], s3 offen offset:3072 lds
    s_add_u32 m0, s72, 65536
    s_add_u32 s3, s73, 1048576
    buffer_load_dwordx4 v220, s[88:91], s3 offen offset:0 lds
    buffer_load_dwordx4 v221, s[88:91], s3 offen offset:1024 lds
    buffer_load_dwordx4 v222, s[88:91], s3 offen offset:2048 lds
    buffer_load_dwordx4 v223, s[88:91], s3 offen offset:3072 lds
    s_mov_b32 s3, 86016
    buffer_load_dwordx4 v[176:179], v21, s[52:55], s3 offen nt
    s_mov_b32 s3, 93184
    buffer_load_dwordx4 v[180:183], v21, s[52:55], s3 offen nt
    s_mov_b32 s3, 100352
    buffer_load_dwordx4 v[184:187], v21, s[52:55], s3 offen nt
    s_mov_b32 s3, 107520
    buffer_load_dwordx4 v[188:191], v21, s[52:55], s3 offen nt
    s_lshr_b32 s3, s71, 3
    s_add_u32 s3, s3, 0
    s_and_b32 s28, s3, 7
    s_lshr_b32 s3, s3, 3
    s_lshl_b32 s3, s3, 6
    s_add_u32 s3, s3, s28
    s_lshl_b32 s3, s3, 11
    buffer_load_dwordx4 v[192:195], v22, s[56:59], s3 offen nt
    s_lshr_b32 s3, s71, 3
    s_add_u32 s3, s3, 1
    s_and_b32 s28, s3, 7
    s_lshr_b32 s3, s3, 3
    s_lshl_b32 s3, s3, 6
    s_add_u32 s3, s3, s28
    s_lshl_b32 s3, s3, 11
    buffer_load_dwordx4 v[196:199], v22, s[56:59], s3 offen nt
    s_lshr_b32 s3, s71, 3
    s_add_u32 s3, s3, 2
    s_and_b32 s28, s3, 7
    s_lshr_b32 s3, s3, 3
    s_lshl_b32 s3, s3, 6
    s_add_u32 s3, s3, s28
    s_lshl_b32 s3, s3, 11
    buffer_load_dwordx4 v[200:203], v22, s[56:59], s3 offen nt
    s_waitcnt vmcnt(19)
    v_lshlrev_b32_e64 v2, 16, v144
    v_and_b32 v3, 0xffff0000, v144
    v_pk_fma_f32 v[120:121], v[2:3], v[100:101], v[120:121] op_sel_hi:[1,0,1]
    v_lshlrev_b32_e64 v4, 16, v145
    v_and_b32 v5, 0xffff0000, v145
    v_pk_fma_f32 v[122:123], v[4:5], v[100:101], v[122:123] op_sel_hi:[1,0,1]
    v_lshlrev_b32_e64 v2, 16, v146
    v_and_b32 v3, 0xffff0000, v146
    v_pk_fma_f32 v[124:125], v[2:3], v[100:101], v[124:125] op_sel_hi:[1,0,1]
    v_lshlrev_b32_e64 v4, 16, v147
    v_and_b32 v5, 0xffff0000, v147
    v_pk_fma_f32 v[126:127], v[4:5], v[100:101], v[126:127] op_sel_hi:[1,0,1]
    v_lshlrev_b32 v2, 16, v148
    v_and_b32 v3, 0xffff0000, v148
    v_mov_b32 v100, v101
    v_pk_fma_f32 v[120:121], v[2:3], v[100:101], v[120:121] op_sel_hi:[1,0,1]
    v_lshlrev_b32_e64 v4, 16, v149
    v_and_b32 v5, 0xffff0000, v149
    v_pk_fma_f32 v[122:123], v[4:5], v[100:101], v[122:123] op_sel_hi:[1,0,1]
    v_lshlrev_b32_e64 v2, 16, v150
    v_and_b32 v3, 0xffff0000, v150
    v_pk_fma_f32 v[124:125], v[2:3], v[100:101], v[124:125] op_sel_hi:[1,0,1]
    v_lshlrev_b32_e64 v4, 16, v151
    v_and_b32 v5, 0xffff0000, v151
    v_pk_fma_f32 v[126:127], v[4:5], v[100:101], v[126:127] op_sel_hi:[1,0,1]
    v_lshlrev_b32_e64 v2, 16, v152
    v_and_b32 v3, 0xffff0000, v152
    v_pk_fma_f32 v[120:121], v[2:3], v[102:103], v[120:121] op_sel_hi:[1,0,1]
    v_lshlrev_b32_e64 v4, 16, v153
    v_and_b32 v5, 0xffff0000, v153
    v_pk_fma_f32 v[122:123], v[4:5], v[102:103], v[122:123] op_sel_hi:[1,0,1]
    v_lshlrev_b32_e64 v2, 16, v154
    v_and_b32 v3, 0xffff0000, v154
    v_pk_fma_f32 v[124:125], v[2:3], v[102:103], v[124:125] op_sel_hi:[1,0,1]
    v_lshlrev_b32_e64 v4, 16, v155
    v_and_b32 v5, 0xffff0000, v155
    v_pk_fma_f32 v[126:127], v[4:5], v[102:103], v[126:127] op_sel_hi:[1,0,1]
    v_lshlrev_b32 v2, 16, v156
    v_and_b32 v3, 0xffff0000, v156
    v_mov_b32 v102, v103
    v_pk_fma_f32 v[120:121], v[2:3], v[102:103], v[120:121] op_sel_hi:[1,0,1]
    v_lshlrev_b32_e64 v4, 16, v157
    v_and_b32 v5, 0xffff0000, v157
    v_pk_fma_f32 v[122:123], v[4:5], v[102:103], v[122:123] op_sel_hi:[1,0,1]
    v_lshlrev_b32_e64 v2, 16, v158
    v_and_b32 v3, 0xffff0000, v158
    v_pk_fma_f32 v[124:125], v[2:3], v[102:103], v[124:125] op_sel_hi:[1,0,1]
    v_lshlrev_b32_e64 v4, 16, v159
    v_and_b32 v5, 0xffff0000, v159
    v_pk_fma_f32 v[126:127], v[4:5], v[102:103], v[126:127] op_sel_hi:[1,0,1]
    v_lshlrev_b32_e64 v2, 16, v160
    v_and_b32 v3, 0xffff0000, v160
    v_pk_fma_f32 v[120:121], v[2:3], v[104:105], v[120:121] op_sel_hi:[1,0,1]
    v_lshlrev_b32_e64 v4, 16, v161
    v_and_b32 v5, 0xffff0000, v161
    v_pk_fma_f32 v[122:123], v[4:5], v[104:105], v[122:123] op_sel_hi:[1,0,1]
    v_lshlrev_b32_e64 v2, 16, v162
    v_and_b32 v3, 0xffff0000, v162
    v_pk_fma_f32 v[124:125], v[2:3], v[104:105], v[124:125] op_sel_hi:[1,0,1]
    v_lshlrev_b32_e64 v4, 16, v163
    v_and_b32 v5, 0xffff0000, v163
    v_pk_fma_f32 v[126:127], v[4:5], v[104:105], v[126:127] op_sel_hi:[1,0,1]
    v_lshlrev_b32 v2, 16, v164
    v_and_b32 v3, 0xffff0000, v164
    v_mov_b32 v104, v105
    v_pk_fma_f32 v[120:121], v[2:3], v[104:105], v[120:121] op_sel_hi:[1,0,1]
    v_lshlrev_b32_e64 v4, 16, v165
    v_and_b32 v5, 0xffff0000, v165
    v_pk_fma_f32 v[122:123], v[4:5], v[104:105], v[122:123] op_sel_hi:[1,0,1]
    v_lshlrev_b32_e64 v2, 16, v166
    v_and_b32 v3, 0xffff0000, v166
    v_pk_fma_f32 v[124:125], v[2:3], v[104:105], v[124:125] op_sel_hi:[1,0,1]
    v_lshlrev_b32_e64 v4, 16, v167
    v_and_b32 v5, 0xffff0000, v167
    v_pk_fma_f32 v[126:127], v[4:5], v[104:105], v[126:127] op_sel_hi:[1,0,1]
    v_lshlrev_b32_e64 v2, 16, v168
    v_and_b32 v3, 0xffff0000, v168
    v_pk_fma_f32 v[120:121], v[2:3], v[106:107], v[120:121] op_sel_hi:[1,0,1]
    v_lshlrev_b32_e64 v4, 16, v169
    v_and_b32 v5, 0xffff0000, v169
    v_pk_fma_f32 v[122:123], v[4:5], v[106:107], v[122:123] op_sel_hi:[1,0,1]
    v_lshlrev_b32_e64 v2, 16, v170
    v_and_b32 v3, 0xffff0000, v170
    v_pk_fma_f32 v[124:125], v[2:3], v[106:107], v[124:125] op_sel_hi:[1,0,1]
    v_lshlrev_b32_e64 v4, 16, v171
    v_and_b32 v5, 0xffff0000, v171
    v_pk_fma_f32 v[126:127], v[4:5], v[106:107], v[126:127] op_sel_hi:[1,0,1]
    v_lshlrev_b32 v2, 16, v172
    v_and_b32 v3, 0xffff0000, v172
    v_mov_b32 v106, v107
    v_pk_fma_f32 v[120:121], v[2:3], v[106:107], v[120:121] op_sel_hi:[1,0,1]
    v_lshlrev_b32_e64 v4, 16, v173
    v_and_b32 v5, 0xffff0000, v173
    v_pk_fma_f32 v[122:123], v[4:5], v[106:107], v[122:123] op_sel_hi:[1,0,1]
    v_lshlrev_b32_e64 v2, 16, v174
    v_and_b32 v3, 0xffff0000, v174
    v_pk_fma_f32 v[124:125], v[2:3], v[106:107], v[124:125] op_sel_hi:[1,0,1]
    v_lshlrev_b32_e64 v4, 16, v175
    v_and_b32 v5, 0xffff0000, v175
    v_pk_fma_f32 v[126:127], v[4:5], v[106:107], v[126:127] op_sel_hi:[1,0,1]
    s_waitcnt vmcnt(15)
    s_waitcnt vmcnt(11)
    s_waitcnt vmcnt(7)
    s_barrier
    s_add_u32 m0, s72, 32768
    s_add_u32 s3, s73, 524288
    buffer_load_dwordx4 v220, s[88:91], s3 offen offset:0 lds
    buffer_load_dwordx4 v221, s[88:91], s3 offen offset:1024 lds
    buffer_load_dwordx4 v222, s[88:91], s3 offen offset:2048 lds
    buffer_load_dwordx4 v223, s[88:91], s3 offen offset:3072 lds
    s_add_u32 m0, s72, 49152
    s_add_u32 s3, s73, 786432
    buffer_load_dwordx4 v220, s[88:91], s3 offen offset:0 lds
    buffer_load_dwordx4 v221, s[88:91], s3 offen offset:1024 lds
    buffer_load_dwordx4 v222, s[88:91], s3 offen offset:2048 lds
    buffer_load_dwordx4 v223, s[88:91], s3 offen offset:3072 lds
    s_add_u32 m0, s72, 81920
    s_add_u32 s3, s73, 1310720
    buffer_load_dwordx4 v220, s[88:91], s3 offen offset:0 lds
    buffer_load_dwordx4 v221, s[88:91], s3 offen offset:1024 lds
    buffer_load_dwordx4 v222, s[88:91], s3 offen offset:2048 lds
    buffer_load_dwordx4 v223, s[88:91], s3 offen offset:3072 lds
    s_setprio 3
    s_cmp_lg_u32 s38, 3
    s_cbranch_scc1 L_npl
    s_mov_b32 s3, 32768
    s_mov_b32 s29, 0
    s_mov_b32 exec_lo, -1
    s_mov_b32 exec_hi, 65535
L_rp:
    buffer_load_dword v118, v113, s[48:51], s3 offen sc1
    s_waitcnt vmcnt(0)
    v_cmp_ne_u32 vcc, s86, v118
    s_cbranch_vccz L_rpk
    s_mov_b64 exec, vcc
    s_add_u32 s29, s29, 1
    s_cmp_lt_u32 s29, 200000
    s_cbranch_scc1 L_rp
L_rpk:
    s_mov_b64 exec, -1
    v_mov_b32 v4, 162128
    v_mov_b32 v5, 1
    ds_write_b32 v4, v5
L_npl:
    v_min_u32 v3, 4, v1
    v_lshlrev_b32_e64 v3, 2, v3
    v_add_u32 v3, 162112, v3
L_fw:
    ds_read_b32 v4, v3
    s_waitcnt lgkmcnt(0)
    v_cmp_eq_u32 vcc, 0, v4
    s_cbranch_vccz L_fk
    s_sleep 1
    s_branch L_fw
L_fk:
    s_waitcnt vmcnt(15)
    v_lshlrev_b32_e64 v2, 16, v176
    v_and_b32 v3, 0xffff0000, v176
    v_pk_fma_f32 v[120:121], v[2:3], v[108:109], v[120:121] op_sel_hi:[1,0,1]
    v_lshlrev_b32_e64 v4, 16, v177
    v_and_b32 v5, 0xffff0000, v177
    v_pk_fma_f32 v[122:123], v[4:5], v[108:109], v[122:123] op_sel_hi:[1,0,1]
    v_lshlrev_b32_e64 v2, 16, v178
    v_and_b32 v3, 0xffff0000, v178
    v_pk_fma_f32 v[124:125], v[2:3], v[108:109], v[124:125] op_sel_hi:[1,0,1]
    v_lshlrev_b32_e64 v4, 16, v179
    v_and_b32 v5, 0xffff0000, v179
    v_pk_fma_f32 v[126:127], v[4:5], v[108:109], v[126:127] op_sel_hi:[1,0,1]
    v_lshlrev_b32 v2, 16, v180
    v_and_b32 v3, 0xffff0000, v180
    v_mov_b32 v108, v109
    v_pk_fma_f32 v[120:121], v[2:3], v[108:109], v[120:121] op_sel_hi:[1,0,1]
    v_lshlrev_b32_e64 v4, 16, v181
    v_and_b32 v5, 0xffff0000, v181
    v_pk_fma_f32 v[122:123], v[4:5], v[108:109], v[122:123] op_sel_hi:[1,0,1]
    v_lshlrev_b32_e64 v2, 16, v182
    v_and_b32 v3, 0xffff0000, v182
    v_pk_fma_f32 v[124:125], v[2:3], v[108:109], v[124:125] op_sel_hi:[1,0,1]
    v_lshlrev_b32_e64 v4, 16, v183
    v_and_b32 v5, 0xffff0000, v183
    v_pk_fma_f32 v[126:127], v[4:5], v[108:109], v[126:127] op_sel_hi:[1,0,1]
    s_add_u32 s3, s76, 0
    buffer_load_dwordx4 v[48:51], v112, s[48:51], s3 offen sc1
    s_add_u32 s3, s76, 33792
    buffer_load_dwordx4 v[52:55], v112, s[48:51], s3 offen sc1
    s_cmp_lg_u32 s83, 0
    s_cbranch_scc1 L_nz
    s_add_u32 s3, s81, 0
    buffer_load_dwordx4 v[32:35], v112, s[48:51], s3 offen sc1
    s_add_u32 s3, s81, 33792
    buffer_load_dwordx4 v[36:39], v112, s[48:51], s3 offen sc1
L_nz:
    v_lshlrev_b32_e64 v2, 16, v184
    v_and_b32 v3, 0xffff0000, v184
    v_pk_fma_f32 v[120:121], v[2:3], v[110:111], v[120:121] op_sel_hi:[1,0,1]
    v_lshlrev_b32_e64 v4, 16, v185
    v_and_b32 v5, 0xffff0000, v185
    v_pk_fma_f32 v[122:123], v[4:5], v[110:111], v[122:123] op_sel_hi:[1,0,1]
    v_lshlrev_b32_e64 v2, 16, v186
    v_and_b32 v3, 0xffff0000, v186
    v_pk_fma_f32 v[124:125], v[2:3], v[110:111], v[124:125] op_sel_hi:[1,0,1]
    v_lshlrev_b32_e64 v4, 16, v187
    v_and_b32 v5, 0xffff0000, v187
    v_pk_fma_f32 v[126:127], v[4:5], v[110:111], v[126:127] op_sel_hi:[1,0,1]
    v_lshlrev_b32 v2, 16, v188
    v_and_b32 v3, 0xffff0000, v188
    v_mov_b32 v110, v111
    v_pk_fma_f32 v[120:121], v[2:3], v[110:111], v[120:121] op_sel_hi:[1,0,1]
    v_lshlrev_b32_e64 v4, 16, v189
    v_and_b32 v5, 0xffff0000, v189
    v_pk_fma_f32 v[122:123], v[4:5], v[110:111], v[122:123] op_sel_hi:[1,0,1]
    v_lshlrev_b32_e64 v2, 16, v190
    v_and_b32 v3, 0xffff0000, v190
    v_pk_fma_f32 v[124:125], v[2:3], v[110:111], v[124:125] op_sel_hi:[1,0,1]
    v_lshlrev_b32_e64 v4, 16, v191
    v_and_b32 v5, 0xffff0000, v191
    v_pk_fma_f32 v[126:127], v[4:5], v[110:111], v[126:127] op_sel_hi:[1,0,1]
    v_permlane32_swap_b32 v120, v124
    v_permlane32_swap_b32 v121, v125
    v_permlane32_swap_b32 v122, v126
    v_permlane32_swap_b32 v123, v127
    v_add_f32 v120, v120, v124
    v_add_f32 v121, v121, v125
    v_add_f32 v122, v122, v126
    v_add_f32 v123, v123, v127
    s_nop 0
    v_permlane16_swap_b32 v120, v122
    v_permlane16_swap_b32 v121, v123
    v_add_f32 v120, v120, v122
    v_add_f32 v121, v121, v123
    s_nop 0
    v_add_f32 v120, v120, v120 row_ror:8 row_mask:0xf bank_mask:0xf
    v_add_f32 v121, v121, v121 row_ror:8 row_mask:0xf bank_mask:0xf
    v_and_b32 v2, 8, v1
    v_cmp_eq_u32 vcc, 0, v2
    s_nop 1
    v_cndmask_b32 v120, v121, v120, vcc
    buffer_store_dword v120, v253, s[48:51], s84 offen sc1
    s_lshr_b32 s3, s71, 3
    s_add_u32 s3, s3, 3
    s_and_b32 s28, s3, 7
    s_lshr_b32 s3, s3, 3
    s_lshl_b32 s3, s3, 6
    s_add_u32 s3, s3, s28
    s_lshl_b32 s3, s3, 11
    buffer_load_dwordx4 v[204:207], v22, s[56:59], s3 offen nt
    s_lshr_b32 s3, s71, 3
    s_add_u32 s3, s3, 4
    s_and_b32 s28, s3, 7
    s_lshr_b32 s3, s3, 3
    s_lshl_b32 s3, s3, 6
    s_add_u32 s3, s3, s28
    s_lshl_b32 s3, s3, 11
    buffer_load_dwordx4 v[208:211], v22, s[56:59], s3 offen nt
    s_lshr_b32 s3, s71, 3
    s_add_u32 s3, s3, 5
    s_and_b32 s28, s3, 7
    s_lshr_b32 s3, s3, 3
    s_lshl_b32 s3, s3, 6
    s_add_u32 s3, s3, s28
    s_lshl_b32 s3, s3, 11
    buffer_load_dwordx4 v[212:215], v22, s[56:59], s3 offen nt
    s_lshr_b32 s3, s71, 3
    s_add_u32 s3, s3, 6
    s_and_b32 s28, s3, 7
    s_lshr_b32 s3, s3, 3
    s_lshl_b32 s3, s3, 6
    s_add_u32 s3, s3, s28
    s_lshl_b32 s3, s3, 11
    buffer_load_dwordx4 v[216:219], v22, s[56:59], s3 offen nt
    s_waitcnt vmcnt(5)
    s_cmp_eq_u32 s83, 0
    s_cbranch_scc1 L_hz
    s_mov_b32 s29, 0
L_k4:
    v_max3_u32 v2, v48, v49, v50
    v_max3_u32 v2, v2, v51, v52
    v_max3_u32 v2, v2, v53, v54
    v_max_u32 v2, v2, v55
    v_cmp_eq_u32 vcc, -1, v2
    s_cbranch_vccz L_k4k
    s_add_u32 s29, s29, 1
    s_cmp_ge_u32 s29, 200000
    s_cbranch_scc1 L_k4k
    s_sleep 1
    s_add_u32 s3, s76, 0
    buffer_load_dwordx4 v[48:51], v112, s[48:51], s3 offen sc1
    s_add_u32 s3, s76, 33792
    buffer_load_dwordx4 v[52:55], v112, s[48:51], s3 offen sc1
    s_waitcnt vmcnt(0)
    s_branch L_k4
L_k4k:
    v_lshlrev_b32 v64, 16, v48
    v_and_b32 v65, 0xffff0000, v48
    v_lshlrev_b32 v66, 16, v49
    v_and_b32 v67, 0xffff0000, v49
    v_lshlrev_b32 v68, 16, v50
    v_and_b32 v69, 0xffff0000, v50
    v_lshlrev_b32 v70, 16, v51
    v_and_b32 v71, 0xffff0000, v51
    v_lshlrev_b32 v72, 16, v52
    v_and_b32 v73, 0xffff0000, v52
    v_pk_add_f32 v[64:65], v[64:65], v[72:73]
    v_lshlrev_b32_e64 v74, 16, v53
    v_and_b32 v75, 0xffff0000, v53
    v_pk_add_f32 v[66:67], v[66:67], v[74:75]
    v_lshlrev_b32_e64 v76, 16, v54
    v_and_b32 v77, 0xffff0000, v54
    v_pk_add_f32 v[68:69], v[68:69], v[76:77]
    v_lshlrev_b32_e64 v78, 16, v55
    v_and_b32 v79, 0xffff0000, v55
    v_pk_add_f32 v[70:71], v[70:71], v[78:79]
    v_permlane32_swap_b32 v64, v68
    v_permlane32_swap_b32 v65, v69
    v_permlane32_swap_b32 v66, v70
    v_permlane32_swap_b32 v67, v71
    v_add_f32 v64, v64, v68
    v_add_f32 v65, v65, v69
    v_add_f32 v66, v66, v70
    v_add_f32 v67, v67, v71
    s_nop 0
    v_permlane16_swap_b32 v64, v66
    v_permlane16_swap_b32 v65, v67
    v_add_f32 v64, v64, v66
    v_add_f32 v65, v65, v67
    s_nop 0
    v_add_f32 v64, v64, v64 row_ror:8 row_mask:0xf bank_mask:0xf
    v_add_f32 v65, v65, v65 row_ror:8 row_mask:0xf bank_mask:0xf
    v_cvt_pk_bf16_f32 v64, v64, v65
    v_mov_b32 v65, v64
    s_nop 1
    v_permlane16_swap_b32 v64, v65
    v_mov_b32 v66, v64
    v_mov_b32 v67, v65
    s_nop 0
    v_permlane32_swap_b32 v64, v66
    v_permlane32_swap_b32 v65, v67
    s_mov_b64 exec, 0xff
    buffer_store_dwordx4 v[64:67], v252, s[48:51], s74 offen sc1
    s_branch L_h1e
L_hz:
    s_mov_b32 s29, 0
L_k3:
    v_max3_u32 v2, v48, v49, v50
    v_max3_u32 v2, v2, v51, v52
    v_max3_u32 v2, v2, v53, v54
    v_max3_u32 v2, v2, v55, v32
    v_max3_u32 v2, v2, v33, v34
    v_max3_u32 v2, v2, v35, v36
    v_max3_u32 v2, v2, v37, v38
    v_max_u32 v2, v2, v39
    v_cmp_eq_u32 vcc, -1, v2
    s_cbranch_vccz L_k3k
    s_add_u32 s29, s29, 1
    s_cmp_ge_u32 s29, 200000
    s_cbranch_scc1 L_k3k
    s_sleep 1
    s_add_u32 s3, s76, 0
    buffer_load_dwordx4 v[48:51], v112, s[48:51], s3 offen sc1
    s_add_u32 s3, s76, 33792
    buffer_load_dwordx4 v[52:55], v112, s[48:51], s3 offen sc1
    s_add_u32 s3, s81, 0
    buffer_load_dwordx4 v[32:35], v112, s[48:51], s3 offen sc1
    s_add_u32 s3, s81, 33792
    buffer_load_dwordx4 v[36:39], v112, s[48:51], s3 offen sc1
    s_waitcnt vmcnt(0)
    s_branch L_k3
L_k3k:
    v_lshlrev_b32 v64, 16, v48
    v_lshlrev_b32 v96, 16, v32
    v_and_b32 v65, 0xffff0000, v48
    v_and_b32 v97, 0xffff0000, v32
    v_lshlrev_b32 v66, 16, v49
    v_lshlrev_b32 v98, 16, v33
    v_and_b32 v67, 0xffff0000, v49
    v_and_b32 v99, 0xffff0000, v33
    v_lshlrev_b32 v68, 16, v50
    v_lshlrev_b32 v100, 16, v34
    v_and_b32 v69, 0xffff0000, v50
    v_and_b32 v101, 0xffff0000, v34
    v_lshlrev_b32 v70, 16, v51
    v_lshlrev_b32 v102, 16, v35
    v_and_b32 v71, 0xffff0000, v51
    v_and_b32 v103, 0xffff0000, v35
    v_lshlrev_b32 v72, 16, v52
    v_lshlrev_b32 v104, 16, v36
    v_and_b32 v73, 0xffff0000, v52
    v_and_b32 v105, 0xffff0000, v36
    v_pk_add_f32 v[64:65], v[64:65], v[72:73]
    v_pk_add_f32 v[96:97], v[96:97], v[104:105]
    v_lshlrev_b32 v74, 16, v53
    v_lshlrev_b32 v106, 16, v37
    v_and_b32 v75, 0xffff0000, v53
    v_and_b32 v107, 0xffff0000, v37
    v_pk_add_f32 v[66:67], v[66:67], v[74:75]
    v_pk_add_f32 v[98:99], v[98:99], v[106:107]
    v_lshlrev_b32 v76, 16, v54
    v_lshlrev_b32 v108, 16, v38
    v_and_b32 v77, 0xffff0000, v54
    v_and_b32 v109, 0xffff0000, v38
    v_pk_add_f32 v[68:69], v[68:69], v[76:77]
    v_pk_add_f32 v[100:101], v[100:101], v[108:109]
    v_lshlrev_b32 v78, 16, v55
    v_lshlrev_b32 v110, 16, v39
    v_and_b32 v79, 0xffff0000, v55
    v_and_b32 v111, 0xffff0000, v39
    v_pk_add_f32 v[70:71], v[70:71], v[78:79]
    v_pk_add_f32 v[102:103], v[102:103], v[110:111]
    v_permlane32_swap_b32 v64, v68
    v_permlane32_swap_b32 v96, v100
    v_permlane32_swap_b32 v65, v69
    v_permlane32_swap_b32 v97, v101
    v_permlane32_swap_b32 v66, v70
    v_permlane32_swap_b32 v98, v102
    v_permlane32_swap_b32 v67, v71
    v_permlane32_swap_b32 v99, v103
    v_add_f32 v64, v64, v68
    v_add_f32 v96, v96, v100
    v_add_f32 v65, v65, v69
    v_add_f32 v97, v97, v101
    v_add_f32 v66, v66, v70
    v_add_f32 v98, v98, v102
    v_add_f32 v67, v67, v71
    v_add_f32 v99, v99, v103
    v_permlane16_swap_b32 v64, v66
    v_permlane16_swap_b32 v96, v98
    v_permlane16_swap_b32 v65, v67
    v_permlane16_swap_b32 v97, v99
    v_add_f32 v64, v64, v66
    v_add_f32 v96, v96, v98
    v_add_f32 v65, v65, v67
    v_add_f32 v97, v97, v99
    v_add_f32 v64, v64, v64 row_ror:8 row_mask:0xf bank_mask:0xf
    v_add_f32 v96, v96, v96 row_ror:8 row_mask:0xf bank_mask:0xf
    v_add_f32 v65, v65, v65 row_ror:8 row_mask:0xf bank_mask:0xf
    v_add_f32 v97, v97, v97 row_ror:8 row_mask:0xf bank_mask:0xf
    v_cvt_pk_bf16_f32 v64, v64, v65
    v_cvt_pk_bf16_f32 v96, v96, v97
    v_mov_b32 v65, v64
    v_mov_b32 v97, v96
    s_nop 0
    v_permlane16_swap_b32 v64, v65
    v_permlane16_swap_b32 v96, v97
    v_mov_b32 v66, v64
    v_mov_b32 v98, v96
    v_mov_b32 v67, v65
    v_mov_b32 v99, v97
    v_permlane32_swap_b32 v64, v66
    v_permlane32_swap_b32 v96, v98
    v_permlane32_swap_b32 v65, v67
    v_permlane32_swap_b32_e64 v97, v99
    s_mov_b64 exec, 0xff
    buffer_store_dwordx4 v[64:67], v252, s[48:51], s74 offen sc1
    buffer_store_dwordx4 v[96:99], v252, s[48:51], s82 offen sc1
L_h1e:
    s_mov_b64 exec, -1
    s_lshl_b32 s3, s38, 2
    s_add_u32 s3, s3, 162112
    v_mov_b32 v4, s3
    v_mov_b32 v5, 3
    ds_write_b32 v4, v5
    s_setprio 0
    v_and_b32 v2, 15, v1
    v_add_u32 v2, s69, v2
    v_lshlrev_b32 v2, 2, v2
    v_add_u32 v2, 152064, v2
    ds_read_b32 v9, v2
    ds_read_b32 v8, v2 offset:1024
    s_waitcnt lgkmcnt(0)
    v_mul_f32 v28, v9, v8
    v_mov_b32 v30, 0xbfb8aa3b
    v_lshlrev_b32 v224, 16, v240
    v_and_b32 v225, 0xffff0000, v240
    v_lshlrev_b32 v226, 16, v241
    v_and_b32 v227, 0xffff0000, v241
    v_lshlrev_b32 v228, 16, v242
    v_and_b32 v229, 0xffff0000, v242
    v_lshlrev_b32 v230, 16, v243
    v_and_b32 v231, 0xffff0000, v243
    v_lshlrev_b32 v232, 16, v244
    v_and_b32 v233, 0xffff0000, v244
    v_lshlrev_b32 v234, 16, v245
    v_and_b32 v235, 0xffff0000, v245
    v_lshlrev_b32 v236, 16, v246
    v_and_b32 v237, 0xffff0000, v246
    v_lshlrev_b32 v238, 16, v247
    v_and_b32 v239, 0xffff0000, v247
    v_pk_fma_f32 v[224:225], v[224:225], v[8:9], v[28:29] op_sel_hi:[1,0,0] neg_lo:[0,0,1] neg_hi:[0,0,1]
    v_pk_fma_f32 v[226:227], v[226:227], v[8:9], v[28:29] op_sel_hi:[1,0,0] neg_lo:[0,0,1] neg_hi:[0,0,1]
    v_pk_fma_f32 v[228:229], v[228:229], v[8:9], v[28:29] op_sel_hi:[1,0,0] neg_lo:[0,0,1] neg_hi:[0,0,1]
    v_pk_fma_f32 v[230:231], v[230:231], v[8:9], v[28:29] op_sel_hi:[1,0,0] neg_lo:[0,0,1] neg_hi:[0,0,1]
    v_pk_fma_f32 v[232:233], v[232:233], v[8:9], v[28:29] op_sel_hi:[1,0,0] neg_lo:[0,0,1] neg_hi:[0,0,1]
    v_pk_fma_f32 v[234:235], v[234:235], v[8:9], v[28:29] op_sel_hi:[1,0,0] neg_lo:[0,0,1] neg_hi:[0,0,1]
    v_pk_fma_f32 v[236:237], v[236:237], v[8:9], v[28:29] op_sel_hi:[1,0,0] neg_lo:[0,0,1] neg_hi:[0,0,1]
    v_pk_fma_f32 v[238:239], v[238:239], v[8:9], v[28:29] op_sel_hi:[1,0,0] neg_lo:[0,0,1] neg_hi:[0,0,1]
    v_pk_mul_f32 v[32:33], v[224:225], v[30:31] op_sel_hi:[1,0]
    v_pk_mul_f32 v[34:35], v[226:227], v[30:31] op_sel_hi:[1,0]
    v_pk_mul_f32 v[36:37], v[228:229], v[30:31] op_sel_hi:[1,0]
    v_pk_mul_f32 v[38:39], v[230:231], v[30:31] op_sel_hi:[1,0]
    v_pk_mul_f32 v[40:41], v[232:233], v[30:31] op_sel_hi:[1,0]
    v_pk_mul_f32 v[42:43], v[234:235], v[30:31] op_sel_hi:[1,0]
    v_pk_mul_f32 v[44:45], v[236:237], v[30:31] op_sel_hi:[1,0]
    v_pk_mul_f32 v[46:47], v[238:239], v[30:31] op_sel_hi:[1,0]
    v_exp_f32 v32, v32
    v_exp_f32 v33, v33
    v_exp_f32 v34, v34
    v_exp_f32 v35, v35
    v_exp_f32 v36, v36
    v_exp_f32 v37, v37
    v_exp_f32 v38, v38
    v_exp_f32 v39, v39
    v_exp_f32 v40, v40
    v_exp_f32 v41, v41
    v_exp_f32 v42, v42
    v_exp_f32 v43, v43
    v_exp_f32 v44, v44
    v_exp_f32 v45, v45
    v_exp_f32 v46, v46
    v_exp_f32 v47, v47
    v_pk_add_f32 v[32:33], v[32:33], 1.0 op_sel_hi:[1,0]
    v_pk_add_f32 v[34:35], v[34:35], 1.0 op_sel_hi:[1,0]
    v_pk_add_f32 v[36:37], v[36:37], 1.0 op_sel_hi:[1,0]
    v_pk_add_f32 v[38:39], v[38:39], 1.0 op_sel_hi:[1,0]
    v_pk_add_f32 v[40:41], v[40:41], 1.0 op_sel_hi:[1,0]
    v_pk_add_f32 v[42:43], v[42:43], 1.0 op_sel_hi:[1,0]
    v_pk_add_f32 v[44:45], v[44:45], 1.0 op_sel_hi:[1,0]
    v_pk_add_f32 v[46:47], v[46:47], 1.0 op_sel_hi:[1,0]
    v_rcp_f32 v32, v32
    v_rcp_f32 v33, v33
    v_rcp_f32 v34, v34
    v_rcp_f32 v35, v35
    v_rcp_f32 v36, v36
    v_rcp_f32 v37, v37
    v_rcp_f32 v38, v38
    v_rcp_f32 v39, v39
    v_rcp_f32 v40, v40
    v_rcp_f32 v41, v41
    v_rcp_f32 v42, v42
    v_rcp_f32 v43, v43
    v_rcp_f32 v44, v44
    v_rcp_f32 v45, v45
    v_rcp_f32 v46, v46
    v_rcp_f32 v47, v47
    v_pk_mul_f32 v[224:225], v[224:225], v[32:33]
    v_pk_mul_f32 v[226:227], v[226:227], v[34:35]
    v_pk_mul_f32 v[228:229], v[228:229], v[36:37]
    v_pk_mul_f32 v[230:231], v[230:231], v[38:39]
    v_pk_mul_f32 v[232:233], v[232:233], v[40:41]
    v_pk_mul_f32 v[234:235], v[234:235], v[42:43]
    v_pk_mul_f32 v[236:237], v[236:237], v[44:45]
    v_pk_mul_f32 v[238:239], v[238:239], v[46:47]
    s_add_u32 s3, s75, 0
    s_nop 0
    buffer_load_dwordx4 v[80:83], v13, s[48:51], s3 offen sc1
    s_add_u32 s3, s75, 57344
    buffer_load_dwordx4 v[84:87], v13, s[48:51], s3 offen sc1
    s_add_u32 s3, s75, 114688
    buffer_load_dwordx4 v[88:91], v13, s[48:51], s3 offen sc1
    s_add_u32 s3, s75, 172032
    buffer_load_dwordx4 v[92:95], v13, s[48:51], s3 offen sc1
    s_waitcnt vmcnt(0)
    s_mov_b32 s29, 0
L_k5:
    v_max3_u32 v2, v80, v81, v82
    v_max3_u32 v2, v2, v83, v84
    v_max3_u32 v2, v2, v85, v86
    v_max3_u32 v2, v2, v87, v88
    v_max3_u32 v2, v2, v89, v90
    v_max3_u32 v2, v2, v91, v92
    v_max3_u32 v2, v2, v93, v94
    v_max_u32 v2, v2, v95
    v_cmp_eq_u32 vcc, -1, v2
    s_cbranch_vccz L_k5k
    s_add_u32 s29, s29, 1
    s_cmp_ge_u32 s29, 200000
    s_cbranch_scc1 L_k5k
    s_sleep 1
    s_add_u32 s3, s75, 0
    s_nop 0
    buffer_load_dwordx4 v[80:83], v13, s[48:51], s3 offen sc1
    s_add_u32 s3, s75, 57344
    buffer_load_dwordx4 v[84:87], v13, s[48:51], s3 offen sc1
    s_add_u32 s3, s75, 114688
    buffer_load_dwordx4 v[88:91], v13, s[48:51], s3 offen sc1
    s_add_u32 s3, s75, 172032
    buffer_load_dwordx4 v[92:95], v13, s[48:51], s3 offen sc1
    s_waitcnt vmcnt(0)
    s_branch L_k5
L_k5k:
    v_pk_add_f32 v[80:81], v[80:81], v[84:85]
    v_pk_add_f32 v[82:83], v[82:83], v[86:87]
    v_pk_add_f32 v[88:89], v[88:89], v[92:93]
    v_pk_add_f32 v[90:91], v[90:91], v[94:95]
    s_nop 0
    v_permlane32_swap_b32 v80, v88
    v_permlane32_swap_b32 v81, v89
    v_permlane32_swap_b32 v82, v90
    v_permlane32_swap_b32 v83, v91
    v_add_f32 v80, v80, v88
    v_add_f32 v81, v81, v89
    v_add_f32 v82, v82, v90
    v_add_f32 v83, v83, v91
    v_permlane16_swap_b32 v80, v81
    s_nop 0
    v_permlane16_swap_b32 v82, v83
    v_add_f32 v80, v80, v81
    v_add_f32 v82, v82, v83
    s_nop 1
    v_permlane32_swap_b32 v80, v82
    v_cvt_pk_bf16_f32 v80, v80, v80
    v_lshlrev_b32 v80, 16, v80
    v_cvt_pk_bf16_f32 v82, v82, v82
    v_lshlrev_b32 v82, 16, v82
    v_mul_f32 v2, 0xbfb8aa3b, v80
    v_exp_f32 v2, v2
    s_nop 0
    v_add_f32 v2, 1.0, v2
    v_rcp_f32 v2, v2
    s_nop 0
    v_mul_f32 v80, v80, v2
    v_cvt_pk_bf16_f32 v80, v80, v80
    v_lshlrev_b32 v80, 16, v80
    v_mul_f32 v80, v80, v82
    v_cvt_pk_bf16_f32 v80, v80, v80
    v_lshlrev_b32 v80, 16, v80
    v_bfe_u32 v2, v1, 3, 2
    v_lshlrev_b32 v2, 6, v2
    v_lshrrev_b32_e64 v3, 5, v1
    v_lshl_add_u32 v2, v3, 2, v2
    ds_bpermute_b32 v128, v2, v80 offset:0
    ds_bpermute_b32 v130, v2, v80 offset:8
    ds_bpermute_b32 v132, v2, v80 offset:16
    ds_bpermute_b32 v134, v2, v80 offset:24
    ds_bpermute_b32 v136, v2, v80 offset:32
    ds_bpermute_b32 v138, v2, v80 offset:40
    ds_bpermute_b32 v140, v2, v80 offset:48
    v_mov_b64 v[120:121], 0
    v_mov_b64 v[122:123], 0
    v_mov_b64 v[124:125], 0
    v_mov_b64 v[126:127], 0
    s_waitcnt lgkmcnt(0)
    v_lshlrev_b32 v2, 16, v192
    v_and_b32 v3, 0xffff0000, v192
    v_pk_fma_f32 v[120:121], v[2:3], v[128:129], v[120:121] op_sel_hi:[1,0,1]
    v_lshlrev_b32_e64 v4, 16, v193
    v_and_b32 v5, 0xffff0000, v193
    v_pk_fma_f32 v[122:123], v[4:5], v[128:129], v[122:123] op_sel_hi:[1,0,1]
    v_lshlrev_b32_e64 v2, 16, v194
    v_and_b32 v3, 0xffff0000, v194
    v_pk_fma_f32 v[124:125], v[2:3], v[128:129], v[124:125] op_sel_hi:[1,0,1]
    v_lshlrev_b32_e64 v4, 16, v195
    v_and_b32 v5, 0xffff0000, v195
    v_pk_fma_f32 v[126:127], v[4:5], v[128:129], v[126:127] op_sel_hi:[1,0,1]
    v_lshlrev_b32_e64 v2, 16, v196
    v_and_b32 v3, 0xffff0000, v196
    v_pk_fma_f32 v[120:121], v[2:3], v[130:131], v[120:121] op_sel_hi:[1,0,1]
    v_lshlrev_b32_e64 v4, 16, v197
    v_and_b32 v5, 0xffff0000, v197
    v_pk_fma_f32 v[122:123], v[4:5], v[130:131], v[122:123] op_sel_hi:[1,0,1]
    v_lshlrev_b32_e64 v2, 16, v198
    v_and_b32 v3, 0xffff0000, v198
    v_pk_fma_f32 v[124:125], v[2:3], v[130:131], v[124:125] op_sel_hi:[1,0,1]
    v_lshlrev_b32_e64 v4, 16, v199
    v_and_b32 v5, 0xffff0000, v199
    v_pk_fma_f32 v[126:127], v[4:5], v[130:131], v[126:127] op_sel_hi:[1,0,1]
    v_lshlrev_b32_e64 v2, 16, v200
    v_and_b32 v3, 0xffff0000, v200
    v_pk_fma_f32 v[120:121], v[2:3], v[132:133], v[120:121] op_sel_hi:[1,0,1]
    v_lshlrev_b32_e64 v4, 16, v201
    v_and_b32 v5, 0xffff0000, v201
    v_pk_fma_f32 v[122:123], v[4:5], v[132:133], v[122:123] op_sel_hi:[1,0,1]
    v_lshlrev_b32_e64 v2, 16, v202
    v_and_b32 v3, 0xffff0000, v202
    v_pk_fma_f32 v[124:125], v[2:3], v[132:133], v[124:125] op_sel_hi:[1,0,1]
    v_lshlrev_b32_e64 v4, 16, v203
    v_and_b32 v5, 0xffff0000, v203
    v_pk_fma_f32 v[126:127], v[4:5], v[132:133], v[126:127] op_sel_hi:[1,0,1]
    v_lshlrev_b32_e64 v2, 16, v204
    v_and_b32 v3, 0xffff0000, v204
    v_pk_fma_f32 v[120:121], v[2:3], v[134:135], v[120:121] op_sel_hi:[1,0,1]
    v_lshlrev_b32_e64 v4, 16, v205
    v_and_b32 v5, 0xffff0000, v205
    v_pk_fma_f32 v[122:123], v[4:5], v[134:135], v[122:123] op_sel_hi:[1,0,1]
    v_lshlrev_b32_e64 v2, 16, v206
    v_and_b32 v3, 0xffff0000, v206
    v_pk_fma_f32 v[124:125], v[2:3], v[134:135], v[124:125] op_sel_hi:[1,0,1]
    v_lshlrev_b32_e64 v4, 16, v207
    v_and_b32 v5, 0xffff0000, v207
    v_pk_fma_f32 v[126:127], v[4:5], v[134:135], v[126:127] op_sel_hi:[1,0,1]
    v_lshlrev_b32_e64 v2, 16, v208
    v_and_b32 v3, 0xffff0000, v208
    v_pk_fma_f32 v[120:121], v[2:3], v[136:137], v[120:121] op_sel_hi:[1,0,1]
    v_lshlrev_b32_e64 v4, 16, v209
    v_and_b32 v5, 0xffff0000, v209
    v_pk_fma_f32 v[122:123], v[4:5], v[136:137], v[122:123] op_sel_hi:[1,0,1]
    v_lshlrev_b32_e64 v2, 16, v210
    v_and_b32 v3, 0xffff0000, v210
    v_pk_fma_f32 v[124:125], v[2:3], v[136:137], v[124:125] op_sel_hi:[1,0,1]
    v_lshlrev_b32_e64 v4, 16, v211
    v_and_b32 v5, 0xffff0000, v211
    v_pk_fma_f32 v[126:127], v[4:5], v[136:137], v[126:127] op_sel_hi:[1,0,1]
    v_lshlrev_b32_e64 v2, 16, v212
    v_and_b32 v3, 0xffff0000, v212
    v_pk_fma_f32 v[120:121], v[2:3], v[138:139], v[120:121] op_sel_hi:[1,0,1]
    v_lshlrev_b32_e64 v4, 16, v213
    v_and_b32 v5, 0xffff0000, v213
    v_pk_fma_f32 v[122:123], v[4:5], v[138:139], v[122:123] op_sel_hi:[1,0,1]
    v_lshlrev_b32_e64 v2, 16, v214
    v_and_b32 v3, 0xffff0000, v214
    v_pk_fma_f32 v[124:125], v[2:3], v[138:139], v[124:125] op_sel_hi:[1,0,1]
    v_lshlrev_b32_e64 v4, 16, v215
    v_and_b32 v5, 0xffff0000, v215
    v_pk_fma_f32 v[126:127], v[4:5], v[138:139], v[126:127] op_sel_hi:[1,0,1]
    v_lshlrev_b32_e64 v2, 16, v216
    v_and_b32 v3, 0xffff0000, v216
    v_pk_fma_f32 v[120:121], v[2:3], v[140:141], v[120:121] op_sel_hi:[1,0,1]
    v_lshlrev_b32_e64 v4, 16, v217
    v_and_b32 v5, 0xffff0000, v217
    v_pk_fma_f32 v[122:123], v[4:5], v[140:141], v[122:123] op_sel_hi:[1,0,1]
    v_lshlrev_b32_e64 v2, 16, v218
    v_and_b32 v3, 0xffff0000, v218
    v_pk_fma_f32 v[124:125], v[2:3], v[140:141], v[124:125] op_sel_hi:[1,0,1]
    v_lshlrev_b32_e64 v4, 16, v219
    v_and_b32 v5, 0xffff0000, v219
    v_pk_fma_f32 v[126:127], v[4:5], v[140:141], v[126:127] op_sel_hi:[1,0,1]
    v_permlane32_swap_b32 v120, v124
    v_permlane32_swap_b32 v121, v125
    v_permlane32_swap_b32 v122, v126
    v_permlane32_swap_b32 v123, v127
    v_add_f32 v120, v120, v124
    v_add_f32 v121, v121, v125
    v_add_f32 v122, v122, v126
    v_add_f32 v123, v123, v127
    s_nop 0
    v_permlane16_swap_b32 v120, v122
    v_permlane16_swap_b32 v121, v123
    v_add_f32 v120, v120, v122
    v_add_f32 v121, v121, v123
    s_nop 0
    v_add_f32 v120, v120, v120 row_ror:8 row_mask:0xf bank_mask:0xf
    v_add_f32 v121, v121, v121 row_ror:8 row_mask:0xf bank_mask:0xf
    v_and_b32 v2, 8, v1
    v_cmp_eq_u32 vcc, 0, v2
    s_and_b32 s3, s2, 15
    s_lshl_b32 s3, s3, 4
    s_lshr_b32 s28, s2, 4
    s_add_u32 s3, s3, s28
    s_lshl_b32 s3, s3, 2
    s_add_u32 s3, s3, s38
    s_lshl_b32 s3, s3, 8
    s_add_u32 s3, s3, 1413120
    v_cndmask_b32 v120, v121, v120, vcc
    buffer_store_dword v120, v253, s[48:51], s3 offen sc1
    v_and_b32 v3, 3, v1
    v_lshlrev_b32 v3, 2, v3
    v_add_u32 v3, 162112, v3
L_ow:
    ds_read_b32 v2, v3
    s_waitcnt lgkmcnt(0)
    v_cmp_ne_u32 vcc, 7, v2
    s_cbranch_vccz L_owk
    s_sleep 1
    s_branch L_ow
L_owk:
    s_branch L_p3
L_C:
    s_and_b32 s64, s38, 1
    s_lshr_b32 s65, s38, 1
    v_and_b32 v3, 15, v1
    v_lshlrev_b32 v3, 7, v3
    s_lshl_b32 s3, s64, 13
    v_add_u32 v3, s3, v3
    v_bfe_u32 v5, v1, 1, 3
    v_lshrrev_b32 v6, 4, v1
    v_xor_b32 v6, v6, v5
    v_lshl_add_u32 v184, v6, 4, v3
    v_xor_b32 v185, 64, v184
    v_lshrrev_b32 v6, 4, v1
    v_lshlrev_b32 v6, 3, v6
    v_bfe_u32 v7, v1, 2, 2
    v_add_u32 v6, v6, v7
    v_lshlrev_b32 v6, 7, v6
    v_and_b32 v7, 3, v1
    v_lshl_add_u32 v6, v7, 3, v6
    v_add_u32 v6, 16384, v6
    v_bfe_u32 v7, v1, 3, 2
    s_lshl_b32 s3, s65, 1
    v_xor_b32 v7, s3, v7
    v_lshl_add_u32 v186, v7, 5, v6
    v_xor_b32_e64 v187, 32, v186
    v_add_u32 v188, 81920, v184
    v_add_u32 v189, 81920, v185
    v_add_u32 v190, 81920, v186
    v_add_u32 v191, 81920, v187
    s_waitcnt lgkmcnt(0)
    s_mov_b32 s48, s26
    s_mov_b32 s49, s27
    s_mov_b32 s50, 268435456
    s_mov_b32 s51, 0x00020000
    s_mov_b32 s40, s4
    s_mov_b32 s41, s5
    s_mov_b32 s42, 4194304
    s_mov_b32 s43, 0x00020000
    s_mov_b32 s88, s10
    s_mov_b32 s89, s11
    s_mov_b32 s90, 2097152
    s_mov_b32 s91, 0x00020000
    s_lshl_b32 s3, s36, 7
    s_lshl_b32 s28, s37, 3
    s_add_u32 s3, s3, s28
    s_lshl_b32 s28, s38, 1
    s_add_u32 s69, s3, s28
    v_lshlrev_b32 v2, 4, v1
    v_mov_b32 v248, 16384
    v_mov_b32 v4, -1
    v_mov_b32 v5, -1
    v_mov_b32 v6, -1
    v_mov_b32_e64 v7, -1
    s_lshl_b32 s28, s2, 2
    s_add_u32 s28, s28, s38
    s_mul_i32 s28, s28, 768
    s_add_u32 s28, s28, 1048320
    s_lshl_b32 s3, s37, 4
    s_add_u32 s3, s3, s36
    s_lshl_b32 s3, s3, 2
    s_add_u32 s3, s3, s38
    s_lshl_b32 s3, s3, 8
    s_add_u32 s3, s3, 524288
    v_cmp_gt_u32 vcc, 16, v1
    v_add_u32 v3, s3, v2
    v_add_u32_e64 v2, s28, v2
    v_cndmask_b32 v2, v2, v3, vcc
    buffer_store_dwordx4 v[4:7], v2, s[48:51], 0 offen sc1
    buffer_load_dword v248, v248, s[48:51], 0 offen sc1
    s_getpc_b64 s[92:93]
L_pc:
    s_sub_u32 s92, s92, L_pc-recurrent_scan__linear_kernel_hedgehog__moe_arch_mod__prompt_kernel
    s_subb_u32 s93, s93, 0
    s_lshr_b32 s3, s2, 3
    s_lshl_b32 s3, s3, 2
    s_add_u32 s3, s3, s38
    s_lshl_b32 s3, s3, 8
    v_lshlrev_b32 v2, 7, v1
    v_add_u32 v2, s3, v2
    s_mov_b64 exec, 3
    global_load_dword v249, v2, s[92:93]
    s_mov_b64 exec, -1
    v_mov_b64 v[8:9], 0
    v_mov_b64 v[10:11], 0
    v_mov_b64 v[12:13], 0
    v_mov_b64 v[14:15], 0
    v_mov_b64 v[16:17], 0
    v_mov_b64 v[18:19], 0
    v_mov_b64 v[20:21], 0
    v_mov_b64 v[22:23], 0
    v_mov_b64 v[24:25], 0
    v_mov_b64 v[26:27], 0
    v_mov_b64 v[28:29], 0
    v_mov_b64 v[30:31], 0
    v_mov_b64 v[32:33], 0
    v_mov_b64 v[34:35], 0
    v_mov_b64 v[36:37], 0
    v_mov_b64 v[38:39], 0
    v_mov_b64 v[40:41], 0
    v_mov_b64 v[42:43], 0
    v_mov_b64 v[44:45], 0
    v_mov_b64 v[46:47], 0
    v_mov_b64 v[48:49], 0
    v_mov_b64 v[50:51], 0
    v_mov_b64 v[52:53], 0
    v_mov_b64 v[54:55], 0
    v_mov_b64 v[56:57], 0
    v_mov_b64 v[58:59], 0
    v_mov_b64 v[60:61], 0
    v_mov_b64 v[62:63], 0
    v_mov_b64 v[64:65], 0
    v_mov_b64 v[66:67], 0
    v_mov_b64 v[68:69], 0
    v_mov_b64 v[70:71], 0
    v_mov_b64 v[72:73], 0
    v_mov_b64 v[74:75], 0
    v_mov_b64 v[76:77], 0
    v_mov_b64 v[78:79], 0
    v_mov_b64 v[80:81], 0
    v_mov_b64 v[82:83], 0
    v_mov_b64 v[84:85], 0
    v_mov_b64 v[86:87], 0
    v_mov_b64 v[88:89], 0
    v_mov_b64 v[90:91], 0
    v_mov_b64 v[92:93], 0
    v_mov_b64 v[94:95], 0
    v_mov_b64 v[96:97], 0
    v_mov_b64 v[98:99], 0
    v_mov_b64 v[100:101], 0
    v_mov_b64 v[102:103], 0
    s_lshl_b32 s3, s38, 2
    s_add_u32 s3, s3, 162112
    v_mov_b32 v2, s3
    v_mov_b32_e64 v3, 0
    ds_write_b32 v2, v3
    ds_write_b32 v2, v3 offset:16
    s_mov_b32 s86, 0
    s_mov_b32 s66, 0
    s_setprio 2
    s_waitcnt lgkmcnt(0)
L_ln:
    s_lshl_b32 s3, s38, 12
    s_add_u32 s3, s3, 131072
    v_lshlrev_b32 v2, 4, v1
    v_add_u32 v3, s3, v2
    v_add_u32 v2, 122880, v2
    s_barrier
    ds_read_b128 v[120:123], v2 offset:0
    ds_read_b128 v[124:127], v2 offset:1024
    ds_read_b128 v[104:107], v3 offset:0
    ds_read_b128 v[108:111], v3 offset:1024
    ds_read_b128 v[112:115], v3 offset:2048
    ds_read_b128 v[116:119], v3 offset:3072
    v_mov_b32 v2, 0x3f803f80
    v_mov_b32 v192, 0
    v_mov_b32 v194, 0
    v_mov_b32 v196, 0
    v_mov_b32 v198, 0
    v_mov_b32 v200, 0
    v_mov_b32 v202, 0
    v_mov_b32 v204, 0
    v_mov_b32 v206, 0
    s_waitcnt lgkmcnt(2)
    v_dot2c_f32_bf16 v192, v104, v2
    v_dot2c_f32_bf16 v196, v104, v104
    v_dot2c_f32_bf16 v200, v104, v120
    v_dot2c_f32_bf16 v204, v120, v2
    v_dot2c_f32_bf16 v192, v105, v2
    v_dot2c_f32_bf16 v196, v105, v105
    v_dot2c_f32_bf16 v200, v105, v121
    v_dot2c_f32_bf16 v204, v121, v2
    v_dot2c_f32_bf16 v192, v106, v2
    v_dot2c_f32_bf16 v196, v106, v106
    v_dot2c_f32_bf16 v200, v106, v122
    v_dot2c_f32_bf16 v204, v122, v2
    v_dot2c_f32_bf16 v192, v107, v2
    v_dot2c_f32_bf16 v196, v107, v107
    v_dot2c_f32_bf16 v200, v107, v123
    v_dot2c_f32_bf16 v204, v123, v2
    v_dot2c_f32_bf16 v192, v108, v2
    v_dot2c_f32_bf16 v196, v108, v108
    v_dot2c_f32_bf16 v200, v108, v124
    v_dot2c_f32_bf16 v204, v124, v2
    v_dot2c_f32_bf16 v192, v109, v2
    v_dot2c_f32_bf16 v196, v109, v109
    v_dot2c_f32_bf16 v200, v109, v125
    v_dot2c_f32_bf16 v204, v125, v2
    v_dot2c_f32_bf16 v192, v110, v2
    v_dot2c_f32_bf16 v196, v110, v110
    v_dot2c_f32_bf16 v200, v110, v126
    v_dot2c_f32_bf16 v204, v126, v2
    v_dot2c_f32_bf16 v192, v111, v2
    v_dot2c_f32_bf16 v196, v111, v111
    v_dot2c_f32_bf16 v200, v111, v127
    v_dot2c_f32_bf16 v204, v127, v2
    s_waitcnt lgkmcnt(0)
    v_dot2c_f32_bf16 v194, v112, v2
    v_dot2c_f32_bf16 v198, v112, v112
    v_dot2c_f32_bf16 v202, v112, v120
    v_dot2c_f32_bf16 v206, v120, v2
    v_dot2c_f32_bf16 v194, v113, v2
    v_dot2c_f32_bf16 v198, v113, v113
    v_dot2c_f32_bf16 v202, v113, v121
    v_dot2c_f32_bf16 v206, v121, v2
    v_dot2c_f32_bf16 v194, v114, v2
    v_dot2c_f32_bf16 v198, v114, v114
    v_dot2c_f32_bf16 v202, v114, v122
    v_dot2c_f32_bf16 v206, v122, v2
    v_dot2c_f32_bf16 v194, v115, v2
    v_dot2c_f32_bf16 v198, v115, v115
    v_dot2c_f32_bf16 v202, v115, v123
    v_dot2c_f32_bf16 v206, v123, v2
    v_dot2c_f32_bf16 v194, v116, v2
    v_dot2c_f32_bf16 v198, v116, v116
    v_dot2c_f32_bf16 v202, v116, v124
    v_dot2c_f32_bf16 v206, v124, v2
    v_dot2c_f32_bf16 v194, v117, v2
    v_dot2c_f32_bf16 v198, v117, v117
    v_dot2c_f32_bf16 v202, v117, v125
    v_dot2c_f32_bf16 v206, v125, v2
    v_dot2c_f32_bf16 v194, v118, v2
    v_dot2c_f32_bf16 v198, v118, v118
    v_dot2c_f32_bf16 v202, v118, v126
    v_dot2c_f32_bf16 v206, v126, v2
    v_dot2c_f32_bf16 v194, v119, v2
    v_dot2c_f32_bf16 v198, v119, v119
    v_dot2c_f32_bf16 v202, v119, v127
    v_dot2c_f32_bf16 v206, v127, v2
    v_permlane32_swap_b32 v192, v194
    v_permlane32_swap_b32 v196, v198
    v_permlane32_swap_b32 v200, v202
    v_permlane32_swap_b32 v204, v206
    v_add_f32 v192, v192, v194
    v_add_f32 v196, v196, v198
    v_add_f32 v200, v200, v202
    v_add_f32 v204, v204, v206
    v_add_f32 v192, v192, v192 quad_perm:[1,0,3,2] row_mask:0xf bank_mask:0xf
    v_add_f32 v196, v196, v196 quad_perm:[1,0,3,2] row_mask:0xf bank_mask:0xf
    v_add_f32 v200, v200, v200 quad_perm:[1,0,3,2] row_mask:0xf bank_mask:0xf
    v_add_f32 v204, v204, v204 quad_perm:[1,0,3,2] row_mask:0xf bank_mask:0xf
    v_add_f32 v192, v192, v192 quad_perm:[2,3,0,1] row_mask:0xf bank_mask:0xf
    v_add_f32 v196, v196, v196 quad_perm:[2,3,0,1] row_mask:0xf bank_mask:0xf
    v_add_f32 v200, v200, v200 quad_perm:[2,3,0,1] row_mask:0xf bank_mask:0xf
    v_add_f32 v204, v204, v204 quad_perm:[2,3,0,1] row_mask:0xf bank_mask:0xf
    v_add_f32 v192, v192, v192 row_half_mirror row_mask:0xf bank_mask:0xf
    v_add_f32 v196, v196, v196 row_half_mirror row_mask:0xf bank_mask:0xf
    v_add_f32 v200, v200, v200 row_half_mirror row_mask:0xf bank_mask:0xf
    v_add_f32 v204, v204, v204 row_half_mirror row_mask:0xf bank_mask:0xf
    v_add_f32 v192, v192, v192 row_mirror row_mask:0xf bank_mask:0xf
    v_add_f32 v196, v196, v196 row_mirror row_mask:0xf bank_mask:0xf
    v_add_f32 v200, v200, v200 row_mirror row_mask:0xf bank_mask:0xf
    v_add_f32 v204, v204, v204 row_mirror row_mask:0xf bank_mask:0xf
    v_mov_b32 v193, v192
    v_mov_b32 v197, v196
    v_mov_b32 v201, v200
    v_mov_b32 v205, v204
    v_permlane16_swap_b32 v192, v193
    v_permlane16_swap_b32 v196, v197
    v_permlane16_swap_b32 v200, v201
    v_permlane16_swap_b32 v204, v205
    v_add_f32 v192, v192, v193
    v_add_f32 v196, v196, v197
    v_add_f32 v200, v200, v201
    v_add_f32 v204, v204, v205
    v_mul_f32 v192, 0x3a800000, v192
    v_mul_f32 v196, 0x3a800000, v196
    v_cvt_pk_bf16_f32 v193, v192, v192
    v_lshlrev_b32 v193, 16, v193
    v_fma_f32 v196, -v192, v192, v196
    v_max_f32 v196, 0, v196
    v_fma_f32 v200, -v193, v204, v200
    s_waitcnt vmcnt(0)
    v_cvt_pk_bf16_f32 v196, v196, v196
    v_lshlrev_b32 v196, 16, v196
    v_add_f32 v196, 0x3727c5ac, v196
    v_cvt_pk_bf16_f32 v196, v196, v196
    v_lshlrev_b32 v196, 16, v196
    v_sqrt_f32 v196, v196
    s_nop 0
    v_cvt_pk_bf16_f32 v196, v196, v196
    v_lshlrev_b32 v196, 16, v196
    v_rcp_f32 v2, v196
    v_lshrrev_b32 v3, 16, v193
    v_or_b32 v4, v3, v196
    v_mul_f32 v200, v200, v2
    v_cvt_pk_bf16_f32 v200, v200, v200
    v_lshlrev_b32 v200, 16, v200
    v_ashrrev_i32 v2, 31, v200
    v_or_b32 v2, 0x80000000, v2
    v_xor_b32 v2, v200, v2
    v_and_b32 v2, 0xffff0000, v2
    v_lshrrev_b32 v3, 5, v1
    v_add_u32 v5, s69, v3
    v_sub_u32 v5, 2047, v5
    v_or_b32 v6, v2, v5
    v_mov_b32 v2, v6
    v_mov_b32 v5, v4
    v_readfirstlane_b32 s86, v248
    v_mov_b32 v3, 0
    s_mul_i32 s86, s86, 1664525
    s_add_u32 s86, s86, 1013904223
    v_mov_b32 v7, s86
    v_permlane32_swap_b32 v6, v2
    v_permlane32_swap_b32 v4, v5
    v_max_u32 v6, v6, v2
    s_lshl_b32 s3, s69, 3
    s_mov_b64 exec, 1
    buffer_store_dwordx4 v[4:7], v3, s[48:51], s3 offen sc1
    s_mov_b64 exec, -1
    s_branch L_lnr
L_lnr:
    s_barrier
    s_nop 0
    ds_read_b128 v[104:107], v184 offset:0
    ds_read_b64_tr_b16 v[120:121], v186 offset:0
    ds_read_b64_tr_b16 v[122:123], v186 offset:512
    ds_read_b64_tr_b16 v[124:125], v187 offset:0
    ds_read_b64_tr_b16 v[126:127], v187 offset:512
    ds_read_b64_tr_b16 v[128:129], v186 offset:8192
    ds_read_b64_tr_b16 v[130:131], v186 offset:8704
    ds_read_b64_tr_b16 v[132:133], v187 offset:8192
    ds_read_b64_tr_b16 v[134:135], v187 offset:8704
    ds_read_b64_tr_b16 v[136:137], v186 offset:16384
    ds_read_b64_tr_b16 v[138:139], v186 offset:16896
    ds_read_b64_tr_b16 v[140:141], v187 offset:16384
    ds_read_b64_tr_b16 v[142:143], v187 offset:16896
    ds_read_b128 v[108:111], v184 offset:2048
    ds_read_b128 v[112:115], v184 offset:4096
    ds_read_b128 v[116:119], v184 offset:6144
    s_branch L_cmid
.p2align 6
L_cloop:
    s_waitcnt lgkmcnt(0)
    s_barrier
    v_mfma_f32_16x16x32_bf16 v[8:11], v[160:163], v[144:147], v[8:11]
    ds_read_b128 v[104:107], v184 offset:0
    v_mfma_f32_16x16x32_bf16 v[12:15], v[164:167], v[144:147], v[12:15]
    ds_read_b64_tr_b16 v[120:121], v186 offset:0
    v_mfma_f32_16x16x32_bf16 v[16:19], v[168:171], v[144:147], v[16:19]
    ds_read_b64_tr_b16 v[122:123], v186 offset:512
    v_mfma_f32_16x16x32_bf16 v[20:23], v[172:175], v[144:147], v[20:23]
    ds_read_b64_tr_b16 v[124:125], v187 offset:0
    v_mfma_f32_16x16x32_bf16 v[24:27], v[144:147], v[176:179], v[24:27]
    ds_read_b64_tr_b16 v[126:127], v187 offset:512
    v_mfma_f32_16x16x32_bf16 v[28:31], v[144:147], v[180:183], v[28:31]
    ds_read_b64_tr_b16 v[128:129], v186 offset:8192
    v_mfma_f32_16x16x32_bf16 v[32:35], v[160:163], v[148:151], v[32:35]
    ds_read_b64_tr_b16 v[130:131], v186 offset:8704
    v_mfma_f32_16x16x32_bf16 v[36:39], v[164:167], v[148:151], v[36:39]
    ds_read_b64_tr_b16 v[132:133], v187 offset:8192
    v_mfma_f32_16x16x32_bf16 v[40:43], v[168:171], v[148:151], v[40:43]
    ds_read_b64_tr_b16 v[134:135], v187 offset:8704
    v_mfma_f32_16x16x32_bf16 v[44:47], v[172:175], v[148:151], v[44:47]
    ds_read_b64_tr_b16 v[136:137], v186 offset:16384
    v_mfma_f32_16x16x32_bf16 v[48:51], v[148:151], v[176:179], v[48:51]
    ds_read_b64_tr_b16 v[138:139], v186 offset:16896
    v_mfma_f32_16x16x32_bf16 v[52:55], v[148:151], v[180:183], v[52:55]
    ds_read_b64_tr_b16 v[140:141], v187 offset:16384
    v_mfma_f32_16x16x32_bf16 v[56:59], v[160:163], v[152:155], v[56:59]
    ds_read_b64_tr_b16 v[142:143], v187 offset:16896
    v_mfma_f32_16x16x32_bf16 v[60:63], v[164:167], v[152:155], v[60:63]
    ds_read_b128 v[108:111], v184 offset:2048
    v_mfma_f32_16x16x32_bf16 v[64:67], v[168:171], v[152:155], v[64:67]
    ds_read_b128 v[112:115], v184 offset:4096
    v_mfma_f32_16x16x32_bf16 v[68:71], v[172:175], v[152:155], v[68:71]
    ds_read_b128 v[116:119], v184 offset:6144
    v_mfma_f32_16x16x32_bf16 v[72:75], v[152:155], v[176:179], v[72:75]
    v_mfma_f32_16x16x32_bf16 v[76:79], v[152:155], v[180:183], v[76:79]
    v_mfma_f32_16x16x32_bf16 v[80:83], v[160:163], v[156:159], v[80:83]
    v_mfma_f32_16x16x32_bf16 v[84:87], v[164:167], v[156:159], v[84:87]
    v_mfma_f32_16x16x32_bf16 v[88:91], v[168:171], v[156:159], v[88:91]
    v_mfma_f32_16x16x32_bf16 v[92:95], v[172:175], v[156:159], v[92:95]
    v_mfma_f32_16x16x32_bf16 v[96:99], v[156:159], v[176:179], v[96:99]
    v_mfma_f32_16x16x32_bf16 v[100:103], v[156:159], v[180:183], v[100:103]
L_cmid:
    s_waitcnt lgkmcnt(0)
    s_nop 0
    v_mfma_f32_16x16x32_bf16 v[8:11], v[120:123], v[104:107], v[8:11]
    ds_read_b128 v[144:147], v185 offset:0
    v_mfma_f32_16x16x32_bf16 v[12:15], v[124:127], v[104:107], v[12:15]
    ds_read_b64_tr_b16 v[160:161], v186 offset:4096
    v_mfma_f32_16x16x32_bf16 v[16:19], v[128:131], v[104:107], v[16:19]
    ds_read_b64_tr_b16 v[162:163], v186 offset:4608
    v_mfma_f32_16x16x32_bf16 v[20:23], v[132:135], v[104:107], v[20:23]
    ds_read_b64_tr_b16 v[164:165], v187 offset:4096
    v_mfma_f32_16x16x32_bf16 v[24:27], v[104:107], v[136:139], v[24:27]
    ds_read_b64_tr_b16 v[166:167], v187 offset:4608
    v_mfma_f32_16x16x32_bf16 v[28:31], v[104:107], v[140:143], v[28:31]
    ds_read_b64_tr_b16 v[168:169], v186 offset:12288
    v_mfma_f32_16x16x32_bf16 v[32:35], v[120:123], v[108:111], v[32:35]
    ds_read_b64_tr_b16 v[170:171], v186 offset:12800
    v_mfma_f32_16x16x32_bf16 v[36:39], v[124:127], v[108:111], v[36:39]
    ds_read_b64_tr_b16 v[172:173], v187 offset:12288
    v_mfma_f32_16x16x32_bf16 v[40:43], v[128:131], v[108:111], v[40:43]
    ds_read_b64_tr_b16 v[174:175], v187 offset:12800
    v_mfma_f32_16x16x32_bf16 v[44:47], v[132:135], v[108:111], v[44:47]
    ds_read_b64_tr_b16 v[176:177], v186 offset:20480
    v_mfma_f32_16x16x32_bf16 v[48:51], v[108:111], v[136:139], v[48:51]
    ds_read_b64_tr_b16 v[178:179], v186 offset:20992
    v_mfma_f32_16x16x32_bf16 v[52:55], v[108:111], v[140:143], v[52:55]
    ds_read_b64_tr_b16 v[180:181], v187 offset:20480
    v_mfma_f32_16x16x32_bf16 v[56:59], v[120:123], v[112:115], v[56:59]
    ds_read_b64_tr_b16 v[182:183], v187 offset:20992
    v_mfma_f32_16x16x32_bf16 v[60:63], v[124:127], v[112:115], v[60:63]
    ds_read_b128 v[148:151], v185 offset:2048
    v_mfma_f32_16x16x32_bf16 v[64:67], v[128:131], v[112:115], v[64:67]
    ds_read_b128 v[152:155], v185 offset:4096
    v_mfma_f32_16x16x32_bf16 v[68:71], v[132:135], v[112:115], v[68:71]
    ds_read_b128 v[156:159], v185 offset:6144
    v_mfma_f32_16x16x32_bf16 v[72:75], v[112:115], v[136:139], v[72:75]
    v_mfma_f32_16x16x32_bf16 v[76:79], v[112:115], v[140:143], v[76:79]
    v_mfma_f32_16x16x32_bf16 v[80:83], v[120:123], v[116:119], v[80:83]
    v_mfma_f32_16x16x32_bf16 v[84:87], v[124:127], v[116:119], v[84:87]
    v_mfma_f32_16x16x32_bf16 v[88:91], v[128:131], v[116:119], v[88:91]
    v_mfma_f32_16x16x32_bf16 v[92:95], v[132:135], v[116:119], v[92:95]
    v_mfma_f32_16x16x32_bf16 v[96:99], v[116:119], v[136:139], v[96:99]
    v_mfma_f32_16x16x32_bf16 v[100:103], v[116:119], v[140:143], v[100:103]
    s_waitcnt lgkmcnt(0)
    s_barrier
    v_mfma_f32_16x16x32_bf16 v[8:11], v[160:163], v[144:147], v[8:11]
    ds_read_b128 v[104:107], v184 offset:40960
    v_mfma_f32_16x16x32_bf16 v[12:15], v[164:167], v[144:147], v[12:15]
    ds_read_b64_tr_b16 v[120:121], v186 offset:40960
    v_mfma_f32_16x16x32_bf16 v[16:19], v[168:171], v[144:147], v[16:19]
    ds_read_b64_tr_b16 v[122:123], v186 offset:41472
    v_mfma_f32_16x16x32_bf16 v[20:23], v[172:175], v[144:147], v[20:23]
    ds_read_b64_tr_b16 v[124:125], v187 offset:40960
    v_mfma_f32_16x16x32_bf16 v[24:27], v[144:147], v[176:179], v[24:27]
    ds_read_b64_tr_b16 v[126:127], v187 offset:41472
    v_mfma_f32_16x16x32_bf16 v[28:31], v[144:147], v[180:183], v[28:31]
    ds_read_b64_tr_b16 v[128:129], v186 offset:49152
    v_mfma_f32_16x16x32_bf16 v[32:35], v[160:163], v[148:151], v[32:35]
    ds_read_b64_tr_b16 v[130:131], v186 offset:49664
    v_mfma_f32_16x16x32_bf16 v[36:39], v[164:167], v[148:151], v[36:39]
    ds_read_b64_tr_b16 v[132:133], v187 offset:49152
    v_mfma_f32_16x16x32_bf16 v[40:43], v[168:171], v[148:151], v[40:43]
    ds_read_b64_tr_b16 v[134:135], v187 offset:49664
    v_mfma_f32_16x16x32_bf16 v[44:47], v[172:175], v[148:151], v[44:47]
    ds_read_b64_tr_b16 v[136:137], v186 offset:57344
    v_mfma_f32_16x16x32_bf16 v[48:51], v[148:151], v[176:179], v[48:51]
    ds_read_b64_tr_b16 v[138:139], v186 offset:57856
    v_mfma_f32_16x16x32_bf16 v[52:55], v[148:151], v[180:183], v[52:55]
    ds_read_b64_tr_b16 v[140:141], v187 offset:57344
    v_mfma_f32_16x16x32_bf16 v[56:59], v[160:163], v[152:155], v[56:59]
    ds_read_b64_tr_b16 v[142:143], v187 offset:57856
    v_mfma_f32_16x16x32_bf16 v[60:63], v[164:167], v[152:155], v[60:63]
    ds_read_b128 v[108:111], v184 offset:43008
    v_mfma_f32_16x16x32_bf16 v[64:67], v[168:171], v[152:155], v[64:67]
    ds_read_b128 v[112:115], v184 offset:45056
    v_mfma_f32_16x16x32_bf16 v[68:71], v[172:175], v[152:155], v[68:71]
    ds_read_b128 v[116:119], v184 offset:47104
    v_mfma_f32_16x16x32_bf16 v[72:75], v[152:155], v[176:179], v[72:75]
    v_mfma_f32_16x16x32_bf16 v[76:79], v[152:155], v[180:183], v[76:79]
    v_mfma_f32_16x16x32_bf16 v[80:83], v[160:163], v[156:159], v[80:83]
    v_mfma_f32_16x16x32_bf16 v[84:87], v[164:167], v[156:159], v[84:87]
    v_mfma_f32_16x16x32_bf16 v[88:91], v[168:171], v[156:159], v[88:91]
    v_mfma_f32_16x16x32_bf16 v[92:95], v[172:175], v[156:159], v[92:95]
    v_mfma_f32_16x16x32_bf16 v[96:99], v[156:159], v[176:179], v[96:99]
    v_mfma_f32_16x16x32_bf16 v[100:103], v[156:159], v[180:183], v[100:103]
    s_waitcnt lgkmcnt(0)
    s_nop 0
    v_mfma_f32_16x16x32_bf16 v[8:11], v[120:123], v[104:107], v[8:11]
    ds_read_b128 v[144:147], v185 offset:40960
    v_mfma_f32_16x16x32_bf16 v[12:15], v[124:127], v[104:107], v[12:15]
    ds_read_b64_tr_b16 v[160:161], v186 offset:45056
    v_mfma_f32_16x16x32_bf16 v[16:19], v[128:131], v[104:107], v[16:19]
    ds_read_b64_tr_b16 v[162:163], v186 offset:45568
    v_mfma_f32_16x16x32_bf16 v[20:23], v[132:135], v[104:107], v[20:23]
    ds_read_b64_tr_b16 v[164:165], v187 offset:45056
    v_mfma_f32_16x16x32_bf16 v[24:27], v[104:107], v[136:139], v[24:27]
    ds_read_b64_tr_b16 v[166:167], v187 offset:45568
    v_mfma_f32_16x16x32_bf16 v[28:31], v[104:107], v[140:143], v[28:31]
    ds_read_b64_tr_b16 v[168:169], v186 offset:53248
    v_mfma_f32_16x16x32_bf16 v[32:35], v[120:123], v[108:111], v[32:35]
    ds_read_b64_tr_b16 v[170:171], v186 offset:53760
    v_mfma_f32_16x16x32_bf16 v[36:39], v[124:127], v[108:111], v[36:39]
    ds_read_b64_tr_b16 v[172:173], v187 offset:53248
    v_mfma_f32_16x16x32_bf16 v[40:43], v[128:131], v[108:111], v[40:43]
    ds_read_b64_tr_b16 v[174:175], v187 offset:53760
    v_mfma_f32_16x16x32_bf16 v[44:47], v[132:135], v[108:111], v[44:47]
    ds_read_b64_tr_b16 v[176:177], v186 offset:61440
    v_mfma_f32_16x16x32_bf16 v[48:51], v[108:111], v[136:139], v[48:51]
    ds_read_b64_tr_b16 v[178:179], v186 offset:61952
    v_mfma_f32_16x16x32_bf16 v[52:55], v[108:111], v[140:143], v[52:55]
    ds_read_b64_tr_b16 v[180:181], v187 offset:61440
    v_mfma_f32_16x16x32_bf16 v[56:59], v[120:123], v[112:115], v[56:59]
    ds_read_b64_tr_b16 v[182:183], v187 offset:61952
    v_mfma_f32_16x16x32_bf16 v[60:63], v[124:127], v[112:115], v[60:63]
    ds_read_b128 v[148:151], v185 offset:43008
    v_mfma_f32_16x16x32_bf16 v[64:67], v[128:131], v[112:115], v[64:67]
    ds_read_b128 v[152:155], v185 offset:45056
    v_mfma_f32_16x16x32_bf16 v[68:71], v[132:135], v[112:115], v[68:71]
    ds_read_b128 v[156:159], v185 offset:47104
    v_mfma_f32_16x16x32_bf16 v[72:75], v[112:115], v[136:139], v[72:75]
    v_mfma_f32_16x16x32_bf16 v[76:79], v[112:115], v[140:143], v[76:79]
    v_mfma_f32_16x16x32_bf16 v[80:83], v[120:123], v[116:119], v[80:83]
    v_mfma_f32_16x16x32_bf16 v[84:87], v[124:127], v[116:119], v[84:87]
    v_mfma_f32_16x16x32_bf16 v[88:91], v[128:131], v[116:119], v[88:91]
    v_mfma_f32_16x16x32_bf16 v[92:95], v[132:135], v[116:119], v[92:95]
    v_mfma_f32_16x16x32_bf16 v[96:99], v[116:119], v[136:139], v[96:99]
    v_mfma_f32_16x16x32_bf16 v[100:103], v[116:119], v[140:143], v[100:103]
    s_waitcnt lgkmcnt(0)
    s_barrier
    v_mfma_f32_16x16x32_bf16 v[8:11], v[160:163], v[144:147], v[8:11]
    ds_read_b128 v[104:107], v188 offset:0
    v_mfma_f32_16x16x32_bf16 v[12:15], v[164:167], v[144:147], v[12:15]
    ds_read_b64_tr_b16 v[120:121], v190 offset:0
    v_mfma_f32_16x16x32_bf16 v[16:19], v[168:171], v[144:147], v[16:19]
    ds_read_b64_tr_b16 v[122:123], v190 offset:512
    v_mfma_f32_16x16x32_bf16 v[20:23], v[172:175], v[144:147], v[20:23]
    ds_read_b64_tr_b16 v[124:125], v191 offset:0
    v_mfma_f32_16x16x32_bf16 v[24:27], v[144:147], v[176:179], v[24:27]
    ds_read_b64_tr_b16 v[126:127], v191 offset:512
    v_mfma_f32_16x16x32_bf16 v[28:31], v[144:147], v[180:183], v[28:31]
    ds_read_b64_tr_b16 v[128:129], v190 offset:8192
    v_mfma_f32_16x16x32_bf16 v[32:35], v[160:163], v[148:151], v[32:35]
    ds_read_b64_tr_b16 v[130:131], v190 offset:8704
    v_mfma_f32_16x16x32_bf16 v[36:39], v[164:167], v[148:151], v[36:39]
    ds_read_b64_tr_b16 v[132:133], v191 offset:8192
    v_mfma_f32_16x16x32_bf16 v[40:43], v[168:171], v[148:151], v[40:43]
    ds_read_b64_tr_b16 v[134:135], v191 offset:8704
    v_mfma_f32_16x16x32_bf16 v[44:47], v[172:175], v[148:151], v[44:47]
    ds_read_b64_tr_b16 v[136:137], v190 offset:16384
    v_mfma_f32_16x16x32_bf16 v[48:51], v[148:151], v[176:179], v[48:51]
    ds_read_b64_tr_b16 v[138:139], v190 offset:16896
    v_mfma_f32_16x16x32_bf16 v[52:55], v[148:151], v[180:183], v[52:55]
    ds_read_b64_tr_b16 v[140:141], v191 offset:16384
    v_mfma_f32_16x16x32_bf16 v[56:59], v[160:163], v[152:155], v[56:59]
    ds_read_b64_tr_b16 v[142:143], v191 offset:16896
    v_mfma_f32_16x16x32_bf16 v[60:63], v[164:167], v[152:155], v[60:63]
    ds_read_b128 v[108:111], v188 offset:2048
    v_mfma_f32_16x16x32_bf16 v[64:67], v[168:171], v[152:155], v[64:67]
    ds_read_b128 v[112:115], v188 offset:4096
    v_mfma_f32_16x16x32_bf16 v[68:71], v[172:175], v[152:155], v[68:71]
    ds_read_b128 v[116:119], v188 offset:6144
    v_mfma_f32_16x16x32_bf16 v[72:75], v[152:155], v[176:179], v[72:75]
    v_mfma_f32_16x16x32_bf16 v[76:79], v[152:155], v[180:183], v[76:79]
    v_mfma_f32_16x16x32_bf16 v[80:83], v[160:163], v[156:159], v[80:83]
    v_mfma_f32_16x16x32_bf16 v[84:87], v[164:167], v[156:159], v[84:87]
    v_mfma_f32_16x16x32_bf16 v[88:91], v[168:171], v[156:159], v[88:91]
    v_mfma_f32_16x16x32_bf16 v[92:95], v[172:175], v[156:159], v[92:95]
    v_mfma_f32_16x16x32_bf16 v[96:99], v[156:159], v[176:179], v[96:99]
    v_mfma_f32_16x16x32_bf16 v[100:103], v[156:159], v[180:183], v[100:103]
    s_waitcnt lgkmcnt(0)
    s_nop 0
    v_mfma_f32_16x16x32_bf16 v[8:11], v[120:123], v[104:107], v[8:11]
    ds_read_b128 v[144:147], v189 offset:0
    v_mfma_f32_16x16x32_bf16 v[12:15], v[124:127], v[104:107], v[12:15]
    ds_read_b64_tr_b16 v[160:161], v190 offset:4096
    v_mfma_f32_16x16x32_bf16 v[16:19], v[128:131], v[104:107], v[16:19]
    ds_read_b64_tr_b16 v[162:163], v190 offset:4608
    v_mfma_f32_16x16x32_bf16 v[20:23], v[132:135], v[104:107], v[20:23]
    ds_read_b64_tr_b16 v[164:165], v191 offset:4096
    v_mfma_f32_16x16x32_bf16 v[24:27], v[104:107], v[136:139], v[24:27]
    ds_read_b64_tr_b16 v[166:167], v191 offset:4608
    v_mfma_f32_16x16x32_bf16 v[28:31], v[104:107], v[140:143], v[28:31]
    ds_read_b64_tr_b16 v[168:169], v190 offset:12288
    v_mfma_f32_16x16x32_bf16 v[32:35], v[120:123], v[108:111], v[32:35]
    ds_read_b64_tr_b16 v[170:171], v190 offset:12800
    v_mfma_f32_16x16x32_bf16 v[36:39], v[124:127], v[108:111], v[36:39]
    ds_read_b64_tr_b16 v[172:173], v191 offset:12288
    v_mfma_f32_16x16x32_bf16 v[40:43], v[128:131], v[108:111], v[40:43]
    ds_read_b64_tr_b16 v[174:175], v191 offset:12800
    v_mfma_f32_16x16x32_bf16 v[44:47], v[132:135], v[108:111], v[44:47]
    ds_read_b64_tr_b16 v[176:177], v190 offset:20480
    v_mfma_f32_16x16x32_bf16 v[48:51], v[108:111], v[136:139], v[48:51]
    ds_read_b64_tr_b16 v[178:179], v190 offset:20992
    v_mfma_f32_16x16x32_bf16 v[52:55], v[108:111], v[140:143], v[52:55]
    ds_read_b64_tr_b16 v[180:181], v191 offset:20480
    v_mfma_f32_16x16x32_bf16 v[56:59], v[120:123], v[112:115], v[56:59]
    ds_read_b64_tr_b16 v[182:183], v191 offset:20992
    v_mfma_f32_16x16x32_bf16 v[60:63], v[124:127], v[112:115], v[60:63]
    ds_read_b128 v[148:151], v189 offset:2048
    v_mfma_f32_16x16x32_bf16 v[64:67], v[128:131], v[112:115], v[64:67]
    ds_read_b128 v[152:155], v189 offset:4096
    v_mfma_f32_16x16x32_bf16 v[68:71], v[132:135], v[112:115], v[68:71]
    ds_read_b128 v[156:159], v189 offset:6144
    v_mfma_f32_16x16x32_bf16 v[72:75], v[112:115], v[136:139], v[72:75]
    s_add_u32 s66, s66, 1
    s_cmp_lt_u32 s66, 5
    v_mfma_f32_16x16x32_bf16 v[76:79], v[112:115], v[140:143], v[76:79]
    v_mfma_f32_16x16x32_bf16 v[80:83], v[120:123], v[116:119], v[80:83]
    v_mfma_f32_16x16x32_bf16 v[84:87], v[124:127], v[116:119], v[84:87]
    v_mfma_f32_16x16x32_bf16 v[88:91], v[128:131], v[116:119], v[88:91]
    v_mfma_f32_16x16x32_bf16 v[92:95], v[132:135], v[116:119], v[92:95]
    v_mfma_f32_16x16x32_bf16 v[96:99], v[116:119], v[136:139], v[96:99]
    v_mfma_f32_16x16x32_bf16 v[100:103], v[116:119], v[140:143], v[100:103]
    s_cbranch_scc1 L_cloop
    s_nop 0
    s_waitcnt lgkmcnt(0)
    s_barrier
    v_mfma_f32_16x16x32_bf16 v[8:11], v[160:163], v[144:147], v[8:11]
    ds_read_b128 v[104:107], v184 offset:0
    s_lshl_b32 s3, s38, 1
    s_lshr_b32 s28, s39, 2
    v_mfma_f32_16x16x32_bf16 v[12:15], v[164:167], v[144:147], v[12:15]
    ds_read_b64_tr_b16 v[120:121], v186 offset:0
    s_add_u32 s3, s3, s28
    s_lshl_b32 s69, s3, 4
    v_mfma_f32_16x16x32_bf16 v[16:19], v[168:171], v[144:147], v[16:19]
    ds_read_b64_tr_b16 v[122:123], v186 offset:512
    v_and_b32 v241, 15, v1
    v_add_u32 v240, s69, v241
    v_mfma_f32_16x16x32_bf16 v[20:23], v[172:175], v[144:147], v[20:23]
    ds_read_b64_tr_b16 v[124:125], v187 offset:0
    v_lshlrev_b32 v240, 7, v240
    v_lshrrev_b32 v241, 1, v241
    v_mfma_f32_16x16x32_bf16 v[24:27], v[144:147], v[176:179], v[24:27]
    ds_read_b64_tr_b16 v[126:127], v187 offset:512
    v_lshrrev_b32 v242, 5, v1
    v_xor_b32 v241, v241, v242
    v_mfma_f32_16x16x32_bf16 v[28:31], v[144:147], v[180:183], v[28:31]
    ds_read_b64_tr_b16 v[128:129], v186 offset:8192
    v_lshl_add_u32 v240, v241, 4, v240
    v_bfe_u32 v242, v1, 4, 1
    v_mfma_f32_16x16x32_bf16 v[32:35], v[160:163], v[148:151], v[32:35]
    ds_read_b64_tr_b16 v[130:131], v186 offset:8704
    v_lshl_add_u32 v240, v242, 3, v240
    v_xor_b32_e64 v241, 32, v240
    v_mfma_f32_16x16x32_bf16 v[36:39], v[164:167], v[148:151], v[36:39]
    ds_read_b64_tr_b16 v[132:133], v187 offset:8192
    v_xor_b32_e64 v242, 64, v240
    v_xor_b32 v243, 96, v240
    v_mfma_f32_16x16x32_bf16 v[40:43], v[168:171], v[148:151], v[40:43]
    ds_read_b64_tr_b16 v[134:135], v187 offset:8704
    v_and_b32 v2, 15, v1
    v_lshrrev_b32 v3, 4, v1
    v_mfma_f32_16x16x32_bf16 v[44:47], v[172:175], v[148:151], v[44:47]
    ds_read_b64_tr_b16 v[136:137], v186 offset:16384
    s_lshl_b32 s3, s64, 8
    s_nop 0
    s_add_u32 s3, s3, 152064
    v_mfma_f32_16x16x32_bf16 v[48:51], v[148:151], v[176:179], v[48:51]
    ds_read_b64_tr_b16 v[138:139], v186 offset:16896
    v_lshl_add_u32 v188, v2, 2, s3
    v_lshl_add_u32 v189, v3, 4, s3
    v_mfma_f32_16x16x32_bf16 v[52:55], v[148:151], v[180:183], v[52:55]
    ds_read_b64_tr_b16 v[140:141], v187 offset:16384
    v_lshrrev_b32_e64 v7, 5, v1
    v_lshl_add_u32 v190, v7, 6, v188
    v_mfma_f32_16x16x32_bf16 v[56:59], v[160:163], v[152:155], v[56:59]
    ds_read_b64_tr_b16 v[142:143], v187 offset:16896
    s_lshl_b32 s3, s65, 7
    s_nop 0
    s_add_u32 s3, s3, 154880
    v_mfma_f32_16x16x32_bf16 v[60:63], v[164:167], v[152:155], v[60:63]
    ds_read_b128 v[108:111], v184 offset:2048
    v_lshl_add_u32 v191, v3, 4, s3
    v_lshl_add_u32 v248, v2, 2, s3
    v_mfma_f32_16x16x32_bf16 v[64:67], v[168:171], v[152:155], v[64:67]
    ds_read_b128 v[112:115], v184 offset:4096
    s_lshl_b32 s3, s64, 7
    s_nop 0
    s_add_u32 s3, s3, 154624
    v_mfma_f32_16x16x32_bf16 v[68:71], v[172:175], v[152:155], v[68:71]
    ds_read_b128 v[116:119], v184 offset:6144
    v_lshl_add_u32 v249, v3, 4, s3
    v_xor_b32 v253, 128, v249
    v_mfma_f32_16x16x32_bf16 v[72:75], v[152:155], v[176:179], v[72:75]
    v_lshrrev_b32 v250, 2, v1
    v_lshlrev_b32 v250, 6, v250
    v_mfma_f32_16x16x32_bf16 v[76:79], v[152:155], v[180:183], v[76:79]
    v_and_b32_e64 v251, 3, v1
    v_lshl_add_u32 v250, v251, 3, v250
    v_mfma_f32_16x16x32_bf16 v[80:83], v[160:163], v[156:159], v[80:83]
    s_lshl_b32 s3, s65, 11
    s_add_u32 s3, s3, 147712
    v_mfma_f32_16x16x32_bf16 v[84:87], v[164:167], v[156:159], v[84:87]
    v_add_u32 v252, s3, v250
    v_bfe_u32 v5, v1, 1, 2
    v_mfma_f32_16x16x32_bf16 v[88:91], v[168:171], v[156:159], v[88:91]
    v_lshlrev_b32_e64 v5, 2, v5
    v_bfe_u32 v4, v1, 3, 1
    v_mfma_f32_16x16x32_bf16 v[92:95], v[172:175], v[156:159], v[92:95]
    v_lshl_add_u32 v5, v4, 1, v5
    v_and_b32 v4, 1, v1
    v_mfma_f32_16x16x32_bf16 v[96:99], v[156:159], v[176:179], v[96:99]
    v_add_u32 v5, v5, v4
    v_xor_b32 v5, v5, v3
    v_mfma_f32_16x16x32_bf16 v[100:103], v[156:159], v[180:183], v[100:103]
    s_lshl_b32 s3, s38, 13
    s_add_u32 s3, s3, 98304
    s_waitcnt lgkmcnt(0)
    s_nop 0
    v_mfma_f32_16x16x32_bf16 v[8:11], v[120:123], v[104:107], v[8:11]
    ds_read_b128 v[144:147], v185 offset:0
    v_lshl_add_u32 v2, v2, 7, s3
    v_lshl_add_u32 v4, v5, 3, v2
    v_mfma_f32_16x16x32_bf16 v[12:15], v[124:127], v[104:107], v[12:15]
    ds_read_b64_tr_b16 v[160:161], v186 offset:4096
    v_xor_b32 v5, 32, v4
    v_xor_b32 v6, 64, v4
    v_mfma_f32_16x16x32_bf16 v[16:19], v[128:131], v[104:107], v[16:19]
    ds_read_b64_tr_b16 v[162:163], v186 offset:4608
    v_xor_b32 v7, 96, v4
    v_bfe_u32 v2, v1, 3, 2
    v_mfma_f32_16x16x32_bf16 v[20:23], v[132:135], v[104:107], v[20:23]
    ds_read_b64_tr_b16 v[164:165], v187 offset:4096
    v_lshlrev_b32 v2, 2, v2
    v_lshrrev_b32 v3, 5, v1
    v_mfma_f32_16x16x32_bf16 v[24:27], v[104:107], v[136:139], v[24:27]
    ds_read_b64_tr_b16 v[166:167], v187 offset:4608
    v_lshl_add_u32 v2, v3, 1, v2
    v_bfe_u32 v3, v1, 2, 1
    v_mfma_f32_16x16x32_bf16 v[28:31], v[104:107], v[140:143], v[28:31]
    ds_read_b64_tr_b16 v[168:169], v186 offset:12288
    v_add_u32 v2, v2, v3
    v_xor_b32 v2, v2, v251
    v_mfma_f32_16x16x32_bf16 v[32:35], v[120:123], v[108:111], v[32:35]
    ds_read_b64_tr_b16 v[170:171], v186 offset:12800
    v_lshrrev_b32_e64 v3, 2, v1
    v_lshl_add_u32 v3, v3, 7, s3
    v_mfma_f32_16x16x32_bf16 v[36:39], v[124:127], v[108:111], v[36:39]
    ds_read_b64_tr_b16 v[172:173], v187 offset:12288
    v_lshl_add_u32 v2, v2, 3, v3
    s_lshl_b32 s28, s64, 6
    v_mfma_f32_16x16x32_bf16 v[40:43], v[128:131], v[108:111], v[40:43]
    ds_read_b64_tr_b16 v[174:175], v187 offset:12800
    v_xor_b32 v201, s28, v2
    v_xor_b32_e64 v203, 32, v201
    v_mfma_f32_16x16x32_bf16 v[44:47], v[132:135], v[108:111], v[44:47]
    ds_read_b64_tr_b16 v[176:177], v186 offset:20480
    s_lshl_b32 s3, s38, 12
    s_add_u32 s3, s3, 131072
    v_mfma_f32_16x16x32_bf16 v[48:51], v[108:111], v[136:139], v[48:51]
    ds_read_b64_tr_b16 v[178:179], v186 offset:20992
    v_lshlrev_b32 v199, 4, v1
    v_add_u32_e64 v197, s3, v199
    v_mfma_f32_16x16x32_bf16 v[52:55], v[108:111], v[140:143], v[52:55]
    ds_read_b64_tr_b16 v[180:181], v187 offset:20480
    s_lshl_b32 s3, s37, 1
    s_add_u32 s67, s3, s65
    v_mfma_f32_16x16x32_bf16 v[56:59], v[120:123], v[112:115], v[56:59]
    ds_read_b64_tr_b16 v[182:183], v187 offset:20992
    s_lshl_b32 s3, s67, 4
    s_add_u32 s3, s3, s36
    v_mfma_f32_16x16x32_bf16 v[60:63], v[124:127], v[112:115], v[60:63]
    ds_read_b128 v[148:151], v185 offset:2048
    s_mul_i32 s3, s3, 4224
    s_add_u32 s75, s3, 8388608
    v_mfma_f32_16x16x32_bf16 v[64:67], v[128:131], v[112:115], v[64:67]
    ds_read_b128 v[152:155], v185 offset:4096
    s_lshl_b32 s3, s64, 11
    s_add_u32 s74, s75, s3
    v_mfma_f32_16x16x32_bf16 v[68:71], v[132:135], v[112:115], v[68:71]
    ds_read_b128 v[156:159], v185 offset:6144
    s_lshl_b32 s3, s64, 6
    s_add_u32 s75, s75, s3
    v_mfma_f32_16x16x32_bf16 v[72:75], v[112:115], v[136:139], v[72:75]
    ds_read_b64 v[232:233], v240
    s_add_u32 s75, s75, 4096
    s_lshl_b32 s3, s37, 4
    v_mfma_f32_16x16x32_bf16 v[76:79], v[112:115], v[140:143], v[76:79]
    ds_read_b64 v[234:235], v241
    s_add_u32 s3, s3, s36
    s_lshl_b32 s3, s3, 7
    v_mfma_f32_16x16x32_bf16 v[80:83], v[120:123], v[116:119], v[80:83]
    ds_read_b64 v[236:237], v242
    s_add_u32 s3, s3, 32768
    v_mov_b32 v251, s86
    v_mfma_f32_16x16x32_bf16 v[84:87], v[124:127], v[116:119], v[84:87]
    ds_read_b64 v[238:239], v243
    s_cmp_lg_u32 s38, 0
    s_cselect_b32 s76, 268435456, s3
    v_mfma_f32_16x16x32_bf16 v[88:91], v[128:131], v[116:119], v[88:91]
    s_nop 0
    v_mfma_f32_16x16x32_bf16 v[92:95], v[132:135], v[116:119], v[92:95]
    s_nop 0
    v_mfma_f32_16x16x32_bf16 v[96:99], v[116:119], v[136:139], v[96:99]
    s_nop 0
    v_mfma_f32_16x16x32_bf16 v[100:103], v[116:119], v[140:143], v[100:103]
    s_nop 0
    s_waitcnt lgkmcnt(0)
    v_mfma_f32_16x16x32_bf16 v[16:19], v[168:171], v[144:147], v[16:19]
    s_barrier
    s_nop 0
    v_mfma_f32_16x16x32_bf16 v[20:23], v[172:175], v[144:147], v[20:23]
    ds_read_b32 v192, v188 offset:0
    ds_read_b32 v194, v188 offset:64
    v_mfma_f32_16x16x32_bf16 v[40:43], v[168:171], v[148:151], v[40:43]
    ds_read_b32 v196, v188 offset:128
    ds_read_b32 v198, v188 offset:192
    v_mfma_f32_16x16x32_bf16 v[44:47], v[172:175], v[148:151], v[44:47]
    ds_read_b128 v[204:207], v191 offset:256
    v_mfma_f32_16x16x32_bf16 v[64:67], v[168:171], v[152:155], v[64:67]
    ds_read_b128 v[208:211], v191 offset:320
    v_mfma_f32_16x16x32_bf16 v[68:71], v[172:175], v[152:155], v[68:71]
    ds_read_b64_tr_b16 v[224:225], v252 offset:0
    v_mfma_f32_16x16x32_bf16 v[88:91], v[168:171], v[156:159], v[88:91]
    ds_read_b64_tr_b16 v[226:227], v252 offset:1024
    v_mfma_f32_16x16x32_bf16 v[92:95], v[172:175], v[156:159], v[92:95]
    ds_read_b64_tr_b16 v[228:229], v252 offset:32
    v_mfma_f32_16x16x32_bf16 v[24:27], v[144:147], v[176:179], v[24:27]
    ds_read_b64_tr_b16 v[230:231], v252 offset:1056
    v_mfma_f32_16x16x32_bf16 v[28:31], v[144:147], v[180:183], v[28:31]
    ds_read_b128 v[104:107], v189 offset:0
    v_mfma_f32_16x16x32_bf16 v[48:51], v[148:151], v[176:179], v[48:51]
    ds_read_b128 v[108:111], v189 offset:64
    v_mfma_f32_16x16x32_bf16 v[52:55], v[148:151], v[180:183], v[52:55]
    ds_read_b128 v[112:115], v189 offset:128
    v_mfma_f32_16x16x32_bf16 v[72:75], v[152:155], v[176:179], v[72:75]
    ds_read_b128 v[116:119], v189 offset:192
    v_mfma_f32_16x16x32_bf16 v[76:79], v[152:155], v[180:183], v[76:79]
    ds_read_b32 v250, v248 offset:576
    ds_read_b32 v248, v248 offset:512
    v_mfma_f32_16x16x32_bf16 v[96:99], v[156:159], v[176:179], v[96:99]
    ds_read_b32 v200, v188 offset:2048
    v_mfma_f32_16x16x32_bf16 v[100:103], v[156:159], v[180:183], v[100:103]
    ds_read_b32 v202, v188 offset:2112
    v_mfma_f32_16x16x32_bf16 v[8:11], v[160:163], v[144:147], v[8:11]
    ds_read_b32 v220, v188 offset:2176
    v_mfma_f32_16x16x32_bf16 v[12:15], v[164:167], v[144:147], v[12:15]
    ds_read_b32 v222, v188 offset:2240
    v_mfma_f32_16x16x32_bf16 v[32:35], v[160:163], v[148:151], v[32:35]
    ds_read_b32 v193, v190 offset:2048
    ds_read_b32 v195, v190 offset:1024
    v_mfma_f32_16x16x32_bf16 v[36:39], v[164:167], v[148:151], v[36:39]
    ds_read_b32 v221, v190 offset:2176
    ds_read_b32 v223, v190 offset:1152
    v_mfma_f32_16x16x32_bf16 v[56:59], v[160:163], v[152:155], v[56:59]
    ds_read_b128 v[120:123], v249 offset:0
    v_mfma_f32_16x16x32_bf16 v[60:63], v[164:167], v[152:155], v[60:63]
    ds_read_b128 v[124:127], v249 offset:64
    v_mfma_f32_16x16x32_bf16 v[80:83], v[160:163], v[156:159], v[80:83]
    ds_read_b128 v[212:215], v191 offset:0
    v_mfma_f32_16x16x32_bf16 v[84:87], v[164:167], v[156:159], v[84:87]
    ds_read_b128 v[216:219], v191 offset:64
    s_waitcnt lgkmcnt(4)
    v_mov_b32 v177, v232
    v_mov_b32 v179, v233
    v_mov_b32 v181, v234
    v_mov_b32 v183, v235
    v_mov_b32 v185, v236
    v_mov_b32 v187, v237
    v_mov_b32 v189, v238
    v_mov_b32_e64 v191, v239
    v_pk_fma_f32 v[16:17], v[192:193], v[204:205], v[16:17] op_sel_hi:[0,1,1] neg_lo:[1,0,0] neg_hi:[1,0,0]
    v_pk_fma_f32 v[18:19], v[192:193], v[206:207], v[18:19] op_sel_hi:[0,1,1] neg_lo:[1,0,0] neg_hi:[1,0,0]
    v_pk_fma_f32 v[20:21], v[192:193], v[208:209], v[20:21] op_sel_hi:[0,1,1] neg_lo:[1,0,0] neg_hi:[1,0,0]
    v_pk_fma_f32 v[22:23], v[192:193], v[210:211], v[22:23] op_sel_hi:[0,1,1] neg_lo:[1,0,0] neg_hi:[1,0,0]
    v_cvt_pk_bf16_f32 v232, v16, v17
    v_cvt_pk_bf16_f32 v233, v18, v19
    v_cvt_pk_bf16_f32 v234, v20, v21
    v_cvt_pk_bf16_f32 v235, v22, v23
    v_pk_fma_f32 v[40:41], v[194:195], v[204:205], v[40:41] op_sel_hi:[0,1,1] neg_lo:[1,0,0] neg_hi:[1,0,0]
    v_pk_fma_f32 v[42:43], v[194:195], v[206:207], v[42:43] op_sel_hi:[0,1,1] neg_lo:[1,0,0] neg_hi:[1,0,0]
    v_pk_fma_f32 v[44:45], v[194:195], v[208:209], v[44:45] op_sel_hi:[0,1,1] neg_lo:[1,0,0] neg_hi:[1,0,0]
    v_pk_fma_f32 v[46:47], v[194:195], v[210:211], v[46:47] op_sel_hi:[0,1,1] neg_lo:[1,0,0] neg_hi:[1,0,0]
    v_cvt_pk_bf16_f32 v236, v40, v41
    v_cvt_pk_bf16_f32 v237, v42, v43
    v_cvt_pk_bf16_f32 v238, v44, v45
    v_cvt_pk_bf16_f32 v239, v46, v47
    v_pk_fma_f32 v[64:65], v[196:197], v[204:205], v[64:65] op_sel_hi:[0,1,1] neg_lo:[1,0,0] neg_hi:[1,0,0]
    v_pk_fma_f32 v[66:67], v[196:197], v[206:207], v[66:67] op_sel_hi:[0,1,1] neg_lo:[1,0,0] neg_hi:[1,0,0]
    v_pk_fma_f32 v[68:69], v[196:197], v[208:209], v[68:69] op_sel_hi:[0,1,1] neg_lo:[1,0,0] neg_hi:[1,0,0]
    v_pk_fma_f32 v[70:71], v[196:197], v[210:211], v[70:71] op_sel_hi:[0,1,1] neg_lo:[1,0,0] neg_hi:[1,0,0]
    v_cvt_pk_bf16_f32 v240, v64, v65
    v_cvt_pk_bf16_f32 v241, v66, v67
    v_cvt_pk_bf16_f32 v242, v68, v69
    v_cvt_pk_bf16_f32 v243, v70, v71
    v_pk_fma_f32 v[88:89], v[198:199], v[204:205], v[88:89] op_sel_hi:[0,1,1] neg_lo:[1,0,0] neg_hi:[1,0,0]
    v_pk_fma_f32 v[90:91], v[198:199], v[206:207], v[90:91] op_sel_hi:[0,1,1] neg_lo:[1,0,0] neg_hi:[1,0,0]
    v_pk_fma_f32 v[92:93], v[198:199], v[208:209], v[92:93] op_sel_hi:[0,1,1] neg_lo:[1,0,0] neg_hi:[1,0,0]
    v_pk_fma_f32 v[94:95], v[198:199], v[210:211], v[94:95] op_sel_hi:[0,1,1] neg_lo:[1,0,0] neg_hi:[1,0,0]
    v_cvt_pk_bf16_f32 v244, v88, v89
    v_cvt_pk_bf16_f32 v245, v90, v91
    v_cvt_pk_bf16_f32 v246, v92, v93
    v_cvt_pk_bf16_f32 v247, v94, v95
    v_mfma_f32_16x16x32_bf16 v[144:147], v[224:227], v[232:235], 0
    v_mfma_f32_16x16x32_bf16 v[148:151], v[228:231], v[232:235], 0
    v_mfma_f32_16x16x32_bf16 v[152:155], v[224:227], v[236:239], 0
    v_mfma_f32_16x16x32_bf16 v[156:159], v[228:231], v[236:239], 0
    v_mfma_f32_16x16x32_bf16 v[160:163], v[224:227], v[240:243], 0
    v_mfma_f32_16x16x32_bf16 v[164:167], v[228:231], v[240:243], 0
    v_mfma_f32_16x16x32_bf16 v[168:171], v[224:227], v[244:247], 0
    v_mfma_f32_16x16x32_bf16 v[172:175], v[228:231], v[244:247], 0
    v_pk_fma_f32 v[24:25], v[104:105], v[248:249], v[24:25] op_sel_hi:[1,0,1] neg_lo:[1,0,0] neg_hi:[1,0,0]
    v_pk_fma_f32 v[26:27], v[106:107], v[248:249], v[26:27] op_sel_hi:[1,0,1] neg_lo:[1,0,0] neg_hi:[1,0,0]
    v_pk_fma_f32 v[28:29], v[104:105], v[250:251], v[28:29] op_sel_hi:[1,0,1] neg_lo:[1,0,0] neg_hi:[1,0,0]
    v_pk_fma_f32 v[30:31], v[106:107], v[250:251], v[30:31] op_sel_hi:[1,0,1] neg_lo:[1,0,0] neg_hi:[1,0,0]
    v_pk_fma_f32 v[48:49], v[108:109], v[248:249], v[48:49] op_sel_hi:[1,0,1] neg_lo:[1,0,0] neg_hi:[1,0,0]
    v_pk_fma_f32 v[50:51], v[110:111], v[248:249], v[50:51] op_sel_hi:[1,0,1] neg_lo:[1,0,0] neg_hi:[1,0,0]
    v_pk_fma_f32 v[52:53], v[108:109], v[250:251], v[52:53] op_sel_hi:[1,0,1] neg_lo:[1,0,0] neg_hi:[1,0,0]
    v_pk_fma_f32 v[54:55], v[110:111], v[250:251], v[54:55] op_sel_hi:[1,0,1] neg_lo:[1,0,0] neg_hi:[1,0,0]
    v_pk_fma_f32 v[72:73], v[112:113], v[248:249], v[72:73] op_sel_hi:[1,0,1] neg_lo:[1,0,0] neg_hi:[1,0,0]
    v_pk_fma_f32 v[74:75], v[114:115], v[248:249], v[74:75] op_sel_hi:[1,0,1] neg_lo:[1,0,0] neg_hi:[1,0,0]
    v_pk_fma_f32 v[76:77], v[112:113], v[250:251], v[76:77] op_sel_hi:[1,0,1] neg_lo:[1,0,0] neg_hi:[1,0,0]
    v_pk_fma_f32 v[78:79], v[114:115], v[250:251], v[78:79] op_sel_hi:[1,0,1] neg_lo:[1,0,0] neg_hi:[1,0,0]
    v_pk_fma_f32 v[96:97], v[116:117], v[248:249], v[96:97] op_sel_hi:[1,0,1] neg_lo:[1,0,0] neg_hi:[1,0,0]
    v_pk_fma_f32 v[98:99], v[118:119], v[248:249], v[98:99] op_sel_hi:[1,0,1] neg_lo:[1,0,0] neg_hi:[1,0,0]
    v_pk_fma_f32 v[100:101], v[116:117], v[250:251], v[100:101] op_sel_hi:[1,0,1] neg_lo:[1,0,0] neg_hi:[1,0,0]
    v_pk_fma_f32 v[102:103], v[118:119], v[250:251], v[102:103] op_sel_hi:[1,0,1] neg_lo:[1,0,0] neg_hi:[1,0,0]
    v_cvt_pk_bf16_f32 v24, v24, v25
    v_cvt_pk_bf16_f32 v25, v26, v27
    v_cvt_pk_bf16_f32 v26, v48, v49
    v_cvt_pk_bf16_f32 v27, v50, v51
    v_cvt_pk_bf16_f32 v28, v28, v29
    v_cvt_pk_bf16_f32 v29, v30, v31
    v_cvt_pk_bf16_f32 v30, v52, v53
    v_cvt_pk_bf16_f32 v31, v54, v55
    v_cvt_pk_bf16_f32 v72, v72, v73
    v_cvt_pk_bf16_f32 v73, v74, v75
    v_cvt_pk_bf16_f32 v74, v96, v97
    v_cvt_pk_bf16_f32 v75, v98, v99
    v_cvt_pk_bf16_f32 v76, v76, v77
    v_cvt_pk_bf16_f32 v77, v78, v79
    v_cvt_pk_bf16_f32 v78, v100, v101
    v_cvt_pk_bf16_f32 v79, v102, v103
    ds_read_b128 v[104:107], v253 offset:0
    ds_read_b128 v[108:111], v253 offset:64
    v_max3_f32 v176, v144, v145, v146
    v_max3_f32 v184, -v144, -v145, -v146
    v_max3_f32 v178, v152, v153, v154
    v_max3_f32 v186, -v152, -v153, -v154
    v_max3_f32 v176, v176, v147, v148
    v_max3_f32 v184, v184, -v147, -v148
    v_max3_f32 v178, v178, v155, v156
    v_max3_f32 v186, v186, -v155, -v156
    v_max3_f32 v176, v176, v149, v150
    v_max3_f32 v184, v184, -v149, -v150
    v_max3_f32 v178, v178, v157, v158
    v_max3_f32 v186, v186, -v157, -v158
    v_max_f32_e64 v176, v176, v151
    v_max_f32_e64 v184, v184, -v151
    v_max_f32_e64 v178, v178, v159
    v_max_f32_e64 v186, v186, -v159
    s_nop 0
    v_permlane32_swap_b32 v176, v178
    v_permlane32_swap_b32_e64 v184, v186
    v_max3_f32 v180, v160, v161, v162
    v_max3_f32 v188, -v160, -v161, -v162
    v_max_f32 v176, v176, v178
    v_max_f32 v184, v184, v186
    v_max3_f32 v182, v168, v169, v170
    v_max3_f32 v190, -v168, -v169, -v170
    v_permlane16_swap_b32 v176, v184
    v_max_f32 v176, v176, v184
    v_max3_f32 v180, v180, v163, v164
    v_max3_f32 v188, v188, -v163, -v164
    v_mul_f32 v184, v176, v193
    v_mul_f32 v176, v176, v193
    v_max3_f32 v182, v182, v171, v172
    v_max3_f32 v190, v190, -v171, -v172
    v_permlane16_swap_b32 v176, v184
    v_mov_b32 v178, v176
    v_max3_f32 v180, v180, v165, v166
    v_max3_f32 v188, v188, -v165, -v166
    v_mov_b32_e64 v186, v184
    v_max3_f32 v182, v182, v173, v174
    v_max3_f32 v190, v190, -v173, -v174
    v_permlane32_swap_b32 v176, v178
    v_permlane32_swap_b32 v184, v186
    v_max_f32_e64 v180, v180, v167
    v_max_f32_e64 v188, v188, -v167
    v_max_f32_e64 v182, v182, v175
    v_max_f32_e64 v190, v190, -v175
    s_nop 0
    v_permlane32_swap_b32 v180, v182
    v_permlane32_swap_b32_e64 v188, v190
    v_pk_fma_f32 v[16:17], v[144:145], v[200:201], v[184:185] op_sel_hi:[1,0,0] neg_lo:[1,0,1] neg_hi:[1,0,1]
    v_pk_fma_f32 v[144:145], v[144:145], v[200:201], v[176:177] op_sel_hi:[1,0,0] neg_lo:[0,0,1] neg_hi:[0,0,1]
    v_max_f32 v180, v180, v182
    v_max_f32 v188, v188, v190
    v_pk_fma_f32 v[18:19], v[146:147], v[200:201], v[184:185] op_sel_hi:[1,0,0] neg_lo:[1,0,1] neg_hi:[1,0,1]
    v_pk_fma_f32 v[146:147], v[146:147], v[200:201], v[176:177] op_sel_hi:[1,0,0] neg_lo:[0,0,1] neg_hi:[0,0,1]
    v_permlane16_swap_b32 v180, v188
    v_max_f32 v180, v180, v188
    v_pk_fma_f32 v[20:21], v[148:149], v[200:201], v[184:185] op_sel_hi:[1,0,0] neg_lo:[1,0,1] neg_hi:[1,0,1]
    v_pk_fma_f32 v[148:149], v[148:149], v[200:201], v[176:177] op_sel_hi:[1,0,0] neg_lo:[0,0,1] neg_hi:[0,0,1]
    v_mul_f32 v188, v180, v221
    v_mul_f32 v180, v180, v221
    v_pk_fma_f32 v[22:23], v[150:151], v[200:201], v[184:185] op_sel_hi:[1,0,0] neg_lo:[1,0,1] neg_hi:[1,0,1]
    v_pk_fma_f32 v[150:151], v[150:151], v[200:201], v[176:177] op_sel_hi:[1,0,0] neg_lo:[0,0,1] neg_hi:[0,0,1]
    v_permlane16_swap_b32 v180, v188
    v_mov_b32 v182, v180
    v_pk_fma_f32 v[40:41], v[152:153], v[202:203], v[186:187] op_sel_hi:[1,0,0] neg_lo:[1,0,1] neg_hi:[1,0,1]
    v_pk_fma_f32 v[152:153], v[152:153], v[202:203], v[178:179] op_sel_hi:[1,0,0] neg_lo:[0,0,1] neg_hi:[0,0,1]
    v_mov_b32_e64 v190, v188
    v_pk_fma_f32 v[42:43], v[154:155], v[202:203], v[186:187] op_sel_hi:[1,0,0] neg_lo:[1,0,1] neg_hi:[1,0,1]
    v_pk_fma_f32 v[154:155], v[154:155], v[202:203], v[178:179] op_sel_hi:[1,0,0] neg_lo:[0,0,1] neg_hi:[0,0,1]
    v_permlane32_swap_b32 v180, v182
    v_permlane32_swap_b32 v188, v190
    v_pk_fma_f32 v[44:45], v[156:157], v[202:203], v[186:187] op_sel_hi:[1,0,0] neg_lo:[1,0,1] neg_hi:[1,0,1]
    v_pk_fma_f32 v[156:157], v[156:157], v[202:203], v[178:179] op_sel_hi:[1,0,0] neg_lo:[0,0,1] neg_hi:[0,0,1]
    v_pk_fma_f32 v[46:47], v[158:159], v[202:203], v[186:187] op_sel_hi:[1,0,0] neg_lo:[1,0,1] neg_hi:[1,0,1]
    v_pk_fma_f32 v[158:159], v[158:159], v[202:203], v[178:179] op_sel_hi:[1,0,0] neg_lo:[0,0,1] neg_hi:[0,0,1]
    v_exp_f32 v16, v16
    v_exp_f32 v144, v144
    v_exp_f32 v17, v17
    v_exp_f32 v145, v145
    v_exp_f32 v18, v18
    v_exp_f32 v146, v146
    v_exp_f32 v19, v19
    v_exp_f32 v147, v147
    v_exp_f32 v20, v20
    v_exp_f32 v148, v148
    v_exp_f32 v21, v21
    v_exp_f32 v149, v149
    v_exp_f32 v22, v22
    v_exp_f32 v150, v150
    v_exp_f32 v23, v23
    v_exp_f32 v151, v151
    v_exp_f32 v40, v40
    v_exp_f32 v152, v152
    v_exp_f32 v41, v41
    v_exp_f32 v153, v153
    v_exp_f32 v42, v42
    v_exp_f32 v154, v154
    v_exp_f32 v43, v43
    v_exp_f32 v155, v155
    v_exp_f32 v44, v44
    v_exp_f32 v156, v156
    v_exp_f32 v45, v45
    v_exp_f32 v157, v157
    v_exp_f32 v46, v46
    v_exp_f32 v158, v158
    v_exp_f32 v47, v47
    v_exp_f32 v159, v159
    v_pk_add_f32 v[128:129], v[144:145], v[146:147]
    v_pk_add_f32 v[130:131], v[16:17], v[18:19]
    v_pk_add_f32 v[132:133], v[152:153], v[154:155]
    v_pk_add_f32 v[134:135], v[40:41], v[42:43]
    v_pk_add_f32 v[128:129], v[128:129], v[148:149]
    v_pk_add_f32 v[130:131], v[130:131], v[20:21]
    v_pk_add_f32 v[132:133], v[132:133], v[156:157]
    v_pk_add_f32 v[134:135], v[134:135], v[44:45]
    v_pk_add_f32 v[128:129], v[128:129], v[150:151]
    v_pk_add_f32 v[130:131], v[130:131], v[22:23]
    v_pk_add_f32 v[132:133], v[132:133], v[158:159]
    v_pk_add_f32 v[134:135], v[134:135], v[46:47]
    v_add_f32 v176, v128, v129
    v_add_f32 v184, v130, v131
    v_add_f32 v178, v132, v133
    v_add_f32 v186, v134, v135
    s_nop 0
    v_permlane32_swap_b32 v176, v178
    v_permlane32_swap_b32_e64 v184, v186
    v_pk_fma_f32 v[64:65], v[160:161], v[220:221], v[188:189] op_sel_hi:[1,0,0] neg_lo:[1,0,1] neg_hi:[1,0,1]
    v_pk_fma_f32 v[160:161], v[160:161], v[220:221], v[180:181] op_sel_hi:[1,0,0] neg_lo:[0,0,1] neg_hi:[0,0,1]
    v_add_f32 v176, v176, v178
    v_add_f32 v184, v184, v186
    v_pk_fma_f32 v[66:67], v[162:163], v[220:221], v[188:189] op_sel_hi:[1,0,0] neg_lo:[1,0,1] neg_hi:[1,0,1]
    v_pk_fma_f32 v[162:163], v[162:163], v[220:221], v[180:181] op_sel_hi:[1,0,0] neg_lo:[0,0,1] neg_hi:[0,0,1]
    v_permlane16_swap_b32 v176, v184
    v_add_f32 v176, v176, v184
    v_pk_fma_f32 v[68:69], v[164:165], v[220:221], v[188:189] op_sel_hi:[1,0,0] neg_lo:[1,0,1] neg_hi:[1,0,1]
    v_pk_fma_f32 v[164:165], v[164:165], v[220:221], v[180:181] op_sel_hi:[1,0,0] neg_lo:[0,0,1] neg_hi:[0,0,1]
    v_rcp_f32_e64 v176, v176
    v_pk_fma_f32 v[70:71], v[166:167], v[220:221], v[188:189] op_sel_hi:[1,0,0] neg_lo:[1,0,1] neg_hi:[1,0,1]
    v_pk_fma_f32 v[166:167], v[166:167], v[220:221], v[180:181] op_sel_hi:[1,0,0] neg_lo:[0,0,1] neg_hi:[0,0,1]
    v_mul_f32 v184, v176, v195
    v_mul_f32 v176, v176, v195
    v_pk_fma_f32 v[88:89], v[168:169], v[222:223], v[190:191] op_sel_hi:[1,0,0] neg_lo:[1,0,1] neg_hi:[1,0,1]
    v_pk_fma_f32 v[168:169], v[168:169], v[222:223], v[182:183] op_sel_hi:[1,0,0] neg_lo:[0,0,1] neg_hi:[0,0,1]
    v_permlane16_swap_b32 v176, v184
    v_mov_b32 v178, v176
    v_pk_fma_f32 v[90:91], v[170:171], v[222:223], v[190:191] op_sel_hi:[1,0,0] neg_lo:[1,0,1] neg_hi:[1,0,1]
    v_pk_fma_f32 v[170:171], v[170:171], v[222:223], v[182:183] op_sel_hi:[1,0,0] neg_lo:[0,0,1] neg_hi:[0,0,1]
    v_mov_b32_e64 v186, v184
    v_pk_fma_f32 v[92:93], v[172:173], v[222:223], v[190:191] op_sel_hi:[1,0,0] neg_lo:[1,0,1] neg_hi:[1,0,1]
    v_pk_fma_f32 v[172:173], v[172:173], v[222:223], v[182:183] op_sel_hi:[1,0,0] neg_lo:[0,0,1] neg_hi:[0,0,1]
    v_permlane32_swap_b32 v176, v178
    v_permlane32_swap_b32 v184, v186
    v_pk_fma_f32 v[94:95], v[174:175], v[222:223], v[190:191] op_sel_hi:[1,0,0] neg_lo:[1,0,1] neg_hi:[1,0,1]
    v_pk_fma_f32 v[174:175], v[174:175], v[222:223], v[182:183] op_sel_hi:[1,0,0] neg_lo:[0,0,1] neg_hi:[0,0,1]
    v_pk_mul_f32 v[144:145], v[144:145], v[176:177] op_sel_hi:[1,0]
    v_pk_mul_f32 v[146:147], v[146:147], v[176:177] op_sel_hi:[1,0]
    v_pk_mul_f32 v[148:149], v[148:149], v[176:177] op_sel_hi:[1,0]
    v_pk_mul_f32 v[150:151], v[150:151], v[176:177] op_sel_hi:[1,0]
    v_cvt_pk_bf16_f32 v144, v144, v145
    v_cvt_pk_bf16_f32 v145, v146, v147
    v_cvt_pk_bf16_f32 v146, v148, v149
    v_cvt_pk_bf16_f32 v147, v150, v151
    ds_write_b64 v4, v[144:145] offset:0
    ds_write_b64 v5, v[146:147] offset:0
    ds_write_b128 v197, v[24:27] offset:0
    v_pk_mul_f32 v[16:17], v[16:17], v[184:185] op_sel_hi:[1,0]
    v_pk_mul_f32 v[18:19], v[18:19], v[184:185] op_sel_hi:[1,0]
    v_pk_mul_f32 v[20:21], v[20:21], v[184:185] op_sel_hi:[1,0]
    v_pk_mul_f32 v[22:23], v[22:23], v[184:185] op_sel_hi:[1,0]
    v_cvt_pk_bf16_f32 v16, v16, v17
    v_cvt_pk_bf16_f32 v17, v18, v19
    v_cvt_pk_bf16_f32 v18, v20, v21
    v_cvt_pk_bf16_f32 v19, v22, v23
    ds_write_b64 v6, v[16:17] offset:0
    ds_write_b64 v7, v[18:19] offset:0
    ds_write_b128 v197, v[28:31] offset:1024
    v_pk_mul_f32 v[152:153], v[152:153], v[178:179] op_sel_hi:[1,0]
    v_pk_mul_f32 v[154:155], v[154:155], v[178:179] op_sel_hi:[1,0]
    v_pk_mul_f32 v[156:157], v[156:157], v[178:179] op_sel_hi:[1,0]
    v_pk_mul_f32 v[158:159], v[158:159], v[178:179] op_sel_hi:[1,0]
    v_cvt_pk_bf16_f32 v152, v152, v153
    v_cvt_pk_bf16_f32 v153, v154, v155
    v_cvt_pk_bf16_f32 v154, v156, v157
    v_cvt_pk_bf16_f32 v155, v158, v159
    ds_write_b64 v4, v[152:153] offset:2048
    ds_write_b64 v5, v[154:155] offset:2048
    ds_write_b128 v197, v[72:75] offset:2048
    v_pk_mul_f32 v[40:41], v[40:41], v[186:187] op_sel_hi:[1,0]
    v_pk_mul_f32 v[42:43], v[42:43], v[186:187] op_sel_hi:[1,0]
    v_pk_mul_f32 v[44:45], v[44:45], v[186:187] op_sel_hi:[1,0]
    v_pk_mul_f32 v[46:47], v[46:47], v[186:187] op_sel_hi:[1,0]
    v_cvt_pk_bf16_f32 v40, v40, v41
    v_cvt_pk_bf16_f32 v41, v42, v43
    v_cvt_pk_bf16_f32 v42, v44, v45
    v_cvt_pk_bf16_f32 v43, v46, v47
    ds_write_b64 v6, v[40:41] offset:2048
    ds_write_b64 v7, v[42:43] offset:2048
    ds_write_b128 v197, v[76:79] offset:3072
    ds_read_b64_tr_b16 v[232:233], v201 offset:0
    ds_read_b64_tr_b16 v[234:235], v201 offset:2048
    ds_read_b64_tr_b16 v[236:237], v203 offset:0
    ds_read_b64_tr_b16 v[238:239], v203 offset:2048
    v_exp_f32 v64, v64
    v_exp_f32 v160, v160
    v_exp_f32 v65, v65
    v_exp_f32 v161, v161
    v_exp_f32 v66, v66
    v_exp_f32 v162, v162
    v_exp_f32 v67, v67
    v_exp_f32 v163, v163
    v_exp_f32 v68, v68
    v_exp_f32 v164, v164
    v_exp_f32 v69, v69
    v_exp_f32 v165, v165
    v_exp_f32 v70, v70
    v_exp_f32 v166, v166
    v_exp_f32 v71, v71
    v_exp_f32 v167, v167
    v_exp_f32 v88, v88
    v_exp_f32 v168, v168
    v_exp_f32 v89, v89
    v_exp_f32 v169, v169
    v_exp_f32 v90, v90
    v_exp_f32 v170, v170
    v_exp_f32 v91, v91
    v_exp_f32 v171, v171
    v_exp_f32 v92, v92
    v_exp_f32 v172, v172
    v_exp_f32 v93, v93
    v_exp_f32 v173, v173
    v_exp_f32 v94, v94
    v_exp_f32 v174, v174
    v_exp_f32 v95, v95
    v_exp_f32 v175, v175
    s_mov_b64 exec, 1
    buffer_store_dword v251, v199, s[48:51], s76 offen sc1
    s_mov_b64 exec, -1
    v_pk_add_f32 v[136:137], v[160:161], v[162:163]
    v_pk_add_f32 v[138:139], v[64:65], v[66:67]
    v_pk_add_f32 v[140:141], v[168:169], v[170:171]
    v_pk_add_f32 v[142:143], v[88:89], v[90:91]
    v_pk_add_f32 v[136:137], v[136:137], v[164:165]
    v_pk_add_f32 v[138:139], v[138:139], v[68:69]
    v_pk_add_f32 v[140:141], v[140:141], v[172:173]
    v_pk_add_f32 v[142:143], v[142:143], v[92:93]
    v_pk_add_f32 v[136:137], v[136:137], v[166:167]
    v_pk_add_f32 v[138:139], v[138:139], v[70:71]
    v_pk_add_f32 v[140:141], v[140:141], v[174:175]
    v_pk_add_f32 v[142:143], v[142:143], v[94:95]
    v_add_f32 v180, v136, v137
    v_add_f32 v188, v138, v139
    v_add_f32 v182, v140, v141
    v_add_f32 v190, v142, v143
    s_nop 0
    v_permlane32_swap_b32 v180, v182
    v_permlane32_swap_b32 v188, v190
    s_waitcnt lgkmcnt(0)
    s_nop 0
    v_mfma_f32_16x16x32_bf16 v[144:147], v[232:235], v[24:27], 0
    v_add_f32 v180, v180, v182
    v_add_f32 v188, v188, v190
    v_mfma_f32_16x16x32_bf16 v[148:151], v[236:239], v[24:27], 0
    s_nop 0
    v_permlane16_swap_b32 v180, v188
    v_add_f32 v180, v180, v188
    v_mfma_f32_16x16x32_bf16 v[152:155], v[232:235], v[28:31], 0
    v_rcp_f32_e64 v180, v180
    v_mfma_f32_16x16x32_bf16 v[156:159], v[236:239], v[28:31], 0
    v_mul_f32 v188, v180, v223
    v_mul_f32 v180, v180, v223
    v_mfma_f32_16x16x32_bf16 v[16:19], v[232:235], v[120:123], 0
    s_nop 0
    v_permlane16_swap_b32 v180, v188
    v_mov_b32_e64 v182, v180
    v_mfma_f32_16x16x32_bf16 v[20:23], v[236:239], v[120:123], 0
    v_mov_b32_e64 v190, v188
    v_permlane32_swap_b32 v180, v182
    s_nop 0
    v_permlane32_swap_b32_e64 v188, v190
    v_pk_mul_f32 v[160:161], v[160:161], v[180:181] op_sel_hi:[1,0]
    v_pk_mul_f32 v[162:163], v[162:163], v[180:181] op_sel_hi:[1,0]
    v_pk_mul_f32 v[164:165], v[164:165], v[180:181] op_sel_hi:[1,0]
    v_pk_mul_f32 v[166:167], v[166:167], v[180:181] op_sel_hi:[1,0]
    v_cvt_pk_bf16_f32 v160, v160, v161
    v_cvt_pk_bf16_f32 v161, v162, v163
    v_cvt_pk_bf16_f32 v162, v164, v165
    v_cvt_pk_bf16_f32 v163, v166, v167
    ds_write_b64 v4, v[160:161] offset:4096
    ds_write_b64 v5, v[162:163] offset:4096
    v_pk_mul_f32 v[64:65], v[64:65], v[188:189] op_sel_hi:[1,0]
    v_pk_mul_f32 v[66:67], v[66:67], v[188:189] op_sel_hi:[1,0]
    v_pk_mul_f32 v[68:69], v[68:69], v[188:189] op_sel_hi:[1,0]
    v_pk_mul_f32 v[70:71], v[70:71], v[188:189] op_sel_hi:[1,0]
    v_cvt_pk_bf16_f32 v64, v64, v65
    v_cvt_pk_bf16_f32 v65, v66, v67
    v_cvt_pk_bf16_f32 v66, v68, v69
    v_cvt_pk_bf16_f32 v67, v70, v71
    ds_write_b64 v6, v[64:65] offset:4096
    ds_write_b64 v7, v[66:67] offset:4096
    v_pk_mul_f32 v[168:169], v[168:169], v[182:183] op_sel_hi:[1,0]
    v_pk_mul_f32 v[170:171], v[170:171], v[182:183] op_sel_hi:[1,0]
    v_pk_mul_f32 v[172:173], v[172:173], v[182:183] op_sel_hi:[1,0]
    v_pk_mul_f32 v[174:175], v[174:175], v[182:183] op_sel_hi:[1,0]
    v_cvt_pk_bf16_f32 v168, v168, v169
    v_cvt_pk_bf16_f32 v169, v170, v171
    v_cvt_pk_bf16_f32 v170, v172, v173
    v_cvt_pk_bf16_f32 v171, v174, v175
    ds_write_b64 v4, v[168:169] offset:6144
    ds_write_b64 v5, v[170:171] offset:6144
    v_pk_mul_f32 v[88:89], v[88:89], v[190:191] op_sel_hi:[1,0]
    v_pk_mul_f32 v[90:91], v[90:91], v[190:191] op_sel_hi:[1,0]
    v_pk_mul_f32 v[92:93], v[92:93], v[190:191] op_sel_hi:[1,0]
    v_pk_mul_f32 v[94:95], v[94:95], v[190:191] op_sel_hi:[1,0]
    v_cvt_pk_bf16_f32 v88, v88, v89
    v_cvt_pk_bf16_f32 v89, v90, v91
    v_cvt_pk_bf16_f32 v90, v92, v93
    v_cvt_pk_bf16_f32 v91, v94, v95
    ds_write_b64 v6, v[88:89] offset:6144
    ds_write_b64 v7, v[90:91] offset:6144
    ds_read_b64_tr_b16 v[240:241], v201 offset:4096
    ds_read_b64_tr_b16 v[242:243], v201 offset:6144
    ds_read_b64_tr_b16 v[244:245], v203 offset:4096
    ds_read_b64_tr_b16 v[246:247], v203 offset:6144
    v_xor_b32 v201, 0x2000, v201
    v_xor_b32 v203, 0x2000, v203
    v_xor_b32 v197, 0x1000, v197
    s_waitcnt lgkmcnt(4)
    s_barrier
    ds_read_b64_tr_b16 v[128:129], v201 offset:0
    ds_read_b64_tr_b16 v[130:131], v201 offset:2048
    ds_read_b64_tr_b16 v[132:133], v203 offset:0
    ds_read_b64_tr_b16 v[134:135], v203 offset:2048
    ds_read_b128 v[48:51], v197 offset:0
    ds_read_b128 v[52:55], v197 offset:1024
    ds_read_b64_tr_b16 v[136:137], v201 offset:4096
    ds_read_b64_tr_b16 v[138:139], v201 offset:6144
    ds_read_b64_tr_b16 v[140:141], v203 offset:4096
    ds_read_b64_tr_b16 v[142:143], v203 offset:6144
    ds_read_b128 v[96:99], v197 offset:2048
    ds_read_b128 v[100:103], v197 offset:3072
    s_waitcnt lgkmcnt(12)
    s_nop 0
    v_mfma_f32_16x16x32_bf16 v[144:147], v[240:243], v[72:75], v[144:147]
    v_mfma_f32_16x16x32_bf16 v[148:151], v[244:247], v[72:75], v[148:151]
    v_mfma_f32_16x16x32_bf16 v[152:155], v[240:243], v[76:79], v[152:155]
    v_mfma_f32_16x16x32_bf16 v[156:159], v[244:247], v[76:79], v[156:159]
    v_mfma_f32_16x16x32_bf16 v[16:19], v[240:243], v[124:127], v[16:19]
    v_mfma_f32_16x16x32_bf16 v[20:23], v[244:247], v[124:127], v[20:23]
    s_waitcnt lgkmcnt(6)
    s_nop 0
    v_mfma_f32_16x16x32_bf16 v[144:147], v[128:131], v[48:51], v[144:147]
    v_mfma_f32_16x16x32_bf16 v[148:151], v[132:135], v[48:51], v[148:151]
    v_mfma_f32_16x16x32_bf16 v[152:155], v[128:131], v[52:55], v[152:155]
    v_mfma_f32_16x16x32_bf16 v[156:159], v[132:135], v[52:55], v[156:159]
    v_mfma_f32_16x16x32_bf16 v[16:19], v[128:131], v[104:107], v[16:19]
    v_mfma_f32_16x16x32_bf16 v[20:23], v[132:135], v[104:107], v[20:23]
    s_waitcnt lgkmcnt(0)
    s_nop 0
    v_mfma_f32_16x16x32_bf16 v[144:147], v[136:139], v[96:99], v[144:147]
    v_mfma_f32_16x16x32_bf16 v[148:151], v[140:143], v[96:99], v[148:151]
    v_mfma_f32_16x16x32_bf16 v[152:155], v[136:139], v[100:103], v[152:155]
    v_mfma_f32_16x16x32_bf16 v[156:159], v[140:143], v[100:103], v[156:159]
    v_mfma_f32_16x16x32_bf16 v[16:19], v[136:139], v[108:111], v[16:19]
    v_mfma_f32_16x16x32_bf16 v[20:23], v[140:143], v[108:111], v[20:23]
    ds_read_b64_tr_b16 v[224:225], v252 offset:8192
    ds_read_b64_tr_b16 v[226:227], v252 offset:9216
    ds_read_b64_tr_b16 v[228:229], v252 offset:8224
    ds_read_b64_tr_b16 v[230:231], v252 offset:9248
    s_xor_b32 s67, s67, 8
    s_lshl_b32 s3, s38, 2
    s_add_u32 s3, s3, 162112
    v_mov_b32 v4, s3
    v_mov_b32 v5, 1
    v_cvt_pk_bf16_f32 v144, v144, v145
    v_cvt_pk_bf16_f32 v145, v146, v147
    v_cvt_pk_bf16_f32 v146, v148, v149
    v_cvt_pk_bf16_f32 v147, v150, v151
    buffer_store_dwordx4 v[144:147], v199, s[48:51], s74 offen offset:0 sc1
    v_cvt_pk_bf16_f32 v152, v152, v153
    v_cvt_pk_bf16_f32 v153, v154, v155
    v_cvt_pk_bf16_f32 v154, v156, v157
    v_cvt_pk_bf16_f32 v155, v158, v159
    buffer_store_dwordx4 v[152:155], v199, s[48:51], s74 offen offset:1024 sc1
    v_cvt_pk_bf16_f32 v16, v16, v17
    v_cvt_pk_bf16_f32 v17, v18, v19
    v_cvt_pk_bf16_f32 v18, v20, v21
    v_cvt_pk_bf16_f32 v19, v22, v23
    s_mov_b32 exec_lo, 0x00010001
    s_mov_b32 exec_hi, 0x00010001
    buffer_store_dwordx4 v[16:19], v1, s[48:51], s75 offen sc1
    s_mov_b64 exec, -1
    ds_write_b32 v4, v5
    s_setprio 0
    v_pk_fma_f32 v[8:9], v[192:193], v[212:213], v[8:9] op_sel_hi:[0,1,1] neg_lo:[1,0,0] neg_hi:[1,0,0]
    v_pk_fma_f32 v[10:11], v[192:193], v[214:215], v[10:11] op_sel_hi:[0,1,1] neg_lo:[1,0,0] neg_hi:[1,0,0]
    v_pk_fma_f32 v[12:13], v[192:193], v[216:217], v[12:13] op_sel_hi:[0,1,1] neg_lo:[1,0,0] neg_hi:[1,0,0]
    v_pk_fma_f32 v[14:15], v[192:193], v[218:219], v[14:15] op_sel_hi:[0,1,1] neg_lo:[1,0,0] neg_hi:[1,0,0]
    v_cvt_pk_bf16_f32 v232, v8, v9
    v_cvt_pk_bf16_f32 v233, v10, v11
    v_cvt_pk_bf16_f32 v234, v12, v13
    v_cvt_pk_bf16_f32 v235, v14, v15
    v_pk_fma_f32 v[32:33], v[194:195], v[212:213], v[32:33] op_sel_hi:[0,1,1] neg_lo:[1,0,0] neg_hi:[1,0,0]
    v_pk_fma_f32 v[34:35], v[194:195], v[214:215], v[34:35] op_sel_hi:[0,1,1] neg_lo:[1,0,0] neg_hi:[1,0,0]
    v_pk_fma_f32 v[36:37], v[194:195], v[216:217], v[36:37] op_sel_hi:[0,1,1] neg_lo:[1,0,0] neg_hi:[1,0,0]
    v_pk_fma_f32 v[38:39], v[194:195], v[218:219], v[38:39] op_sel_hi:[0,1,1] neg_lo:[1,0,0] neg_hi:[1,0,0]
    v_cvt_pk_bf16_f32 v236, v32, v33
    v_cvt_pk_bf16_f32 v237, v34, v35
    v_cvt_pk_bf16_f32 v238, v36, v37
    v_cvt_pk_bf16_f32 v239, v38, v39
    v_pk_fma_f32 v[56:57], v[196:197], v[212:213], v[56:57] op_sel_hi:[0,1,1] neg_lo:[1,0,0] neg_hi:[1,0,0]
    v_pk_fma_f32 v[58:59], v[196:197], v[214:215], v[58:59] op_sel_hi:[0,1,1] neg_lo:[1,0,0] neg_hi:[1,0,0]
    v_pk_fma_f32 v[60:61], v[196:197], v[216:217], v[60:61] op_sel_hi:[0,1,1] neg_lo:[1,0,0] neg_hi:[1,0,0]
    v_pk_fma_f32 v[62:63], v[196:197], v[218:219], v[62:63] op_sel_hi:[0,1,1] neg_lo:[1,0,0] neg_hi:[1,0,0]
    v_cvt_pk_bf16_f32 v240, v56, v57
    v_cvt_pk_bf16_f32 v241, v58, v59
    v_cvt_pk_bf16_f32 v242, v60, v61
    v_cvt_pk_bf16_f32 v243, v62, v63
    v_pk_fma_f32 v[80:81], v[198:199], v[212:213], v[80:81] op_sel_hi:[0,1,1] neg_lo:[1,0,0] neg_hi:[1,0,0]
    v_pk_fma_f32 v[82:83], v[198:199], v[214:215], v[82:83] op_sel_hi:[0,1,1] neg_lo:[1,0,0] neg_hi:[1,0,0]
    v_pk_fma_f32 v[84:85], v[198:199], v[216:217], v[84:85] op_sel_hi:[0,1,1] neg_lo:[1,0,0] neg_hi:[1,0,0]
    v_pk_fma_f32 v[86:87], v[198:199], v[218:219], v[86:87] op_sel_hi:[0,1,1] neg_lo:[1,0,0] neg_hi:[1,0,0]
    v_cvt_pk_bf16_f32 v244, v80, v81
    v_cvt_pk_bf16_f32 v245, v82, v83
    v_cvt_pk_bf16_f32 v246, v84, v85
    v_cvt_pk_bf16_f32 v247, v86, v87
    s_waitcnt lgkmcnt(1)
    s_nop 0
    v_mfma_f32_16x16x32_bf16 v[144:147], v[224:227], v[232:235], 0
    v_mfma_f32_16x16x32_bf16 v[148:151], v[228:231], v[232:235], 0
    v_mfma_f32_16x16x32_bf16 v[152:155], v[224:227], v[236:239], 0
    v_mfma_f32_16x16x32_bf16 v[156:159], v[228:231], v[236:239], 0
    v_mfma_f32_16x16x32_bf16 v[160:163], v[224:227], v[240:243], 0
    v_mfma_f32_16x16x32_bf16 v[164:167], v[228:231], v[240:243], 0
    v_mfma_f32_16x16x32_bf16 v[168:171], v[224:227], v[244:247], 0
    v_mfma_f32_16x16x32_bf16 v[172:175], v[228:231], v[244:247], 0
    s_nop 0
    s_nop 0
    v_max3_f32 v176, v144, v145, v146
    v_max3_f32 v184, -v144, -v145, -v146
    v_max3_f32 v178, v152, v153, v154
    v_max3_f32 v186, -v152, -v153, -v154
    v_max3_f32 v176, v176, v147, v148
    v_max3_f32 v184, v184, -v147, -v148
    v_max3_f32 v178, v178, v155, v156
    v_max3_f32 v186, v186, -v155, -v156
    v_max3_f32 v176, v176, v149, v150
    v_max3_f32 v184, v184, -v149, -v150
    v_max3_f32 v178, v178, v157, v158
    v_max3_f32 v186, v186, -v157, -v158
    v_max_f32_e64 v176, v176, v151
    v_max_f32_e64 v184, v184, -v151
    v_max_f32_e64 v178, v178, v159
    v_max_f32_e64 v186, v186, -v159
    s_nop 0
    v_permlane32_swap_b32 v176, v178
    v_permlane32_swap_b32_e64 v184, v186
    v_max3_f32 v180, v160, v161, v162
    v_max3_f32 v188, -v160, -v161, -v162
    v_max_f32 v176, v176, v178
    v_max_f32 v184, v184, v186
    v_max3_f32 v182, v168, v169, v170
    v_max3_f32 v190, -v168, -v169, -v170
    v_permlane16_swap_b32 v176, v184
    v_max_f32 v176, v176, v184
    v_max3_f32 v180, v180, v163, v164
    v_max3_f32 v188, v188, -v163, -v164
    v_mul_f32 v184, v176, v193
    v_mul_f32 v176, v176, v193
    v_max3_f32 v182, v182, v171, v172
    v_max3_f32 v190, v190, -v171, -v172
    v_permlane16_swap_b32 v176, v184
    v_mov_b32 v178, v176
    v_max3_f32 v180, v180, v165, v166
    v_max3_f32 v188, v188, -v165, -v166
    v_mov_b32_e64 v186, v184
    v_max3_f32 v182, v182, v173, v174
    v_max3_f32 v190, v190, -v173, -v174
    v_permlane32_swap_b32 v176, v178
    v_permlane32_swap_b32 v184, v186
    v_max_f32_e64 v180, v180, v167
    v_max_f32_e64 v188, v188, -v167
    v_max_f32_e64 v182, v182, v175
    v_max_f32_e64 v190, v190, -v175
    s_nop 0
    v_permlane32_swap_b32 v180, v182
    v_permlane32_swap_b32_e64 v188, v190
    v_pk_fma_f32 v[8:9], v[144:145], v[200:201], v[184:185] op_sel_hi:[1,0,0] neg_lo:[1,0,1] neg_hi:[1,0,1]
    v_pk_fma_f32 v[144:145], v[144:145], v[200:201], v[176:177] op_sel_hi:[1,0,0] neg_lo:[0,0,1] neg_hi:[0,0,1]
    v_max_f32 v180, v180, v182
    v_max_f32 v188, v188, v190
    v_pk_fma_f32 v[10:11], v[146:147], v[200:201], v[184:185] op_sel_hi:[1,0,0] neg_lo:[1,0,1] neg_hi:[1,0,1]
    v_pk_fma_f32 v[146:147], v[146:147], v[200:201], v[176:177] op_sel_hi:[1,0,0] neg_lo:[0,0,1] neg_hi:[0,0,1]
    v_permlane16_swap_b32 v180, v188
    v_max_f32 v180, v180, v188
    v_pk_fma_f32 v[12:13], v[148:149], v[200:201], v[184:185] op_sel_hi:[1,0,0] neg_lo:[1,0,1] neg_hi:[1,0,1]
    v_pk_fma_f32 v[148:149], v[148:149], v[200:201], v[176:177] op_sel_hi:[1,0,0] neg_lo:[0,0,1] neg_hi:[0,0,1]
    v_mul_f32 v188, v180, v221
    v_mul_f32 v180, v180, v221
    v_pk_fma_f32 v[14:15], v[150:151], v[200:201], v[184:185] op_sel_hi:[1,0,0] neg_lo:[1,0,1] neg_hi:[1,0,1]
    v_pk_fma_f32 v[150:151], v[150:151], v[200:201], v[176:177] op_sel_hi:[1,0,0] neg_lo:[0,0,1] neg_hi:[0,0,1]
    v_permlane16_swap_b32 v180, v188
    v_mov_b32 v182, v180
    v_pk_fma_f32 v[32:33], v[152:153], v[202:203], v[186:187] op_sel_hi:[1,0,0] neg_lo:[1,0,1] neg_hi:[1,0,1]
    v_pk_fma_f32 v[152:153], v[152:153], v[202:203], v[178:179] op_sel_hi:[1,0,0] neg_lo:[0,0,1] neg_hi:[0,0,1]
    v_mov_b32_e64 v190, v188
    v_pk_fma_f32 v[34:35], v[154:155], v[202:203], v[186:187] op_sel_hi:[1,0,0] neg_lo:[1,0,1] neg_hi:[1,0,1]
    v_pk_fma_f32 v[154:155], v[154:155], v[202:203], v[178:179] op_sel_hi:[1,0,0] neg_lo:[0,0,1] neg_hi:[0,0,1]
    v_permlane32_swap_b32 v180, v182
    v_permlane32_swap_b32 v188, v190
    v_pk_fma_f32 v[36:37], v[156:157], v[202:203], v[186:187] op_sel_hi:[1,0,0] neg_lo:[1,0,1] neg_hi:[1,0,1]
    v_pk_fma_f32 v[156:157], v[156:157], v[202:203], v[178:179] op_sel_hi:[1,0,0] neg_lo:[0,0,1] neg_hi:[0,0,1]
    v_pk_fma_f32 v[38:39], v[158:159], v[202:203], v[186:187] op_sel_hi:[1,0,0] neg_lo:[1,0,1] neg_hi:[1,0,1]
    v_pk_fma_f32 v[158:159], v[158:159], v[202:203], v[178:179] op_sel_hi:[1,0,0] neg_lo:[0,0,1] neg_hi:[0,0,1]
    v_exp_f32 v8, v8
    v_exp_f32 v144, v144
    v_exp_f32 v9, v9
    v_exp_f32 v145, v145
    v_exp_f32 v10, v10
    v_exp_f32 v146, v146
    v_exp_f32 v11, v11
    v_exp_f32 v147, v147
    v_exp_f32 v12, v12
    v_exp_f32 v148, v148
    v_exp_f32 v13, v13
    v_exp_f32 v149, v149
    v_exp_f32 v14, v14
    v_exp_f32 v150, v150
    v_exp_f32 v15, v15
    v_exp_f32 v151, v151
    v_exp_f32 v32, v32
    v_exp_f32 v152, v152
    v_exp_f32 v33, v33
    v_exp_f32 v153, v153
    v_exp_f32 v34, v34
    v_exp_f32 v154, v154
    v_exp_f32 v35, v35
    v_exp_f32 v155, v155
    v_exp_f32 v36, v36
    v_exp_f32 v156, v156
    v_exp_f32 v37, v37
    v_exp_f32 v157, v157
    v_exp_f32 v38, v38
    v_exp_f32 v158, v158
    v_exp_f32 v39, v39
    v_exp_f32 v159, v159
    v_pk_add_f32 v[128:129], v[144:145], v[146:147]
    v_pk_add_f32 v[130:131], v[8:9], v[10:11]
    v_pk_add_f32 v[132:133], v[152:153], v[154:155]
    v_pk_add_f32 v[134:135], v[32:33], v[34:35]
    v_pk_add_f32 v[128:129], v[128:129], v[148:149]
    v_pk_add_f32 v[130:131], v[130:131], v[12:13]
    v_pk_add_f32 v[132:133], v[132:133], v[156:157]
    v_pk_add_f32 v[134:135], v[134:135], v[36:37]
    v_pk_add_f32 v[128:129], v[128:129], v[150:151]
    v_pk_add_f32 v[130:131], v[130:131], v[14:15]
    v_pk_add_f32 v[132:133], v[132:133], v[158:159]
    v_pk_add_f32 v[134:135], v[134:135], v[38:39]
    v_add_f32 v176, v128, v129
    v_add_f32 v184, v130, v131
    v_add_f32 v178, v132, v133
    v_add_f32 v186, v134, v135
    s_nop 0
    v_permlane32_swap_b32 v176, v178
    v_permlane32_swap_b32_e64 v184, v186
    v_pk_fma_f32 v[56:57], v[160:161], v[220:221], v[188:189] op_sel_hi:[1,0,0] neg_lo:[1,0,1] neg_hi:[1,0,1]
    v_pk_fma_f32 v[160:161], v[160:161], v[220:221], v[180:181] op_sel_hi:[1,0,0] neg_lo:[0,0,1] neg_hi:[0,0,1]
    v_add_f32 v176, v176, v178
    v_add_f32 v184, v184, v186
    v_pk_fma_f32 v[58:59], v[162:163], v[220:221], v[188:189] op_sel_hi:[1,0,0] neg_lo:[1,0,1] neg_hi:[1,0,1]
    v_pk_fma_f32 v[162:163], v[162:163], v[220:221], v[180:181] op_sel_hi:[1,0,0] neg_lo:[0,0,1] neg_hi:[0,0,1]
    v_permlane16_swap_b32 v176, v184
    v_add_f32 v176, v176, v184
    v_pk_fma_f32 v[60:61], v[164:165], v[220:221], v[188:189] op_sel_hi:[1,0,0] neg_lo:[1,0,1] neg_hi:[1,0,1]
    v_pk_fma_f32 v[164:165], v[164:165], v[220:221], v[180:181] op_sel_hi:[1,0,0] neg_lo:[0,0,1] neg_hi:[0,0,1]
    v_rcp_f32_e64 v176, v176
    v_pk_fma_f32 v[62:63], v[166:167], v[220:221], v[188:189] op_sel_hi:[1,0,0] neg_lo:[1,0,1] neg_hi:[1,0,1]
    v_pk_fma_f32 v[166:167], v[166:167], v[220:221], v[180:181] op_sel_hi:[1,0,0] neg_lo:[0,0,1] neg_hi:[0,0,1]
    v_mov_b32_e64 v184, v176
    v_pk_fma_f32 v[80:81], v[168:169], v[222:223], v[190:191] op_sel_hi:[1,0,0] neg_lo:[1,0,1] neg_hi:[1,0,1]
    v_pk_fma_f32 v[168:169], v[168:169], v[222:223], v[182:183] op_sel_hi:[1,0,0] neg_lo:[0,0,1] neg_hi:[0,0,1]
    v_permlane16_swap_b32 v176, v184
    v_mov_b32 v178, v176
    v_pk_fma_f32 v[82:83], v[170:171], v[222:223], v[190:191] op_sel_hi:[1,0,0] neg_lo:[1,0,1] neg_hi:[1,0,1]
    v_pk_fma_f32 v[170:171], v[170:171], v[222:223], v[182:183] op_sel_hi:[1,0,0] neg_lo:[0,0,1] neg_hi:[0,0,1]
    v_mov_b32_e64 v186, v184
    v_pk_fma_f32 v[84:85], v[172:173], v[222:223], v[190:191] op_sel_hi:[1,0,0] neg_lo:[1,0,1] neg_hi:[1,0,1]
    v_pk_fma_f32 v[172:173], v[172:173], v[222:223], v[182:183] op_sel_hi:[1,0,0] neg_lo:[0,0,1] neg_hi:[0,0,1]
    v_permlane32_swap_b32 v176, v178
    v_permlane32_swap_b32 v184, v186
    v_pk_fma_f32 v[86:87], v[174:175], v[222:223], v[190:191] op_sel_hi:[1,0,0] neg_lo:[1,0,1] neg_hi:[1,0,1]
    v_pk_fma_f32 v[174:175], v[174:175], v[222:223], v[182:183] op_sel_hi:[1,0,0] neg_lo:[0,0,1] neg_hi:[0,0,1]
    v_pk_mul_f32 v[144:145], v[144:145], v[176:177] op_sel_hi:[1,0]
    v_pk_mul_f32 v[146:147], v[146:147], v[176:177] op_sel_hi:[1,0]
    v_pk_mul_f32 v[148:149], v[148:149], v[176:177] op_sel_hi:[1,0]
    v_pk_mul_f32 v[150:151], v[150:151], v[176:177] op_sel_hi:[1,0]
    v_cvt_pk_bf16_f32 v144, v144, v145
    v_cvt_pk_bf16_f32 v145, v146, v147
    v_cvt_pk_bf16_f32 v146, v148, v149
    v_cvt_pk_bf16_f32 v147, v150, v151
    v_pk_mul_f32 v[8:9], v[8:9], v[184:185] op_sel_hi:[1,0]
    v_pk_mul_f32 v[10:11], v[10:11], v[184:185] op_sel_hi:[1,0]
    v_pk_mul_f32 v[12:13], v[12:13], v[184:185] op_sel_hi:[1,0]
    v_pk_mul_f32 v[14:15], v[14:15], v[184:185] op_sel_hi:[1,0]
    v_cvt_pk_bf16_f32 v8, v8, v9
    v_cvt_pk_bf16_f32 v9, v10, v11
    v_cvt_pk_bf16_f32 v10, v12, v13
    v_cvt_pk_bf16_f32 v11, v14, v15
    v_pk_mul_f32 v[152:153], v[152:153], v[178:179] op_sel_hi:[1,0]
    v_pk_mul_f32 v[154:155], v[154:155], v[178:179] op_sel_hi:[1,0]
    v_pk_mul_f32 v[156:157], v[156:157], v[178:179] op_sel_hi:[1,0]
    v_pk_mul_f32 v[158:159], v[158:159], v[178:179] op_sel_hi:[1,0]
    v_cvt_pk_bf16_f32 v152, v152, v153
    v_cvt_pk_bf16_f32 v153, v154, v155
    v_cvt_pk_bf16_f32 v154, v156, v157
    v_cvt_pk_bf16_f32 v155, v158, v159
    v_pk_mul_f32 v[32:33], v[32:33], v[186:187] op_sel_hi:[1,0]
    v_pk_mul_f32 v[34:35], v[34:35], v[186:187] op_sel_hi:[1,0]
    v_pk_mul_f32 v[36:37], v[36:37], v[186:187] op_sel_hi:[1,0]
    v_pk_mul_f32 v[38:39], v[38:39], v[186:187] op_sel_hi:[1,0]
    v_cvt_pk_bf16_f32 v32, v32, v33
    v_cvt_pk_bf16_f32 v33, v34, v35
    v_cvt_pk_bf16_f32 v34, v36, v37
    v_cvt_pk_bf16_f32 v35, v38, v39
    v_exp_f32 v56, v56
    v_exp_f32 v160, v160
    v_exp_f32 v57, v57
    v_exp_f32 v161, v161
    v_exp_f32 v58, v58
    v_exp_f32 v162, v162
    v_exp_f32 v59, v59
    v_exp_f32 v163, v163
    v_exp_f32 v60, v60
    v_exp_f32 v164, v164
    v_exp_f32 v61, v61
    v_exp_f32 v165, v165
    v_exp_f32 v62, v62
    v_exp_f32 v166, v166
    v_exp_f32 v63, v63
    v_exp_f32 v167, v167
    v_exp_f32 v80, v80
    v_exp_f32 v168, v168
    v_exp_f32 v81, v81
    v_exp_f32 v169, v169
    v_exp_f32 v82, v82
    v_exp_f32 v170, v170
    v_exp_f32 v83, v83
    v_exp_f32 v171, v171
    v_exp_f32 v84, v84
    v_exp_f32 v172, v172
    v_exp_f32 v85, v85
    v_exp_f32 v173, v173
    v_exp_f32 v86, v86
    v_exp_f32 v174, v174
    v_exp_f32 v87, v87
    v_exp_f32 v175, v175
    v_pk_add_f32 v[136:137], v[160:161], v[162:163]
    v_pk_add_f32 v[138:139], v[56:57], v[58:59]
    v_pk_add_f32 v[140:141], v[168:169], v[170:171]
    v_pk_add_f32 v[142:143], v[80:81], v[82:83]
    v_pk_add_f32 v[136:137], v[136:137], v[164:165]
    v_pk_add_f32 v[138:139], v[138:139], v[60:61]
    v_pk_add_f32 v[140:141], v[140:141], v[172:173]
    v_pk_add_f32 v[142:143], v[142:143], v[84:85]
    v_pk_add_f32 v[136:137], v[136:137], v[166:167]
    v_pk_add_f32 v[138:139], v[138:139], v[62:63]
    v_pk_add_f32 v[140:141], v[140:141], v[174:175]
    v_pk_add_f32 v[142:143], v[142:143], v[86:87]
    v_add_f32 v180, v136, v137
    v_add_f32 v188, v138, v139
    v_add_f32 v182, v140, v141
    v_add_f32 v190, v142, v143
    s_nop 0
    v_permlane32_swap_b32 v180, v182
    v_permlane32_swap_b32 v188, v190
    v_add_f32 v180, v180, v182
    v_add_f32 v188, v188, v190
    s_nop 1
    v_permlane16_swap_b32 v180, v188
    v_add_f32 v180, v180, v188
    v_rcp_f32_e64 v180, v180
    s_nop 0
    v_mov_b32_e64 v188, v180
    s_nop 1
    v_permlane16_swap_b32 v180, v188
    v_mov_b32 v182, v180
    v_mov_b32_e64 v190, v188
    s_nop 0
    v_permlane32_swap_b32 v180, v182
    v_permlane32_swap_b32_e64 v188, v190
    v_pk_mul_f32 v[160:161], v[160:161], v[180:181] op_sel_hi:[1,0]
    v_pk_mul_f32 v[162:163], v[162:163], v[180:181] op_sel_hi:[1,0]
    v_pk_mul_f32 v[164:165], v[164:165], v[180:181] op_sel_hi:[1,0]
    v_pk_mul_f32 v[166:167], v[166:167], v[180:181] op_sel_hi:[1,0]
    v_cvt_pk_bf16_f32 v160, v160, v161
    v_cvt_pk_bf16_f32 v161, v162, v163
    v_cvt_pk_bf16_f32 v162, v164, v165
    v_cvt_pk_bf16_f32 v163, v166, v167
    v_pk_mul_f32 v[56:57], v[56:57], v[188:189] op_sel_hi:[1,0]
    v_pk_mul_f32 v[58:59], v[58:59], v[188:189] op_sel_hi:[1,0]
    v_pk_mul_f32 v[60:61], v[60:61], v[188:189] op_sel_hi:[1,0]
    v_pk_mul_f32 v[62:63], v[62:63], v[188:189] op_sel_hi:[1,0]
    v_cvt_pk_bf16_f32 v56, v56, v57
    v_cvt_pk_bf16_f32 v57, v58, v59
    v_cvt_pk_bf16_f32 v58, v60, v61
    v_cvt_pk_bf16_f32 v59, v62, v63
    v_pk_mul_f32 v[168:169], v[168:169], v[182:183] op_sel_hi:[1,0]
    v_pk_mul_f32 v[170:171], v[170:171], v[182:183] op_sel_hi:[1,0]
    v_pk_mul_f32 v[172:173], v[172:173], v[182:183] op_sel_hi:[1,0]
    v_pk_mul_f32 v[174:175], v[174:175], v[182:183] op_sel_hi:[1,0]
    v_cvt_pk_bf16_f32 v168, v168, v169
    v_cvt_pk_bf16_f32 v169, v170, v171
    v_cvt_pk_bf16_f32 v170, v172, v173
    v_cvt_pk_bf16_f32 v171, v174, v175
    v_pk_mul_f32 v[80:81], v[80:81], v[190:191] op_sel_hi:[1,0]
    v_pk_mul_f32 v[82:83], v[82:83], v[190:191] op_sel_hi:[1,0]
    v_pk_mul_f32 v[84:85], v[84:85], v[190:191] op_sel_hi:[1,0]
    v_pk_mul_f32 v[86:87], v[86:87], v[190:191] op_sel_hi:[1,0]
    v_cvt_pk_bf16_f32 v80, v80, v81
    v_cvt_pk_bf16_f32 v81, v82, v83
    v_cvt_pk_bf16_f32 v82, v84, v85
    v_cvt_pk_bf16_f32 v83, v86, v87
    v_mov_b32 v240, v177
    v_mov_b32 v241, v179
    v_mov_b32 v242, v181
    v_mov_b32 v243, v183
    v_mov_b32 v244, v185
    v_mov_b32 v245, v187
    v_mov_b32 v246, v189
    v_mov_b32 v247, v191
    v_mov_b32 v2, 162048
    ds_read_b32 v248, v2
    v_lshrrev_b32 v5, 3, v1
    v_lshlrev_b32 v6, 11, v5
    v_bfe_u32 v5, v1, 4, 2
    v_lshlrev_b32 v5, 1, v5
    v_and_b32 v7, 7, v1
    v_xor_b32 v5, v5, v7
    v_lshl_add_u32 v6, v5, 4, v6
    s_lshl_b32 s3, s35, 7
    v_add_u32 v6, s3, v6
    v_add_u32 v216, 0, v6
    v_add_u32 v217, 15360, v6
    v_add_u32 v218, 30720, v6
    v_add_u32 v219, 46080, v6
    s_lshl_b32 s72, s38, 12
    s_lshl_b32 s73, s38, 16
    v_and_b32 v2, 15, v1
    v_add_u32 v2, s69, v2
    v_lshlrev_b32_e64 v2, 2, v2
    v_add_u32 v2, 152064, v2
    ds_read_b32 v193, v2
    ds_read_b32 v192, v2 offset:1024
    s_mul_i32 s76, s67, 4224
    s_add_u32 s76, s76, 1048576
    v_lshlrev_b32 v5, 4, v1
    v_and_b32 v6, 48, v1
    v_add_u32 v6, 4096, v6
    s_lshl_b32 s3, s38, 2
    s_add_u32 s3, s3, 162112
    v_mov_b32 v3, s3
L_gw:
    ds_read_b32 v2, v3
    s_waitcnt lgkmcnt(0)
    v_readfirstlane_b32 s3, v2
    s_nop 0
    s_cmp_eq_u32 s3, 3
    s_cbranch_scc1 L_gk
    s_sleep 1
    s_branch L_gw
L_gk:
    v_mul_f32 v196, v193, v192
    v_mov_b32 v198, 0xbfb8aa3b
    v_lshlrev_b32 v224, 16, v240
    v_and_b32 v225, 0xffff0000, v240
    v_lshlrev_b32 v226, 16, v241
    v_and_b32 v227, 0xffff0000, v241
    v_lshlrev_b32 v228, 16, v242
    v_and_b32 v229, 0xffff0000, v242
    v_lshlrev_b32 v230, 16, v243
    v_and_b32 v231, 0xffff0000, v243
    v_lshlrev_b32 v232, 16, v244
    v_and_b32 v233, 0xffff0000, v244
    v_lshlrev_b32 v234, 16, v245
    v_and_b32 v235, 0xffff0000, v245
    v_lshlrev_b32 v236, 16, v246
    v_and_b32 v237, 0xffff0000, v246
    v_lshlrev_b32 v238, 16, v247
    v_and_b32 v239, 0xffff0000, v247
    v_pk_fma_f32 v[224:225], v[224:225], v[192:193], v[196:197] op_sel_hi:[1,0,0] neg_lo:[0,0,1] neg_hi:[0,0,1]
    v_pk_fma_f32 v[226:227], v[226:227], v[192:193], v[196:197] op_sel_hi:[1,0,0] neg_lo:[0,0,1] neg_hi:[0,0,1]
    v_pk_fma_f32 v[228:229], v[228:229], v[192:193], v[196:197] op_sel_hi:[1,0,0] neg_lo:[0,0,1] neg_hi:[0,0,1]
    v_pk_fma_f32 v[230:231], v[230:231], v[192:193], v[196:197] op_sel_hi:[1,0,0] neg_lo:[0,0,1] neg_hi:[0,0,1]
    v_pk_fma_f32 v[232:233], v[232:233], v[192:193], v[196:197] op_sel_hi:[1,0,0] neg_lo:[0,0,1] neg_hi:[0,0,1]
    v_pk_fma_f32 v[234:235], v[234:235], v[192:193], v[196:197] op_sel_hi:[1,0,0] neg_lo:[0,0,1] neg_hi:[0,0,1]
    v_pk_fma_f32 v[236:237], v[236:237], v[192:193], v[196:197] op_sel_hi:[1,0,0] neg_lo:[0,0,1] neg_hi:[0,0,1]
    v_pk_fma_f32 v[238:239], v[238:239], v[192:193], v[196:197] op_sel_hi:[1,0,0] neg_lo:[0,0,1] neg_hi:[0,0,1]
    v_pk_mul_f32 v[200:201], v[224:225], v[198:199] op_sel_hi:[1,0]
    v_pk_mul_f32 v[202:203], v[226:227], v[198:199] op_sel_hi:[1,0]
    v_pk_mul_f32 v[204:205], v[228:229], v[198:199] op_sel_hi:[1,0]
    v_pk_mul_f32 v[206:207], v[230:231], v[198:199] op_sel_hi:[1,0]
    v_pk_mul_f32 v[208:209], v[232:233], v[198:199] op_sel_hi:[1,0]
    v_pk_mul_f32 v[210:211], v[234:235], v[198:199] op_sel_hi:[1,0]
    v_pk_mul_f32 v[212:213], v[236:237], v[198:199] op_sel_hi:[1,0]
    v_pk_mul_f32 v[214:215], v[238:239], v[198:199] op_sel_hi:[1,0]
    v_exp_f32 v200, v200
    v_exp_f32 v201, v201
    v_exp_f32 v202, v202
    v_exp_f32 v203, v203
    v_exp_f32 v204, v204
    v_exp_f32 v205, v205
    v_exp_f32 v206, v206
    v_exp_f32 v207, v207
    v_exp_f32 v208, v208
    v_exp_f32 v209, v209
    v_exp_f32 v210, v210
    v_exp_f32 v211, v211
    v_exp_f32 v212, v212
    v_exp_f32 v213, v213
    v_exp_f32 v214, v214
    v_exp_f32 v215, v215
    v_pk_add_f32 v[200:201], v[200:201], 1.0 op_sel_hi:[1,0]
    v_pk_add_f32 v[202:203], v[202:203], 1.0 op_sel_hi:[1,0]
    v_pk_add_f32 v[204:205], v[204:205], 1.0 op_sel_hi:[1,0]
    v_pk_add_f32 v[206:207], v[206:207], 1.0 op_sel_hi:[1,0]
    v_pk_add_f32 v[208:209], v[208:209], 1.0 op_sel_hi:[1,0]
    v_pk_add_f32 v[210:211], v[210:211], 1.0 op_sel_hi:[1,0]
    v_pk_add_f32 v[212:213], v[212:213], 1.0 op_sel_hi:[1,0]
    v_pk_add_f32 v[214:215], v[214:215], 1.0 op_sel_hi:[1,0]
    v_rcp_f32 v200, v200
    v_rcp_f32 v201, v201
    v_rcp_f32 v202, v202
    v_rcp_f32 v203, v203
    v_rcp_f32 v204, v204
    v_rcp_f32 v205, v205
    v_rcp_f32 v206, v206
    v_rcp_f32 v207, v207
    v_rcp_f32 v208, v208
    v_rcp_f32 v209, v209
    v_rcp_f32 v210, v210
    v_rcp_f32 v211, v211
    v_rcp_f32 v212, v212
    v_rcp_f32 v213, v213
    v_rcp_f32 v214, v214
    v_rcp_f32 v215, v215
    v_pk_mul_f32 v[224:225], v[224:225], v[200:201]
    v_pk_mul_f32 v[226:227], v[226:227], v[202:203]
    v_pk_mul_f32 v[228:229], v[228:229], v[204:205]
    v_pk_mul_f32 v[230:231], v[230:231], v[206:207]
    v_pk_mul_f32 v[232:233], v[232:233], v[208:209]
    v_pk_mul_f32 v[234:235], v[234:235], v[210:211]
    v_pk_mul_f32 v[236:237], v[236:237], v[212:213]
    v_pk_mul_f32 v[238:239], v[238:239], v[214:215]
    buffer_load_dwordx4 v[104:107], v5, s[48:51], s76 offen offset:0 sc1
    buffer_load_dwordx4 v[108:111], v5, s[48:51], s76 offen offset:1024 sc1
    buffer_load_dwordx4 v[112:115], v5, s[48:51], s76 offen offset:2048 sc1
    buffer_load_dwordx4 v[116:119], v5, s[48:51], s76 offen offset:3072 sc1
    buffer_load_dwordx4 v[120:123], v6, s[48:51], s76 offen offset:0 sc1
    buffer_load_dwordx4 v[124:127], v6, s[48:51], s76 offen offset:64 sc1
    s_waitcnt lgkmcnt(0)
    v_readfirstlane_b32 s70, v248
    s_nop 0
    s_and_b32 s68, s70, 0x7ff
    s_sub_u32 s68, 2047, s68
    s_lshl_b32 s3, s36, 3
    s_lshl_b32 s28, s64, 2
    s_add_u32 s3, s3, s28
    s_lshl_b32 s3, s3, 5
    s_add_u32 s3, s3, s67
    s_lshl_b32 s77, s3, 10
    s_add_u32 s77, s77, 4194304
    s_waitcnt vmcnt(0)
    s_mov_b32 s29, 0
L_k7:
    s_nop 0
    v_max3_u32 v2, v104, v105, v106
    v_max3_u32 v2, v2, v107, v108
    v_max3_u32 v2, v2, v109, v110
    v_max3_u32 v2, v2, v111, v112
    v_max3_u32 v2, v2, v113, v114
    v_max3_u32 v2, v2, v115, v116
    v_max3_u32 v2, v2, v117, v118
    v_max3_u32 v2, v2, v119, v120
    v_max3_u32 v2, v2, v121, v122
    v_max3_u32 v2, v2, v123, v124
    v_max3_u32 v2, v2, v125, v126
    v_max_u32 v2, v2, v127
    v_cmp_eq_u32 vcc, -1, v2
    s_cbranch_vccz L_k7k
    s_add_u32 s29, s29, 1
    s_cmp_ge_u32 s29, 200000
    s_cbranch_scc1 L_k7k
    s_sleep 1
    buffer_load_dwordx4 v[104:107], v5, s[48:51], s76 offen offset:0 sc1
    buffer_load_dwordx4 v[108:111], v5, s[48:51], s76 offen offset:1024 sc1
    buffer_load_dwordx4 v[112:115], v5, s[48:51], s76 offen offset:2048 sc1
    buffer_load_dwordx4 v[116:119], v5, s[48:51], s76 offen offset:3072 sc1
    buffer_load_dwordx4 v[120:123], v6, s[48:51], s76 offen offset:0 sc1
    buffer_load_dwordx4 v[124:127], v6, s[48:51], s76 offen offset:64 sc1
    s_waitcnt vmcnt(0)
    s_branch L_k7
L_k7k:
    s_setprio 2
    s_nop 0
    v_mfma_f32_16x16x32_bf16 v[24:27], v[120:123], v[144:147], 0
    v_mfma_f32_16x16x32_bf16 v[16:19], v[104:107], v[144:147], 0
    v_mfma_f32_16x16x32_bf16 v[20:23], v[108:111], v[144:147], 0
    v_mfma_f32_16x16x32_bf16 v[24:27], v[124:127], v[8:11], v[24:27]
    v_mfma_f32_16x16x32_bf16 v[16:19], v[112:115], v[8:11], v[16:19]
    v_mfma_f32_16x16x32_bf16 v[20:23], v[116:119], v[8:11], v[20:23]
    v_mfma_f32_16x16x32_bf16 v[48:51], v[120:123], v[152:155], 0
    v_mfma_f32_16x16x32_bf16 v[40:43], v[104:107], v[152:155], 0
    v_mfma_f32_16x16x32_bf16 v[44:47], v[108:111], v[152:155], 0
    v_mfma_f32_16x16x32_bf16 v[48:51], v[124:127], v[32:35], v[48:51]
    v_mfma_f32_16x16x32_bf16 v[40:43], v[112:115], v[32:35], v[40:43]
    v_mfma_f32_16x16x32_bf16 v[44:47], v[116:119], v[32:35], v[44:47]
    v_mfma_f32_16x16x32_bf16 v[72:75], v[120:123], v[160:163], 0
    v_mfma_f32_16x16x32_bf16 v[64:67], v[104:107], v[160:163], 0
    v_mfma_f32_16x16x32_bf16 v[68:71], v[108:111], v[160:163], 0
    v_mfma_f32_16x16x32_bf16 v[72:75], v[124:127], v[56:59], v[72:75]
    v_mfma_f32_16x16x32_bf16 v[64:67], v[112:115], v[56:59], v[64:67]
    v_mfma_f32_16x16x32_bf16 v[68:71], v[116:119], v[56:59], v[68:71]
    v_mfma_f32_16x16x32_bf16 v[96:99], v[120:123], v[168:171], 0
    v_mfma_f32_16x16x32_bf16 v[88:91], v[104:107], v[168:171], 0
    v_mfma_f32_16x16x32_bf16 v[92:95], v[108:111], v[168:171], 0
    v_mfma_f32_16x16x32_bf16 v[96:99], v[124:127], v[80:83], v[96:99]
    v_mfma_f32_16x16x32_bf16 v[88:91], v[112:115], v[80:83], v[88:91]
    v_mfma_f32_16x16x32_bf16 v[92:95], v[116:119], v[80:83], v[92:95]
    v_add_f32 v24, 0x358637bd, v24
    v_add_f32 v48, 0x358637bd, v48
    v_add_f32 v72, 0x358637bd, v72
    s_nop 2
    v_add_f32 v96, 0x358637bd, v96
    v_rcp_f32 v24, v24
    v_rcp_f32 v48, v48
    v_rcp_f32 v72, v72
    v_rcp_f32_e64 v96, v96
    v_pk_mul_f32 v[16:17], v[16:17], v[24:25] op_sel_hi:[1,0]
    v_pk_mul_f32 v[18:19], v[18:19], v[24:25] op_sel_hi:[1,0]
    v_pk_mul_f32 v[20:21], v[20:21], v[24:25] op_sel_hi:[1,0]
    v_pk_mul_f32 v[22:23], v[22:23], v[24:25] op_sel_hi:[1,0]
    v_cvt_pk_bf16_f32 v16, v16, v17
    v_cvt_pk_bf16_f32 v17, v18, v19
    v_cvt_pk_bf16_f32 v18, v20, v21
    v_cvt_pk_bf16_f32 v19, v22, v23
    buffer_store_dwordx4 v[16:19], v5, s[48:51], s77 offen sc1
    s_add_u32 s77, s77, 32768
    v_pk_mul_f32 v[40:41], v[40:41], v[48:49] op_sel_hi:[1,0]
    v_pk_mul_f32 v[42:43], v[42:43], v[48:49] op_sel_hi:[1,0]
    v_pk_mul_f32 v[44:45], v[44:45], v[48:49] op_sel_hi:[1,0]
    v_pk_mul_f32 v[46:47], v[46:47], v[48:49] op_sel_hi:[1,0]
    v_cvt_pk_bf16_f32 v40, v40, v41
    v_cvt_pk_bf16_f32 v41, v42, v43
    v_cvt_pk_bf16_f32 v42, v44, v45
    v_cvt_pk_bf16_f32 v43, v46, v47
    buffer_store_dwordx4 v[40:43], v5, s[48:51], s77 offen sc1
    s_add_u32 s77, s77, 32768
    v_pk_mul_f32 v[64:65], v[64:65], v[72:73] op_sel_hi:[1,0]
    v_pk_mul_f32 v[66:67], v[66:67], v[72:73] op_sel_hi:[1,0]
    v_pk_mul_f32 v[68:69], v[68:69], v[72:73] op_sel_hi:[1,0]
    v_pk_mul_f32 v[70:71], v[70:71], v[72:73] op_sel_hi:[1,0]
    v_cvt_pk_bf16_f32 v64, v64, v65
    v_cvt_pk_bf16_f32 v65, v66, v67
    v_cvt_pk_bf16_f32 v66, v68, v69
    v_cvt_pk_bf16_f32 v67, v70, v71
    buffer_store_dwordx4 v[64:67], v5, s[48:51], s77 offen sc1
    s_add_u32 s77, s77, 32768
    v_pk_mul_f32 v[88:89], v[88:89], v[96:97] op_sel_hi:[1,0]
    v_pk_mul_f32 v[90:91], v[90:91], v[96:97] op_sel_hi:[1,0]
    v_pk_mul_f32 v[92:93], v[92:93], v[96:97] op_sel_hi:[1,0]
    v_pk_mul_f32 v[94:95], v[94:95], v[96:97] op_sel_hi:[1,0]
    v_cvt_pk_bf16_f32 v88, v88, v89
    v_cvt_pk_bf16_f32 v89, v90, v91
    v_cvt_pk_bf16_f32 v90, v92, v93
    v_cvt_pk_bf16_f32 v91, v94, v95
    buffer_store_dwordx4 v[88:91], v5, s[48:51], s77 offen sc1
    v_mov_b32_e64 v2, 7
    ds_write_b32 v3, v2
    s_and_b32 s3, s68, 127
    s_lshl_b32 s3, s3, 2
    s_add_u32 s3, s3, 152064
    v_mov_b32 v2, s3
    ds_read_b32 v250, v2
    ds_read_b32 v251, v2 offset:1024
    s_setprio 0
    v_and_b32 v3, 3, v1
    v_lshlrev_b32_e64 v3, 2, v3
    v_add_u32 v3, 162112, v3
L_cw:
    ds_read_b32 v2, v3
    s_waitcnt lgkmcnt(0)
    v_cmp_ne_u32_e64 vcc, 7, v2
    s_cbranch_vccz L_cwk
    s_sleep 1
    s_branch L_cw
L_cwk:
    s_add_u32 m0, s72, 98304
    s_add_u32 s3, s73, 1572864
    buffer_load_dwordx4 v216, s[88:91], s3 offen offset:0 lds
    buffer_load_dwordx4 v217, s[88:91], s3 offen offset:1024 lds
    buffer_load_dwordx4 v218, s[88:91], s3 offen offset:2048 lds
    buffer_load_dwordx4 v219, s[88:91], s3 offen offset:3072 lds
    s_add_u32 m0, s72, 114688
    s_add_u32 s3, s73, 1835008
    buffer_load_dwordx4 v216, s[88:91], s3 offen offset:0 lds
    buffer_load_dwordx4 v217, s[88:91], s3 offen offset:1024 lds
    buffer_load_dwordx4 v218, s[88:91], s3 offen offset:2048 lds
    buffer_load_dwordx4 v219, s[88:91], s3 offen offset:3072 lds
L_p3:
    s_nop 3
    s_mov_b32 s56, s22
    s_mov_b32 s57, s23
    s_mov_b32 s58, 4194304
    s_mov_b32 s59, 0x00020000
    s_lshr_b32 s64, s39, 2
    s_lshl_b32 s3, s34, 2
    s_add_u32 s3, s3, s38
    s_lshl_b32 s3, s3, 16
    s_lshl_b32 s28, s64, 14
    s_add_u32 s3, s3, s28
    s_add_u32 s76, s3, 4194304
    s_lshl_b32 s3, s64, 15
    v_lshlrev_b32 v2, 4, v1
    v_add_u32 v116, s3, v2
    v_xor_b32 v117, 0x8000, v116
    v_lshrrev_b32 v2, 2, v1
    v_lshlrev_b32 v2, 7, v2
    v_bfe_u32 v3, v1, 3, 2
    v_lshl_add_u32 v2, v3, 5, v2
    v_and_b32 v3, 3, v1
    v_lshl_add_u32 v2, v3, 3, v2
    s_lshl_b32 s3, s64, 16
    v_add_u32 v112, s3, v2
    v_xor_b32 v113, 32, v112
    v_xor_b32 v114, 64, v112
    v_xor_b32 v115, 96, v112
    s_add_u32 s77, s76, 0
    buffer_load_dwordx4 v[40:43], v116, s[48:51], s77 offen offset:0 sc1
    buffer_load_dwordx4 v[44:47], v117, s[48:51], s77 offen offset:0 sc1
    buffer_load_dwordx4 v[48:51], v116, s[48:51], s77 offen offset:1024 sc1
    buffer_load_dwordx4 v[52:55], v117, s[48:51], s77 offen offset:1024 sc1
    buffer_load_dwordx4 v[56:59], v116, s[48:51], s77 offen offset:2048 sc1
    buffer_load_dwordx4 v[60:63], v117, s[48:51], s77 offen offset:2048 sc1
    buffer_load_dwordx4 v[64:67], v116, s[48:51], s77 offen offset:3072 sc1
    buffer_load_dwordx4 v[68:71], v117, s[48:51], s77 offen offset:3072 sc1
    s_lshr_b32 s3, s68, 7
    s_xor_b32 s83, s3, s34
    s_or_b32 s83, s83, s39
    v_lshlrev_b32 v222, 4, v1
    ds_read_b64_tr_b16 v[80:81], v112 offset:0
    ds_read_b64_tr_b16 v[82:83], v112 offset:2048
    ds_read_b64_tr_b16 v[84:85], v113 offset:0
    ds_read_b64_tr_b16 v[86:87], v113 offset:2048
    ds_read_b64_tr_b16 v[88:89], v114 offset:0
    ds_read_b64_tr_b16 v[90:91], v114 offset:2048
    ds_read_b64_tr_b16 v[92:93], v115 offset:0
    ds_read_b64_tr_b16 v[94:95], v115 offset:2048
    s_mov_b32 s29, 0
    s_waitcnt vmcnt(6)
    v_max3_u32 v2, v40, v41, v42
    v_max3_u32 v2, v2, v43, v44
    v_max3_u32 v2, v2, v45, v46
    v_max_u32 v2, v2, v47
    v_cmp_eq_u32 vcc, -1, v2
    s_cbranch_vccnz L_r0
L_g0:
    s_waitcnt lgkmcnt(0)
    v_mfma_f32_16x16x32_bf16 v[8:11], v[80:83], v[40:43], 0
    ds_read_b64_tr_b16 v[96:97], v112 offset:4096
    ds_read_b64_tr_b16 v[98:99], v112 offset:6144
    v_mfma_f32_16x16x32_bf16 v[24:27], v[80:83], v[44:47], 0
    ds_read_b64_tr_b16 v[100:101], v113 offset:4096
    ds_read_b64_tr_b16 v[102:103], v113 offset:6144
    v_mfma_f32_16x16x32_bf16 v[12:15], v[84:87], v[40:43], 0
    ds_read_b64_tr_b16 v[104:105], v114 offset:4096
    ds_read_b64_tr_b16 v[106:107], v114 offset:6144
    v_mfma_f32_16x16x32_bf16 v[28:31], v[84:87], v[44:47], 0
    ds_read_b64_tr_b16 v[108:109], v115 offset:4096
    ds_read_b64_tr_b16 v[110:111], v115 offset:6144
    v_mfma_f32_16x16x32_bf16 v[16:19], v[88:91], v[40:43], 0
    s_add_u32 s77, s76, 4096
    buffer_load_dwordx4 v[72:75], v116, s[48:51], s77 offen offset:0 sc1
    buffer_load_dwordx4 v[76:79], v117, s[48:51], s77 offen offset:0 sc1
    v_mfma_f32_16x16x32_bf16 v[32:35], v[88:91], v[44:47], 0
    s_waitcnt vmcnt(6)
    v_max3_u32 v2, v48, v49, v50
    v_mfma_f32_16x16x32_bf16 v[20:23], v[92:95], v[40:43], 0
    v_max3_u32 v2, v2, v51, v52
    v_max3_u32 v2, v2, v53, v54
    v_mfma_f32_16x16x32_bf16 v[36:39], v[92:95], v[44:47], 0
    v_max_u32 v2, v2, v55
    v_cmp_eq_u32_e64 vcc, -1, v2
    s_cbranch_vccnz L_r1
L_g1:
    s_waitcnt lgkmcnt(0)
    v_mfma_f32_16x16x32_bf16 v[8:11], v[96:99], v[48:51], v[8:11]
    ds_read_b64_tr_b16 v[80:81], v112 offset:8192
    ds_read_b64_tr_b16 v[82:83], v112 offset:10240
    v_mfma_f32_16x16x32_bf16 v[24:27], v[96:99], v[52:55], v[24:27]
    ds_read_b64_tr_b16 v[84:85], v113 offset:8192
    ds_read_b64_tr_b16 v[86:87], v113 offset:10240
    v_mfma_f32_16x16x32_bf16 v[12:15], v[100:103], v[48:51], v[12:15]
    ds_read_b64_tr_b16 v[88:89], v114 offset:8192
    ds_read_b64_tr_b16 v[90:91], v114 offset:10240
    v_mfma_f32_16x16x32_bf16 v[28:31], v[100:103], v[52:55], v[28:31]
    ds_read_b64_tr_b16 v[92:93], v115 offset:8192
    ds_read_b64_tr_b16 v[94:95], v115 offset:10240
    v_mfma_f32_16x16x32_bf16 v[16:19], v[104:107], v[48:51], v[16:19]
    buffer_load_dwordx4 v[40:43], v116, s[48:51], s77 offen offset:1024 sc1
    buffer_load_dwordx4 v[44:47], v117, s[48:51], s77 offen offset:1024 sc1
    v_mfma_f32_16x16x32_bf16 v[32:35], v[104:107], v[52:55], v[32:35]
    s_waitcnt vmcnt(6)
    v_max3_u32 v2, v56, v57, v58
    v_mfma_f32_16x16x32_bf16 v[20:23], v[108:111], v[48:51], v[20:23]
    v_max3_u32 v2, v2, v59, v60
    v_max3_u32 v2, v2, v61, v62
    v_mfma_f32_16x16x32_bf16 v[36:39], v[108:111], v[52:55], v[36:39]
    v_max_u32 v2, v2, v63
    v_cmp_eq_u32_e64 vcc, -1, v2
    s_cbranch_vccnz L_r2
L_g2:
    s_waitcnt lgkmcnt(0)
    v_mfma_f32_16x16x32_bf16 v[8:11], v[80:83], v[56:59], v[8:11]
    ds_read_b64_tr_b16 v[96:97], v112 offset:12288
    ds_read_b64_tr_b16 v[98:99], v112 offset:14336
    v_mfma_f32_16x16x32_bf16 v[24:27], v[80:83], v[60:63], v[24:27]
    ds_read_b64_tr_b16 v[100:101], v113 offset:12288
    ds_read_b64_tr_b16 v[102:103], v113 offset:14336
    v_mfma_f32_16x16x32_bf16 v[12:15], v[84:87], v[56:59], v[12:15]
    ds_read_b64_tr_b16 v[104:105], v114 offset:12288
    ds_read_b64_tr_b16 v[106:107], v114 offset:14336
    v_mfma_f32_16x16x32_bf16 v[28:31], v[84:87], v[60:63], v[28:31]
    ds_read_b64_tr_b16 v[108:109], v115 offset:12288
    ds_read_b64_tr_b16 v[110:111], v115 offset:14336
    v_mfma_f32_16x16x32_bf16 v[16:19], v[88:91], v[56:59], v[16:19]
    buffer_load_dwordx4 v[48:51], v116, s[48:51], s77 offen offset:2048 sc1
    buffer_load_dwordx4 v[52:55], v117, s[48:51], s77 offen offset:2048 sc1
    v_mfma_f32_16x16x32_bf16 v[32:35], v[88:91], v[60:63], v[32:35]
    s_waitcnt vmcnt(6)
    v_max3_u32 v2, v64, v65, v66
    v_mfma_f32_16x16x32_bf16 v[20:23], v[92:95], v[56:59], v[20:23]
    v_max3_u32 v2, v2, v67, v68
    v_max3_u32 v2, v2, v69, v70
    v_mfma_f32_16x16x32_bf16 v[36:39], v[92:95], v[60:63], v[36:39]
    v_max_u32 v2, v2, v71
    v_cmp_eq_u32 vcc, -1, v2
    s_cbranch_vccnz L_r3
L_g3:
    s_waitcnt lgkmcnt(0)
    s_cmp_eq_u32 s64, 0
    s_cbranch_scc1 L_nb3
    s_barrier
L_nb3:
    v_mfma_f32_16x16x32_bf16 v[8:11], v[96:99], v[64:67], v[8:11]
    ds_read_b64_tr_b16 v[80:81], v112 offset:16384
    ds_read_b64_tr_b16 v[82:83], v112 offset:18432
    v_mfma_f32_16x16x32_bf16 v[24:27], v[96:99], v[68:71], v[24:27]
    ds_read_b64_tr_b16 v[84:85], v113 offset:16384
    ds_read_b64_tr_b16 v[86:87], v113 offset:18432
    v_mfma_f32_16x16x32_bf16 v[12:15], v[100:103], v[64:67], v[12:15]
    ds_read_b64_tr_b16 v[88:89], v114 offset:16384
    ds_read_b64_tr_b16 v[90:91], v114 offset:18432
    v_mfma_f32_16x16x32_bf16 v[28:31], v[100:103], v[68:71], v[28:31]
    ds_read_b64_tr_b16 v[92:93], v115 offset:16384
    ds_read_b64_tr_b16 v[94:95], v115 offset:18432
    v_mfma_f32_16x16x32_bf16 v[16:19], v[104:107], v[64:67], v[16:19]
    buffer_load_dwordx4 v[56:59], v116, s[48:51], s77 offen offset:3072 sc1
    buffer_load_dwordx4 v[60:63], v117, s[48:51], s77 offen offset:3072 sc1
    v_mfma_f32_16x16x32_bf16 v[32:35], v[104:107], v[68:71], v[32:35]
    s_waitcnt vmcnt(6)
    v_max3_u32 v2, v72, v73, v74
    v_mfma_f32_16x16x32_bf16 v[20:23], v[108:111], v[64:67], v[20:23]
    v_max3_u32 v2, v2, v75, v76
    v_max3_u32 v2, v2, v77, v78
    v_mfma_f32_16x16x32_bf16 v[36:39], v[108:111], v[68:71], v[36:39]
    v_max_u32 v2, v2, v79
    v_cmp_eq_u32_e64 vcc, -1, v2
    s_cbranch_vccnz L_r4
L_g4:
    s_waitcnt lgkmcnt(0)
    v_mfma_f32_16x16x32_bf16 v[8:11], v[80:83], v[72:75], v[8:11]
    ds_read_b64_tr_b16 v[96:97], v112 offset:20480
    ds_read_b64_tr_b16 v[98:99], v112 offset:22528
    v_mfma_f32_16x16x32_bf16 v[24:27], v[80:83], v[76:79], v[24:27]
    ds_read_b64_tr_b16 v[100:101], v113 offset:20480
    ds_read_b64_tr_b16 v[102:103], v113 offset:22528
    v_mfma_f32_16x16x32_bf16 v[12:15], v[84:87], v[72:75], v[12:15]
    ds_read_b64_tr_b16 v[104:105], v114 offset:20480
    ds_read_b64_tr_b16 v[106:107], v114 offset:22528
    v_mfma_f32_16x16x32_bf16 v[28:31], v[84:87], v[76:79], v[28:31]
    ds_read_b64_tr_b16 v[108:109], v115 offset:20480
    ds_read_b64_tr_b16 v[110:111], v115 offset:22528
    v_mfma_f32_16x16x32_bf16 v[16:19], v[88:91], v[72:75], v[16:19]
    s_add_u32 s77, s76, 8192
    buffer_load_dwordx4 v[64:67], v116, s[48:51], s77 offen offset:0 sc1
    buffer_load_dwordx4 v[68:71], v117, s[48:51], s77 offen offset:0 sc1
    v_mfma_f32_16x16x32_bf16 v[32:35], v[88:91], v[76:79], v[32:35]
    s_waitcnt vmcnt(6)
    v_max3_u32 v2, v40, v41, v42
    v_mfma_f32_16x16x32_bf16 v[20:23], v[92:95], v[72:75], v[20:23]
    v_max3_u32 v2, v2, v43, v44
    v_max3_u32 v2, v2, v45, v46
    v_mfma_f32_16x16x32_bf16 v[36:39], v[92:95], v[76:79], v[36:39]
    v_max_u32 v2, v2, v47
    v_cmp_eq_u32_e64 vcc, -1, v2
    s_cbranch_vccnz L_r5
L_g5:
    s_waitcnt lgkmcnt(0)
    v_mfma_f32_16x16x32_bf16 v[8:11], v[96:99], v[40:43], v[8:11]
    ds_read_b64_tr_b16 v[80:81], v112 offset:24576
    ds_read_b64_tr_b16 v[82:83], v112 offset:26624
    v_mfma_f32_16x16x32_bf16 v[24:27], v[96:99], v[44:47], v[24:27]
    ds_read_b64_tr_b16 v[84:85], v113 offset:24576
    ds_read_b64_tr_b16 v[86:87], v113 offset:26624
    v_mfma_f32_16x16x32_bf16 v[12:15], v[100:103], v[40:43], v[12:15]
    ds_read_b64_tr_b16 v[88:89], v114 offset:24576
    ds_read_b64_tr_b16 v[90:91], v114 offset:26624
    v_mfma_f32_16x16x32_bf16 v[28:31], v[100:103], v[44:47], v[28:31]
    ds_read_b64_tr_b16 v[92:93], v115 offset:24576
    ds_read_b64_tr_b16 v[94:95], v115 offset:26624
    v_mfma_f32_16x16x32_bf16 v[16:19], v[104:107], v[40:43], v[16:19]
    buffer_load_dwordx4 v[72:75], v116, s[48:51], s77 offen offset:1024 sc1
    buffer_load_dwordx4 v[76:79], v117, s[48:51], s77 offen offset:1024 sc1
    v_mfma_f32_16x16x32_bf16 v[32:35], v[104:107], v[44:47], v[32:35]
    s_waitcnt vmcnt(6)
    v_max3_u32 v2, v48, v49, v50
    v_mfma_f32_16x16x32_bf16 v[20:23], v[108:111], v[40:43], v[20:23]
    v_max3_u32 v2, v2, v51, v52
    v_max3_u32 v2, v2, v53, v54
    v_mfma_f32_16x16x32_bf16 v[36:39], v[108:111], v[44:47], v[36:39]
    v_max_u32 v2, v2, v55
    v_cmp_eq_u32_e64 vcc, -1, v2
    s_cbranch_vccnz L_r6
L_g6:
    s_waitcnt lgkmcnt(0)
    v_mfma_f32_16x16x32_bf16 v[8:11], v[80:83], v[48:51], v[8:11]
    ds_read_b64_tr_b16 v[96:97], v112 offset:28672
    ds_read_b64_tr_b16 v[98:99], v112 offset:30720
    v_mfma_f32_16x16x32_bf16 v[24:27], v[80:83], v[52:55], v[24:27]
    ds_read_b64_tr_b16 v[100:101], v113 offset:28672
    ds_read_b64_tr_b16 v[102:103], v113 offset:30720
    v_mfma_f32_16x16x32_bf16 v[12:15], v[84:87], v[48:51], v[12:15]
    ds_read_b64_tr_b16 v[104:105], v114 offset:28672
    ds_read_b64_tr_b16 v[106:107], v114 offset:30720
    v_mfma_f32_16x16x32_bf16 v[28:31], v[84:87], v[52:55], v[28:31]
    ds_read_b64_tr_b16 v[108:109], v115 offset:28672
    ds_read_b64_tr_b16 v[110:111], v115 offset:30720
    v_mfma_f32_16x16x32_bf16 v[16:19], v[88:91], v[48:51], v[16:19]
    buffer_load_dwordx4 v[40:43], v116, s[48:51], s77 offen offset:2048 sc1
    buffer_load_dwordx4 v[44:47], v117, s[48:51], s77 offen offset:2048 sc1
    v_mfma_f32_16x16x32_bf16 v[32:35], v[88:91], v[52:55], v[32:35]
    s_waitcnt vmcnt(6)
    v_max3_u32 v2, v56, v57, v58
    v_mfma_f32_16x16x32_bf16 v[20:23], v[92:95], v[48:51], v[20:23]
    v_max3_u32 v2, v2, v59, v60
    v_max3_u32 v2, v2, v61, v62
    v_mfma_f32_16x16x32_bf16 v[36:39], v[92:95], v[52:55], v[36:39]
    v_max_u32 v2, v2, v63
    v_cmp_eq_u32 vcc, -1, v2
    s_cbranch_vccnz L_r7
L_g7:
    s_waitcnt lgkmcnt(0)
    s_cmp_eq_u32 s64, 1
    s_cbranch_scc1 L_nb7
    s_barrier
L_nb7:
    v_mfma_f32_16x16x32_bf16 v[8:11], v[96:99], v[56:59], v[8:11]
    ds_read_b64_tr_b16 v[80:81], v112 offset:32768
    ds_read_b64_tr_b16 v[82:83], v112 offset:34816
    v_mfma_f32_16x16x32_bf16 v[24:27], v[96:99], v[60:63], v[24:27]
    ds_read_b64_tr_b16 v[84:85], v113 offset:32768
    ds_read_b64_tr_b16 v[86:87], v113 offset:34816
    v_mfma_f32_16x16x32_bf16 v[12:15], v[100:103], v[56:59], v[12:15]
    ds_read_b64_tr_b16 v[88:89], v114 offset:32768
    ds_read_b64_tr_b16 v[90:91], v114 offset:34816
    v_mfma_f32_16x16x32_bf16 v[28:31], v[100:103], v[60:63], v[28:31]
    ds_read_b64_tr_b16 v[92:93], v115 offset:32768
    ds_read_b64_tr_b16 v[94:95], v115 offset:34816
    v_mfma_f32_16x16x32_bf16 v[16:19], v[104:107], v[56:59], v[16:19]
    buffer_load_dwordx4 v[48:51], v116, s[48:51], s77 offen offset:3072 sc1
    buffer_load_dwordx4 v[52:55], v117, s[48:51], s77 offen offset:3072 sc1
    v_mfma_f32_16x16x32_bf16 v[32:35], v[104:107], v[60:63], v[32:35]
    s_waitcnt vmcnt(6)
    v_max3_u32 v2, v64, v65, v66
    v_mfma_f32_16x16x32_bf16 v[20:23], v[108:111], v[56:59], v[20:23]
    v_max3_u32 v2, v2, v67, v68
    v_max3_u32 v2, v2, v69, v70
    v_mfma_f32_16x16x32_bf16 v[36:39], v[108:111], v[60:63], v[36:39]
    v_max_u32 v2, v2, v71
    v_cmp_eq_u32_e64 vcc, -1, v2
    s_cbranch_vccnz L_r8
L_g8:
    s_waitcnt lgkmcnt(0)
    v_mfma_f32_16x16x32_bf16 v[8:11], v[80:83], v[64:67], v[8:11]
    ds_read_b64_tr_b16 v[96:97], v112 offset:36864
    ds_read_b64_tr_b16 v[98:99], v112 offset:38912
    v_mfma_f32_16x16x32_bf16 v[24:27], v[80:83], v[68:71], v[24:27]
    ds_read_b64_tr_b16 v[100:101], v113 offset:36864
    ds_read_b64_tr_b16 v[102:103], v113 offset:38912
    v_mfma_f32_16x16x32_bf16 v[12:15], v[84:87], v[64:67], v[12:15]
    ds_read_b64_tr_b16 v[104:105], v114 offset:36864
    ds_read_b64_tr_b16 v[106:107], v114 offset:38912
    v_mfma_f32_16x16x32_bf16 v[28:31], v[84:87], v[68:71], v[28:31]
    ds_read_b64_tr_b16 v[108:109], v115 offset:36864
    ds_read_b64_tr_b16 v[110:111], v115 offset:38912
    v_mfma_f32_16x16x32_bf16 v[16:19], v[88:91], v[64:67], v[16:19]
    s_add_u32 s77, s76, 12288
    buffer_load_dwordx4 v[56:59], v116, s[48:51], s77 offen offset:0 sc1
    buffer_load_dwordx4 v[60:63], v117, s[48:51], s77 offen offset:0 sc1
    v_mfma_f32_16x16x32_bf16 v[32:35], v[88:91], v[68:71], v[32:35]
    s_waitcnt vmcnt(6)
    v_max3_u32 v2, v72, v73, v74
    v_mfma_f32_16x16x32_bf16 v[20:23], v[92:95], v[64:67], v[20:23]
    v_max3_u32 v2, v2, v75, v76
    v_max3_u32 v2, v2, v77, v78
    v_mfma_f32_16x16x32_bf16 v[36:39], v[92:95], v[68:71], v[36:39]
    v_max_u32 v2, v2, v79
    v_cmp_eq_u32_e64 vcc, -1, v2
    s_cbranch_vccnz L_r9
L_g9:
    s_waitcnt lgkmcnt(0)
    v_mfma_f32_16x16x32_bf16 v[8:11], v[96:99], v[72:75], v[8:11]
    ds_read_b64_tr_b16 v[80:81], v112 offset:40960
    ds_read_b64_tr_b16 v[82:83], v112 offset:43008
    v_mfma_f32_16x16x32_bf16 v[24:27], v[96:99], v[76:79], v[24:27]
    ds_read_b64_tr_b16 v[84:85], v113 offset:40960
    ds_read_b64_tr_b16 v[86:87], v113 offset:43008
    v_mfma_f32_16x16x32_bf16 v[12:15], v[100:103], v[72:75], v[12:15]
    ds_read_b64_tr_b16 v[88:89], v114 offset:40960
    ds_read_b64_tr_b16 v[90:91], v114 offset:43008
    v_mfma_f32_16x16x32_bf16 v[28:31], v[100:103], v[76:79], v[28:31]
    ds_read_b64_tr_b16 v[92:93], v115 offset:40960
    ds_read_b64_tr_b16 v[94:95], v115 offset:43008
    v_mfma_f32_16x16x32_bf16 v[16:19], v[104:107], v[72:75], v[16:19]
    buffer_load_dwordx4 v[64:67], v116, s[48:51], s77 offen offset:1024 sc1
    buffer_load_dwordx4 v[68:71], v117, s[48:51], s77 offen offset:1024 sc1
    v_mfma_f32_16x16x32_bf16 v[32:35], v[104:107], v[76:79], v[32:35]
    s_waitcnt vmcnt(6)
    v_max3_u32 v2, v40, v41, v42
    v_mfma_f32_16x16x32_bf16 v[20:23], v[108:111], v[72:75], v[20:23]
    v_max3_u32 v2, v2, v43, v44
    v_max3_u32 v2, v2, v45, v46
    v_mfma_f32_16x16x32_bf16 v[36:39], v[108:111], v[76:79], v[36:39]
    v_max_u32 v2, v2, v47
    v_cmp_eq_u32_e64 vcc, -1, v2
    s_cbranch_vccnz L_r10
L_g10:
    s_waitcnt lgkmcnt(0)
    v_mfma_f32_16x16x32_bf16 v[8:11], v[80:83], v[40:43], v[8:11]
    ds_read_b64_tr_b16 v[96:97], v112 offset:45056
    ds_read_b64_tr_b16 v[98:99], v112 offset:47104
    v_mfma_f32_16x16x32_bf16 v[24:27], v[80:83], v[44:47], v[24:27]
    ds_read_b64_tr_b16 v[100:101], v113 offset:45056
    ds_read_b64_tr_b16 v[102:103], v113 offset:47104
    v_mfma_f32_16x16x32_bf16 v[12:15], v[84:87], v[40:43], v[12:15]
    ds_read_b64_tr_b16 v[104:105], v114 offset:45056
    ds_read_b64_tr_b16 v[106:107], v114 offset:47104
    v_mfma_f32_16x16x32_bf16 v[28:31], v[84:87], v[44:47], v[28:31]
    ds_read_b64_tr_b16 v[108:109], v115 offset:45056
    ds_read_b64_tr_b16 v[110:111], v115 offset:47104
    v_mfma_f32_16x16x32_bf16 v[16:19], v[88:91], v[40:43], v[16:19]
    buffer_load_dwordx4 v[72:75], v116, s[48:51], s77 offen offset:2048 sc1
    buffer_load_dwordx4 v[76:79], v117, s[48:51], s77 offen offset:2048 sc1
    v_mfma_f32_16x16x32_bf16 v[32:35], v[88:91], v[44:47], v[32:35]
    s_waitcnt vmcnt(6)
    v_max3_u32 v2, v48, v49, v50
    v_mfma_f32_16x16x32_bf16 v[20:23], v[92:95], v[40:43], v[20:23]
    v_max3_u32 v2, v2, v51, v52
    v_max3_u32 v2, v2, v53, v54
    v_mfma_f32_16x16x32_bf16 v[36:39], v[92:95], v[44:47], v[36:39]
    v_max_u32 v2, v2, v55
    v_cmp_eq_u32_e64 vcc, -1, v2
    s_cbranch_vccnz L_r11
L_g11:
    s_waitcnt lgkmcnt(0)
    v_mfma_f32_16x16x32_bf16 v[8:11], v[96:99], v[48:51], v[8:11]
    ds_read_b64_tr_b16 v[80:81], v112 offset:49152
    ds_read_b64_tr_b16 v[82:83], v112 offset:51200
    v_mfma_f32_16x16x32_bf16 v[24:27], v[96:99], v[52:55], v[24:27]
    ds_read_b64_tr_b16 v[84:85], v113 offset:49152
    ds_read_b64_tr_b16 v[86:87], v113 offset:51200
    v_mfma_f32_16x16x32_bf16 v[12:15], v[100:103], v[48:51], v[12:15]
    ds_read_b64_tr_b16 v[88:89], v114 offset:49152
    ds_read_b64_tr_b16 v[90:91], v114 offset:51200
    v_mfma_f32_16x16x32_bf16 v[28:31], v[100:103], v[52:55], v[28:31]
    ds_read_b64_tr_b16 v[92:93], v115 offset:49152
    ds_read_b64_tr_b16 v[94:95], v115 offset:51200
    v_mfma_f32_16x16x32_bf16 v[16:19], v[104:107], v[48:51], v[16:19]
    buffer_load_dwordx4 v[40:43], v116, s[48:51], s77 offen offset:3072 sc1
    buffer_load_dwordx4 v[44:47], v117, s[48:51], s77 offen offset:3072 sc1
    v_mfma_f32_16x16x32_bf16 v[32:35], v[104:107], v[52:55], v[32:35]
    s_waitcnt vmcnt(6)
    v_max3_u32 v2, v56, v57, v58
    v_mfma_f32_16x16x32_bf16 v[20:23], v[108:111], v[48:51], v[20:23]
    v_max3_u32 v2, v2, v59, v60
    v_max3_u32 v2, v2, v61, v62
    v_mfma_f32_16x16x32_bf16 v[36:39], v[108:111], v[52:55], v[36:39]
    v_max_u32 v2, v2, v63
    v_cmp_eq_u32_e64 vcc, -1, v2
    s_cbranch_vccnz L_r12
L_g12:
    s_waitcnt lgkmcnt(0)
    v_mfma_f32_16x16x32_bf16 v[8:11], v[80:83], v[56:59], v[8:11]
    ds_read_b64_tr_b16 v[96:97], v112 offset:53248
    ds_read_b64_tr_b16 v[98:99], v112 offset:55296
    v_mfma_f32_16x16x32_bf16 v[24:27], v[80:83], v[60:63], v[24:27]
    ds_read_b64_tr_b16 v[100:101], v113 offset:53248
    ds_read_b64_tr_b16 v[102:103], v113 offset:55296
    v_mfma_f32_16x16x32_bf16 v[12:15], v[84:87], v[56:59], v[12:15]
    ds_read_b64_tr_b16 v[104:105], v114 offset:53248
    ds_read_b64_tr_b16 v[106:107], v114 offset:55296
    v_mfma_f32_16x16x32_bf16 v[28:31], v[84:87], v[60:63], v[28:31]
    ds_read_b64_tr_b16 v[108:109], v115 offset:53248
    ds_read_b64_tr_b16 v[110:111], v115 offset:55296
    v_mfma_f32_16x16x32_bf16 v[16:19], v[88:91], v[56:59], v[16:19]
    v_mfma_f32_16x16x32_bf16 v[32:35], v[88:91], v[60:63], v[32:35]
    s_waitcnt vmcnt(4)
    v_max3_u32 v2, v64, v65, v66
    v_mfma_f32_16x16x32_bf16 v[20:23], v[92:95], v[56:59], v[20:23]
    v_max3_u32 v2, v2, v67, v68
    v_max3_u32 v2, v2, v69, v70
    v_mfma_f32_16x16x32_bf16 v[36:39], v[92:95], v[60:63], v[36:39]
    v_max_u32 v2, v2, v71
    v_cmp_eq_u32_e64 vcc, -1, v2
    s_cbranch_vccnz L_r13
L_g13:
    s_waitcnt lgkmcnt(0)
    v_mfma_f32_16x16x32_bf16 v[8:11], v[96:99], v[64:67], v[8:11]
    ds_read_b64_tr_b16 v[80:81], v112 offset:57344
    ds_read_b64_tr_b16 v[82:83], v112 offset:59392
    v_mfma_f32_16x16x32_bf16 v[24:27], v[96:99], v[68:71], v[24:27]
    ds_read_b64_tr_b16 v[84:85], v113 offset:57344
    ds_read_b64_tr_b16 v[86:87], v113 offset:59392
    v_mfma_f32_16x16x32_bf16 v[12:15], v[100:103], v[64:67], v[12:15]
    ds_read_b64_tr_b16 v[88:89], v114 offset:57344
    ds_read_b64_tr_b16 v[90:91], v114 offset:59392
    v_mfma_f32_16x16x32_bf16 v[28:31], v[100:103], v[68:71], v[28:31]
    ds_read_b64_tr_b16 v[92:93], v115 offset:57344
    ds_read_b64_tr_b16 v[94:95], v115 offset:59392
    v_mfma_f32_16x16x32_bf16 v[16:19], v[104:107], v[64:67], v[16:19]
    v_mfma_f32_16x16x32_bf16 v[32:35], v[104:107], v[68:71], v[32:35]
    s_waitcnt vmcnt(2)
    v_max3_u32 v2, v72, v73, v74
    v_mfma_f32_16x16x32_bf16 v[20:23], v[108:111], v[64:67], v[20:23]
    v_max3_u32 v2, v2, v75, v76
    v_max3_u32 v2, v2, v77, v78
    v_mfma_f32_16x16x32_bf16 v[36:39], v[108:111], v[68:71], v[36:39]
    v_max_u32 v2, v2, v79
    v_cmp_eq_u32_e64 vcc, -1, v2
    s_cbranch_vccnz L_r14
L_g14:
    s_cmp_eq_u32 s83, 0
    s_cbranch_scc1 L_fx1
L_fx1r:
    s_waitcnt lgkmcnt(0)
    v_mfma_f32_16x16x32_bf16 v[8:11], v[80:83], v[72:75], v[8:11]
    ds_read_b64_tr_b16 v[96:97], v112 offset:61440
    ds_read_b64_tr_b16 v[98:99], v112 offset:63488
    v_mfma_f32_16x16x32_bf16 v[24:27], v[80:83], v[76:79], v[24:27]
    ds_read_b64_tr_b16 v[100:101], v113 offset:61440
    ds_read_b64_tr_b16 v[102:103], v113 offset:63488
    v_mfma_f32_16x16x32_bf16 v[12:15], v[84:87], v[72:75], v[12:15]
    ds_read_b64_tr_b16 v[104:105], v114 offset:61440
    ds_read_b64_tr_b16 v[106:107], v114 offset:63488
    v_mfma_f32_16x16x32_bf16 v[28:31], v[84:87], v[76:79], v[28:31]
    ds_read_b64_tr_b16 v[108:109], v115 offset:61440
    ds_read_b64_tr_b16 v[110:111], v115 offset:63488
    v_mfma_f32_16x16x32_bf16 v[16:19], v[88:91], v[72:75], v[16:19]
    v_mfma_f32_16x16x32_bf16 v[32:35], v[88:91], v[76:79], v[32:35]
    s_waitcnt vmcnt(0)
    v_max3_u32 v2, v40, v41, v42
    v_mfma_f32_16x16x32_bf16 v[20:23], v[92:95], v[72:75], v[20:23]
    v_max3_u32 v2, v2, v43, v44
    v_max3_u32 v2, v2, v45, v46
    v_mfma_f32_16x16x32_bf16 v[36:39], v[92:95], v[76:79], v[36:39]
    v_max_u32 v2, v2, v47
    v_cmp_eq_u32_e64 vcc, -1, v2
    s_cbranch_vccnz L_r15
L_g15:
    s_waitcnt lgkmcnt(0)
    v_mfma_f32_16x16x32_bf16 v[8:11], v[96:99], v[40:43], v[8:11]
    v_mfma_f32_16x16x32_bf16 v[24:27], v[96:99], v[44:47], v[24:27]
    v_mfma_f32_16x16x32_bf16 v[12:15], v[100:103], v[40:43], v[12:15]
    v_mfma_f32_16x16x32_bf16 v[28:31], v[100:103], v[44:47], v[28:31]
    v_mfma_f32_16x16x32_bf16 v[16:19], v[104:107], v[40:43], v[16:19]
    v_mfma_f32_16x16x32_bf16 v[32:35], v[104:107], v[44:47], v[32:35]
    v_mfma_f32_16x16x32_bf16 v[20:23], v[108:111], v[40:43], v[20:23]
    v_mfma_f32_16x16x32_bf16 v[36:39], v[108:111], v[44:47], v[36:39]
    s_cmp_eq_u32 s83, 0
    s_cbranch_scc1 L_fx2
L_fx2r:
    s_lshl_b32 s3, s39, 12
    s_add_u32 s3, s3, 131072
    v_lshlrev_b32 v2, 4, v1
    v_add_u32_e64 v2, s3, v2
    v_xor_b32 v3, 0x4000, v2
    s_xor_b32 s28, s3, 0x4000
    ds_write_b128 v2, v[24:27] offset:0
    ds_write_b128 v2, v[28:31] offset:1024
    ds_write_b128 v2, v[32:35] offset:2048
    ds_write_b128 v2, v[36:39] offset:3072
    v_lshlrev_b32 v40, 16, v240
    v_and_b32 v41, 0xffff0000, v240
    v_lshlrev_b32 v42, 16, v241
    v_and_b32 v43, 0xffff0000, v241
    v_lshlrev_b32 v44, 16, v242
    v_and_b32 v45, 0xffff0000, v242
    v_lshlrev_b32 v46, 16, v243
    v_and_b32 v47, 0xffff0000, v243
    v_lshlrev_b32 v48, 16, v244
    v_and_b32 v49, 0xffff0000, v244
    v_lshlrev_b32 v50, 16, v245
    v_and_b32 v51, 0xffff0000, v245
    v_lshlrev_b32 v52, 16, v246
    v_and_b32 v53, 0xffff0000, v246
    v_lshlrev_b32 v54, 16, v247
    v_and_b32 v55, 0xffff0000, v247
    v_and_b32 v4, 15, v1
    v_lshrrev_b32 v5, 4, v1
    v_lshlrev_b32 v6, 1, v4
    v_and_b32 v6, 14, v6
    v_xor_b32_e64 v5, v5, v6
    v_lshl_add_u32 v4, v4, 7, s28
    v_lshl_add_u32 v4, v5, 3, v4
    v_lshrrev_b32 v5, 3, v1
    v_and_b32 v6, 7, v1
    v_xor_b32_e64 v7, v6, v5
    v_lshl_add_u32 v7, v7, 4, s28
    v_lshl_add_u32 v7, v5, 7, v7
    s_lshl_b32 s3, s34, 7
    s_add_u32 s3, s3, s69
    v_add_u32 v5, s3, v5
    v_lshlrev_b32 v5, 11, v5
    v_lshl_add_u32 v5, v6, 4, v5
    s_lshl_b32 s3, s35, 7
    s_add_u32 s28, s3, 16384
    s_lshl_b32 s29, s34, 7
    s_add_u32 s29, s29, s69
    s_andn2_b32 s77, s68, 15
    s_cmp_lg_u32 s29, s77
    s_waitcnt lgkmcnt(0)
    s_barrier
    s_cbranch_scc1 L_nov
    v_and_b32 v2, 48, v1
    s_and_b32 s29, s68, 15
    s_lshl_b32 exec_lo, 0x00010001, s29
    s_mov_b32 exec_hi, exec_lo
    ds_read_b128 v[224:227], v2 offset:0
    ds_read_b128 v[228:231], v2 offset:64
    ds_read_b128 v[232:235], v2 offset:128
    ds_read_b128 v[236:239], v2 offset:192
    s_mov_b64 exec, -1
L_nov:
    ds_read_b128 v[24:27], v3 offset:0
    ds_read_b128 v[28:31], v3 offset:1024
    ds_read_b128 v[32:35], v3 offset:2048
    ds_read_b128 v[36:39], v3 offset:3072
    s_waitcnt lgkmcnt(3)
    s_nop 0
    v_pk_add_f32 v[8:9], v[8:9], v[24:25]
    v_pk_add_f32 v[10:11], v[10:11], v[26:27]
    v_pk_fma_f32 v[40:41], v[8:9], v[224:225], v[40:41]
    v_pk_fma_f32 v[42:43], v[10:11], v[226:227], v[42:43]
    v_cvt_pk_bf16_f32 v8, v40, v41
    v_cvt_pk_bf16_f32 v9, v42, v43
    s_waitcnt lgkmcnt(2)
    s_nop 0
    v_pk_add_f32 v[12:13], v[12:13], v[28:29]
    v_pk_add_f32 v[14:15], v[14:15], v[30:31]
    v_pk_fma_f32 v[44:45], v[12:13], v[228:229], v[44:45]
    v_pk_fma_f32 v[46:47], v[14:15], v[230:231], v[46:47]
    v_cvt_pk_bf16_f32 v10, v44, v45
    v_cvt_pk_bf16_f32 v11, v46, v47
    s_waitcnt lgkmcnt(1)
    s_nop 0
    v_pk_add_f32 v[16:17], v[16:17], v[32:33]
    v_pk_add_f32 v[18:19], v[18:19], v[34:35]
    v_pk_fma_f32 v[48:49], v[16:17], v[232:233], v[48:49]
    v_pk_fma_f32 v[50:51], v[18:19], v[234:235], v[50:51]
    v_cvt_pk_bf16_f32 v12, v48, v49
    v_cvt_pk_bf16_f32 v13, v50, v51
    s_waitcnt lgkmcnt(0)
    s_nop 0
    v_pk_add_f32 v[20:21], v[20:21], v[36:37]
    v_pk_add_f32 v[22:23], v[22:23], v[38:39]
    v_pk_fma_f32 v[52:53], v[20:21], v[236:237], v[52:53]
    v_pk_fma_f32 v[54:55], v[22:23], v[238:239], v[54:55]
    v_cvt_pk_bf16_f32 v14, v52, v53
    v_cvt_pk_bf16_f32 v15, v54, v55
    ds_write_b64 v4, v[8:9]
    v_xor_b32 v6, 32, v4
    ds_write_b64 v6, v[10:11]
    v_xor_b32 v6, 64, v4
    ds_write_b64 v6, v[12:13]
    v_xor_b32 v6, 96, v4
    ds_write_b64 v6, v[14:15]
    ds_read_b128 v[24:27], v7 offset:0
    ds_read_b128 v[28:31], v7 offset:1024
    s_waitcnt lgkmcnt(1)
    buffer_store_dwordx4 v[24:27], v5, s[56:59], s3 offen sc1
    s_waitcnt lgkmcnt(0)
    buffer_store_dwordx4 v[28:31], v5, s[56:59], s28 offen sc1
L_done:
    s_endpgm
L_fx1:
    s_lshl_b32 s78, s35, 14
    s_add_u32 s78, s78, 1413120
    v_and_b32 v2, 15, v1
    v_lshrrev_b32 v3, 4, v1
    v_lshl_add_u32 v193, v2, 2, v3
    v_and_b32 v2, 7, v193
    v_lshrrev_b32 v193, 3, v193
    v_lshl_add_u32 v193, v2, 3, v193
    v_lshlrev_b32 v2, 1, v193
    s_lshl_b32 s3, s68, 11
    s_lshl_b32 s28, s35, 7
    s_add_u32 s3, s3, s28
    buffer_load_ushort v194, v2, s[40:43], s3 offen
    s_add_u32 s3, s78, 0
    s_nop 0
    buffer_load_dwordx4 v[128:131], v222, s[48:51], s3 offen offset:0 sc1
    buffer_load_dwordx4 v[132:135], v222, s[48:51], s3 offen offset:1024 sc1
    buffer_load_dwordx4 v[136:139], v222, s[48:51], s3 offen offset:2048 sc1
    buffer_load_dwordx4 v[140:143], v222, s[48:51], s3 offen offset:3072 sc1
    s_add_u32 s3, s78, 4096
    buffer_load_dwordx4 v[144:147], v222, s[48:51], s3 offen offset:0 sc1
    buffer_load_dwordx4 v[148:151], v222, s[48:51], s3 offen offset:1024 sc1
    buffer_load_dwordx4 v[152:155], v222, s[48:51], s3 offen offset:2048 sc1
    buffer_load_dwordx4 v[156:159], v222, s[48:51], s3 offen offset:3072 sc1
    s_add_u32 s3, s78, 8192
    buffer_load_dwordx4 v[160:163], v222, s[48:51], s3 offen offset:0 sc1
    buffer_load_dwordx4 v[164:167], v222, s[48:51], s3 offen offset:1024 sc1
    buffer_load_dwordx4 v[168:171], v222, s[48:51], s3 offen offset:2048 sc1
    buffer_load_dwordx4 v[172:175], v222, s[48:51], s3 offen offset:3072 sc1
    s_add_u32 s3, s78, 12288
    buffer_load_dwordx4 v[176:179], v222, s[48:51], s3 offen offset:0 sc1
    buffer_load_dwordx4 v[180:183], v222, s[48:51], s3 offen offset:1024 sc1
    buffer_load_dwordx4 v[184:187], v222, s[48:51], s3 offen offset:2048 sc1
    buffer_load_dwordx4 v[188:191], v222, s[48:51], s3 offen offset:3072 sc1
    s_branch L_fx1r
L_fx2:
    s_and_b32 s3, s70, 0xffff0000
    s_xor_b32 s28, s3, 0x80000000
    s_not_b32 s29, s3
    s_and_b32 s29, s29, 0xffff0000
    s_bitcmp1_b32 s3, 31
    s_cselect_b32 s3, s28, s29
    v_mov_b32 v195, s3
    v_mul_f32 v195, 0xbfb8aa3b, v195
    v_exp_f32 v195, v195
    s_nop 0
    v_add_f32 v195, 1.0, v195
    v_rcp_f32 v195, v195
    s_nop 0
    v_cvt_pk_bf16_f32 v195, v195, v195
    v_lshlrev_b32 v195, 16, v195
    s_mov_b32 s29, 0
L_k6:
    v_max3_u32 v2, v128, v129, v130
    v_max3_u32 v2, v2, v131, v132
    v_max3_u32 v2, v2, v133, v134
    v_max3_u32 v2, v2, v135, v136
    v_max3_u32 v2, v2, v137, v138
    v_max3_u32 v2, v2, v139, v140
    v_max3_u32 v2, v2, v141, v142
    v_max3_u32 v2, v2, v143, v144
    v_max3_u32 v2, v2, v145, v146
    v_max3_u32 v2, v2, v147, v148
    v_max3_u32 v2, v2, v149, v150
    v_max3_u32 v2, v2, v151, v152
    v_max3_u32 v2, v2, v153, v154
    v_max3_u32 v2, v2, v155, v156
    v_max3_u32 v2, v2, v157, v158
    v_max3_u32 v2, v2, v159, v160
    v_max3_u32 v2, v2, v161, v162
    v_max3_u32 v2, v2, v163, v164
    v_max3_u32 v2, v2, v165, v166
    v_max3_u32 v2, v2, v167, v168
    v_max3_u32 v2, v2, v169, v170
    v_max3_u32 v2, v2, v171, v172
    v_max3_u32 v2, v2, v173, v174
    v_max3_u32 v2, v2, v175, v176
    v_max3_u32 v2, v2, v177, v178
    v_max3_u32 v2, v2, v179, v180
    v_max3_u32 v2, v2, v181, v182
    v_max3_u32 v2, v2, v183, v184
    v_max3_u32 v2, v2, v185, v186
    v_max3_u32 v2, v2, v187, v188
    v_max3_u32 v2, v2, v189, v190
    v_max_u32 v2, v2, v191
    v_cmp_eq_u32 vcc, -1, v2
    s_cbranch_vccz L_k6k
    s_add_u32 s29, s29, 1
    s_cmp_ge_u32 s29, 200000
    s_cbranch_scc1 L_k6k
    s_sleep 4
    s_add_u32 s3, s78, 0
    s_nop 0
    buffer_load_dwordx4 v[128:131], v222, s[48:51], s3 offen offset:0 sc1
    buffer_load_dwordx4 v[132:135], v222, s[48:51], s3 offen offset:1024 sc1
    buffer_load_dwordx4 v[136:139], v222, s[48:51], s3 offen offset:2048 sc1
    buffer_load_dwordx4 v[140:143], v222, s[48:51], s3 offen offset:3072 sc1
    s_add_u32 s3, s78, 4096
    buffer_load_dwordx4 v[144:147], v222, s[48:51], s3 offen offset:0 sc1
    buffer_load_dwordx4 v[148:151], v222, s[48:51], s3 offen offset:1024 sc1
    buffer_load_dwordx4 v[152:155], v222, s[48:51], s3 offen offset:2048 sc1
    buffer_load_dwordx4 v[156:159], v222, s[48:51], s3 offen offset:3072 sc1
    s_add_u32 s3, s78, 8192
    buffer_load_dwordx4 v[160:163], v222, s[48:51], s3 offen offset:0 sc1
    buffer_load_dwordx4 v[164:167], v222, s[48:51], s3 offen offset:1024 sc1
    buffer_load_dwordx4 v[168:171], v222, s[48:51], s3 offen offset:2048 sc1
    buffer_load_dwordx4 v[172:175], v222, s[48:51], s3 offen offset:3072 sc1
    s_add_u32 s3, s78, 12288
    buffer_load_dwordx4 v[176:179], v222, s[48:51], s3 offen offset:0 sc1
    buffer_load_dwordx4 v[180:183], v222, s[48:51], s3 offen offset:1024 sc1
    buffer_load_dwordx4 v[184:187], v222, s[48:51], s3 offen offset:2048 sc1
    buffer_load_dwordx4 v[188:191], v222, s[48:51], s3 offen offset:3072 sc1
    s_waitcnt vmcnt(0)
    s_branch L_k6
L_k6k:
    v_pk_add_f32 v[128:129], v[128:129], v[160:161]
    v_pk_add_f32 v[130:131], v[130:131], v[162:163]
    v_pk_add_f32 v[132:133], v[132:133], v[164:165]
    v_pk_add_f32 v[134:135], v[134:135], v[166:167]
    v_pk_add_f32 v[136:137], v[136:137], v[168:169]
    v_pk_add_f32 v[138:139], v[138:139], v[170:171]
    v_pk_add_f32 v[140:141], v[140:141], v[172:173]
    v_pk_add_f32 v[142:143], v[142:143], v[174:175]
    v_pk_add_f32 v[144:145], v[144:145], v[176:177]
    v_pk_add_f32 v[146:147], v[146:147], v[178:179]
    v_pk_add_f32 v[148:149], v[148:149], v[180:181]
    v_pk_add_f32 v[150:151], v[150:151], v[182:183]
    v_pk_add_f32 v[152:153], v[152:153], v[184:185]
    v_pk_add_f32 v[154:155], v[154:155], v[186:187]
    v_pk_add_f32 v[156:157], v[156:157], v[188:189]
    v_pk_add_f32 v[158:159], v[158:159], v[190:191]
    v_pk_add_f32 v[128:129], v[128:129], v[144:145]
    v_pk_add_f32 v[130:131], v[130:131], v[146:147]
    v_pk_add_f32 v[132:133], v[132:133], v[148:149]
    v_pk_add_f32 v[134:135], v[134:135], v[150:151]
    v_pk_add_f32 v[136:137], v[136:137], v[152:153]
    v_pk_add_f32 v[138:139], v[138:139], v[154:155]
    v_pk_add_f32 v[140:141], v[140:141], v[156:157]
    v_pk_add_f32 v[142:143], v[142:143], v[158:159]
    v_pk_add_f32 v[128:129], v[128:129], v[136:137]
    v_pk_add_f32 v[130:131], v[130:131], v[138:139]
    v_pk_add_f32 v[132:133], v[132:133], v[140:141]
    v_pk_add_f32 v[134:135], v[134:135], v[142:143]
    v_pk_add_f32 v[128:129], v[128:129], v[132:133]
    v_pk_add_f32 v[130:131], v[130:131], v[134:135]
    s_nop 1
    v_permlane32_swap_b32 v128, v130
    v_permlane32_swap_b32 v129, v131
    v_add_f32 v128, v128, v130
    v_add_f32 v129, v129, v131
    s_nop 1
    v_permlane16_swap_b32 v128, v129
    v_add_f32 v128, v128, v129
    v_cvt_pk_bf16_f32 v128, v128, v128
    v_lshlrev_b32 v128, 16, v128
    v_mul_f32 v128, v128, v195
    v_lshlrev_b32 v194, 16, v194
    v_sub_f32 v194, v194, v250
    v_cvt_pk_bf16_f32 v128, v128, v128
    v_lshlrev_b32 v128, 16, v128
    v_cvt_pk_bf16_f32 v194, v194, v194
    v_lshlrev_b32 v194, 16, v194
    v_mul_f32 v194, v194, v251
    v_cvt_pk_bf16_f32 v194, v194, v194
    v_lshlrev_b32 v194, 16, v194
    v_add_f32 v128, v128, v194
    v_cvt_pk_bf16_f32 v128, v128, v128
    v_lshlrev_b32 v128, 16, v128
    v_mul_f32 v2, 0xbfb8aa3b, v128
    v_exp_f32 v2, v2
    s_nop 0
    v_add_f32 v2, 1.0, v2
    v_rcp_f32 v2, v2
    s_nop 0
    v_mul_f32 v2, v128, v2
    v_lshlrev_b32 v3, 2, v193
    ds_write_b32 v3, v2
    s_branch L_fx2r
L_r0:
    s_add_u32 s29, s29, 1
    s_cmp_ge_u32 s29, 200000
    s_cbranch_scc1 L_g0
    s_add_u32 s3, s76, 0
    buffer_load_dwordx4 v[40:43], v116, s[48:51], s3 offen offset:0 sc1
    buffer_load_dwordx4 v[44:47], v117, s[48:51], s3 offen offset:0 sc1
    s_waitcnt vmcnt(0)
    v_max3_u32 v2, v40, v41, v42
    v_max3_u32 v2, v2, v43, v44
    v_max3_u32 v2, v2, v45, v46
    v_max_u32 v2, v2, v47
    v_cmp_eq_u32 vcc, -1, v2
    s_cbranch_vccnz L_r0
    s_branch L_g0
L_r1:
    s_add_u32 s29, s29, 1
    s_cmp_ge_u32 s29, 200000
    s_cbranch_scc1 L_g1
    s_add_u32 s3, s76, 0
    buffer_load_dwordx4 v[48:51], v116, s[48:51], s3 offen offset:1024 sc1
    buffer_load_dwordx4 v[52:55], v117, s[48:51], s3 offen offset:1024 sc1
    s_waitcnt vmcnt(0)
    v_max3_u32 v2, v48, v49, v50
    v_max3_u32 v2, v2, v51, v52
    v_max3_u32 v2, v2, v53, v54
    v_max_u32 v2, v2, v55
    v_cmp_eq_u32 vcc, -1, v2
    s_cbranch_vccnz L_r1
    s_branch L_g1
L_r2:
    s_add_u32 s29, s29, 1
    s_cmp_ge_u32 s29, 200000
    s_cbranch_scc1 L_g2
    s_add_u32 s3, s76, 0
    buffer_load_dwordx4 v[56:59], v116, s[48:51], s3 offen offset:2048 sc1
    buffer_load_dwordx4 v[60:63], v117, s[48:51], s3 offen offset:2048 sc1
    s_waitcnt vmcnt(0)
    v_max3_u32 v2, v56, v57, v58
    v_max3_u32 v2, v2, v59, v60
    v_max3_u32 v2, v2, v61, v62
    v_max_u32 v2, v2, v63
    v_cmp_eq_u32 vcc, -1, v2
    s_cbranch_vccnz L_r2
    s_branch L_g2
L_r3:
    s_add_u32 s29, s29, 1
    s_cmp_ge_u32 s29, 200000
    s_cbranch_scc1 L_g3
    s_add_u32 s3, s76, 0
    buffer_load_dwordx4 v[64:67], v116, s[48:51], s3 offen offset:3072 sc1
    buffer_load_dwordx4 v[68:71], v117, s[48:51], s3 offen offset:3072 sc1
    s_waitcnt vmcnt(0)
    v_max3_u32 v2, v64, v65, v66
    v_max3_u32 v2, v2, v67, v68
    v_max3_u32 v2, v2, v69, v70
    v_max_u32 v2, v2, v71
    v_cmp_eq_u32 vcc, -1, v2
    s_cbranch_vccnz L_r3
    s_branch L_g3
L_r4:
    s_add_u32 s29, s29, 1
    s_cmp_ge_u32 s29, 200000
    s_cbranch_scc1 L_g4
    s_add_u32 s3, s76, 4096
    buffer_load_dwordx4 v[72:75], v116, s[48:51], s3 offen offset:0 sc1
    buffer_load_dwordx4 v[76:79], v117, s[48:51], s3 offen offset:0 sc1
    s_waitcnt vmcnt(0)
    v_max3_u32 v2, v72, v73, v74
    v_max3_u32 v2, v2, v75, v76
    v_max3_u32 v2, v2, v77, v78
    v_max_u32 v2, v2, v79
    v_cmp_eq_u32 vcc, -1, v2
    s_cbranch_vccnz L_r4
    s_branch L_g4
L_r5:
    s_add_u32 s29, s29, 1
    s_cmp_ge_u32 s29, 200000
    s_cbranch_scc1 L_g5
    s_add_u32 s3, s76, 4096
    buffer_load_dwordx4 v[40:43], v116, s[48:51], s3 offen offset:1024 sc1
    buffer_load_dwordx4 v[44:47], v117, s[48:51], s3 offen offset:1024 sc1
    s_waitcnt vmcnt(0)
    v_max3_u32 v2, v40, v41, v42
    v_max3_u32 v2, v2, v43, v44
    v_max3_u32 v2, v2, v45, v46
    v_max_u32 v2, v2, v47
    v_cmp_eq_u32 vcc, -1, v2
    s_cbranch_vccnz L_r5
    s_branch L_g5
L_r6:
    s_add_u32 s29, s29, 1
    s_cmp_ge_u32 s29, 200000
    s_cbranch_scc1 L_g6
    s_add_u32 s3, s76, 4096
    buffer_load_dwordx4 v[48:51], v116, s[48:51], s3 offen offset:2048 sc1
    buffer_load_dwordx4 v[52:55], v117, s[48:51], s3 offen offset:2048 sc1
    s_waitcnt vmcnt(0)
    v_max3_u32 v2, v48, v49, v50
    v_max3_u32 v2, v2, v51, v52
    v_max3_u32 v2, v2, v53, v54
    v_max_u32 v2, v2, v55
    v_cmp_eq_u32 vcc, -1, v2
    s_cbranch_vccnz L_r6
    s_branch L_g6
L_r7:
    s_add_u32 s29, s29, 1
    s_cmp_ge_u32 s29, 200000
    s_cbranch_scc1 L_g7
    s_add_u32 s3, s76, 4096
    buffer_load_dwordx4 v[56:59], v116, s[48:51], s3 offen offset:3072 sc1
    buffer_load_dwordx4 v[60:63], v117, s[48:51], s3 offen offset:3072 sc1
    s_waitcnt vmcnt(0)
    v_max3_u32 v2, v56, v57, v58
    v_max3_u32 v2, v2, v59, v60
    v_max3_u32 v2, v2, v61, v62
    v_max_u32 v2, v2, v63
    v_cmp_eq_u32 vcc, -1, v2
    s_cbranch_vccnz L_r7
    s_branch L_g7
L_r8:
    s_add_u32 s29, s29, 1
    s_cmp_ge_u32 s29, 200000
    s_cbranch_scc1 L_g8
    s_add_u32 s3, s76, 8192
    buffer_load_dwordx4 v[64:67], v116, s[48:51], s3 offen offset:0 sc1
    buffer_load_dwordx4 v[68:71], v117, s[48:51], s3 offen offset:0 sc1
    s_waitcnt vmcnt(0)
    v_max3_u32 v2, v64, v65, v66
    v_max3_u32 v2, v2, v67, v68
    v_max3_u32 v2, v2, v69, v70
    v_max_u32 v2, v2, v71
    v_cmp_eq_u32 vcc, -1, v2
    s_cbranch_vccnz L_r8
    s_branch L_g8
L_r9:
    s_add_u32 s29, s29, 1
    s_cmp_ge_u32 s29, 200000
    s_cbranch_scc1 L_g9
    s_add_u32 s3, s76, 8192
    buffer_load_dwordx4 v[72:75], v116, s[48:51], s3 offen offset:1024 sc1
    buffer_load_dwordx4 v[76:79], v117, s[48:51], s3 offen offset:1024 sc1
    s_waitcnt vmcnt(0)
    v_max3_u32 v2, v72, v73, v74
    v_max3_u32 v2, v2, v75, v76
    v_max3_u32 v2, v2, v77, v78
    v_max_u32 v2, v2, v79
    v_cmp_eq_u32 vcc, -1, v2
    s_cbranch_vccnz L_r9
    s_branch L_g9
L_r10:
    s_add_u32 s29, s29, 1
    s_cmp_ge_u32 s29, 200000
    s_cbranch_scc1 L_g10
    s_add_u32 s3, s76, 8192
    buffer_load_dwordx4 v[40:43], v116, s[48:51], s3 offen offset:2048 sc1
    buffer_load_dwordx4 v[44:47], v117, s[48:51], s3 offen offset:2048 sc1
    s_waitcnt vmcnt(0)
    v_max3_u32 v2, v40, v41, v42
    v_max3_u32 v2, v2, v43, v44
    v_max3_u32 v2, v2, v45, v46
    v_max_u32 v2, v2, v47
    v_cmp_eq_u32 vcc, -1, v2
    s_cbranch_vccnz L_r10
    s_branch L_g10
L_r11:
    s_add_u32 s29, s29, 1
    s_cmp_ge_u32 s29, 200000
    s_cbranch_scc1 L_g11
    s_add_u32 s3, s76, 8192
    buffer_load_dwordx4 v[48:51], v116, s[48:51], s3 offen offset:3072 sc1
    buffer_load_dwordx4 v[52:55], v117, s[48:51], s3 offen offset:3072 sc1
    s_waitcnt vmcnt(0)
    v_max3_u32 v2, v48, v49, v50
    v_max3_u32 v2, v2, v51, v52
    v_max3_u32 v2, v2, v53, v54
    v_max_u32 v2, v2, v55
    v_cmp_eq_u32 vcc, -1, v2
    s_cbranch_vccnz L_r11
    s_branch L_g11
L_r12:
    s_add_u32 s29, s29, 1
    s_cmp_ge_u32 s29, 200000
    s_cbranch_scc1 L_g12
    s_add_u32 s3, s76, 12288
    buffer_load_dwordx4 v[56:59], v116, s[48:51], s3 offen offset:0 sc1
    buffer_load_dwordx4 v[60:63], v117, s[48:51], s3 offen offset:0 sc1
    s_waitcnt vmcnt(0)
    v_max3_u32 v2, v56, v57, v58
    v_max3_u32 v2, v2, v59, v60
    v_max3_u32 v2, v2, v61, v62
    v_max_u32 v2, v2, v63
    v_cmp_eq_u32 vcc, -1, v2
    s_cbranch_vccnz L_r12
    s_branch L_g12
L_r13:
    s_add_u32 s29, s29, 1
    s_cmp_ge_u32 s29, 200000
    s_cbranch_scc1 L_g13
    s_add_u32 s3, s76, 12288
    buffer_load_dwordx4 v[64:67], v116, s[48:51], s3 offen offset:1024 sc1
    buffer_load_dwordx4 v[68:71], v117, s[48:51], s3 offen offset:1024 sc1
    s_waitcnt vmcnt(0)
    v_max3_u32 v2, v64, v65, v66
    v_max3_u32 v2, v2, v67, v68
    v_max3_u32 v2, v2, v69, v70
    v_max_u32 v2, v2, v71
    v_cmp_eq_u32 vcc, -1, v2
    s_cbranch_vccnz L_r13
    s_branch L_g13
L_r14:
    s_add_u32 s29, s29, 1
    s_cmp_ge_u32 s29, 200000
    s_cbranch_scc1 L_g14
    s_add_u32 s3, s76, 12288
    buffer_load_dwordx4 v[72:75], v116, s[48:51], s3 offen offset:2048 sc1
    buffer_load_dwordx4 v[76:79], v117, s[48:51], s3 offen offset:2048 sc1
    s_waitcnt vmcnt(0)
    v_max3_u32 v2, v72, v73, v74
    v_max3_u32 v2, v2, v75, v76
    v_max3_u32 v2, v2, v77, v78
    v_max_u32 v2, v2, v79
    v_cmp_eq_u32 vcc, -1, v2
    s_cbranch_vccnz L_r14
    s_branch L_g14
L_r15:
    s_add_u32 s29, s29, 1
    s_cmp_ge_u32 s29, 200000
    s_cbranch_scc1 L_g15
    s_add_u32 s3, s76, 12288
    buffer_load_dwordx4 v[40:43], v116, s[48:51], s3 offen offset:3072 sc1
    buffer_load_dwordx4 v[44:47], v117, s[48:51], s3 offen offset:3072 sc1
    s_waitcnt vmcnt(0)
    v_max3_u32 v2, v40, v41, v42
    v_max3_u32 v2, v2, v43, v44
    v_max3_u32 v2, v2, v45, v46
    v_max_u32 v2, v2, v47
    v_cmp_eq_u32 vcc, -1, v2
    s_cbranch_vccnz L_r15
    s_branch L_g15
.p2align 8
.fill 4096, 4, 0xbf800000
.section .rodata,"a"
.p2align 6
.amdhsa_kernel recurrent_scan__linear_kernel_hedgehog__moe_arch_mod__prompt_kernel
  .amdhsa_next_free_vgpr 256
  .amdhsa_next_free_sgpr 102
  .amdhsa_accum_offset 256
  .amdhsa_group_segment_fixed_size 0
  .amdhsa_kernarg_size 96
  .amdhsa_user_sgpr_count 2
  .amdhsa_user_sgpr_kernarg_segment_ptr 1
  .amdhsa_system_sgpr_workgroup_id_x 1
.end_amdhsa_kernel
```

```asm
; @launch grid=(256,1,1) block=(512,1,1) lds=163840
.amdgcn_target "amdgcn-amd-amdhsa--gfx950"
.text
.globl recurrent_scan__linear_kernel_hedgehog__moe_arch_mod__prompt_kernel
.p2align 8
.type recurrent_scan__linear_kernel_hedgehog__moe_arch_mod__prompt_kernel,@function
recurrent_scan__linear_kernel_hedgehog__moe_arch_mod__prompt_kernel:
    s_cmp_ge_u32 s2, 256
    s_cbranch_scc1 L_done
    s_load_dwordx16 s[4:19], s[0:1], 0
    s_load_dwordx8 s[20:27], s[0:1], 64
    v_and_b32 v1, 63, v0
    v_lshrrev_b32 v2, 6, v0
    s_nop 0
    v_readfirstlane_b32 s39, v2
    s_and_b32 s34, s2, 1
    s_lshl_b32 s34, s34, 3
    s_bfe_u32 s3, s2, 0x30003
    s_add_u32 s36, s34, s3
    s_bfe_u32 s37, s2, 0x20001
    s_lshl_b32 s37, s37, 2
    s_lshr_b32 s28, s2, 6
    s_add_u32 s37, s37, s28
    s_and_b32 s80, s37, 12
    s_xor_b32 s80, s80, s34
    s_add_u32 s85, s36, s37
    s_and_b32 s85, s85, 3
    s_add_u32 s3, s85, 3
    s_and_b32 s3, s3, 3
    s_xor_b32 s35, s80, 12
    s_or_b32 s35, s35, s3
    s_mov_b32 s34, s36
    s_and_b32 s38, s39, 3
    s_cmp_lt_u32 s39, 4
    s_cbranch_scc1 L_C
L_H:
    v_and_b32 v4, 7, v1
    s_lshl_b32 s33, s37, 7
    s_lshl_b32 s87, s85, 7
    s_lshl_b32 s66, s80, 7
    s_lshl_b32 s3, s36, 7
    s_lshl_b32 s28, s38, 5
    s_add_u32 s3, s3, s28
    v_lshrrev_b32 v7, 3, v1
    v_add_u32 v3, s3, v7
    v_lshlrev_b32 v3, 11, v3
    v_lshrrev_b32 v5, 4, v1
    v_xor_b32 v6, v4, v5
    v_xor_b32 v5, 4, v6
    v_lshl_add_u32 v6, v6, 4, v3
    v_lshl_add_u32 v5, v5, 4, v3
    v_add_u32_e64 v8, 0, v6
    v_add_u32 v9, 15360, v5
    v_add_u32 v10, 30720, v6
    v_add_u32 v11, 46080, v5
    s_lshr_b32 s32, s36, 1
    s_and_b32 s32, s32, 2
    s_xor_b32 s32, s32, s38
    s_lshl_b32 s3, s32, 4
    v_add_u32_e64 v7, s3, v7
    v_mul_u32_u24 v7, 6144, v7
    v_bfe_u32 v6, v1, 4, 1
    v_lshlrev_b32 v6, 1, v6
    v_xor_b32 v5, v4, v6
    v_add_u32 v7, s33, v7
    v_xor_b32 v6, 4, v5
    v_lshl_add_u32 v6, v6, 4, v7
    v_lshl_add_u32 v7, v5, 4, v7
    v_add_u32_e64 v12, 0, v7
    v_add_u32 v13, 48128, v6
    v_add_u32 v14, 2048, v7
    v_add_u32 v15, 50176, v6
    v_add_u32 v16, 4096, v7
    v_add_u32 v17, 52224, v6
    v_xor_b32 v12, 512, v12
    v_xor_b32 v13, 512, v13
    s_lshl_b32 s30, s38, 12
    s_lshl_b32 s31, s32, 11
    s_add_u32 s31, s31, 16384
    s_waitcnt lgkmcnt(0)
    s_mov_b32 s44, s6
    s_mov_b32 s45, s7
    s_mov_b32 s46, 6291456
    s_mov_b32 s47, 0x00020000
    s_mov_b32 s40, s4
    s_mov_b32 s41, s5
    s_mov_b32 s42, 4194304
    s_mov_b32 s43, 0x00020000
    v_lshlrev_b32 v252, 4, v1
    s_mov_b32 s48, s26
    s_mov_b32 s49, s27
    s_mov_b32 s50, 268435456
    s_mov_b32 s51, 0x00020000
    v_mov_b32 v19, 16384
    buffer_load_dword v19, v19, s[48:51], 0 offen sc1
    s_lshl_b32 s3, s36, 7
    s_lshl_b32 s28, s37, 3
    s_add_u32 s3, s3, s28
    s_lshl_b32 s3, s3, 11
    s_add_u32 s3, s3, s30
    s_add_u32 m0, s30, 131072
    s_nop 0
    buffer_load_dwordx4 v252, s[40:43], s3 offen offset:0 lds
    buffer_load_dwordx4 v252, s[40:43], s3 offen offset:2048 lds
    s_lshl_b32 s3, s36, 7
    s_lshl_b32 s28, s37, 3
    s_add_u32 s3, s3, s28
    s_lshl_b32 s3, s3, 11
    s_add_u32 s3, s3, s30
    s_add_u32 m0, s30, 131072
    s_nop 0
    buffer_load_dwordx4 v252, s[40:43], s3 offen offset:1024 lds
    buffer_load_dwordx4 v252, s[40:43], s3 offen offset:3072 lds
    s_mov_b32 s60, s14
    s_mov_b32 s61, s15
    s_mov_b32 s62, 2048
    s_mov_b32 s63, 0x00020000
    s_lshl_b32 s3, s38, 9
    s_add_u32 m0, s3, 122880
    s_mov_b32 exec_hi, 0
    buffer_load_dwordx4 v252, s[60:63], s3 offen lds
    s_mov_b64 exec, -1
    s_add_u32 s64, s87, 0
    s_and_b32 s64, s64, 511
    s_or_b32 s64, s64, 0
    s_xor_b32 s64, s64, s66
    s_mul_i32 s65, s64, 3072
    s_add_u32 m0, s31, 0
    s_nop 0
    buffer_load_dwordx4 v12, s[44:47], s65 offen offset:0 lds
    buffer_load_dwordx4 v13, s[44:47], s65 offen offset:1024 lds
    s_add_u32 m0, s31, 8192
    s_nop 0
    buffer_load_dwordx4 v14, s[44:47], s65 offen offset:0 lds
    buffer_load_dwordx4 v15, s[44:47], s65 offen offset:1024 lds
    s_add_u32 m0, s31, 16384
    s_nop 0
    buffer_load_dwordx4 v16, s[44:47], s65 offen offset:0 lds
    buffer_load_dwordx4 v17, s[44:47], s65 offen offset:1024 lds
    v_mov_b32 v248, -1
    v_mov_b32 v249, -1
    v_mov_b32 v250, -1
    v_mov_b32 v251, -1
    v_lshlrev_b32 v252, 4, v1
    s_and_b32 s85, s85, 0
    s_lshl_b32 s3, s37, 4
    s_add_u32 s3, s3, s36
    s_lshl_b32 s67, s3, 10
    s_add_u32 s67, s67, 524288
    s_lshl_b32 s3, s38, 8
    s_add_u32 s67, s67, s3
    v_mov_b32 v24, 0
    v_mov_b32 v25, 0
    v_mov_b32 v26, 0
    v_mov_b32 v27, 0
    v_mov_b32 v28, 0
    v_mov_b32 v29, 0
    v_mov_b32 v30, 0
    v_mov_b32 v31, 0
    v_lshlrev_b32 v253, 2, v1
    s_cmp_gt_u32 s37, 3
    s_subb_u32 s77, s37, 0
    s_cmp_gt_u32 s37, 11
    s_subb_u32 s77, s77, 0
    s_lshl_b32 s77, s77, 4
    s_add_u32 s77, s77, s36
    s_and_b32 s3, s37, 7
    s_cmp_eq_u32 s3, 3
    s_cselect_b32 s77, 224, s77
    s_bitcmp1_b32 s38, 0
    s_cselect_b32 s52, s18, s16
    s_cselect_b32 s53, s19, s17
    s_cmp_lt_u32 s77, 224
    s_cselect_b32 s54, 7340032, 0
    s_mov_b32 s55, 0x00020000
    s_mov_b32 s56, s20
    s_mov_b32 s57, s21
    s_mov_b32 s58, 7340032
    s_mov_b32 s59, 0x00020000
    s_and_b32 s3, s77, 3
    s_lshl_b32 s3, s3, 8
    s_lshr_b32 s28, s38, 1
    s_lshl_b32 s28, s28, 7
    s_add_u32 s3, s3, s28
    v_lshrrev_b32_e64 v5, 3, v1
    v_lshl_add_u32 v6, v5, 4, s3
    v_mul_u32_u24 v6, 7168, v6
    v_lshl_add_u32 v6, v4, 4, v6
    s_lshr_b32 s3, s77, 2
    s_lshl_b32 s3, s3, 7
    v_add_u32 v21, s3, v6
    s_lshr_b32 s3, s2, 4
    s_mul_i32 s3, s3, 224
    s_mul_i32 s28, s38, 56
    s_add_u32 s71, s3, s28
    v_lshlrev_b32 v6, 14, v5
    v_lshl_add_u32 v6, v4, 4, v6
    s_and_b32 s3, s2, 15
    s_lshl_b32 s3, s3, 7
    v_add_u32 v22, s3, v6
    v_lshrrev_b32 v2, 2, v1
    v_and_b32 v3, 3, v1
    v_lshlrev_b32 v3, 4, v3
    v_lshl_add_u32 v232, v2, 10, v3
    v_lshlrev_b32 v2, 3, v1
    v_add_u32 v230, 152064, v2
    v_and_b32_e64 v4, 49, v1
    v_bfe_u32 v7, v1, 1, 2
    v_lshl_add_u32 v4, v7, 2, v4
    v_bfe_u32 v7, v1, 3, 1
    v_lshl_add_u32 v4, v7, 1, v4
    v_lshlrev_b32 v4, 2, v4
    v_add_u32 v231, 154624, v4
    s_mul_i32 s3, s38, 48
    v_and_b32 v2, 15, v1
    v_lshrrev_b32 v3, 4, v1
    v_cmp_gt_u32 vcc, 12, v2
    v_lshl_add_u32 v4, v2, 2, s3
    v_add_u32 v2, v4, v3
    v_mov_b32 v5, 192
    v_cndmask_b32 v4, v5, v4, vcc
    v_lshlrev_b32 v4, 2, v4
    v_lshl_add_u32 v235, v3, 10, v4
    v_and_b32_e64 v5, 7, v2
    v_bfe_u32 v6, v2, 3, 3
    v_lshl_add_u32 v5, v5, 3, v6
    v_and_b32 v2, 0xc0, v2
    v_add_u32 v2, v2, v5
    v_lshlrev_b32 v2, 2, v2
    v_add_u32 v2, 154880, v2
    v_mov_b32 v5, 162048
    v_cndmask_b32 v233, v5, v2, vcc
    v_lshrrev_b32 v5, 3, v1
    v_lshlrev_b32 v6, 11, v5
    v_bfe_u32 v5, v1, 4, 2
    v_lshlrev_b32 v5, 1, v5
    v_and_b32 v7, 7, v1
    v_xor_b32 v5, v5, v7
    v_lshl_add_u32 v6, v5, 4, v6
    s_lshl_b32 s3, s35, 7
    v_add_u32 v6, s3, v6
    v_add_u32_e64 v220, 0, v6
    v_add_u32 v221, 15360, v6
    v_add_u32 v222, 30720, v6
    v_add_u32 v223, 46080, v6
    s_lshl_b32 s72, s38, 12
    s_lshl_b32 s73, s38, 16
    s_lshl_b32 s3, s36, 2
    s_add_u32 s3, s3, s38
    s_lshr_b32 s28, s3, 5
    s_and_b32 s3, s3, 31
    s_lshl_b32 s74, s3, 7
    s_lshl_b32 s3, s37, 1
    s_add_u32 s75, s3, s28
    v_lshrrev_b32 v5, 3, v1
    v_mul_u32_u24 v5, 4224, v5
    v_and_b32_e64 v7, 7, v1
    v_lshl_add_u32 v112, v7, 4, v5
    s_mul_i32 s76, s75, 67584
    s_add_u32 s76, s76, s74
    s_add_u32 s76, s76, 8388608
    s_mul_i32 s3, s75, 4224
    s_add_u32 s3, s3, s74
    s_add_u32 s74, s3, 1048576
    s_lshl_b32 s75, s37, 1
    s_add_u32 s75, s75, s36
    s_mul_i32 s81, s75, 67584
    s_add_u32 s81, s81, 8392704
    s_mul_i32 s82, s75, 4224
    s_add_u32 s82, s82, 1052672
    s_lshr_b32 s3, s36, 1
    s_or_b32 s83, s3, s38
    s_and_b32 s3, s38, 1
    s_lshl_b32 s3, s3, 3
    s_and_b32 s28, s77, 3
    s_lshl_b32 s28, s28, 1
    s_add_u32 s3, s3, s28
    s_lshr_b32 s28, s38, 1
    s_add_u32 s3, s3, s28
    s_mul_i32 s3, s3, 14336
    s_lshr_b32 s28, s77, 2
    s_lshl_b32 s28, s28, 8
    s_add_u32 s3, s3, s28
    s_add_u32 s3, s3, 1183744
    s_cmp_lt_u32 s77, 224
    s_cselect_b32 s84, s3, 268435456
    v_and_b32 v2, 15, v1
    v_bfe_u32 v3, v1, 4, 1
    v_mul_u32_u24 v3, 4, v3
    v_xor_b32_e64 v3, s37, v3
    v_lshl_add_u32 v3, v3, 4, v2
    v_lshl_add_u32 v2, v2, 4, s34
    v_cmp_gt_u32 vcc, 32, v1
    s_nop 1
    v_cndmask_b32 v2, v2, v3, vcc
    v_lshlrev_b32 v113, 7, v2
    s_lshl_b32 s3, s38, 1
    s_lshr_b32 s28, s39, 2
    s_add_u32 s3, s3, s28
    s_lshl_b32 s69, s3, 4
    v_and_b32 v2, 15, v1
    v_add_u32 v23, s69, v2
    v_lshlrev_b32 v23, 7, v23
    v_lshrrev_b32 v2, 1, v2
    v_lshrrev_b32 v3, 5, v1
    v_xor_b32 v2, v2, v3
    v_lshl_add_u32 v23, v2, 4, v23
    v_bfe_u32 v3, v1, 4, 1
    v_lshl_add_u32 v23, v3, 3, v23
    v_bfe_u32 v5, v1, 4, 1
    v_lshlrev_b32 v5, 5, v5
    v_xor_b32 v5, v5, v252
    s_min_u32 s3, s38, 2
    s_lshl_b32 s3, s3, 13
    s_and_b32 s28, s36, 4
    s_lshl_b32 s28, s28, 10
    s_add_u32 s3, s3, s28
    s_add_u32 s3, s3, 16384
    v_add_u32 v18, s3, v5
    s_lshr_b32 s3, s38, 1
    s_lshl_b32 s28, s37, 1
    s_add_u32 s28, s28, s3
    s_and_b32 s29, s38, 1
    s_lshl_b32 s3, s28, 4
    s_add_u32 s3, s3, s36
    s_mul_i32 s3, s3, 4224
    s_mul_i32 s78, s29, 2112
    s_add_u32 s78, s78, s3
    s_add_u32 s78, s78, 8388608
    s_lshl_b32 s3, s36, 1
    s_add_u32 s29, s29, s3
    s_xor_b32 s28, s28, 8
    s_lshl_b32 s3, s29, 7
    s_add_u32 s3, s3, s28
    s_lshl_b32 s3, s3, 10
    s_add_u32 s79, s3, 4194304
    s_mov_b32 s88, s10
    s_mov_b32 s89, s11
    s_mov_b32 s90, 2097152
    s_mov_b32 s91, 0x00020000
    s_add_u32 s64, s87, 0
    s_and_b32 s64, s64, 511
    s_or_b32 s64, s64, 0
    s_xor_b32 s64, s64, s66
    s_mul_i32 s65, s64, 3072
    s_add_u32 m0, s30, 0
    s_nop 0
    buffer_load_dwordx4 v8, s[40:43], s64 offen offset:0 lds
    buffer_load_dwordx4 v9, s[40:43], s64 offen offset:1024 lds
    buffer_load_dwordx4 v10, s[40:43], s64 offen offset:2048 lds
    buffer_load_dwordx4 v11, s[40:43], s64 offen offset:3072 lds
    s_waitcnt vmcnt(10)
    s_barrier
    s_add_u32 s64, s87, 128
    s_and_b32 s64, s64, 511
    s_or_b32 s64, s64, 0
    s_xor_b32 s64, s64, s66
    s_mul_i32 s65, s64, 3072
    s_add_u32 m0, s30, 40960
    s_nop 0
    buffer_load_dwordx4 v8, s[40:43], s64 offen offset:0 lds
    buffer_load_dwordx4 v9, s[40:43], s64 offen offset:1024 lds
    buffer_load_dwordx4 v10, s[40:43], s64 offen offset:2048 lds
    buffer_load_dwordx4 v11, s[40:43], s64 offen offset:3072 lds
    s_add_u32 m0, s31, 40960
    s_nop 0
    buffer_load_dwordx4 v12, s[44:47], s65 offen offset:0 lds
    buffer_load_dwordx4 v13, s[44:47], s65 offen offset:1024 lds
    s_add_u32 m0, s31, 49152
    s_nop 0
    buffer_load_dwordx4 v14, s[44:47], s65 offen offset:0 lds
    buffer_load_dwordx4 v15, s[44:47], s65 offen offset:1024 lds
    s_add_u32 m0, s31, 57344
    s_nop 0
    buffer_load_dwordx4 v16, s[44:47], s65 offen offset:0 lds
    buffer_load_dwordx4 v17, s[44:47], s65 offen offset:1024 lds
    v_readfirstlane_b32 s86, v19
    s_nop 0
    s_mul_i32 s86, s86, 1664525
    s_add_u32 s86, s86, 1013904223
    s_waitcnt vmcnt(10)
    s_waitcnt lgkmcnt(0)
    s_barrier
    v_add_u32 v2, 0, v18
    v_xor_b32_e64 v3, 64, v2
    ds_read_b128 v[32:35], v2 offset:0
    ds_read_b128 v[36:39], v3 offset:1024
    ds_read_b128 v[40:43], v2 offset:2048
    ds_read_b128 v[44:47], v3 offset:3072
    s_add_u32 s64, s87, 256
    s_and_b32 s64, s64, 511
    s_or_b32 s64, s64, 0
    s_xor_b32 s64, s64, s66
    s_mul_i32 s65, s64, 3072
    s_add_u32 m0, s30, 81920
    s_nop 0
    buffer_load_dwordx4 v8, s[40:43], s64 offen offset:0 lds
    buffer_load_dwordx4 v9, s[40:43], s64 offen offset:1024 lds
    buffer_load_dwordx4 v10, s[40:43], s64 offen offset:2048 lds
    buffer_load_dwordx4 v11, s[40:43], s64 offen offset:3072 lds
    s_add_u32 m0, s31, 81920
    s_nop 0
    buffer_load_dwordx4 v12, s[44:47], s65 offen offset:0 lds
    buffer_load_dwordx4 v13, s[44:47], s65 offen offset:1024 lds
    s_add_u32 m0, s31, 90112
    s_nop 0
    buffer_load_dwordx4 v14, s[44:47], s65 offen offset:0 lds
    buffer_load_dwordx4 v15, s[44:47], s65 offen offset:1024 lds
    s_add_u32 m0, s31, 98304
    s_nop 0
    buffer_load_dwordx4 v16, s[44:47], s65 offen offset:0 lds
    buffer_load_dwordx4 v17, s[44:47], s65 offen offset:1024 lds
    buffer_store_dwordx4 v[248:251], v252, s[48:51], s78 offen offset:0 sc1
    s_waitcnt vmcnt(11)
    s_waitcnt lgkmcnt(0)
    s_barrier
    s_add_u32 s64, s87, 384
    s_and_b32 s64, s64, 511
    s_or_b32 s64, s64, 0
    s_xor_b32 s64, s64, s66
    s_mul_i32 s65, s64, 3072
    s_add_u32 m0, s30, 0
    s_nop 0
    buffer_load_dwordx4 v8, s[40:43], s64 offen offset:0 lds
    buffer_load_dwordx4 v9, s[40:43], s64 offen offset:1024 lds
    v_lshlrev_b32 v2, 16, v32
    v_and_b32 v3, 0xffff0000, v32
    v_add_f32 v24, v24, v2
    v_add_f32 v25, v25, v3
    buffer_load_dwordx4 v10, s[40:43], s64 offen offset:2048 lds
    v_lshlrev_b32 v4, 16, v33
    v_and_b32 v5, 0xffff0000, v33
    v_add_f32 v26, v26, v4
    v_add_f32 v27, v27, v5
    buffer_load_dwordx4 v11, s[40:43], s64 offen offset:3072 lds
    v_lshlrev_b32 v2, 16, v34
    v_and_b32 v3, 0xffff0000, v34
    v_add_f32 v28, v28, v2
    v_add_f32 v29, v29, v3
    s_add_u32 m0, s31, 0
    s_nop 0
    buffer_load_dwordx4 v12, s[44:47], s65 offen offset:0 lds
    v_lshlrev_b32 v4, 16, v35
    v_and_b32 v5, 0xffff0000, v35
    v_add_f32 v30, v30, v4
    v_add_f32 v31, v31, v5
    buffer_load_dwordx4 v13, s[44:47], s65 offen offset:1024 lds
    v_lshlrev_b32 v2, 16, v36
    v_and_b32 v3, 0xffff0000, v36
    v_add_f32 v24, v24, v2
    v_add_f32 v25, v25, v3
    s_add_u32 m0, s31, 8192
    s_nop 0
    buffer_load_dwordx4 v14, s[44:47], s65 offen offset:0 lds
    v_lshlrev_b32 v4, 16, v37
    v_and_b32 v5, 0xffff0000, v37
    v_add_f32 v26, v26, v4
    v_add_f32 v27, v27, v5
    buffer_load_dwordx4 v15, s[44:47], s65 offen offset:1024 lds
    v_lshlrev_b32 v2, 16, v38
    v_and_b32 v3, 0xffff0000, v38
    v_add_f32 v28, v28, v2
    v_add_f32 v29, v29, v3
    s_add_u32 m0, s31, 16384
    s_nop 0
    buffer_load_dwordx4 v16, s[44:47], s65 offen offset:0 lds
    v_lshlrev_b32 v4, 16, v39
    v_and_b32 v5, 0xffff0000, v39
    v_add_f32 v30, v30, v4
    v_add_f32_e64 v31, v31, v5
    buffer_load_dwordx4 v17, s[44:47], s65 offen offset:1024 lds
    buffer_store_dwordx4 v[248:251], v252, s[48:51], s78 offen offset:1024 sc1
    s_mov_b64 exec, 15
    buffer_store_dwordx4 v[248:251], v252, s[48:51], s78 offen offset:2048 sc1
    s_mov_b64 exec, -1
    s_waitcnt vmcnt(13)
    s_waitcnt lgkmcnt(0)
    s_barrier
    s_add_u32 s64, s87, 0
    s_and_b32 s64, s64, 511
    s_or_b32 s64, s64, 512
    s_xor_b32 s64, s64, s66
    s_mul_i32 s65, s64, 3072
    s_add_u32 m0, s30, 40960
    s_nop 0
    buffer_load_dwordx4 v8, s[40:43], s64 offen offset:0 lds
    buffer_load_dwordx4 v9, s[40:43], s64 offen offset:1024 lds
    v_lshlrev_b32 v2, 16, v40
    v_and_b32 v3, 0xffff0000, v40
    v_add_f32 v24, v24, v2
    v_add_f32 v25, v25, v3
    buffer_load_dwordx4 v10, s[40:43], s64 offen offset:2048 lds
    v_lshlrev_b32 v4, 16, v41
    v_and_b32 v5, 0xffff0000, v41
    v_add_f32 v26, v26, v4
    v_add_f32 v27, v27, v5
    buffer_load_dwordx4 v11, s[40:43], s64 offen offset:3072 lds
    v_lshlrev_b32 v2, 16, v42
    v_and_b32 v3, 0xffff0000, v42
    v_add_f32 v28, v28, v2
    v_add_f32 v29, v29, v3
    s_add_u32 m0, s31, 40960
    s_nop 0
    buffer_load_dwordx4 v12, s[44:47], s65 offen offset:0 lds
    v_lshlrev_b32 v4, 16, v43
    v_and_b32 v5, 0xffff0000, v43
    v_add_f32 v30, v30, v4
    v_add_f32 v31, v31, v5
    buffer_load_dwordx4 v13, s[44:47], s65 offen offset:1024 lds
    v_lshlrev_b32 v2, 16, v44
    v_and_b32 v3, 0xffff0000, v44
    v_add_f32 v24, v24, v2
    v_add_f32 v25, v25, v3
    s_add_u32 m0, s31, 49152
    s_nop 0
    buffer_load_dwordx4 v14, s[44:47], s65 offen offset:0 lds
    v_lshlrev_b32 v4, 16, v45
    v_and_b32 v5, 0xffff0000, v45
    v_add_f32 v26, v26, v4
    v_add_f32 v27, v27, v5
    buffer_load_dwordx4 v15, s[44:47], s65 offen offset:1024 lds
    v_lshlrev_b32 v2, 16, v46
    v_and_b32 v3, 0xffff0000, v46
    v_add_f32 v28, v28, v2
    v_add_f32 v29, v29, v3
    s_add_u32 m0, s31, 57344
    s_nop 0
    buffer_load_dwordx4 v16, s[44:47], s65 offen offset:0 lds
    v_lshlrev_b32 v4, 16, v47
    v_and_b32 v5, 0xffff0000, v47
    v_add_f32 v30, v30, v4
    v_add_f32 v31, v31, v5
    buffer_load_dwordx4 v17, s[44:47], s65 offen offset:1024 lds
    s_waitcnt vmcnt(12)
    s_waitcnt lgkmcnt(0)
    s_barrier
    s_add_u32 s64, s87, 128
    s_and_b32 s64, s64, 511
    s_or_b32 s64, s64, 512
    s_xor_b32 s64, s64, s66
    s_mul_i32 s65, s64, 3072
    s_add_u32 m0, s30, 81920
    s_nop 0
    buffer_load_dwordx4 v8, s[40:43], s64 offen offset:0 lds
    buffer_load_dwordx4 v9, s[40:43], s64 offen offset:1024 lds
    buffer_load_dwordx4 v10, s[40:43], s64 offen offset:2048 lds
    buffer_load_dwordx4 v11, s[40:43], s64 offen offset:3072 lds
    s_add_u32 m0, s31, 81920
    s_nop 0
    buffer_load_dwordx4 v12, s[44:47], s65 offen offset:0 lds
    buffer_load_dwordx4 v13, s[44:47], s65 offen offset:1024 lds
    s_add_u32 m0, s31, 90112
    s_nop 0
    buffer_load_dwordx4 v14, s[44:47], s65 offen offset:0 lds
    buffer_load_dwordx4 v15, s[44:47], s65 offen offset:1024 lds
    s_add_u32 m0, s31, 98304
    s_nop 0
    buffer_load_dwordx4 v16, s[44:47], s65 offen offset:0 lds
    buffer_load_dwordx4 v17, s[44:47], s65 offen offset:1024 lds
    s_mov_b32 s60, s8
    s_mov_b32 s61, s9
    s_mov_b32 s62, 65536
    s_mov_b32 s63, 0x00020000
    s_lshl_b32 s3, s38, 10
    s_add_u32 m0, s3, 147712
    s_lshl_b32 s28, s37, 12
    s_add_u32 s3, s3, s28
    buffer_load_dwordx4 v252, s[60:63], s3 offen lds
    s_add_u32 m0, m0, 8192
    s_xor_b32 s3, s3, 16384
    buffer_load_dwordx4 v252, s[60:63], s3 offen lds
    s_lshl_b32 s3, s2, 13
    s_lshl_b32 s28, s38, 11
    s_add_u32 s3, s3, s28
    v_lshlrev_b32 v3, 7, v1
    s_mov_b64 exec, 0xffff
    buffer_load_dword v20, v3, s[88:91], s3 offen
    s_mov_b64 exec, -1
    s_mov_b32 s3, 0
    buffer_load_dwordx4 v[128:131], v21, s[52:55], s3 offen nt
    s_mov_b32 s3, 7168
    buffer_load_dwordx4 v[132:135], v21, s[52:55], s3 offen nt
    s_mov_b32 s3, 14336
    buffer_load_dwordx4 v[136:139], v21, s[52:55], s3 offen nt
    s_mov_b32 s3, 21504
    buffer_load_dwordx4 v[140:143], v21, s[52:55], s3 offen nt
    s_waitcnt vmcnt(17)
    s_waitcnt lgkmcnt(0)
    s_barrier
    v_add_u32 v2, 40960, v18
    v_xor_b32 v3, 64, v2
    ds_read_b128 v[48:51], v2 offset:0
    ds_read_b128 v[52:55], v3 offset:1024
    ds_read_b128 v[56:59], v2 offset:2048
    ds_read_b128 v[60:63], v3 offset:3072
    s_add_u32 s64, s87, 256
    s_and_b32 s64, s64, 511
    s_or_b32 s64, s64, 512
    s_xor_b32 s64, s64, s66
    s_mul_i32 s65, s64, 3072
    s_add_u32 m0, s30, 0
    s_nop 0
    buffer_load_dwordx4 v8, s[40:43], s64 offen offset:0 lds
    buffer_load_dwordx4 v9, s[40:43], s64 offen offset:1024 lds
    buffer_load_dwordx4 v10, s[40:43], s64 offen offset:2048 lds
    buffer_load_dwordx4 v11, s[40:43], s64 offen offset:3072 lds
    s_add_u32 m0, s31, 0
    s_nop 0
    buffer_load_dwordx4 v12, s[44:47], s65 offen offset:0 lds
    buffer_load_dwordx4 v13, s[44:47], s65 offen offset:1024 lds
    s_add_u32 m0, s31, 8192
    s_nop 0
    buffer_load_dwordx4 v14, s[44:47], s65 offen offset:0 lds
    buffer_load_dwordx4 v15, s[44:47], s65 offen offset:1024 lds
    s_add_u32 m0, s31, 16384
    s_nop 0
    buffer_load_dwordx4 v16, s[44:47], s65 offen offset:0 lds
    buffer_load_dwordx4 v17, s[44:47], s65 offen offset:1024 lds
    s_lshl_b32 s3, s36, 10
    buffer_load_dwordx4 v[72:75], v252, s[48:51], s3 offen sc1
    s_lshl_b32 s3, s37, 6
    buffer_load_dword v76, v232, s[48:51], s3 offen offset:12 sc1
    s_waitcnt vmcnt(19)
    s_waitcnt lgkmcnt(0)
    s_barrier
    s_add_u32 s64, s87, 384
    s_and_b32 s64, s64, 511
    s_or_b32 s64, s64, 512
    s_xor_b32 s64, s64, s66
    s_mul_i32 s65, s64, 3072
    s_add_u32 m0, s30, 40960
    s_nop 0
    buffer_load_dwordx4 v8, s[40:43], s64 offen offset:0 lds
    buffer_load_dwordx4 v9, s[40:43], s64 offen offset:1024 lds
    v_lshlrev_b32 v2, 16, v48
    v_and_b32 v3, 0xffff0000, v48
    v_add_f32 v24, v24, v2
    v_add_f32 v25, v25, v3
    buffer_load_dwordx4 v10, s[40:43], s64 offen offset:2048 lds
    v_lshlrev_b32 v4, 16, v49
    v_and_b32 v5, 0xffff0000, v49
    v_add_f32 v26, v26, v4
    v_add_f32 v27, v27, v5
    buffer_load_dwordx4 v11, s[40:43], s64 offen offset:3072 lds
    v_lshlrev_b32 v2, 16, v50
    v_and_b32 v3, 0xffff0000, v50
    v_add_f32 v28, v28, v2
    v_add_f32 v29, v29, v3
    s_add_u32 m0, s31, 40960
    s_nop 0
    buffer_load_dwordx4 v12, s[44:47], s65 offen offset:0 lds
    v_lshlrev_b32 v4, 16, v51
    v_and_b32 v5, 0xffff0000, v51
    v_add_f32 v30, v30, v4
    v_add_f32 v31, v31, v5
    buffer_load_dwordx4 v13, s[44:47], s65 offen offset:1024 lds
    v_lshlrev_b32 v2, 16, v52
    v_and_b32 v3, 0xffff0000, v52
    v_add_f32 v24, v24, v2
    v_add_f32 v25, v25, v3
    s_add_u32 m0, s31, 49152
    s_nop 0
    buffer_load_dwordx4 v14, s[44:47], s65 offen offset:0 lds
    v_lshlrev_b32 v4, 16, v53
    v_and_b32 v5, 0xffff0000, v53
    v_add_f32 v26, v26, v4
    v_add_f32 v27, v27, v5
    buffer_load_dwordx4 v15, s[44:47], s65 offen offset:1024 lds
    v_lshlrev_b32 v2, 16, v54
    v_and_b32 v3, 0xffff0000, v54
    v_add_f32 v28, v28, v2
    v_add_f32 v29, v29, v3
    s_add_u32 m0, s31, 57344
    s_nop 0
    buffer_load_dwordx4 v16, s[44:47], s65 offen offset:0 lds
    v_lshlrev_b32 v4, 16, v55
    v_and_b32 v5, 0xffff0000, v55
    v_add_f32 v30, v30, v4
    v_add_f32 v31, v31, v5
    buffer_load_dwordx4 v17, s[44:47], s65 offen offset:1024 lds
    s_add_u32 s3, s79, 0
    buffer_store_dwordx4 v[248:251], v252, s[48:51], s3 offen sc1
    s_add_u32 s3, s79, 32768
    buffer_store_dwordx4 v[248:251], v252, s[48:51], s3 offen sc1
    s_waitcnt vmcnt(14)
    s_waitcnt lgkmcnt(0)
    s_barrier
    s_waitcnt vmcnt(12)
    s_mov_b32 s29, 0
L_k1:
    v_cmp_ne_u32 vcc, s86, v75
    v_cmp_ne_u32 s[92:93], s86, v76
    s_nop 0
    s_or_b64 vcc, vcc, s[92:93]
    s_cbranch_vccz L_k1k
    s_add_u32 s29, s29, 1
    s_cmp_ge_u32 s29, 200000
    s_cbranch_scc1 L_k1k
    s_sleep 2
    s_lshl_b32 s3, s36, 10
    buffer_load_dwordx4 v[72:75], v252, s[48:51], s3 offen sc1
    s_lshl_b32 s3, s37, 6
    buffer_load_dword v76, v232, s[48:51], s3 offen offset:12 sc1
    s_waitcnt vmcnt(0)
    s_branch L_k1
L_k1k:
    s_add_u32 s64, s87, 0
    s_and_b32 s64, s64, 511
    s_or_b32 s64, s64, 1024
    s_xor_b32 s64, s64, s66
    s_mul_i32 s65, s64, 3072
    s_add_u32 m0, s30, 81920
    s_nop 0
    buffer_load_dwordx4 v8, s[40:43], s64 offen offset:0 lds
    buffer_load_dwordx4 v9, s[40:43], s64 offen offset:1024 lds
    v_lshlrev_b32 v2, 16, v56
    v_and_b32 v3, 0xffff0000, v56
    v_add_f32 v24, v24, v2
    v_add_f32 v25, v25, v3
    buffer_load_dwordx4 v10, s[40:43], s64 offen offset:2048 lds
    v_lshlrev_b32 v4, 16, v57
    v_and_b32 v5, 0xffff0000, v57
    v_add_f32 v26, v26, v4
    v_add_f32 v27, v27, v5
    buffer_load_dwordx4 v11, s[40:43], s64 offen offset:3072 lds
    v_lshlrev_b32 v2, 16, v58
    v_and_b32 v3, 0xffff0000, v58
    v_add_f32 v28, v28, v2
    v_add_f32 v29, v29, v3
    s_add_u32 m0, s31, 81920
    s_nop 0
    buffer_load_dwordx4 v12, s[44:47], s65 offen offset:0 lds
    v_lshlrev_b32 v4, 16, v59
    v_and_b32 v5, 0xffff0000, v59
    v_add_f32 v30, v30, v4
    v_add_f32 v31, v31, v5
    buffer_load_dwordx4 v13, s[44:47], s65 offen offset:1024 lds
    v_lshlrev_b32 v2, 16, v60
    v_and_b32 v3, 0xffff0000, v60
    v_add_f32 v24, v24, v2
    v_add_f32 v25, v25, v3
    s_add_u32 m0, s31, 90112
    s_nop 0
    buffer_load_dwordx4 v14, s[44:47], s65 offen offset:0 lds
    v_lshlrev_b32 v4, 16, v61
    v_and_b32 v5, 0xffff0000, v61
    v_add_f32 v26, v26, v4
    v_add_f32 v27, v27, v5
    buffer_load_dwordx4 v15, s[44:47], s65 offen offset:1024 lds
    v_lshlrev_b32 v2, 16, v62
    v_and_b32 v3, 0xffff0000, v62
    v_add_f32 v28, v28, v2
    v_add_f32 v29, v29, v3
    s_add_u32 m0, s31, 98304
    s_nop 0
    buffer_load_dwordx4 v16, s[44:47], s65 offen offset:0 lds
    v_lshlrev_b32 v4, 16, v63
    v_and_b32 v5, 0xffff0000, v63
    v_add_f32 v30, v30, v4
    v_add_f32 v31, v31, v5
    buffer_load_dwordx4 v17, s[44:47], s65 offen offset:1024 lds
    s_waitcnt vmcnt(12)
    s_waitcnt lgkmcnt(0)
    s_barrier
    v_max_u32 v74, v74, v74 quad_perm:[1,0,3,2] row_mask:0xf bank_mask:0xf
    s_nop 1
    v_max_u32 v74, v74, v74 quad_perm:[2,3,0,1] row_mask:0xf bank_mask:0xf
    s_nop 1
    v_max_u32 v74, v74, v74 row_half_mirror row_mask:0xf bank_mask:0xf
    s_nop 1
    v_max_u32 v74, v74, v74 row_mirror row_mask:0xf bank_mask:0xf
    v_and_b32 v2, 0xffff0000, v72
    v_lshlrev_b32 v224, 16, v72
    v_and_b32 v3, 0xffff0000, v73
    v_lshlrev_b32 v225, 16, v73
    v_rcp_f32 v226, v2
    v_rcp_f32 v227, v3
    v_lshrrev_b32 v2, 16, v2
    v_or_b32 v236, v2, v3
    v_mul_f32 v228, 1069066811, v226
    v_mul_f32 v229, 1069066811, v227
    v_readlane_b32 s70, v74, 0
    v_readlane_b32 s3, v74, 16
    v_readlane_b32 s28, v74, 32
    v_readlane_b32 s29, v74, 48
    s_max_u32 s70, s70, s3
    s_max_u32 s28, s28, s29
    s_max_u32 s70, s70, s28
    v_permlane32_swap_b32 v24, v28
    v_permlane32_swap_b32 v25, v29
    v_permlane32_swap_b32 v26, v30
    v_permlane32_swap_b32 v27, v31
    v_add_f32 v24, v24, v28
    v_add_f32 v25, v25, v29
    v_add_f32 v26, v26, v30
    v_add_f32 v27, v27, v31
    s_nop 0
    v_permlane16_swap_b32 v24, v26
    v_permlane16_swap_b32 v25, v27
    v_add_f32 v24, v24, v26
    v_add_f32_e64 v25, v25, v27
    s_nop 0
    v_add_f32 v24, v24, v24 row_ror:8 row_mask:0xf bank_mask:0xf
    v_add_f32 v25, v25, v25 row_ror:8 row_mask:0xf bank_mask:0xf
    v_and_b32 v2, 8, v1
    v_cmp_eq_u32 vcc, 0, v2
    s_nop 1
    v_cndmask_b32 v24, v25, v24, vcc
    s_cmp_eq_u32 s38, 3
    s_cselect_b64 exec, -1, 0
    v_mov_b32 v24, s70
    s_mov_b64 exec, -1
    buffer_store_dword v24, v253, s[48:51], s67 offen sc1
    s_add_u32 s64, s87, 128
    s_and_b32 s64, s64, 511
    s_or_b32 s64, s64, 1024
    s_xor_b32 s64, s64, s66
    s_mul_i32 s65, s64, 3072
    s_add_u32 m0, s30, 0
    s_nop 0
    buffer_load_dwordx4 v8, s[40:43], s64 offen offset:0 lds
    buffer_load_dwordx4 v9, s[40:43], s64 offen offset:1024 lds
    buffer_load_dwordx4 v10, s[40:43], s64 offen offset:2048 lds
    buffer_load_dwordx4 v11, s[40:43], s64 offen offset:3072 lds
    s_add_u32 m0, s31, 0
    s_nop 0
    buffer_load_dwordx4 v12, s[44:47], s65 offen offset:0 lds
    buffer_load_dwordx4 v13, s[44:47], s65 offen offset:1024 lds
    s_add_u32 m0, s31, 8192
    s_nop 0
    buffer_load_dwordx4 v14, s[44:47], s65 offen offset:0 lds
    buffer_load_dwordx4 v15, s[44:47], s65 offen offset:1024 lds
    s_add_u32 m0, s31, 16384
    s_nop 0
    buffer_load_dwordx4 v16, s[44:47], s65 offen offset:0 lds
    buffer_load_dwordx4 v17, s[44:47], s65 offen offset:1024 lds
    s_waitcnt vmcnt(11)
    s_waitcnt lgkmcnt(0)
    s_barrier
    s_add_u32 s64, s87, 256
    s_and_b32 s64, s64, 511
    s_or_b32 s64, s64, 1024
    s_xor_b32 s64, s64, s66
    s_mul_i32 s65, s64, 3072
    s_add_u32 m0, s30, 40960
    s_nop 0
    buffer_load_dwordx4 v8, s[40:43], s64 offen offset:0 lds
    buffer_load_dwordx4 v9, s[40:43], s64 offen offset:1024 lds
    buffer_load_dwordx4 v10, s[40:43], s64 offen offset:2048 lds
    buffer_load_dwordx4 v11, s[40:43], s64 offen offset:3072 lds
    s_add_u32 m0, s31, 40960
    s_nop 0
    buffer_load_dwordx4 v12, s[44:47], s65 offen offset:0 lds
    buffer_load_dwordx4 v13, s[44:47], s65 offen offset:1024 lds
    s_add_u32 m0, s31, 49152
    s_nop 0
    buffer_load_dwordx4 v14, s[44:47], s65 offen offset:0 lds
    buffer_load_dwordx4 v15, s[44:47], s65 offen offset:1024 lds
    s_add_u32 m0, s31, 57344
    s_nop 0
    s_nop 0
    buffer_load_dwordx4 v16, s[44:47], s65 offen offset:0 lds
    buffer_load_dwordx4 v17, s[44:47], s65 offen offset:1024 lds
    s_add_u32 s3, s79, 65536
    buffer_store_dwordx4 v[248:251], v252, s[48:51], s3 offen sc1
    s_add_u32 s3, s79, 98304
    buffer_store_dwordx4 v[248:251], v252, s[48:51], s3 offen sc1
    s_waitcnt vmcnt(12)
    s_waitcnt lgkmcnt(0)
    s_barrier
    s_add_u32 s64, s87, 384
    s_and_b32 s64, s64, 511
    s_or_b32 s64, s64, 1024
    s_xor_b32 s64, s64, s66
    s_mul_i32 s65, s64, 3072
    s_add_u32 m0, s30, 81920
    s_nop 0
    buffer_load_dwordx4 v8, s[40:43], s64 offen offset:0 lds
    buffer_load_dwordx4 v9, s[40:43], s64 offen offset:1024 lds
    buffer_load_dwordx4 v10, s[40:43], s64 offen offset:2048 lds
    buffer_load_dwordx4 v11, s[40:43], s64 offen offset:3072 lds
    s_add_u32 m0, s31, 81920
    s_nop 0
    buffer_load_dwordx4 v12, s[44:47], s65 offen offset:0 lds
    buffer_load_dwordx4 v13, s[44:47], s65 offen offset:1024 lds
    s_add_u32 m0, s31, 90112
    s_nop 0
    buffer_load_dwordx4 v14, s[44:47], s65 offen offset:0 lds
    buffer_load_dwordx4 v15, s[44:47], s65 offen offset:1024 lds
    s_add_u32 m0, s31, 98304
    s_nop 0
    buffer_load_dwordx4 v16, s[44:47], s65 offen offset:0 lds
    buffer_load_dwordx4 v17, s[44:47], s65 offen offset:1024 lds
    s_lshl_b32 s3, s37, 14
    s_add_u32 s3, s3, 524288
    s_add_u32 s28, s3, 0
    buffer_load_dwordx4 v[80:83], v235, s[48:51], s28 offen sc1
    s_add_u32 s28, s3, 4096
    buffer_load_dwordx4 v[84:87], v235, s[48:51], s28 offen sc1
    s_waitcnt vmcnt(14)
    s_waitcnt lgkmcnt(0)
    s_barrier
    s_lshl_b32 s3, s37, 14
    s_add_u32 s3, s3, 524288
    s_add_u32 s28, s3, 8192
    buffer_load_dwordx4 v[88:91], v235, s[48:51], s28 offen sc1
    s_add_u32 s28, s3, 12288
    buffer_load_dwordx4 v[92:95], v235, s[48:51], s28 offen sc1
    s_add_u32 s64, s87, 0
    s_and_b32 s64, s64, 511
    s_or_b32 s64, s64, 1536
    s_xor_b32 s64, s64, s66
    s_mul_i32 s65, s64, 3072
    s_add_u32 m0, s30, 0
    s_nop 0
    buffer_load_dwordx4 v8, s[40:43], s64 offen offset:0 lds
    buffer_load_dwordx4 v9, s[40:43], s64 offen offset:1024 lds
    buffer_load_dwordx4 v10, s[40:43], s64 offen offset:2048 lds
    buffer_load_dwordx4 v11, s[40:43], s64 offen offset:3072 lds
    s_add_u32 m0, s31, 0
    s_nop 0
    buffer_load_dwordx4 v12, s[44:47], s65 offen offset:0 lds
    buffer_load_dwordx4 v13, s[44:47], s65 offen offset:1024 lds
    s_add_u32 m0, s31, 8192
    s_nop 0
    buffer_load_dwordx4 v14, s[44:47], s65 offen offset:0 lds
    buffer_load_dwordx4 v15, s[44:47], s65 offen offset:1024 lds
    s_add_u32 m0, s31, 16384
    s_nop 0
    buffer_load_dwordx4 v16, s[44:47], s65 offen offset:0 lds
    buffer_load_dwordx4 v17, s[44:47], s65 offen offset:1024 lds
    s_waitcnt vmcnt(14)
    s_waitcnt lgkmcnt(0)
    s_barrier
    s_waitcnt vmcnt(10)
    s_mov_b32 s29, 0
L_k2:
    s_nop 0
    v_max3_u32 v2, v80, v81, v82
    v_max3_u32 v2, v2, v83, v84
    v_max3_u32 v2, v2, v85, v86
    v_max3_u32 v2, v2, v87, v88
    v_max3_u32 v2, v2, v89, v90
    v_max3_u32 v2, v2, v91, v92
    v_max3_u32 v2, v2, v93, v94
    v_max_u32 v2, v2, v95
    v_cmp_eq_u32 vcc, -1, v2
    s_cbranch_vccz L_k2k
    s_add_u32 s29, s29, 1
    s_cmp_ge_u32 s29, 200000
    s_cbranch_scc1 L_k2k
    s_sleep 1
    s_lshl_b32 s3, s37, 14
    s_add_u32 s3, s3, 524288
    s_add_u32 s28, s3, 0
    buffer_load_dwordx4 v[80:83], v235, s[48:51], s28 offen sc1
    s_add_u32 s28, s3, 4096
    buffer_load_dwordx4 v[84:87], v235, s[48:51], s28 offen sc1
    s_add_u32 s28, s3, 8192
    buffer_load_dwordx4 v[88:91], v235, s[48:51], s28 offen sc1
    s_add_u32 s28, s3, 12288
    buffer_load_dwordx4 v[92:95], v235, s[48:51], s28 offen sc1
    s_waitcnt vmcnt(0)
    s_branch L_k2
L_k2k:
    v_max3_u32 v2, v80, v84, v88
    v_max_u32 v2, v2, v92
    v_add_f32 v80, v80, v88
    v_add_f32 v81, v81, v89
    v_add_f32 v82, v82, v90
    v_add_f32 v83, v83, v91
    v_add_f32 v84, v84, v92
    v_add_f32 v85, v85, v93
    v_add_f32 v86, v86, v94
    v_add_f32 v87, v87, v95
    v_add_f32 v80, v80, v84
    v_add_f32 v81, v81, v85
    v_add_f32 v82, v82, v86
    v_add_f32_e64 v83, v83, v87
    v_readlane_b32 s70, v2, 12
    v_readlane_b32 s3, v2, 28
    v_readlane_b32 s28, v2, 44
    v_readlane_b32 s29, v2, 60
    s_max_u32 s70, s70, s3
    s_max_u32 s28, s28, s29
    s_max_u32 s70, s70, s28
    v_permlane32_swap_b32 v80, v82
    v_permlane32_swap_b32 v81, v83
    v_add_f32 v80, v80, v82
    v_add_f32 v81, v81, v83
    s_nop 1
    v_permlane16_swap_b32 v80, v81
    v_add_f32 v80, v80, v81
    s_mov_b32 exec_lo, 0xf000f000
    s_mov_b32 exec_hi, 0xf000f000
    v_mov_b32 v80, s70
    s_mov_b64 exec, -1
    s_and_b32 s68, s70, 0x7ff
    s_sub_u32 s68, 2047, s68
    s_lshl_b32 s3, s68, 11
    s_and_b32 s28, s77, 3
    s_lshl_b32 s28, s28, 9
    s_add_u32 s3, s3, s28
    s_lshr_b32 s28, s38, 1
    s_lshl_b32 s28, s28, 8
    s_add_u32 s3, s3, s28
    v_lshrrev_b32 v3, 3, v1
    v_lshlrev_b32_e64 v3, 5, v3
    buffer_load_dwordx4 v[64:67], v3, s[40:43], s3 offen
    buffer_load_dwordx4 v[68:71], v3, s[40:43], s3 offen offset:16
    s_lshr_b32 s3, s68, 1
    s_lshl_b32 s3, s3, 4
    s_and_b32 s28, s68, 1
    s_lshl_b32 s28, s28, 2
    s_add_u32 s3, s3, s28
    v_mov_b32 v3, 0
    buffer_load_dword v116, v3, s[48:51], s3 offen sc1
    s_add_u32 s64, s87, 128
    s_and_b32 s64, s64, 511
    s_or_b32 s64, s64, 1536
    s_xor_b32 s64, s64, s66
    s_mul_i32 s65, s64, 3072
    s_add_u32 m0, s30, 40960
    s_nop 0
    buffer_load_dwordx4 v8, s[40:43], s64 offen offset:0 lds
    buffer_load_dwordx4 v9, s[40:43], s64 offen offset:1024 lds
    buffer_load_dwordx4 v10, s[40:43], s64 offen offset:2048 lds
    buffer_load_dwordx4 v11, s[40:43], s64 offen offset:3072 lds
    s_add_u32 m0, s31, 40960
    s_nop 0
    buffer_load_dwordx4 v12, s[44:47], s65 offen offset:0 lds
    buffer_load_dwordx4 v13, s[44:47], s65 offen offset:1024 lds
    s_add_u32 m0, s31, 49152
    s_nop 0
    buffer_load_dwordx4 v14, s[44:47], s65 offen offset:0 lds
    buffer_load_dwordx4 v15, s[44:47], s65 offen offset:1024 lds
    s_add_u32 m0, s31, 57344
    s_nop 0
    buffer_load_dwordx4 v16, s[44:47], s65 offen offset:0 lds
    buffer_load_dwordx4 v17, s[44:47], s65 offen offset:1024 lds
    s_waitcnt vmcnt(13)
    s_waitcnt lgkmcnt(0)
    s_barrier
    s_add_u32 s64, s87, 256
    s_and_b32 s64, s64, 511
    s_or_b32 s64, s64, 1536
    s_xor_b32 s64, s64, s66
    s_mul_i32 s65, s64, 3072
    s_add_u32 m0, s30, 81920
    s_nop 0
    buffer_load_dwordx4 v8, s[40:43], s64 offen offset:0 lds
    buffer_load_dwordx4 v9, s[40:43], s64 offen offset:1024 lds
    buffer_load_dwordx4 v10, s[40:43], s64 offen offset:2048 lds
    buffer_load_dwordx4 v11, s[40:43], s64 offen offset:3072 lds
    s_add_u32 m0, s31, 81920
    s_nop 0
    buffer_load_dwordx4 v12, s[44:47], s65 offen offset:0 lds
    buffer_load_dwordx4 v13, s[44:47], s65 offen offset:1024 lds
    s_add_u32 m0, s31, 90112
    s_nop 0
    buffer_load_dwordx4 v14, s[44:47], s65 offen offset:0 lds
    buffer_load_dwordx4 v15, s[44:47], s65 offen offset:1024 lds
    s_add_u32 m0, s31, 98304
    s_nop 0
    buffer_load_dwordx4 v16, s[44:47], s65 offen offset:0 lds
    buffer_load_dwordx4 v17, s[44:47], s65 offen offset:1024 lds
    s_or_b32 s3, s2, s38
    s_mov_b32 s28, 16384
    s_cmp_lg_u32 s3, 0
    s_cselect_b32 s3, 268435456, s28
    v_mov_b32 v2, s86
    s_mov_b64 exec, 1
    buffer_store_dword v2, v252, s[48:51], s3 offen sc1
    s_mov_b64 exec, -1
    s_waitcnt vmcnt(11)
    s_waitcnt lgkmcnt(0)
    s_barrier
    s_add_u32 s64, s87, 384
    s_and_b32 s64, s64, 511
    s_or_b32 s64, s64, 1536
    s_xor_b32 s64, s64, s66
    s_mul_i32 s65, s64, 3072
    s_add_u32 m0, s30, 0
    s_nop 0
    buffer_load_dwordx4 v8, s[40:43], s64 offen offset:0 lds
    buffer_load_dwordx4 v9, s[40:43], s64 offen offset:1024 lds
    v_and_b32 v5, 0xffff0000, v116
    v_lshlrev_b32 v116, 16, v116
    v_rcp_f32 v117, v5
    v_lshlrev_b32_e64 v96, 16, v64
    v_and_b32 v97, 0xffff0000, v64
    buffer_load_dwordx4 v10, s[40:43], s64 offen offset:2048 lds
    v_lshlrev_b32 v98, 16, v65
    v_and_b32 v99, 0xffff0000, v65
    v_lshlrev_b32 v100, 16, v66
    v_and_b32 v101, 0xffff0000, v66
    v_lshlrev_b32_e64 v102, 16, v67
    buffer_load_dwordx4 v11, s[40:43], s64 offen offset:3072 lds
    v_and_b32 v103, 0xffff0000, v67
    v_lshlrev_b32 v104, 16, v68
    v_and_b32 v105, 0xffff0000, v68
    v_lshlrev_b32 v106, 16, v69
    v_and_b32 v107, 0xffff0000, v69
    s_add_u32 m0, s31, 0
    s_nop 0
    buffer_load_dwordx4 v12, s[44:47], s65 offen offset:0 lds
    v_lshlrev_b32 v108, 16, v70
    v_and_b32 v109, 0xffff0000, v70
    v_lshlrev_b32 v110, 16, v71
    v_and_b32 v111, 0xffff0000, v71
    v_mul_f32_e64 v119, v116, v117
    buffer_load_dwordx4 v13, s[44:47], s65 offen offset:1024 lds
    v_fma_f32 v96, v96, v117, -v119
    v_fma_f32 v97, v97, v117, -v119
    v_fma_f32 v98, v98, v117, -v119
    v_fma_f32 v99, v99, v117, -v119
    v_fma_f32 v100, v100, v117, -v119
    s_add_u32 m0, s31, 8192
    s_nop 0
    s_nop 0
    buffer_load_dwordx4 v14, s[44:47], s65 offen offset:0 lds
    v_fma_f32 v101, v101, v117, -v119
    v_fma_f32 v102, v102, v117, -v119
    v_fma_f32 v103, v103, v117, -v119
    v_fma_f32 v104, v104, v117, -v119
    v_fma_f32 v105, v105, v117, -v119
    buffer_load_dwordx4 v15, s[44:47], s65 offen offset:1024 lds
    v_fma_f32 v106, v106, v117, -v119
    v_fma_f32 v107, v107, v117, -v119
    v_fma_f32 v108, v108, v117, -v119
    v_fma_f32 v109, v109, v117, -v119
    v_fma_f32 v110, v110, v117, -v119
    s_add_u32 m0, s31, 16384
    s_nop 0
    buffer_load_dwordx4 v16, s[44:47], s65 offen offset:0 lds
    v_fma_f32 v111, v111, v117, -v119
    v_mov_b32 v120, 0
    v_mov_b32 v121, 0
    v_mov_b32 v122, 0
    v_mov_b32 v123, 0
    buffer_load_dwordx4 v17, s[44:47], s65 offen offset:1024 lds
    v_mov_b32 v124, 0
    v_mov_b32 v125, 0
    v_mov_b32 v126, 0
    v_mov_b32 v127, 0
    s_waitcnt vmcnt(11)
    s_waitcnt lgkmcnt(0)
    s_barrier
    s_mov_b32 s3, 28672
    buffer_load_dwordx4 v[144:147], v21, s[52:55], s3 offen nt
    s_mov_b32 s3, 35840
    buffer_load_dwordx4 v[148:151], v21, s[52:55], s3 offen nt
    s_mov_b32 s3, 43008
    buffer_load_dwordx4 v[152:155], v21, s[52:55], s3 offen nt
    s_mov_b32 s3, 50176
    buffer_load_dwordx4 v[156:159], v21, s[52:55], s3 offen nt
    s_mov_b32 s3, 57344
    buffer_load_dwordx4 v[160:163], v21, s[52:55], s3 offen nt
    s_mov_b32 s3, 64512
    buffer_load_dwordx4 v[164:167], v21, s[52:55], s3 offen nt
    s_mov_b32 s3, 71680
    buffer_load_dwordx4 v[168:171], v21, s[52:55], s3 offen nt
    s_mov_b32 s3, 78848
    buffer_load_dwordx4 v[172:175], v21, s[52:55], s3 offen nt
    ds_write_b32 v233, v80
    s_lshl_b32 s3, s38, 4
    s_lshl_b64 exec, 0xffff, s3
    ds_write_b64 v230, v[224:225]
    ds_write_b64 v230, v[226:227] offset:1024
    ds_write_b64 v230, v[228:229] offset:2048
    ds_write_b32 v231, v236
    s_mov_b64 exec, -1
    v_lshlrev_b32 v2, 16, v128
    v_and_b32 v3, 0xffff0000, v128
    v_fmac_f32 v120, v2, v96
    v_fmac_f32 v121, v3, v96
    v_lshlrev_b32 v4, 16, v129
    v_and_b32 v5, 0xffff0000, v129
    v_fmac_f32 v122, v4, v96
    v_fmac_f32 v123, v5, v96
    v_lshlrev_b32 v2, 16, v130
    v_and_b32 v3, 0xffff0000, v130
    v_fmac_f32 v124, v2, v96
    v_fmac_f32 v125, v3, v96
    v_lshlrev_b32 v4, 16, v131
    v_and_b32 v5, 0xffff0000, v131
    v_fmac_f32 v126, v4, v96
    v_fmac_f32 v127, v5, v96
    v_lshlrev_b32 v2, 16, v132
    v_and_b32 v3, 0xffff0000, v132
    v_fmac_f32 v120, v2, v97
    v_fmac_f32 v121, v3, v97
    v_lshlrev_b32 v4, 16, v133
    v_and_b32 v5, 0xffff0000, v133
    v_fmac_f32 v122, v4, v97
    v_fmac_f32 v123, v5, v97
    v_lshlrev_b32 v2, 16, v134
    v_and_b32 v3, 0xffff0000, v134
    v_fmac_f32 v124, v2, v97
    v_fmac_f32 v125, v3, v97
    v_lshlrev_b32 v4, 16, v135
    v_and_b32 v5, 0xffff0000, v135
    v_fmac_f32 v126, v4, v97
    v_fmac_f32 v127, v5, v97
    s_waitcnt vmcnt(8)
    s_waitcnt lgkmcnt(0)
    s_barrier
    v_xor_b32 v2, 0, v23
    ds_read_b64 v[240:241], v2
    v_xor_b32 v2, 32, v23
    ds_read_b64 v[242:243], v2
    v_xor_b32 v2, 64, v23
    ds_read_b64 v[244:245], v2
    v_xor_b32 v2, 96, v23
    ds_read_b64 v[246:247], v2
    v_lshlrev_b32 v2, 16, v136
    v_and_b32 v3, 0xffff0000, v136
    v_fmac_f32 v120, v2, v98
    v_fmac_f32 v121, v3, v98
    v_lshlrev_b32 v4, 16, v137
    v_and_b32 v5, 0xffff0000, v137
    v_fmac_f32 v122, v4, v98
    v_fmac_f32 v123, v5, v98
    v_lshlrev_b32 v2, 16, v138
    v_and_b32 v3, 0xffff0000, v138
    v_fmac_f32 v124, v2, v98
    v_fmac_f32 v125, v3, v98
    v_lshlrev_b32 v4, 16, v139
    v_and_b32 v5, 0xffff0000, v139
    v_fmac_f32 v126, v4, v98
    v_fmac_f32 v127, v5, v98
    v_lshlrev_b32 v2, 16, v140
    v_and_b32 v3, 0xffff0000, v140
    v_fmac_f32 v120, v2, v99
    v_fmac_f32 v121, v3, v99
    v_lshlrev_b32 v4, 16, v141
    v_and_b32 v5, 0xffff0000, v141
    v_fmac_f32 v122, v4, v99
    v_fmac_f32 v123, v5, v99
    v_lshlrev_b32 v2, 16, v142
    v_and_b32 v3, 0xffff0000, v142
    v_fmac_f32 v124, v2, v99
    v_fmac_f32 v125, v3, v99
    v_lshlrev_b32 v4, 16, v143
    v_and_b32 v5, 0xffff0000, v143
    v_fmac_f32 v126, v4, v99
    v_fmac_f32 v127, v5, v99
    s_waitcnt lgkmcnt(0)
    s_barrier
    v_and_b32 v2, 15, v1
    v_min_u32 v2, 13, v2
    v_lshrrev_b32_e64 v3, 4, v1
    v_mul_u32_u24 v3, 14336, v3
    v_lshl_add_u32 v13, v2, 4, v3
    s_lshl_b32 s75, s71, 2
    s_add_u32 s75, s75, 1183744
    s_add_u32 m0, s72, 0
    s_add_u32 s3, s73, 0
    s_nop 0
    buffer_load_dwordx4 v220, s[88:91], s3 offen offset:0 lds
    buffer_load_dwordx4 v221, s[88:91], s3 offen offset:1024 lds
    buffer_load_dwordx4 v222, s[88:91], s3 offen offset:2048 lds
    buffer_load_dwordx4 v223, s[88:91], s3 offen offset:3072 lds
    s_add_u32 m0, s72, 16384
    s_add_u32 s3, s73, 262144
    buffer_load_dwordx4 v220, s[88:91], s3 offen offset:0 lds
    buffer_load_dwordx4 v221, s[88:91], s3 offen offset:1024 lds
    buffer_load_dwordx4 v222, s[88:91], s3 offen offset:2048 lds
    buffer_load_dwordx4 v223, s[88:91], s3 offen offset:3072 lds
    s_add_u32 m0, s72, 65536
    s_add_u32 s3, s73, 1048576
    buffer_load_dwordx4 v220, s[88:91], s3 offen offset:0 lds
    buffer_load_dwordx4 v221, s[88:91], s3 offen offset:1024 lds
    buffer_load_dwordx4 v222, s[88:91], s3 offen offset:2048 lds
    buffer_load_dwordx4 v223, s[88:91], s3 offen offset:3072 lds
    s_mov_b32 s3, 86016
    buffer_load_dwordx4 v[176:179], v21, s[52:55], s3 offen nt
    s_mov_b32 s3, 93184
    buffer_load_dwordx4 v[180:183], v21, s[52:55], s3 offen nt
    s_mov_b32 s3, 100352
    buffer_load_dwordx4 v[184:187], v21, s[52:55], s3 offen nt
    s_mov_b32 s3, 107520
    buffer_load_dwordx4 v[188:191], v21, s[52:55], s3 offen nt
    s_lshr_b32 s3, s71, 3
    s_add_u32 s3, s3, 0
    s_and_b32 s28, s3, 7
    s_lshr_b32 s3, s3, 3
    s_lshl_b32 s3, s3, 6
    s_add_u32 s3, s3, s28
    s_lshl_b32 s3, s3, 11
    buffer_load_dwordx4 v[192:195], v22, s[56:59], s3 offen nt
    s_lshr_b32 s3, s71, 3
    s_add_u32 s3, s3, 1
    s_and_b32 s28, s3, 7
    s_lshr_b32 s3, s3, 3
    s_lshl_b32 s3, s3, 6
    s_add_u32 s3, s3, s28
    s_lshl_b32 s3, s3, 11
    buffer_load_dwordx4 v[196:199], v22, s[56:59], s3 offen nt
    s_lshr_b32 s3, s71, 3
    s_add_u32 s3, s3, 2
    s_and_b32 s28, s3, 7
    s_lshr_b32 s3, s3, 3
    s_lshl_b32 s3, s3, 6
    s_add_u32 s3, s3, s28
    s_lshl_b32 s3, s3, 11
    buffer_load_dwordx4 v[200:203], v22, s[56:59], s3 offen nt
    s_waitcnt vmcnt(19)
    v_lshlrev_b32_e64 v2, 16, v144
    v_and_b32 v3, 0xffff0000, v144
    v_pk_fma_f32 v[120:121], v[2:3], v[100:101], v[120:121] op_sel_hi:[1,0,1]
    v_lshlrev_b32_e64 v4, 16, v145
    v_and_b32 v5, 0xffff0000, v145
    v_pk_fma_f32 v[122:123], v[4:5], v[100:101], v[122:123] op_sel_hi:[1,0,1]
    v_lshlrev_b32_e64 v2, 16, v146
    v_and_b32 v3, 0xffff0000, v146
    v_pk_fma_f32 v[124:125], v[2:3], v[100:101], v[124:125] op_sel_hi:[1,0,1]
    v_lshlrev_b32_e64 v4, 16, v147
    v_and_b32 v5, 0xffff0000, v147
    v_pk_fma_f32 v[126:127], v[4:5], v[100:101], v[126:127] op_sel_hi:[1,0,1]
    v_lshlrev_b32 v2, 16, v148
    v_and_b32 v3, 0xffff0000, v148
    v_mov_b32 v100, v101
    v_pk_fma_f32 v[120:121], v[2:3], v[100:101], v[120:121] op_sel_hi:[1,0,1]
    v_lshlrev_b32_e64 v4, 16, v149
    v_and_b32 v5, 0xffff0000, v149
    v_pk_fma_f32 v[122:123], v[4:5], v[100:101], v[122:123] op_sel_hi:[1,0,1]
    v_lshlrev_b32_e64 v2, 16, v150
    v_and_b32 v3, 0xffff0000, v150
    v_pk_fma_f32 v[124:125], v[2:3], v[100:101], v[124:125] op_sel_hi:[1,0,1]
    v_lshlrev_b32_e64 v4, 16, v151
    v_and_b32 v5, 0xffff0000, v151
    v_pk_fma_f32 v[126:127], v[4:5], v[100:101], v[126:127] op_sel_hi:[1,0,1]
    v_lshlrev_b32_e64 v2, 16, v152
    v_and_b32 v3, 0xffff0000, v152
    v_pk_fma_f32 v[120:121], v[2:3], v[102:103], v[120:121] op_sel_hi:[1,0,1]
    v_lshlrev_b32_e64 v4, 16, v153
    v_and_b32 v5, 0xffff0000, v153
    v_pk_fma_f32 v[122:123], v[4:5], v[102:103], v[122:123] op_sel_hi:[1,0,1]
    v_lshlrev_b32_e64 v2, 16, v154
    v_and_b32 v3, 0xffff0000, v154
    v_pk_fma_f32 v[124:125], v[2:3], v[102:103], v[124:125] op_sel_hi:[1,0,1]
    v_lshlrev_b32_e64 v4, 16, v155
    v_and_b32 v5, 0xffff0000, v155
    v_pk_fma_f32 v[126:127], v[4:5], v[102:103], v[126:127] op_sel_hi:[1,0,1]
    v_lshlrev_b32 v2, 16, v156
    v_and_b32 v3, 0xffff0000, v156
    v_mov_b32 v102, v103
    v_pk_fma_f32 v[120:121], v[2:3], v[102:103], v[120:121] op_sel_hi:[1,0,1]
    v_lshlrev_b32_e64 v4, 16, v157
    v_and_b32 v5, 0xffff0000, v157
    v_pk_fma_f32 v[122:123], v[4:5], v[102:103], v[122:123] op_sel_hi:[1,0,1]
    v_lshlrev_b32_e64 v2, 16, v158
    v_and_b32 v3, 0xffff0000, v158
    v_pk_fma_f32 v[124:125], v[2:3], v[102:103], v[124:125] op_sel_hi:[1,0,1]
    v_lshlrev_b32_e64 v4, 16, v159
    v_and_b32 v5, 0xffff0000, v159
    v_pk_fma_f32 v[126:127], v[4:5], v[102:103], v[126:127] op_sel_hi:[1,0,1]
    v_lshlrev_b32_e64 v2, 16, v160
    v_and_b32 v3, 0xffff0000, v160
    v_pk_fma_f32 v[120:121], v[2:3], v[104:105], v[120:121] op_sel_hi:[1,0,1]
    v_lshlrev_b32_e64 v4, 16, v161
    v_and_b32 v5, 0xffff0000, v161
    v_pk_fma_f32 v[122:123], v[4:5], v[104:105], v[122:123] op_sel_hi:[1,0,1]
    v_lshlrev_b32_e64 v2, 16, v162
    v_and_b32 v3, 0xffff0000, v162
    v_pk_fma_f32 v[124:125], v[2:3], v[104:105], v[124:125] op_sel_hi:[1,0,1]
    v_lshlrev_b32_e64 v4, 16, v163
    v_and_b32 v5, 0xffff0000, v163
    v_pk_fma_f32 v[126:127], v[4:5], v[104:105], v[126:127] op_sel_hi:[1,0,1]
    v_lshlrev_b32 v2, 16, v164
    v_and_b32 v3, 0xffff0000, v164
    v_mov_b32 v104, v105
    v_pk_fma_f32 v[120:121], v[2:3], v[104:105], v[120:121] op_sel_hi:[1,0,1]
    v_lshlrev_b32_e64 v4, 16, v165
    v_and_b32 v5, 0xffff0000, v165
    v_pk_fma_f32 v[122:123], v[4:5], v[104:105], v[122:123] op_sel_hi:[1,0,1]
    v_lshlrev_b32_e64 v2, 16, v166
    v_and_b32 v3, 0xffff0000, v166
    v_pk_fma_f32 v[124:125], v[2:3], v[104:105], v[124:125] op_sel_hi:[1,0,1]
    v_lshlrev_b32_e64 v4, 16, v167
    v_and_b32 v5, 0xffff0000, v167
    v_pk_fma_f32 v[126:127], v[4:5], v[104:105], v[126:127] op_sel_hi:[1,0,1]
    v_lshlrev_b32_e64 v2, 16, v168
    v_and_b32 v3, 0xffff0000, v168
    v_pk_fma_f32 v[120:121], v[2:3], v[106:107], v[120:121] op_sel_hi:[1,0,1]
    v_lshlrev_b32_e64 v4, 16, v169
    v_and_b32 v5, 0xffff0000, v169
    v_pk_fma_f32 v[122:123], v[4:5], v[106:107], v[122:123] op_sel_hi:[1,0,1]
    v_lshlrev_b32_e64 v2, 16, v170
    v_and_b32 v3, 0xffff0000, v170
    v_pk_fma_f32 v[124:125], v[2:3], v[106:107], v[124:125] op_sel_hi:[1,0,1]
    v_lshlrev_b32_e64 v4, 16, v171
    v_and_b32 v5, 0xffff0000, v171
    v_pk_fma_f32 v[126:127], v[4:5], v[106:107], v[126:127] op_sel_hi:[1,0,1]
    v_lshlrev_b32 v2, 16, v172
    v_and_b32 v3, 0xffff0000, v172
    v_mov_b32 v106, v107
    v_pk_fma_f32 v[120:121], v[2:3], v[106:107], v[120:121] op_sel_hi:[1,0,1]
    v_lshlrev_b32_e64 v4, 16, v173
    v_and_b32 v5, 0xffff0000, v173
    v_pk_fma_f32 v[122:123], v[4:5], v[106:107], v[122:123] op_sel_hi:[1,0,1]
    v_lshlrev_b32_e64 v2, 16, v174
    v_and_b32 v3, 0xffff0000, v174
    v_pk_fma_f32 v[124:125], v[2:3], v[106:107], v[124:125] op_sel_hi:[1,0,1]
    v_lshlrev_b32_e64 v4, 16, v175
    v_and_b32 v5, 0xffff0000, v175
    v_pk_fma_f32 v[126:127], v[4:5], v[106:107], v[126:127] op_sel_hi:[1,0,1]
    s_waitcnt vmcnt(15)
    s_waitcnt vmcnt(11)
    s_waitcnt vmcnt(7)
    s_barrier
    s_add_u32 m0, s72, 32768
    s_add_u32 s3, s73, 524288
    buffer_load_dwordx4 v220, s[88:91], s3 offen offset:0 lds
    buffer_load_dwordx4 v221, s[88:91], s3 offen offset:1024 lds
    buffer_load_dwordx4 v222, s[88:91], s3 offen offset:2048 lds
    buffer_load_dwordx4 v223, s[88:91], s3 offen offset:3072 lds
    s_add_u32 m0, s72, 49152
    s_add_u32 s3, s73, 786432
    buffer_load_dwordx4 v220, s[88:91], s3 offen offset:0 lds
    buffer_load_dwordx4 v221, s[88:91], s3 offen offset:1024 lds
    buffer_load_dwordx4 v222, s[88:91], s3 offen offset:2048 lds
    buffer_load_dwordx4 v223, s[88:91], s3 offen offset:3072 lds
    s_add_u32 m0, s72, 81920
    s_add_u32 s3, s73, 1310720
    buffer_load_dwordx4 v220, s[88:91], s3 offen offset:0 lds
    buffer_load_dwordx4 v221, s[88:91], s3 offen offset:1024 lds
    buffer_load_dwordx4 v222, s[88:91], s3 offen offset:2048 lds
    buffer_load_dwordx4 v223, s[88:91], s3 offen offset:3072 lds
    s_setprio 3
    s_cmp_lg_u32 s38, 3
    s_cbranch_scc1 L_npl
    s_mov_b32 s3, 32768
    s_mov_b32 s29, 0
    s_mov_b32 exec_lo, -1
    s_mov_b32 exec_hi, 65535
L_rp:
    buffer_load_dword v118, v113, s[48:51], s3 offen sc1
    s_waitcnt vmcnt(0)
    v_cmp_ne_u32 vcc, s86, v118
    s_cbranch_vccz L_rpk
    s_mov_b64 exec, vcc
    s_add_u32 s29, s29, 1
    s_cmp_lt_u32 s29, 200000
    s_cbranch_scc1 L_rp
L_rpk:
    s_mov_b64 exec, -1
    v_mov_b32 v4, 162128
    v_mov_b32 v5, 1
    ds_write_b32 v4, v5
L_npl:
    v_min_u32 v3, 4, v1
    v_lshlrev_b32_e64 v3, 2, v3
    v_add_u32 v3, 162112, v3
L_fw:
    ds_read_b32 v4, v3
    s_waitcnt lgkmcnt(0)
    v_cmp_eq_u32 vcc, 0, v4
    s_cbranch_vccz L_fk
    s_sleep 1
    s_branch L_fw
L_fk:
    s_waitcnt vmcnt(15)
    v_lshlrev_b32_e64 v2, 16, v176
    v_and_b32 v3, 0xffff0000, v176
    v_pk_fma_f32 v[120:121], v[2:3], v[108:109], v[120:121] op_sel_hi:[1,0,1]
    v_lshlrev_b32_e64 v4, 16, v177
    v_and_b32 v5, 0xffff0000, v177
    v_pk_fma_f32 v[122:123], v[4:5], v[108:109], v[122:123] op_sel_hi:[1,0,1]
    v_lshlrev_b32_e64 v2, 16, v178
    v_and_b32 v3, 0xffff0000, v178
    v_pk_fma_f32 v[124:125], v[2:3], v[108:109], v[124:125] op_sel_hi:[1,0,1]
    v_lshlrev_b32_e64 v4, 16, v179
    v_and_b32 v5, 0xffff0000, v179
    v_pk_fma_f32 v[126:127], v[4:5], v[108:109], v[126:127] op_sel_hi:[1,0,1]
    v_lshlrev_b32 v2, 16, v180
    v_and_b32 v3, 0xffff0000, v180
    v_mov_b32 v108, v109
    v_pk_fma_f32 v[120:121], v[2:3], v[108:109], v[120:121] op_sel_hi:[1,0,1]
    v_lshlrev_b32_e64 v4, 16, v181
    v_and_b32 v5, 0xffff0000, v181
    v_pk_fma_f32 v[122:123], v[4:5], v[108:109], v[122:123] op_sel_hi:[1,0,1]
    v_lshlrev_b32_e64 v2, 16, v182
    v_and_b32 v3, 0xffff0000, v182
    v_pk_fma_f32 v[124:125], v[2:3], v[108:109], v[124:125] op_sel_hi:[1,0,1]
    v_lshlrev_b32_e64 v4, 16, v183
    v_and_b32 v5, 0xffff0000, v183
    v_pk_fma_f32 v[126:127], v[4:5], v[108:109], v[126:127] op_sel_hi:[1,0,1]
    s_add_u32 s3, s76, 0
    buffer_load_dwordx4 v[48:51], v112, s[48:51], s3 offen sc1
    s_add_u32 s3, s76, 33792
    buffer_load_dwordx4 v[52:55], v112, s[48:51], s3 offen sc1
    s_cmp_lg_u32 s83, 0
    s_cbranch_scc1 L_nz
    s_add_u32 s3, s81, 0
    buffer_load_dwordx4 v[32:35], v112, s[48:51], s3 offen sc1
    s_add_u32 s3, s81, 33792
    buffer_load_dwordx4 v[36:39], v112, s[48:51], s3 offen sc1
L_nz:
    v_lshlrev_b32_e64 v2, 16, v184
    v_and_b32 v3, 0xffff0000, v184
    v_pk_fma_f32 v[120:121], v[2:3], v[110:111], v[120:121] op_sel_hi:[1,0,1]
    v_lshlrev_b32_e64 v4, 16, v185
    v_and_b32 v5, 0xffff0000, v185
    v_pk_fma_f32 v[122:123], v[4:5], v[110:111], v[122:123] op_sel_hi:[1,0,1]
    v_lshlrev_b32_e64 v2, 16, v186
    v_and_b32 v3, 0xffff0000, v186
    v_pk_fma_f32 v[124:125], v[2:3], v[110:111], v[124:125] op_sel_hi:[1,0,1]
    v_lshlrev_b32_e64 v4, 16, v187
    v_and_b32 v5, 0xffff0000, v187
    v_pk_fma_f32 v[126:127], v[4:5], v[110:111], v[126:127] op_sel_hi:[1,0,1]
    v_lshlrev_b32 v2, 16, v188
    v_and_b32 v3, 0xffff0000, v188
    v_mov_b32 v110, v111
    v_pk_fma_f32 v[120:121], v[2:3], v[110:111], v[120:121] op_sel_hi:[1,0,1]
    v_lshlrev_b32_e64 v4, 16, v189
    v_and_b32 v5, 0xffff0000, v189
    v_pk_fma_f32 v[122:123], v[4:5], v[110:111], v[122:123] op_sel_hi:[1,0,1]
    v_lshlrev_b32_e64 v2, 16, v190
    v_and_b32 v3, 0xffff0000, v190
    v_pk_fma_f32 v[124:125], v[2:3], v[110:111], v[124:125] op_sel_hi:[1,0,1]
    v_lshlrev_b32_e64 v4, 16, v191
    v_and_b32 v5, 0xffff0000, v191
    v_pk_fma_f32 v[126:127], v[4:5], v[110:111], v[126:127] op_sel_hi:[1,0,1]
    v_permlane32_swap_b32 v120, v124
    v_permlane32_swap_b32 v121, v125
    v_permlane32_swap_b32 v122, v126
    v_permlane32_swap_b32 v123, v127
    v_add_f32 v120, v120, v124
    v_add_f32 v121, v121, v125
    v_add_f32 v122, v122, v126
    v_add_f32 v123, v123, v127
    s_nop 0
    v_permlane16_swap_b32 v120, v122
    v_permlane16_swap_b32 v121, v123
    v_add_f32 v120, v120, v122
    v_add_f32 v121, v121, v123
    s_nop 0
    v_add_f32 v120, v120, v120 row_ror:8 row_mask:0xf bank_mask:0xf
    v_add_f32 v121, v121, v121 row_ror:8 row_mask:0xf bank_mask:0xf
    v_and_b32 v2, 8, v1
    v_cmp_eq_u32 vcc, 0, v2
    s_nop 1
    v_cndmask_b32 v120, v121, v120, vcc
    buffer_store_dword v120, v253, s[48:51], s84 offen sc1
    s_lshr_b32 s3, s71, 3
    s_add_u32 s3, s3, 3
    s_and_b32 s28, s3, 7
    s_lshr_b32 s3, s3, 3
    s_lshl_b32 s3, s3, 6
    s_add_u32 s3, s3, s28
    s_lshl_b32 s3, s3, 11
    buffer_load_dwordx4 v[204:207], v22, s[56:59], s3 offen nt
    s_lshr_b32 s3, s71, 3
    s_add_u32 s3, s3, 4
    s_and_b32 s28, s3, 7
    s_lshr_b32 s3, s3, 3
    s_lshl_b32 s3, s3, 6
    s_add_u32 s3, s3, s28
    s_lshl_b32 s3, s3, 11
    buffer_load_dwordx4 v[208:211], v22, s[56:59], s3 offen nt
    s_lshr_b32 s3, s71, 3
    s_add_u32 s3, s3, 5
    s_and_b32 s28, s3, 7
    s_lshr_b32 s3, s3, 3
    s_lshl_b32 s3, s3, 6
    s_add_u32 s3, s3, s28
    s_lshl_b32 s3, s3, 11
    buffer_load_dwordx4 v[212:215], v22, s[56:59], s3 offen nt
    s_lshr_b32 s3, s71, 3
    s_add_u32 s3, s3, 6
    s_and_b32 s28, s3, 7
    s_lshr_b32 s3, s3, 3
    s_lshl_b32 s3, s3, 6
    s_add_u32 s3, s3, s28
    s_lshl_b32 s3, s3, 11
    buffer_load_dwordx4 v[216:219], v22, s[56:59], s3 offen nt
    s_waitcnt vmcnt(5)
    s_cmp_eq_u32 s83, 0
    s_cbranch_scc1 L_hz
    s_mov_b32 s29, 0
L_k4:
    v_max3_u32 v2, v48, v49, v50
    v_max3_u32 v2, v2, v51, v52
    v_max3_u32 v2, v2, v53, v54
    v_max_u32 v2, v2, v55
    v_cmp_eq_u32 vcc, -1, v2
    s_cbranch_vccz L_k4k
    s_add_u32 s29, s29, 1
    s_cmp_ge_u32 s29, 200000
    s_cbranch_scc1 L_k4k
    s_sleep 1
    s_add_u32 s3, s76, 0
    buffer_load_dwordx4 v[48:51], v112, s[48:51], s3 offen sc1
    s_add_u32 s3, s76, 33792
    buffer_load_dwordx4 v[52:55], v112, s[48:51], s3 offen sc1
    s_waitcnt vmcnt(0)
    s_branch L_k4
L_k4k:
    v_lshlrev_b32 v64, 16, v48
    v_and_b32 v65, 0xffff0000, v48
    v_lshlrev_b32 v66, 16, v49
    v_and_b32 v67, 0xffff0000, v49
    v_lshlrev_b32 v68, 16, v50
    v_and_b32 v69, 0xffff0000, v50
    v_lshlrev_b32 v70, 16, v51
    v_and_b32 v71, 0xffff0000, v51
    v_lshlrev_b32 v72, 16, v52
    v_and_b32 v73, 0xffff0000, v52
    v_pk_add_f32 v[64:65], v[64:65], v[72:73]
    v_lshlrev_b32_e64 v74, 16, v53
    v_and_b32 v75, 0xffff0000, v53
    v_pk_add_f32 v[66:67], v[66:67], v[74:75]
    v_lshlrev_b32_e64 v76, 16, v54
    v_and_b32 v77, 0xffff0000, v54
    v_pk_add_f32 v[68:69], v[68:69], v[76:77]
    v_lshlrev_b32_e64 v78, 16, v55
    v_and_b32 v79, 0xffff0000, v55
    v_pk_add_f32 v[70:71], v[70:71], v[78:79]
    v_permlane32_swap_b32 v64, v68
    v_permlane32_swap_b32 v65, v69
    v_permlane32_swap_b32 v66, v70
    v_permlane32_swap_b32 v67, v71
    v_add_f32 v64, v64, v68
    v_add_f32 v65, v65, v69
    v_add_f32 v66, v66, v70
    v_add_f32 v67, v67, v71
    s_nop 0
    v_permlane16_swap_b32 v64, v66
    v_permlane16_swap_b32 v65, v67
    v_add_f32 v64, v64, v66
    v_add_f32 v65, v65, v67
    s_nop 0
    v_add_f32 v64, v64, v64 row_ror:8 row_mask:0xf bank_mask:0xf
    v_add_f32 v65, v65, v65 row_ror:8 row_mask:0xf bank_mask:0xf
    v_cvt_pk_bf16_f32 v64, v64, v65
    v_mov_b32 v65, v64
    s_nop 1
    v_permlane16_swap_b32 v64, v65
    v_mov_b32 v66, v64
    v_mov_b32 v67, v65
    s_nop 0
    v_permlane32_swap_b32 v64, v66
    v_permlane32_swap_b32 v65, v67
    s_mov_b64 exec, 0xff
    buffer_store_dwordx4 v[64:67], v252, s[48:51], s74 offen sc1
    s_branch L_h1e
L_hz:
    s_mov_b32 s29, 0
L_k3:
    v_max3_u32 v2, v48, v49, v50
    v_max3_u32 v2, v2, v51, v52
    v_max3_u32 v2, v2, v53, v54
    v_max3_u32 v2, v2, v55, v32
    v_max3_u32 v2, v2, v33, v34
    v_max3_u32 v2, v2, v35, v36
    v_max3_u32 v2, v2, v37, v38
    v_max_u32 v2, v2, v39
    v_cmp_eq_u32 vcc, -1, v2
    s_cbranch_vccz L_k3k
    s_add_u32 s29, s29, 1
    s_cmp_ge_u32 s29, 200000
    s_cbranch_scc1 L_k3k
    s_sleep 1
    s_add_u32 s3, s76, 0
    buffer_load_dwordx4 v[48:51], v112, s[48:51], s3 offen sc1
    s_add_u32 s3, s76, 33792
    buffer_load_dwordx4 v[52:55], v112, s[48:51], s3 offen sc1
    s_add_u32 s3, s81, 0
    buffer_load_dwordx4 v[32:35], v112, s[48:51], s3 offen sc1
    s_add_u32 s3, s81, 33792
    buffer_load_dwordx4 v[36:39], v112, s[48:51], s3 offen sc1
    s_waitcnt vmcnt(0)
    s_branch L_k3
L_k3k:
    v_lshlrev_b32 v64, 16, v48
    v_lshlrev_b32 v96, 16, v32
    v_and_b32 v65, 0xffff0000, v48
    v_and_b32 v97, 0xffff0000, v32
    v_lshlrev_b32 v66, 16, v49
    v_lshlrev_b32 v98, 16, v33
    v_and_b32 v67, 0xffff0000, v49
    v_and_b32 v99, 0xffff0000, v33
    v_lshlrev_b32 v68, 16, v50
    v_lshlrev_b32 v100, 16, v34
    v_and_b32 v69, 0xffff0000, v50
    v_and_b32 v101, 0xffff0000, v34
    v_lshlrev_b32 v70, 16, v51
    v_lshlrev_b32 v102, 16, v35
    v_and_b32 v71, 0xffff0000, v51
    v_and_b32 v103, 0xffff0000, v35
    v_lshlrev_b32 v72, 16, v52
    v_lshlrev_b32 v104, 16, v36
    v_and_b32 v73, 0xffff0000, v52
    v_and_b32 v105, 0xffff0000, v36
    v_pk_add_f32 v[64:65], v[64:65], v[72:73]
    v_pk_add_f32 v[96:97], v[96:97], v[104:105]
    v_lshlrev_b32 v74, 16, v53
    v_lshlrev_b32 v106, 16, v37
    v_and_b32 v75, 0xffff0000, v53
    v_and_b32 v107, 0xffff0000, v37
    v_pk_add_f32 v[66:67], v[66:67], v[74:75]
    v_pk_add_f32 v[98:99], v[98:99], v[106:107]
    v_lshlrev_b32 v76, 16, v54
    v_lshlrev_b32 v108, 16, v38
    v_and_b32 v77, 0xffff0000, v54
    v_and_b32 v109, 0xffff0000, v38
    v_pk_add_f32 v[68:69], v[68:69], v[76:77]
    v_pk_add_f32 v[100:101], v[100:101], v[108:109]
    v_lshlrev_b32 v78, 16, v55
    v_lshlrev_b32 v110, 16, v39
    v_and_b32 v79, 0xffff0000, v55
    v_and_b32 v111, 0xffff0000, v39
    v_pk_add_f32 v[70:71], v[70:71], v[78:79]
    v_pk_add_f32 v[102:103], v[102:103], v[110:111]
    v_permlane32_swap_b32 v64, v68
    v_permlane32_swap_b32 v96, v100
    v_permlane32_swap_b32 v65, v69
    v_permlane32_swap_b32 v97, v101
    v_permlane32_swap_b32 v66, v70
    v_permlane32_swap_b32 v98, v102
    v_permlane32_swap_b32 v67, v71
    v_permlane32_swap_b32 v99, v103
    v_add_f32 v64, v64, v68
    v_add_f32 v96, v96, v100
    v_add_f32 v65, v65, v69
    v_add_f32 v97, v97, v101
    v_add_f32 v66, v66, v70
    v_add_f32 v98, v98, v102
    v_add_f32 v67, v67, v71
    v_add_f32 v99, v99, v103
    v_permlane16_swap_b32 v64, v66
    v_permlane16_swap_b32 v96, v98
    v_permlane16_swap_b32 v65, v67
    v_permlane16_swap_b32 v97, v99
    v_add_f32 v64, v64, v66
    v_add_f32 v96, v96, v98
    v_add_f32 v65, v65, v67
    v_add_f32 v97, v97, v99
    v_add_f32 v64, v64, v64 row_ror:8 row_mask:0xf bank_mask:0xf
    v_add_f32 v96, v96, v96 row_ror:8 row_mask:0xf bank_mask:0xf
    v_add_f32 v65, v65, v65 row_ror:8 row_mask:0xf bank_mask:0xf
    v_add_f32 v97, v97, v97 row_ror:8 row_mask:0xf bank_mask:0xf
    v_cvt_pk_bf16_f32 v64, v64, v65
    v_cvt_pk_bf16_f32 v96, v96, v97
    v_mov_b32 v65, v64
    v_mov_b32 v97, v96
    s_nop 0
    v_permlane16_swap_b32 v64, v65
    v_permlane16_swap_b32 v96, v97
    v_mov_b32 v66, v64
    v_mov_b32 v98, v96
    v_mov_b32 v67, v65
    v_mov_b32 v99, v97
    v_permlane32_swap_b32 v64, v66
    v_permlane32_swap_b32 v96, v98
    v_permlane32_swap_b32 v65, v67
    v_permlane32_swap_b32_e64 v97, v99
    s_mov_b64 exec, 0xff
    buffer_store_dwordx4 v[64:67], v252, s[48:51], s74 offen sc1
    buffer_store_dwordx4 v[96:99], v252, s[48:51], s82 offen sc1
L_h1e:
    s_mov_b64 exec, -1
    s_lshl_b32 s3, s38, 2
    s_add_u32 s3, s3, 162112
    v_mov_b32 v4, s3
    v_mov_b32 v5, 3
    ds_write_b32 v4, v5
    s_setprio 0
    v_and_b32 v2, 15, v1
    v_add_u32 v2, s69, v2
    v_lshlrev_b32 v2, 2, v2
    v_add_u32 v2, 152064, v2
    ds_read_b32 v9, v2
    ds_read_b32 v8, v2 offset:1024
    s_waitcnt lgkmcnt(0)
    v_mul_f32 v28, v9, v8
    v_mov_b32 v30, 0xbfb8aa3b
    v_lshlrev_b32 v224, 16, v240
    v_and_b32 v225, 0xffff0000, v240
    v_lshlrev_b32 v226, 16, v241
    v_and_b32 v227, 0xffff0000, v241
    v_lshlrev_b32 v228, 16, v242
    v_and_b32 v229, 0xffff0000, v242
    v_lshlrev_b32 v230, 16, v243
    v_and_b32 v231, 0xffff0000, v243
    v_lshlrev_b32 v232, 16, v244
    v_and_b32 v233, 0xffff0000, v244
    v_lshlrev_b32 v234, 16, v245
    v_and_b32 v235, 0xffff0000, v245
    v_lshlrev_b32 v236, 16, v246
    v_and_b32 v237, 0xffff0000, v246
    v_lshlrev_b32 v238, 16, v247
    v_and_b32 v239, 0xffff0000, v247
    v_pk_fma_f32 v[224:225], v[224:225], v[8:9], v[28:29] op_sel_hi:[1,0,0] neg_lo:[0,0,1] neg_hi:[0,0,1]
    v_pk_fma_f32 v[226:227], v[226:227], v[8:9], v[28:29] op_sel_hi:[1,0,0] neg_lo:[0,0,1] neg_hi:[0,0,1]
    v_pk_fma_f32 v[228:229], v[228:229], v[8:9], v[28:29] op_sel_hi:[1,0,0] neg_lo:[0,0,1] neg_hi:[0,0,1]
    v_pk_fma_f32 v[230:231], v[230:231], v[8:9], v[28:29] op_sel_hi:[1,0,0] neg_lo:[0,0,1] neg_hi:[0,0,1]
    v_pk_fma_f32 v[232:233], v[232:233], v[8:9], v[28:29] op_sel_hi:[1,0,0] neg_lo:[0,0,1] neg_hi:[0,0,1]
    v_pk_fma_f32 v[234:235], v[234:235], v[8:9], v[28:29] op_sel_hi:[1,0,0] neg_lo:[0,0,1] neg_hi:[0,0,1]
    v_pk_fma_f32 v[236:237], v[236:237], v[8:9], v[28:29] op_sel_hi:[1,0,0] neg_lo:[0,0,1] neg_hi:[0,0,1]
    v_pk_fma_f32 v[238:239], v[238:239], v[8:9], v[28:29] op_sel_hi:[1,0,0] neg_lo:[0,0,1] neg_hi:[0,0,1]
    v_pk_mul_f32 v[32:33], v[224:225], v[30:31] op_sel_hi:[1,0]
    v_pk_mul_f32 v[34:35], v[226:227], v[30:31] op_sel_hi:[1,0]
    v_pk_mul_f32 v[36:37], v[228:229], v[30:31] op_sel_hi:[1,0]
    v_pk_mul_f32 v[38:39], v[230:231], v[30:31] op_sel_hi:[1,0]
    v_pk_mul_f32 v[40:41], v[232:233], v[30:31] op_sel_hi:[1,0]
    v_pk_mul_f32 v[42:43], v[234:235], v[30:31] op_sel_hi:[1,0]
    v_pk_mul_f32 v[44:45], v[236:237], v[30:31] op_sel_hi:[1,0]
    v_pk_mul_f32 v[46:47], v[238:239], v[30:31] op_sel_hi:[1,0]
    v_exp_f32 v32, v32
    v_exp_f32 v33, v33
    v_exp_f32 v34, v34
    v_exp_f32 v35, v35
    v_exp_f32 v36, v36
    v_exp_f32 v37, v37
    v_exp_f32 v38, v38
    v_exp_f32 v39, v39
    v_exp_f32 v40, v40
    v_exp_f32 v41, v41
    v_exp_f32 v42, v42
    v_exp_f32 v43, v43
    v_exp_f32 v44, v44
    v_exp_f32 v45, v45
    v_exp_f32 v46, v46
    v_exp_f32 v47, v47
    v_pk_add_f32 v[32:33], v[32:33], 1.0 op_sel_hi:[1,0]
    v_pk_add_f32 v[34:35], v[34:35], 1.0 op_sel_hi:[1,0]
    v_pk_add_f32 v[36:37], v[36:37], 1.0 op_sel_hi:[1,0]
    v_pk_add_f32 v[38:39], v[38:39], 1.0 op_sel_hi:[1,0]
    v_pk_add_f32 v[40:41], v[40:41], 1.0 op_sel_hi:[1,0]
    v_pk_add_f32 v[42:43], v[42:43], 1.0 op_sel_hi:[1,0]
    v_pk_add_f32 v[44:45], v[44:45], 1.0 op_sel_hi:[1,0]
    v_pk_add_f32 v[46:47], v[46:47], 1.0 op_sel_hi:[1,0]
    v_rcp_f32 v32, v32
    v_rcp_f32 v33, v33
    v_rcp_f32 v34, v34
    v_rcp_f32 v35, v35
    v_rcp_f32 v36, v36
    v_rcp_f32 v37, v37
    v_rcp_f32 v38, v38
    v_rcp_f32 v39, v39
    v_rcp_f32 v40, v40
    v_rcp_f32 v41, v41
    v_rcp_f32 v42, v42
    v_rcp_f32 v43, v43
    v_rcp_f32 v44, v44
    v_rcp_f32 v45, v45
    v_rcp_f32 v46, v46
    v_rcp_f32 v47, v47
    v_pk_mul_f32 v[224:225], v[224:225], v[32:33]
    v_pk_mul_f32 v[226:227], v[226:227], v[34:35]
    v_pk_mul_f32 v[228:229], v[228:229], v[36:37]
    v_pk_mul_f32 v[230:231], v[230:231], v[38:39]
    v_pk_mul_f32 v[232:233], v[232:233], v[40:41]
    v_pk_mul_f32 v[234:235], v[234:235], v[42:43]
    v_pk_mul_f32 v[236:237], v[236:237], v[44:45]
    v_pk_mul_f32 v[238:239], v[238:239], v[46:47]
    s_add_u32 s3, s75, 0
    s_nop 0
    buffer_load_dwordx4 v[80:83], v13, s[48:51], s3 offen sc1
    s_add_u32 s3, s75, 57344
    buffer_load_dwordx4 v[84:87], v13, s[48:51], s3 offen sc1
    s_add_u32 s3, s75, 114688
    buffer_load_dwordx4 v[88:91], v13, s[48:51], s3 offen sc1
    s_add_u32 s3, s75, 172032
    buffer_load_dwordx4 v[92:95], v13, s[48:51], s3 offen sc1
    s_waitcnt vmcnt(0)
    s_mov_b32 s29, 0
L_k5:
    v_max3_u32 v2, v80, v81, v82
    v_max3_u32 v2, v2, v83, v84
    v_max3_u32 v2, v2, v85, v86
    v_max3_u32 v2, v2, v87, v88
    v_max3_u32 v2, v2, v89, v90
    v_max3_u32 v2, v2, v91, v92
    v_max3_u32 v2, v2, v93, v94
    v_max_u32 v2, v2, v95
    v_cmp_eq_u32 vcc, -1, v2
    s_cbranch_vccz L_k5k
    s_add_u32 s29, s29, 1
    s_cmp_ge_u32 s29, 200000
    s_cbranch_scc1 L_k5k
    s_sleep 1
    s_add_u32 s3, s75, 0
    s_nop 0
    buffer_load_dwordx4 v[80:83], v13, s[48:51], s3 offen sc1
    s_add_u32 s3, s75, 57344
    buffer_load_dwordx4 v[84:87], v13, s[48:51], s3 offen sc1
    s_add_u32 s3, s75, 114688
    buffer_load_dwordx4 v[88:91], v13, s[48:51], s3 offen sc1
    s_add_u32 s3, s75, 172032
    buffer_load_dwordx4 v[92:95], v13, s[48:51], s3 offen sc1
    s_waitcnt vmcnt(0)
    s_branch L_k5
L_k5k:
    v_pk_add_f32 v[80:81], v[80:81], v[84:85]
    v_pk_add_f32 v[82:83], v[82:83], v[86:87]
    v_pk_add_f32 v[88:89], v[88:89], v[92:93]
    v_pk_add_f32 v[90:91], v[90:91], v[94:95]
    s_nop 0
    v_permlane32_swap_b32 v80, v88
    v_permlane32_swap_b32 v81, v89
    v_permlane32_swap_b32 v82, v90
    v_permlane32_swap_b32 v83, v91
    v_add_f32 v80, v80, v88
    v_add_f32 v81, v81, v89
    v_add_f32 v82, v82, v90
    v_add_f32 v83, v83, v91
    v_permlane16_swap_b32 v80, v81
    s_nop 0
    v_permlane16_swap_b32 v82, v83
    v_add_f32 v80, v80, v81
    v_add_f32 v82, v82, v83
    s_nop 1
    v_permlane32_swap_b32 v80, v82
    v_cvt_pk_bf16_f32 v80, v80, v80
    v_lshlrev_b32 v80, 16, v80
    v_cvt_pk_bf16_f32 v82, v82, v82
    v_lshlrev_b32 v82, 16, v82
    v_mul_f32 v2, 0xbfb8aa3b, v80
    v_exp_f32 v2, v2
    s_nop 0
    v_add_f32 v2, 1.0, v2
    v_rcp_f32 v2, v2
    s_nop 0
    v_mul_f32 v80, v80, v2
    v_cvt_pk_bf16_f32 v80, v80, v80
    v_lshlrev_b32 v80, 16, v80
    v_mul_f32 v80, v80, v82
    v_cvt_pk_bf16_f32 v80, v80, v80
    v_lshlrev_b32 v80, 16, v80
    v_bfe_u32 v2, v1, 3, 2
    v_lshlrev_b32 v2, 6, v2
    v_lshrrev_b32_e64 v3, 5, v1
    v_lshl_add_u32 v2, v3, 2, v2
    ds_bpermute_b32 v128, v2, v80 offset:0
    ds_bpermute_b32 v130, v2, v80 offset:8
    ds_bpermute_b32 v132, v2, v80 offset:16
    ds_bpermute_b32 v134, v2, v80 offset:24
    ds_bpermute_b32 v136, v2, v80 offset:32
    ds_bpermute_b32 v138, v2, v80 offset:40
    ds_bpermute_b32 v140, v2, v80 offset:48
    v_mov_b64 v[120:121], 0
    v_mov_b64 v[122:123], 0
    v_mov_b64 v[124:125], 0
    v_mov_b64 v[126:127], 0
    s_waitcnt lgkmcnt(0)
    v_lshlrev_b32 v2, 16, v192
    v_and_b32 v3, 0xffff0000, v192
    v_pk_fma_f32 v[120:121], v[2:3], v[128:129], v[120:121] op_sel_hi:[1,0,1]
    v_lshlrev_b32_e64 v4, 16, v193
    v_and_b32 v5, 0xffff0000, v193
    v_pk_fma_f32 v[122:123], v[4:5], v[128:129], v[122:123] op_sel_hi:[1,0,1]
    v_lshlrev_b32_e64 v2, 16, v194
    v_and_b32 v3, 0xffff0000, v194
    v_pk_fma_f32 v[124:125], v[2:3], v[128:129], v[124:125] op_sel_hi:[1,0,1]
    v_lshlrev_b32_e64 v4, 16, v195
    v_and_b32 v5, 0xffff0000, v195
    v_pk_fma_f32 v[126:127], v[4:5], v[128:129], v[126:127] op_sel_hi:[1,0,1]
    v_lshlrev_b32_e64 v2, 16, v196
    v_and_b32 v3, 0xffff0000, v196
    v_pk_fma_f32 v[120:121], v[2:3], v[130:131], v[120:121] op_sel_hi:[1,0,1]
    v_lshlrev_b32_e64 v4, 16, v197
    v_and_b32 v5, 0xffff0000, v197
    v_pk_fma_f32 v[122:123], v[4:5], v[130:131], v[122:123] op_sel_hi:[1,0,1]
    v_lshlrev_b32_e64 v2, 16, v198
    v_and_b32 v3, 0xffff0000, v198
    v_pk_fma_f32 v[124:125], v[2:3], v[130:131], v[124:125] op_sel_hi:[1,0,1]
    v_lshlrev_b32_e64 v4, 16, v199
    v_and_b32 v5, 0xffff0000, v199
    v_pk_fma_f32 v[126:127], v[4:5], v[130:131], v[126:127] op_sel_hi:[1,0,1]
    v_lshlrev_b32_e64 v2, 16, v200
    v_and_b32 v3, 0xffff0000, v200
    v_pk_fma_f32 v[120:121], v[2:3], v[132:133], v[120:121] op_sel_hi:[1,0,1]
    v_lshlrev_b32_e64 v4, 16, v201
    v_and_b32 v5, 0xffff0000, v201
    v_pk_fma_f32 v[122:123], v[4:5], v[132:133], v[122:123] op_sel_hi:[1,0,1]
    v_lshlrev_b32_e64 v2, 16, v202
    v_and_b32 v3, 0xffff0000, v202
    v_pk_fma_f32 v[124:125], v[2:3], v[132:133], v[124:125] op_sel_hi:[1,0,1]
    v_lshlrev_b32_e64 v4, 16, v203
    v_and_b32 v5, 0xffff0000, v203
    v_pk_fma_f32 v[126:127], v[4:5], v[132:133], v[126:127] op_sel_hi:[1,0,1]
    v_lshlrev_b32_e64 v2, 16, v204
    v_and_b32 v3, 0xffff0000, v204
    v_pk_fma_f32 v[120:121], v[2:3], v[134:135], v[120:121] op_sel_hi:[1,0,1]
    v_lshlrev_b32_e64 v4, 16, v205
    v_and_b32 v5, 0xffff0000, v205
    v_pk_fma_f32 v[122:123], v[4:5], v[134:135], v[122:123] op_sel_hi:[1,0,1]
    v_lshlrev_b32_e64 v2, 16, v206
    v_and_b32 v3, 0xffff0000, v206
    v_pk_fma_f32 v[124:125], v[2:3], v[134:135], v[124:125] op_sel_hi:[1,0,1]
    v_lshlrev_b32_e64 v4, 16, v207
    v_and_b32 v5, 0xffff0000, v207
    v_pk_fma_f32 v[126:127], v[4:5], v[134:135], v[126:127] op_sel_hi:[1,0,1]
    v_lshlrev_b32_e64 v2, 16, v208
    v_and_b32 v3, 0xffff0000, v208
    v_pk_fma_f32 v[120:121], v[2:3], v[136:137], v[120:121] op_sel_hi:[1,0,1]
    v_lshlrev_b32_e64 v4, 16, v209
    v_and_b32 v5, 0xffff0000, v209
    v_pk_fma_f32 v[122:123], v[4:5], v[136:137], v[122:123] op_sel_hi:[1,0,1]
    v_lshlrev_b32_e64 v2, 16, v210
    v_and_b32 v3, 0xffff0000, v210
    v_pk_fma_f32 v[124:125], v[2:3], v[136:137], v[124:125] op_sel_hi:[1,0,1]
    v_lshlrev_b32_e64 v4, 16, v211
    v_and_b32 v5, 0xffff0000, v211
    v_pk_fma_f32 v[126:127], v[4:5], v[136:137], v[126:127] op_sel_hi:[1,0,1]
    v_lshlrev_b32_e64 v2, 16, v212
    v_and_b32 v3, 0xffff0000, v212
    v_pk_fma_f32 v[120:121], v[2:3], v[138:139], v[120:121] op_sel_hi:[1,0,1]
    v_lshlrev_b32_e64 v4, 16, v213
    v_and_b32 v5, 0xffff0000, v213
    v_pk_fma_f32 v[122:123], v[4:5], v[138:139], v[122:123] op_sel_hi:[1,0,1]
    v_lshlrev_b32_e64 v2, 16, v214
    v_and_b32 v3, 0xffff0000, v214
    v_pk_fma_f32 v[124:125], v[2:3], v[138:139], v[124:125] op_sel_hi:[1,0,1]
    v_lshlrev_b32_e64 v4, 16, v215
    v_and_b32 v5, 0xffff0000, v215
    v_pk_fma_f32 v[126:127], v[4:5], v[138:139], v[126:127] op_sel_hi:[1,0,1]
    v_lshlrev_b32_e64 v2, 16, v216
    v_and_b32 v3, 0xffff0000, v216
    v_pk_fma_f32 v[120:121], v[2:3], v[140:141], v[120:121] op_sel_hi:[1,0,1]
    v_lshlrev_b32_e64 v4, 16, v217
    v_and_b32 v5, 0xffff0000, v217
    v_pk_fma_f32 v[122:123], v[4:5], v[140:141], v[122:123] op_sel_hi:[1,0,1]
    v_lshlrev_b32_e64 v2, 16, v218
    v_and_b32 v3, 0xffff0000, v218
    v_pk_fma_f32 v[124:125], v[2:3], v[140:141], v[124:125] op_sel_hi:[1,0,1]
    v_lshlrev_b32_e64 v4, 16, v219
    v_and_b32 v5, 0xffff0000, v219
    v_pk_fma_f32 v[126:127], v[4:5], v[140:141], v[126:127] op_sel_hi:[1,0,1]
    v_permlane32_swap_b32 v120, v124
    v_permlane32_swap_b32 v121, v125
    v_permlane32_swap_b32 v122, v126
    v_permlane32_swap_b32 v123, v127
    v_add_f32 v120, v120, v124
    v_add_f32 v121, v121, v125
    v_add_f32 v122, v122, v126
    v_add_f32 v123, v123, v127
    s_nop 0
    v_permlane16_swap_b32 v120, v122
    v_permlane16_swap_b32 v121, v123
    v_add_f32 v120, v120, v122
    v_add_f32 v121, v121, v123
    s_nop 0
    v_add_f32 v120, v120, v120 row_ror:8 row_mask:0xf bank_mask:0xf
    v_add_f32 v121, v121, v121 row_ror:8 row_mask:0xf bank_mask:0xf
    v_and_b32 v2, 8, v1
    v_cmp_eq_u32 vcc, 0, v2
    s_and_b32 s3, s2, 15
    s_lshl_b32 s3, s3, 4
    s_lshr_b32 s28, s2, 4
    s_add_u32 s3, s3, s28
    s_lshl_b32 s3, s3, 2
    s_add_u32 s3, s3, s38
    s_lshl_b32 s3, s3, 8
    s_add_u32 s3, s3, 1413120
    v_cndmask_b32 v120, v121, v120, vcc
    buffer_store_dword v120, v253, s[48:51], s3 offen sc1
    v_and_b32 v3, 3, v1
    v_lshlrev_b32 v3, 2, v3
    v_add_u32 v3, 162112, v3
L_ow:
    ds_read_b32 v2, v3
    s_waitcnt lgkmcnt(0)
    v_cmp_ne_u32 vcc, 7, v2
    s_cbranch_vccz L_owk
    s_sleep 1
    s_branch L_ow
L_owk:
    s_branch L_p3
L_C:
    s_and_b32 s64, s38, 1
    s_lshr_b32 s65, s38, 1
    v_and_b32 v3, 15, v1
    v_lshlrev_b32 v3, 7, v3
    s_lshl_b32 s3, s64, 13
    v_add_u32 v3, s3, v3
    v_bfe_u32 v5, v1, 1, 3
    v_lshrrev_b32 v6, 4, v1
    v_xor_b32 v6, v6, v5
    v_lshl_add_u32 v184, v6, 4, v3
    v_xor_b32 v185, 64, v184
    v_lshrrev_b32 v6, 4, v1
    v_lshlrev_b32 v6, 3, v6
    v_bfe_u32 v7, v1, 2, 2
    v_add_u32 v6, v6, v7
    v_lshlrev_b32 v6, 7, v6
    v_and_b32 v7, 3, v1
    v_lshl_add_u32 v6, v7, 3, v6
    v_add_u32 v6, 16384, v6
    v_bfe_u32 v7, v1, 3, 2
    s_lshl_b32 s3, s65, 1
    v_xor_b32 v7, s3, v7
    v_lshl_add_u32 v186, v7, 5, v6
    v_xor_b32_e64 v187, 32, v186
    v_add_u32 v188, 81920, v184
    v_add_u32 v189, 81920, v185
    v_add_u32 v190, 81920, v186
    v_add_u32 v191, 81920, v187
    s_waitcnt lgkmcnt(0)
    s_mov_b32 s48, s26
    s_mov_b32 s49, s27
    s_mov_b32 s50, 268435456
    s_mov_b32 s51, 0x00020000
    s_mov_b32 s40, s4
    s_mov_b32 s41, s5
    s_mov_b32 s42, 4194304
    s_mov_b32 s43, 0x00020000
    s_mov_b32 s88, s10
    s_mov_b32 s89, s11
    s_mov_b32 s90, 2097152
    s_mov_b32 s91, 0x00020000
    s_lshl_b32 s3, s36, 7
    s_lshl_b32 s28, s37, 3
    s_add_u32 s3, s3, s28
    s_lshl_b32 s28, s38, 1
    s_add_u32 s71, s3, s28
    v_lshlrev_b32 v2, 4, v1
    v_mov_b32 v164, 16384
    v_mov_b32 v4, -1
    v_mov_b32 v5, -1
    v_mov_b32 v6, -1
    v_mov_b32_e64 v7, -1
    s_lshl_b32 s28, s2, 2
    s_add_u32 s28, s28, s38
    s_mul_i32 s28, s28, 768
    s_add_u32 s28, s28, 1048320
    s_lshl_b32 s3, s37, 4
    s_add_u32 s3, s3, s36
    s_lshl_b32 s3, s3, 2
    s_add_u32 s3, s3, s38
    s_lshl_b32 s3, s3, 8
    s_add_u32 s3, s3, 524288
    v_cmp_gt_u32 vcc, 16, v1
    v_add_u32 v3, s3, v2
    v_add_u32_e64 v2, s28, v2
    v_cndmask_b32 v2, v2, v3, vcc
    buffer_store_dwordx4 v[4:7], v2, s[48:51], 0 offen sc1
    buffer_load_dword v164, v164, s[48:51], 0 offen sc1
    s_getpc_b64 s[92:93]
L_pc:
    s_sub_u32 s92, s92, L_pc-recurrent_scan__linear_kernel_hedgehog__moe_arch_mod__prompt_kernel
    s_subb_u32 s93, s93, 0
    s_lshr_b32 s3, s2, 3
    s_lshl_b32 s3, s3, 2
    s_add_u32 s3, s3, s38
    s_lshl_b32 s3, s3, 8
    v_lshlrev_b32 v2, 7, v1
    v_add_u32 v2, s3, v2
    s_mov_b64 exec, 3
    global_load_dword v165, v2, s[92:93]
    s_mov_b64 exec, -1
    v_mov_b64 v[8:9], 0
    v_mov_b64 v[10:11], 0
    v_mov_b64 v[12:13], 0
    v_mov_b64 v[14:15], 0
    v_mov_b64 v[16:17], 0
    v_mov_b64 v[18:19], 0
    v_mov_b64 v[20:21], 0
    v_mov_b64 v[22:23], 0
    v_mov_b64 v[24:25], 0
    v_mov_b64 v[26:27], 0
    v_mov_b64 v[28:29], 0
    v_mov_b64 v[30:31], 0
    v_mov_b64 v[32:33], 0
    v_mov_b64 v[34:35], 0
    v_mov_b64 v[36:37], 0
    v_mov_b64 v[38:39], 0
    v_mov_b64 v[40:41], 0
    v_mov_b64 v[42:43], 0
    v_mov_b64 v[44:45], 0
    v_mov_b64 v[46:47], 0
    v_mov_b64 v[48:49], 0
    v_mov_b64 v[50:51], 0
    v_mov_b64 v[52:53], 0
    v_mov_b64 v[54:55], 0
    v_mov_b64 v[56:57], 0
    v_mov_b64 v[58:59], 0
    v_mov_b64 v[60:61], 0
    v_mov_b64 v[62:63], 0
    v_mov_b64 v[64:65], 0
    v_mov_b64 v[66:67], 0
    v_mov_b64 v[68:69], 0
    v_mov_b64 v[70:71], 0
    v_mov_b64 v[72:73], 0
    v_mov_b64 v[74:75], 0
    v_mov_b64 v[76:77], 0
    v_mov_b64 v[78:79], 0
    v_mov_b64 v[80:81], 0
    v_mov_b64 v[82:83], 0
    v_mov_b64 v[84:85], 0
    v_mov_b64 v[86:87], 0
    v_mov_b64 v[88:89], 0
    v_mov_b64 v[90:91], 0
    v_mov_b64 v[92:93], 0
    v_mov_b64 v[94:95], 0
    v_mov_b64 v[96:97], 0
    v_mov_b64 v[98:99], 0
    v_mov_b64 v[100:101], 0
    v_mov_b64 v[102:103], 0
    s_lshl_b32 s3, s38, 2
    s_add_u32 s3, s3, 162112
    v_mov_b32 v2, s3
    v_mov_b32_e64 v3, 0
    ds_write_b32 v2, v3
    ds_write_b32 v2, v3 offset:16
    s_mov_b32 s86, 0
    s_mov_b32 s66, 0
    s_setprio 2
    s_waitcnt lgkmcnt(0)
    s_lshl_b32 s3, s38, 1
    s_lshr_b32 s28, s39, 2
    s_add_u32 s3, s3, s28
    s_lshl_b32 s69, s3, 4
    v_and_b32 v237, 15, v1
    v_add_u32 v236, s69, v237
    v_lshlrev_b32 v236, 7, v236
    v_lshrrev_b32 v237, 1, v237
    v_lshrrev_b32 v238, 5, v1
    v_xor_b32 v237, v237, v238
    v_lshl_add_u32 v236, v237, 4, v236
    v_bfe_u32 v238, v1, 4, 1
    v_lshl_add_u32 v236, v238, 3, v236
    v_xor_b32 v237, 32, v236
    v_xor_b32 v238, 64, v236
    v_xor_b32 v239, 96, v236
    v_and_b32 v2, 15, v1
    v_lshrrev_b32_e64 v3, 4, v1
    s_lshl_b32 s3, s64, 8
    s_add_u32 s3, s3, 152064
    v_lshl_add_u32 v232, v2, 2, s3
    v_lshl_add_u32 v233, v3, 4, s3
    v_lshrrev_b32 v7, 5, v1
    v_lshl_add_u32 v234, v7, 6, v232
    s_lshl_b32 s3, s65, 7
    s_add_u32 s3, s3, 154880
    v_lshl_add_u32 v235, v3, 4, s3
    v_lshl_add_u32 v248, v2, 2, s3
    s_lshl_b32 s3, s64, 7
    s_add_u32 s3, s3, 154624
    v_lshl_add_u32 v249, v3, 4, s3
    v_xor_b32 v253, 128, v249
    v_lshrrev_b32 v250, 2, v1
    v_lshlrev_b32 v250, 6, v250
    v_and_b32 v251, 3, v1
    v_lshl_add_u32 v250, v251, 3, v250
    s_lshl_b32 s3, s65, 11
    s_add_u32 s3, s3, 147712
    v_add_u32 v252, s3, v250
    v_bfe_u32 v5, v1, 1, 2
    v_lshlrev_b32_e64 v5, 2, v5
    v_bfe_u32 v4, v1, 3, 1
    v_lshl_add_u32 v5, v4, 1, v5
    v_and_b32 v4, 1, v1
    v_add_u32 v5, v5, v4
    v_xor_b32 v5, v5, v3
    s_lshl_b32 s3, s38, 13
    s_add_u32 s3, s3, 98304
    v_lshl_add_u32 v2, v2, 7, s3
    v_lshl_add_u32 v4, v5, 3, v2
    v_xor_b32 v5, 32, v4
    v_xor_b32 v6, 64, v4
    v_xor_b32 v7, 96, v4
    v_bfe_u32 v2, v1, 3, 2
    v_lshlrev_b32 v2, 2, v2
    v_lshrrev_b32 v3, 5, v1
    v_lshl_add_u32 v2, v3, 1, v2
    v_bfe_u32 v3, v1, 2, 1
    v_add_u32 v2, v2, v3
    v_xor_b32 v2, v2, v251
    v_lshrrev_b32_e64 v3, 2, v1
    v_lshl_add_u32 v3, v3, 7, s3
    v_lshl_add_u32 v2, v2, 3, v3
    s_lshl_b32 s28, s64, 6
    v_xor_b32 v201, s28, v2
    v_xor_b32 v203, 32, v201
    s_lshl_b32 s3, s38, 12
    s_add_u32 s3, s3, 131072
    v_lshlrev_b32 v199, 4, v1
    v_add_u32 v197, s3, v199
    s_lshl_b32 s3, s37, 1
    s_add_u32 s67, s3, s65
    s_lshl_b32 s3, s67, 4
    s_add_u32 s3, s3, s36
    s_mul_i32 s3, s3, 4224
    s_add_u32 s75, s3, 8388608
    s_lshl_b32 s3, s64, 11
    s_add_u32 s74, s75, s3
    s_lshl_b32 s3, s64, 6
    s_add_u32 s75, s75, s3
    s_add_u32 s75, s75, 4096
    s_lshl_b32 s3, s37, 4
    s_add_u32 s3, s3, s36
    s_lshl_b32 s3, s3, 7
    s_add_u32 s3, s3, 32768
    s_cmp_lg_u32 s38, 0
    s_cselect_b32 s76, 268435456, s3
L_ln:
    s_lshl_b32 s3, s38, 12
    s_add_u32 s3, s3, 131072
    v_lshlrev_b32 v2, 4, v1
    v_add_u32 v3, s3, v2
    v_add_u32 v2, 122880, v2
    s_barrier
    ds_read_b128 v[120:123], v2 offset:0
    ds_read_b128 v[124:127], v2 offset:1024
    ds_read_b128 v[104:107], v3 offset:0
    ds_read_b128 v[108:111], v3 offset:1024
    ds_read_b128 v[112:115], v3 offset:2048
    ds_read_b128 v[116:119], v3 offset:3072
    v_mov_b32 v2, 0x3f803f80
    v_mov_b32 v144, 0
    v_mov_b32 v146, 0
    v_mov_b32 v148, 0
    v_mov_b32 v150, 0
    v_mov_b32 v152, 0
    v_mov_b32 v154, 0
    v_mov_b32 v156, 0
    v_mov_b32 v158, 0
    s_waitcnt lgkmcnt(2)
    v_dot2c_f32_bf16 v144, v104, v2
    v_dot2c_f32_bf16 v148, v104, v104
    v_dot2c_f32_bf16 v152, v104, v120
    v_dot2c_f32_bf16 v156, v120, v2
    v_dot2c_f32_bf16 v144, v105, v2
    v_dot2c_f32_bf16 v148, v105, v105
    v_dot2c_f32_bf16 v152, v105, v121
    v_dot2c_f32_bf16 v156, v121, v2
    v_dot2c_f32_bf16 v144, v106, v2
    v_dot2c_f32_bf16 v148, v106, v106
    v_dot2c_f32_bf16 v152, v106, v122
    v_dot2c_f32_bf16 v156, v122, v2
    v_dot2c_f32_bf16 v144, v107, v2
    v_dot2c_f32_bf16 v148, v107, v107
    v_dot2c_f32_bf16 v152, v107, v123
    v_dot2c_f32_bf16 v156, v123, v2
    v_dot2c_f32_bf16 v144, v108, v2
    v_dot2c_f32_bf16 v148, v108, v108
    v_dot2c_f32_bf16 v152, v108, v124
    v_dot2c_f32_bf16 v156, v124, v2
    v_dot2c_f32_bf16 v144, v109, v2
    v_dot2c_f32_bf16 v148, v109, v109
    v_dot2c_f32_bf16 v152, v109, v125
    v_dot2c_f32_bf16 v156, v125, v2
    v_dot2c_f32_bf16 v144, v110, v2
    v_dot2c_f32_bf16 v148, v110, v110
    v_dot2c_f32_bf16 v152, v110, v126
    v_dot2c_f32_bf16 v156, v126, v2
    v_dot2c_f32_bf16 v144, v111, v2
    v_dot2c_f32_bf16 v148, v111, v111
    v_dot2c_f32_bf16 v152, v111, v127
    v_dot2c_f32_bf16 v156, v127, v2
    s_waitcnt lgkmcnt(0)
    v_dot2c_f32_bf16 v146, v112, v2
    v_dot2c_f32_bf16 v150, v112, v112
    v_dot2c_f32_bf16 v154, v112, v120
    v_dot2c_f32_bf16 v158, v120, v2
    v_dot2c_f32_bf16 v146, v113, v2
    v_dot2c_f32_bf16 v150, v113, v113
    v_dot2c_f32_bf16 v154, v113, v121
    v_dot2c_f32_bf16 v158, v121, v2
    v_dot2c_f32_bf16 v146, v114, v2
    v_dot2c_f32_bf16 v150, v114, v114
    v_dot2c_f32_bf16 v154, v114, v122
    v_dot2c_f32_bf16 v158, v122, v2
    v_dot2c_f32_bf16 v146, v115, v2
    v_dot2c_f32_bf16 v150, v115, v115
    v_dot2c_f32_bf16 v154, v115, v123
    v_dot2c_f32_bf16 v158, v123, v2
    v_dot2c_f32_bf16 v146, v116, v2
    v_dot2c_f32_bf16 v150, v116, v116
    v_dot2c_f32_bf16 v154, v116, v124
    v_dot2c_f32_bf16 v158, v124, v2
    v_dot2c_f32_bf16 v146, v117, v2
    v_dot2c_f32_bf16 v150, v117, v117
    v_dot2c_f32_bf16 v154, v117, v125
    v_dot2c_f32_bf16 v158, v125, v2
    v_dot2c_f32_bf16 v146, v118, v2
    v_dot2c_f32_bf16 v150, v118, v118
    v_dot2c_f32_bf16 v154, v118, v126
    v_dot2c_f32_bf16 v158, v126, v2
    v_dot2c_f32_bf16 v146, v119, v2
    v_dot2c_f32_bf16 v150, v119, v119
    v_dot2c_f32_bf16 v154, v119, v127
    v_dot2c_f32_bf16 v158, v127, v2
    v_permlane32_swap_b32 v144, v146
    v_permlane32_swap_b32 v148, v150
    v_permlane32_swap_b32 v152, v154
    v_permlane32_swap_b32 v156, v158
    v_add_f32 v144, v144, v146
    v_add_f32 v148, v148, v150
    v_add_f32 v152, v152, v154
    v_add_f32 v156, v156, v158
    v_add_f32 v144, v144, v144 quad_perm:[1,0,3,2] row_mask:0xf bank_mask:0xf
    v_add_f32 v148, v148, v148 quad_perm:[1,0,3,2] row_mask:0xf bank_mask:0xf
    v_add_f32 v152, v152, v152 quad_perm:[1,0,3,2] row_mask:0xf bank_mask:0xf
    v_add_f32 v156, v156, v156 quad_perm:[1,0,3,2] row_mask:0xf bank_mask:0xf
    v_add_f32 v144, v144, v144 quad_perm:[2,3,0,1] row_mask:0xf bank_mask:0xf
    v_add_f32 v148, v148, v148 quad_perm:[2,3,0,1] row_mask:0xf bank_mask:0xf
    v_add_f32 v152, v152, v152 quad_perm:[2,3,0,1] row_mask:0xf bank_mask:0xf
    v_add_f32 v156, v156, v156 quad_perm:[2,3,0,1] row_mask:0xf bank_mask:0xf
    v_add_f32 v144, v144, v144 row_half_mirror row_mask:0xf bank_mask:0xf
    v_add_f32 v148, v148, v148 row_half_mirror row_mask:0xf bank_mask:0xf
    v_add_f32 v152, v152, v152 row_half_mirror row_mask:0xf bank_mask:0xf
    v_add_f32 v156, v156, v156 row_half_mirror row_mask:0xf bank_mask:0xf
    v_add_f32 v144, v144, v144 row_mirror row_mask:0xf bank_mask:0xf
    v_add_f32 v148, v148, v148 row_mirror row_mask:0xf bank_mask:0xf
    v_add_f32 v152, v152, v152 row_mirror row_mask:0xf bank_mask:0xf
    v_add_f32 v156, v156, v156 row_mirror row_mask:0xf bank_mask:0xf
    v_mov_b32 v145, v144
    v_mov_b32 v149, v148
    v_mov_b32 v153, v152
    v_mov_b32 v157, v156
    v_permlane16_swap_b32 v144, v145
    v_permlane16_swap_b32 v148, v149
    v_permlane16_swap_b32 v152, v153
    v_permlane16_swap_b32 v156, v157
    v_add_f32 v144, v144, v145
    v_add_f32 v148, v148, v149
    v_add_f32 v152, v152, v153
    v_add_f32 v156, v156, v157
    v_mul_f32 v144, 0x3a800000, v144
    v_mul_f32 v148, 0x3a800000, v148
    v_cvt_pk_bf16_f32 v145, v144, v144
    v_lshlrev_b32 v145, 16, v145
    v_fma_f32 v148, -v144, v144, v148
    v_max_f32 v148, 0, v148
    v_fma_f32 v152, -v145, v156, v152
    s_waitcnt vmcnt(0)
    v_cvt_pk_bf16_f32 v148, v148, v148
    v_lshlrev_b32 v148, 16, v148
    v_add_f32 v148, 0x3727c5ac, v148
    v_cvt_pk_bf16_f32 v148, v148, v148
    v_lshlrev_b32 v148, 16, v148
    v_sqrt_f32 v148, v148
    s_nop 0
    v_cvt_pk_bf16_f32 v148, v148, v148
    v_lshlrev_b32 v148, 16, v148
    v_rcp_f32 v2, v148
    v_lshrrev_b32 v3, 16, v145
    v_or_b32 v160, v3, v148
    v_mul_f32 v152, v152, v2
    v_cvt_pk_bf16_f32 v152, v152, v152
    v_lshlrev_b32 v152, 16, v152
    v_ashrrev_i32 v2, 31, v152
    v_or_b32 v2, 0x80000000, v2
    v_xor_b32 v2, v152, v2
    v_and_b32 v2, 0xffff0000, v2
    v_lshrrev_b32 v3, 5, v1
    v_add_u32 v161, s71, v3
    v_sub_u32 v161, 2047, v161
    v_or_b32 v162, v2, v161
    v_mov_b32 v2, v162
    v_mov_b32 v161, v160
    v_readfirstlane_b32 s86, v164
    v_mov_b32 v3, 0
    s_mul_i32 s86, s86, 1664525
    s_add_u32 s86, s86, 1013904223
    v_mov_b32 v163, s86
    v_permlane32_swap_b32 v162, v2
    v_permlane32_swap_b32 v160, v161
    v_max_u32 v162, v162, v2
    s_lshl_b32 s3, s71, 3
    s_mov_b64 exec, 1
    buffer_store_dwordx4 v[160:163], v3, s[48:51], s3 offen sc1
    s_mov_b64 exec, -1
    v_mov_b32_e64 v251, s86
    s_barrier
    ds_read_b128 v[104:107], v184 offset:0
    ds_read_b64_tr_b16 v[120:121], v186 offset:0
    ds_read_b64_tr_b16 v[122:123], v186 offset:512
    ds_read_b64_tr_b16 v[124:125], v187 offset:0
    ds_read_b64_tr_b16 v[126:127], v187 offset:512
    ds_read_b64_tr_b16 v[128:129], v186 offset:8192
    ds_read_b64_tr_b16 v[130:131], v186 offset:8704
    ds_read_b64_tr_b16 v[132:133], v187 offset:8192
    ds_read_b64_tr_b16 v[134:135], v187 offset:8704
    ds_read_b64_tr_b16 v[136:137], v186 offset:16384
    ds_read_b64_tr_b16 v[138:139], v186 offset:16896
    ds_read_b64_tr_b16 v[140:141], v187 offset:16384
    ds_read_b64_tr_b16 v[142:143], v187 offset:16896
    ds_read_b128 v[108:111], v184 offset:2048
    ds_read_b128 v[112:115], v184 offset:4096
    ds_read_b128 v[116:119], v184 offset:6144
    s_branch L_cmid
.p2align 6
L_cloop:
    s_waitcnt lgkmcnt(0)
    s_barrier
    v_mfma_f32_16x16x32_bf16 v[8:11], v[160:163], v[144:147], v[8:11]
    ds_read_b128 v[104:107], v184 offset:0
    v_mfma_f32_16x16x32_bf16 v[12:15], v[164:167], v[144:147], v[12:15]
    ds_read_b64_tr_b16 v[120:121], v186 offset:0
    v_mfma_f32_16x16x32_bf16 v[16:19], v[168:171], v[144:147], v[16:19]
    ds_read_b64_tr_b16 v[122:123], v186 offset:512
    v_mfma_f32_16x16x32_bf16 v[20:23], v[172:175], v[144:147], v[20:23]
    ds_read_b64_tr_b16 v[124:125], v187 offset:0
    v_mfma_f32_16x16x32_bf16 v[24:27], v[144:147], v[176:179], v[24:27]
    ds_read_b64_tr_b16 v[126:127], v187 offset:512
    v_mfma_f32_16x16x32_bf16 v[28:31], v[144:147], v[180:183], v[28:31]
    ds_read_b64_tr_b16 v[128:129], v186 offset:8192
    v_mfma_f32_16x16x32_bf16 v[32:35], v[160:163], v[148:151], v[32:35]
    ds_read_b64_tr_b16 v[130:131], v186 offset:8704
    v_mfma_f32_16x16x32_bf16 v[36:39], v[164:167], v[148:151], v[36:39]
    ds_read_b64_tr_b16 v[132:133], v187 offset:8192
    v_mfma_f32_16x16x32_bf16 v[40:43], v[168:171], v[148:151], v[40:43]
    ds_read_b64_tr_b16 v[134:135], v187 offset:8704
    v_mfma_f32_16x16x32_bf16 v[44:47], v[172:175], v[148:151], v[44:47]
    ds_read_b64_tr_b16 v[136:137], v186 offset:16384
    v_mfma_f32_16x16x32_bf16 v[48:51], v[148:151], v[176:179], v[48:51]
    ds_read_b64_tr_b16 v[138:139], v186 offset:16896
    v_mfma_f32_16x16x32_bf16 v[52:55], v[148:151], v[180:183], v[52:55]
    ds_read_b64_tr_b16 v[140:141], v187 offset:16384
    v_mfma_f32_16x16x32_bf16 v[56:59], v[160:163], v[152:155], v[56:59]
    ds_read_b64_tr_b16 v[142:143], v187 offset:16896
    v_mfma_f32_16x16x32_bf16 v[60:63], v[164:167], v[152:155], v[60:63]
    ds_read_b128 v[108:111], v184 offset:2048
    v_mfma_f32_16x16x32_bf16 v[64:67], v[168:171], v[152:155], v[64:67]
    ds_read_b128 v[112:115], v184 offset:4096
    v_mfma_f32_16x16x32_bf16 v[68:71], v[172:175], v[152:155], v[68:71]
    ds_read_b128 v[116:119], v184 offset:6144
    v_mfma_f32_16x16x32_bf16 v[72:75], v[152:155], v[176:179], v[72:75]
    v_mfma_f32_16x16x32_bf16 v[76:79], v[152:155], v[180:183], v[76:79]
    v_mfma_f32_16x16x32_bf16 v[80:83], v[160:163], v[156:159], v[80:83]
    v_mfma_f32_16x16x32_bf16 v[84:87], v[164:167], v[156:159], v[84:87]
    v_mfma_f32_16x16x32_bf16 v[88:91], v[168:171], v[156:159], v[88:91]
    v_mfma_f32_16x16x32_bf16 v[92:95], v[172:175], v[156:159], v[92:95]
    v_mfma_f32_16x16x32_bf16 v[96:99], v[156:159], v[176:179], v[96:99]
    v_mfma_f32_16x16x32_bf16 v[100:103], v[156:159], v[180:183], v[100:103]
L_cmid:
    s_waitcnt lgkmcnt(0)
    s_nop 0
    v_mfma_f32_16x16x32_bf16 v[8:11], v[120:123], v[104:107], v[8:11]
    ds_read_b128 v[144:147], v185 offset:0
    v_mfma_f32_16x16x32_bf16 v[12:15], v[124:127], v[104:107], v[12:15]
    ds_read_b64_tr_b16 v[160:161], v186 offset:4096
    v_mfma_f32_16x16x32_bf16 v[16:19], v[128:131], v[104:107], v[16:19]
    ds_read_b64_tr_b16 v[162:163], v186 offset:4608
    v_mfma_f32_16x16x32_bf16 v[20:23], v[132:135], v[104:107], v[20:23]
    ds_read_b64_tr_b16 v[164:165], v187 offset:4096
    v_mfma_f32_16x16x32_bf16 v[24:27], v[104:107], v[136:139], v[24:27]
    ds_read_b64_tr_b16 v[166:167], v187 offset:4608
    v_mfma_f32_16x16x32_bf16 v[28:31], v[104:107], v[140:143], v[28:31]
    ds_read_b64_tr_b16 v[168:169], v186 offset:12288
    v_mfma_f32_16x16x32_bf16 v[32:35], v[120:123], v[108:111], v[32:35]
    ds_read_b64_tr_b16 v[170:171], v186 offset:12800
    v_mfma_f32_16x16x32_bf16 v[36:39], v[124:127], v[108:111], v[36:39]
    ds_read_b64_tr_b16 v[172:173], v187 offset:12288
    v_mfma_f32_16x16x32_bf16 v[40:43], v[128:131], v[108:111], v[40:43]
    ds_read_b64_tr_b16 v[174:175], v187 offset:12800
    v_mfma_f32_16x16x32_bf16 v[44:47], v[132:135], v[108:111], v[44:47]
    ds_read_b64_tr_b16 v[176:177], v186 offset:20480
    v_mfma_f32_16x16x32_bf16 v[48:51], v[108:111], v[136:139], v[48:51]
    ds_read_b64_tr_b16 v[178:179], v186 offset:20992
    v_mfma_f32_16x16x32_bf16 v[52:55], v[108:111], v[140:143], v[52:55]
    ds_read_b64_tr_b16 v[180:181], v187 offset:20480
    v_mfma_f32_16x16x32_bf16 v[56:59], v[120:123], v[112:115], v[56:59]
    ds_read_b64_tr_b16 v[182:183], v187 offset:20992
    v_mfma_f32_16x16x32_bf16 v[60:63], v[124:127], v[112:115], v[60:63]
    ds_read_b128 v[148:151], v185 offset:2048
    v_mfma_f32_16x16x32_bf16 v[64:67], v[128:131], v[112:115], v[64:67]
    ds_read_b128 v[152:155], v185 offset:4096
    v_mfma_f32_16x16x32_bf16 v[68:71], v[132:135], v[112:115], v[68:71]
    ds_read_b128 v[156:159], v185 offset:6144
    v_mfma_f32_16x16x32_bf16 v[72:75], v[112:115], v[136:139], v[72:75]
    v_mfma_f32_16x16x32_bf16 v[76:79], v[112:115], v[140:143], v[76:79]
    v_mfma_f32_16x16x32_bf16 v[80:83], v[120:123], v[116:119], v[80:83]
    v_mfma_f32_16x16x32_bf16 v[84:87], v[124:127], v[116:119], v[84:87]
    v_mfma_f32_16x16x32_bf16 v[88:91], v[128:131], v[116:119], v[88:91]
    v_mfma_f32_16x16x32_bf16 v[92:95], v[132:135], v[116:119], v[92:95]
    v_mfma_f32_16x16x32_bf16 v[96:99], v[116:119], v[136:139], v[96:99]
    v_mfma_f32_16x16x32_bf16 v[100:103], v[116:119], v[140:143], v[100:103]
    s_waitcnt lgkmcnt(0)
    s_barrier
    v_mfma_f32_16x16x32_bf16 v[8:11], v[160:163], v[144:147], v[8:11]
    ds_read_b128 v[104:107], v184 offset:40960
    v_mfma_f32_16x16x32_bf16 v[12:15], v[164:167], v[144:147], v[12:15]
    ds_read_b64_tr_b16 v[120:121], v186 offset:40960
    v_mfma_f32_16x16x32_bf16 v[16:19], v[168:171], v[144:147], v[16:19]
    ds_read_b64_tr_b16 v[122:123], v186 offset:41472
    v_mfma_f32_16x16x32_bf16 v[20:23], v[172:175], v[144:147], v[20:23]
    ds_read_b64_tr_b16 v[124:125], v187 offset:40960
    v_mfma_f32_16x16x32_bf16 v[24:27], v[144:147], v[176:179], v[24:27]
    ds_read_b64_tr_b16 v[126:127], v187 offset:41472
    v_mfma_f32_16x16x32_bf16 v[28:31], v[144:147], v[180:183], v[28:31]
    ds_read_b64_tr_b16 v[128:129], v186 offset:49152
    v_mfma_f32_16x16x32_bf16 v[32:35], v[160:163], v[148:151], v[32:35]
    ds_read_b64_tr_b16 v[130:131], v186 offset:49664
    v_mfma_f32_16x16x32_bf16 v[36:39], v[164:167], v[148:151], v[36:39]
    ds_read_b64_tr_b16 v[132:133], v187 offset:49152
    v_mfma_f32_16x16x32_bf16 v[40:43], v[168:171], v[148:151], v[40:43]
    ds_read_b64_tr_b16 v[134:135], v187 offset:49664
    v_mfma_f32_16x16x32_bf16 v[44:47], v[172:175], v[148:151], v[44:47]
    ds_read_b64_tr_b16 v[136:137], v186 offset:57344
    v_mfma_f32_16x16x32_bf16 v[48:51], v[148:151], v[176:179], v[48:51]
    ds_read_b64_tr_b16 v[138:139], v186 offset:57856
    v_mfma_f32_16x16x32_bf16 v[52:55], v[148:151], v[180:183], v[52:55]
    ds_read_b64_tr_b16 v[140:141], v187 offset:57344
    v_mfma_f32_16x16x32_bf16 v[56:59], v[160:163], v[152:155], v[56:59]
    ds_read_b64_tr_b16 v[142:143], v187 offset:57856
    v_mfma_f32_16x16x32_bf16 v[60:63], v[164:167], v[152:155], v[60:63]
    ds_read_b128 v[108:111], v184 offset:43008
    v_mfma_f32_16x16x32_bf16 v[64:67], v[168:171], v[152:155], v[64:67]
    ds_read_b128 v[112:115], v184 offset:45056
    v_mfma_f32_16x16x32_bf16 v[68:71], v[172:175], v[152:155], v[68:71]
    ds_read_b128 v[116:119], v184 offset:47104
    v_mfma_f32_16x16x32_bf16 v[72:75], v[152:155], v[176:179], v[72:75]
    v_mfma_f32_16x16x32_bf16 v[76:79], v[152:155], v[180:183], v[76:79]
    v_mfma_f32_16x16x32_bf16 v[80:83], v[160:163], v[156:159], v[80:83]
    v_mfma_f32_16x16x32_bf16 v[84:87], v[164:167], v[156:159], v[84:87]
    v_mfma_f32_16x16x32_bf16 v[88:91], v[168:171], v[156:159], v[88:91]
    v_mfma_f32_16x16x32_bf16 v[92:95], v[172:175], v[156:159], v[92:95]
    v_mfma_f32_16x16x32_bf16 v[96:99], v[156:159], v[176:179], v[96:99]
    v_mfma_f32_16x16x32_bf16 v[100:103], v[156:159], v[180:183], v[100:103]
    s_waitcnt lgkmcnt(0)
    s_nop 0
    v_mfma_f32_16x16x32_bf16 v[8:11], v[120:123], v[104:107], v[8:11]
    ds_read_b128 v[144:147], v185 offset:40960
    v_mfma_f32_16x16x32_bf16 v[12:15], v[124:127], v[104:107], v[12:15]
    ds_read_b64_tr_b16 v[160:161], v186 offset:45056
    v_mfma_f32_16x16x32_bf16 v[16:19], v[128:131], v[104:107], v[16:19]
    ds_read_b64_tr_b16 v[162:163], v186 offset:45568
    v_mfma_f32_16x16x32_bf16 v[20:23], v[132:135], v[104:107], v[20:23]
    ds_read_b64_tr_b16 v[164:165], v187 offset:45056
    v_mfma_f32_16x16x32_bf16 v[24:27], v[104:107], v[136:139], v[24:27]
    ds_read_b64_tr_b16 v[166:167], v187 offset:45568
    v_mfma_f32_16x16x32_bf16 v[28:31], v[104:107], v[140:143], v[28:31]
    ds_read_b64_tr_b16 v[168:169], v186 offset:53248
    v_mfma_f32_16x16x32_bf16 v[32:35], v[120:123], v[108:111], v[32:35]
    ds_read_b64_tr_b16 v[170:171], v186 offset:53760
    v_mfma_f32_16x16x32_bf16 v[36:39], v[124:127], v[108:111], v[36:39]
    ds_read_b64_tr_b16 v[172:173], v187 offset:53248
    v_mfma_f32_16x16x32_bf16 v[40:43], v[128:131], v[108:111], v[40:43]
    ds_read_b64_tr_b16 v[174:175], v187 offset:53760
    v_mfma_f32_16x16x32_bf16 v[44:47], v[132:135], v[108:111], v[44:47]
    ds_read_b64_tr_b16 v[176:177], v186 offset:61440
    v_mfma_f32_16x16x32_bf16 v[48:51], v[108:111], v[136:139], v[48:51]
    ds_read_b64_tr_b16 v[178:179], v186 offset:61952
    v_mfma_f32_16x16x32_bf16 v[52:55], v[108:111], v[140:143], v[52:55]
    ds_read_b64_tr_b16 v[180:181], v187 offset:61440
    v_mfma_f32_16x16x32_bf16 v[56:59], v[120:123], v[112:115], v[56:59]
    ds_read_b64_tr_b16 v[182:183], v187 offset:61952
    v_mfma_f32_16x16x32_bf16 v[60:63], v[124:127], v[112:115], v[60:63]
    ds_read_b128 v[148:151], v185 offset:43008
    v_mfma_f32_16x16x32_bf16 v[64:67], v[128:131], v[112:115], v[64:67]
    ds_read_b128 v[152:155], v185 offset:45056
    v_mfma_f32_16x16x32_bf16 v[68:71], v[132:135], v[112:115], v[68:71]
    ds_read_b128 v[156:159], v185 offset:47104
    v_mfma_f32_16x16x32_bf16 v[72:75], v[112:115], v[136:139], v[72:75]
    v_mfma_f32_16x16x32_bf16 v[76:79], v[112:115], v[140:143], v[76:79]
    v_mfma_f32_16x16x32_bf16 v[80:83], v[120:123], v[116:119], v[80:83]
    v_mfma_f32_16x16x32_bf16 v[84:87], v[124:127], v[116:119], v[84:87]
    v_mfma_f32_16x16x32_bf16 v[88:91], v[128:131], v[116:119], v[88:91]
    v_mfma_f32_16x16x32_bf16 v[92:95], v[132:135], v[116:119], v[92:95]
    v_mfma_f32_16x16x32_bf16 v[96:99], v[116:119], v[136:139], v[96:99]
    v_mfma_f32_16x16x32_bf16 v[100:103], v[116:119], v[140:143], v[100:103]
    s_waitcnt lgkmcnt(0)
    s_barrier
    v_mfma_f32_16x16x32_bf16 v[8:11], v[160:163], v[144:147], v[8:11]
    ds_read_b128 v[104:107], v188 offset:0
    v_mfma_f32_16x16x32_bf16 v[12:15], v[164:167], v[144:147], v[12:15]
    ds_read_b64_tr_b16 v[120:121], v190 offset:0
    v_mfma_f32_16x16x32_bf16 v[16:19], v[168:171], v[144:147], v[16:19]
    ds_read_b64_tr_b16 v[122:123], v190 offset:512
    v_mfma_f32_16x16x32_bf16 v[20:23], v[172:175], v[144:147], v[20:23]
    ds_read_b64_tr_b16 v[124:125], v191 offset:0
    v_mfma_f32_16x16x32_bf16 v[24:27], v[144:147], v[176:179], v[24:27]
    ds_read_b64_tr_b16 v[126:127], v191 offset:512
    v_mfma_f32_16x16x32_bf16 v[28:31], v[144:147], v[180:183], v[28:31]
    ds_read_b64_tr_b16 v[128:129], v190 offset:8192
    v_mfma_f32_16x16x32_bf16 v[32:35], v[160:163], v[148:151], v[32:35]
    ds_read_b64_tr_b16 v[130:131], v190 offset:8704
    v_mfma_f32_16x16x32_bf16 v[36:39], v[164:167], v[148:151], v[36:39]
    ds_read_b64_tr_b16 v[132:133], v191 offset:8192
    v_mfma_f32_16x16x32_bf16 v[40:43], v[168:171], v[148:151], v[40:43]
    ds_read_b64_tr_b16 v[134:135], v191 offset:8704
    v_mfma_f32_16x16x32_bf16 v[44:47], v[172:175], v[148:151], v[44:47]
    ds_read_b64_tr_b16 v[136:137], v190 offset:16384
    v_mfma_f32_16x16x32_bf16 v[48:51], v[148:151], v[176:179], v[48:51]
    ds_read_b64_tr_b16 v[138:139], v190 offset:16896
    v_mfma_f32_16x16x32_bf16 v[52:55], v[148:151], v[180:183], v[52:55]
    ds_read_b64_tr_b16 v[140:141], v191 offset:16384
    v_mfma_f32_16x16x32_bf16 v[56:59], v[160:163], v[152:155], v[56:59]
    ds_read_b64_tr_b16 v[142:143], v191 offset:16896
    v_mfma_f32_16x16x32_bf16 v[60:63], v[164:167], v[152:155], v[60:63]
    ds_read_b128 v[108:111], v188 offset:2048
    v_mfma_f32_16x16x32_bf16 v[64:67], v[168:171], v[152:155], v[64:67]
    ds_read_b128 v[112:115], v188 offset:4096
    v_mfma_f32_16x16x32_bf16 v[68:71], v[172:175], v[152:155], v[68:71]
    ds_read_b128 v[116:119], v188 offset:6144
    v_mfma_f32_16x16x32_bf16 v[72:75], v[152:155], v[176:179], v[72:75]
    v_mfma_f32_16x16x32_bf16 v[76:79], v[152:155], v[180:183], v[76:79]
    v_mfma_f32_16x16x32_bf16 v[80:83], v[160:163], v[156:159], v[80:83]
    v_mfma_f32_16x16x32_bf16 v[84:87], v[164:167], v[156:159], v[84:87]
    v_mfma_f32_16x16x32_bf16 v[88:91], v[168:171], v[156:159], v[88:91]
    v_mfma_f32_16x16x32_bf16 v[92:95], v[172:175], v[156:159], v[92:95]
    v_mfma_f32_16x16x32_bf16 v[96:99], v[156:159], v[176:179], v[96:99]
    v_mfma_f32_16x16x32_bf16 v[100:103], v[156:159], v[180:183], v[100:103]
    s_waitcnt lgkmcnt(0)
    s_nop 0
    v_mfma_f32_16x16x32_bf16 v[8:11], v[120:123], v[104:107], v[8:11]
    ds_read_b128 v[144:147], v189 offset:0
    v_mfma_f32_16x16x32_bf16 v[12:15], v[124:127], v[104:107], v[12:15]
    ds_read_b64_tr_b16 v[160:161], v190 offset:4096
    v_mfma_f32_16x16x32_bf16 v[16:19], v[128:131], v[104:107], v[16:19]
    ds_read_b64_tr_b16 v[162:163], v190 offset:4608
    v_mfma_f32_16x16x32_bf16 v[20:23], v[132:135], v[104:107], v[20:23]
    ds_read_b64_tr_b16 v[164:165], v191 offset:4096
    v_mfma_f32_16x16x32_bf16 v[24:27], v[104:107], v[136:139], v[24:27]
    ds_read_b64_tr_b16 v[166:167], v191 offset:4608
    v_mfma_f32_16x16x32_bf16 v[28:31], v[104:107], v[140:143], v[28:31]
    ds_read_b64_tr_b16 v[168:169], v190 offset:12288
    v_mfma_f32_16x16x32_bf16 v[32:35], v[120:123], v[108:111], v[32:35]
    ds_read_b64_tr_b16 v[170:171], v190 offset:12800
    v_mfma_f32_16x16x32_bf16 v[36:39], v[124:127], v[108:111], v[36:39]
    ds_read_b64_tr_b16 v[172:173], v191 offset:12288
    v_mfma_f32_16x16x32_bf16 v[40:43], v[128:131], v[108:111], v[40:43]
    ds_read_b64_tr_b16 v[174:175], v191 offset:12800
    v_mfma_f32_16x16x32_bf16 v[44:47], v[132:135], v[108:111], v[44:47]
    ds_read_b64_tr_b16 v[176:177], v190 offset:20480
    v_mfma_f32_16x16x32_bf16 v[48:51], v[108:111], v[136:139], v[48:51]
    ds_read_b64_tr_b16 v[178:179], v190 offset:20992
    v_mfma_f32_16x16x32_bf16 v[52:55], v[108:111], v[140:143], v[52:55]
    ds_read_b64_tr_b16 v[180:181], v191 offset:20480
    v_mfma_f32_16x16x32_bf16 v[56:59], v[120:123], v[112:115], v[56:59]
    ds_read_b64_tr_b16 v[182:183], v191 offset:20992
    v_mfma_f32_16x16x32_bf16 v[60:63], v[124:127], v[112:115], v[60:63]
    ds_read_b128 v[148:151], v189 offset:2048
    v_mfma_f32_16x16x32_bf16 v[64:67], v[128:131], v[112:115], v[64:67]
    ds_read_b128 v[152:155], v189 offset:4096
    v_mfma_f32_16x16x32_bf16 v[68:71], v[132:135], v[112:115], v[68:71]
    ds_read_b128 v[156:159], v189 offset:6144
    v_mfma_f32_16x16x32_bf16 v[72:75], v[112:115], v[136:139], v[72:75]
    s_add_u32 s66, s66, 1
    s_cmp_lt_u32 s66, 5
    v_mfma_f32_16x16x32_bf16 v[76:79], v[112:115], v[140:143], v[76:79]
    v_mfma_f32_16x16x32_bf16 v[80:83], v[120:123], v[116:119], v[80:83]
    v_mfma_f32_16x16x32_bf16 v[84:87], v[124:127], v[116:119], v[84:87]
    v_mfma_f32_16x16x32_bf16 v[88:91], v[128:131], v[116:119], v[88:91]
    v_mfma_f32_16x16x32_bf16 v[92:95], v[132:135], v[116:119], v[92:95]
    v_mfma_f32_16x16x32_bf16 v[96:99], v[116:119], v[136:139], v[96:99]
    v_mfma_f32_16x16x32_bf16 v[100:103], v[116:119], v[140:143], v[100:103]
    s_cbranch_scc1 L_cloop
    s_nop 0
    s_waitcnt lgkmcnt(0)
    s_barrier
    v_mfma_f32_16x16x32_bf16 v[8:11], v[160:163], v[144:147], v[8:11]
    ds_read_b128 v[104:107], v184 offset:0
    v_mfma_f32_16x16x32_bf16 v[12:15], v[164:167], v[144:147], v[12:15]
    ds_read_b64_tr_b16 v[120:121], v186 offset:0
    v_mfma_f32_16x16x32_bf16 v[16:19], v[168:171], v[144:147], v[16:19]
    ds_read_b64_tr_b16 v[122:123], v186 offset:512
    v_mfma_f32_16x16x32_bf16 v[20:23], v[172:175], v[144:147], v[20:23]
    ds_read_b64_tr_b16 v[124:125], v187 offset:0
    v_mfma_f32_16x16x32_bf16 v[24:27], v[144:147], v[176:179], v[24:27]
    ds_read_b64_tr_b16 v[126:127], v187 offset:512
    v_mfma_f32_16x16x32_bf16 v[28:31], v[144:147], v[180:183], v[28:31]
    ds_read_b64_tr_b16 v[128:129], v186 offset:8192
    v_mfma_f32_16x16x32_bf16 v[32:35], v[160:163], v[148:151], v[32:35]
    ds_read_b64_tr_b16 v[130:131], v186 offset:8704
    v_mfma_f32_16x16x32_bf16 v[36:39], v[164:167], v[148:151], v[36:39]
    ds_read_b64_tr_b16 v[132:133], v187 offset:8192
    v_mfma_f32_16x16x32_bf16 v[40:43], v[168:171], v[148:151], v[40:43]
    ds_read_b64_tr_b16 v[134:135], v187 offset:8704
    v_mfma_f32_16x16x32_bf16 v[44:47], v[172:175], v[148:151], v[44:47]
    ds_read_b64_tr_b16 v[136:137], v186 offset:16384
    v_mfma_f32_16x16x32_bf16 v[48:51], v[148:151], v[176:179], v[48:51]
    ds_read_b64_tr_b16 v[138:139], v186 offset:16896
    v_mfma_f32_16x16x32_bf16 v[52:55], v[148:151], v[180:183], v[52:55]
    ds_read_b64_tr_b16 v[140:141], v187 offset:16384
    v_mfma_f32_16x16x32_bf16 v[56:59], v[160:163], v[152:155], v[56:59]
    ds_read_b64_tr_b16 v[142:143], v187 offset:16896
    v_mfma_f32_16x16x32_bf16 v[60:63], v[164:167], v[152:155], v[60:63]
    ds_read_b128 v[108:111], v184 offset:2048
    v_mfma_f32_16x16x32_bf16 v[64:67], v[168:171], v[152:155], v[64:67]
    ds_read_b128 v[112:115], v184 offset:4096
    v_mfma_f32_16x16x32_bf16 v[68:71], v[172:175], v[152:155], v[68:71]
    ds_read_b128 v[116:119], v184 offset:6144
    v_mfma_f32_16x16x32_bf16 v[72:75], v[152:155], v[176:179], v[72:75]
    ds_read_b32 v192, v232 offset:0
    v_mfma_f32_16x16x32_bf16 v[76:79], v[152:155], v[180:183], v[76:79]
    ds_read_b32 v194, v232 offset:64
    v_mfma_f32_16x16x32_bf16 v[80:83], v[160:163], v[156:159], v[80:83]
    ds_read_b32 v196, v232 offset:128
    v_mfma_f32_16x16x32_bf16 v[84:87], v[164:167], v[156:159], v[84:87]
    ds_read_b32 v198, v232 offset:192
    v_mfma_f32_16x16x32_bf16 v[88:91], v[168:171], v[156:159], v[88:91]
    ds_read_b128 v[204:207], v235 offset:256
    v_mfma_f32_16x16x32_bf16 v[92:95], v[172:175], v[156:159], v[92:95]
    ds_read_b128 v[208:211], v235 offset:320
    v_mfma_f32_16x16x32_bf16 v[96:99], v[156:159], v[176:179], v[96:99]
    ds_read_b128 v[212:215], v235 offset:0
    v_mfma_f32_16x16x32_bf16 v[100:103], v[156:159], v[180:183], v[100:103]
    ds_read_b128 v[216:219], v235 offset:64
    s_waitcnt lgkmcnt(8)
    s_nop 0
    v_mfma_f32_16x16x32_bf16 v[8:11], v[120:123], v[104:107], v[8:11]
    ds_read_b128 v[144:147], v185 offset:0
    v_mfma_f32_16x16x32_bf16 v[12:15], v[124:127], v[104:107], v[12:15]
    ds_read_b64_tr_b16 v[160:161], v186 offset:4096
    v_mfma_f32_16x16x32_bf16 v[16:19], v[128:131], v[104:107], v[16:19]
    ds_read_b64_tr_b16 v[162:163], v186 offset:4608
    v_mfma_f32_16x16x32_bf16 v[20:23], v[132:135], v[104:107], v[20:23]
    ds_read_b64_tr_b16 v[164:165], v187 offset:4096
    v_mfma_f32_16x16x32_bf16 v[24:27], v[104:107], v[136:139], v[24:27]
    ds_read_b64_tr_b16 v[166:167], v187 offset:4608
    v_mfma_f32_16x16x32_bf16 v[28:31], v[104:107], v[140:143], v[28:31]
    ds_read_b64_tr_b16 v[168:169], v186 offset:12288
    v_mfma_f32_16x16x32_bf16 v[32:35], v[120:123], v[108:111], v[32:35]
    ds_read_b64_tr_b16 v[170:171], v186 offset:12800
    v_mfma_f32_16x16x32_bf16 v[36:39], v[124:127], v[108:111], v[36:39]
    ds_read_b64_tr_b16 v[172:173], v187 offset:12288
    v_mfma_f32_16x16x32_bf16 v[40:43], v[128:131], v[108:111], v[40:43]
    ds_read_b64_tr_b16 v[174:175], v187 offset:12800
    v_mfma_f32_16x16x32_bf16 v[44:47], v[132:135], v[108:111], v[44:47]
    ds_read_b64_tr_b16 v[176:177], v186 offset:20480
    v_mfma_f32_16x16x32_bf16 v[48:51], v[108:111], v[136:139], v[48:51]
    ds_read_b64_tr_b16 v[178:179], v186 offset:20992
    v_mfma_f32_16x16x32_bf16 v[52:55], v[108:111], v[140:143], v[52:55]
    ds_read_b64_tr_b16 v[180:181], v187 offset:20480
    v_mfma_f32_16x16x32_bf16 v[56:59], v[120:123], v[112:115], v[56:59]
    ds_read_b64_tr_b16 v[182:183], v187 offset:20992
    v_mfma_f32_16x16x32_bf16 v[60:63], v[124:127], v[112:115], v[60:63]
    ds_read_b128 v[148:151], v185 offset:2048
    v_mfma_f32_16x16x32_bf16 v[64:67], v[128:131], v[112:115], v[64:67]
    ds_read_b128 v[152:155], v185 offset:4096
    v_mfma_f32_16x16x32_bf16 v[68:71], v[132:135], v[112:115], v[68:71]
    ds_read_b128 v[156:159], v185 offset:6144
    v_mfma_f32_16x16x32_bf16 v[72:75], v[112:115], v[136:139], v[72:75]
    ds_read_b64 v[240:241], v236
    v_mfma_f32_16x16x32_bf16 v[76:79], v[112:115], v[140:143], v[76:79]
    ds_read_b64 v[242:243], v237
    v_mfma_f32_16x16x32_bf16 v[80:83], v[120:123], v[116:119], v[80:83]
    ds_read_b64 v[244:245], v238
    v_mfma_f32_16x16x32_bf16 v[84:87], v[124:127], v[116:119], v[84:87]
    ds_read_b64 v[246:247], v239
    v_mfma_f32_16x16x32_bf16 v[88:91], v[128:131], v[116:119], v[88:91]
    ds_read_b64_tr_b16 v[224:225], v252 offset:0
    v_mfma_f32_16x16x32_bf16 v[92:95], v[132:135], v[116:119], v[92:95]
    ds_read_b64_tr_b16 v[226:227], v252 offset:1024
    v_mfma_f32_16x16x32_bf16 v[96:99], v[116:119], v[136:139], v[96:99]
    ds_read_b64_tr_b16 v[228:229], v252 offset:32
    v_mfma_f32_16x16x32_bf16 v[100:103], v[116:119], v[140:143], v[100:103]
    ds_read_b64_tr_b16 v[230:231], v252 offset:1056
    s_waitcnt lgkmcnt(4)
    v_mfma_f32_16x16x32_bf16 v[16:19], v[168:171], v[144:147], v[16:19]
    s_barrier
    v_mfma_f32_16x16x32_bf16 v[20:23], v[172:175], v[144:147], v[20:23]
    ds_read_b128 v[104:107], v233 offset:0
    ds_read_b128 v[108:111], v233 offset:64
    v_mfma_f32_16x16x32_bf16 v[40:43], v[168:171], v[148:151], v[40:43]
    ds_read_b128 v[112:115], v233 offset:128
    ds_read_b128 v[116:119], v233 offset:192
    v_mfma_f32_16x16x32_bf16 v[44:47], v[172:175], v[148:151], v[44:47]
    ds_read_b32 v250, v248 offset:576
    ds_read_b32 v248, v248 offset:512
    v_mfma_f32_16x16x32_bf16 v[64:67], v[168:171], v[152:155], v[64:67]
    ds_read_b32 v200, v232 offset:2048
    ds_read_b32 v202, v232 offset:2112
    v_mfma_f32_16x16x32_bf16 v[68:71], v[172:175], v[152:155], v[68:71]
    ds_read_b32 v220, v232 offset:2176
    ds_read_b32 v222, v232 offset:2240
    v_mfma_f32_16x16x32_bf16 v[88:91], v[168:171], v[156:159], v[88:91]
    ds_read_b32 v193, v234 offset:2048
    ds_read_b32 v195, v234 offset:1024
    v_mfma_f32_16x16x32_bf16 v[92:95], v[172:175], v[156:159], v[92:95]
    ds_read_b32 v221, v234 offset:2176
    ds_read_b32 v223, v234 offset:1152
    v_mfma_f32_16x16x32_bf16 v[24:27], v[144:147], v[176:179], v[24:27]
    v_fma_f32 v16, -v192, v204, v16
    v_fma_f32 v17, -v192, v205, v17
    v_fma_f32 v18, -v192, v206, v18
    v_mfma_f32_16x16x32_bf16 v[28:31], v[144:147], v[180:183], v[28:31]
    v_fma_f32 v19, -v192, v207, v19
    v_fma_f32 v20, -v192, v208, v20
    v_fma_f32 v21, -v192, v209, v21
    v_mfma_f32_16x16x32_bf16 v[48:51], v[148:151], v[176:179], v[48:51]
    v_fma_f32 v22, -v192, v210, v22
    v_fma_f32 v23, -v192, v211, v23
    v_cvt_pk_bf16_f32 v16, v16, v17
    v_mfma_f32_16x16x32_bf16 v[52:55], v[148:151], v[180:183], v[52:55]
    v_cvt_pk_bf16_f32 v17, v18, v19
    v_cvt_pk_bf16_f32 v18, v20, v21
    v_cvt_pk_bf16_f32 v19, v22, v23
    v_mfma_f32_16x16x32_bf16 v[72:75], v[152:155], v[176:179], v[72:75]
    v_fma_f32 v40, -v194, v204, v40
    v_fma_f32 v41, -v194, v205, v41
    v_fma_f32 v42, -v194, v206, v42
    v_mfma_f32_16x16x32_bf16 v[76:79], v[152:155], v[180:183], v[76:79]
    v_fma_f32 v43, -v194, v207, v43
    v_fma_f32 v44, -v194, v208, v44
    v_fma_f32 v45, -v194, v209, v45
    v_mfma_f32_16x16x32_bf16 v[96:99], v[156:159], v[176:179], v[96:99]
    v_fma_f32 v46, -v194, v210, v46
    v_fma_f32 v47, -v194, v211, v47
    v_cvt_pk_bf16_f32 v40, v40, v41
    v_mfma_f32_16x16x32_bf16 v[100:103], v[156:159], v[180:183], v[100:103]
    v_cvt_pk_bf16_f32 v41, v42, v43
    v_cvt_pk_bf16_f32 v42, v44, v45
    v_cvt_pk_bf16_f32 v43, v46, v47
    v_mfma_f32_16x16x32_bf16 v[8:11], v[160:163], v[144:147], v[8:11]
    v_fma_f32 v64, -v196, v204, v64
    v_fma_f32 v65, -v196, v205, v65
    v_fma_f32 v66, -v196, v206, v66
    v_mfma_f32_16x16x32_bf16 v[12:15], v[164:167], v[144:147], v[12:15]
    v_fma_f32 v67, -v196, v207, v67
    v_fma_f32 v68, -v196, v208, v68
    v_fma_f32 v69, -v196, v209, v69
    v_mfma_f32_16x16x32_bf16 v[32:35], v[160:163], v[148:151], v[32:35]
    v_fma_f32 v70, -v196, v210, v70
    v_fma_f32 v71, -v196, v211, v71
    v_cvt_pk_bf16_f32 v64, v64, v65
    v_mfma_f32_16x16x32_bf16 v[36:39], v[164:167], v[148:151], v[36:39]
    v_cvt_pk_bf16_f32 v65, v66, v67
    v_cvt_pk_bf16_f32 v66, v68, v69
    v_cvt_pk_bf16_f32 v67, v70, v71
    v_mfma_f32_16x16x32_bf16 v[56:59], v[160:163], v[152:155], v[56:59]
    v_fma_f32 v88, -v198, v204, v88
    v_fma_f32 v89, -v198, v205, v89
    v_fma_f32 v90, -v198, v206, v90
    v_mfma_f32_16x16x32_bf16 v[60:63], v[164:167], v[152:155], v[60:63]
    v_fma_f32 v91, -v198, v207, v91
    v_fma_f32 v92, -v198, v208, v92
    v_fma_f32 v93, -v198, v209, v93
    v_mfma_f32_16x16x32_bf16 v[80:83], v[160:163], v[156:159], v[80:83]
    v_fma_f32 v94, -v198, v210, v94
    v_fma_f32 v95, -v198, v211, v95
    v_cvt_pk_bf16_f32 v88, v88, v89
    v_mfma_f32_16x16x32_bf16 v[84:87], v[164:167], v[156:159], v[84:87]
    v_cvt_pk_bf16_f32 v89, v90, v91
    v_cvt_pk_bf16_f32 v90, v92, v93
    v_cvt_pk_bf16_f32 v91, v94, v95
    ds_read_b128 v[120:123], v249 offset:0
    ds_read_b128 v[124:127], v249 offset:64
    s_waitcnt lgkmcnt(2)
    s_nop 0
    v_mfma_f32_16x16x32_bf16 v[144:147], v[224:227], v[16:19], 0
    v_mfma_f32_16x16x32_bf16 v[148:151], v[228:231], v[16:19], 0
    v_mfma_f32_16x16x32_bf16 v[152:155], v[224:227], v[40:43], 0
    v_mfma_f32_16x16x32_bf16 v[156:159], v[228:231], v[40:43], 0
    v_mfma_f32_16x16x32_bf16 v[160:163], v[224:227], v[64:67], 0
    v_mfma_f32_16x16x32_bf16 v[164:167], v[228:231], v[64:67], 0
    v_mfma_f32_16x16x32_bf16 v[168:171], v[224:227], v[88:91], 0
    v_mfma_f32_16x16x32_bf16 v[172:175], v[228:231], v[88:91], 0
    v_pk_fma_f32 v[24:25], v[104:105], v[248:249], v[24:25] op_sel_hi:[1,0,1] neg_lo:[1,0,0] neg_hi:[1,0,0]
    v_pk_fma_f32 v[26:27], v[106:107], v[248:249], v[26:27] op_sel_hi:[1,0,1] neg_lo:[1,0,0] neg_hi:[1,0,0]
    v_pk_fma_f32 v[28:29], v[104:105], v[250:251], v[28:29] op_sel_hi:[1,0,1] neg_lo:[1,0,0] neg_hi:[1,0,0]
    v_pk_fma_f32 v[30:31], v[106:107], v[250:251], v[30:31] op_sel_hi:[1,0,1] neg_lo:[1,0,0] neg_hi:[1,0,0]
    v_pk_fma_f32 v[48:49], v[108:109], v[248:249], v[48:49] op_sel_hi:[1,0,1] neg_lo:[1,0,0] neg_hi:[1,0,0]
    v_pk_fma_f32 v[50:51], v[110:111], v[248:249], v[50:51] op_sel_hi:[1,0,1] neg_lo:[1,0,0] neg_hi:[1,0,0]
    v_pk_fma_f32 v[52:53], v[108:109], v[250:251], v[52:53] op_sel_hi:[1,0,1] neg_lo:[1,0,0] neg_hi:[1,0,0]
    v_pk_fma_f32 v[54:55], v[110:111], v[250:251], v[54:55] op_sel_hi:[1,0,1] neg_lo:[1,0,0] neg_hi:[1,0,0]
    v_pk_fma_f32 v[72:73], v[112:113], v[248:249], v[72:73] op_sel_hi:[1,0,1] neg_lo:[1,0,0] neg_hi:[1,0,0]
    v_pk_fma_f32 v[74:75], v[114:115], v[248:249], v[74:75] op_sel_hi:[1,0,1] neg_lo:[1,0,0] neg_hi:[1,0,0]
    v_pk_fma_f32 v[76:77], v[112:113], v[250:251], v[76:77] op_sel_hi:[1,0,1] neg_lo:[1,0,0] neg_hi:[1,0,0]
    v_pk_fma_f32 v[78:79], v[114:115], v[250:251], v[78:79] op_sel_hi:[1,0,1] neg_lo:[1,0,0] neg_hi:[1,0,0]
    v_pk_fma_f32 v[96:97], v[116:117], v[248:249], v[96:97] op_sel_hi:[1,0,1] neg_lo:[1,0,0] neg_hi:[1,0,0]
    v_pk_fma_f32 v[98:99], v[118:119], v[248:249], v[98:99] op_sel_hi:[1,0,1] neg_lo:[1,0,0] neg_hi:[1,0,0]
    v_pk_fma_f32 v[100:101], v[116:117], v[250:251], v[100:101] op_sel_hi:[1,0,1] neg_lo:[1,0,0] neg_hi:[1,0,0]
    v_pk_fma_f32 v[102:103], v[118:119], v[250:251], v[102:103] op_sel_hi:[1,0,1] neg_lo:[1,0,0] neg_hi:[1,0,0]
    v_cvt_pk_bf16_f32 v24, v24, v25
    v_cvt_pk_bf16_f32 v25, v26, v27
    v_cvt_pk_bf16_f32 v26, v48, v49
    v_cvt_pk_bf16_f32 v27, v50, v51
    v_cvt_pk_bf16_f32 v28, v28, v29
    v_cvt_pk_bf16_f32 v29, v30, v31
    v_cvt_pk_bf16_f32 v30, v52, v53
    v_cvt_pk_bf16_f32 v31, v54, v55
    v_cvt_pk_bf16_f32 v72, v72, v73
    v_cvt_pk_bf16_f32 v73, v74, v75
    v_cvt_pk_bf16_f32 v74, v96, v97
    v_cvt_pk_bf16_f32 v75, v98, v99
    v_cvt_pk_bf16_f32 v76, v76, v77
    v_cvt_pk_bf16_f32 v77, v78, v79
    v_cvt_pk_bf16_f32 v78, v100, v101
    v_cvt_pk_bf16_f32 v79, v102, v103
    ds_read_b128 v[104:107], v253 offset:0
    ds_read_b128 v[108:111], v253 offset:64
    v_max3_f32 v176, v144, v145, v146
    v_max3_f32 v184, -v144, -v145, -v146
    v_max3_f32 v178, v152, v153, v154
    v_max3_f32 v186, -v152, -v153, -v154
    v_max3_f32 v176, v176, v147, v148
    v_max3_f32 v184, v184, -v147, -v148
    v_max3_f32 v178, v178, v155, v156
    v_max3_f32 v186, v186, -v155, -v156
    v_max3_f32 v176, v176, v149, v150
    v_max3_f32 v184, v184, -v149, -v150
    v_max3_f32 v178, v178, v157, v158
    v_max3_f32 v186, v186, -v157, -v158
    v_max_f32_e64 v176, v176, v151
    v_max_f32_e64 v184, v184, -v151
    v_max_f32_e64 v178, v178, v159
    v_max_f32_e64 v186, v186, -v159
    s_nop 0
    v_permlane32_swap_b32 v176, v178
    v_permlane32_swap_b32_e64 v184, v186
    v_max3_f32 v180, v160, v161, v162
    v_max3_f32 v188, -v160, -v161, -v162
    v_max_f32 v176, v176, v178
    v_max_f32 v184, v184, v186
    v_max3_f32 v182, v168, v169, v170
    v_max3_f32 v190, -v168, -v169, -v170
    v_permlane16_swap_b32 v176, v184
    v_max_f32 v176, v176, v184
    v_max3_f32 v180, v180, v163, v164
    v_max3_f32 v188, v188, -v163, -v164
    v_mul_f32 v184, v176, v193
    v_mul_f32 v176, v176, v193
    v_max3_f32 v182, v182, v171, v172
    v_max3_f32 v190, v190, -v171, -v172
    v_permlane16_swap_b32 v176, v184
    v_mov_b32 v178, v176
    v_max3_f32 v180, v180, v165, v166
    v_max3_f32 v188, v188, -v165, -v166
    v_mov_b32_e64 v186, v184
    v_max3_f32 v182, v182, v173, v174
    v_max3_f32 v190, v190, -v173, -v174
    v_permlane32_swap_b32 v176, v178
    v_permlane32_swap_b32 v184, v186
    v_max_f32_e64 v180, v180, v167
    v_max_f32_e64 v188, v188, -v167
    v_max_f32_e64 v182, v182, v175
    v_max_f32_e64 v190, v190, -v175
    s_nop 0
    v_permlane32_swap_b32 v180, v182
    v_permlane32_swap_b32_e64 v188, v190
    v_pk_fma_f32 v[16:17], v[144:145], v[200:201], v[184:185] op_sel_hi:[1,0,0] neg_lo:[1,0,1] neg_hi:[1,0,1]
    v_pk_fma_f32 v[144:145], v[144:145], v[200:201], v[176:177] op_sel_hi:[1,0,0] neg_lo:[0,0,1] neg_hi:[0,0,1]
    v_max_f32 v180, v180, v182
    v_max_f32 v188, v188, v190
    v_pk_fma_f32 v[18:19], v[146:147], v[200:201], v[184:185] op_sel_hi:[1,0,0] neg_lo:[1,0,1] neg_hi:[1,0,1]
    v_pk_fma_f32 v[146:147], v[146:147], v[200:201], v[176:177] op_sel_hi:[1,0,0] neg_lo:[0,0,1] neg_hi:[0,0,1]
    v_permlane16_swap_b32 v180, v188
    v_max_f32 v180, v180, v188
    v_pk_fma_f32 v[20:21], v[148:149], v[200:201], v[184:185] op_sel_hi:[1,0,0] neg_lo:[1,0,1] neg_hi:[1,0,1]
    v_pk_fma_f32 v[148:149], v[148:149], v[200:201], v[176:177] op_sel_hi:[1,0,0] neg_lo:[0,0,1] neg_hi:[0,0,1]
    v_mul_f32 v188, v180, v221
    v_mul_f32 v180, v180, v221
    v_pk_fma_f32 v[22:23], v[150:151], v[200:201], v[184:185] op_sel_hi:[1,0,0] neg_lo:[1,0,1] neg_hi:[1,0,1]
    v_pk_fma_f32 v[150:151], v[150:151], v[200:201], v[176:177] op_sel_hi:[1,0,0] neg_lo:[0,0,1] neg_hi:[0,0,1]
    v_permlane16_swap_b32 v180, v188
    v_mov_b32 v182, v180
    v_pk_fma_f32 v[40:41], v[152:153], v[202:203], v[186:187] op_sel_hi:[1,0,0] neg_lo:[1,0,1] neg_hi:[1,0,1]
    v_pk_fma_f32 v[152:153], v[152:153], v[202:203], v[178:179] op_sel_hi:[1,0,0] neg_lo:[0,0,1] neg_hi:[0,0,1]
    v_mov_b32_e64 v190, v188
    v_pk_fma_f32 v[42:43], v[154:155], v[202:203], v[186:187] op_sel_hi:[1,0,0] neg_lo:[1,0,1] neg_hi:[1,0,1]
    v_pk_fma_f32 v[154:155], v[154:155], v[202:203], v[178:179] op_sel_hi:[1,0,0] neg_lo:[0,0,1] neg_hi:[0,0,1]
    v_permlane32_swap_b32 v180, v182
    v_permlane32_swap_b32 v188, v190
    v_pk_fma_f32 v[44:45], v[156:157], v[202:203], v[186:187] op_sel_hi:[1,0,0] neg_lo:[1,0,1] neg_hi:[1,0,1]
    v_pk_fma_f32 v[156:157], v[156:157], v[202:203], v[178:179] op_sel_hi:[1,0,0] neg_lo:[0,0,1] neg_hi:[0,0,1]
    v_pk_fma_f32 v[46:47], v[158:159], v[202:203], v[186:187] op_sel_hi:[1,0,0] neg_lo:[1,0,1] neg_hi:[1,0,1]
    v_pk_fma_f32 v[158:159], v[158:159], v[202:203], v[178:179] op_sel_hi:[1,0,0] neg_lo:[0,0,1] neg_hi:[0,0,1]
    v_exp_f32 v16, v16
    v_exp_f32 v144, v144
    v_exp_f32 v17, v17
    v_exp_f32 v145, v145
    v_exp_f32 v18, v18
    v_exp_f32 v146, v146
    v_exp_f32 v19, v19
    v_exp_f32 v147, v147
    v_exp_f32 v20, v20
    v_exp_f32 v148, v148
    v_exp_f32 v21, v21
    v_exp_f32 v149, v149
    v_exp_f32 v22, v22
    v_exp_f32 v150, v150
    v_exp_f32 v23, v23
    v_exp_f32 v151, v151
    v_exp_f32 v40, v40
    v_exp_f32 v152, v152
    v_exp_f32 v41, v41
    v_exp_f32 v153, v153
    v_exp_f32 v42, v42
    v_exp_f32 v154, v154
    v_exp_f32 v43, v43
    v_exp_f32 v155, v155
    v_exp_f32 v44, v44
    v_exp_f32 v156, v156
    v_exp_f32 v45, v45
    v_exp_f32 v157, v157
    v_exp_f32 v46, v46
    v_exp_f32 v158, v158
    v_exp_f32 v47, v47
    v_exp_f32 v159, v159
    v_pk_add_f32 v[128:129], v[144:145], v[146:147]
    v_pk_add_f32 v[130:131], v[16:17], v[18:19]
    v_pk_add_f32 v[132:133], v[152:153], v[154:155]
    v_pk_add_f32 v[134:135], v[40:41], v[42:43]
    v_pk_add_f32 v[128:129], v[128:129], v[148:149]
    v_pk_add_f32 v[130:131], v[130:131], v[20:21]
    v_pk_add_f32 v[132:133], v[132:133], v[156:157]
    v_pk_add_f32 v[134:135], v[134:135], v[44:45]
    v_pk_add_f32 v[128:129], v[128:129], v[150:151]
    v_pk_add_f32 v[130:131], v[130:131], v[22:23]
    v_pk_add_f32 v[132:133], v[132:133], v[158:159]
    v_pk_add_f32 v[134:135], v[134:135], v[46:47]
    v_add_f32 v176, v128, v129
    v_add_f32 v184, v130, v131
    v_add_f32 v178, v132, v133
    v_add_f32 v186, v134, v135
    s_nop 0
    v_permlane32_swap_b32 v176, v178
    v_permlane32_swap_b32_e64 v184, v186
    v_pk_fma_f32 v[64:65], v[160:161], v[220:221], v[188:189] op_sel_hi:[1,0,0] neg_lo:[1,0,1] neg_hi:[1,0,1]
    v_pk_fma_f32 v[160:161], v[160:161], v[220:221], v[180:181] op_sel_hi:[1,0,0] neg_lo:[0,0,1] neg_hi:[0,0,1]
    v_add_f32 v176, v176, v178
    v_add_f32 v184, v184, v186
    v_pk_fma_f32 v[66:67], v[162:163], v[220:221], v[188:189] op_sel_hi:[1,0,0] neg_lo:[1,0,1] neg_hi:[1,0,1]
    v_pk_fma_f32 v[162:163], v[162:163], v[220:221], v[180:181] op_sel_hi:[1,0,0] neg_lo:[0,0,1] neg_hi:[0,0,1]
    v_permlane16_swap_b32 v176, v184
    v_add_f32 v176, v176, v184
    v_pk_fma_f32 v[68:69], v[164:165], v[220:221], v[188:189] op_sel_hi:[1,0,0] neg_lo:[1,0,1] neg_hi:[1,0,1]
    v_pk_fma_f32 v[164:165], v[164:165], v[220:221], v[180:181] op_sel_hi:[1,0,0] neg_lo:[0,0,1] neg_hi:[0,0,1]
    v_rcp_f32_e64 v176, v176
    v_pk_fma_f32 v[70:71], v[166:167], v[220:221], v[188:189] op_sel_hi:[1,0,0] neg_lo:[1,0,1] neg_hi:[1,0,1]
    v_pk_fma_f32 v[166:167], v[166:167], v[220:221], v[180:181] op_sel_hi:[1,0,0] neg_lo:[0,0,1] neg_hi:[0,0,1]
    v_mul_f32 v184, v176, v195
    v_mul_f32 v176, v176, v195
    v_pk_fma_f32 v[88:89], v[168:169], v[222:223], v[190:191] op_sel_hi:[1,0,0] neg_lo:[1,0,1] neg_hi:[1,0,1]
    v_pk_fma_f32 v[168:169], v[168:169], v[222:223], v[182:183] op_sel_hi:[1,0,0] neg_lo:[0,0,1] neg_hi:[0,0,1]
    v_permlane16_swap_b32 v176, v184
    v_mov_b32 v178, v176
    v_pk_fma_f32 v[90:91], v[170:171], v[222:223], v[190:191] op_sel_hi:[1,0,0] neg_lo:[1,0,1] neg_hi:[1,0,1]
    v_pk_fma_f32 v[170:171], v[170:171], v[222:223], v[182:183] op_sel_hi:[1,0,0] neg_lo:[0,0,1] neg_hi:[0,0,1]
    v_mov_b32_e64 v186, v184
    v_pk_fma_f32 v[92:93], v[172:173], v[222:223], v[190:191] op_sel_hi:[1,0,0] neg_lo:[1,0,1] neg_hi:[1,0,1]
    v_pk_fma_f32 v[172:173], v[172:173], v[222:223], v[182:183] op_sel_hi:[1,0,0] neg_lo:[0,0,1] neg_hi:[0,0,1]
    v_permlane32_swap_b32 v176, v178
    v_permlane32_swap_b32 v184, v186
    v_pk_fma_f32 v[94:95], v[174:175], v[222:223], v[190:191] op_sel_hi:[1,0,0] neg_lo:[1,0,1] neg_hi:[1,0,1]
    v_pk_fma_f32 v[174:175], v[174:175], v[222:223], v[182:183] op_sel_hi:[1,0,0] neg_lo:[0,0,1] neg_hi:[0,0,1]
    v_pk_mul_f32 v[144:145], v[144:145], v[176:177] op_sel_hi:[1,0]
    v_pk_mul_f32 v[146:147], v[146:147], v[176:177] op_sel_hi:[1,0]
    v_pk_mul_f32 v[148:149], v[148:149], v[176:177] op_sel_hi:[1,0]
    v_pk_mul_f32 v[150:151], v[150:151], v[176:177] op_sel_hi:[1,0]
    v_cvt_pk_bf16_f32 v144, v144, v145
    v_cvt_pk_bf16_f32 v145, v146, v147
    v_cvt_pk_bf16_f32 v146, v148, v149
    v_cvt_pk_bf16_f32 v147, v150, v151
    ds_write_b64 v4, v[144:145] offset:0
    ds_write_b64 v5, v[146:147] offset:0
    ds_write_b128 v197, v[24:27] offset:0
    v_pk_mul_f32 v[16:17], v[16:17], v[184:185] op_sel_hi:[1,0]
    v_pk_mul_f32 v[18:19], v[18:19], v[184:185] op_sel_hi:[1,0]
    v_pk_mul_f32 v[20:21], v[20:21], v[184:185] op_sel_hi:[1,0]
    v_pk_mul_f32 v[22:23], v[22:23], v[184:185] op_sel_hi:[1,0]
    v_cvt_pk_bf16_f32 v16, v16, v17
    v_cvt_pk_bf16_f32 v17, v18, v19
    v_cvt_pk_bf16_f32 v18, v20, v21
    v_cvt_pk_bf16_f32 v19, v22, v23
    ds_write_b64 v6, v[16:17] offset:0
    ds_write_b64 v7, v[18:19] offset:0
    ds_write_b128 v197, v[28:31] offset:1024
    v_pk_mul_f32 v[152:153], v[152:153], v[178:179] op_sel_hi:[1,0]
    v_pk_mul_f32 v[154:155], v[154:155], v[178:179] op_sel_hi:[1,0]
    v_pk_mul_f32 v[156:157], v[156:157], v[178:179] op_sel_hi:[1,0]
    v_pk_mul_f32 v[158:159], v[158:159], v[178:179] op_sel_hi:[1,0]
    v_cvt_pk_bf16_f32 v152, v152, v153
    v_cvt_pk_bf16_f32 v153, v154, v155
    v_cvt_pk_bf16_f32 v154, v156, v157
    v_cvt_pk_bf16_f32 v155, v158, v159
    ds_write_b64 v4, v[152:153] offset:2048
    ds_write_b64 v5, v[154:155] offset:2048
    ds_write_b128 v197, v[72:75] offset:2048
    v_pk_mul_f32 v[40:41], v[40:41], v[186:187] op_sel_hi:[1,0]
    v_pk_mul_f32 v[42:43], v[42:43], v[186:187] op_sel_hi:[1,0]
    v_pk_mul_f32 v[44:45], v[44:45], v[186:187] op_sel_hi:[1,0]
    v_pk_mul_f32 v[46:47], v[46:47], v[186:187] op_sel_hi:[1,0]
    v_cvt_pk_bf16_f32 v40, v40, v41
    v_cvt_pk_bf16_f32 v41, v42, v43
    v_cvt_pk_bf16_f32 v42, v44, v45
    v_cvt_pk_bf16_f32 v43, v46, v47
    ds_write_b64 v6, v[40:41] offset:2048
    ds_write_b64 v7, v[42:43] offset:2048
    ds_write_b128 v197, v[76:79] offset:3072
    ds_read_b64_tr_b16 v[232:233], v201 offset:0
    ds_read_b64_tr_b16 v[234:235], v201 offset:2048
    ds_read_b64_tr_b16 v[236:237], v203 offset:0
    ds_read_b64_tr_b16 v[238:239], v203 offset:2048
    v_exp_f32 v64, v64
    v_exp_f32 v160, v160
    v_exp_f32 v65, v65
    v_exp_f32 v161, v161
    v_exp_f32 v66, v66
    v_exp_f32 v162, v162
    v_exp_f32 v67, v67
    v_exp_f32 v163, v163
    v_exp_f32 v68, v68
    v_exp_f32 v164, v164
    v_exp_f32 v69, v69
    v_exp_f32 v165, v165
    v_exp_f32 v70, v70
    v_exp_f32 v166, v166
    v_exp_f32 v71, v71
    v_exp_f32 v167, v167
    v_exp_f32 v88, v88
    v_exp_f32 v168, v168
    v_exp_f32 v89, v89
    v_exp_f32 v169, v169
    v_exp_f32 v90, v90
    v_exp_f32 v170, v170
    v_exp_f32 v91, v91
    v_exp_f32 v171, v171
    v_exp_f32 v92, v92
    v_exp_f32 v172, v172
    v_exp_f32 v93, v93
    v_exp_f32 v173, v173
    v_exp_f32 v94, v94
    v_exp_f32 v174, v174
    v_exp_f32 v95, v95
    v_exp_f32 v175, v175
    s_mov_b64 exec, 1
    buffer_store_dword v251, v199, s[48:51], s76 offen sc1
    s_mov_b64 exec, -1
    v_pk_add_f32 v[136:137], v[160:161], v[162:163]
    v_pk_add_f32 v[138:139], v[64:65], v[66:67]
    v_pk_add_f32 v[140:141], v[168:169], v[170:171]
    v_pk_add_f32 v[142:143], v[88:89], v[90:91]
    v_pk_add_f32 v[136:137], v[136:137], v[164:165]
    v_pk_add_f32 v[138:139], v[138:139], v[68:69]
    v_pk_add_f32 v[140:141], v[140:141], v[172:173]
    v_pk_add_f32 v[142:143], v[142:143], v[92:93]
    v_pk_add_f32 v[136:137], v[136:137], v[166:167]
    v_pk_add_f32 v[138:139], v[138:139], v[70:71]
    v_pk_add_f32 v[140:141], v[140:141], v[174:175]
    v_pk_add_f32 v[142:143], v[142:143], v[94:95]
    v_add_f32 v180, v136, v137
    v_add_f32 v188, v138, v139
    v_add_f32 v182, v140, v141
    v_add_f32 v190, v142, v143
    s_nop 0
    v_permlane32_swap_b32 v180, v182
    v_permlane32_swap_b32 v188, v190
    s_waitcnt lgkmcnt(0)
    s_nop 0
    v_mfma_f32_16x16x32_bf16 v[144:147], v[232:235], v[24:27], 0
    v_add_f32 v180, v180, v182
    v_add_f32 v188, v188, v190
    v_mfma_f32_16x16x32_bf16 v[148:151], v[236:239], v[24:27], 0
    s_nop 0
    v_permlane16_swap_b32 v180, v188
    v_add_f32 v180, v180, v188
    v_mfma_f32_16x16x32_bf16 v[152:155], v[232:235], v[28:31], 0
    v_rcp_f32_e64 v180, v180
    v_mfma_f32_16x16x32_bf16 v[156:159], v[236:239], v[28:31], 0
    v_mul_f32 v188, v180, v223
    v_mul_f32 v180, v180, v223
    v_mfma_f32_16x16x32_bf16 v[16:19], v[232:235], v[120:123], 0
    s_nop 0
    v_permlane16_swap_b32 v180, v188
    v_mov_b32_e64 v182, v180
    v_mfma_f32_16x16x32_bf16 v[20:23], v[236:239], v[120:123], 0
    v_mov_b32_e64 v190, v188
    v_permlane32_swap_b32 v180, v182
    s_nop 0
    v_permlane32_swap_b32_e64 v188, v190
    v_pk_mul_f32 v[160:161], v[160:161], v[180:181] op_sel_hi:[1,0]
    v_pk_mul_f32 v[162:163], v[162:163], v[180:181] op_sel_hi:[1,0]
    v_pk_mul_f32 v[164:165], v[164:165], v[180:181] op_sel_hi:[1,0]
    v_pk_mul_f32 v[166:167], v[166:167], v[180:181] op_sel_hi:[1,0]
    v_cvt_pk_bf16_f32 v160, v160, v161
    v_cvt_pk_bf16_f32 v161, v162, v163
    v_cvt_pk_bf16_f32 v162, v164, v165
    v_cvt_pk_bf16_f32 v163, v166, v167
    ds_write_b64 v4, v[160:161] offset:4096
    ds_write_b64 v5, v[162:163] offset:4096
    v_pk_mul_f32 v[64:65], v[64:65], v[188:189] op_sel_hi:[1,0]
    v_pk_mul_f32 v[66:67], v[66:67], v[188:189] op_sel_hi:[1,0]
    v_pk_mul_f32 v[68:69], v[68:69], v[188:189] op_sel_hi:[1,0]
    v_pk_mul_f32 v[70:71], v[70:71], v[188:189] op_sel_hi:[1,0]
    v_cvt_pk_bf16_f32 v64, v64, v65
    v_cvt_pk_bf16_f32 v65, v66, v67
    v_cvt_pk_bf16_f32 v66, v68, v69
    v_cvt_pk_bf16_f32 v67, v70, v71
    ds_write_b64 v6, v[64:65] offset:4096
    ds_write_b64 v7, v[66:67] offset:4096
    v_pk_mul_f32 v[168:169], v[168:169], v[182:183] op_sel_hi:[1,0]
    v_pk_mul_f32 v[170:171], v[170:171], v[182:183] op_sel_hi:[1,0]
    v_pk_mul_f32 v[172:173], v[172:173], v[182:183] op_sel_hi:[1,0]
    v_pk_mul_f32 v[174:175], v[174:175], v[182:183] op_sel_hi:[1,0]
    v_cvt_pk_bf16_f32 v168, v168, v169
    v_cvt_pk_bf16_f32 v169, v170, v171
    v_cvt_pk_bf16_f32 v170, v172, v173
    v_cvt_pk_bf16_f32 v171, v174, v175
    ds_write_b64 v4, v[168:169] offset:6144
    ds_write_b64 v5, v[170:171] offset:6144
    v_pk_mul_f32 v[88:89], v[88:89], v[190:191] op_sel_hi:[1,0]
    v_pk_mul_f32 v[90:91], v[90:91], v[190:191] op_sel_hi:[1,0]
    v_pk_mul_f32 v[92:93], v[92:93], v[190:191] op_sel_hi:[1,0]
    v_pk_mul_f32 v[94:95], v[94:95], v[190:191] op_sel_hi:[1,0]
    v_cvt_pk_bf16_f32 v88, v88, v89
    v_cvt_pk_bf16_f32 v89, v90, v91
    v_cvt_pk_bf16_f32 v90, v92, v93
    v_cvt_pk_bf16_f32 v91, v94, v95
    ds_write_b64 v6, v[88:89] offset:6144
    ds_write_b64 v7, v[90:91] offset:6144
    ds_read_b64_tr_b16 v[204:205], v201 offset:4096
    ds_read_b64_tr_b16 v[206:207], v201 offset:6144
    ds_read_b64_tr_b16 v[208:209], v203 offset:4096
    ds_read_b64_tr_b16 v[210:211], v203 offset:6144
    v_xor_b32 v201, 0x2000, v201
    v_xor_b32 v203, 0x2000, v203
    v_xor_b32 v197, 0x1000, v197
    s_waitcnt lgkmcnt(4)
    s_barrier
    ds_read_b64_tr_b16 v[128:129], v201 offset:0
    ds_read_b64_tr_b16 v[130:131], v201 offset:2048
    ds_read_b64_tr_b16 v[132:133], v203 offset:0
    ds_read_b64_tr_b16 v[134:135], v203 offset:2048
    ds_read_b128 v[48:51], v197 offset:0
    ds_read_b128 v[52:55], v197 offset:1024
    ds_read_b64_tr_b16 v[136:137], v201 offset:4096
    ds_read_b64_tr_b16 v[138:139], v201 offset:6144
    ds_read_b64_tr_b16 v[140:141], v203 offset:4096
    ds_read_b64_tr_b16 v[142:143], v203 offset:6144
    ds_read_b128 v[96:99], v197 offset:2048
    ds_read_b128 v[100:103], v197 offset:3072
    s_waitcnt lgkmcnt(12)
    s_nop 0
    v_mfma_f32_16x16x32_bf16 v[144:147], v[204:207], v[72:75], v[144:147]
    v_mfma_f32_16x16x32_bf16 v[148:151], v[208:211], v[72:75], v[148:151]
    v_mfma_f32_16x16x32_bf16 v[152:155], v[204:207], v[76:79], v[152:155]
    v_mfma_f32_16x16x32_bf16 v[156:159], v[208:211], v[76:79], v[156:159]
    v_mfma_f32_16x16x32_bf16 v[16:19], v[204:207], v[124:127], v[16:19]
    v_mfma_f32_16x16x32_bf16 v[20:23], v[208:211], v[124:127], v[20:23]
    s_waitcnt lgkmcnt(6)
    s_nop 0
    v_mfma_f32_16x16x32_bf16 v[144:147], v[128:131], v[48:51], v[144:147]
    v_mfma_f32_16x16x32_bf16 v[148:151], v[132:135], v[48:51], v[148:151]
    v_mfma_f32_16x16x32_bf16 v[152:155], v[128:131], v[52:55], v[152:155]
    v_mfma_f32_16x16x32_bf16 v[156:159], v[132:135], v[52:55], v[156:159]
    v_mfma_f32_16x16x32_bf16 v[16:19], v[128:131], v[104:107], v[16:19]
    v_mfma_f32_16x16x32_bf16 v[20:23], v[132:135], v[104:107], v[20:23]
    s_waitcnt lgkmcnt(0)
    s_nop 0
    v_mfma_f32_16x16x32_bf16 v[144:147], v[136:139], v[96:99], v[144:147]
    v_mfma_f32_16x16x32_bf16 v[148:151], v[140:143], v[96:99], v[148:151]
    v_mfma_f32_16x16x32_bf16 v[152:155], v[136:139], v[100:103], v[152:155]
    v_mfma_f32_16x16x32_bf16 v[156:159], v[140:143], v[100:103], v[156:159]
    v_mfma_f32_16x16x32_bf16 v[16:19], v[136:139], v[108:111], v[16:19]
    v_mfma_f32_16x16x32_bf16 v[20:23], v[140:143], v[108:111], v[20:23]
    ds_read_b64_tr_b16 v[224:225], v252 offset:8192
    ds_read_b64_tr_b16 v[226:227], v252 offset:9216
    ds_read_b64_tr_b16 v[228:229], v252 offset:8224
    ds_read_b64_tr_b16 v[230:231], v252 offset:9248
    s_xor_b32 s67, s67, 8
    s_lshl_b32 s3, s38, 2
    s_add_u32 s3, s3, 162112
    v_mov_b32 v4, s3
    v_mov_b32 v5, 1
    v_cvt_pk_bf16_f32 v144, v144, v145
    v_cvt_pk_bf16_f32 v145, v146, v147
    v_cvt_pk_bf16_f32 v146, v148, v149
    v_cvt_pk_bf16_f32 v147, v150, v151
    buffer_store_dwordx4 v[144:147], v199, s[48:51], s74 offen offset:0 sc1
    v_cvt_pk_bf16_f32 v152, v152, v153
    v_cvt_pk_bf16_f32 v153, v154, v155
    v_cvt_pk_bf16_f32 v154, v156, v157
    v_cvt_pk_bf16_f32 v155, v158, v159
    buffer_store_dwordx4 v[152:155], v199, s[48:51], s74 offen offset:1024 sc1
    v_cvt_pk_bf16_f32 v16, v16, v17
    v_cvt_pk_bf16_f32 v17, v18, v19
    v_cvt_pk_bf16_f32 v18, v20, v21
    v_cvt_pk_bf16_f32 v19, v22, v23
    s_mov_b32 exec_lo, 0x00010001
    s_mov_b32 exec_hi, 0x00010001
    buffer_store_dwordx4 v[16:19], v1, s[48:51], s75 offen sc1
    s_mov_b64 exec, -1
    ds_write_b32 v4, v5
    s_setprio 0
    v_pk_fma_f32 v[8:9], v[192:193], v[212:213], v[8:9] op_sel_hi:[0,1,1] neg_lo:[1,0,0] neg_hi:[1,0,0]
    v_pk_fma_f32 v[10:11], v[192:193], v[214:215], v[10:11] op_sel_hi:[0,1,1] neg_lo:[1,0,0] neg_hi:[1,0,0]
    v_pk_fma_f32 v[12:13], v[192:193], v[216:217], v[12:13] op_sel_hi:[0,1,1] neg_lo:[1,0,0] neg_hi:[1,0,0]
    v_pk_fma_f32 v[14:15], v[192:193], v[218:219], v[14:15] op_sel_hi:[0,1,1] neg_lo:[1,0,0] neg_hi:[1,0,0]
    v_cvt_pk_bf16_f32 v8, v8, v9
    v_cvt_pk_bf16_f32 v9, v10, v11
    v_cvt_pk_bf16_f32 v10, v12, v13
    v_cvt_pk_bf16_f32 v11, v14, v15
    v_pk_fma_f32 v[32:33], v[194:195], v[212:213], v[32:33] op_sel_hi:[0,1,1] neg_lo:[1,0,0] neg_hi:[1,0,0]
    v_pk_fma_f32 v[34:35], v[194:195], v[214:215], v[34:35] op_sel_hi:[0,1,1] neg_lo:[1,0,0] neg_hi:[1,0,0]
    v_pk_fma_f32 v[36:37], v[194:195], v[216:217], v[36:37] op_sel_hi:[0,1,1] neg_lo:[1,0,0] neg_hi:[1,0,0]
    v_pk_fma_f32 v[38:39], v[194:195], v[218:219], v[38:39] op_sel_hi:[0,1,1] neg_lo:[1,0,0] neg_hi:[1,0,0]
    v_cvt_pk_bf16_f32 v32, v32, v33
    v_cvt_pk_bf16_f32 v33, v34, v35
    v_cvt_pk_bf16_f32 v34, v36, v37
    v_cvt_pk_bf16_f32 v35, v38, v39
    v_pk_fma_f32 v[56:57], v[196:197], v[212:213], v[56:57] op_sel_hi:[0,1,1] neg_lo:[1,0,0] neg_hi:[1,0,0]
    v_pk_fma_f32 v[58:59], v[196:197], v[214:215], v[58:59] op_sel_hi:[0,1,1] neg_lo:[1,0,0] neg_hi:[1,0,0]
    v_pk_fma_f32 v[60:61], v[196:197], v[216:217], v[60:61] op_sel_hi:[0,1,1] neg_lo:[1,0,0] neg_hi:[1,0,0]
    v_pk_fma_f32 v[62:63], v[196:197], v[218:219], v[62:63] op_sel_hi:[0,1,1] neg_lo:[1,0,0] neg_hi:[1,0,0]
    v_cvt_pk_bf16_f32 v56, v56, v57
    v_cvt_pk_bf16_f32 v57, v58, v59
    v_cvt_pk_bf16_f32 v58, v60, v61
    v_cvt_pk_bf16_f32 v59, v62, v63
    v_pk_fma_f32 v[80:81], v[198:199], v[212:213], v[80:81] op_sel_hi:[0,1,1] neg_lo:[1,0,0] neg_hi:[1,0,0]
    v_pk_fma_f32 v[82:83], v[198:199], v[214:215], v[82:83] op_sel_hi:[0,1,1] neg_lo:[1,0,0] neg_hi:[1,0,0]
    v_pk_fma_f32 v[84:85], v[198:199], v[216:217], v[84:85] op_sel_hi:[0,1,1] neg_lo:[1,0,0] neg_hi:[1,0,0]
    v_pk_fma_f32 v[86:87], v[198:199], v[218:219], v[86:87] op_sel_hi:[0,1,1] neg_lo:[1,0,0] neg_hi:[1,0,0]
    v_cvt_pk_bf16_f32 v80, v80, v81
    v_cvt_pk_bf16_f32 v81, v82, v83
    v_cvt_pk_bf16_f32 v82, v84, v85
    v_cvt_pk_bf16_f32 v83, v86, v87
    s_waitcnt lgkmcnt(1)
    s_nop 0
    v_mfma_f32_16x16x32_bf16 v[144:147], v[224:227], v[8:11], 0
    v_mfma_f32_16x16x32_bf16 v[148:151], v[228:231], v[8:11], 0
    v_mfma_f32_16x16x32_bf16 v[152:155], v[224:227], v[32:35], 0
    v_mfma_f32_16x16x32_bf16 v[156:159], v[228:231], v[32:35], 0
    v_mfma_f32_16x16x32_bf16 v[160:163], v[224:227], v[56:59], 0
    v_mfma_f32_16x16x32_bf16 v[164:167], v[228:231], v[56:59], 0
    v_mfma_f32_16x16x32_bf16 v[168:171], v[224:227], v[80:83], 0
    v_mfma_f32_16x16x32_bf16 v[172:175], v[228:231], v[80:83], 0
    s_nop 0
    s_nop 0
    v_max3_f32 v176, v144, v145, v146
    v_max3_f32 v184, -v144, -v145, -v146
    v_max3_f32 v178, v152, v153, v154
    v_max3_f32 v186, -v152, -v153, -v154
    v_max3_f32 v176, v176, v147, v148
    v_max3_f32 v184, v184, -v147, -v148
    v_max3_f32 v178, v178, v155, v156
    v_max3_f32 v186, v186, -v155, -v156
    v_max3_f32 v176, v176, v149, v150
    v_max3_f32 v184, v184, -v149, -v150
    v_max3_f32 v178, v178, v157, v158
    v_max3_f32 v186, v186, -v157, -v158
    v_max_f32_e64 v176, v176, v151
    v_max_f32_e64 v184, v184, -v151
    v_max_f32_e64 v178, v178, v159
    v_max_f32_e64 v186, v186, -v159
    s_nop 0
    v_permlane32_swap_b32 v176, v178
    v_permlane32_swap_b32_e64 v184, v186
    v_max3_f32 v180, v160, v161, v162
    v_max3_f32 v188, -v160, -v161, -v162
    v_max_f32 v176, v176, v178
    v_max_f32 v184, v184, v186
    v_max3_f32 v182, v168, v169, v170
    v_max3_f32 v190, -v168, -v169, -v170
    v_permlane16_swap_b32 v176, v184
    v_max_f32 v176, v176, v184
    v_max3_f32 v180, v180, v163, v164
    v_max3_f32 v188, v188, -v163, -v164
    v_mul_f32 v184, v176, v193
    v_mul_f32 v176, v176, v193
    v_max3_f32 v182, v182, v171, v172
    v_max3_f32 v190, v190, -v171, -v172
    v_permlane16_swap_b32 v176, v184
    v_mov_b32 v178, v176
    v_max3_f32 v180, v180, v165, v166
    v_max3_f32 v188, v188, -v165, -v166
    v_mov_b32_e64 v186, v184
    v_max3_f32 v182, v182, v173, v174
    v_max3_f32 v190, v190, -v173, -v174
    v_permlane32_swap_b32 v176, v178
    v_permlane32_swap_b32 v184, v186
    v_max_f32_e64 v180, v180, v167
    v_max_f32_e64 v188, v188, -v167
    v_max_f32_e64 v182, v182, v175
    v_max_f32_e64 v190, v190, -v175
    s_nop 0
    v_permlane32_swap_b32 v180, v182
    v_permlane32_swap_b32_e64 v188, v190
    v_pk_fma_f32 v[8:9], v[144:145], v[200:201], v[184:185] op_sel_hi:[1,0,0] neg_lo:[1,0,1] neg_hi:[1,0,1]
    v_pk_fma_f32 v[144:145], v[144:145], v[200:201], v[176:177] op_sel_hi:[1,0,0] neg_lo:[0,0,1] neg_hi:[0,0,1]
    v_max_f32 v180, v180, v182
    v_max_f32 v188, v188, v190
    v_pk_fma_f32 v[10:11], v[146:147], v[200:201], v[184:185] op_sel_hi:[1,0,0] neg_lo:[1,0,1] neg_hi:[1,0,1]
    v_pk_fma_f32 v[146:147], v[146:147], v[200:201], v[176:177] op_sel_hi:[1,0,0] neg_lo:[0,0,1] neg_hi:[0,0,1]
    v_permlane16_swap_b32 v180, v188
    v_max_f32 v180, v180, v188
    v_pk_fma_f32 v[12:13], v[148:149], v[200:201], v[184:185] op_sel_hi:[1,0,0] neg_lo:[1,0,1] neg_hi:[1,0,1]
    v_pk_fma_f32 v[148:149], v[148:149], v[200:201], v[176:177] op_sel_hi:[1,0,0] neg_lo:[0,0,1] neg_hi:[0,0,1]
    v_mul_f32 v188, v180, v221
    v_mul_f32 v180, v180, v221
    v_pk_fma_f32 v[14:15], v[150:151], v[200:201], v[184:185] op_sel_hi:[1,0,0] neg_lo:[1,0,1] neg_hi:[1,0,1]
    v_pk_fma_f32 v[150:151], v[150:151], v[200:201], v[176:177] op_sel_hi:[1,0,0] neg_lo:[0,0,1] neg_hi:[0,0,1]
    v_permlane16_swap_b32 v180, v188
    v_mov_b32 v182, v180
    v_pk_fma_f32 v[32:33], v[152:153], v[202:203], v[186:187] op_sel_hi:[1,0,0] neg_lo:[1,0,1] neg_hi:[1,0,1]
    v_pk_fma_f32 v[152:153], v[152:153], v[202:203], v[178:179] op_sel_hi:[1,0,0] neg_lo:[0,0,1] neg_hi:[0,0,1]
    v_mov_b32_e64 v190, v188
    v_pk_fma_f32 v[34:35], v[154:155], v[202:203], v[186:187] op_sel_hi:[1,0,0] neg_lo:[1,0,1] neg_hi:[1,0,1]
    v_pk_fma_f32 v[154:155], v[154:155], v[202:203], v[178:179] op_sel_hi:[1,0,0] neg_lo:[0,0,1] neg_hi:[0,0,1]
    v_permlane32_swap_b32 v180, v182
    v_permlane32_swap_b32 v188, v190
    v_pk_fma_f32 v[36:37], v[156:157], v[202:203], v[186:187] op_sel_hi:[1,0,0] neg_lo:[1,0,1] neg_hi:[1,0,1]
    v_pk_fma_f32 v[156:157], v[156:157], v[202:203], v[178:179] op_sel_hi:[1,0,0] neg_lo:[0,0,1] neg_hi:[0,0,1]
    v_pk_fma_f32 v[38:39], v[158:159], v[202:203], v[186:187] op_sel_hi:[1,0,0] neg_lo:[1,0,1] neg_hi:[1,0,1]
    v_pk_fma_f32 v[158:159], v[158:159], v[202:203], v[178:179] op_sel_hi:[1,0,0] neg_lo:[0,0,1] neg_hi:[0,0,1]
    v_exp_f32 v8, v8
    v_exp_f32 v144, v144
    v_exp_f32 v9, v9
    v_exp_f32 v145, v145
    v_exp_f32 v10, v10
    v_exp_f32 v146, v146
    v_exp_f32 v11, v11
    v_exp_f32 v147, v147
    v_exp_f32 v12, v12
    v_exp_f32 v148, v148
    v_exp_f32 v13, v13
    v_exp_f32 v149, v149
    v_exp_f32 v14, v14
    v_exp_f32 v150, v150
    v_exp_f32 v15, v15
    v_exp_f32 v151, v151
    v_exp_f32 v32, v32
    v_exp_f32 v152, v152
    v_exp_f32 v33, v33
    v_exp_f32 v153, v153
    v_exp_f32 v34, v34
    v_exp_f32 v154, v154
    v_exp_f32 v35, v35
    v_exp_f32 v155, v155
    v_exp_f32 v36, v36
    v_exp_f32 v156, v156
    v_exp_f32 v37, v37
    v_exp_f32 v157, v157
    v_exp_f32 v38, v38
    v_exp_f32 v158, v158
    v_exp_f32 v39, v39
    v_exp_f32 v159, v159
    v_pk_add_f32 v[128:129], v[144:145], v[146:147]
    v_pk_add_f32 v[130:131], v[8:9], v[10:11]
    v_pk_add_f32 v[132:133], v[152:153], v[154:155]
    v_pk_add_f32 v[134:135], v[32:33], v[34:35]
    v_pk_add_f32 v[128:129], v[128:129], v[148:149]
    v_pk_add_f32 v[130:131], v[130:131], v[12:13]
    v_pk_add_f32 v[132:133], v[132:133], v[156:157]
    v_pk_add_f32 v[134:135], v[134:135], v[36:37]
    v_pk_add_f32 v[128:129], v[128:129], v[150:151]
    v_pk_add_f32 v[130:131], v[130:131], v[14:15]
    v_pk_add_f32 v[132:133], v[132:133], v[158:159]
    v_pk_add_f32 v[134:135], v[134:135], v[38:39]
    v_add_f32 v176, v128, v129
    v_add_f32 v184, v130, v131
    v_add_f32 v178, v132, v133
    v_add_f32 v186, v134, v135
    s_nop 0
    v_permlane32_swap_b32 v176, v178
    v_permlane32_swap_b32_e64 v184, v186
    v_pk_fma_f32 v[56:57], v[160:161], v[220:221], v[188:189] op_sel_hi:[1,0,0] neg_lo:[1,0,1] neg_hi:[1,0,1]
    v_pk_fma_f32 v[160:161], v[160:161], v[220:221], v[180:181] op_sel_hi:[1,0,0] neg_lo:[0,0,1] neg_hi:[0,0,1]
    v_add_f32 v176, v176, v178
    v_add_f32 v184, v184, v186
    v_pk_fma_f32 v[58:59], v[162:163], v[220:221], v[188:189] op_sel_hi:[1,0,0] neg_lo:[1,0,1] neg_hi:[1,0,1]
    v_pk_fma_f32 v[162:163], v[162:163], v[220:221], v[180:181] op_sel_hi:[1,0,0] neg_lo:[0,0,1] neg_hi:[0,0,1]
    v_permlane16_swap_b32 v176, v184
    v_add_f32 v176, v176, v184
    v_pk_fma_f32 v[60:61], v[164:165], v[220:221], v[188:189] op_sel_hi:[1,0,0] neg_lo:[1,0,1] neg_hi:[1,0,1]
    v_pk_fma_f32 v[164:165], v[164:165], v[220:221], v[180:181] op_sel_hi:[1,0,0] neg_lo:[0,0,1] neg_hi:[0,0,1]
    v_rcp_f32_e64 v176, v176
    v_pk_fma_f32 v[62:63], v[166:167], v[220:221], v[188:189] op_sel_hi:[1,0,0] neg_lo:[1,0,1] neg_hi:[1,0,1]
    v_pk_fma_f32 v[166:167], v[166:167], v[220:221], v[180:181] op_sel_hi:[1,0,0] neg_lo:[0,0,1] neg_hi:[0,0,1]
    v_mov_b32_e64 v184, v176
    v_pk_fma_f32 v[80:81], v[168:169], v[222:223], v[190:191] op_sel_hi:[1,0,0] neg_lo:[1,0,1] neg_hi:[1,0,1]
    v_pk_fma_f32 v[168:169], v[168:169], v[222:223], v[182:183] op_sel_hi:[1,0,0] neg_lo:[0,0,1] neg_hi:[0,0,1]
    v_permlane16_swap_b32 v176, v184
    v_mov_b32 v178, v176
    v_pk_fma_f32 v[82:83], v[170:171], v[222:223], v[190:191] op_sel_hi:[1,0,0] neg_lo:[1,0,1] neg_hi:[1,0,1]
    v_pk_fma_f32 v[170:171], v[170:171], v[222:223], v[182:183] op_sel_hi:[1,0,0] neg_lo:[0,0,1] neg_hi:[0,0,1]
    v_mov_b32_e64 v186, v184
    v_pk_fma_f32 v[84:85], v[172:173], v[222:223], v[190:191] op_sel_hi:[1,0,0] neg_lo:[1,0,1] neg_hi:[1,0,1]
    v_pk_fma_f32 v[172:173], v[172:173], v[222:223], v[182:183] op_sel_hi:[1,0,0] neg_lo:[0,0,1] neg_hi:[0,0,1]
    v_permlane32_swap_b32 v176, v178
    v_permlane32_swap_b32 v184, v186
    v_pk_fma_f32 v[86:87], v[174:175], v[222:223], v[190:191] op_sel_hi:[1,0,0] neg_lo:[1,0,1] neg_hi:[1,0,1]
    v_pk_fma_f32 v[174:175], v[174:175], v[222:223], v[182:183] op_sel_hi:[1,0,0] neg_lo:[0,0,1] neg_hi:[0,0,1]
    v_pk_mul_f32 v[144:145], v[144:145], v[176:177] op_sel_hi:[1,0]
    v_pk_mul_f32 v[146:147], v[146:147], v[176:177] op_sel_hi:[1,0]
    v_pk_mul_f32 v[148:149], v[148:149], v[176:177] op_sel_hi:[1,0]
    v_pk_mul_f32 v[150:151], v[150:151], v[176:177] op_sel_hi:[1,0]
    v_cvt_pk_bf16_f32 v144, v144, v145
    v_cvt_pk_bf16_f32 v145, v146, v147
    v_cvt_pk_bf16_f32 v146, v148, v149
    v_cvt_pk_bf16_f32 v147, v150, v151
    v_pk_mul_f32 v[8:9], v[8:9], v[184:185] op_sel_hi:[1,0]
    v_pk_mul_f32 v[10:11], v[10:11], v[184:185] op_sel_hi:[1,0]
    v_pk_mul_f32 v[12:13], v[12:13], v[184:185] op_sel_hi:[1,0]
    v_pk_mul_f32 v[14:15], v[14:15], v[184:185] op_sel_hi:[1,0]
    v_cvt_pk_bf16_f32 v8, v8, v9
    v_cvt_pk_bf16_f32 v9, v10, v11
    v_cvt_pk_bf16_f32 v10, v12, v13
    v_cvt_pk_bf16_f32 v11, v14, v15
    v_pk_mul_f32 v[152:153], v[152:153], v[178:179] op_sel_hi:[1,0]
    v_pk_mul_f32 v[154:155], v[154:155], v[178:179] op_sel_hi:[1,0]
    v_pk_mul_f32 v[156:157], v[156:157], v[178:179] op_sel_hi:[1,0]
    v_pk_mul_f32 v[158:159], v[158:159], v[178:179] op_sel_hi:[1,0]
    v_cvt_pk_bf16_f32 v152, v152, v153
    v_cvt_pk_bf16_f32 v153, v154, v155
    v_cvt_pk_bf16_f32 v154, v156, v157
    v_cvt_pk_bf16_f32 v155, v158, v159
    v_pk_mul_f32 v[32:33], v[32:33], v[186:187] op_sel_hi:[1,0]
    v_pk_mul_f32 v[34:35], v[34:35], v[186:187] op_sel_hi:[1,0]
    v_pk_mul_f32 v[36:37], v[36:37], v[186:187] op_sel_hi:[1,0]
    v_pk_mul_f32 v[38:39], v[38:39], v[186:187] op_sel_hi:[1,0]
    v_cvt_pk_bf16_f32 v32, v32, v33
    v_cvt_pk_bf16_f32 v33, v34, v35
    v_cvt_pk_bf16_f32 v34, v36, v37
    v_cvt_pk_bf16_f32 v35, v38, v39
    v_exp_f32 v56, v56
    v_exp_f32 v160, v160
    v_exp_f32 v57, v57
    v_exp_f32 v161, v161
    v_exp_f32 v58, v58
    v_exp_f32 v162, v162
    v_exp_f32 v59, v59
    v_exp_f32 v163, v163
    v_exp_f32 v60, v60
    v_exp_f32 v164, v164
    v_exp_f32 v61, v61
    v_exp_f32 v165, v165
    v_exp_f32 v62, v62
    v_exp_f32 v166, v166
    v_exp_f32 v63, v63
    v_exp_f32 v167, v167
    v_exp_f32 v80, v80
    v_exp_f32 v168, v168
    v_exp_f32 v81, v81
    v_exp_f32 v169, v169
    v_exp_f32 v82, v82
    v_exp_f32 v170, v170
    v_exp_f32 v83, v83
    v_exp_f32 v171, v171
    v_exp_f32 v84, v84
    v_exp_f32 v172, v172
    v_exp_f32 v85, v85
    v_exp_f32 v173, v173
    v_exp_f32 v86, v86
    v_exp_f32 v174, v174
    v_exp_f32 v87, v87
    v_exp_f32 v175, v175
    v_pk_add_f32 v[136:137], v[160:161], v[162:163]
    v_pk_add_f32 v[138:139], v[56:57], v[58:59]
    v_pk_add_f32 v[140:141], v[168:169], v[170:171]
    v_pk_add_f32 v[142:143], v[80:81], v[82:83]
    v_pk_add_f32 v[136:137], v[136:137], v[164:165]
    v_pk_add_f32 v[138:139], v[138:139], v[60:61]
    v_pk_add_f32 v[140:141], v[140:141], v[172:173]
    v_pk_add_f32 v[142:143], v[142:143], v[84:85]
    v_pk_add_f32 v[136:137], v[136:137], v[166:167]
    v_pk_add_f32 v[138:139], v[138:139], v[62:63]
    v_pk_add_f32 v[140:141], v[140:141], v[174:175]
    v_pk_add_f32 v[142:143], v[142:143], v[86:87]
    v_add_f32 v180, v136, v137
    v_add_f32 v188, v138, v139
    v_add_f32 v182, v140, v141
    v_add_f32 v190, v142, v143
    s_nop 0
    v_permlane32_swap_b32 v180, v182
    v_permlane32_swap_b32 v188, v190
    v_add_f32 v180, v180, v182
    v_add_f32 v188, v188, v190
    s_nop 1
    v_permlane16_swap_b32 v180, v188
    v_add_f32 v180, v180, v188
    v_rcp_f32_e64 v180, v180
    s_nop 0
    v_mov_b32_e64 v188, v180
    s_nop 1
    v_permlane16_swap_b32 v180, v188
    v_mov_b32 v182, v180
    v_mov_b32_e64 v190, v188
    s_nop 0
    v_permlane32_swap_b32 v180, v182
    v_permlane32_swap_b32_e64 v188, v190
    v_pk_mul_f32 v[160:161], v[160:161], v[180:181] op_sel_hi:[1,0]
    v_pk_mul_f32 v[162:163], v[162:163], v[180:181] op_sel_hi:[1,0]
    v_pk_mul_f32 v[164:165], v[164:165], v[180:181] op_sel_hi:[1,0]
    v_pk_mul_f32 v[166:167], v[166:167], v[180:181] op_sel_hi:[1,0]
    v_cvt_pk_bf16_f32 v160, v160, v161
    v_cvt_pk_bf16_f32 v161, v162, v163
    v_cvt_pk_bf16_f32 v162, v164, v165
    v_cvt_pk_bf16_f32 v163, v166, v167
    v_pk_mul_f32 v[56:57], v[56:57], v[188:189] op_sel_hi:[1,0]
    v_pk_mul_f32 v[58:59], v[58:59], v[188:189] op_sel_hi:[1,0]
    v_pk_mul_f32 v[60:61], v[60:61], v[188:189] op_sel_hi:[1,0]
    v_pk_mul_f32 v[62:63], v[62:63], v[188:189] op_sel_hi:[1,0]
    v_cvt_pk_bf16_f32 v56, v56, v57
    v_cvt_pk_bf16_f32 v57, v58, v59
    v_cvt_pk_bf16_f32 v58, v60, v61
    v_cvt_pk_bf16_f32 v59, v62, v63
    v_pk_mul_f32 v[168:169], v[168:169], v[182:183] op_sel_hi:[1,0]
    v_pk_mul_f32 v[170:171], v[170:171], v[182:183] op_sel_hi:[1,0]
    v_pk_mul_f32 v[172:173], v[172:173], v[182:183] op_sel_hi:[1,0]
    v_pk_mul_f32 v[174:175], v[174:175], v[182:183] op_sel_hi:[1,0]
    v_cvt_pk_bf16_f32 v168, v168, v169
    v_cvt_pk_bf16_f32 v169, v170, v171
    v_cvt_pk_bf16_f32 v170, v172, v173
    v_cvt_pk_bf16_f32 v171, v174, v175
    v_pk_mul_f32 v[80:81], v[80:81], v[190:191] op_sel_hi:[1,0]
    v_pk_mul_f32 v[82:83], v[82:83], v[190:191] op_sel_hi:[1,0]
    v_pk_mul_f32 v[84:85], v[84:85], v[190:191] op_sel_hi:[1,0]
    v_pk_mul_f32 v[86:87], v[86:87], v[190:191] op_sel_hi:[1,0]
    v_cvt_pk_bf16_f32 v80, v80, v81
    v_cvt_pk_bf16_f32 v81, v82, v83
    v_cvt_pk_bf16_f32 v82, v84, v85
    v_cvt_pk_bf16_f32 v83, v86, v87
    v_mov_b32 v2, 162048
    ds_read_b32 v248, v2
    v_lshrrev_b32 v5, 3, v1
    v_lshlrev_b32 v6, 11, v5
    v_bfe_u32 v5, v1, 4, 2
    v_lshlrev_b32 v5, 1, v5
    v_and_b32 v7, 7, v1
    v_xor_b32 v5, v5, v7
    v_lshl_add_u32 v6, v5, 4, v6
    s_lshl_b32 s3, s35, 7
    v_add_u32 v6, s3, v6
    v_add_u32 v216, 0, v6
    v_add_u32 v217, 15360, v6
    v_add_u32 v218, 30720, v6
    v_add_u32 v219, 46080, v6
    s_lshl_b32 s72, s38, 12
    s_lshl_b32 s73, s38, 16
    v_and_b32 v2, 15, v1
    v_add_u32 v2, s69, v2
    v_lshlrev_b32_e64 v2, 2, v2
    v_add_u32 v2, 152064, v2
    ds_read_b32 v193, v2
    ds_read_b32 v192, v2 offset:1024
    s_mul_i32 s76, s67, 4224
    s_add_u32 s76, s76, 1048576
    v_lshlrev_b32 v5, 4, v1
    v_and_b32 v6, 48, v1
    v_add_u32 v6, 4096, v6
    s_lshl_b32 s3, s38, 2
    s_add_u32 s3, s3, 162112
    v_mov_b32 v3, s3
L_gw:
    ds_read_b32 v2, v3
    s_waitcnt lgkmcnt(0)
    v_readfirstlane_b32 s3, v2
    s_nop 0
    s_cmp_eq_u32 s3, 3
    s_cbranch_scc1 L_gk
    s_sleep 1
    s_branch L_gw
L_gk:
    v_mul_f32 v196, v193, v192
    v_mov_b32 v198, 0xbfb8aa3b
    v_lshlrev_b32 v224, 16, v240
    v_and_b32 v225, 0xffff0000, v240
    v_lshlrev_b32 v226, 16, v241
    v_and_b32 v227, 0xffff0000, v241
    v_lshlrev_b32 v228, 16, v242
    v_and_b32 v229, 0xffff0000, v242
    v_lshlrev_b32 v230, 16, v243
    v_and_b32 v231, 0xffff0000, v243
    v_lshlrev_b32 v232, 16, v244
    v_and_b32 v233, 0xffff0000, v244
    v_lshlrev_b32 v234, 16, v245
    v_and_b32 v235, 0xffff0000, v245
    v_lshlrev_b32 v236, 16, v246
    v_and_b32 v237, 0xffff0000, v246
    v_lshlrev_b32 v238, 16, v247
    v_and_b32 v239, 0xffff0000, v247
    v_pk_fma_f32 v[224:225], v[224:225], v[192:193], v[196:197] op_sel_hi:[1,0,0] neg_lo:[0,0,1] neg_hi:[0,0,1]
    v_pk_fma_f32 v[226:227], v[226:227], v[192:193], v[196:197] op_sel_hi:[1,0,0] neg_lo:[0,0,1] neg_hi:[0,0,1]
    v_pk_fma_f32 v[228:229], v[228:229], v[192:193], v[196:197] op_sel_hi:[1,0,0] neg_lo:[0,0,1] neg_hi:[0,0,1]
    v_pk_fma_f32 v[230:231], v[230:231], v[192:193], v[196:197] op_sel_hi:[1,0,0] neg_lo:[0,0,1] neg_hi:[0,0,1]
    v_pk_fma_f32 v[232:233], v[232:233], v[192:193], v[196:197] op_sel_hi:[1,0,0] neg_lo:[0,0,1] neg_hi:[0,0,1]
    v_pk_fma_f32 v[234:235], v[234:235], v[192:193], v[196:197] op_sel_hi:[1,0,0] neg_lo:[0,0,1] neg_hi:[0,0,1]
    v_pk_fma_f32 v[236:237], v[236:237], v[192:193], v[196:197] op_sel_hi:[1,0,0] neg_lo:[0,0,1] neg_hi:[0,0,1]
    v_pk_fma_f32 v[238:239], v[238:239], v[192:193], v[196:197] op_sel_hi:[1,0,0] neg_lo:[0,0,1] neg_hi:[0,0,1]
    v_pk_mul_f32 v[200:201], v[224:225], v[198:199] op_sel_hi:[1,0]
    v_pk_mul_f32 v[202:203], v[226:227], v[198:199] op_sel_hi:[1,0]
    v_pk_mul_f32 v[204:205], v[228:229], v[198:199] op_sel_hi:[1,0]
    v_pk_mul_f32 v[206:207], v[230:231], v[198:199] op_sel_hi:[1,0]
    v_pk_mul_f32 v[208:209], v[232:233], v[198:199] op_sel_hi:[1,0]
    v_pk_mul_f32 v[210:211], v[234:235], v[198:199] op_sel_hi:[1,0]
    v_pk_mul_f32 v[212:213], v[236:237], v[198:199] op_sel_hi:[1,0]
    v_pk_mul_f32 v[214:215], v[238:239], v[198:199] op_sel_hi:[1,0]
    v_exp_f32 v200, v200
    v_exp_f32 v201, v201
    v_exp_f32 v202, v202
    v_exp_f32 v203, v203
    v_exp_f32 v204, v204
    v_exp_f32 v205, v205
    v_exp_f32 v206, v206
    v_exp_f32 v207, v207
    v_exp_f32 v208, v208
    v_exp_f32 v209, v209
    v_exp_f32 v210, v210
    v_exp_f32 v211, v211
    v_exp_f32 v212, v212
    v_exp_f32 v213, v213
    v_exp_f32 v214, v214
    v_exp_f32 v215, v215
    v_pk_add_f32 v[200:201], v[200:201], 1.0 op_sel_hi:[1,0]
    v_pk_add_f32 v[202:203], v[202:203], 1.0 op_sel_hi:[1,0]
    v_pk_add_f32 v[204:205], v[204:205], 1.0 op_sel_hi:[1,0]
    v_pk_add_f32 v[206:207], v[206:207], 1.0 op_sel_hi:[1,0]
    v_pk_add_f32 v[208:209], v[208:209], 1.0 op_sel_hi:[1,0]
    v_pk_add_f32 v[210:211], v[210:211], 1.0 op_sel_hi:[1,0]
    v_pk_add_f32 v[212:213], v[212:213], 1.0 op_sel_hi:[1,0]
    v_pk_add_f32 v[214:215], v[214:215], 1.0 op_sel_hi:[1,0]
    v_rcp_f32 v200, v200
    v_rcp_f32 v201, v201
    v_rcp_f32 v202, v202
    v_rcp_f32 v203, v203
    v_rcp_f32 v204, v204
    v_rcp_f32 v205, v205
    v_rcp_f32 v206, v206
    v_rcp_f32 v207, v207
    v_rcp_f32 v208, v208
    v_rcp_f32 v209, v209
    v_rcp_f32 v210, v210
    v_rcp_f32 v211, v211
    v_rcp_f32 v212, v212
    v_rcp_f32 v213, v213
    v_rcp_f32 v214, v214
    v_rcp_f32 v215, v215
    v_pk_mul_f32 v[224:225], v[224:225], v[200:201]
    v_pk_mul_f32 v[226:227], v[226:227], v[202:203]
    v_pk_mul_f32 v[228:229], v[228:229], v[204:205]
    v_pk_mul_f32 v[230:231], v[230:231], v[206:207]
    v_pk_mul_f32 v[232:233], v[232:233], v[208:209]
    v_pk_mul_f32 v[234:235], v[234:235], v[210:211]
    v_pk_mul_f32 v[236:237], v[236:237], v[212:213]
    v_pk_mul_f32 v[238:239], v[238:239], v[214:215]
    buffer_load_dwordx4 v[104:107], v5, s[48:51], s76 offen offset:0 sc1
    buffer_load_dwordx4 v[108:111], v5, s[48:51], s76 offen offset:1024 sc1
    buffer_load_dwordx4 v[112:115], v5, s[48:51], s76 offen offset:2048 sc1
    buffer_load_dwordx4 v[116:119], v5, s[48:51], s76 offen offset:3072 sc1
    buffer_load_dwordx4 v[120:123], v6, s[48:51], s76 offen offset:0 sc1
    buffer_load_dwordx4 v[124:127], v6, s[48:51], s76 offen offset:64 sc1
    s_waitcnt lgkmcnt(0)
    v_readfirstlane_b32 s70, v248
    s_nop 0
    s_and_b32 s68, s70, 0x7ff
    s_sub_u32 s68, 2047, s68
    s_lshl_b32 s3, s36, 3
    s_lshl_b32 s28, s64, 2
    s_add_u32 s3, s3, s28
    s_lshl_b32 s3, s3, 5
    s_add_u32 s3, s3, s67
    s_lshl_b32 s77, s3, 10
    s_add_u32 s77, s77, 4194304
    s_waitcnt vmcnt(0)
    s_mov_b32 s29, 0
L_k7:
    s_nop 0
    v_max3_u32 v2, v104, v105, v106
    v_max3_u32 v2, v2, v107, v108
    v_max3_u32 v2, v2, v109, v110
    v_max3_u32 v2, v2, v111, v112
    v_max3_u32 v2, v2, v113, v114
    v_max3_u32 v2, v2, v115, v116
    v_max3_u32 v2, v2, v117, v118
    v_max3_u32 v2, v2, v119, v120
    v_max3_u32 v2, v2, v121, v122
    v_max3_u32 v2, v2, v123, v124
    v_max3_u32 v2, v2, v125, v126
    v_max_u32 v2, v2, v127
    v_cmp_eq_u32 vcc, -1, v2
    s_cbranch_vccz L_k7k
    s_add_u32 s29, s29, 1
    s_cmp_ge_u32 s29, 200000
    s_cbranch_scc1 L_k7k
    s_sleep 1
    buffer_load_dwordx4 v[104:107], v5, s[48:51], s76 offen offset:0 sc1
    buffer_load_dwordx4 v[108:111], v5, s[48:51], s76 offen offset:1024 sc1
    buffer_load_dwordx4 v[112:115], v5, s[48:51], s76 offen offset:2048 sc1
    buffer_load_dwordx4 v[116:119], v5, s[48:51], s76 offen offset:3072 sc1
    buffer_load_dwordx4 v[120:123], v6, s[48:51], s76 offen offset:0 sc1
    buffer_load_dwordx4 v[124:127], v6, s[48:51], s76 offen offset:64 sc1
    s_waitcnt vmcnt(0)
    s_branch L_k7
L_k7k:
    s_setprio 2
    s_nop 0
    v_mfma_f32_16x16x32_bf16 v[24:27], v[120:123], v[144:147], 0
    v_mfma_f32_16x16x32_bf16 v[16:19], v[104:107], v[144:147], 0
    v_mfma_f32_16x16x32_bf16 v[20:23], v[108:111], v[144:147], 0
    v_mfma_f32_16x16x32_bf16 v[24:27], v[124:127], v[8:11], v[24:27]
    v_mfma_f32_16x16x32_bf16 v[16:19], v[112:115], v[8:11], v[16:19]
    v_mfma_f32_16x16x32_bf16 v[20:23], v[116:119], v[8:11], v[20:23]
    v_mfma_f32_16x16x32_bf16 v[48:51], v[120:123], v[152:155], 0
    v_mfma_f32_16x16x32_bf16 v[40:43], v[104:107], v[152:155], 0
    v_mfma_f32_16x16x32_bf16 v[44:47], v[108:111], v[152:155], 0
    v_mfma_f32_16x16x32_bf16 v[48:51], v[124:127], v[32:35], v[48:51]
    v_mfma_f32_16x16x32_bf16 v[40:43], v[112:115], v[32:35], v[40:43]
    v_mfma_f32_16x16x32_bf16 v[44:47], v[116:119], v[32:35], v[44:47]
    v_mfma_f32_16x16x32_bf16 v[72:75], v[120:123], v[160:163], 0
    v_mfma_f32_16x16x32_bf16 v[64:67], v[104:107], v[160:163], 0
    v_mfma_f32_16x16x32_bf16 v[68:71], v[108:111], v[160:163], 0
    v_mfma_f32_16x16x32_bf16 v[72:75], v[124:127], v[56:59], v[72:75]
    v_mfma_f32_16x16x32_bf16 v[64:67], v[112:115], v[56:59], v[64:67]
    v_mfma_f32_16x16x32_bf16 v[68:71], v[116:119], v[56:59], v[68:71]
    v_mfma_f32_16x16x32_bf16 v[96:99], v[120:123], v[168:171], 0
    v_mfma_f32_16x16x32_bf16 v[88:91], v[104:107], v[168:171], 0
    v_mfma_f32_16x16x32_bf16 v[92:95], v[108:111], v[168:171], 0
    v_mfma_f32_16x16x32_bf16 v[96:99], v[124:127], v[80:83], v[96:99]
    v_mfma_f32_16x16x32_bf16 v[88:91], v[112:115], v[80:83], v[88:91]
    v_mfma_f32_16x16x32_bf16 v[92:95], v[116:119], v[80:83], v[92:95]
    v_add_f32 v24, 0x358637bd, v24
    v_add_f32 v48, 0x358637bd, v48
    v_add_f32 v72, 0x358637bd, v72
    s_nop 2
    v_add_f32 v96, 0x358637bd, v96
    v_rcp_f32 v24, v24
    v_rcp_f32 v48, v48
    v_rcp_f32 v72, v72
    v_rcp_f32_e64 v96, v96
    v_pk_mul_f32 v[16:17], v[16:17], v[24:25] op_sel_hi:[1,0]
    v_pk_mul_f32 v[18:19], v[18:19], v[24:25] op_sel_hi:[1,0]
    v_pk_mul_f32 v[20:21], v[20:21], v[24:25] op_sel_hi:[1,0]
    v_pk_mul_f32 v[22:23], v[22:23], v[24:25] op_sel_hi:[1,0]
    v_cvt_pk_bf16_f32 v16, v16, v17
    v_cvt_pk_bf16_f32 v17, v18, v19
    v_cvt_pk_bf16_f32 v18, v20, v21
    v_cvt_pk_bf16_f32 v19, v22, v23
    buffer_store_dwordx4 v[16:19], v5, s[48:51], s77 offen sc1
    s_add_u32 s77, s77, 32768
    v_pk_mul_f32 v[40:41], v[40:41], v[48:49] op_sel_hi:[1,0]
    v_pk_mul_f32 v[42:43], v[42:43], v[48:49] op_sel_hi:[1,0]
    v_pk_mul_f32 v[44:45], v[44:45], v[48:49] op_sel_hi:[1,0]
    v_pk_mul_f32 v[46:47], v[46:47], v[48:49] op_sel_hi:[1,0]
    v_cvt_pk_bf16_f32 v40, v40, v41
    v_cvt_pk_bf16_f32 v41, v42, v43
    v_cvt_pk_bf16_f32 v42, v44, v45
    v_cvt_pk_bf16_f32 v43, v46, v47
    buffer_store_dwordx4 v[40:43], v5, s[48:51], s77 offen sc1
    s_add_u32 s77, s77, 32768
    v_pk_mul_f32 v[64:65], v[64:65], v[72:73] op_sel_hi:[1,0]
    v_pk_mul_f32 v[66:67], v[66:67], v[72:73] op_sel_hi:[1,0]
    v_pk_mul_f32 v[68:69], v[68:69], v[72:73] op_sel_hi:[1,0]
    v_pk_mul_f32 v[70:71], v[70:71], v[72:73] op_sel_hi:[1,0]
    v_cvt_pk_bf16_f32 v64, v64, v65
    v_cvt_pk_bf16_f32 v65, v66, v67
    v_cvt_pk_bf16_f32 v66, v68, v69
    v_cvt_pk_bf16_f32 v67, v70, v71
    buffer_store_dwordx4 v[64:67], v5, s[48:51], s77 offen sc1
    s_add_u32 s77, s77, 32768
    v_pk_mul_f32 v[88:89], v[88:89], v[96:97] op_sel_hi:[1,0]
    v_pk_mul_f32 v[90:91], v[90:91], v[96:97] op_sel_hi:[1,0]
    v_pk_mul_f32 v[92:93], v[92:93], v[96:97] op_sel_hi:[1,0]
    v_pk_mul_f32 v[94:95], v[94:95], v[96:97] op_sel_hi:[1,0]
    v_cvt_pk_bf16_f32 v88, v88, v89
    v_cvt_pk_bf16_f32 v89, v90, v91
    v_cvt_pk_bf16_f32 v90, v92, v93
    v_cvt_pk_bf16_f32 v91, v94, v95
    buffer_store_dwordx4 v[88:91], v5, s[48:51], s77 offen sc1
    v_mov_b32_e64 v2, 7
    ds_write_b32 v3, v2
    s_and_b32 s3, s68, 127
    s_lshl_b32 s3, s3, 2
    s_add_u32 s3, s3, 152064
    v_mov_b32 v2, s3
    ds_read_b32 v250, v2
    ds_read_b32 v251, v2 offset:1024
    s_setprio 0
    v_and_b32 v3, 3, v1
    v_lshlrev_b32_e64 v3, 2, v3
    v_add_u32 v3, 162112, v3
L_cw:
    ds_read_b32 v2, v3
    s_waitcnt lgkmcnt(0)
    v_cmp_ne_u32_e64 vcc, 7, v2
    s_cbranch_vccz L_cwk
    s_sleep 1
    s_branch L_cw
L_cwk:
    s_add_u32 m0, s72, 98304
    s_add_u32 s3, s73, 1572864
    buffer_load_dwordx4 v216, s[88:91], s3 offen offset:0 lds
    buffer_load_dwordx4 v217, s[88:91], s3 offen offset:1024 lds
    buffer_load_dwordx4 v218, s[88:91], s3 offen offset:2048 lds
    buffer_load_dwordx4 v219, s[88:91], s3 offen offset:3072 lds
    s_add_u32 m0, s72, 114688
    s_add_u32 s3, s73, 1835008
    buffer_load_dwordx4 v216, s[88:91], s3 offen offset:0 lds
    buffer_load_dwordx4 v217, s[88:91], s3 offen offset:1024 lds
    buffer_load_dwordx4 v218, s[88:91], s3 offen offset:2048 lds
    buffer_load_dwordx4 v219, s[88:91], s3 offen offset:3072 lds
L_p3:
    s_nop 3
    s_mov_b32 s56, s22
    s_mov_b32 s57, s23
    s_mov_b32 s58, 4194304
    s_mov_b32 s59, 0x00020000
    s_lshr_b32 s64, s39, 2
    s_lshl_b32 s3, s34, 2
    s_add_u32 s3, s3, s38
    s_lshl_b32 s3, s3, 16
    s_lshl_b32 s28, s64, 14
    s_add_u32 s3, s3, s28
    s_add_u32 s76, s3, 4194304
    s_lshl_b32 s3, s64, 15
    v_lshlrev_b32 v2, 4, v1
    v_add_u32 v116, s3, v2
    v_xor_b32 v117, 0x8000, v116
    v_lshrrev_b32 v2, 2, v1
    v_lshlrev_b32 v2, 7, v2
    v_bfe_u32 v3, v1, 3, 2
    v_lshl_add_u32 v2, v3, 5, v2
    v_and_b32 v3, 3, v1
    v_lshl_add_u32 v2, v3, 3, v2
    s_lshl_b32 s3, s64, 16
    v_add_u32 v112, s3, v2
    v_xor_b32 v113, 32, v112
    v_xor_b32 v114, 64, v112
    v_xor_b32 v115, 96, v112
    s_add_u32 s77, s76, 0
    buffer_load_dwordx4 v[40:43], v116, s[48:51], s77 offen offset:0 sc1
    buffer_load_dwordx4 v[44:47], v117, s[48:51], s77 offen offset:0 sc1
    buffer_load_dwordx4 v[48:51], v116, s[48:51], s77 offen offset:1024 sc1
    buffer_load_dwordx4 v[52:55], v117, s[48:51], s77 offen offset:1024 sc1
    buffer_load_dwordx4 v[56:59], v116, s[48:51], s77 offen offset:2048 sc1
    buffer_load_dwordx4 v[60:63], v117, s[48:51], s77 offen offset:2048 sc1
    buffer_load_dwordx4 v[64:67], v116, s[48:51], s77 offen offset:3072 sc1
    buffer_load_dwordx4 v[68:71], v117, s[48:51], s77 offen offset:3072 sc1
    s_lshr_b32 s3, s68, 7
    s_xor_b32 s83, s3, s34
    s_or_b32 s83, s83, s39
    v_lshlrev_b32 v222, 4, v1
    ds_read_b64_tr_b16 v[80:81], v112 offset:0
    ds_read_b64_tr_b16 v[82:83], v112 offset:2048
    ds_read_b64_tr_b16 v[84:85], v113 offset:0
    ds_read_b64_tr_b16 v[86:87], v113 offset:2048
    ds_read_b64_tr_b16 v[88:89], v114 offset:0
    ds_read_b64_tr_b16 v[90:91], v114 offset:2048
    ds_read_b64_tr_b16 v[92:93], v115 offset:0
    ds_read_b64_tr_b16 v[94:95], v115 offset:2048
    s_mov_b32 s29, 0
    s_waitcnt vmcnt(6)
    v_max3_u32 v2, v40, v41, v42
    v_max3_u32 v2, v2, v43, v44
    v_max3_u32 v2, v2, v45, v46
    v_max_u32 v2, v2, v47
    v_cmp_eq_u32 vcc, -1, v2
    s_cbranch_vccnz L_r0
L_g0:
    s_waitcnt lgkmcnt(0)
    v_mfma_f32_16x16x32_bf16 v[8:11], v[80:83], v[40:43], 0
    ds_read_b64_tr_b16 v[96:97], v112 offset:4096
    ds_read_b64_tr_b16 v[98:99], v112 offset:6144
    v_mfma_f32_16x16x32_bf16 v[24:27], v[80:83], v[44:47], 0
    ds_read_b64_tr_b16 v[100:101], v113 offset:4096
    ds_read_b64_tr_b16 v[102:103], v113 offset:6144
    v_mfma_f32_16x16x32_bf16 v[12:15], v[84:87], v[40:43], 0
    ds_read_b64_tr_b16 v[104:105], v114 offset:4096
    ds_read_b64_tr_b16 v[106:107], v114 offset:6144
    v_mfma_f32_16x16x32_bf16 v[28:31], v[84:87], v[44:47], 0
    ds_read_b64_tr_b16 v[108:109], v115 offset:4096
    ds_read_b64_tr_b16 v[110:111], v115 offset:6144
    v_mfma_f32_16x16x32_bf16 v[16:19], v[88:91], v[40:43], 0
    s_add_u32 s77, s76, 4096
    buffer_load_dwordx4 v[72:75], v116, s[48:51], s77 offen offset:0 sc1
    buffer_load_dwordx4 v[76:79], v117, s[48:51], s77 offen offset:0 sc1
    v_mfma_f32_16x16x32_bf16 v[32:35], v[88:91], v[44:47], 0
    s_waitcnt vmcnt(6)
    v_max3_u32 v2, v48, v49, v50
    v_mfma_f32_16x16x32_bf16 v[20:23], v[92:95], v[40:43], 0
    v_max3_u32 v2, v2, v51, v52
    v_max3_u32 v2, v2, v53, v54
    v_mfma_f32_16x16x32_bf16 v[36:39], v[92:95], v[44:47], 0
    v_max_u32 v2, v2, v55
    v_cmp_eq_u32_e64 vcc, -1, v2
    s_cbranch_vccnz L_r1
L_g1:
    s_waitcnt lgkmcnt(0)
    v_mfma_f32_16x16x32_bf16 v[8:11], v[96:99], v[48:51], v[8:11]
    ds_read_b64_tr_b16 v[80:81], v112 offset:8192
    ds_read_b64_tr_b16 v[82:83], v112 offset:10240
    v_mfma_f32_16x16x32_bf16 v[24:27], v[96:99], v[52:55], v[24:27]
    ds_read_b64_tr_b16 v[84:85], v113 offset:8192
    ds_read_b64_tr_b16 v[86:87], v113 offset:10240
    v_mfma_f32_16x16x32_bf16 v[12:15], v[100:103], v[48:51], v[12:15]
    ds_read_b64_tr_b16 v[88:89], v114 offset:8192
    ds_read_b64_tr_b16 v[90:91], v114 offset:10240
    v_mfma_f32_16x16x32_bf16 v[28:31], v[100:103], v[52:55], v[28:31]
    ds_read_b64_tr_b16 v[92:93], v115 offset:8192
    ds_read_b64_tr_b16 v[94:95], v115 offset:10240
    v_mfma_f32_16x16x32_bf16 v[16:19], v[104:107], v[48:51], v[16:19]
    buffer_load_dwordx4 v[40:43], v116, s[48:51], s77 offen offset:1024 sc1
    buffer_load_dwordx4 v[44:47], v117, s[48:51], s77 offen offset:1024 sc1
    v_mfma_f32_16x16x32_bf16 v[32:35], v[104:107], v[52:55], v[32:35]
    s_waitcnt vmcnt(6)
    v_max3_u32 v2, v56, v57, v58
    v_mfma_f32_16x16x32_bf16 v[20:23], v[108:111], v[48:51], v[20:23]
    v_max3_u32 v2, v2, v59, v60
    v_max3_u32 v2, v2, v61, v62
    v_mfma_f32_16x16x32_bf16 v[36:39], v[108:111], v[52:55], v[36:39]
    v_max_u32 v2, v2, v63
    v_cmp_eq_u32_e64 vcc, -1, v2
    s_cbranch_vccnz L_r2
L_g2:
    s_waitcnt lgkmcnt(0)
    v_mfma_f32_16x16x32_bf16 v[8:11], v[80:83], v[56:59], v[8:11]
    ds_read_b64_tr_b16 v[96:97], v112 offset:12288
    ds_read_b64_tr_b16 v[98:99], v112 offset:14336
    v_mfma_f32_16x16x32_bf16 v[24:27], v[80:83], v[60:63], v[24:27]
    ds_read_b64_tr_b16 v[100:101], v113 offset:12288
    ds_read_b64_tr_b16 v[102:103], v113 offset:14336
    v_mfma_f32_16x16x32_bf16 v[12:15], v[84:87], v[56:59], v[12:15]
    ds_read_b64_tr_b16 v[104:105], v114 offset:12288
    ds_read_b64_tr_b16 v[106:107], v114 offset:14336
    v_mfma_f32_16x16x32_bf16 v[28:31], v[84:87], v[60:63], v[28:31]
    ds_read_b64_tr_b16 v[108:109], v115 offset:12288
    ds_read_b64_tr_b16 v[110:111], v115 offset:14336
    v_mfma_f32_16x16x32_bf16 v[16:19], v[88:91], v[56:59], v[16:19]
    buffer_load_dwordx4 v[48:51], v116, s[48:51], s77 offen offset:2048 sc1
    buffer_load_dwordx4 v[52:55], v117, s[48:51], s77 offen offset:2048 sc1
    v_mfma_f32_16x16x32_bf16 v[32:35], v[88:91], v[60:63], v[32:35]
    s_waitcnt vmcnt(6)
    v_max3_u32 v2, v64, v65, v66
    v_mfma_f32_16x16x32_bf16 v[20:23], v[92:95], v[56:59], v[20:23]
    v_max3_u32 v2, v2, v67, v68
    v_max3_u32 v2, v2, v69, v70
    v_mfma_f32_16x16x32_bf16 v[36:39], v[92:95], v[60:63], v[36:39]
    v_max_u32 v2, v2, v71
    v_cmp_eq_u32 vcc, -1, v2
    s_cbranch_vccnz L_r3
L_g3:
    s_waitcnt lgkmcnt(0)
    s_cmp_eq_u32 s64, 0
    s_cbranch_scc1 L_nb3
    s_barrier
L_nb3:
    v_mfma_f32_16x16x32_bf16 v[8:11], v[96:99], v[64:67], v[8:11]
    ds_read_b64_tr_b16 v[80:81], v112 offset:16384
    ds_read_b64_tr_b16 v[82:83], v112 offset:18432
    v_mfma_f32_16x16x32_bf16 v[24:27], v[96:99], v[68:71], v[24:27]
    ds_read_b64_tr_b16 v[84:85], v113 offset:16384
    ds_read_b64_tr_b16 v[86:87], v113 offset:18432
    v_mfma_f32_16x16x32_bf16 v[12:15], v[100:103], v[64:67], v[12:15]
    ds_read_b64_tr_b16 v[88:89], v114 offset:16384
    ds_read_b64_tr_b16 v[90:91], v114 offset:18432
    v_mfma_f32_16x16x32_bf16 v[28:31], v[100:103], v[68:71], v[28:31]
    ds_read_b64_tr_b16 v[92:93], v115 offset:16384
    ds_read_b64_tr_b16 v[94:95], v115 offset:18432
    v_mfma_f32_16x16x32_bf16 v[16:19], v[104:107], v[64:67], v[16:19]
    buffer_load_dwordx4 v[56:59], v116, s[48:51], s77 offen offset:3072 sc1
    buffer_load_dwordx4 v[60:63], v117, s[48:51], s77 offen offset:3072 sc1
    v_mfma_f32_16x16x32_bf16 v[32:35], v[104:107], v[68:71], v[32:35]
    s_waitcnt vmcnt(6)
    v_max3_u32 v2, v72, v73, v74
    v_mfma_f32_16x16x32_bf16 v[20:23], v[108:111], v[64:67], v[20:23]
    v_max3_u32 v2, v2, v75, v76
    v_max3_u32 v2, v2, v77, v78
    v_mfma_f32_16x16x32_bf16 v[36:39], v[108:111], v[68:71], v[36:39]
    v_max_u32 v2, v2, v79
    v_cmp_eq_u32_e64 vcc, -1, v2
    s_cbranch_vccnz L_r4
L_g4:
    s_waitcnt lgkmcnt(0)
    v_mfma_f32_16x16x32_bf16 v[8:11], v[80:83], v[72:75], v[8:11]
    ds_read_b64_tr_b16 v[96:97], v112 offset:20480
    ds_read_b64_tr_b16 v[98:99], v112 offset:22528
    v_mfma_f32_16x16x32_bf16 v[24:27], v[80:83], v[76:79], v[24:27]
    ds_read_b64_tr_b16 v[100:101], v113 offset:20480
    ds_read_b64_tr_b16 v[102:103], v113 offset:22528
    v_mfma_f32_16x16x32_bf16 v[12:15], v[84:87], v[72:75], v[12:15]
    ds_read_b64_tr_b16 v[104:105], v114 offset:20480
    ds_read_b64_tr_b16 v[106:107], v114 offset:22528
    v_mfma_f32_16x16x32_bf16 v[28:31], v[84:87], v[76:79], v[28:31]
    ds_read_b64_tr_b16 v[108:109], v115 offset:20480
    ds_read_b64_tr_b16 v[110:111], v115 offset:22528
    v_mfma_f32_16x16x32_bf16 v[16:19], v[88:91], v[72:75], v[16:19]
    s_add_u32 s77, s76, 8192
    buffer_load_dwordx4 v[64:67], v116, s[48:51], s77 offen offset:0 sc1
    buffer_load_dwordx4 v[68:71], v117, s[48:51], s77 offen offset:0 sc1
    v_mfma_f32_16x16x32_bf16 v[32:35], v[88:91], v[76:79], v[32:35]
    s_waitcnt vmcnt(6)
    v_max3_u32 v2, v40, v41, v42
    v_mfma_f32_16x16x32_bf16 v[20:23], v[92:95], v[72:75], v[20:23]
    v_max3_u32 v2, v2, v43, v44
    v_max3_u32 v2, v2, v45, v46
    v_mfma_f32_16x16x32_bf16 v[36:39], v[92:95], v[76:79], v[36:39]
    v_max_u32 v2, v2, v47
    v_cmp_eq_u32_e64 vcc, -1, v2
    s_cbranch_vccnz L_r5
L_g5:
    s_waitcnt lgkmcnt(0)
    v_mfma_f32_16x16x32_bf16 v[8:11], v[96:99], v[40:43], v[8:11]
    ds_read_b64_tr_b16 v[80:81], v112 offset:24576
    ds_read_b64_tr_b16 v[82:83], v112 offset:26624
    v_mfma_f32_16x16x32_bf16 v[24:27], v[96:99], v[44:47], v[24:27]
    ds_read_b64_tr_b16 v[84:85], v113 offset:24576
    ds_read_b64_tr_b16 v[86:87], v113 offset:26624
    v_mfma_f32_16x16x32_bf16 v[12:15], v[100:103], v[40:43], v[12:15]
    ds_read_b64_tr_b16 v[88:89], v114 offset:24576
    ds_read_b64_tr_b16 v[90:91], v114 offset:26624
    v_mfma_f32_16x16x32_bf16 v[28:31], v[100:103], v[44:47], v[28:31]
    ds_read_b64_tr_b16 v[92:93], v115 offset:24576
    ds_read_b64_tr_b16 v[94:95], v115 offset:26624
    v_mfma_f32_16x16x32_bf16 v[16:19], v[104:107], v[40:43], v[16:19]
    buffer_load_dwordx4 v[72:75], v116, s[48:51], s77 offen offset:1024 sc1
    buffer_load_dwordx4 v[76:79], v117, s[48:51], s77 offen offset:1024 sc1
    v_mfma_f32_16x16x32_bf16 v[32:35], v[104:107], v[44:47], v[32:35]
    s_waitcnt vmcnt(6)
    v_max3_u32 v2, v48, v49, v50
    v_mfma_f32_16x16x32_bf16 v[20:23], v[108:111], v[40:43], v[20:23]
    v_max3_u32 v2, v2, v51, v52
    v_max3_u32 v2, v2, v53, v54
    v_mfma_f32_16x16x32_bf16 v[36:39], v[108:111], v[44:47], v[36:39]
    v_max_u32 v2, v2, v55
    v_cmp_eq_u32_e64 vcc, -1, v2
    s_cbranch_vccnz L_r6
L_g6:
    s_waitcnt lgkmcnt(0)
    v_mfma_f32_16x16x32_bf16 v[8:11], v[80:83], v[48:51], v[8:11]
    ds_read_b64_tr_b16 v[96:97], v112 offset:28672
    ds_read_b64_tr_b16 v[98:99], v112 offset:30720
    v_mfma_f32_16x16x32_bf16 v[24:27], v[80:83], v[52:55], v[24:27]
    ds_read_b64_tr_b16 v[100:101], v113 offset:28672
    ds_read_b64_tr_b16 v[102:103], v113 offset:30720
    v_mfma_f32_16x16x32_bf16 v[12:15], v[84:87], v[48:51], v[12:15]
    ds_read_b64_tr_b16 v[104:105], v114 offset:28672
    ds_read_b64_tr_b16 v[106:107], v114 offset:30720
    v_mfma_f32_16x16x32_bf16 v[28:31], v[84:87], v[52:55], v[28:31]
    ds_read_b64_tr_b16 v[108:109], v115 offset:28672
    ds_read_b64_tr_b16 v[110:111], v115 offset:30720
    v_mfma_f32_16x16x32_bf16 v[16:19], v[88:91], v[48:51], v[16:19]
    buffer_load_dwordx4 v[40:43], v116, s[48:51], s77 offen offset:2048 sc1
    buffer_load_dwordx4 v[44:47], v117, s[48:51], s77 offen offset:2048 sc1
    v_mfma_f32_16x16x32_bf16 v[32:35], v[88:91], v[52:55], v[32:35]
    s_waitcnt vmcnt(6)
    v_max3_u32 v2, v56, v57, v58
    v_mfma_f32_16x16x32_bf16 v[20:23], v[92:95], v[48:51], v[20:23]
    v_max3_u32 v2, v2, v59, v60
    v_max3_u32 v2, v2, v61, v62
    v_mfma_f32_16x16x32_bf16 v[36:39], v[92:95], v[52:55], v[36:39]
    v_max_u32 v2, v2, v63
    v_cmp_eq_u32 vcc, -1, v2
    s_cbranch_vccnz L_r7
L_g7:
    s_waitcnt lgkmcnt(0)
    s_cmp_eq_u32 s64, 1
    s_cbranch_scc1 L_nb7
    s_barrier
L_nb7:
    v_mfma_f32_16x16x32_bf16 v[8:11], v[96:99], v[56:59], v[8:11]
    ds_read_b64_tr_b16 v[80:81], v112 offset:32768
    ds_read_b64_tr_b16 v[82:83], v112 offset:34816
    v_mfma_f32_16x16x32_bf16 v[24:27], v[96:99], v[60:63], v[24:27]
    ds_read_b64_tr_b16 v[84:85], v113 offset:32768
    ds_read_b64_tr_b16 v[86:87], v113 offset:34816
    v_mfma_f32_16x16x32_bf16 v[12:15], v[100:103], v[56:59], v[12:15]
    ds_read_b64_tr_b16 v[88:89], v114 offset:32768
    ds_read_b64_tr_b16 v[90:91], v114 offset:34816
    v_mfma_f32_16x16x32_bf16 v[28:31], v[100:103], v[60:63], v[28:31]
    ds_read_b64_tr_b16 v[92:93], v115 offset:32768
    ds_read_b64_tr_b16 v[94:95], v115 offset:34816
    v_mfma_f32_16x16x32_bf16 v[16:19], v[104:107], v[56:59], v[16:19]
    buffer_load_dwordx4 v[48:51], v116, s[48:51], s77 offen offset:3072 sc1
    buffer_load_dwordx4 v[52:55], v117, s[48:51], s77 offen offset:3072 sc1
    v_mfma_f32_16x16x32_bf16 v[32:35], v[104:107], v[60:63], v[32:35]
    s_waitcnt vmcnt(6)
    v_max3_u32 v2, v64, v65, v66
    v_mfma_f32_16x16x32_bf16 v[20:23], v[108:111], v[56:59], v[20:23]
    v_max3_u32 v2, v2, v67, v68
    v_max3_u32 v2, v2, v69, v70
    v_mfma_f32_16x16x32_bf16 v[36:39], v[108:111], v[60:63], v[36:39]
    v_max_u32 v2, v2, v71
    v_cmp_eq_u32_e64 vcc, -1, v2
    s_cbranch_vccnz L_r8
L_g8:
    s_waitcnt lgkmcnt(0)
    v_mfma_f32_16x16x32_bf16 v[8:11], v[80:83], v[64:67], v[8:11]
    ds_read_b64_tr_b16 v[96:97], v112 offset:36864
    ds_read_b64_tr_b16 v[98:99], v112 offset:38912
    v_mfma_f32_16x16x32_bf16 v[24:27], v[80:83], v[68:71], v[24:27]
    ds_read_b64_tr_b16 v[100:101], v113 offset:36864
    ds_read_b64_tr_b16 v[102:103], v113 offset:38912
    v_mfma_f32_16x16x32_bf16 v[12:15], v[84:87], v[64:67], v[12:15]
    ds_read_b64_tr_b16 v[104:105], v114 offset:36864
    ds_read_b64_tr_b16 v[106:107], v114 offset:38912
    v_mfma_f32_16x16x32_bf16 v[28:31], v[84:87], v[68:71], v[28:31]
    ds_read_b64_tr_b16 v[108:109], v115 offset:36864
    ds_read_b64_tr_b16 v[110:111], v115 offset:38912
    v_mfma_f32_16x16x32_bf16 v[16:19], v[88:91], v[64:67], v[16:19]
    s_add_u32 s77, s76, 12288
    buffer_load_dwordx4 v[56:59], v116, s[48:51], s77 offen offset:0 sc1
    buffer_load_dwordx4 v[60:63], v117, s[48:51], s77 offen offset:0 sc1
    v_mfma_f32_16x16x32_bf16 v[32:35], v[88:91], v[68:71], v[32:35]
    s_waitcnt vmcnt(6)
    v_max3_u32 v2, v72, v73, v74
    v_mfma_f32_16x16x32_bf16 v[20:23], v[92:95], v[64:67], v[20:23]
    v_max3_u32 v2, v2, v75, v76
    v_max3_u32 v2, v2, v77, v78
    v_mfma_f32_16x16x32_bf16 v[36:39], v[92:95], v[68:71], v[36:39]
    v_max_u32 v2, v2, v79
    v_cmp_eq_u32_e64 vcc, -1, v2
    s_cbranch_vccnz L_r9
L_g9:
    s_waitcnt lgkmcnt(0)
    v_mfma_f32_16x16x32_bf16 v[8:11], v[96:99], v[72:75], v[8:11]
    ds_read_b64_tr_b16 v[80:81], v112 offset:40960
    ds_read_b64_tr_b16 v[82:83], v112 offset:43008
    v_mfma_f32_16x16x32_bf16 v[24:27], v[96:99], v[76:79], v[24:27]
    ds_read_b64_tr_b16 v[84:85], v113 offset:40960
    ds_read_b64_tr_b16 v[86:87], v113 offset:43008
    v_mfma_f32_16x16x32_bf16 v[12:15], v[100:103], v[72:75], v[12:15]
    ds_read_b64_tr_b16 v[88:89], v114 offset:40960
    ds_read_b64_tr_b16 v[90:91], v114 offset:43008
    v_mfma_f32_16x16x32_bf16 v[28:31], v[100:103], v[76:79], v[28:31]
    ds_read_b64_tr_b16 v[92:93], v115 offset:40960
    ds_read_b64_tr_b16 v[94:95], v115 offset:43008
    v_mfma_f32_16x16x32_bf16 v[16:19], v[104:107], v[72:75], v[16:19]
    buffer_load_dwordx4 v[64:67], v116, s[48:51], s77 offen offset:1024 sc1
    buffer_load_dwordx4 v[68:71], v117, s[48:51], s77 offen offset:1024 sc1
    v_mfma_f32_16x16x32_bf16 v[32:35], v[104:107], v[76:79], v[32:35]
    s_waitcnt vmcnt(6)
    v_max3_u32 v2, v40, v41, v42
    v_mfma_f32_16x16x32_bf16 v[20:23], v[108:111], v[72:75], v[20:23]
    v_max3_u32 v2, v2, v43, v44
    v_max3_u32 v2, v2, v45, v46
    v_mfma_f32_16x16x32_bf16 v[36:39], v[108:111], v[76:79], v[36:39]
    v_max_u32 v2, v2, v47
    v_cmp_eq_u32_e64 vcc, -1, v2
    s_cbranch_vccnz L_r10
L_g10:
    s_waitcnt lgkmcnt(0)
    v_mfma_f32_16x16x32_bf16 v[8:11], v[80:83], v[40:43], v[8:11]
    ds_read_b64_tr_b16 v[96:97], v112 offset:45056
    ds_read_b64_tr_b16 v[98:99], v112 offset:47104
    v_mfma_f32_16x16x32_bf16 v[24:27], v[80:83], v[44:47], v[24:27]
    ds_read_b64_tr_b16 v[100:101], v113 offset:45056
    ds_read_b64_tr_b16 v[102:103], v113 offset:47104
    v_mfma_f32_16x16x32_bf16 v[12:15], v[84:87], v[40:43], v[12:15]
    ds_read_b64_tr_b16 v[104:105], v114 offset:45056
    ds_read_b64_tr_b16 v[106:107], v114 offset:47104
    v_mfma_f32_16x16x32_bf16 v[28:31], v[84:87], v[44:47], v[28:31]
    ds_read_b64_tr_b16 v[108:109], v115 offset:45056
    ds_read_b64_tr_b16 v[110:111], v115 offset:47104
    v_mfma_f32_16x16x32_bf16 v[16:19], v[88:91], v[40:43], v[16:19]
    buffer_load_dwordx4 v[72:75], v116, s[48:51], s77 offen offset:2048 sc1
    buffer_load_dwordx4 v[76:79], v117, s[48:51], s77 offen offset:2048 sc1
    v_mfma_f32_16x16x32_bf16 v[32:35], v[88:91], v[44:47], v[32:35]
    s_waitcnt vmcnt(6)
    v_max3_u32 v2, v48, v49, v50
    v_mfma_f32_16x16x32_bf16 v[20:23], v[92:95], v[40:43], v[20:23]
    v_max3_u32 v2, v2, v51, v52
    v_max3_u32 v2, v2, v53, v54
    v_mfma_f32_16x16x32_bf16 v[36:39], v[92:95], v[44:47], v[36:39]
    v_max_u32 v2, v2, v55
    v_cmp_eq_u32_e64 vcc, -1, v2
    s_cbranch_vccnz L_r11
L_g11:
    s_waitcnt lgkmcnt(0)
    v_mfma_f32_16x16x32_bf16 v[8:11], v[96:99], v[48:51], v[8:11]
    ds_read_b64_tr_b16 v[80:81], v112 offset:49152
    ds_read_b64_tr_b16 v[82:83], v112 offset:51200
    v_mfma_f32_16x16x32_bf16 v[24:27], v[96:99], v[52:55], v[24:27]
    ds_read_b64_tr_b16 v[84:85], v113 offset:49152
    ds_read_b64_tr_b16 v[86:87], v113 offset:51200
    v_mfma_f32_16x16x32_bf16 v[12:15], v[100:103], v[48:51], v[12:15]
    ds_read_b64_tr_b16 v[88:89], v114 offset:49152
    ds_read_b64_tr_b16 v[90:91], v114 offset:51200
    v_mfma_f32_16x16x32_bf16 v[28:31], v[100:103], v[52:55], v[28:31]
    ds_read_b64_tr_b16 v[92:93], v115 offset:49152
    ds_read_b64_tr_b16 v[94:95], v115 offset:51200
    v_mfma_f32_16x16x32_bf16 v[16:19], v[104:107], v[48:51], v[16:19]
    buffer_load_dwordx4 v[40:43], v116, s[48:51], s77 offen offset:3072 sc1
    buffer_load_dwordx4 v[44:47], v117, s[48:51], s77 offen offset:3072 sc1
    v_mfma_f32_16x16x32_bf16 v[32:35], v[104:107], v[52:55], v[32:35]
    s_waitcnt vmcnt(6)
    v_max3_u32 v2, v56, v57, v58
    v_mfma_f32_16x16x32_bf16 v[20:23], v[108:111], v[48:51], v[20:23]
    v_max3_u32 v2, v2, v59, v60
    v_max3_u32 v2, v2, v61, v62
    v_mfma_f32_16x16x32_bf16 v[36:39], v[108:111], v[52:55], v[36:39]
    v_max_u32 v2, v2, v63
    v_cmp_eq_u32_e64 vcc, -1, v2
    s_cbranch_vccnz L_r12
L_g12:
    s_waitcnt lgkmcnt(0)
    v_mfma_f32_16x16x32_bf16 v[8:11], v[80:83], v[56:59], v[8:11]
    ds_read_b64_tr_b16 v[96:97], v112 offset:53248
    ds_read_b64_tr_b16 v[98:99], v112 offset:55296
    v_mfma_f32_16x16x32_bf16 v[24:27], v[80:83], v[60:63], v[24:27]
    ds_read_b64_tr_b16 v[100:101], v113 offset:53248
    ds_read_b64_tr_b16 v[102:103], v113 offset:55296
    v_mfma_f32_16x16x32_bf16 v[12:15], v[84:87], v[56:59], v[12:15]
    ds_read_b64_tr_b16 v[104:105], v114 offset:53248
    ds_read_b64_tr_b16 v[106:107], v114 offset:55296
    v_mfma_f32_16x16x32_bf16 v[28:31], v[84:87], v[60:63], v[28:31]
    ds_read_b64_tr_b16 v[108:109], v115 offset:53248
    ds_read_b64_tr_b16 v[110:111], v115 offset:55296
    v_mfma_f32_16x16x32_bf16 v[16:19], v[88:91], v[56:59], v[16:19]
    v_mfma_f32_16x16x32_bf16 v[32:35], v[88:91], v[60:63], v[32:35]
    s_waitcnt vmcnt(4)
    v_max3_u32 v2, v64, v65, v66
    v_mfma_f32_16x16x32_bf16 v[20:23], v[92:95], v[56:59], v[20:23]
    v_max3_u32 v2, v2, v67, v68
    v_max3_u32 v2, v2, v69, v70
    v_mfma_f32_16x16x32_bf16 v[36:39], v[92:95], v[60:63], v[36:39]
    v_max_u32 v2, v2, v71
    v_cmp_eq_u32_e64 vcc, -1, v2
    s_cbranch_vccnz L_r13
L_g13:
    s_waitcnt lgkmcnt(0)
    v_mfma_f32_16x16x32_bf16 v[8:11], v[96:99], v[64:67], v[8:11]
    ds_read_b64_tr_b16 v[80:81], v112 offset:57344
    ds_read_b64_tr_b16 v[82:83], v112 offset:59392
    v_mfma_f32_16x16x32_bf16 v[24:27], v[96:99], v[68:71], v[24:27]
    ds_read_b64_tr_b16 v[84:85], v113 offset:57344
    ds_read_b64_tr_b16 v[86:87], v113 offset:59392
    v_mfma_f32_16x16x32_bf16 v[12:15], v[100:103], v[64:67], v[12:15]
    ds_read_b64_tr_b16 v[88:89], v114 offset:57344
    ds_read_b64_tr_b16 v[90:91], v114 offset:59392
    v_mfma_f32_16x16x32_bf16 v[28:31], v[100:103], v[68:71], v[28:31]
    ds_read_b64_tr_b16 v[92:93], v115 offset:57344
    ds_read_b64_tr_b16 v[94:95], v115 offset:59392
    v_mfma_f32_16x16x32_bf16 v[16:19], v[104:107], v[64:67], v[16:19]
    v_mfma_f32_16x16x32_bf16 v[32:35], v[104:107], v[68:71], v[32:35]
    s_waitcnt vmcnt(2)
    v_max3_u32 v2, v72, v73, v74
    v_mfma_f32_16x16x32_bf16 v[20:23], v[108:111], v[64:67], v[20:23]
    v_max3_u32 v2, v2, v75, v76
    v_max3_u32 v2, v2, v77, v78
    v_mfma_f32_16x16x32_bf16 v[36:39], v[108:111], v[68:71], v[36:39]
    v_max_u32 v2, v2, v79
    v_cmp_eq_u32_e64 vcc, -1, v2
    s_cbranch_vccnz L_r14
L_g14:
    s_cmp_eq_u32 s83, 0
    s_cbranch_scc1 L_fx1
L_fx1r:
    s_waitcnt lgkmcnt(0)
    v_mfma_f32_16x16x32_bf16 v[8:11], v[80:83], v[72:75], v[8:11]
    ds_read_b64_tr_b16 v[96:97], v112 offset:61440
    ds_read_b64_tr_b16 v[98:99], v112 offset:63488
    v_mfma_f32_16x16x32_bf16 v[24:27], v[80:83], v[76:79], v[24:27]
    ds_read_b64_tr_b16 v[100:101], v113 offset:61440
    ds_read_b64_tr_b16 v[102:103], v113 offset:63488
    v_mfma_f32_16x16x32_bf16 v[12:15], v[84:87], v[72:75], v[12:15]
    ds_read_b64_tr_b16 v[104:105], v114 offset:61440
    ds_read_b64_tr_b16 v[106:107], v114 offset:63488
    v_mfma_f32_16x16x32_bf16 v[28:31], v[84:87], v[76:79], v[28:31]
    ds_read_b64_tr_b16 v[108:109], v115 offset:61440
    ds_read_b64_tr_b16 v[110:111], v115 offset:63488
    v_mfma_f32_16x16x32_bf16 v[16:19], v[88:91], v[72:75], v[16:19]
    v_mfma_f32_16x16x32_bf16 v[32:35], v[88:91], v[76:79], v[32:35]
    s_waitcnt vmcnt(0)
    v_max3_u32 v2, v40, v41, v42
    v_mfma_f32_16x16x32_bf16 v[20:23], v[92:95], v[72:75], v[20:23]
    v_max3_u32 v2, v2, v43, v44
    v_max3_u32 v2, v2, v45, v46
    v_mfma_f32_16x16x32_bf16 v[36:39], v[92:95], v[76:79], v[36:39]
    v_max_u32 v2, v2, v47
    v_cmp_eq_u32_e64 vcc, -1, v2
    s_cbranch_vccnz L_r15
L_g15:
    s_waitcnt lgkmcnt(0)
    v_mfma_f32_16x16x32_bf16 v[8:11], v[96:99], v[40:43], v[8:11]
    v_mfma_f32_16x16x32_bf16 v[24:27], v[96:99], v[44:47], v[24:27]
    v_mfma_f32_16x16x32_bf16 v[12:15], v[100:103], v[40:43], v[12:15]
    v_mfma_f32_16x16x32_bf16 v[28:31], v[100:103], v[44:47], v[28:31]
    v_mfma_f32_16x16x32_bf16 v[16:19], v[104:107], v[40:43], v[16:19]
    v_mfma_f32_16x16x32_bf16 v[32:35], v[104:107], v[44:47], v[32:35]
    v_mfma_f32_16x16x32_bf16 v[20:23], v[108:111], v[40:43], v[20:23]
    v_mfma_f32_16x16x32_bf16 v[36:39], v[108:111], v[44:47], v[36:39]
    s_cmp_eq_u32 s83, 0
    s_cbranch_scc1 L_fx2
L_fx2r:
    s_lshl_b32 s3, s39, 12
    s_add_u32 s3, s3, 131072
    v_lshlrev_b32 v2, 4, v1
    v_add_u32_e64 v2, s3, v2
    v_xor_b32 v3, 0x4000, v2
    s_xor_b32 s28, s3, 0x4000
    ds_write_b128 v2, v[24:27] offset:0
    ds_write_b128 v2, v[28:31] offset:1024
    ds_write_b128 v2, v[32:35] offset:2048
    ds_write_b128 v2, v[36:39] offset:3072
    v_lshlrev_b32 v40, 16, v240
    v_and_b32 v41, 0xffff0000, v240
    v_lshlrev_b32 v42, 16, v241
    v_and_b32 v43, 0xffff0000, v241
    v_lshlrev_b32 v44, 16, v242
    v_and_b32 v45, 0xffff0000, v242
    v_lshlrev_b32 v46, 16, v243
    v_and_b32 v47, 0xffff0000, v243
    v_lshlrev_b32 v48, 16, v244
    v_and_b32 v49, 0xffff0000, v244
    v_lshlrev_b32 v50, 16, v245
    v_and_b32 v51, 0xffff0000, v245
    v_lshlrev_b32 v52, 16, v246
    v_and_b32 v53, 0xffff0000, v246
    v_lshlrev_b32 v54, 16, v247
    v_and_b32 v55, 0xffff0000, v247
    v_and_b32 v4, 15, v1
    v_lshrrev_b32 v5, 4, v1
    v_lshlrev_b32 v6, 1, v4
    v_and_b32 v6, 14, v6
    v_xor_b32_e64 v5, v5, v6
    v_lshl_add_u32 v4, v4, 7, s28
    v_lshl_add_u32 v4, v5, 3, v4
    v_lshrrev_b32 v5, 3, v1
    v_and_b32 v6, 7, v1
    v_xor_b32_e64 v7, v6, v5
    v_lshl_add_u32 v7, v7, 4, s28
    v_lshl_add_u32 v7, v5, 7, v7
    s_lshl_b32 s3, s34, 7
    s_add_u32 s3, s3, s69
    v_add_u32 v5, s3, v5
    v_lshlrev_b32 v5, 11, v5
    v_lshl_add_u32 v5, v6, 4, v5
    s_lshl_b32 s3, s35, 7
    s_add_u32 s28, s3, 16384
    s_lshl_b32 s29, s34, 7
    s_add_u32 s29, s29, s69
    s_andn2_b32 s77, s68, 15
    s_cmp_lg_u32 s29, s77
    s_waitcnt lgkmcnt(0)
    s_barrier
    s_cbranch_scc1 L_nov
    v_and_b32 v2, 48, v1
    s_and_b32 s29, s68, 15
    s_lshl_b32 exec_lo, 0x00010001, s29
    s_mov_b32 exec_hi, exec_lo
    ds_read_b128 v[224:227], v2 offset:0
    ds_read_b128 v[228:231], v2 offset:64
    ds_read_b128 v[232:235], v2 offset:128
    ds_read_b128 v[236:239], v2 offset:192
    s_mov_b64 exec, -1
L_nov:
    ds_read_b128 v[24:27], v3 offset:0
    ds_read_b128 v[28:31], v3 offset:1024
    ds_read_b128 v[32:35], v3 offset:2048
    ds_read_b128 v[36:39], v3 offset:3072
    s_waitcnt lgkmcnt(3)
    s_nop 0
    v_pk_add_f32 v[8:9], v[8:9], v[24:25]
    v_pk_add_f32 v[10:11], v[10:11], v[26:27]
    v_pk_fma_f32 v[40:41], v[8:9], v[224:225], v[40:41]
    v_pk_fma_f32 v[42:43], v[10:11], v[226:227], v[42:43]
    v_cvt_pk_bf16_f32 v8, v40, v41
    v_cvt_pk_bf16_f32 v9, v42, v43
    s_waitcnt lgkmcnt(2)
    s_nop 0
    v_pk_add_f32 v[12:13], v[12:13], v[28:29]
    v_pk_add_f32 v[14:15], v[14:15], v[30:31]
    v_pk_fma_f32 v[44:45], v[12:13], v[228:229], v[44:45]
    v_pk_fma_f32 v[46:47], v[14:15], v[230:231], v[46:47]
    v_cvt_pk_bf16_f32 v10, v44, v45
    v_cvt_pk_bf16_f32 v11, v46, v47
    s_waitcnt lgkmcnt(1)
    s_nop 0
    v_pk_add_f32 v[16:17], v[16:17], v[32:33]
    v_pk_add_f32 v[18:19], v[18:19], v[34:35]
    v_pk_fma_f32 v[48:49], v[16:17], v[232:233], v[48:49]
    v_pk_fma_f32 v[50:51], v[18:19], v[234:235], v[50:51]
    v_cvt_pk_bf16_f32 v12, v48, v49
    v_cvt_pk_bf16_f32 v13, v50, v51
    s_waitcnt lgkmcnt(0)
    s_nop 0
    v_pk_add_f32 v[20:21], v[20:21], v[36:37]
    v_pk_add_f32 v[22:23], v[22:23], v[38:39]
    v_pk_fma_f32 v[52:53], v[20:21], v[236:237], v[52:53]
    v_pk_fma_f32 v[54:55], v[22:23], v[238:239], v[54:55]
    v_cvt_pk_bf16_f32 v14, v52, v53
    v_cvt_pk_bf16_f32 v15, v54, v55
    ds_write_b64 v4, v[8:9]
    v_xor_b32 v6, 32, v4
    ds_write_b64 v6, v[10:11]
    v_xor_b32 v6, 64, v4
    ds_write_b64 v6, v[12:13]
    v_xor_b32 v6, 96, v4
    ds_write_b64 v6, v[14:15]
    ds_read_b128 v[24:27], v7 offset:0
    ds_read_b128 v[28:31], v7 offset:1024
    s_waitcnt lgkmcnt(1)
    buffer_store_dwordx4 v[24:27], v5, s[56:59], s3 offen sc1
    s_waitcnt lgkmcnt(0)
    buffer_store_dwordx4 v[28:31], v5, s[56:59], s28 offen sc1
L_done:
    s_endpgm
L_fx1:
    s_lshl_b32 s78, s35, 14
    s_add_u32 s78, s78, 1413120
    v_and_b32 v2, 15, v1
    v_lshrrev_b32 v3, 4, v1
    v_lshl_add_u32 v193, v2, 2, v3
    v_and_b32 v2, 7, v193
    v_lshrrev_b32 v193, 3, v193
    v_lshl_add_u32 v193, v2, 3, v193
    v_lshlrev_b32 v2, 1, v193
    s_lshl_b32 s3, s68, 11
    s_lshl_b32 s28, s35, 7
    s_add_u32 s3, s3, s28
    buffer_load_ushort v194, v2, s[40:43], s3 offen
    s_add_u32 s3, s78, 0
    s_nop 0
    buffer_load_dwordx4 v[128:131], v222, s[48:51], s3 offen offset:0 sc1
    buffer_load_dwordx4 v[132:135], v222, s[48:51], s3 offen offset:1024 sc1
    buffer_load_dwordx4 v[136:139], v222, s[48:51], s3 offen offset:2048 sc1
    buffer_load_dwordx4 v[140:143], v222, s[48:51], s3 offen offset:3072 sc1
    s_add_u32 s3, s78, 4096
    buffer_load_dwordx4 v[144:147], v222, s[48:51], s3 offen offset:0 sc1
    buffer_load_dwordx4 v[148:151], v222, s[48:51], s3 offen offset:1024 sc1
    buffer_load_dwordx4 v[152:155], v222, s[48:51], s3 offen offset:2048 sc1
    buffer_load_dwordx4 v[156:159], v222, s[48:51], s3 offen offset:3072 sc1
    s_add_u32 s3, s78, 8192
    buffer_load_dwordx4 v[160:163], v222, s[48:51], s3 offen offset:0 sc1
    buffer_load_dwordx4 v[164:167], v222, s[48:51], s3 offen offset:1024 sc1
    buffer_load_dwordx4 v[168:171], v222, s[48:51], s3 offen offset:2048 sc1
    buffer_load_dwordx4 v[172:175], v222, s[48:51], s3 offen offset:3072 sc1
    s_add_u32 s3, s78, 12288
    buffer_load_dwordx4 v[176:179], v222, s[48:51], s3 offen offset:0 sc1
    buffer_load_dwordx4 v[180:183], v222, s[48:51], s3 offen offset:1024 sc1
    buffer_load_dwordx4 v[184:187], v222, s[48:51], s3 offen offset:2048 sc1
    buffer_load_dwordx4 v[188:191], v222, s[48:51], s3 offen offset:3072 sc1
    s_branch L_fx1r
L_fx2:
    s_and_b32 s3, s70, 0xffff0000
    s_xor_b32 s28, s3, 0x80000000
    s_not_b32 s29, s3
    s_and_b32 s29, s29, 0xffff0000
    s_bitcmp1_b32 s3, 31
    s_cselect_b32 s3, s28, s29
    v_mov_b32 v195, s3
    v_mul_f32 v195, 0xbfb8aa3b, v195
    v_exp_f32 v195, v195
    s_nop 0
    v_add_f32 v195, 1.0, v195
    v_rcp_f32 v195, v195
    s_nop 0
    v_cvt_pk_bf16_f32 v195, v195, v195
    v_lshlrev_b32 v195, 16, v195
    s_mov_b32 s29, 0
L_k6:
    v_max3_u32 v2, v128, v129, v130
    v_max3_u32 v2, v2, v131, v132
    v_max3_u32 v2, v2, v133, v134
    v_max3_u32 v2, v2, v135, v136
    v_max3_u32 v2, v2, v137, v138
    v_max3_u32 v2, v2, v139, v140
    v_max3_u32 v2, v2, v141, v142
    v_max3_u32 v2, v2, v143, v144
    v_max3_u32 v2, v2, v145, v146
    v_max3_u32 v2, v2, v147, v148
    v_max3_u32 v2, v2, v149, v150
    v_max3_u32 v2, v2, v151, v152
    v_max3_u32 v2, v2, v153, v154
    v_max3_u32 v2, v2, v155, v156
    v_max3_u32 v2, v2, v157, v158
    v_max3_u32 v2, v2, v159, v160
    v_max3_u32 v2, v2, v161, v162
    v_max3_u32 v2, v2, v163, v164
    v_max3_u32 v2, v2, v165, v166
    v_max3_u32 v2, v2, v167, v168
    v_max3_u32 v2, v2, v169, v170
    v_max3_u32 v2, v2, v171, v172
    v_max3_u32 v2, v2, v173, v174
    v_max3_u32 v2, v2, v175, v176
    v_max3_u32 v2, v2, v177, v178
    v_max3_u32 v2, v2, v179, v180
    v_max3_u32 v2, v2, v181, v182
    v_max3_u32 v2, v2, v183, v184
    v_max3_u32 v2, v2, v185, v186
    v_max3_u32 v2, v2, v187, v188
    v_max3_u32 v2, v2, v189, v190
    v_max_u32 v2, v2, v191
    v_cmp_eq_u32 vcc, -1, v2
    s_cbranch_vccz L_k6k
    s_add_u32 s29, s29, 1
    s_cmp_ge_u32 s29, 200000
    s_cbranch_scc1 L_k6k
    s_sleep 4
    s_add_u32 s3, s78, 0
    s_nop 0
    buffer_load_dwordx4 v[128:131], v222, s[48:51], s3 offen offset:0 sc1
    buffer_load_dwordx4 v[132:135], v222, s[48:51], s3 offen offset:1024 sc1
    buffer_load_dwordx4 v[136:139], v222, s[48:51], s3 offen offset:2048 sc1
    buffer_load_dwordx4 v[140:143], v222, s[48:51], s3 offen offset:3072 sc1
    s_add_u32 s3, s78, 4096
    buffer_load_dwordx4 v[144:147], v222, s[48:51], s3 offen offset:0 sc1
    buffer_load_dwordx4 v[148:151], v222, s[48:51], s3 offen offset:1024 sc1
    buffer_load_dwordx4 v[152:155], v222, s[48:51], s3 offen offset:2048 sc1
    buffer_load_dwordx4 v[156:159], v222, s[48:51], s3 offen offset:3072 sc1
    s_add_u32 s3, s78, 8192
    buffer_load_dwordx4 v[160:163], v222, s[48:51], s3 offen offset:0 sc1
    buffer_load_dwordx4 v[164:167], v222, s[48:51], s3 offen offset:1024 sc1
    buffer_load_dwordx4 v[168:171], v222, s[48:51], s3 offen offset:2048 sc1
    buffer_load_dwordx4 v[172:175], v222, s[48:51], s3 offen offset:3072 sc1
    s_add_u32 s3, s78, 12288
    buffer_load_dwordx4 v[176:179], v222, s[48:51], s3 offen offset:0 sc1
    buffer_load_dwordx4 v[180:183], v222, s[48:51], s3 offen offset:1024 sc1
    buffer_load_dwordx4 v[184:187], v222, s[48:51], s3 offen offset:2048 sc1
    buffer_load_dwordx4 v[188:191], v222, s[48:51], s3 offen offset:3072 sc1
    s_waitcnt vmcnt(0)
    s_branch L_k6
L_k6k:
    v_pk_add_f32 v[128:129], v[128:129], v[160:161]
    v_pk_add_f32 v[130:131], v[130:131], v[162:163]
    v_pk_add_f32 v[132:133], v[132:133], v[164:165]
    v_pk_add_f32 v[134:135], v[134:135], v[166:167]
    v_pk_add_f32 v[136:137], v[136:137], v[168:169]
    v_pk_add_f32 v[138:139], v[138:139], v[170:171]
    v_pk_add_f32 v[140:141], v[140:141], v[172:173]
    v_pk_add_f32 v[142:143], v[142:143], v[174:175]
    v_pk_add_f32 v[144:145], v[144:145], v[176:177]
    v_pk_add_f32 v[146:147], v[146:147], v[178:179]
    v_pk_add_f32 v[148:149], v[148:149], v[180:181]
    v_pk_add_f32 v[150:151], v[150:151], v[182:183]
    v_pk_add_f32 v[152:153], v[152:153], v[184:185]
    v_pk_add_f32 v[154:155], v[154:155], v[186:187]
    v_pk_add_f32 v[156:157], v[156:157], v[188:189]
    v_pk_add_f32 v[158:159], v[158:159], v[190:191]
    v_pk_add_f32 v[128:129], v[128:129], v[144:145]
    v_pk_add_f32 v[130:131], v[130:131], v[146:147]
    v_pk_add_f32 v[132:133], v[132:133], v[148:149]
    v_pk_add_f32 v[134:135], v[134:135], v[150:151]
    v_pk_add_f32 v[136:137], v[136:137], v[152:153]
    v_pk_add_f32 v[138:139], v[138:139], v[154:155]
    v_pk_add_f32 v[140:141], v[140:141], v[156:157]
    v_pk_add_f32 v[142:143], v[142:143], v[158:159]
    v_pk_add_f32 v[128:129], v[128:129], v[136:137]
    v_pk_add_f32 v[130:131], v[130:131], v[138:139]
    v_pk_add_f32 v[132:133], v[132:133], v[140:141]
    v_pk_add_f32 v[134:135], v[134:135], v[142:143]
    v_pk_add_f32 v[128:129], v[128:129], v[132:133]
    v_pk_add_f32 v[130:131], v[130:131], v[134:135]
    s_nop 1
    v_permlane32_swap_b32 v128, v130
    v_permlane32_swap_b32 v129, v131
    v_add_f32 v128, v128, v130
    v_add_f32 v129, v129, v131
    s_nop 1
    v_permlane16_swap_b32 v128, v129
    v_add_f32 v128, v128, v129
    v_cvt_pk_bf16_f32 v128, v128, v128
    v_lshlrev_b32 v128, 16, v128
    v_mul_f32 v128, v128, v195
    v_lshlrev_b32 v194, 16, v194
    v_sub_f32 v194, v194, v250
    v_cvt_pk_bf16_f32 v128, v128, v128
    v_lshlrev_b32 v128, 16, v128
    v_cvt_pk_bf16_f32 v194, v194, v194
    v_lshlrev_b32 v194, 16, v194
    v_mul_f32 v194, v194, v251
    v_cvt_pk_bf16_f32 v194, v194, v194
    v_lshlrev_b32 v194, 16, v194
    v_add_f32 v128, v128, v194
    v_cvt_pk_bf16_f32 v128, v128, v128
    v_lshlrev_b32 v128, 16, v128
    v_mul_f32 v2, 0xbfb8aa3b, v128
    v_exp_f32 v2, v2
    s_nop 0
    v_add_f32 v2, 1.0, v2
    v_rcp_f32 v2, v2
    s_nop 0
    v_mul_f32 v2, v128, v2
    v_lshlrev_b32 v3, 2, v193
    ds_write_b32 v3, v2
    s_branch L_fx2r
L_r0:
    s_add_u32 s29, s29, 1
    s_cmp_ge_u32 s29, 200000
    s_cbranch_scc1 L_g0
    s_add_u32 s3, s76, 0
    buffer_load_dwordx4 v[40:43], v116, s[48:51], s3 offen offset:0 sc1
    buffer_load_dwordx4 v[44:47], v117, s[48:51], s3 offen offset:0 sc1
    s_waitcnt vmcnt(0)
    v_max3_u32 v2, v40, v41, v42
    v_max3_u32 v2, v2, v43, v44
    v_max3_u32 v2, v2, v45, v46
    v_max_u32 v2, v2, v47
    v_cmp_eq_u32 vcc, -1, v2
    s_cbranch_vccnz L_r0
    s_branch L_g0
L_r1:
    s_add_u32 s29, s29, 1
    s_cmp_ge_u32 s29, 200000
    s_cbranch_scc1 L_g1
    s_add_u32 s3, s76, 0
    buffer_load_dwordx4 v[48:51], v116, s[48:51], s3 offen offset:1024 sc1
    buffer_load_dwordx4 v[52:55], v117, s[48:51], s3 offen offset:1024 sc1
    s_waitcnt vmcnt(0)
    v_max3_u32 v2, v48, v49, v50
    v_max3_u32 v2, v2, v51, v52
    v_max3_u32 v2, v2, v53, v54
    v_max_u32 v2, v2, v55
    v_cmp_eq_u32 vcc, -1, v2
    s_cbranch_vccnz L_r1
    s_branch L_g1
L_r2:
    s_add_u32 s29, s29, 1
    s_cmp_ge_u32 s29, 200000
    s_cbranch_scc1 L_g2
    s_add_u32 s3, s76, 0
    buffer_load_dwordx4 v[56:59], v116, s[48:51], s3 offen offset:2048 sc1
    buffer_load_dwordx4 v[60:63], v117, s[48:51], s3 offen offset:2048 sc1
    s_waitcnt vmcnt(0)
    v_max3_u32 v2, v56, v57, v58
    v_max3_u32 v2, v2, v59, v60
    v_max3_u32 v2, v2, v61, v62
    v_max_u32 v2, v2, v63
    v_cmp_eq_u32 vcc, -1, v2
    s_cbranch_vccnz L_r2
    s_branch L_g2
L_r3:
    s_add_u32 s29, s29, 1
    s_cmp_ge_u32 s29, 200000
    s_cbranch_scc1 L_g3
    s_add_u32 s3, s76, 0
    buffer_load_dwordx4 v[64:67], v116, s[48:51], s3 offen offset:3072 sc1
    buffer_load_dwordx4 v[68:71], v117, s[48:51], s3 offen offset:3072 sc1
    s_waitcnt vmcnt(0)
    v_max3_u32 v2, v64, v65, v66
    v_max3_u32 v2, v2, v67, v68
    v_max3_u32 v2, v2, v69, v70
    v_max_u32 v2, v2, v71
    v_cmp_eq_u32 vcc, -1, v2
    s_cbranch_vccnz L_r3
    s_branch L_g3
L_r4:
    s_add_u32 s29, s29, 1
    s_cmp_ge_u32 s29, 200000
    s_cbranch_scc1 L_g4
    s_add_u32 s3, s76, 4096
    buffer_load_dwordx4 v[72:75], v116, s[48:51], s3 offen offset:0 sc1
    buffer_load_dwordx4 v[76:79], v117, s[48:51], s3 offen offset:0 sc1
    s_waitcnt vmcnt(0)
    v_max3_u32 v2, v72, v73, v74
    v_max3_u32 v2, v2, v75, v76
    v_max3_u32 v2, v2, v77, v78
    v_max_u32 v2, v2, v79
    v_cmp_eq_u32 vcc, -1, v2
    s_cbranch_vccnz L_r4
    s_branch L_g4
L_r5:
    s_add_u32 s29, s29, 1
    s_cmp_ge_u32 s29, 200000
    s_cbranch_scc1 L_g5
    s_add_u32 s3, s76, 4096
    buffer_load_dwordx4 v[40:43], v116, s[48:51], s3 offen offset:1024 sc1
    buffer_load_dwordx4 v[44:47], v117, s[48:51], s3 offen offset:1024 sc1
    s_waitcnt vmcnt(0)
    v_max3_u32 v2, v40, v41, v42
    v_max3_u32 v2, v2, v43, v44
    v_max3_u32 v2, v2, v45, v46
    v_max_u32 v2, v2, v47
    v_cmp_eq_u32 vcc, -1, v2
    s_cbranch_vccnz L_r5
    s_branch L_g5
L_r6:
    s_add_u32 s29, s29, 1
    s_cmp_ge_u32 s29, 200000
    s_cbranch_scc1 L_g6
    s_add_u32 s3, s76, 4096
    buffer_load_dwordx4 v[48:51], v116, s[48:51], s3 offen offset:2048 sc1
    buffer_load_dwordx4 v[52:55], v117, s[48:51], s3 offen offset:2048 sc1
    s_waitcnt vmcnt(0)
    v_max3_u32 v2, v48, v49, v50
    v_max3_u32 v2, v2, v51, v52
    v_max3_u32 v2, v2, v53, v54
    v_max_u32 v2, v2, v55
    v_cmp_eq_u32 vcc, -1, v2
    s_cbranch_vccnz L_r6
    s_branch L_g6
L_r7:
    s_add_u32 s29, s29, 1
    s_cmp_ge_u32 s29, 200000
    s_cbranch_scc1 L_g7
    s_add_u32 s3, s76, 4096
    buffer_load_dwordx4 v[56:59], v116, s[48:51], s3 offen offset:3072 sc1
    buffer_load_dwordx4 v[60:63], v117, s[48:51], s3 offen offset:3072 sc1
    s_waitcnt vmcnt(0)
    v_max3_u32 v2, v56, v57, v58
    v_max3_u32 v2, v2, v59, v60
    v_max3_u32 v2, v2, v61, v62
    v_max_u32 v2, v2, v63
    v_cmp_eq_u32 vcc, -1, v2
    s_cbranch_vccnz L_r7
    s_branch L_g7
L_r8:
    s_add_u32 s29, s29, 1
    s_cmp_ge_u32 s29, 200000
    s_cbranch_scc1 L_g8
    s_add_u32 s3, s76, 8192
    buffer_load_dwordx4 v[64:67], v116, s[48:51], s3 offen offset:0 sc1
    buffer_load_dwordx4 v[68:71], v117, s[48:51], s3 offen offset:0 sc1
    s_waitcnt vmcnt(0)
    v_max3_u32 v2, v64, v65, v66
    v_max3_u32 v2, v2, v67, v68
    v_max3_u32 v2, v2, v69, v70
    v_max_u32 v2, v2, v71
    v_cmp_eq_u32 vcc, -1, v2
    s_cbranch_vccnz L_r8
    s_branch L_g8
L_r9:
    s_add_u32 s29, s29, 1
    s_cmp_ge_u32 s29, 200000
    s_cbranch_scc1 L_g9
    s_add_u32 s3, s76, 8192
    buffer_load_dwordx4 v[72:75], v116, s[48:51], s3 offen offset:1024 sc1
    buffer_load_dwordx4 v[76:79], v117, s[48:51], s3 offen offset:1024 sc1
    s_waitcnt vmcnt(0)
    v_max3_u32 v2, v72, v73, v74
    v_max3_u32 v2, v2, v75, v76
    v_max3_u32 v2, v2, v77, v78
    v_max_u32 v2, v2, v79
    v_cmp_eq_u32 vcc, -1, v2
    s_cbranch_vccnz L_r9
    s_branch L_g9
L_r10:
    s_add_u32 s29, s29, 1
    s_cmp_ge_u32 s29, 200000
    s_cbranch_scc1 L_g10
    s_add_u32 s3, s76, 8192
    buffer_load_dwordx4 v[40:43], v116, s[48:51], s3 offen offset:2048 sc1
    buffer_load_dwordx4 v[44:47], v117, s[48:51], s3 offen offset:2048 sc1
    s_waitcnt vmcnt(0)
    v_max3_u32 v2, v40, v41, v42
    v_max3_u32 v2, v2, v43, v44
    v_max3_u32 v2, v2, v45, v46
    v_max_u32 v2, v2, v47
    v_cmp_eq_u32 vcc, -1, v2
    s_cbranch_vccnz L_r10
    s_branch L_g10
L_r11:
    s_add_u32 s29, s29, 1
    s_cmp_ge_u32 s29, 200000
    s_cbranch_scc1 L_g11
    s_add_u32 s3, s76, 8192
    buffer_load_dwordx4 v[48:51], v116, s[48:51], s3 offen offset:3072 sc1
    buffer_load_dwordx4 v[52:55], v117, s[48:51], s3 offen offset:3072 sc1
    s_waitcnt vmcnt(0)
    v_max3_u32 v2, v48, v49, v50
    v_max3_u32 v2, v2, v51, v52
    v_max3_u32 v2, v2, v53, v54
    v_max_u32 v2, v2, v55
    v_cmp_eq_u32 vcc, -1, v2
    s_cbranch_vccnz L_r11
    s_branch L_g11
L_r12:
    s_add_u32 s29, s29, 1
    s_cmp_ge_u32 s29, 200000
    s_cbranch_scc1 L_g12
    s_add_u32 s3, s76, 12288
    buffer_load_dwordx4 v[56:59], v116, s[48:51], s3 offen offset:0 sc1
    buffer_load_dwordx4 v[60:63], v117, s[48:51], s3 offen offset:0 sc1
    s_waitcnt vmcnt(0)
    v_max3_u32 v2, v56, v57, v58
    v_max3_u32 v2, v2, v59, v60
    v_max3_u32 v2, v2, v61, v62
    v_max_u32 v2, v2, v63
    v_cmp_eq_u32 vcc, -1, v2
    s_cbranch_vccnz L_r12
    s_branch L_g12
L_r13:
    s_add_u32 s29, s29, 1
    s_cmp_ge_u32 s29, 200000
    s_cbranch_scc1 L_g13
    s_add_u32 s3, s76, 12288
    buffer_load_dwordx4 v[64:67], v116, s[48:51], s3 offen offset:1024 sc1
    buffer_load_dwordx4 v[68:71], v117, s[48:51], s3 offen offset:1024 sc1
    s_waitcnt vmcnt(0)
    v_max3_u32 v2, v64, v65, v66
    v_max3_u32 v2, v2, v67, v68
    v_max3_u32 v2, v2, v69, v70
    v_max_u32 v2, v2, v71
    v_cmp_eq_u32 vcc, -1, v2
    s_cbranch_vccnz L_r13
    s_branch L_g13
L_r14:
    s_add_u32 s29, s29, 1
    s_cmp_ge_u32 s29, 200000
    s_cbranch_scc1 L_g14
    s_add_u32 s3, s76, 12288
    buffer_load_dwordx4 v[72:75], v116, s[48:51], s3 offen offset:2048 sc1
    buffer_load_dwordx4 v[76:79], v117, s[48:51], s3 offen offset:2048 sc1
    s_waitcnt vmcnt(0)
    v_max3_u32 v2, v72, v73, v74
    v_max3_u32 v2, v2, v75, v76
    v_max3_u32 v2, v2, v77, v78
    v_max_u32 v2, v2, v79
    v_cmp_eq_u32 vcc, -1, v2
    s_cbranch_vccnz L_r14
    s_branch L_g14
L_r15:
    s_add_u32 s29, s29, 1
    s_cmp_ge_u32 s29, 200000
    s_cbranch_scc1 L_g15
    s_add_u32 s3, s76, 12288
    buffer_load_dwordx4 v[40:43], v116, s[48:51], s3 offen offset:3072 sc1
    buffer_load_dwordx4 v[44:47], v117, s[48:51], s3 offen offset:3072 sc1
    s_waitcnt vmcnt(0)
    v_max3_u32 v2, v40, v41, v42
    v_max3_u32 v2, v2, v43, v44
    v_max3_u32 v2, v2, v45, v46
    v_max_u32 v2, v2, v47
    v_cmp_eq_u32 vcc, -1, v2
    s_cbranch_vccnz L_r15
    s_branch L_g15
.p2align 8
.fill 4096, 4, 0xbf800000
.section .rodata,"a"
.p2align 6
.amdhsa_kernel recurrent_scan__linear_kernel_hedgehog__moe_arch_mod__prompt_kernel
  .amdhsa_next_free_vgpr 256
  .amdhsa_next_free_sgpr 102
  .amdhsa_accum_offset 256
  .amdhsa_group_segment_fixed_size 0
  .amdhsa_kernarg_size 96
  .amdhsa_user_sgpr_count 2
  .amdhsa_user_sgpr_kernarg_segment_ptr 1
  .amdhsa_system_sgpr_workgroup_id_x 1
.end_amdhsa_kernel
```

```asm
; @launch grid=(256,1,1) block=(512,1,1) lds=163840
.amdgcn_target "amdgcn-amd-amdhsa--gfx950"
.text
.globl recurrent_scan__linear_kernel_hedgehog__moe_arch_mod__prompt_kernel
.p2align 8
.type recurrent_scan__linear_kernel_hedgehog__moe_arch_mod__prompt_kernel,@function
recurrent_scan__linear_kernel_hedgehog__moe_arch_mod__prompt_kernel:
    s_cmp_ge_u32 s2, 256
    s_cbranch_scc1 L_done
    s_load_dwordx16 s[4:19], s[0:1], 0
    s_load_dwordx8 s[20:27], s[0:1], 64
    v_and_b32 v1, 63, v0
    v_lshrrev_b32 v2, 6, v0
    s_nop 0
    v_readfirstlane_b32 s39, v2
    s_and_b32 s34, s2, 1
    s_lshl_b32 s34, s34, 3
    s_bfe_u32 s3, s2, 0x30003
    s_add_u32 s36, s34, s3
    s_bfe_u32 s37, s2, 0x20001
    s_lshl_b32 s37, s37, 2
    s_lshr_b32 s28, s2, 6
    s_add_u32 s37, s37, s28
    s_and_b32 s80, s37, 12
    s_xor_b32 s80, s80, s34
    s_add_u32 s85, s36, s37
    s_and_b32 s85, s85, 3
    s_or_b32 s35, s80, s85
    s_mov_b32 s34, s36
    s_and_b32 s38, s39, 3
    s_cmp_lt_u32 s39, 4
    s_cbranch_scc1 L_C
L_H:
    v_and_b32 v4, 7, v1
    s_lshl_b32 s33, s37, 7
    s_lshl_b32 s87, s85, 7
    s_lshl_b32 s66, s80, 7
    s_lshl_b32 s3, s36, 7
    s_lshl_b32 s28, s38, 5
    s_add_u32 s3, s3, s28
    v_lshrrev_b32 v7, 3, v1
    v_add_u32 v3, s3, v7
    v_lshlrev_b32 v3, 11, v3
    v_lshrrev_b32 v5, 4, v1
    v_xor_b32 v6, v4, v5
    v_xor_b32_e64 v5, 4, v6
    v_lshl_add_u32 v6, v6, 4, v3
    v_lshl_add_u32 v5, v5, 4, v3
    v_add_u32_e64 v8, 0, v6
    v_add_u32 v9, 15360, v5
    v_add_u32 v10, 30720, v6
    v_add_u32 v11, 46080, v5
    s_lshr_b32 s32, s36, 1
    s_and_b32 s32, s32, 2
    s_xor_b32 s32, s32, s38
    s_lshl_b32 s3, s32, 4
    v_add_u32_e64 v7, s3, v7
    v_mul_u32_u24 v7, 6144, v7
    v_bfe_u32 v6, v1, 4, 1
    v_lshlrev_b32 v6, 1, v6
    v_xor_b32 v5, v4, v6
    v_add_u32 v7, s33, v7
    v_xor_b32 v6, 4, v5
    v_lshl_add_u32 v6, v6, 4, v7
    v_lshl_add_u32 v7, v5, 4, v7
    v_add_u32_e64 v12, 0, v7
    v_add_u32 v13, 48128, v6
    v_add_u32 v14, 2048, v7
    v_add_u32 v15, 50176, v6
    v_add_u32 v16, 4096, v7
    v_add_u32 v17, 52224, v6
    v_xor_b32 v12, 512, v12
    v_xor_b32 v13, 512, v13
    s_lshl_b32 s30, s38, 12
    s_lshl_b32 s31, s32, 11
    s_add_u32 s31, s31, 16384
    s_waitcnt lgkmcnt(0)
    s_mov_b32 s44, s6
    s_mov_b32 s45, s7
    s_mov_b32 s46, 6291456
    s_mov_b32 s47, 0x00020000
    s_mov_b32 s40, s4
    s_mov_b32 s41, s5
    s_mov_b32 s42, 4194304
    s_mov_b32 s43, 0x00020000
    v_lshlrev_b32 v252, 4, v1
    s_mov_b32 s48, s26
    s_mov_b32 s49, s27
    s_mov_b32 s50, 268435456
    s_mov_b32 s51, 0x00020000
    v_mov_b32 v19, 16384
    buffer_load_dword v19, v19, s[48:51], 0 offen sc1
    s_lshl_b32 s3, s36, 7
    s_lshl_b32 s28, s37, 3
    s_add_u32 s3, s3, s28
    s_lshl_b32 s3, s3, 11
    s_add_u32 s3, s3, s30
    s_add_u32 m0, s30, 131072
    s_nop 0
    buffer_load_dwordx4 v252, s[40:43], s3 offen offset:0 lds
    buffer_load_dwordx4 v252, s[40:43], s3 offen offset:2048 lds
    s_lshl_b32 s3, s36, 7
    s_lshl_b32 s28, s37, 3
    s_add_u32 s3, s3, s28
    s_lshl_b32 s3, s3, 11
    s_add_u32 s3, s3, s30
    s_add_u32 m0, s30, 131072
    s_nop 0
    buffer_load_dwordx4 v252, s[40:43], s3 offen offset:1024 lds
    buffer_load_dwordx4 v252, s[40:43], s3 offen offset:3072 lds
    s_mov_b32 s60, s14
    s_mov_b32 s61, s15
    s_mov_b32 s62, 2048
    s_mov_b32 s63, 0x00020000
    s_lshl_b32 s3, s38, 9
    s_add_u32 m0, s3, 122880
    s_mov_b32 exec_hi, 0
    buffer_load_dwordx4 v252, s[60:63], s3 offen lds
    s_mov_b64 exec, -1
    s_add_u32 s64, s87, 0
    s_and_b32 s64, s64, 511
    s_or_b32 s64, s64, 0
    s_xor_b32 s64, s64, s66
    s_mul_i32 s65, s64, 3072
    s_add_u32 m0, s31, 0
    s_nop 0
    buffer_load_dwordx4 v12, s[44:47], s65 offen offset:0 lds
    buffer_load_dwordx4 v13, s[44:47], s65 offen offset:1024 lds
    s_add_u32 m0, s31, 8192
    s_nop 0
    buffer_load_dwordx4 v14, s[44:47], s65 offen offset:0 lds
    buffer_load_dwordx4 v15, s[44:47], s65 offen offset:1024 lds
    s_add_u32 m0, s31, 16384
    s_nop 0
    buffer_load_dwordx4 v16, s[44:47], s65 offen offset:0 lds
    buffer_load_dwordx4 v17, s[44:47], s65 offen offset:1024 lds
    v_mov_b32 v248, -1
    v_mov_b32 v249, -1
    v_mov_b32 v250, -1
    v_mov_b32 v251, -1
    v_lshlrev_b32 v252, 4, v1
    s_and_b32 s85, s85, 0
    s_lshl_b32 s3, s37, 4
    s_add_u32 s3, s3, s36
    s_lshl_b32 s67, s3, 10
    s_add_u32 s67, s67, 524288
    s_lshl_b32 s3, s38, 8
    s_add_u32 s67, s67, s3
    v_mov_b32 v24, 0
    v_mov_b32 v25, 0
    v_mov_b32 v26, 0
    v_mov_b32 v27, 0
    v_mov_b32 v28, 0
    v_mov_b32 v29, 0
    v_mov_b32 v30, 0
    v_mov_b32 v31, 0
    v_lshlrev_b32 v253, 2, v1
    s_cmp_gt_u32 s37, 3
    s_subb_u32 s77, s37, 0
    s_cmp_gt_u32 s37, 11
    s_subb_u32 s77, s77, 0
    s_lshl_b32 s77, s77, 4
    s_add_u32 s77, s77, s36
    s_and_b32 s3, s37, 7
    s_cmp_eq_u32 s3, 3
    s_cselect_b32 s77, 224, s77
    s_bitcmp1_b32 s38, 0
    s_cselect_b32 s52, s18, s16
    s_cselect_b32 s53, s19, s17
    s_cmp_lt_u32 s77, 224
    s_cselect_b32 s54, 7340032, 0
    s_mov_b32 s55, 0x00020000
    s_mov_b32 s56, s20
    s_mov_b32 s57, s21
    s_mov_b32 s58, 7340032
    s_mov_b32 s59, 0x00020000
    s_and_b32 s3, s77, 3
    s_lshl_b32 s3, s3, 8
    s_lshr_b32 s28, s38, 1
    s_lshl_b32 s28, s28, 7
    s_add_u32 s3, s3, s28
    v_lshrrev_b32_e64 v5, 3, v1
    v_lshl_add_u32 v6, v5, 4, s3
    v_mul_u32_u24 v6, 7168, v6
    v_lshl_add_u32 v6, v4, 4, v6
    s_lshr_b32 s3, s77, 2
    s_lshl_b32 s3, s3, 7
    v_add_u32 v21, s3, v6
    s_lshr_b32 s3, s2, 4
    s_mul_i32 s3, s3, 224
    s_mul_i32 s28, s38, 56
    s_add_u32 s71, s3, s28
    v_lshlrev_b32 v6, 14, v5
    v_lshl_add_u32 v6, v4, 4, v6
    s_and_b32 s3, s2, 15
    s_lshl_b32 s3, s3, 7
    v_add_u32 v22, s3, v6
    s_mov_b32 s94, 1985229328
    s_mov_b32 s95, 4275878552
    s_cmp_eq_u32 s87, 128
    s_cselect_b32 s94, 1989161553, s94
    s_cselect_b32 s95, 3488135892, s95
    s_cmp_eq_u32 s87, 256
    s_cselect_b32 s94, 2052130354, s94
    s_cselect_b32 s95, 3487088276, s95
    s_cmp_eq_u32 s87, 384
    s_cselect_b32 s94, 3058856195, s94
    s_cselect_b32 s95, 3470326420, s95
    v_lshrrev_b32 v2, 2, v1
    v_and_b32 v3, 3, v1
    v_lshlrev_b32 v3, 4, v3
    v_lshl_add_u32 v232, v2, 10, v3
    v_lshlrev_b32 v2, 3, v1
    v_add_u32 v230, 152064, v2
    v_and_b32_e64 v4, 49, v1
    v_bfe_u32 v7, v1, 1, 2
    v_lshl_add_u32 v4, v7, 2, v4
    v_bfe_u32 v7, v1, 3, 1
    v_lshl_add_u32 v4, v7, 1, v4
    v_lshlrev_b32 v4, 2, v4
    v_add_u32 v231, 154624, v4
    s_mul_i32 s3, s38, 48
    v_and_b32 v2, 15, v1
    v_lshrrev_b32 v3, 4, v1
    v_cmp_gt_u32 vcc, 12, v2
    v_lshl_add_u32 v4, v2, 2, s3
    v_add_u32 v2, v4, v3
    v_mov_b32 v5, 192
    v_cndmask_b32 v4, v5, v4, vcc
    v_lshlrev_b32 v4, 2, v4
    v_lshl_add_u32 v235, v3, 10, v4
    v_and_b32_e64 v5, 7, v2
    v_bfe_u32 v6, v2, 3, 3
    v_lshl_add_u32 v5, v5, 3, v6
    v_and_b32 v2, 0xc0, v2
    v_add_u32 v2, v2, v5
    v_lshlrev_b32 v2, 2, v2
    v_add_u32 v2, 154880, v2
    v_mov_b32 v5, 162048
    v_cndmask_b32 v233, v5, v2, vcc
    v_lshrrev_b32 v5, 3, v1
    v_lshlrev_b32 v6, 11, v5
    v_bfe_u32 v5, v1, 4, 2
    v_lshlrev_b32 v5, 1, v5
    v_and_b32 v7, 7, v1
    v_xor_b32 v5, v5, v7
    v_lshl_add_u32 v6, v5, 4, v6
    s_lshl_b32 s3, s35, 7
    v_add_u32 v6, s3, v6
    v_add_u32_e64 v220, 0, v6
    v_add_u32 v221, 15360, v6
    v_add_u32 v222, 30720, v6
    v_add_u32 v223, 46080, v6
    s_lshl_b32 s72, s38, 12
    s_lshl_b32 s73, s38, 16
    s_lshl_b32 s3, s36, 2
    s_add_u32 s3, s3, s38
    s_lshr_b32 s28, s3, 5
    s_and_b32 s3, s3, 31
    s_lshl_b32 s74, s3, 7
    s_lshl_b32 s3, s37, 1
    s_add_u32 s75, s3, s28
    v_lshrrev_b32 v5, 3, v1
    v_mul_u32_u24 v5, 4224, v5
    v_and_b32_e64 v7, 7, v1
    v_lshl_add_u32 v112, v7, 4, v5
    s_mul_i32 s76, s75, 67584
    s_add_u32 s76, s76, s74
    s_add_u32 s76, s76, 8388608
    s_mul_i32 s3, s75, 4224
    s_add_u32 s3, s3, s74
    s_add_u32 s74, s3, 1048576
    s_lshl_b32 s75, s37, 1
    s_add_u32 s75, s75, s36
    s_mul_i32 s81, s75, 67584
    s_add_u32 s81, s81, 8392704
    s_mul_i32 s82, s75, 4224
    s_add_u32 s82, s82, 1052672
    s_lshr_b32 s3, s36, 1
    s_or_b32 s83, s3, s38
    s_and_b32 s3, s38, 1
    s_lshl_b32 s3, s3, 3
    s_and_b32 s28, s77, 3
    s_lshl_b32 s28, s28, 1
    s_add_u32 s3, s3, s28
    s_lshr_b32 s28, s38, 1
    s_add_u32 s3, s3, s28
    s_mul_i32 s3, s3, 14336
    s_lshr_b32 s28, s77, 2
    s_lshl_b32 s28, s28, 8
    s_add_u32 s3, s3, s28
    s_add_u32 s3, s3, 1183744
    s_cmp_lt_u32 s77, 224
    s_cselect_b32 s84, s3, 268435456
    v_and_b32 v2, 15, v1
    v_bfe_u32 v3, v1, 4, 1
    v_mul_u32_u24 v3, 4, v3
    v_xor_b32_e64 v3, s37, v3
    v_lshl_add_u32 v3, v3, 4, v2
    v_lshl_add_u32 v2, v2, 4, s34
    v_cmp_gt_u32 vcc, 32, v1
    s_nop 1
    v_cndmask_b32 v2, v2, v3, vcc
    v_lshlrev_b32 v113, 7, v2
    s_lshl_b32 s3, s38, 1
    s_lshr_b32 s28, s39, 2
    s_add_u32 s3, s3, s28
    s_lshl_b32 s69, s3, 4
    v_and_b32 v2, 15, v1
    v_add_u32 v23, s69, v2
    v_lshlrev_b32 v23, 7, v23
    v_lshrrev_b32 v2, 1, v2
    v_lshrrev_b32 v3, 5, v1
    v_xor_b32 v2, v2, v3
    v_lshl_add_u32 v23, v2, 4, v23
    v_bfe_u32 v3, v1, 4, 1
    v_lshl_add_u32 v23, v3, 3, v23
    v_bfe_u32 v5, v1, 4, 1
    v_lshlrev_b32 v5, 5, v5
    v_xor_b32 v5, v5, v252
    s_min_u32 s3, s38, 2
    s_lshl_b32 s3, s3, 13
    s_and_b32 s28, s36, 4
    s_lshl_b32 s28, s28, 10
    s_add_u32 s3, s3, s28
    s_add_u32 s3, s3, 16384
    v_add_u32 v18, s3, v5
    s_lshr_b32 s3, s38, 1
    s_lshl_b32 s28, s37, 1
    s_add_u32 s28, s28, s3
    s_and_b32 s29, s38, 1
    s_lshl_b32 s3, s28, 4
    s_add_u32 s3, s3, s36
    s_mul_i32 s3, s3, 4224
    s_mul_i32 s78, s29, 2112
    s_add_u32 s78, s78, s3
    s_add_u32 s78, s78, 8388608
    s_lshl_b32 s3, s36, 1
    s_add_u32 s29, s29, s3
    s_xor_b32 s28, s28, 8
    s_lshl_b32 s3, s29, 7
    s_add_u32 s3, s3, s28
    s_lshl_b32 s3, s3, 10
    s_add_u32 s79, s3, 4194304
    s_mov_b32 s88, s10
    s_mov_b32 s89, s11
    s_mov_b32 s90, 2097152
    s_mov_b32 s91, 0x00020000
    s_add_u32 s64, s87, 0
    s_and_b32 s64, s64, 511
    s_or_b32 s64, s64, 0
    s_xor_b32 s64, s64, s66
    s_mul_i32 s65, s64, 3072
    s_add_u32 m0, s30, 0
    s_nop 0
    buffer_load_dwordx4 v8, s[40:43], s64 offen offset:0 lds
    buffer_load_dwordx4 v9, s[40:43], s64 offen offset:1024 lds
    buffer_load_dwordx4 v10, s[40:43], s64 offen offset:2048 lds
    buffer_load_dwordx4 v11, s[40:43], s64 offen offset:3072 lds
    s_waitcnt vmcnt(10)
    s_barrier
    s_bfe_u32 s64, s94, 262148
    s_lshl_b32 s64, s64, 7
    s_xor_b32 s64, s64, s66
    s_mul_i32 s65, s64, 3072
    s_add_u32 m0, s30, 40960
    s_nop 0
    buffer_load_dwordx4 v8, s[40:43], s64 offen offset:0 lds
    buffer_load_dwordx4 v9, s[40:43], s64 offen offset:1024 lds
    buffer_load_dwordx4 v10, s[40:43], s64 offen offset:2048 lds
    buffer_load_dwordx4 v11, s[40:43], s64 offen offset:3072 lds
    s_add_u32 m0, s31, 40960
    s_nop 0
    buffer_load_dwordx4 v12, s[44:47], s65 offen offset:0 lds
    buffer_load_dwordx4 v13, s[44:47], s65 offen offset:1024 lds
    s_add_u32 m0, s31, 49152
    s_nop 0
    buffer_load_dwordx4 v14, s[44:47], s65 offen offset:0 lds
    buffer_load_dwordx4 v15, s[44:47], s65 offen offset:1024 lds
    s_add_u32 m0, s31, 57344
    s_nop 0
    buffer_load_dwordx4 v16, s[44:47], s65 offen offset:0 lds
    buffer_load_dwordx4 v17, s[44:47], s65 offen offset:1024 lds
    v_readfirstlane_b32 s86, v19
    s_nop 0
    s_mul_i32 s86, s86, 1664525
    s_add_u32 s86, s86, 1013904223
    s_waitcnt vmcnt(10)
    s_waitcnt lgkmcnt(0)
    s_barrier
    s_bfe_u32 s64, s94, 262152
    s_lshl_b32 s64, s64, 7
    s_xor_b32 s64, s64, s66
    s_mul_i32 s65, s64, 3072
    s_add_u32 m0, s30, 81920
    s_nop 0
    buffer_load_dwordx4 v8, s[40:43], s64 offen offset:0 lds
    buffer_load_dwordx4 v9, s[40:43], s64 offen offset:1024 lds
    buffer_load_dwordx4 v10, s[40:43], s64 offen offset:2048 lds
    buffer_load_dwordx4 v11, s[40:43], s64 offen offset:3072 lds
    s_add_u32 m0, s31, 81920
    s_nop 0
    buffer_load_dwordx4 v12, s[44:47], s65 offen offset:0 lds
    buffer_load_dwordx4 v13, s[44:47], s65 offen offset:1024 lds
    s_add_u32 m0, s31, 90112
    s_nop 0
    buffer_load_dwordx4 v14, s[44:47], s65 offen offset:0 lds
    buffer_load_dwordx4 v15, s[44:47], s65 offen offset:1024 lds
    s_add_u32 m0, s31, 98304
    s_nop 0
    buffer_load_dwordx4 v16, s[44:47], s65 offen offset:0 lds
    buffer_load_dwordx4 v17, s[44:47], s65 offen offset:1024 lds
    v_xor_b32 v4, 0, v23
    ds_read_b64 v[240:241], v4
    v_xor_b32 v5, 32, v23
    ds_read_b64 v[242:243], v5
    v_xor_b32 v6, 64, v23
    ds_read_b64 v[244:245], v6
    v_xor_b32 v7, 96, v23
    ds_read_b64 v[246:247], v7
    v_add_u32 v2, 0, v18
    v_xor_b32 v3, 64, v2
    ds_read_b128 v[32:35], v2 offset:0
    ds_read_b128 v[36:39], v3 offset:1024
    ds_read_b128 v[40:43], v2 offset:2048
    ds_read_b128 v[44:47], v3 offset:3072
    buffer_store_dwordx4 v[248:251], v252, s[48:51], s78 offen offset:0 sc1
    s_waitcnt vmcnt(11)
    s_waitcnt lgkmcnt(0)
    s_barrier
    s_cmp_eq_u32 s87, 0
    s_cbranch_scc1 L_nc1
    s_cmp_eq_u32 s87, 256
    s_cbranch_scc1 L_nc1
    s_cmp_eq_u32 s87, 384
    s_cbranch_scc1 L_nc1
    v_add_u32 v2, 40960, v18
    v_xor_b32 v3, 64, v2
    ds_read_b128 v[48:51], v2 offset:0
    ds_read_b128 v[52:55], v3 offset:1024
    ds_read_b128 v[56:59], v2 offset:2048
    ds_read_b128 v[60:63], v3 offset:3072
L_nc1:
    s_bfe_u32 s64, s94, 262156
    s_lshl_b32 s64, s64, 7
    s_xor_b32 s64, s64, s66
    s_mul_i32 s65, s64, 3072
    s_add_u32 m0, s30, 0
    s_nop 0
    buffer_load_dwordx4 v8, s[40:43], s64 offen offset:0 lds
    buffer_load_dwordx4 v9, s[40:43], s64 offen offset:1024 lds
    v_lshlrev_b32 v2, 16, v32
    v_and_b32 v3, 0xffff0000, v32
    v_add_f32 v24, v24, v2
    v_add_f32 v25, v25, v3
    buffer_load_dwordx4 v10, s[40:43], s64 offen offset:2048 lds
    v_lshlrev_b32 v4, 16, v33
    v_and_b32 v5, 0xffff0000, v33
    v_add_f32 v26, v26, v4
    v_add_f32 v27, v27, v5
    buffer_load_dwordx4 v11, s[40:43], s64 offen offset:3072 lds
    v_lshlrev_b32 v2, 16, v34
    v_and_b32 v3, 0xffff0000, v34
    v_add_f32 v28, v28, v2
    v_add_f32 v29, v29, v3
    s_add_u32 m0, s31, 0
    s_nop 0
    buffer_load_dwordx4 v12, s[44:47], s65 offen offset:0 lds
    v_lshlrev_b32 v4, 16, v35
    v_and_b32 v5, 0xffff0000, v35
    v_add_f32 v30, v30, v4
    v_add_f32 v31, v31, v5
    buffer_load_dwordx4 v13, s[44:47], s65 offen offset:1024 lds
    v_lshlrev_b32 v2, 16, v36
    v_and_b32 v3, 0xffff0000, v36
    v_add_f32 v24, v24, v2
    v_add_f32 v25, v25, v3
    s_add_u32 m0, s31, 8192
    s_nop 0
    buffer_load_dwordx4 v14, s[44:47], s65 offen offset:0 lds
    v_lshlrev_b32 v4, 16, v37
    v_and_b32 v5, 0xffff0000, v37
    v_add_f32 v26, v26, v4
    v_add_f32 v27, v27, v5
    buffer_load_dwordx4 v15, s[44:47], s65 offen offset:1024 lds
    v_lshlrev_b32 v2, 16, v38
    v_and_b32 v3, 0xffff0000, v38
    v_add_f32 v28, v28, v2
    v_add_f32 v29, v29, v3
    s_add_u32 m0, s31, 16384
    s_nop 0
    buffer_load_dwordx4 v16, s[44:47], s65 offen offset:0 lds
    v_lshlrev_b32 v4, 16, v39
    v_and_b32 v5, 0xffff0000, v39
    v_add_f32 v30, v30, v4
    v_add_f32 v31, v31, v5
    buffer_load_dwordx4 v17, s[44:47], s65 offen offset:1024 lds
    buffer_store_dwordx4 v[248:251], v252, s[48:51], s78 offen offset:1024 sc1
    s_mov_b64 exec, 15
    buffer_store_dwordx4 v[248:251], v252, s[48:51], s78 offen offset:2048 sc1
    s_mov_b64 exec, -1
    s_waitcnt vmcnt(13)
    s_waitcnt lgkmcnt(0)
    s_barrier
    s_cmp_eq_u32 s87, 0
    s_cbranch_scc1 L_nc2
    s_cmp_eq_u32 s87, 128
    s_cbranch_scc1 L_nc2
    s_cmp_eq_u32 s87, 384
    s_cbranch_scc1 L_nc2
    v_add_u32 v2, 81920, v18
    v_xor_b32 v3, 64, v2
    ds_read_b128 v[48:51], v2 offset:0
    ds_read_b128 v[52:55], v3 offset:1024
    ds_read_b128 v[56:59], v2 offset:2048
    ds_read_b128 v[60:63], v3 offset:3072
L_nc2:
    s_bfe_u32 s64, s94, 262160
    s_lshl_b32 s64, s64, 7
    s_xor_b32 s64, s64, s66
    s_mul_i32 s65, s64, 3072
    s_add_u32 m0, s30, 40960
    s_nop 0
    buffer_load_dwordx4 v8, s[40:43], s64 offen offset:0 lds
    buffer_load_dwordx4 v9, s[40:43], s64 offen offset:1024 lds
    v_lshlrev_b32 v2, 16, v40
    v_and_b32 v3, 0xffff0000, v40
    v_add_f32 v24, v24, v2
    v_add_f32 v25, v25, v3
    buffer_load_dwordx4 v10, s[40:43], s64 offen offset:2048 lds
    v_lshlrev_b32 v4, 16, v41
    v_and_b32 v5, 0xffff0000, v41
    v_add_f32 v26, v26, v4
    v_add_f32 v27, v27, v5
    buffer_load_dwordx4 v11, s[40:43], s64 offen offset:3072 lds
    v_lshlrev_b32 v2, 16, v42
    v_and_b32 v3, 0xffff0000, v42
    v_add_f32 v28, v28, v2
    v_add_f32 v29, v29, v3
    s_add_u32 m0, s31, 40960
    s_nop 0
    buffer_load_dwordx4 v12, s[44:47], s65 offen offset:0 lds
    v_lshlrev_b32 v4, 16, v43
    v_and_b32 v5, 0xffff0000, v43
    v_add_f32 v30, v30, v4
    v_add_f32 v31, v31, v5
    buffer_load_dwordx4 v13, s[44:47], s65 offen offset:1024 lds
    v_lshlrev_b32 v2, 16, v44
    v_and_b32 v3, 0xffff0000, v44
    v_add_f32 v24, v24, v2
    v_add_f32 v25, v25, v3
    s_add_u32 m0, s31, 49152
    s_nop 0
    buffer_load_dwordx4 v14, s[44:47], s65 offen offset:0 lds
    v_lshlrev_b32 v4, 16, v45
    v_and_b32 v5, 0xffff0000, v45
    v_add_f32 v26, v26, v4
    v_add_f32 v27, v27, v5
    buffer_load_dwordx4 v15, s[44:47], s65 offen offset:1024 lds
    v_lshlrev_b32 v2, 16, v46
    v_and_b32 v3, 0xffff0000, v46
    v_add_f32 v28, v28, v2
    v_add_f32 v29, v29, v3
    s_add_u32 m0, s31, 57344
    s_nop 0
    buffer_load_dwordx4 v16, s[44:47], s65 offen offset:0 lds
    v_lshlrev_b32 v4, 16, v47
    v_and_b32 v5, 0xffff0000, v47
    v_add_f32 v30, v30, v4
    v_add_f32 v31, v31, v5
    buffer_load_dwordx4 v17, s[44:47], s65 offen offset:1024 lds
    s_waitcnt vmcnt(12)
    s_waitcnt lgkmcnt(0)
    s_barrier
    s_cmp_eq_u32 s87, 0
    s_cbranch_scc1 L_nc3
    s_cmp_eq_u32 s87, 128
    s_cbranch_scc1 L_nc3
    s_cmp_eq_u32 s87, 256
    s_cbranch_scc1 L_nc3
    v_add_u32 v2, 0, v18
    v_xor_b32_e64 v3, 64, v2
    ds_read_b128 v[48:51], v2 offset:0
    ds_read_b128 v[52:55], v3 offset:1024
    ds_read_b128 v[56:59], v2 offset:2048
    ds_read_b128 v[60:63], v3 offset:3072
L_nc3:
    s_bfe_u32 s64, s94, 262164
    s_lshl_b32 s64, s64, 7
    s_xor_b32 s64, s64, s66
    s_mul_i32 s65, s64, 3072
    s_add_u32 m0, s30, 81920
    s_nop 0
    buffer_load_dwordx4 v8, s[40:43], s64 offen offset:0 lds
    buffer_load_dwordx4 v9, s[40:43], s64 offen offset:1024 lds
    buffer_load_dwordx4 v10, s[40:43], s64 offen offset:2048 lds
    buffer_load_dwordx4 v11, s[40:43], s64 offen offset:3072 lds
    s_add_u32 m0, s31, 81920
    s_nop 0
    buffer_load_dwordx4 v12, s[44:47], s65 offen offset:0 lds
    buffer_load_dwordx4 v13, s[44:47], s65 offen offset:1024 lds
    s_add_u32 m0, s31, 90112
    s_nop 0
    buffer_load_dwordx4 v14, s[44:47], s65 offen offset:0 lds
    buffer_load_dwordx4 v15, s[44:47], s65 offen offset:1024 lds
    s_add_u32 m0, s31, 98304
    s_nop 0
    buffer_load_dwordx4 v16, s[44:47], s65 offen offset:0 lds
    buffer_load_dwordx4 v17, s[44:47], s65 offen offset:1024 lds
    s_lshl_b32 s3, s36, 10
    buffer_load_dwordx4 v[72:75], v252, s[48:51], s3 offen sc1
    s_lshl_b32 s3, s37, 6
    buffer_load_dword v76, v232, s[48:51], s3 offen offset:12 sc1
    s_mov_b32 s60, s8
    s_mov_b32 s61, s9
    s_mov_b32 s62, 65536
    s_mov_b32 s63, 0x00020000
    s_lshl_b32 s3, s38, 10
    s_add_u32 m0, s3, 147712
    s_lshl_b32 s28, s37, 12
    s_add_u32 s3, s3, s28
    buffer_load_dwordx4 v252, s[60:63], s3 offen lds
    s_add_u32 m0, m0, 8192
    s_xor_b32 s3, s3, 16384
    buffer_load_dwordx4 v252, s[60:63], s3 offen lds
    s_lshl_b32 s3, s2, 13
    s_lshl_b32 s28, s38, 11
    s_add_u32 s3, s3, s28
    v_lshlrev_b32_e64 v3, 7, v1
    s_mov_b64 exec, 0xffff
    buffer_load_dword v20, v3, s[88:91], s3 offen
    s_mov_b64 exec, -1
    s_mov_b32 s3, 0
    buffer_load_dwordx4 v[128:131], v21, s[52:55], s3 offen nt
    s_mov_b32 s3, 7168
    buffer_load_dwordx4 v[132:135], v21, s[52:55], s3 offen nt
    s_mov_b32 s3, 14336
    buffer_load_dwordx4 v[136:139], v21, s[52:55], s3 offen nt
    s_mov_b32 s3, 21504
    buffer_load_dwordx4 v[140:143], v21, s[52:55], s3 offen nt
    s_waitcnt vmcnt(19)
    s_waitcnt lgkmcnt(0)
    s_barrier
    s_cmp_eq_u32 s87, 128
    s_cbranch_scc1 L_nc4
    s_cmp_eq_u32 s87, 256
    s_cbranch_scc1 L_nc4
    s_cmp_eq_u32 s87, 384
    s_cbranch_scc1 L_nc4
    v_add_u32 v2, 40960, v18
    v_xor_b32_e64 v3, 64, v2
    ds_read_b128 v[48:51], v2 offset:0
    ds_read_b128 v[52:55], v3 offset:1024
    ds_read_b128 v[56:59], v2 offset:2048
    ds_read_b128 v[60:63], v3 offset:3072
L_nc4:
    s_waitcnt vmcnt(7)
    s_mov_b32 s29, 0
L_k1:
    v_cmp_ne_u32 vcc, s86, v75
    v_cmp_ne_u32 s[92:93], s86, v76
    s_nop 0
    s_or_b64 vcc, vcc, s[92:93]
    s_cbranch_vccz L_k1k
    s_add_u32 s29, s29, 1
    s_cmp_ge_u32 s29, 200000
    s_cbranch_scc1 L_k1k
    s_sleep 2
    s_lshl_b32 s3, s36, 10
    buffer_load_dwordx4 v[72:75], v252, s[48:51], s3 offen sc1
    s_lshl_b32 s3, s37, 6
    buffer_load_dword v76, v232, s[48:51], s3 offen offset:12 sc1
    s_waitcnt vmcnt(0)
    s_branch L_k1
L_k1k:
    v_max_u32 v74, v74, v74 quad_perm:[1,0,3,2] row_mask:0xf bank_mask:0xf
    s_nop 1
    v_max_u32 v74, v74, v74 quad_perm:[2,3,0,1] row_mask:0xf bank_mask:0xf
    s_nop 1
    v_max_u32 v74, v74, v74 row_half_mirror row_mask:0xf bank_mask:0xf
    s_nop 1
    v_max_u32 v74, v74, v74 row_mirror row_mask:0xf bank_mask:0xf
    v_and_b32 v2, 0xffff0000, v72
    v_lshlrev_b32 v224, 16, v72
    v_and_b32 v3, 0xffff0000, v73
    v_lshlrev_b32 v225, 16, v73
    v_rcp_f32 v226, v2
    v_rcp_f32 v227, v3
    v_lshrrev_b32 v2, 16, v2
    v_or_b32 v236, v2, v3
    v_mul_f32 v228, 1069066811, v226
    v_mul_f32 v229, 1069066811, v227
    v_readlane_b32 s70, v74, 0
    v_readlane_b32 s3, v74, 16
    v_readlane_b32 s28, v74, 32
    v_readlane_b32 s29, v74, 48
    s_max_u32 s70, s70, s3
    s_max_u32 s28, s28, s29
    s_max_u32 s70, s70, s28
    s_bfe_u32 s64, s94, 262168
    s_lshl_b32 s64, s64, 7
    s_xor_b32 s64, s64, s66
    s_mul_i32 s65, s64, 3072
    s_add_u32 m0, s30, 0
    s_nop 0
    buffer_load_dwordx4 v8, s[40:43], s64 offen offset:0 lds
    buffer_load_dwordx4 v9, s[40:43], s64 offen offset:1024 lds
    buffer_load_dwordx4 v10, s[40:43], s64 offen offset:2048 lds
    buffer_load_dwordx4 v11, s[40:43], s64 offen offset:3072 lds
    s_add_u32 m0, s31, 0
    s_nop 0
    buffer_load_dwordx4 v12, s[44:47], s65 offen offset:0 lds
    buffer_load_dwordx4 v13, s[44:47], s65 offen offset:1024 lds
    s_add_u32 m0, s31, 8192
    s_nop 0
    buffer_load_dwordx4 v14, s[44:47], s65 offen offset:0 lds
    buffer_load_dwordx4 v15, s[44:47], s65 offen offset:1024 lds
    s_add_u32 m0, s31, 16384
    s_nop 0
    buffer_load_dwordx4 v16, s[44:47], s65 offen offset:0 lds
    buffer_load_dwordx4 v17, s[44:47], s65 offen offset:1024 lds
    s_waitcnt lgkmcnt(0)
    s_barrier
    s_bfe_u32 s64, s94, 262172
    s_lshl_b32 s64, s64, 7
    s_xor_b32 s64, s64, s66
    s_mul_i32 s65, s64, 3072
    s_add_u32 m0, s30, 40960
    s_nop 0
    buffer_load_dwordx4 v8, s[40:43], s64 offen offset:0 lds
    buffer_load_dwordx4 v9, s[40:43], s64 offen offset:1024 lds
    v_lshlrev_b32 v2, 16, v48
    v_and_b32 v3, 0xffff0000, v48
    v_add_f32 v24, v24, v2
    v_add_f32 v25, v25, v3
    buffer_load_dwordx4 v10, s[40:43], s64 offen offset:2048 lds
    v_lshlrev_b32 v4, 16, v49
    v_and_b32 v5, 0xffff0000, v49
    v_add_f32 v26, v26, v4
    v_add_f32 v27, v27, v5
    buffer_load_dwordx4 v11, s[40:43], s64 offen offset:3072 lds
    v_lshlrev_b32 v2, 16, v50
    v_and_b32 v3, 0xffff0000, v50
    v_add_f32 v28, v28, v2
    v_add_f32 v29, v29, v3
    s_add_u32 m0, s31, 40960
    s_nop 0
    buffer_load_dwordx4 v12, s[44:47], s65 offen offset:0 lds
    v_lshlrev_b32 v4, 16, v51
    v_and_b32 v5, 0xffff0000, v51
    v_add_f32 v30, v30, v4
    v_add_f32 v31, v31, v5
    buffer_load_dwordx4 v13, s[44:47], s65 offen offset:1024 lds
    v_lshlrev_b32 v2, 16, v52
    v_and_b32 v3, 0xffff0000, v52
    v_add_f32 v24, v24, v2
    v_add_f32 v25, v25, v3
    s_add_u32 m0, s31, 49152
    s_nop 0
    buffer_load_dwordx4 v14, s[44:47], s65 offen offset:0 lds
    v_lshlrev_b32 v4, 16, v53
    v_and_b32 v5, 0xffff0000, v53
    v_add_f32 v26, v26, v4
    v_add_f32 v27, v27, v5
    buffer_load_dwordx4 v15, s[44:47], s65 offen offset:1024 lds
    v_lshlrev_b32 v2, 16, v54
    v_and_b32 v3, 0xffff0000, v54
    v_add_f32 v28, v28, v2
    v_add_f32 v29, v29, v3
    s_add_u32 m0, s31, 57344
    s_nop 0
    buffer_load_dwordx4 v16, s[44:47], s65 offen offset:0 lds
    v_lshlrev_b32 v4, 16, v55
    v_and_b32 v5, 0xffff0000, v55
    v_add_f32 v30, v30, v4
    v_add_f32 v31, v31, v5
    buffer_load_dwordx4 v17, s[44:47], s65 offen offset:1024 lds
    s_add_u32 s3, s79, 0
    buffer_store_dwordx4 v[248:251], v252, s[48:51], s3 offen sc1
    s_waitcnt vmcnt(11)
    s_waitcnt lgkmcnt(0)
    s_barrier
    s_bfe_u32 s64, s95, 262144
    s_lshl_b32 s64, s64, 7
    s_xor_b32 s64, s64, s66
    s_mul_i32 s65, s64, 3072
    s_add_u32 m0, s30, 81920
    s_nop 0
    buffer_load_dwordx4 v8, s[40:43], s64 offen offset:0 lds
    buffer_load_dwordx4 v9, s[40:43], s64 offen offset:1024 lds
    v_lshlrev_b32 v2, 16, v56
    v_and_b32 v3, 0xffff0000, v56
    v_add_f32 v24, v24, v2
    v_add_f32 v25, v25, v3
    buffer_load_dwordx4 v10, s[40:43], s64 offen offset:2048 lds
    v_lshlrev_b32 v4, 16, v57
    v_and_b32 v5, 0xffff0000, v57
    v_add_f32 v26, v26, v4
    v_add_f32 v27, v27, v5
    buffer_load_dwordx4 v11, s[40:43], s64 offen offset:3072 lds
    v_lshlrev_b32 v2, 16, v58
    v_and_b32 v3, 0xffff0000, v58
    v_add_f32 v28, v28, v2
    v_add_f32 v29, v29, v3
    s_add_u32 m0, s31, 81920
    s_nop 0
    buffer_load_dwordx4 v12, s[44:47], s65 offen offset:0 lds
    v_lshlrev_b32 v4, 16, v59
    v_and_b32 v5, 0xffff0000, v59
    v_add_f32 v30, v30, v4
    v_add_f32 v31, v31, v5
    buffer_load_dwordx4 v13, s[44:47], s65 offen offset:1024 lds
    v_lshlrev_b32 v2, 16, v60
    v_and_b32 v3, 0xffff0000, v60
    v_add_f32 v24, v24, v2
    v_add_f32 v25, v25, v3
    s_add_u32 m0, s31, 90112
    s_nop 0
    buffer_load_dwordx4 v14, s[44:47], s65 offen offset:0 lds
    v_lshlrev_b32 v4, 16, v61
    v_and_b32 v5, 0xffff0000, v61
    v_add_f32 v26, v26, v4
    v_add_f32 v27, v27, v5
    buffer_load_dwordx4 v15, s[44:47], s65 offen offset:1024 lds
    v_lshlrev_b32 v2, 16, v62
    v_and_b32 v3, 0xffff0000, v62
    v_add_f32 v28, v28, v2
    v_add_f32 v29, v29, v3
    s_add_u32 m0, s31, 98304
    s_nop 0
    buffer_load_dwordx4 v16, s[44:47], s65 offen offset:0 lds
    v_lshlrev_b32 v4, 16, v63
    v_and_b32 v5, 0xffff0000, v63
    v_add_f32 v30, v30, v4
    v_add_f32_e64 v31, v31, v5
    buffer_load_dwordx4 v17, s[44:47], s65 offen offset:1024 lds
    s_add_u32 s3, s79, 32768
    buffer_store_dwordx4 v[248:251], v252, s[48:51], s3 offen sc1
    s_waitcnt vmcnt(12)
    s_waitcnt lgkmcnt(0)
    s_barrier
    s_bfe_u32 s64, s95, 262148
    s_lshl_b32 s64, s64, 7
    s_xor_b32 s64, s64, s66
    s_mul_i32 s65, s64, 3072
    s_add_u32 m0, s30, 0
    s_nop 0
    buffer_load_dwordx4 v8, s[40:43], s64 offen offset:0 lds
    buffer_load_dwordx4 v9, s[40:43], s64 offen offset:1024 lds
    v_permlane32_swap_b32 v24, v28
    v_permlane32_swap_b32 v25, v29
    buffer_load_dwordx4 v10, s[40:43], s64 offen offset:2048 lds
    v_permlane32_swap_b32 v26, v30
    v_permlane32_swap_b32 v27, v31
    buffer_load_dwordx4 v11, s[40:43], s64 offen offset:3072 lds
    v_add_f32 v24, v24, v28
    v_add_f32 v25, v25, v29
    s_add_u32 m0, s31, 0
    s_nop 0
    buffer_load_dwordx4 v12, s[44:47], s65 offen offset:0 lds
    v_add_f32 v26, v26, v30
    v_add_f32 v27, v27, v31
    buffer_load_dwordx4 v13, s[44:47], s65 offen offset:1024 lds
    v_permlane16_swap_b32 v24, v26
    v_permlane16_swap_b32 v25, v27
    s_add_u32 m0, s31, 8192
    s_nop 0
    buffer_load_dwordx4 v14, s[44:47], s65 offen offset:0 lds
    v_add_f32 v24, v24, v26
    v_add_f32 v25, v25, v27
    buffer_load_dwordx4 v15, s[44:47], s65 offen offset:1024 lds
    v_add_f32 v24, v24, v24 row_ror:8 row_mask:0xf bank_mask:0xf
    v_add_f32 v25, v25, v25 row_ror:8 row_mask:0xf bank_mask:0xf
    s_add_u32 m0, s31, 16384
    s_nop 0
    buffer_load_dwordx4 v16, s[44:47], s65 offen offset:0 lds
    buffer_load_dwordx4 v17, s[44:47], s65 offen offset:1024 lds
    v_and_b32 v2, 8, v1
    v_cmp_eq_u32 vcc, 0, v2
    s_nop 1
    v_cndmask_b32 v24, v25, v24, vcc
    s_cmp_eq_u32 s38, 3
    s_cselect_b64 exec, -1, 0
    v_mov_b32 v24, s70
    s_mov_b64 exec, -1
    buffer_store_dword v24, v253, s[48:51], s67 offen sc1
    s_waitcnt vmcnt(12)
    s_waitcnt lgkmcnt(0)
    s_barrier
    s_bfe_u32 s64, s95, 262152
    s_lshl_b32 s64, s64, 7
    s_xor_b32 s64, s64, s66
    s_mul_i32 s65, s64, 3072
    s_add_u32 m0, s30, 40960
    s_nop 0
    buffer_load_dwordx4 v8, s[40:43], s64 offen offset:0 lds
    buffer_load_dwordx4 v9, s[40:43], s64 offen offset:1024 lds
    buffer_load_dwordx4 v10, s[40:43], s64 offen offset:2048 lds
    buffer_load_dwordx4 v11, s[40:43], s64 offen offset:3072 lds
    s_add_u32 m0, s31, 40960
    s_nop 0
    buffer_load_dwordx4 v12, s[44:47], s65 offen offset:0 lds
    buffer_load_dwordx4 v13, s[44:47], s65 offen offset:1024 lds
    s_add_u32 m0, s31, 49152
    s_nop 0
    buffer_load_dwordx4 v14, s[44:47], s65 offen offset:0 lds
    buffer_load_dwordx4 v15, s[44:47], s65 offen offset:1024 lds
    s_add_u32 m0, s31, 57344
    s_nop 0
    buffer_load_dwordx4 v16, s[44:47], s65 offen offset:0 lds
    buffer_load_dwordx4 v17, s[44:47], s65 offen offset:1024 lds
    s_add_u32 s3, s79, 65536
    buffer_store_dwordx4 v[248:251], v252, s[48:51], s3 offen sc1
    s_add_u32 s3, s79, 98304
    buffer_store_dwordx4 v[248:251], v252, s[48:51], s3 offen sc1
    s_waitcnt vmcnt(13)
    s_waitcnt lgkmcnt(0)
    s_barrier
    s_bfe_u32 s64, s95, 262156
    s_lshl_b32 s64, s64, 7
    s_xor_b32 s64, s64, s66
    s_mul_i32 s65, s64, 3072
    s_add_u32 m0, s30, 81920
    s_nop 0
    buffer_load_dwordx4 v8, s[40:43], s64 offen offset:0 lds
    buffer_load_dwordx4 v9, s[40:43], s64 offen offset:1024 lds
    buffer_load_dwordx4 v10, s[40:43], s64 offen offset:2048 lds
    buffer_load_dwordx4 v11, s[40:43], s64 offen offset:3072 lds
    s_add_u32 m0, s31, 81920
    s_nop 0
    buffer_load_dwordx4 v12, s[44:47], s65 offen offset:0 lds
    buffer_load_dwordx4 v13, s[44:47], s65 offen offset:1024 lds
    s_add_u32 m0, s31, 90112
    s_nop 0
    buffer_load_dwordx4 v14, s[44:47], s65 offen offset:0 lds
    buffer_load_dwordx4 v15, s[44:47], s65 offen offset:1024 lds
    s_add_u32 m0, s31, 98304
    s_nop 0
    buffer_load_dwordx4 v16, s[44:47], s65 offen offset:0 lds
    buffer_load_dwordx4 v17, s[44:47], s65 offen offset:1024 lds
    s_lshl_b32 s3, s37, 14
    s_add_u32 s3, s3, 524288
    s_add_u32 s28, s3, 0
    buffer_load_dwordx4 v[80:83], v235, s[48:51], s28 offen sc1
    s_add_u32 s28, s3, 4096
    buffer_load_dwordx4 v[84:87], v235, s[48:51], s28 offen sc1
    s_waitcnt vmcnt(14)
    s_waitcnt lgkmcnt(0)
    s_barrier
    s_lshl_b32 s3, s37, 14
    s_nop 0
    s_add_u32 s3, s3, 524288
    s_add_u32 s28, s3, 8192
    buffer_load_dwordx4 v[88:91], v235, s[48:51], s28 offen sc1
    s_add_u32 s28, s3, 12288
    buffer_load_dwordx4 v[92:95], v235, s[48:51], s28 offen sc1
    s_bfe_u32 s64, s95, 262160
    s_lshl_b32 s64, s64, 7
    s_xor_b32 s64, s64, s66
    s_mul_i32 s65, s64, 3072
    s_add_u32 m0, s30, 0
    s_nop 0
    buffer_load_dwordx4 v8, s[40:43], s64 offen offset:0 lds
    buffer_load_dwordx4 v9, s[40:43], s64 offen offset:1024 lds
    buffer_load_dwordx4 v10, s[40:43], s64 offen offset:2048 lds
    buffer_load_dwordx4 v11, s[40:43], s64 offen offset:3072 lds
    s_add_u32 m0, s31, 0
    s_nop 0
    buffer_load_dwordx4 v12, s[44:47], s65 offen offset:0 lds
    buffer_load_dwordx4 v13, s[44:47], s65 offen offset:1024 lds
    s_add_u32 m0, s31, 8192
    s_nop 0
    buffer_load_dwordx4 v14, s[44:47], s65 offen offset:0 lds
    buffer_load_dwordx4 v15, s[44:47], s65 offen offset:1024 lds
    s_add_u32 m0, s31, 16384
    s_nop 0
    buffer_load_dwordx4 v16, s[44:47], s65 offen offset:0 lds
    buffer_load_dwordx4 v17, s[44:47], s65 offen offset:1024 lds
    s_waitcnt vmcnt(14)
    s_waitcnt lgkmcnt(0)
    s_barrier
    s_waitcnt vmcnt(10)
    s_mov_b32 s29, 0
L_k2:
    s_nop 0
    v_max3_u32 v2, v80, v81, v82
    v_max3_u32 v2, v2, v83, v84
    v_max3_u32 v2, v2, v85, v86
    v_max3_u32 v2, v2, v87, v88
    v_max3_u32 v2, v2, v89, v90
    v_max3_u32 v2, v2, v91, v92
    v_max3_u32 v2, v2, v93, v94
    v_max_u32 v2, v2, v95
    v_cmp_eq_u32 vcc, -1, v2
    s_cbranch_vccz L_k2k
    s_add_u32 s29, s29, 1
    s_cmp_ge_u32 s29, 200000
    s_cbranch_scc1 L_k2k
    s_sleep 1
    s_lshl_b32 s3, s37, 14
    s_add_u32 s3, s3, 524288
    s_add_u32 s28, s3, 0
    buffer_load_dwordx4 v[80:83], v235, s[48:51], s28 offen sc1
    s_add_u32 s28, s3, 4096
    buffer_load_dwordx4 v[84:87], v235, s[48:51], s28 offen sc1
    s_add_u32 s28, s3, 8192
    buffer_load_dwordx4 v[88:91], v235, s[48:51], s28 offen sc1
    s_add_u32 s28, s3, 12288
    buffer_load_dwordx4 v[92:95], v235, s[48:51], s28 offen sc1
    s_waitcnt vmcnt(0)
    s_branch L_k2
L_k2k:
    s_bfe_u32 s64, s95, 262164
    s_lshl_b32 s64, s64, 7
    s_xor_b32 s64, s64, s66
    s_mul_i32 s65, s64, 3072
    s_add_u32 m0, s30, 40960
    s_nop 0
    buffer_load_dwordx4 v8, s[40:43], s64 offen offset:0 lds
    buffer_load_dwordx4 v9, s[40:43], s64 offen offset:1024 lds
    v_max3_u32 v2, v80, v84, v88
    v_max_u32 v2, v2, v92
    v_add_f32 v80, v80, v88
    buffer_load_dwordx4 v10, s[40:43], s64 offen offset:2048 lds
    v_add_f32 v81, v81, v89
    v_add_f32 v82, v82, v90
    v_add_f32 v83, v83, v91
    buffer_load_dwordx4 v11, s[40:43], s64 offen offset:3072 lds
    v_add_f32 v84, v84, v92
    v_add_f32 v85, v85, v93
    v_add_f32 v86, v86, v94
    s_add_u32 m0, s31, 40960
    s_nop 0
    buffer_load_dwordx4 v12, s[44:47], s65 offen offset:0 lds
    v_add_f32 v87, v87, v95
    v_add_f32 v80, v80, v84
    v_add_f32 v81, v81, v85
    buffer_load_dwordx4 v13, s[44:47], s65 offen offset:1024 lds
    v_add_f32 v82, v82, v86
    v_add_f32_e64 v83, v83, v87
    v_readlane_b32 s70, v2, 12
    s_add_u32 m0, s31, 49152
    s_nop 0
    buffer_load_dwordx4 v14, s[44:47], s65 offen offset:0 lds
    v_readlane_b32 s3, v2, 28
    v_readlane_b32 s28, v2, 44
    v_readlane_b32 s29, v2, 60
    buffer_load_dwordx4 v15, s[44:47], s65 offen offset:1024 lds
    s_max_u32 s70, s70, s3
    s_max_u32 s28, s28, s29
    s_max_u32 s70, s70, s28
    s_add_u32 m0, s31, 57344
    s_nop 0
    buffer_load_dwordx4 v16, s[44:47], s65 offen offset:0 lds
    v_permlane32_swap_b32 v80, v82
    v_permlane32_swap_b32 v81, v83
    v_add_f32 v80, v80, v82
    buffer_load_dwordx4 v17, s[44:47], s65 offen offset:1024 lds
    v_add_f32 v81, v81, v83
    s_nop 1
    v_permlane16_swap_b32 v80, v81
    v_add_f32 v80, v80, v81
    s_mov_b32 exec_lo, 0xf000f000
    s_mov_b32 exec_hi, 0xf000f000
    v_mov_b32 v80, s70
    s_mov_b64 exec, -1
    s_waitcnt vmcnt(10)
    s_waitcnt lgkmcnt(0)
    s_barrier
    s_bfe_u32 s64, s95, 262168
    s_lshl_b32 s64, s64, 7
    s_xor_b32 s64, s64, s66
    s_mul_i32 s65, s64, 3072
    s_add_u32 m0, s30, 81920
    s_nop 0
    buffer_load_dwordx4 v8, s[40:43], s64 offen offset:0 lds
    buffer_load_dwordx4 v9, s[40:43], s64 offen offset:1024 lds
    buffer_load_dwordx4 v10, s[40:43], s64 offen offset:2048 lds
    buffer_load_dwordx4 v11, s[40:43], s64 offen offset:3072 lds
    s_add_u32 m0, s31, 81920
    s_nop 0
    buffer_load_dwordx4 v12, s[44:47], s65 offen offset:0 lds
    buffer_load_dwordx4 v13, s[44:47], s65 offen offset:1024 lds
    s_add_u32 m0, s31, 90112
    s_nop 0
    buffer_load_dwordx4 v14, s[44:47], s65 offen offset:0 lds
    buffer_load_dwordx4 v15, s[44:47], s65 offen offset:1024 lds
    s_add_u32 m0, s31, 98304
    s_nop 0
    buffer_load_dwordx4 v16, s[44:47], s65 offen offset:0 lds
    buffer_load_dwordx4 v17, s[44:47], s65 offen offset:1024 lds
    s_and_b32 s68, s70, 0x7ff
    s_sub_u32 s68, 2047, s68
    s_lshl_b32 s3, s68, 11
    s_and_b32 s28, s77, 3
    s_lshl_b32 s28, s28, 9
    s_add_u32 s3, s3, s28
    s_lshr_b32 s28, s38, 1
    s_lshl_b32 s28, s28, 8
    s_add_u32 s3, s3, s28
    v_lshrrev_b32 v3, 3, v1
    v_lshlrev_b32 v3, 5, v3
    buffer_load_dwordx4 v[64:67], v3, s[40:43], s3 offen
    buffer_load_dwordx4 v[68:71], v3, s[40:43], s3 offen offset:16
    s_lshr_b32 s3, s68, 1
    s_lshl_b32 s3, s3, 4
    s_and_b32 s28, s68, 1
    s_lshl_b32 s28, s28, 2
    s_add_u32 s3, s3, s28
    v_mov_b32 v3, 0
    buffer_load_dword v116, v3, s[48:51], s3 offen sc1
    s_waitcnt vmcnt(13)
    s_waitcnt lgkmcnt(0)
    s_barrier
    s_bfe_u32 s64, s95, 262172
    s_lshl_b32 s64, s64, 7
    s_xor_b32 s64, s64, s66
    s_mul_i32 s65, s64, 3072
    s_add_u32 m0, s30, 0
    s_nop 0
    buffer_load_dwordx4 v8, s[40:43], s64 offen offset:0 lds
    buffer_load_dwordx4 v9, s[40:43], s64 offen offset:1024 lds
    buffer_load_dwordx4 v10, s[40:43], s64 offen offset:2048 lds
    buffer_load_dwordx4 v11, s[40:43], s64 offen offset:3072 lds
    s_add_u32 m0, s31, 0
    s_nop 0
    buffer_load_dwordx4 v12, s[44:47], s65 offen offset:0 lds
    buffer_load_dwordx4 v13, s[44:47], s65 offen offset:1024 lds
    s_add_u32 m0, s31, 8192
    s_nop 0
    buffer_load_dwordx4 v14, s[44:47], s65 offen offset:0 lds
    buffer_load_dwordx4 v15, s[44:47], s65 offen offset:1024 lds
    s_add_u32 m0, s31, 16384
    s_nop 0
    buffer_load_dwordx4 v16, s[44:47], s65 offen offset:0 lds
    buffer_load_dwordx4 v17, s[44:47], s65 offen offset:1024 lds
    s_or_b32 s3, s2, s38
    s_mov_b32 s28, 16384
    s_cmp_lg_u32 s3, 0
    s_cselect_b32 s3, 268435456, s28
    v_mov_b32 v2, s86
    s_mov_b64 exec, 1
    buffer_store_dword v2, v252, s[48:51], s3 offen sc1
    s_mov_b64 exec, -1
    s_waitcnt vmcnt(14)
    s_waitcnt lgkmcnt(0)
    s_barrier
    s_nop 0
    s_mov_b32 s3, 28672
    buffer_load_dwordx4 v[144:147], v21, s[52:55], s3 offen nt
    s_mov_b32 s3, 35840
    buffer_load_dwordx4 v[148:151], v21, s[52:55], s3 offen nt
    s_mov_b32 s3, 43008
    buffer_load_dwordx4 v[152:155], v21, s[52:55], s3 offen nt
    s_mov_b32 s3, 50176
    buffer_load_dwordx4 v[156:159], v21, s[52:55], s3 offen nt
    s_mov_b32 s3, 57344
    buffer_load_dwordx4 v[160:163], v21, s[52:55], s3 offen nt
    s_mov_b32 s3, 64512
    buffer_load_dwordx4 v[164:167], v21, s[52:55], s3 offen nt
    s_mov_b32 s3, 71680
    buffer_load_dwordx4 v[168:171], v21, s[52:55], s3 offen nt
    s_mov_b32 s3, 78848
    buffer_load_dwordx4 v[172:175], v21, s[52:55], s3 offen nt
    ds_write_b32 v233, v80
    s_lshl_b32 s3, s38, 4
    s_lshl_b64 exec, 0xffff, s3
    ds_write_b64 v230, v[224:225]
    ds_write_b64 v230, v[226:227] offset:1024
    ds_write_b64 v230, v[228:229] offset:2048
    ds_write_b32 v231, v236
    s_mov_b64 exec, -1
    s_waitcnt vmcnt(19)
    v_and_b32 v5, 0xffff0000, v116
    v_lshlrev_b32 v116, 16, v116
    v_rcp_f32 v117, v5
    v_lshlrev_b32 v96, 16, v64
    v_and_b32 v97, 0xffff0000, v64
    v_lshlrev_b32 v98, 16, v65
    v_and_b32 v99, 0xffff0000, v65
    v_lshlrev_b32 v100, 16, v66
    v_and_b32 v101, 0xffff0000, v66
    v_lshlrev_b32 v102, 16, v67
    v_and_b32 v103, 0xffff0000, v67
    v_lshlrev_b32 v104, 16, v68
    v_and_b32 v105, 0xffff0000, v68
    v_lshlrev_b32 v106, 16, v69
    v_and_b32 v107, 0xffff0000, v69
    v_lshlrev_b32 v108, 16, v70
    v_and_b32 v109, 0xffff0000, v70
    v_lshlrev_b32 v110, 16, v71
    v_and_b32 v111, 0xffff0000, v71
    v_mul_f32 v119, v116, v117
    v_fma_f32 v96, v96, v117, -v119
    v_fma_f32 v97, v97, v117, -v119
    v_fma_f32 v98, v98, v117, -v119
    v_fma_f32 v99, v99, v117, -v119
    v_fma_f32 v100, v100, v117, -v119
    v_fma_f32 v101, v101, v117, -v119
    v_fma_f32 v102, v102, v117, -v119
    v_fma_f32 v103, v103, v117, -v119
    v_fma_f32 v104, v104, v117, -v119
    v_fma_f32 v105, v105, v117, -v119
    v_fma_f32 v106, v106, v117, -v119
    v_fma_f32 v107, v107, v117, -v119
    v_fma_f32 v108, v108, v117, -v119
    v_fma_f32 v109, v109, v117, -v119
    v_fma_f32 v110, v110, v117, -v119
    v_fma_f32 v111, v111, v117, -v119
    v_mov_b32 v120, 0
    v_mov_b32 v121, 0
    v_mov_b32 v122, 0
    v_mov_b32 v123, 0
    v_mov_b32 v124, 0
    v_mov_b32 v125, 0
    v_mov_b32 v126, 0
    v_mov_b32 v127, 0
    s_waitcnt vmcnt(9)
    s_waitcnt lgkmcnt(0)
    s_barrier
    v_lshlrev_b32 v2, 16, v128
    v_and_b32 v3, 0xffff0000, v128
    v_fmac_f32 v120, v2, v96
    v_fmac_f32 v121, v3, v96
    v_lshlrev_b32 v4, 16, v129
    v_and_b32 v5, 0xffff0000, v129
    v_fmac_f32 v122, v4, v96
    v_fmac_f32 v123, v5, v96
    v_lshlrev_b32 v2, 16, v130
    v_and_b32 v3, 0xffff0000, v130
    v_fmac_f32 v124, v2, v96
    v_fmac_f32 v125, v3, v96
    v_lshlrev_b32 v4, 16, v131
    v_and_b32 v5, 0xffff0000, v131
    v_fmac_f32 v126, v4, v96
    v_fmac_f32 v127, v5, v96
    v_lshlrev_b32 v2, 16, v132
    v_and_b32 v3, 0xffff0000, v132
    v_fmac_f32 v120, v2, v97
    v_fmac_f32 v121, v3, v97
    v_lshlrev_b32 v4, 16, v133
    v_and_b32 v5, 0xffff0000, v133
    v_fmac_f32 v122, v4, v97
    v_fmac_f32 v123, v5, v97
    v_lshlrev_b32 v2, 16, v134
    v_and_b32 v3, 0xffff0000, v134
    v_fmac_f32 v124, v2, v97
    v_fmac_f32 v125, v3, v97
    v_lshlrev_b32 v4, 16, v135
    v_and_b32 v5, 0xffff0000, v135
    v_fmac_f32 v126, v4, v97
    v_fmac_f32 v127, v5, v97
    v_lshlrev_b32 v2, 16, v136
    v_and_b32 v3, 0xffff0000, v136
    v_fmac_f32 v120, v2, v98
    v_fmac_f32 v121, v3, v98
    v_lshlrev_b32 v4, 16, v137
    v_and_b32 v5, 0xffff0000, v137
    v_fmac_f32 v122, v4, v98
    v_fmac_f32 v123, v5, v98
    v_lshlrev_b32 v2, 16, v138
    v_and_b32 v3, 0xffff0000, v138
    v_fmac_f32 v124, v2, v98
    v_fmac_f32 v125, v3, v98
    v_lshlrev_b32 v4, 16, v139
    v_and_b32 v5, 0xffff0000, v139
    v_fmac_f32 v126, v4, v98
    v_fmac_f32 v127, v5, v98
    v_lshlrev_b32 v2, 16, v140
    v_and_b32 v3, 0xffff0000, v140
    v_fmac_f32 v120, v2, v99
    v_fmac_f32 v121, v3, v99
    v_lshlrev_b32 v4, 16, v141
    v_and_b32 v5, 0xffff0000, v141
    v_fmac_f32 v122, v4, v99
    v_fmac_f32 v123, v5, v99
    v_lshlrev_b32 v2, 16, v142
    v_and_b32 v3, 0xffff0000, v142
    v_fmac_f32 v124, v2, v99
    v_fmac_f32 v125, v3, v99
    v_lshlrev_b32 v4, 16, v143
    v_and_b32 v5, 0xffff0000, v143
    v_fmac_f32 v126, v4, v99
    v_fmac_f32 v127, v5, v99
    s_waitcnt lgkmcnt(0)
    s_barrier
    v_and_b32 v2, 15, v1
    v_min_u32 v2, 13, v2
    v_lshrrev_b32 v3, 4, v1
    v_mul_u32_u24 v3, 14336, v3
    v_lshl_add_u32 v13, v2, 4, v3
    s_lshl_b32 s75, s71, 2
    s_add_u32 s75, s75, 1183744
    s_add_u32 m0, s72, 0
    s_add_u32 s3, s73, 0
    s_nop 0
    buffer_load_dwordx4 v220, s[88:91], s3 offen offset:0 lds
    buffer_load_dwordx4 v221, s[88:91], s3 offen offset:1024 lds
    buffer_load_dwordx4 v222, s[88:91], s3 offen offset:2048 lds
    buffer_load_dwordx4 v223, s[88:91], s3 offen offset:3072 lds
    s_add_u32 m0, s72, 16384
    s_add_u32 s3, s73, 262144
    buffer_load_dwordx4 v220, s[88:91], s3 offen offset:0 lds
    buffer_load_dwordx4 v221, s[88:91], s3 offen offset:1024 lds
    buffer_load_dwordx4 v222, s[88:91], s3 offen offset:2048 lds
    buffer_load_dwordx4 v223, s[88:91], s3 offen offset:3072 lds
    s_add_u32 m0, s72, 65536
    s_add_u32 s3, s73, 1048576
    buffer_load_dwordx4 v220, s[88:91], s3 offen offset:0 lds
    buffer_load_dwordx4 v221, s[88:91], s3 offen offset:1024 lds
    buffer_load_dwordx4 v222, s[88:91], s3 offen offset:2048 lds
    buffer_load_dwordx4 v223, s[88:91], s3 offen offset:3072 lds
    s_mov_b32 s3, 86016
    buffer_load_dwordx4 v[176:179], v21, s[52:55], s3 offen nt
    s_mov_b32 s3, 93184
    buffer_load_dwordx4 v[180:183], v21, s[52:55], s3 offen nt
    s_mov_b32 s3, 100352
    buffer_load_dwordx4 v[184:187], v21, s[52:55], s3 offen nt
    s_mov_b32 s3, 107520
    buffer_load_dwordx4 v[188:191], v21, s[52:55], s3 offen nt
    s_lshr_b32 s3, s71, 3
    s_add_u32 s3, s3, 0
    s_and_b32 s28, s3, 7
    s_lshr_b32 s3, s3, 3
    s_lshl_b32 s3, s3, 6
    s_add_u32 s3, s3, s28
    s_lshl_b32 s3, s3, 11
    buffer_load_dwordx4 v[192:195], v22, s[56:59], s3 offen nt
    s_lshr_b32 s3, s71, 3
    s_add_u32 s3, s3, 1
    s_and_b32 s28, s3, 7
    s_lshr_b32 s3, s3, 3
    s_lshl_b32 s3, s3, 6
    s_add_u32 s3, s3, s28
    s_lshl_b32 s3, s3, 11
    buffer_load_dwordx4 v[196:199], v22, s[56:59], s3 offen nt
    s_lshr_b32 s3, s71, 3
    s_add_u32 s3, s3, 2
    s_and_b32 s28, s3, 7
    s_lshr_b32 s3, s3, 3
    s_lshl_b32 s3, s3, 6
    s_add_u32 s3, s3, s28
    s_lshl_b32 s3, s3, 11
    buffer_load_dwordx4 v[200:203], v22, s[56:59], s3 offen nt
    s_waitcnt vmcnt(19)
    v_lshlrev_b32_e64 v2, 16, v144
    v_and_b32 v3, 0xffff0000, v144
    v_pk_fma_f32 v[120:121], v[2:3], v[100:101], v[120:121] op_sel_hi:[1,0,1]
    v_lshlrev_b32_e64 v4, 16, v145
    v_and_b32 v5, 0xffff0000, v145
    v_pk_fma_f32 v[122:123], v[4:5], v[100:101], v[122:123] op_sel_hi:[1,0,1]
    v_lshlrev_b32_e64 v2, 16, v146
    v_and_b32 v3, 0xffff0000, v146
    v_pk_fma_f32 v[124:125], v[2:3], v[100:101], v[124:125] op_sel_hi:[1,0,1]
    v_lshlrev_b32_e64 v4, 16, v147
    v_and_b32 v5, 0xffff0000, v147
    v_pk_fma_f32 v[126:127], v[4:5], v[100:101], v[126:127] op_sel_hi:[1,0,1]
    v_lshlrev_b32 v2, 16, v148
    v_and_b32 v3, 0xffff0000, v148
    v_mov_b32 v100, v101
    v_pk_fma_f32 v[120:121], v[2:3], v[100:101], v[120:121] op_sel_hi:[1,0,1]
    v_lshlrev_b32_e64 v4, 16, v149
    v_and_b32 v5, 0xffff0000, v149
    v_pk_fma_f32 v[122:123], v[4:5], v[100:101], v[122:123] op_sel_hi:[1,0,1]
    v_lshlrev_b32_e64 v2, 16, v150
    v_and_b32 v3, 0xffff0000, v150
    v_pk_fma_f32 v[124:125], v[2:3], v[100:101], v[124:125] op_sel_hi:[1,0,1]
    v_lshlrev_b32_e64 v4, 16, v151
    v_and_b32 v5, 0xffff0000, v151
    v_pk_fma_f32 v[126:127], v[4:5], v[100:101], v[126:127] op_sel_hi:[1,0,1]
    v_lshlrev_b32_e64 v2, 16, v152
    v_and_b32 v3, 0xffff0000, v152
    v_pk_fma_f32 v[120:121], v[2:3], v[102:103], v[120:121] op_sel_hi:[1,0,1]
    v_lshlrev_b32_e64 v4, 16, v153
    v_and_b32 v5, 0xffff0000, v153
    v_pk_fma_f32 v[122:123], v[4:5], v[102:103], v[122:123] op_sel_hi:[1,0,1]
    v_lshlrev_b32_e64 v2, 16, v154
    v_and_b32 v3, 0xffff0000, v154
    v_pk_fma_f32 v[124:125], v[2:3], v[102:103], v[124:125] op_sel_hi:[1,0,1]
    v_lshlrev_b32_e64 v4, 16, v155
    v_and_b32 v5, 0xffff0000, v155
    v_pk_fma_f32 v[126:127], v[4:5], v[102:103], v[126:127] op_sel_hi:[1,0,1]
    v_lshlrev_b32 v2, 16, v156
    v_and_b32 v3, 0xffff0000, v156
    v_mov_b32 v102, v103
    v_pk_fma_f32 v[120:121], v[2:3], v[102:103], v[120:121] op_sel_hi:[1,0,1]
    v_lshlrev_b32_e64 v4, 16, v157
    v_and_b32 v5, 0xffff0000, v157
    v_pk_fma_f32 v[122:123], v[4:5], v[102:103], v[122:123] op_sel_hi:[1,0,1]
    v_lshlrev_b32_e64 v2, 16, v158
    v_and_b32 v3, 0xffff0000, v158
    v_pk_fma_f32 v[124:125], v[2:3], v[102:103], v[124:125] op_sel_hi:[1,0,1]
    v_lshlrev_b32_e64 v4, 16, v159
    v_and_b32 v5, 0xffff0000, v159
    v_pk_fma_f32 v[126:127], v[4:5], v[102:103], v[126:127] op_sel_hi:[1,0,1]
    v_lshlrev_b32_e64 v2, 16, v160
    v_and_b32 v3, 0xffff0000, v160
    v_pk_fma_f32 v[120:121], v[2:3], v[104:105], v[120:121] op_sel_hi:[1,0,1]
    v_lshlrev_b32_e64 v4, 16, v161
    v_and_b32 v5, 0xffff0000, v161
    v_pk_fma_f32 v[122:123], v[4:5], v[104:105], v[122:123] op_sel_hi:[1,0,1]
    v_lshlrev_b32_e64 v2, 16, v162
    v_and_b32 v3, 0xffff0000, v162
    v_pk_fma_f32 v[124:125], v[2:3], v[104:105], v[124:125] op_sel_hi:[1,0,1]
    v_lshlrev_b32_e64 v4, 16, v163
    v_and_b32 v5, 0xffff0000, v163
    v_pk_fma_f32 v[126:127], v[4:5], v[104:105], v[126:127] op_sel_hi:[1,0,1]
    v_lshlrev_b32 v2, 16, v164
    v_and_b32 v3, 0xffff0000, v164
    v_mov_b32 v104, v105
    v_pk_fma_f32 v[120:121], v[2:3], v[104:105], v[120:121] op_sel_hi:[1,0,1]
    v_lshlrev_b32_e64 v4, 16, v165
    v_and_b32 v5, 0xffff0000, v165
    v_pk_fma_f32 v[122:123], v[4:5], v[104:105], v[122:123] op_sel_hi:[1,0,1]
    v_lshlrev_b32_e64 v2, 16, v166
    v_and_b32 v3, 0xffff0000, v166
    v_pk_fma_f32 v[124:125], v[2:3], v[104:105], v[124:125] op_sel_hi:[1,0,1]
    v_lshlrev_b32_e64 v4, 16, v167
    v_and_b32 v5, 0xffff0000, v167
    v_pk_fma_f32 v[126:127], v[4:5], v[104:105], v[126:127] op_sel_hi:[1,0,1]
    v_lshlrev_b32_e64 v2, 16, v168
    v_and_b32 v3, 0xffff0000, v168
    v_pk_fma_f32 v[120:121], v[2:3], v[106:107], v[120:121] op_sel_hi:[1,0,1]
    v_lshlrev_b32_e64 v4, 16, v169
    v_and_b32 v5, 0xffff0000, v169
    v_pk_fma_f32 v[122:123], v[4:5], v[106:107], v[122:123] op_sel_hi:[1,0,1]
    v_lshlrev_b32_e64 v2, 16, v170
    v_and_b32 v3, 0xffff0000, v170
    v_pk_fma_f32 v[124:125], v[2:3], v[106:107], v[124:125] op_sel_hi:[1,0,1]
    v_lshlrev_b32_e64 v4, 16, v171
    v_and_b32 v5, 0xffff0000, v171
    v_pk_fma_f32 v[126:127], v[4:5], v[106:107], v[126:127] op_sel_hi:[1,0,1]
    v_lshlrev_b32 v2, 16, v172
    v_and_b32 v3, 0xffff0000, v172
    v_mov_b32 v106, v107
    v_pk_fma_f32 v[120:121], v[2:3], v[106:107], v[120:121] op_sel_hi:[1,0,1]
    v_lshlrev_b32_e64 v4, 16, v173
    v_and_b32 v5, 0xffff0000, v173
    v_pk_fma_f32 v[122:123], v[4:5], v[106:107], v[122:123] op_sel_hi:[1,0,1]
    v_lshlrev_b32_e64 v2, 16, v174
    v_and_b32 v3, 0xffff0000, v174
    v_pk_fma_f32 v[124:125], v[2:3], v[106:107], v[124:125] op_sel_hi:[1,0,1]
    v_lshlrev_b32_e64 v4, 16, v175
    v_and_b32 v5, 0xffff0000, v175
    v_pk_fma_f32 v[126:127], v[4:5], v[106:107], v[126:127] op_sel_hi:[1,0,1]
    s_waitcnt vmcnt(15)
    s_waitcnt vmcnt(11)
    s_waitcnt vmcnt(7)
    s_barrier
    s_add_u32 m0, s72, 32768
    s_add_u32 s3, s73, 524288
    buffer_load_dwordx4 v220, s[88:91], s3 offen offset:0 lds
    buffer_load_dwordx4 v221, s[88:91], s3 offen offset:1024 lds
    buffer_load_dwordx4 v222, s[88:91], s3 offen offset:2048 lds
    buffer_load_dwordx4 v223, s[88:91], s3 offen offset:3072 lds
    s_add_u32 m0, s72, 49152
    s_add_u32 s3, s73, 786432
    buffer_load_dwordx4 v220, s[88:91], s3 offen offset:0 lds
    buffer_load_dwordx4 v221, s[88:91], s3 offen offset:1024 lds
    buffer_load_dwordx4 v222, s[88:91], s3 offen offset:2048 lds
    buffer_load_dwordx4 v223, s[88:91], s3 offen offset:3072 lds
    s_add_u32 m0, s72, 81920
    s_add_u32 s3, s73, 1310720
    buffer_load_dwordx4 v220, s[88:91], s3 offen offset:0 lds
    buffer_load_dwordx4 v221, s[88:91], s3 offen offset:1024 lds
    buffer_load_dwordx4 v222, s[88:91], s3 offen offset:2048 lds
    buffer_load_dwordx4 v223, s[88:91], s3 offen offset:3072 lds
    s_setprio 3
    s_cmp_lg_u32 s38, 3
    s_cbranch_scc1 L_npl
    s_mov_b32 s3, 32768
    s_mov_b32 s29, 0
    s_mov_b32 exec_lo, -1
    s_mov_b32 exec_hi, 65535
L_rp:
    buffer_load_dword v118, v113, s[48:51], s3 offen sc1
    s_waitcnt vmcnt(0)
    v_cmp_ne_u32 vcc, s86, v118
    s_cbranch_vccz L_rpk
    s_mov_b64 exec, vcc
    s_add_u32 s29, s29, 1
    s_cmp_lt_u32 s29, 200000
    s_cbranch_scc1 L_rp
L_rpk:
    s_mov_b64 exec, -1
    v_mov_b32 v4, 162128
    v_mov_b32 v5, 1
    ds_write_b32 v4, v5
L_npl:
    v_min_u32 v3, 4, v1
    v_lshlrev_b32_e64 v3, 2, v3
    v_add_u32 v3, 162112, v3
L_fw:
    ds_read_b32 v4, v3
    s_waitcnt lgkmcnt(0)
    v_cmp_eq_u32 vcc, 0, v4
    s_cbranch_vccz L_fk
    s_sleep 1
    s_branch L_fw
L_fk:
    s_waitcnt vmcnt(15)
    v_lshlrev_b32_e64 v2, 16, v176
    v_and_b32 v3, 0xffff0000, v176
    v_pk_fma_f32 v[120:121], v[2:3], v[108:109], v[120:121] op_sel_hi:[1,0,1]
    v_lshlrev_b32_e64 v4, 16, v177
    v_and_b32 v5, 0xffff0000, v177
    v_pk_fma_f32 v[122:123], v[4:5], v[108:109], v[122:123] op_sel_hi:[1,0,1]
    v_lshlrev_b32_e64 v2, 16, v178
    v_and_b32 v3, 0xffff0000, v178
    v_pk_fma_f32 v[124:125], v[2:3], v[108:109], v[124:125] op_sel_hi:[1,0,1]
    v_lshlrev_b32_e64 v4, 16, v179
    v_and_b32 v5, 0xffff0000, v179
    v_pk_fma_f32 v[126:127], v[4:5], v[108:109], v[126:127] op_sel_hi:[1,0,1]
    v_lshlrev_b32 v2, 16, v180
    v_and_b32 v3, 0xffff0000, v180
    v_mov_b32 v108, v109
    v_pk_fma_f32 v[120:121], v[2:3], v[108:109], v[120:121] op_sel_hi:[1,0,1]
    v_lshlrev_b32_e64 v4, 16, v181
    v_and_b32 v5, 0xffff0000, v181
    v_pk_fma_f32 v[122:123], v[4:5], v[108:109], v[122:123] op_sel_hi:[1,0,1]
    v_lshlrev_b32_e64 v2, 16, v182
    v_and_b32 v3, 0xffff0000, v182
    v_pk_fma_f32 v[124:125], v[2:3], v[108:109], v[124:125] op_sel_hi:[1,0,1]
    v_lshlrev_b32_e64 v4, 16, v183
    v_and_b32 v5, 0xffff0000, v183
    v_pk_fma_f32 v[126:127], v[4:5], v[108:109], v[126:127] op_sel_hi:[1,0,1]
    s_add_u32 s3, s76, 0
    buffer_load_dwordx4 v[48:51], v112, s[48:51], s3 offen sc1
    s_add_u32 s3, s76, 33792
    buffer_load_dwordx4 v[52:55], v112, s[48:51], s3 offen sc1
    s_cmp_lg_u32 s83, 0
    s_cbranch_scc1 L_nz
    s_add_u32 s3, s81, 0
    buffer_load_dwordx4 v[32:35], v112, s[48:51], s3 offen sc1
    s_add_u32 s3, s81, 33792
    buffer_load_dwordx4 v[36:39], v112, s[48:51], s3 offen sc1
L_nz:
    v_lshlrev_b32_e64 v2, 16, v184
    v_and_b32 v3, 0xffff0000, v184
    v_pk_fma_f32 v[120:121], v[2:3], v[110:111], v[120:121] op_sel_hi:[1,0,1]
    v_lshlrev_b32_e64 v4, 16, v185
    v_and_b32 v5, 0xffff0000, v185
    v_pk_fma_f32 v[122:123], v[4:5], v[110:111], v[122:123] op_sel_hi:[1,0,1]
    v_lshlrev_b32_e64 v2, 16, v186
    v_and_b32 v3, 0xffff0000, v186
    v_pk_fma_f32 v[124:125], v[2:3], v[110:111], v[124:125] op_sel_hi:[1,0,1]
    v_lshlrev_b32_e64 v4, 16, v187
    v_and_b32 v5, 0xffff0000, v187
    v_pk_fma_f32 v[126:127], v[4:5], v[110:111], v[126:127] op_sel_hi:[1,0,1]
    v_lshlrev_b32 v2, 16, v188
    v_and_b32 v3, 0xffff0000, v188
    v_mov_b32 v110, v111
    v_pk_fma_f32 v[120:121], v[2:3], v[110:111], v[120:121] op_sel_hi:[1,0,1]
    v_lshlrev_b32_e64 v4, 16, v189
    v_and_b32 v5, 0xffff0000, v189
    v_pk_fma_f32 v[122:123], v[4:5], v[110:111], v[122:123] op_sel_hi:[1,0,1]
    v_lshlrev_b32_e64 v2, 16, v190
    v_and_b32 v3, 0xffff0000, v190
    v_pk_fma_f32 v[124:125], v[2:3], v[110:111], v[124:125] op_sel_hi:[1,0,1]
    v_lshlrev_b32_e64 v4, 16, v191
    v_and_b32 v5, 0xffff0000, v191
    v_pk_fma_f32 v[126:127], v[4:5], v[110:111], v[126:127] op_sel_hi:[1,0,1]
    v_permlane32_swap_b32 v120, v124
    v_permlane32_swap_b32 v121, v125
    v_permlane32_swap_b32 v122, v126
    v_permlane32_swap_b32 v123, v127
    v_add_f32 v120, v120, v124
    v_add_f32 v121, v121, v125
    v_add_f32 v122, v122, v126
    v_add_f32 v123, v123, v127
    s_nop 0
    v_permlane16_swap_b32 v120, v122
    v_permlane16_swap_b32 v121, v123
    v_add_f32 v120, v120, v122
    v_add_f32 v121, v121, v123
    s_nop 0
    v_add_f32 v120, v120, v120 row_ror:8 row_mask:0xf bank_mask:0xf
    v_add_f32 v121, v121, v121 row_ror:8 row_mask:0xf bank_mask:0xf
    v_and_b32 v2, 8, v1
    v_cmp_eq_u32 vcc, 0, v2
    s_nop 1
    v_cndmask_b32 v120, v121, v120, vcc
    buffer_store_dword v120, v253, s[48:51], s84 offen sc1
    s_lshr_b32 s3, s71, 3
    s_add_u32 s3, s3, 3
    s_and_b32 s28, s3, 7
    s_lshr_b32 s3, s3, 3
    s_lshl_b32 s3, s3, 6
    s_add_u32 s3, s3, s28
    s_lshl_b32 s3, s3, 11
    buffer_load_dwordx4 v[204:207], v22, s[56:59], s3 offen nt
    s_lshr_b32 s3, s71, 3
    s_add_u32 s3, s3, 4
    s_and_b32 s28, s3, 7
    s_lshr_b32 s3, s3, 3
    s_lshl_b32 s3, s3, 6
    s_add_u32 s3, s3, s28
    s_lshl_b32 s3, s3, 11
    buffer_load_dwordx4 v[208:211], v22, s[56:59], s3 offen nt
    s_lshr_b32 s3, s71, 3
    s_add_u32 s3, s3, 5
    s_and_b32 s28, s3, 7
    s_lshr_b32 s3, s3, 3
    s_lshl_b32 s3, s3, 6
    s_add_u32 s3, s3, s28
    s_lshl_b32 s3, s3, 11
    buffer_load_dwordx4 v[212:215], v22, s[56:59], s3 offen nt
    s_lshr_b32 s3, s71, 3
    s_add_u32 s3, s3, 6
    s_and_b32 s28, s3, 7
    s_lshr_b32 s3, s3, 3
    s_lshl_b32 s3, s3, 6
    s_add_u32 s3, s3, s28
    s_lshl_b32 s3, s3, 11
    buffer_load_dwordx4 v[216:219], v22, s[56:59], s3 offen nt
    s_waitcnt vmcnt(5)
    s_cmp_eq_u32 s83, 0
    s_cbranch_scc1 L_hz
    s_mov_b32 s29, 0
L_k4:
    v_max3_u32 v2, v48, v49, v50
    v_max3_u32 v2, v2, v51, v52
    v_max3_u32 v2, v2, v53, v54
    v_max_u32 v2, v2, v55
    v_cmp_eq_u32 vcc, -1, v2
    s_cbranch_vccz L_k4k
    s_add_u32 s29, s29, 1
    s_cmp_ge_u32 s29, 200000
    s_cbranch_scc1 L_k4k
    s_sleep 1
    s_add_u32 s3, s76, 0
    buffer_load_dwordx4 v[48:51], v112, s[48:51], s3 offen sc1
    s_add_u32 s3, s76, 33792
    buffer_load_dwordx4 v[52:55], v112, s[48:51], s3 offen sc1
    s_waitcnt vmcnt(0)
    s_branch L_k4
L_k4k:
    v_lshlrev_b32 v64, 16, v48
    v_and_b32 v65, 0xffff0000, v48
    v_lshlrev_b32 v66, 16, v49
    v_and_b32 v67, 0xffff0000, v49
    v_lshlrev_b32 v68, 16, v50
    v_and_b32 v69, 0xffff0000, v50
    v_lshlrev_b32 v70, 16, v51
    v_and_b32 v71, 0xffff0000, v51
    v_lshlrev_b32 v72, 16, v52
    v_and_b32 v73, 0xffff0000, v52
    v_pk_add_f32 v[64:65], v[64:65], v[72:73]
    v_lshlrev_b32_e64 v74, 16, v53
    v_and_b32 v75, 0xffff0000, v53
    v_pk_add_f32 v[66:67], v[66:67], v[74:75]
    v_lshlrev_b32_e64 v76, 16, v54
    v_and_b32 v77, 0xffff0000, v54
    v_pk_add_f32 v[68:69], v[68:69], v[76:77]
    v_lshlrev_b32_e64 v78, 16, v55
    v_and_b32 v79, 0xffff0000, v55
    v_pk_add_f32 v[70:71], v[70:71], v[78:79]
    v_permlane32_swap_b32 v64, v68
    v_permlane32_swap_b32 v65, v69
    v_permlane32_swap_b32 v66, v70
    v_permlane32_swap_b32 v67, v71
    v_add_f32 v64, v64, v68
    v_add_f32 v65, v65, v69
    v_add_f32 v66, v66, v70
    v_add_f32 v67, v67, v71
    s_nop 0
    v_permlane16_swap_b32 v64, v66
    v_permlane16_swap_b32 v65, v67
    v_add_f32 v64, v64, v66
    v_add_f32 v65, v65, v67
    s_nop 0
    v_add_f32 v64, v64, v64 row_ror:8 row_mask:0xf bank_mask:0xf
    v_add_f32 v65, v65, v65 row_ror:8 row_mask:0xf bank_mask:0xf
    v_cvt_pk_bf16_f32 v64, v64, v65
    v_mov_b32 v65, v64
    s_nop 1
    v_permlane16_swap_b32 v64, v65
    v_mov_b32 v66, v64
    v_mov_b32 v67, v65
    s_nop 0
    v_permlane32_swap_b32 v64, v66
    v_permlane32_swap_b32 v65, v67
    s_mov_b64 exec, 0xff
    buffer_store_dwordx4 v[64:67], v252, s[48:51], s74 offen sc1
    s_branch L_h1e
L_hz:
    s_mov_b32 s29, 0
L_k3:
    v_max3_u32 v2, v48, v49, v50
    v_max3_u32 v2, v2, v51, v52
    v_max3_u32 v2, v2, v53, v54
    v_max3_u32 v2, v2, v55, v32
    v_max3_u32 v2, v2, v33, v34
    v_max3_u32 v2, v2, v35, v36
    v_max3_u32 v2, v2, v37, v38
    v_max_u32 v2, v2, v39
    v_cmp_eq_u32 vcc, -1, v2
    s_cbranch_vccz L_k3k
    s_add_u32 s29, s29, 1
    s_cmp_ge_u32 s29, 200000
    s_cbranch_scc1 L_k3k
    s_sleep 1
    s_add_u32 s3, s76, 0
    buffer_load_dwordx4 v[48:51], v112, s[48:51], s3 offen sc1
    s_add_u32 s3, s76, 33792
    buffer_load_dwordx4 v[52:55], v112, s[48:51], s3 offen sc1
    s_add_u32 s3, s81, 0
    buffer_load_dwordx4 v[32:35], v112, s[48:51], s3 offen sc1
    s_add_u32 s3, s81, 33792
    buffer_load_dwordx4 v[36:39], v112, s[48:51], s3 offen sc1
    s_waitcnt vmcnt(0)
    s_branch L_k3
L_k3k:
    v_lshlrev_b32 v64, 16, v48
    v_lshlrev_b32 v96, 16, v32
    v_and_b32 v65, 0xffff0000, v48
    v_and_b32 v97, 0xffff0000, v32
    v_lshlrev_b32 v66, 16, v49
    v_lshlrev_b32 v98, 16, v33
    v_and_b32 v67, 0xffff0000, v49
    v_and_b32 v99, 0xffff0000, v33
    v_lshlrev_b32 v68, 16, v50
    v_lshlrev_b32 v100, 16, v34
    v_and_b32 v69, 0xffff0000, v50
    v_and_b32 v101, 0xffff0000, v34
    v_lshlrev_b32 v70, 16, v51
    v_lshlrev_b32 v102, 16, v35
    v_and_b32 v71, 0xffff0000, v51
    v_and_b32 v103, 0xffff0000, v35
    v_lshlrev_b32 v72, 16, v52
    v_lshlrev_b32 v104, 16, v36
    v_and_b32 v73, 0xffff0000, v52
    v_and_b32 v105, 0xffff0000, v36
    v_pk_add_f32 v[64:65], v[64:65], v[72:73]
    v_pk_add_f32 v[96:97], v[96:97], v[104:105]
    v_lshlrev_b32 v74, 16, v53
    v_lshlrev_b32 v106, 16, v37
    v_and_b32 v75, 0xffff0000, v53
    v_and_b32 v107, 0xffff0000, v37
    v_pk_add_f32 v[66:67], v[66:67], v[74:75]
    v_pk_add_f32 v[98:99], v[98:99], v[106:107]
    v_lshlrev_b32 v76, 16, v54
    v_lshlrev_b32 v108, 16, v38
    v_and_b32 v77, 0xffff0000, v54
    v_and_b32 v109, 0xffff0000, v38
    v_pk_add_f32 v[68:69], v[68:69], v[76:77]
    v_pk_add_f32 v[100:101], v[100:101], v[108:109]
    v_lshlrev_b32 v78, 16, v55
    v_lshlrev_b32 v110, 16, v39
    v_and_b32 v79, 0xffff0000, v55
    v_and_b32 v111, 0xffff0000, v39
    v_pk_add_f32 v[70:71], v[70:71], v[78:79]
    v_pk_add_f32 v[102:103], v[102:103], v[110:111]
    v_permlane32_swap_b32 v64, v68
    v_permlane32_swap_b32 v96, v100
    v_permlane32_swap_b32 v65, v69
    v_permlane32_swap_b32 v97, v101
    v_permlane32_swap_b32 v66, v70
    v_permlane32_swap_b32 v98, v102
    v_permlane32_swap_b32 v67, v71
    v_permlane32_swap_b32 v99, v103
    v_add_f32 v64, v64, v68
    v_add_f32 v96, v96, v100
    v_add_f32 v65, v65, v69
    v_add_f32 v97, v97, v101
    v_add_f32 v66, v66, v70
    v_add_f32 v98, v98, v102
    v_add_f32 v67, v67, v71
    v_add_f32 v99, v99, v103
    v_permlane16_swap_b32 v64, v66
    v_permlane16_swap_b32 v96, v98
    v_permlane16_swap_b32 v65, v67
    v_permlane16_swap_b32 v97, v99
    v_add_f32 v64, v64, v66
    v_add_f32 v96, v96, v98
    v_add_f32 v65, v65, v67
    v_add_f32 v97, v97, v99
    v_add_f32 v64, v64, v64 row_ror:8 row_mask:0xf bank_mask:0xf
    v_add_f32 v96, v96, v96 row_ror:8 row_mask:0xf bank_mask:0xf
    v_add_f32 v65, v65, v65 row_ror:8 row_mask:0xf bank_mask:0xf
    v_add_f32 v97, v97, v97 row_ror:8 row_mask:0xf bank_mask:0xf
    v_cvt_pk_bf16_f32 v64, v64, v65
    v_cvt_pk_bf16_f32 v96, v96, v97
    v_mov_b32 v65, v64
    v_mov_b32 v97, v96
    s_nop 0
    v_permlane16_swap_b32 v64, v65
    v_permlane16_swap_b32 v96, v97
    v_mov_b32 v66, v64
    v_mov_b32 v98, v96
    v_mov_b32 v67, v65
    v_mov_b32 v99, v97
    v_permlane32_swap_b32 v64, v66
    v_permlane32_swap_b32 v96, v98
    v_permlane32_swap_b32 v65, v67
    v_permlane32_swap_b32_e64 v97, v99
    s_mov_b64 exec, 0xff
    buffer_store_dwordx4 v[64:67], v252, s[48:51], s74 offen sc1
    buffer_store_dwordx4 v[96:99], v252, s[48:51], s82 offen sc1
L_h1e:
    s_mov_b64 exec, -1
    s_lshl_b32 s3, s38, 2
    s_add_u32 s3, s3, 162112
    v_mov_b32 v4, s3
    v_mov_b32 v5, 3
    ds_write_b32 v4, v5
    s_setprio 0
    v_and_b32 v2, 15, v1
    v_add_u32 v2, s69, v2
    v_lshlrev_b32 v2, 2, v2
    v_add_u32 v2, 152064, v2
    ds_read_b32 v9, v2
    ds_read_b32 v8, v2 offset:1024
    s_waitcnt lgkmcnt(0)
    v_mul_f32 v28, v9, v8
    v_mov_b32 v30, 0xbfb8aa3b
    v_lshlrev_b32 v224, 16, v240
    v_and_b32 v225, 0xffff0000, v240
    v_lshlrev_b32 v226, 16, v241
    v_and_b32 v227, 0xffff0000, v241
    v_lshlrev_b32 v228, 16, v242
    v_and_b32 v229, 0xffff0000, v242
    v_lshlrev_b32 v230, 16, v243
    v_and_b32 v231, 0xffff0000, v243
    v_lshlrev_b32 v232, 16, v244
    v_and_b32 v233, 0xffff0000, v244
    v_lshlrev_b32 v234, 16, v245
    v_and_b32 v235, 0xffff0000, v245
    v_lshlrev_b32 v236, 16, v246
    v_and_b32 v237, 0xffff0000, v246
    v_lshlrev_b32 v238, 16, v247
    v_and_b32 v239, 0xffff0000, v247
    v_pk_fma_f32 v[224:225], v[224:225], v[8:9], v[28:29] op_sel_hi:[1,0,0] neg_lo:[0,0,1] neg_hi:[0,0,1]
    v_pk_fma_f32 v[226:227], v[226:227], v[8:9], v[28:29] op_sel_hi:[1,0,0] neg_lo:[0,0,1] neg_hi:[0,0,1]
    v_pk_fma_f32 v[228:229], v[228:229], v[8:9], v[28:29] op_sel_hi:[1,0,0] neg_lo:[0,0,1] neg_hi:[0,0,1]
    v_pk_fma_f32 v[230:231], v[230:231], v[8:9], v[28:29] op_sel_hi:[1,0,0] neg_lo:[0,0,1] neg_hi:[0,0,1]
    v_pk_fma_f32 v[232:233], v[232:233], v[8:9], v[28:29] op_sel_hi:[1,0,0] neg_lo:[0,0,1] neg_hi:[0,0,1]
    v_pk_fma_f32 v[234:235], v[234:235], v[8:9], v[28:29] op_sel_hi:[1,0,0] neg_lo:[0,0,1] neg_hi:[0,0,1]
    v_pk_fma_f32 v[236:237], v[236:237], v[8:9], v[28:29] op_sel_hi:[1,0,0] neg_lo:[0,0,1] neg_hi:[0,0,1]
    v_pk_fma_f32 v[238:239], v[238:239], v[8:9], v[28:29] op_sel_hi:[1,0,0] neg_lo:[0,0,1] neg_hi:[0,0,1]
    v_pk_mul_f32 v[32:33], v[224:225], v[30:31] op_sel_hi:[1,0]
    v_pk_mul_f32 v[34:35], v[226:227], v[30:31] op_sel_hi:[1,0]
    v_pk_mul_f32 v[36:37], v[228:229], v[30:31] op_sel_hi:[1,0]
    v_pk_mul_f32 v[38:39], v[230:231], v[30:31] op_sel_hi:[1,0]
    v_pk_mul_f32 v[40:41], v[232:233], v[30:31] op_sel_hi:[1,0]
    v_pk_mul_f32 v[42:43], v[234:235], v[30:31] op_sel_hi:[1,0]
    v_pk_mul_f32 v[44:45], v[236:237], v[30:31] op_sel_hi:[1,0]
    v_pk_mul_f32 v[46:47], v[238:239], v[30:31] op_sel_hi:[1,0]
    v_exp_f32 v32, v32
    v_exp_f32 v33, v33
    v_exp_f32 v34, v34
    v_exp_f32 v35, v35
    v_exp_f32 v36, v36
    v_exp_f32 v37, v37
    v_exp_f32 v38, v38
    v_exp_f32 v39, v39
    v_exp_f32 v40, v40
    v_exp_f32 v41, v41
    v_exp_f32 v42, v42
    v_exp_f32 v43, v43
    v_exp_f32 v44, v44
    v_exp_f32 v45, v45
    v_exp_f32 v46, v46
    v_exp_f32 v47, v47
    v_pk_add_f32 v[32:33], v[32:33], 1.0 op_sel_hi:[1,0]
    v_pk_add_f32 v[34:35], v[34:35], 1.0 op_sel_hi:[1,0]
    v_pk_add_f32 v[36:37], v[36:37], 1.0 op_sel_hi:[1,0]
    v_pk_add_f32 v[38:39], v[38:39], 1.0 op_sel_hi:[1,0]
    v_pk_add_f32 v[40:41], v[40:41], 1.0 op_sel_hi:[1,0]
    v_pk_add_f32 v[42:43], v[42:43], 1.0 op_sel_hi:[1,0]
    v_pk_add_f32 v[44:45], v[44:45], 1.0 op_sel_hi:[1,0]
    v_pk_add_f32 v[46:47], v[46:47], 1.0 op_sel_hi:[1,0]
    v_rcp_f32 v32, v32
    v_rcp_f32 v33, v33
    v_rcp_f32 v34, v34
    v_rcp_f32 v35, v35
    v_rcp_f32 v36, v36
    v_rcp_f32 v37, v37
    v_rcp_f32 v38, v38
    v_rcp_f32 v39, v39
    v_rcp_f32 v40, v40
    v_rcp_f32 v41, v41
    v_rcp_f32 v42, v42
    v_rcp_f32 v43, v43
    v_rcp_f32 v44, v44
    v_rcp_f32 v45, v45
    v_rcp_f32 v46, v46
    v_rcp_f32 v47, v47
    v_pk_mul_f32 v[224:225], v[224:225], v[32:33]
    v_pk_mul_f32 v[226:227], v[226:227], v[34:35]
    v_pk_mul_f32 v[228:229], v[228:229], v[36:37]
    v_pk_mul_f32 v[230:231], v[230:231], v[38:39]
    v_pk_mul_f32 v[232:233], v[232:233], v[40:41]
    v_pk_mul_f32 v[234:235], v[234:235], v[42:43]
    v_pk_mul_f32 v[236:237], v[236:237], v[44:45]
    v_pk_mul_f32 v[238:239], v[238:239], v[46:47]
    s_add_u32 s3, s75, 0
    s_nop 0
    buffer_load_dwordx4 v[80:83], v13, s[48:51], s3 offen sc1
    s_add_u32 s3, s75, 57344
    buffer_load_dwordx4 v[84:87], v13, s[48:51], s3 offen sc1
    s_add_u32 s3, s75, 114688
    buffer_load_dwordx4 v[88:91], v13, s[48:51], s3 offen sc1
    s_add_u32 s3, s75, 172032
    buffer_load_dwordx4 v[92:95], v13, s[48:51], s3 offen sc1
    s_waitcnt vmcnt(0)
    s_mov_b32 s29, 0
L_k5:
    v_max3_u32 v2, v80, v81, v82
    v_max3_u32 v2, v2, v83, v84
    v_max3_u32 v2, v2, v85, v86
    v_max3_u32 v2, v2, v87, v88
    v_max3_u32 v2, v2, v89, v90
    v_max3_u32 v2, v2, v91, v92
    v_max3_u32 v2, v2, v93, v94
    v_max_u32 v2, v2, v95
    v_cmp_eq_u32 vcc, -1, v2
    s_cbranch_vccz L_k5k
    s_add_u32 s29, s29, 1
    s_cmp_ge_u32 s29, 200000
    s_cbranch_scc1 L_k5k
    s_sleep 1
    s_add_u32 s3, s75, 0
    s_nop 0
    buffer_load_dwordx4 v[80:83], v13, s[48:51], s3 offen sc1
    s_add_u32 s3, s75, 57344
    buffer_load_dwordx4 v[84:87], v13, s[48:51], s3 offen sc1
    s_add_u32 s3, s75, 114688
    buffer_load_dwordx4 v[88:91], v13, s[48:51], s3 offen sc1
    s_add_u32 s3, s75, 172032
    buffer_load_dwordx4 v[92:95], v13, s[48:51], s3 offen sc1
    s_waitcnt vmcnt(0)
    s_branch L_k5
L_k5k:
    v_pk_add_f32 v[80:81], v[80:81], v[84:85]
    v_pk_add_f32 v[82:83], v[82:83], v[86:87]
    v_pk_add_f32 v[88:89], v[88:89], v[92:93]
    v_pk_add_f32 v[90:91], v[90:91], v[94:95]
    s_nop 0
    v_permlane32_swap_b32 v80, v88
    v_permlane32_swap_b32 v81, v89
    v_permlane32_swap_b32 v82, v90
    v_permlane32_swap_b32 v83, v91
    v_add_f32 v80, v80, v88
    v_add_f32 v81, v81, v89
    v_add_f32 v82, v82, v90
    v_add_f32 v83, v83, v91
    v_permlane16_swap_b32 v80, v81
    s_nop 0
    v_permlane16_swap_b32 v82, v83
    v_add_f32 v80, v80, v81
    v_add_f32 v82, v82, v83
    s_nop 1
    v_permlane32_swap_b32 v80, v82
    v_cvt_pk_bf16_f32 v80, v80, v80
    v_lshlrev_b32 v80, 16, v80
    v_cvt_pk_bf16_f32 v82, v82, v82
    v_lshlrev_b32 v82, 16, v82
    v_mul_f32 v2, 0xbfb8aa3b, v80
    v_exp_f32 v2, v2
    s_nop 0
    v_add_f32 v2, 1.0, v2
    v_rcp_f32 v2, v2
    s_nop 0
    v_mul_f32 v80, v80, v2
    v_cvt_pk_bf16_f32 v80, v80, v80
    v_lshlrev_b32 v80, 16, v80
    v_mul_f32 v80, v80, v82
    v_cvt_pk_bf16_f32 v80, v80, v80
    v_lshlrev_b32 v80, 16, v80
    v_bfe_u32 v2, v1, 3, 2
    v_lshlrev_b32 v2, 6, v2
    v_lshrrev_b32_e64 v3, 5, v1
    v_lshl_add_u32 v2, v3, 2, v2
    ds_bpermute_b32 v128, v2, v80 offset:0
    ds_bpermute_b32 v130, v2, v80 offset:8
    ds_bpermute_b32 v132, v2, v80 offset:16
    ds_bpermute_b32 v134, v2, v80 offset:24
    ds_bpermute_b32 v136, v2, v80 offset:32
    ds_bpermute_b32 v138, v2, v80 offset:40
    ds_bpermute_b32 v140, v2, v80 offset:48
    v_mov_b64 v[120:121], 0
    v_mov_b64 v[122:123], 0
    v_mov_b64 v[124:125], 0
    v_mov_b64 v[126:127], 0
    s_waitcnt lgkmcnt(0)
    v_lshlrev_b32 v2, 16, v192
    v_and_b32 v3, 0xffff0000, v192
    v_pk_fma_f32 v[120:121], v[2:3], v[128:129], v[120:121] op_sel_hi:[1,0,1]
    v_lshlrev_b32_e64 v4, 16, v193
    v_and_b32 v5, 0xffff0000, v193
    v_pk_fma_f32 v[122:123], v[4:5], v[128:129], v[122:123] op_sel_hi:[1,0,1]
    v_lshlrev_b32_e64 v2, 16, v194
    v_and_b32 v3, 0xffff0000, v194
    v_pk_fma_f32 v[124:125], v[2:3], v[128:129], v[124:125] op_sel_hi:[1,0,1]
    v_lshlrev_b32_e64 v4, 16, v195
    v_and_b32 v5, 0xffff0000, v195
    v_pk_fma_f32 v[126:127], v[4:5], v[128:129], v[126:127] op_sel_hi:[1,0,1]
    v_lshlrev_b32_e64 v2, 16, v196
    v_and_b32 v3, 0xffff0000, v196
    v_pk_fma_f32 v[120:121], v[2:3], v[130:131], v[120:121] op_sel_hi:[1,0,1]
    v_lshlrev_b32_e64 v4, 16, v197
    v_and_b32 v5, 0xffff0000, v197
    v_pk_fma_f32 v[122:123], v[4:5], v[130:131], v[122:123] op_sel_hi:[1,0,1]
    v_lshlrev_b32_e64 v2, 16, v198
    v_and_b32 v3, 0xffff0000, v198
    v_pk_fma_f32 v[124:125], v[2:3], v[130:131], v[124:125] op_sel_hi:[1,0,1]
    v_lshlrev_b32_e64 v4, 16, v199
    v_and_b32 v5, 0xffff0000, v199
    v_pk_fma_f32 v[126:127], v[4:5], v[130:131], v[126:127] op_sel_hi:[1,0,1]
    v_lshlrev_b32_e64 v2, 16, v200
    v_and_b32 v3, 0xffff0000, v200
    v_pk_fma_f32 v[120:121], v[2:3], v[132:133], v[120:121] op_sel_hi:[1,0,1]
    v_lshlrev_b32_e64 v4, 16, v201
    v_and_b32 v5, 0xffff0000, v201
    v_pk_fma_f32 v[122:123], v[4:5], v[132:133], v[122:123] op_sel_hi:[1,0,1]
    v_lshlrev_b32_e64 v2, 16, v202
    v_and_b32 v3, 0xffff0000, v202
    v_pk_fma_f32 v[124:125], v[2:3], v[132:133], v[124:125] op_sel_hi:[1,0,1]
    v_lshlrev_b32_e64 v4, 16, v203
    v_and_b32 v5, 0xffff0000, v203
    v_pk_fma_f32 v[126:127], v[4:5], v[132:133], v[126:127] op_sel_hi:[1,0,1]
    v_lshlrev_b32_e64 v2, 16, v204
    v_and_b32 v3, 0xffff0000, v204
    v_pk_fma_f32 v[120:121], v[2:3], v[134:135], v[120:121] op_sel_hi:[1,0,1]
    v_lshlrev_b32_e64 v4, 16, v205
    v_and_b32 v5, 0xffff0000, v205
    v_pk_fma_f32 v[122:123], v[4:5], v[134:135], v[122:123] op_sel_hi:[1,0,1]
    v_lshlrev_b32_e64 v2, 16, v206
    v_and_b32 v3, 0xffff0000, v206
    v_pk_fma_f32 v[124:125], v[2:3], v[134:135], v[124:125] op_sel_hi:[1,0,1]
    v_lshlrev_b32_e64 v4, 16, v207
    v_and_b32 v5, 0xffff0000, v207
    v_pk_fma_f32 v[126:127], v[4:5], v[134:135], v[126:127] op_sel_hi:[1,0,1]
    v_lshlrev_b32_e64 v2, 16, v208
    v_and_b32 v3, 0xffff0000, v208
    v_pk_fma_f32 v[120:121], v[2:3], v[136:137], v[120:121] op_sel_hi:[1,0,1]
    v_lshlrev_b32_e64 v4, 16, v209
    v_and_b32 v5, 0xffff0000, v209
    v_pk_fma_f32 v[122:123], v[4:5], v[136:137], v[122:123] op_sel_hi:[1,0,1]
    v_lshlrev_b32_e64 v2, 16, v210
    v_and_b32 v3, 0xffff0000, v210
    v_pk_fma_f32 v[124:125], v[2:3], v[136:137], v[124:125] op_sel_hi:[1,0,1]
    v_lshlrev_b32_e64 v4, 16, v211
    v_and_b32 v5, 0xffff0000, v211
    v_pk_fma_f32 v[126:127], v[4:5], v[136:137], v[126:127] op_sel_hi:[1,0,1]
    v_lshlrev_b32_e64 v2, 16, v212
    v_and_b32 v3, 0xffff0000, v212
    v_pk_fma_f32 v[120:121], v[2:3], v[138:139], v[120:121] op_sel_hi:[1,0,1]
    v_lshlrev_b32_e64 v4, 16, v213
    v_and_b32 v5, 0xffff0000, v213
    v_pk_fma_f32 v[122:123], v[4:5], v[138:139], v[122:123] op_sel_hi:[1,0,1]
    v_lshlrev_b32_e64 v2, 16, v214
    v_and_b32 v3, 0xffff0000, v214
    v_pk_fma_f32 v[124:125], v[2:3], v[138:139], v[124:125] op_sel_hi:[1,0,1]
    v_lshlrev_b32_e64 v4, 16, v215
    v_and_b32 v5, 0xffff0000, v215
    v_pk_fma_f32 v[126:127], v[4:5], v[138:139], v[126:127] op_sel_hi:[1,0,1]
    v_lshlrev_b32_e64 v2, 16, v216
    v_and_b32 v3, 0xffff0000, v216
    v_pk_fma_f32 v[120:121], v[2:3], v[140:141], v[120:121] op_sel_hi:[1,0,1]
    v_lshlrev_b32_e64 v4, 16, v217
    v_and_b32 v5, 0xffff0000, v217
    v_pk_fma_f32 v[122:123], v[4:5], v[140:141], v[122:123] op_sel_hi:[1,0,1]
    v_lshlrev_b32_e64 v2, 16, v218
    v_and_b32 v3, 0xffff0000, v218
    v_pk_fma_f32 v[124:125], v[2:3], v[140:141], v[124:125] op_sel_hi:[1,0,1]
    v_lshlrev_b32_e64 v4, 16, v219
    v_and_b32 v5, 0xffff0000, v219
    v_pk_fma_f32 v[126:127], v[4:5], v[140:141], v[126:127] op_sel_hi:[1,0,1]
    v_permlane32_swap_b32 v120, v124
    v_permlane32_swap_b32 v121, v125
    v_permlane32_swap_b32 v122, v126
    v_permlane32_swap_b32 v123, v127
    v_add_f32 v120, v120, v124
    v_add_f32 v121, v121, v125
    v_add_f32 v122, v122, v126
    v_add_f32 v123, v123, v127
    s_nop 0
    v_permlane16_swap_b32 v120, v122
    v_permlane16_swap_b32 v121, v123
    v_add_f32 v120, v120, v122
    v_add_f32 v121, v121, v123
    s_nop 0
    v_add_f32 v120, v120, v120 row_ror:8 row_mask:0xf bank_mask:0xf
    v_add_f32 v121, v121, v121 row_ror:8 row_mask:0xf bank_mask:0xf
    v_and_b32 v2, 8, v1
    v_cmp_eq_u32 vcc, 0, v2
    s_and_b32 s3, s2, 15
    s_lshl_b32 s3, s3, 4
    s_lshr_b32 s28, s2, 4
    s_add_u32 s3, s3, s28
    s_lshl_b32 s3, s3, 2
    s_add_u32 s3, s3, s38
    s_lshl_b32 s3, s3, 8
    s_add_u32 s3, s3, 1413120
    v_cndmask_b32 v120, v121, v120, vcc
    buffer_store_dword v120, v253, s[48:51], s3 offen sc1
    v_and_b32 v3, 3, v1
    v_lshlrev_b32 v3, 2, v3
    v_add_u32 v3, 162112, v3
L_ow:
    ds_read_b32 v2, v3
    s_waitcnt lgkmcnt(0)
    v_cmp_ne_u32 vcc, 7, v2
    s_cbranch_vccz L_owk
    s_sleep 1
    s_branch L_ow
L_owk:
    s_branch L_p3
L_C:
    s_and_b32 s64, s38, 1
    s_lshr_b32 s65, s38, 1
    v_and_b32 v3, 15, v1
    v_lshlrev_b32 v3, 7, v3
    s_lshl_b32 s3, s64, 13
    v_add_u32 v3, s3, v3
    v_bfe_u32 v5, v1, 1, 3
    v_lshrrev_b32 v6, 4, v1
    v_xor_b32 v6, v6, v5
    v_lshl_add_u32 v184, v6, 4, v3
    v_xor_b32 v185, 64, v184
    v_lshrrev_b32 v6, 4, v1
    v_lshlrev_b32 v6, 3, v6
    v_bfe_u32 v7, v1, 2, 2
    v_add_u32 v6, v6, v7
    v_lshlrev_b32 v6, 7, v6
    v_and_b32 v7, 3, v1
    v_lshl_add_u32 v6, v7, 3, v6
    v_add_u32 v6, 16384, v6
    v_bfe_u32 v7, v1, 3, 2
    s_lshl_b32 s3, s65, 1
    v_xor_b32 v7, s3, v7
    v_lshl_add_u32 v186, v7, 5, v6
    v_xor_b32_e64 v187, 32, v186
    v_add_u32 v188, 81920, v184
    v_add_u32 v189, 81920, v185
    v_add_u32 v190, 81920, v186
    v_add_u32 v191, 81920, v187
    s_waitcnt lgkmcnt(0)
    s_mov_b32 s48, s26
    s_mov_b32 s49, s27
    s_mov_b32 s50, 268435456
    s_mov_b32 s51, 0x00020000
    s_mov_b32 s40, s4
    s_mov_b32 s41, s5
    s_mov_b32 s42, 4194304
    s_mov_b32 s43, 0x00020000
    s_mov_b32 s88, s10
    s_mov_b32 s89, s11
    s_mov_b32 s90, 2097152
    s_mov_b32 s91, 0x00020000
    s_lshl_b32 s3, s36, 7
    s_lshl_b32 s28, s37, 3
    s_add_u32 s3, s3, s28
    s_lshl_b32 s28, s38, 1
    s_add_u32 s71, s3, s28
    v_lshlrev_b32 v2, 4, v1
    v_mov_b32 v212, 16384
    v_mov_b32 v4, -1
    v_mov_b32 v5, -1
    v_mov_b32 v6, -1
    v_mov_b32_e64 v7, -1
    s_lshl_b32 s28, s2, 2
    s_add_u32 s28, s28, s38
    s_mul_i32 s28, s28, 768
    s_add_u32 s28, s28, 1048320
    s_lshl_b32 s3, s37, 4
    s_add_u32 s3, s3, s36
    s_lshl_b32 s3, s3, 2
    s_add_u32 s3, s3, s38
    s_lshl_b32 s3, s3, 8
    s_add_u32 s3, s3, 524288
    v_cmp_gt_u32 vcc, 16, v1
    v_add_u32 v3, s3, v2
    v_add_u32_e64 v2, s28, v2
    v_cndmask_b32 v2, v2, v3, vcc
    buffer_store_dwordx4 v[4:7], v2, s[48:51], 0 offen sc1
    buffer_load_dword v212, v212, s[48:51], 0 offen sc1
    s_getpc_b64 s[92:93]
L_pc:
    s_sub_u32 s92, s92, L_pc-recurrent_scan__linear_kernel_hedgehog__moe_arch_mod__prompt_kernel
    s_subb_u32 s93, s93, 0
    s_lshr_b32 s3, s2, 3
    s_lshl_b32 s3, s3, 2
    s_add_u32 s3, s3, s38
    s_lshl_b32 s3, s3, 8
    v_lshlrev_b32 v2, 7, v1
    v_add_u32 v2, s3, v2
    s_mov_b64 exec, 3
    global_load_dword v213, v2, s[92:93]
    s_mov_b64 exec, -1
    v_mov_b64 v[8:9], 0
    v_mov_b64 v[10:11], 0
    v_mov_b64 v[12:13], 0
    v_mov_b64 v[14:15], 0
    v_mov_b64 v[16:17], 0
    v_mov_b64 v[18:19], 0
    v_mov_b64 v[20:21], 0
    v_mov_b64 v[22:23], 0
    v_mov_b64 v[24:25], 0
    v_mov_b64 v[26:27], 0
    v_mov_b64 v[28:29], 0
    v_mov_b64 v[30:31], 0
    v_mov_b64 v[32:33], 0
    v_mov_b64 v[34:35], 0
    v_mov_b64 v[36:37], 0
    v_mov_b64 v[38:39], 0
    v_mov_b64 v[40:41], 0
    v_mov_b64 v[42:43], 0
    v_mov_b64 v[44:45], 0
    v_mov_b64 v[46:47], 0
    v_mov_b64 v[48:49], 0
    v_mov_b64 v[50:51], 0
    v_mov_b64 v[52:53], 0
    v_mov_b64 v[54:55], 0
    v_mov_b64 v[56:57], 0
    v_mov_b64 v[58:59], 0
    v_mov_b64 v[60:61], 0
    v_mov_b64 v[62:63], 0
    v_mov_b64 v[64:65], 0
    v_mov_b64 v[66:67], 0
    v_mov_b64 v[68:69], 0
    v_mov_b64 v[70:71], 0
    v_mov_b64 v[72:73], 0
    v_mov_b64 v[74:75], 0
    v_mov_b64 v[76:77], 0
    v_mov_b64 v[78:79], 0
    v_mov_b64 v[80:81], 0
    v_mov_b64 v[82:83], 0
    v_mov_b64 v[84:85], 0
    v_mov_b64 v[86:87], 0
    v_mov_b64 v[88:89], 0
    v_mov_b64 v[90:91], 0
    v_mov_b64 v[92:93], 0
    v_mov_b64 v[94:95], 0
    v_mov_b64 v[96:97], 0
    v_mov_b64 v[98:99], 0
    v_mov_b64 v[100:101], 0
    v_mov_b64 v[102:103], 0
    s_lshl_b32 s3, s38, 2
    s_add_u32 s3, s3, 162112
    v_mov_b32 v2, s3
    v_mov_b32_e64 v3, 0
    ds_write_b32 v2, v3
    ds_write_b32 v2, v3 offset:16
    s_mov_b32 s86, 0
    s_mov_b32 s66, 0
    s_setprio 2
    s_waitcnt lgkmcnt(0)
    s_lshl_b32 s3, s38, 1
    s_lshr_b32 s28, s39, 2
    s_add_u32 s3, s3, s28
    s_lshl_b32 s69, s3, 4
    v_and_b32 v237, 15, v1
    v_add_u32 v236, s69, v237
    v_lshlrev_b32 v236, 7, v236
    v_lshrrev_b32 v237, 1, v237
    v_lshrrev_b32 v238, 5, v1
    v_xor_b32 v237, v237, v238
    v_lshl_add_u32 v236, v237, 4, v236
    v_bfe_u32 v238, v1, 4, 1
    v_lshl_add_u32 v236, v238, 3, v236
    v_xor_b32 v237, 32, v236
    v_xor_b32 v238, 64, v236
    v_xor_b32 v239, 96, v236
    v_and_b32 v2, 15, v1
    v_lshrrev_b32_e64 v3, 4, v1
    s_lshl_b32 s3, s64, 8
    s_add_u32 s3, s3, 152064
    v_lshl_add_u32 v232, v2, 2, s3
    v_lshl_add_u32 v233, v3, 4, s3
    v_lshrrev_b32 v7, 5, v1
    v_lshl_add_u32 v234, v7, 6, v232
    s_lshl_b32 s3, s65, 7
    s_add_u32 s3, s3, 154880
    v_lshl_add_u32 v235, v3, 4, s3
    v_lshl_add_u32 v248, v2, 2, s3
    s_lshl_b32 s3, s64, 7
    s_add_u32 s3, s3, 154624
    v_lshl_add_u32 v249, v3, 4, s3
    v_xor_b32 v253, 128, v249
    v_lshrrev_b32 v250, 2, v1
    v_lshlrev_b32 v250, 6, v250
    v_and_b32 v251, 3, v1
    v_lshl_add_u32 v250, v251, 3, v250
    s_lshl_b32 s3, s65, 11
    s_add_u32 s3, s3, 147712
    v_add_u32 v252, s3, v250
    v_bfe_u32 v5, v1, 1, 2
    v_lshlrev_b32_e64 v5, 2, v5
    v_bfe_u32 v4, v1, 3, 1
    v_lshl_add_u32 v5, v4, 1, v5
    v_and_b32 v4, 1, v1
    v_add_u32 v5, v5, v4
    v_xor_b32 v5, v5, v3
    s_lshl_b32 s3, s38, 13
    s_add_u32 s3, s3, 98304
    v_lshl_add_u32 v2, v2, 7, s3
    v_lshl_add_u32 v4, v5, 3, v2
    v_xor_b32 v5, 32, v4
    v_xor_b32 v6, 64, v4
    v_xor_b32 v7, 96, v4
    v_bfe_u32 v2, v1, 3, 2
    v_lshlrev_b32 v2, 2, v2
    v_lshrrev_b32 v3, 5, v1
    v_lshl_add_u32 v2, v3, 1, v2
    v_bfe_u32 v3, v1, 2, 1
    v_add_u32 v2, v2, v3
    v_xor_b32 v2, v2, v251
    v_lshrrev_b32_e64 v3, 2, v1
    v_lshl_add_u32 v3, v3, 7, s3
    v_lshl_add_u32 v2, v2, 3, v3
    s_lshl_b32 s28, s64, 6
    v_xor_b32 v201, s28, v2
    v_xor_b32 v203, 32, v201
    s_lshl_b32 s3, s38, 12
    s_add_u32 s3, s3, 131072
    v_lshlrev_b32 v199, 4, v1
    v_add_u32 v197, s3, v199
    s_lshl_b32 s3, s37, 1
    s_add_u32 s67, s3, s65
    s_lshl_b32 s3, s67, 4
    s_add_u32 s3, s3, s36
    s_mul_i32 s3, s3, 4224
    s_add_u32 s75, s3, 8388608
    s_lshl_b32 s3, s64, 11
    s_add_u32 s74, s75, s3
    s_lshl_b32 s3, s64, 6
    s_add_u32 s75, s75, s3
    s_add_u32 s75, s75, 4096
    s_lshl_b32 s3, s37, 4
    s_add_u32 s3, s3, s36
    s_lshl_b32 s3, s3, 7
    s_add_u32 s3, s3, 32768
    s_cmp_lg_u32 s38, 0
    s_cselect_b32 s76, 268435456, s3
L_ln:
    s_lshl_b32 s3, s38, 12
    s_add_u32 s3, s3, 131072
    v_lshlrev_b32 v2, 4, v1
    v_add_u32 v3, s3, v2
    v_add_u32 v2, 122880, v2
    s_barrier
    ds_read_b128 v[120:123], v2 offset:0
    ds_read_b128 v[124:127], v2 offset:1024
    ds_read_b128 v[104:107], v3 offset:0
    ds_read_b128 v[108:111], v3 offset:1024
    ds_read_b128 v[112:115], v3 offset:2048
    ds_read_b128 v[116:119], v3 offset:3072
    v_mov_b32 v2, 0x3f803f80
    v_mov_b32 v128, 0
    v_mov_b32 v130, 0
    v_mov_b32 v132, 0
    v_mov_b32 v134, 0
    v_mov_b32 v136, 0
    v_mov_b32 v138, 0
    v_mov_b32 v140, 0
    v_mov_b32 v142, 0
    s_waitcnt lgkmcnt(2)
    v_dot2c_f32_bf16 v128, v104, v2
    v_dot2c_f32_bf16 v132, v104, v104
    v_dot2c_f32_bf16 v136, v104, v120
    v_dot2c_f32_bf16 v140, v120, v2
    v_dot2c_f32_bf16 v128, v105, v2
    v_dot2c_f32_bf16 v132, v105, v105
    v_dot2c_f32_bf16 v136, v105, v121
    v_dot2c_f32_bf16 v140, v121, v2
    v_dot2c_f32_bf16 v128, v106, v2
    v_dot2c_f32_bf16 v132, v106, v106
    v_dot2c_f32_bf16 v136, v106, v122
    v_dot2c_f32_bf16 v140, v122, v2
    v_dot2c_f32_bf16 v128, v107, v2
    v_dot2c_f32_bf16 v132, v107, v107
    v_dot2c_f32_bf16 v136, v107, v123
    v_dot2c_f32_bf16 v140, v123, v2
    v_dot2c_f32_bf16 v128, v108, v2
    v_dot2c_f32_bf16 v132, v108, v108
    v_dot2c_f32_bf16 v136, v108, v124
    v_dot2c_f32_bf16 v140, v124, v2
    v_dot2c_f32_bf16 v128, v109, v2
    v_dot2c_f32_bf16 v132, v109, v109
    v_dot2c_f32_bf16 v136, v109, v125
    v_dot2c_f32_bf16 v140, v125, v2
    v_dot2c_f32_bf16 v128, v110, v2
    v_dot2c_f32_bf16 v132, v110, v110
    v_dot2c_f32_bf16 v136, v110, v126
    v_dot2c_f32_bf16 v140, v126, v2
    v_dot2c_f32_bf16 v128, v111, v2
    v_dot2c_f32_bf16 v132, v111, v111
    v_dot2c_f32_bf16 v136, v111, v127
    v_dot2c_f32_bf16 v140, v127, v2
    s_waitcnt lgkmcnt(0)
    v_dot2c_f32_bf16 v130, v112, v2
    v_dot2c_f32_bf16 v134, v112, v112
    v_dot2c_f32_bf16 v138, v112, v120
    v_dot2c_f32_bf16 v142, v120, v2
    v_dot2c_f32_bf16 v130, v113, v2
    v_dot2c_f32_bf16 v134, v113, v113
    v_dot2c_f32_bf16 v138, v113, v121
    v_dot2c_f32_bf16 v142, v121, v2
    v_dot2c_f32_bf16 v130, v114, v2
    v_dot2c_f32_bf16 v134, v114, v114
    v_dot2c_f32_bf16 v138, v114, v122
    v_dot2c_f32_bf16 v142, v122, v2
    v_dot2c_f32_bf16 v130, v115, v2
    v_dot2c_f32_bf16 v134, v115, v115
    v_dot2c_f32_bf16 v138, v115, v123
    v_dot2c_f32_bf16 v142, v123, v2
    v_dot2c_f32_bf16 v130, v116, v2
    v_dot2c_f32_bf16 v134, v116, v116
    v_dot2c_f32_bf16 v138, v116, v124
    v_dot2c_f32_bf16 v142, v124, v2
    v_dot2c_f32_bf16 v130, v117, v2
    v_dot2c_f32_bf16 v134, v117, v117
    v_dot2c_f32_bf16 v138, v117, v125
    v_dot2c_f32_bf16 v142, v125, v2
    v_dot2c_f32_bf16 v130, v118, v2
    v_dot2c_f32_bf16 v134, v118, v118
    v_dot2c_f32_bf16 v138, v118, v126
    v_dot2c_f32_bf16 v142, v126, v2
    v_dot2c_f32_bf16 v130, v119, v2
    v_dot2c_f32_bf16 v134, v119, v119
    v_dot2c_f32_bf16 v138, v119, v127
    v_dot2c_f32_bf16 v142, v127, v2
    v_permlane32_swap_b32 v128, v130
    v_permlane32_swap_b32 v132, v134
    v_permlane32_swap_b32 v136, v138
    v_permlane32_swap_b32 v140, v142
    v_add_f32 v128, v128, v130
    v_add_f32 v132, v132, v134
    v_add_f32 v136, v136, v138
    v_add_f32 v140, v140, v142
    v_add_f32 v128, v128, v128 quad_perm:[1,0,3,2] row_mask:0xf bank_mask:0xf
    v_add_f32 v132, v132, v132 quad_perm:[1,0,3,2] row_mask:0xf bank_mask:0xf
    v_add_f32 v136, v136, v136 quad_perm:[1,0,3,2] row_mask:0xf bank_mask:0xf
    v_add_f32 v140, v140, v140 quad_perm:[1,0,3,2] row_mask:0xf bank_mask:0xf
    v_add_f32 v128, v128, v128 quad_perm:[2,3,0,1] row_mask:0xf bank_mask:0xf
    v_add_f32 v132, v132, v132 quad_perm:[2,3,0,1] row_mask:0xf bank_mask:0xf
    v_add_f32 v136, v136, v136 quad_perm:[2,3,0,1] row_mask:0xf bank_mask:0xf
    v_add_f32 v140, v140, v140 quad_perm:[2,3,0,1] row_mask:0xf bank_mask:0xf
    v_add_f32 v128, v128, v128 row_half_mirror row_mask:0xf bank_mask:0xf
    v_add_f32 v132, v132, v132 row_half_mirror row_mask:0xf bank_mask:0xf
    v_add_f32 v136, v136, v136 row_half_mirror row_mask:0xf bank_mask:0xf
    v_add_f32 v140, v140, v140 row_half_mirror row_mask:0xf bank_mask:0xf
    v_add_f32 v128, v128, v128 row_mirror row_mask:0xf bank_mask:0xf
    v_add_f32 v132, v132, v132 row_mirror row_mask:0xf bank_mask:0xf
    v_add_f32 v136, v136, v136 row_mirror row_mask:0xf bank_mask:0xf
    v_add_f32 v140, v140, v140 row_mirror row_mask:0xf bank_mask:0xf
    v_mov_b32 v129, v128
    v_mov_b32 v133, v132
    v_mov_b32 v137, v136
    v_mov_b32 v141, v140
    v_permlane16_swap_b32 v128, v129
    v_permlane16_swap_b32 v132, v133
    v_permlane16_swap_b32 v136, v137
    v_permlane16_swap_b32 v140, v141
    v_add_f32 v128, v128, v129
    v_add_f32 v132, v132, v133
    v_add_f32 v136, v136, v137
    v_add_f32 v140, v140, v141
    v_mul_f32 v128, 0x3a800000, v128
    v_mul_f32 v132, 0x3a800000, v132
    v_cvt_pk_bf16_f32 v129, v128, v128
    v_lshlrev_b32 v129, 16, v129
    v_fma_f32 v132, -v128, v128, v132
    v_max_f32 v132, 0, v132
    v_fma_f32 v136, -v129, v140, v136
    s_waitcnt vmcnt(0)
    v_cvt_pk_bf16_f32 v132, v132, v132
    v_lshlrev_b32 v132, 16, v132
    v_add_f32 v132, 0x3727c5ac, v132
    v_cvt_pk_bf16_f32 v132, v132, v132
    v_lshlrev_b32 v132, 16, v132
    v_sqrt_f32 v132, v132
    s_nop 0
    v_cvt_pk_bf16_f32 v132, v132, v132
    v_lshlrev_b32 v132, 16, v132
    v_rcp_f32 v2, v132
    v_lshrrev_b32 v3, 16, v129
    v_or_b32 v208, v3, v132
    v_mul_f32 v136, v136, v2
    v_cvt_pk_bf16_f32 v136, v136, v136
    v_lshlrev_b32 v136, 16, v136
    v_ashrrev_i32 v2, 31, v136
    v_or_b32 v2, 0x80000000, v2
    v_xor_b32 v2, v136, v2
    v_and_b32 v2, 0xffff0000, v2
    v_lshrrev_b32 v3, 5, v1
    v_add_u32 v209, s71, v3
    v_sub_u32 v209, 2047, v209
    v_or_b32 v210, v2, v209
    v_mov_b32 v2, v210
    v_mov_b32 v209, v208
    v_readfirstlane_b32 s86, v212
    v_mov_b32 v3, 0
    s_mul_i32 s86, s86, 1664525
    s_add_u32 s86, s86, 1013904223
    v_mov_b32 v211, s86
    v_permlane32_swap_b32 v210, v2
    v_permlane32_swap_b32 v208, v209
    v_max_u32 v210, v210, v2
    s_lshl_b32 s3, s71, 3
    s_mov_b64 exec, 1
    buffer_store_dwordx4 v[208:211], v3, s[48:51], s3 offen sc1
    s_mov_b64 exec, -1
    v_mov_b32_e64 v251, s86
    s_barrier
    ds_read_b128 v[104:107], v184 offset:0
    ds_read_b64_tr_b16 v[120:121], v186 offset:0
    ds_read_b64_tr_b16 v[122:123], v186 offset:512
    ds_read_b64_tr_b16 v[124:125], v187 offset:0
    ds_read_b64_tr_b16 v[126:127], v187 offset:512
    ds_read_b64_tr_b16 v[128:129], v186 offset:8192
    ds_read_b64_tr_b16 v[130:131], v186 offset:8704
    ds_read_b64_tr_b16 v[132:133], v187 offset:8192
    ds_read_b64_tr_b16 v[134:135], v187 offset:8704
    ds_read_b64_tr_b16 v[136:137], v186 offset:16384
    ds_read_b64_tr_b16 v[138:139], v186 offset:16896
    ds_read_b64_tr_b16 v[140:141], v187 offset:16384
    ds_read_b64_tr_b16 v[142:143], v187 offset:16896
    ds_read_b128 v[108:111], v184 offset:2048
    ds_read_b128 v[112:115], v184 offset:4096
    ds_read_b128 v[116:119], v184 offset:6144
    ds_read_b64 v[240:241], v236
    ds_read_b64 v[242:243], v237
    ds_read_b64 v[244:245], v238
    ds_read_b64 v[246:247], v239
    s_waitcnt lgkmcnt(4)
    s_branch L_cmid
.p2align 6
L_cloop:
    s_waitcnt lgkmcnt(0)
    s_barrier
    v_mfma_f32_16x16x32_bf16 v[8:11], v[160:163], v[144:147], v[8:11]
    ds_read_b128 v[104:107], v184 offset:0
    v_mfma_f32_16x16x32_bf16 v[12:15], v[164:167], v[144:147], v[12:15]
    ds_read_b64_tr_b16 v[120:121], v186 offset:0
    v_mfma_f32_16x16x32_bf16 v[16:19], v[168:171], v[144:147], v[16:19]
    ds_read_b64_tr_b16 v[122:123], v186 offset:512
    v_mfma_f32_16x16x32_bf16 v[20:23], v[172:175], v[144:147], v[20:23]
    ds_read_b64_tr_b16 v[124:125], v187 offset:0
    v_mfma_f32_16x16x32_bf16 v[24:27], v[144:147], v[176:179], v[24:27]
    ds_read_b64_tr_b16 v[126:127], v187 offset:512
    v_mfma_f32_16x16x32_bf16 v[28:31], v[144:147], v[180:183], v[28:31]
    ds_read_b64_tr_b16 v[128:129], v186 offset:8192
    v_mfma_f32_16x16x32_bf16 v[32:35], v[160:163], v[148:151], v[32:35]
    ds_read_b64_tr_b16 v[130:131], v186 offset:8704
    v_mfma_f32_16x16x32_bf16 v[36:39], v[164:167], v[148:151], v[36:39]
    ds_read_b64_tr_b16 v[132:133], v187 offset:8192
    v_mfma_f32_16x16x32_bf16 v[40:43], v[168:171], v[148:151], v[40:43]
    ds_read_b64_tr_b16 v[134:135], v187 offset:8704
    v_mfma_f32_16x16x32_bf16 v[44:47], v[172:175], v[148:151], v[44:47]
    ds_read_b64_tr_b16 v[136:137], v186 offset:16384
    v_mfma_f32_16x16x32_bf16 v[48:51], v[148:151], v[176:179], v[48:51]
    ds_read_b64_tr_b16 v[138:139], v186 offset:16896
    v_mfma_f32_16x16x32_bf16 v[52:55], v[148:151], v[180:183], v[52:55]
    ds_read_b64_tr_b16 v[140:141], v187 offset:16384
    v_mfma_f32_16x16x32_bf16 v[56:59], v[160:163], v[152:155], v[56:59]
    ds_read_b64_tr_b16 v[142:143], v187 offset:16896
    v_mfma_f32_16x16x32_bf16 v[60:63], v[164:167], v[152:155], v[60:63]
    ds_read_b128 v[108:111], v184 offset:2048
    v_mfma_f32_16x16x32_bf16 v[64:67], v[168:171], v[152:155], v[64:67]
    ds_read_b128 v[112:115], v184 offset:4096
    v_mfma_f32_16x16x32_bf16 v[68:71], v[172:175], v[152:155], v[68:71]
    ds_read_b128 v[116:119], v184 offset:6144
    v_mfma_f32_16x16x32_bf16 v[72:75], v[152:155], v[176:179], v[72:75]
    v_mfma_f32_16x16x32_bf16 v[76:79], v[152:155], v[180:183], v[76:79]
    v_mfma_f32_16x16x32_bf16 v[80:83], v[160:163], v[156:159], v[80:83]
    v_mfma_f32_16x16x32_bf16 v[84:87], v[164:167], v[156:159], v[84:87]
    v_mfma_f32_16x16x32_bf16 v[88:91], v[168:171], v[156:159], v[88:91]
    v_mfma_f32_16x16x32_bf16 v[92:95], v[172:175], v[156:159], v[92:95]
    v_mfma_f32_16x16x32_bf16 v[96:99], v[156:159], v[176:179], v[96:99]
    v_mfma_f32_16x16x32_bf16 v[100:103], v[156:159], v[180:183], v[100:103]
    s_waitcnt lgkmcnt(0)
    s_nop 0
L_cmid:
    v_mfma_f32_16x16x32_bf16 v[8:11], v[120:123], v[104:107], v[8:11]
    ds_read_b128 v[144:147], v185 offset:0
    v_mfma_f32_16x16x32_bf16 v[12:15], v[124:127], v[104:107], v[12:15]
    ds_read_b64_tr_b16 v[160:161], v186 offset:4096
    v_mfma_f32_16x16x32_bf16 v[16:19], v[128:131], v[104:107], v[16:19]
    ds_read_b64_tr_b16 v[162:163], v186 offset:4608
    v_mfma_f32_16x16x32_bf16 v[20:23], v[132:135], v[104:107], v[20:23]
    ds_read_b64_tr_b16 v[164:165], v187 offset:4096
    v_mfma_f32_16x16x32_bf16 v[24:27], v[104:107], v[136:139], v[24:27]
    ds_read_b64_tr_b16 v[166:167], v187 offset:4608
    v_mfma_f32_16x16x32_bf16 v[28:31], v[104:107], v[140:143], v[28:31]
    ds_read_b64_tr_b16 v[168:169], v186 offset:12288
    v_mfma_f32_16x16x32_bf16 v[32:35], v[120:123], v[108:111], v[32:35]
    ds_read_b64_tr_b16 v[170:171], v186 offset:12800
    v_mfma_f32_16x16x32_bf16 v[36:39], v[124:127], v[108:111], v[36:39]
    ds_read_b64_tr_b16 v[172:173], v187 offset:12288
    v_mfma_f32_16x16x32_bf16 v[40:43], v[128:131], v[108:111], v[40:43]
    ds_read_b64_tr_b16 v[174:175], v187 offset:12800
    v_mfma_f32_16x16x32_bf16 v[44:47], v[132:135], v[108:111], v[44:47]
    ds_read_b64_tr_b16 v[176:177], v186 offset:20480
    v_mfma_f32_16x16x32_bf16 v[48:51], v[108:111], v[136:139], v[48:51]
    ds_read_b64_tr_b16 v[178:179], v186 offset:20992
    v_mfma_f32_16x16x32_bf16 v[52:55], v[108:111], v[140:143], v[52:55]
    ds_read_b64_tr_b16 v[180:181], v187 offset:20480
    v_mfma_f32_16x16x32_bf16 v[56:59], v[120:123], v[112:115], v[56:59]
    ds_read_b64_tr_b16 v[182:183], v187 offset:20992
    v_mfma_f32_16x16x32_bf16 v[60:63], v[124:127], v[112:115], v[60:63]
    ds_read_b128 v[148:151], v185 offset:2048
    v_mfma_f32_16x16x32_bf16 v[64:67], v[128:131], v[112:115], v[64:67]
    ds_read_b128 v[152:155], v185 offset:4096
    v_mfma_f32_16x16x32_bf16 v[68:71], v[132:135], v[112:115], v[68:71]
    ds_read_b128 v[156:159], v185 offset:6144
    v_mfma_f32_16x16x32_bf16 v[72:75], v[112:115], v[136:139], v[72:75]
    v_mfma_f32_16x16x32_bf16 v[76:79], v[112:115], v[140:143], v[76:79]
    v_mfma_f32_16x16x32_bf16 v[80:83], v[120:123], v[116:119], v[80:83]
    v_mfma_f32_16x16x32_bf16 v[84:87], v[124:127], v[116:119], v[84:87]
    v_mfma_f32_16x16x32_bf16 v[88:91], v[128:131], v[116:119], v[88:91]
    v_mfma_f32_16x16x32_bf16 v[92:95], v[132:135], v[116:119], v[92:95]
    v_mfma_f32_16x16x32_bf16 v[96:99], v[116:119], v[136:139], v[96:99]
    v_mfma_f32_16x16x32_bf16 v[100:103], v[116:119], v[140:143], v[100:103]
    s_waitcnt lgkmcnt(0)
    s_barrier
    v_mfma_f32_16x16x32_bf16 v[8:11], v[160:163], v[144:147], v[8:11]
    ds_read_b128 v[104:107], v184 offset:40960
    v_mfma_f32_16x16x32_bf16 v[12:15], v[164:167], v[144:147], v[12:15]
    ds_read_b64_tr_b16 v[120:121], v186 offset:40960
    v_mfma_f32_16x16x32_bf16 v[16:19], v[168:171], v[144:147], v[16:19]
    ds_read_b64_tr_b16 v[122:123], v186 offset:41472
    v_mfma_f32_16x16x32_bf16 v[20:23], v[172:175], v[144:147], v[20:23]
    ds_read_b64_tr_b16 v[124:125], v187 offset:40960
    v_mfma_f32_16x16x32_bf16 v[24:27], v[144:147], v[176:179], v[24:27]
    ds_read_b64_tr_b16 v[126:127], v187 offset:41472
    v_mfma_f32_16x16x32_bf16 v[28:31], v[144:147], v[180:183], v[28:31]
    ds_read_b64_tr_b16 v[128:129], v186 offset:49152
    v_mfma_f32_16x16x32_bf16 v[32:35], v[160:163], v[148:151], v[32:35]
    ds_read_b64_tr_b16 v[130:131], v186 offset:49664
    v_mfma_f32_16x16x32_bf16 v[36:39], v[164:167], v[148:151], v[36:39]
    ds_read_b64_tr_b16 v[132:133], v187 offset:49152
    v_mfma_f32_16x16x32_bf16 v[40:43], v[168:171], v[148:151], v[40:43]
    ds_read_b64_tr_b16 v[134:135], v187 offset:49664
    v_mfma_f32_16x16x32_bf16 v[44:47], v[172:175], v[148:151], v[44:47]
    ds_read_b64_tr_b16 v[136:137], v186 offset:57344
    v_mfma_f32_16x16x32_bf16 v[48:51], v[148:151], v[176:179], v[48:51]
    ds_read_b64_tr_b16 v[138:139], v186 offset:57856
    v_mfma_f32_16x16x32_bf16 v[52:55], v[148:151], v[180:183], v[52:55]
    ds_read_b64_tr_b16 v[140:141], v187 offset:57344
    v_mfma_f32_16x16x32_bf16 v[56:59], v[160:163], v[152:155], v[56:59]
    ds_read_b64_tr_b16 v[142:143], v187 offset:57856
    v_mfma_f32_16x16x32_bf16 v[60:63], v[164:167], v[152:155], v[60:63]
    ds_read_b128 v[108:111], v184 offset:43008
    v_mfma_f32_16x16x32_bf16 v[64:67], v[168:171], v[152:155], v[64:67]
    ds_read_b128 v[112:115], v184 offset:45056
    v_mfma_f32_16x16x32_bf16 v[68:71], v[172:175], v[152:155], v[68:71]
    ds_read_b128 v[116:119], v184 offset:47104
    v_mfma_f32_16x16x32_bf16 v[72:75], v[152:155], v[176:179], v[72:75]
    v_mfma_f32_16x16x32_bf16 v[76:79], v[152:155], v[180:183], v[76:79]
    v_mfma_f32_16x16x32_bf16 v[80:83], v[160:163], v[156:159], v[80:83]
    v_mfma_f32_16x16x32_bf16 v[84:87], v[164:167], v[156:159], v[84:87]
    v_mfma_f32_16x16x32_bf16 v[88:91], v[168:171], v[156:159], v[88:91]
    v_mfma_f32_16x16x32_bf16 v[92:95], v[172:175], v[156:159], v[92:95]
    v_mfma_f32_16x16x32_bf16 v[96:99], v[156:159], v[176:179], v[96:99]
    v_mfma_f32_16x16x32_bf16 v[100:103], v[156:159], v[180:183], v[100:103]
    s_waitcnt lgkmcnt(0)
    s_nop 0
    v_mfma_f32_16x16x32_bf16 v[8:11], v[120:123], v[104:107], v[8:11]
    ds_read_b128 v[144:147], v185 offset:40960
    v_mfma_f32_16x16x32_bf16 v[12:15], v[124:127], v[104:107], v[12:15]
    ds_read_b64_tr_b16 v[160:161], v186 offset:45056
    v_mfma_f32_16x16x32_bf16 v[16:19], v[128:131], v[104:107], v[16:19]
    ds_read_b64_tr_b16 v[162:163], v186 offset:45568
    v_mfma_f32_16x16x32_bf16 v[20:23], v[132:135], v[104:107], v[20:23]
    ds_read_b64_tr_b16 v[164:165], v187 offset:45056
    v_mfma_f32_16x16x32_bf16 v[24:27], v[104:107], v[136:139], v[24:27]
    ds_read_b64_tr_b16 v[166:167], v187 offset:45568
    v_mfma_f32_16x16x32_bf16 v[28:31], v[104:107], v[140:143], v[28:31]
    ds_read_b64_tr_b16 v[168:169], v186 offset:53248
    v_mfma_f32_16x16x32_bf16 v[32:35], v[120:123], v[108:111], v[32:35]
    ds_read_b64_tr_b16 v[170:171], v186 offset:53760
    v_mfma_f32_16x16x32_bf16 v[36:39], v[124:127], v[108:111], v[36:39]
    ds_read_b64_tr_b16 v[172:173], v187 offset:53248
    v_mfma_f32_16x16x32_bf16 v[40:43], v[128:131], v[108:111], v[40:43]
    ds_read_b64_tr_b16 v[174:175], v187 offset:53760
    v_mfma_f32_16x16x32_bf16 v[44:47], v[132:135], v[108:111], v[44:47]
    ds_read_b64_tr_b16 v[176:177], v186 offset:61440
    v_mfma_f32_16x16x32_bf16 v[48:51], v[108:111], v[136:139], v[48:51]
    ds_read_b64_tr_b16 v[178:179], v186 offset:61952
    v_mfma_f32_16x16x32_bf16 v[52:55], v[108:111], v[140:143], v[52:55]
    ds_read_b64_tr_b16 v[180:181], v187 offset:61440
    v_mfma_f32_16x16x32_bf16 v[56:59], v[120:123], v[112:115], v[56:59]
    ds_read_b64_tr_b16 v[182:183], v187 offset:61952
    v_mfma_f32_16x16x32_bf16 v[60:63], v[124:127], v[112:115], v[60:63]
    ds_read_b128 v[148:151], v185 offset:43008
    v_mfma_f32_16x16x32_bf16 v[64:67], v[128:131], v[112:115], v[64:67]
    ds_read_b128 v[152:155], v185 offset:45056
    v_mfma_f32_16x16x32_bf16 v[68:71], v[132:135], v[112:115], v[68:71]
    ds_read_b128 v[156:159], v185 offset:47104
    v_mfma_f32_16x16x32_bf16 v[72:75], v[112:115], v[136:139], v[72:75]
    v_mfma_f32_16x16x32_bf16 v[76:79], v[112:115], v[140:143], v[76:79]
    v_mfma_f32_16x16x32_bf16 v[80:83], v[120:123], v[116:119], v[80:83]
    v_mfma_f32_16x16x32_bf16 v[84:87], v[124:127], v[116:119], v[84:87]
    v_mfma_f32_16x16x32_bf16 v[88:91], v[128:131], v[116:119], v[88:91]
    v_mfma_f32_16x16x32_bf16 v[92:95], v[132:135], v[116:119], v[92:95]
    v_mfma_f32_16x16x32_bf16 v[96:99], v[116:119], v[136:139], v[96:99]
    v_mfma_f32_16x16x32_bf16 v[100:103], v[116:119], v[140:143], v[100:103]
    s_waitcnt lgkmcnt(0)
    s_barrier
    v_mfma_f32_16x16x32_bf16 v[8:11], v[160:163], v[144:147], v[8:11]
    ds_read_b128 v[104:107], v188 offset:0
    v_mfma_f32_16x16x32_bf16 v[12:15], v[164:167], v[144:147], v[12:15]
    ds_read_b64_tr_b16 v[120:121], v190 offset:0
    v_mfma_f32_16x16x32_bf16 v[16:19], v[168:171], v[144:147], v[16:19]
    ds_read_b64_tr_b16 v[122:123], v190 offset:512
    v_mfma_f32_16x16x32_bf16 v[20:23], v[172:175], v[144:147], v[20:23]
    ds_read_b64_tr_b16 v[124:125], v191 offset:0
    v_mfma_f32_16x16x32_bf16 v[24:27], v[144:147], v[176:179], v[24:27]
    ds_read_b64_tr_b16 v[126:127], v191 offset:512
    v_mfma_f32_16x16x32_bf16 v[28:31], v[144:147], v[180:183], v[28:31]
    ds_read_b64_tr_b16 v[128:129], v190 offset:8192
    v_mfma_f32_16x16x32_bf16 v[32:35], v[160:163], v[148:151], v[32:35]
    ds_read_b64_tr_b16 v[130:131], v190 offset:8704
    v_mfma_f32_16x16x32_bf16 v[36:39], v[164:167], v[148:151], v[36:39]
    ds_read_b64_tr_b16 v[132:133], v191 offset:8192
    v_mfma_f32_16x16x32_bf16 v[40:43], v[168:171], v[148:151], v[40:43]
    ds_read_b64_tr_b16 v[134:135], v191 offset:8704
    v_mfma_f32_16x16x32_bf16 v[44:47], v[172:175], v[148:151], v[44:47]
    ds_read_b64_tr_b16 v[136:137], v190 offset:16384
    v_mfma_f32_16x16x32_bf16 v[48:51], v[148:151], v[176:179], v[48:51]
    ds_read_b64_tr_b16 v[138:139], v190 offset:16896
    v_mfma_f32_16x16x32_bf16 v[52:55], v[148:151], v[180:183], v[52:55]
    ds_read_b64_tr_b16 v[140:141], v191 offset:16384
    v_mfma_f32_16x16x32_bf16 v[56:59], v[160:163], v[152:155], v[56:59]
    ds_read_b64_tr_b16 v[142:143], v191 offset:16896
    v_mfma_f32_16x16x32_bf16 v[60:63], v[164:167], v[152:155], v[60:63]
    ds_read_b128 v[108:111], v188 offset:2048
    v_mfma_f32_16x16x32_bf16 v[64:67], v[168:171], v[152:155], v[64:67]
    ds_read_b128 v[112:115], v188 offset:4096
    v_mfma_f32_16x16x32_bf16 v[68:71], v[172:175], v[152:155], v[68:71]
    ds_read_b128 v[116:119], v188 offset:6144
    v_mfma_f32_16x16x32_bf16 v[72:75], v[152:155], v[176:179], v[72:75]
    v_mfma_f32_16x16x32_bf16 v[76:79], v[152:155], v[180:183], v[76:79]
    v_mfma_f32_16x16x32_bf16 v[80:83], v[160:163], v[156:159], v[80:83]
    v_mfma_f32_16x16x32_bf16 v[84:87], v[164:167], v[156:159], v[84:87]
    v_mfma_f32_16x16x32_bf16 v[88:91], v[168:171], v[156:159], v[88:91]
    v_mfma_f32_16x16x32_bf16 v[92:95], v[172:175], v[156:159], v[92:95]
    v_mfma_f32_16x16x32_bf16 v[96:99], v[156:159], v[176:179], v[96:99]
    v_mfma_f32_16x16x32_bf16 v[100:103], v[156:159], v[180:183], v[100:103]
    s_waitcnt lgkmcnt(0)
    s_nop 0
    v_mfma_f32_16x16x32_bf16 v[8:11], v[120:123], v[104:107], v[8:11]
    ds_read_b128 v[144:147], v189 offset:0
    v_mfma_f32_16x16x32_bf16 v[12:15], v[124:127], v[104:107], v[12:15]
    ds_read_b64_tr_b16 v[160:161], v190 offset:4096
    v_mfma_f32_16x16x32_bf16 v[16:19], v[128:131], v[104:107], v[16:19]
    ds_read_b64_tr_b16 v[162:163], v190 offset:4608
    v_mfma_f32_16x16x32_bf16 v[20:23], v[132:135], v[104:107], v[20:23]
    ds_read_b64_tr_b16 v[164:165], v191 offset:4096
    v_mfma_f32_16x16x32_bf16 v[24:27], v[104:107], v[136:139], v[24:27]
    ds_read_b64_tr_b16 v[166:167], v191 offset:4608
    v_mfma_f32_16x16x32_bf16 v[28:31], v[104:107], v[140:143], v[28:31]
    ds_read_b64_tr_b16 v[168:169], v190 offset:12288
    v_mfma_f32_16x16x32_bf16 v[32:35], v[120:123], v[108:111], v[32:35]
    ds_read_b64_tr_b16 v[170:171], v190 offset:12800
    v_mfma_f32_16x16x32_bf16 v[36:39], v[124:127], v[108:111], v[36:39]
    ds_read_b64_tr_b16 v[172:173], v191 offset:12288
    v_mfma_f32_16x16x32_bf16 v[40:43], v[128:131], v[108:111], v[40:43]
    ds_read_b64_tr_b16 v[174:175], v191 offset:12800
    v_mfma_f32_16x16x32_bf16 v[44:47], v[132:135], v[108:111], v[44:47]
    ds_read_b64_tr_b16 v[176:177], v190 offset:20480
    v_mfma_f32_16x16x32_bf16 v[48:51], v[108:111], v[136:139], v[48:51]
    ds_read_b64_tr_b16 v[178:179], v190 offset:20992
    v_mfma_f32_16x16x32_bf16 v[52:55], v[108:111], v[140:143], v[52:55]
    ds_read_b64_tr_b16 v[180:181], v191 offset:20480
    v_mfma_f32_16x16x32_bf16 v[56:59], v[120:123], v[112:115], v[56:59]
    ds_read_b64_tr_b16 v[182:183], v191 offset:20992
    v_mfma_f32_16x16x32_bf16 v[60:63], v[124:127], v[112:115], v[60:63]
    ds_read_b128 v[148:151], v189 offset:2048
    v_mfma_f32_16x16x32_bf16 v[64:67], v[128:131], v[112:115], v[64:67]
    ds_read_b128 v[152:155], v189 offset:4096
    v_mfma_f32_16x16x32_bf16 v[68:71], v[132:135], v[112:115], v[68:71]
    ds_read_b128 v[156:159], v189 offset:6144
    v_mfma_f32_16x16x32_bf16 v[72:75], v[112:115], v[136:139], v[72:75]
    s_add_u32 s66, s66, 1
    s_cmp_lt_u32 s66, 5
    v_mfma_f32_16x16x32_bf16 v[76:79], v[112:115], v[140:143], v[76:79]
    v_mfma_f32_16x16x32_bf16 v[80:83], v[120:123], v[116:119], v[80:83]
    v_mfma_f32_16x16x32_bf16 v[84:87], v[124:127], v[116:119], v[84:87]
    v_mfma_f32_16x16x32_bf16 v[88:91], v[128:131], v[116:119], v[88:91]
    v_mfma_f32_16x16x32_bf16 v[92:95], v[132:135], v[116:119], v[92:95]
    v_mfma_f32_16x16x32_bf16 v[96:99], v[116:119], v[136:139], v[96:99]
    v_mfma_f32_16x16x32_bf16 v[100:103], v[116:119], v[140:143], v[100:103]
    s_cbranch_scc1 L_cloop
    s_nop 0
    s_waitcnt lgkmcnt(0)
    s_barrier
    v_mfma_f32_16x16x32_bf16 v[8:11], v[160:163], v[144:147], v[8:11]
    ds_read_b128 v[104:107], v184 offset:0
    v_mfma_f32_16x16x32_bf16 v[12:15], v[164:167], v[144:147], v[12:15]
    ds_read_b64_tr_b16 v[120:121], v186 offset:0
    v_mfma_f32_16x16x32_bf16 v[16:19], v[168:171], v[144:147], v[16:19]
    ds_read_b64_tr_b16 v[122:123], v186 offset:512
    v_mfma_f32_16x16x32_bf16 v[20:23], v[172:175], v[144:147], v[20:23]
    ds_read_b64_tr_b16 v[124:125], v187 offset:0
    v_mfma_f32_16x16x32_bf16 v[24:27], v[144:147], v[176:179], v[24:27]
    ds_read_b64_tr_b16 v[126:127], v187 offset:512
    v_mfma_f32_16x16x32_bf16 v[28:31], v[144:147], v[180:183], v[28:31]
    ds_read_b64_tr_b16 v[128:129], v186 offset:8192
    v_mfma_f32_16x16x32_bf16 v[32:35], v[160:163], v[148:151], v[32:35]
    ds_read_b64_tr_b16 v[130:131], v186 offset:8704
    v_mfma_f32_16x16x32_bf16 v[36:39], v[164:167], v[148:151], v[36:39]
    ds_read_b64_tr_b16 v[132:133], v187 offset:8192
    v_mfma_f32_16x16x32_bf16 v[40:43], v[168:171], v[148:151], v[40:43]
    ds_read_b64_tr_b16 v[134:135], v187 offset:8704
    v_mfma_f32_16x16x32_bf16 v[44:47], v[172:175], v[148:151], v[44:47]
    ds_read_b64_tr_b16 v[136:137], v186 offset:16384
    v_mfma_f32_16x16x32_bf16 v[48:51], v[148:151], v[176:179], v[48:51]
    ds_read_b64_tr_b16 v[138:139], v186 offset:16896
    v_mfma_f32_16x16x32_bf16 v[52:55], v[148:151], v[180:183], v[52:55]
    ds_read_b64_tr_b16 v[140:141], v187 offset:16384
    v_mfma_f32_16x16x32_bf16 v[56:59], v[160:163], v[152:155], v[56:59]
    ds_read_b64_tr_b16 v[142:143], v187 offset:16896
    v_mfma_f32_16x16x32_bf16 v[60:63], v[164:167], v[152:155], v[60:63]
    ds_read_b128 v[108:111], v184 offset:2048
    v_mfma_f32_16x16x32_bf16 v[64:67], v[168:171], v[152:155], v[64:67]
    ds_read_b128 v[112:115], v184 offset:4096
    v_mfma_f32_16x16x32_bf16 v[68:71], v[172:175], v[152:155], v[68:71]
    ds_read_b128 v[116:119], v184 offset:6144
    v_mfma_f32_16x16x32_bf16 v[72:75], v[152:155], v[176:179], v[72:75]
    ds_read_b32 v192, v232 offset:0
    v_mfma_f32_16x16x32_bf16 v[76:79], v[152:155], v[180:183], v[76:79]
    ds_read_b32 v194, v232 offset:64
    v_mfma_f32_16x16x32_bf16 v[80:83], v[160:163], v[156:159], v[80:83]
    ds_read_b32 v196, v232 offset:128
    v_mfma_f32_16x16x32_bf16 v[84:87], v[164:167], v[156:159], v[84:87]
    ds_read_b32 v198, v232 offset:192
    v_mfma_f32_16x16x32_bf16 v[88:91], v[168:171], v[156:159], v[88:91]
    ds_read_b128 v[204:207], v235 offset:256
    v_mfma_f32_16x16x32_bf16 v[92:95], v[172:175], v[156:159], v[92:95]
    ds_read_b128 v[208:211], v235 offset:320
    v_mfma_f32_16x16x32_bf16 v[96:99], v[156:159], v[176:179], v[96:99]
    ds_read_b128 v[212:215], v235 offset:0
    v_mfma_f32_16x16x32_bf16 v[100:103], v[156:159], v[180:183], v[100:103]
    ds_read_b128 v[216:219], v235 offset:64
    s_waitcnt lgkmcnt(8)
    s_nop 0
    v_mfma_f32_16x16x32_bf16 v[8:11], v[120:123], v[104:107], v[8:11]
    ds_read_b128 v[144:147], v185 offset:0
    v_mfma_f32_16x16x32_bf16 v[12:15], v[124:127], v[104:107], v[12:15]
    ds_read_b64_tr_b16 v[160:161], v186 offset:4096
    v_mfma_f32_16x16x32_bf16 v[16:19], v[128:131], v[104:107], v[16:19]
    ds_read_b64_tr_b16 v[162:163], v186 offset:4608
    v_mfma_f32_16x16x32_bf16 v[20:23], v[132:135], v[104:107], v[20:23]
    ds_read_b64_tr_b16 v[164:165], v187 offset:4096
    v_mfma_f32_16x16x32_bf16 v[24:27], v[104:107], v[136:139], v[24:27]
    ds_read_b64_tr_b16 v[166:167], v187 offset:4608
    v_mfma_f32_16x16x32_bf16 v[28:31], v[104:107], v[140:143], v[28:31]
    ds_read_b64_tr_b16 v[168:169], v186 offset:12288
    v_mfma_f32_16x16x32_bf16 v[32:35], v[120:123], v[108:111], v[32:35]
    ds_read_b64_tr_b16 v[170:171], v186 offset:12800
    v_mfma_f32_16x16x32_bf16 v[36:39], v[124:127], v[108:111], v[36:39]
    ds_read_b64_tr_b16 v[172:173], v187 offset:12288
    v_mfma_f32_16x16x32_bf16 v[40:43], v[128:131], v[108:111], v[40:43]
    ds_read_b64_tr_b16 v[174:175], v187 offset:12800
    v_mfma_f32_16x16x32_bf16 v[44:47], v[132:135], v[108:111], v[44:47]
    ds_read_b64_tr_b16 v[176:177], v186 offset:20480
    v_mfma_f32_16x16x32_bf16 v[48:51], v[108:111], v[136:139], v[48:51]
    ds_read_b64_tr_b16 v[178:179], v186 offset:20992
    v_mfma_f32_16x16x32_bf16 v[52:55], v[108:111], v[140:143], v[52:55]
    ds_read_b64_tr_b16 v[180:181], v187 offset:20480
    v_mfma_f32_16x16x32_bf16 v[56:59], v[120:123], v[112:115], v[56:59]
    ds_read_b64_tr_b16 v[182:183], v187 offset:20992
    v_mfma_f32_16x16x32_bf16 v[60:63], v[124:127], v[112:115], v[60:63]
    ds_read_b128 v[148:151], v185 offset:2048
    v_mfma_f32_16x16x32_bf16 v[64:67], v[128:131], v[112:115], v[64:67]
    ds_read_b128 v[152:155], v185 offset:4096
    v_mfma_f32_16x16x32_bf16 v[68:71], v[132:135], v[112:115], v[68:71]
    ds_read_b128 v[156:159], v185 offset:6144
    v_mfma_f32_16x16x32_bf16 v[72:75], v[112:115], v[136:139], v[72:75]
    ds_read_b64_tr_b16 v[224:225], v252 offset:0
    v_mfma_f32_16x16x32_bf16 v[76:79], v[112:115], v[140:143], v[76:79]
    ds_read_b64_tr_b16 v[226:227], v252 offset:1024
    v_mfma_f32_16x16x32_bf16 v[80:83], v[120:123], v[116:119], v[80:83]
    ds_read_b64_tr_b16 v[228:229], v252 offset:32
    v_mfma_f32_16x16x32_bf16 v[84:87], v[124:127], v[116:119], v[84:87]
    ds_read_b64_tr_b16 v[230:231], v252 offset:1056
    v_mfma_f32_16x16x32_bf16 v[88:91], v[128:131], v[116:119], v[88:91]
    v_mfma_f32_16x16x32_bf16 v[92:95], v[132:135], v[116:119], v[92:95]
    v_mfma_f32_16x16x32_bf16 v[96:99], v[116:119], v[136:139], v[96:99]
    v_mfma_f32_16x16x32_bf16 v[100:103], v[116:119], v[140:143], v[100:103]
    s_waitcnt lgkmcnt(4)
    v_mfma_f32_16x16x32_bf16 v[16:19], v[168:171], v[144:147], v[16:19]
    s_barrier
    v_mfma_f32_16x16x32_bf16 v[20:23], v[172:175], v[144:147], v[20:23]
    ds_read_b128 v[104:107], v233 offset:0
    ds_read_b128 v[108:111], v233 offset:64
    v_mfma_f32_16x16x32_bf16 v[40:43], v[168:171], v[148:151], v[40:43]
    ds_read_b128 v[112:115], v233 offset:128
    ds_read_b128 v[116:119], v233 offset:192
    v_mfma_f32_16x16x32_bf16 v[44:47], v[172:175], v[148:151], v[44:47]
    ds_read_b32 v250, v248 offset:576
    ds_read_b32 v248, v248 offset:512
    v_mfma_f32_16x16x32_bf16 v[64:67], v[168:171], v[152:155], v[64:67]
    ds_read_b32 v200, v232 offset:2048
    ds_read_b32 v202, v232 offset:2112
    v_mfma_f32_16x16x32_bf16 v[68:71], v[172:175], v[152:155], v[68:71]
    ds_read_b32 v220, v232 offset:2176
    ds_read_b32 v222, v232 offset:2240
    v_mfma_f32_16x16x32_bf16 v[88:91], v[168:171], v[156:159], v[88:91]
    ds_read_b32 v193, v234 offset:2048
    ds_read_b32 v195, v234 offset:1024
    v_mfma_f32_16x16x32_bf16 v[92:95], v[172:175], v[156:159], v[92:95]
    ds_read_b32 v221, v234 offset:2176
    ds_read_b32 v223, v234 offset:1152
    v_mfma_f32_16x16x32_bf16 v[24:27], v[144:147], v[176:179], v[24:27]
    v_fma_f32 v16, -v192, v204, v16
    v_fma_f32 v17, -v192, v205, v17
    v_fma_f32 v18, -v192, v206, v18
    v_mfma_f32_16x16x32_bf16 v[28:31], v[144:147], v[180:183], v[28:31]
    v_fma_f32 v19, -v192, v207, v19
    v_fma_f32 v20, -v192, v208, v20
    v_fma_f32 v21, -v192, v209, v21
    v_mfma_f32_16x16x32_bf16 v[48:51], v[148:151], v[176:179], v[48:51]
    v_fma_f32 v22, -v192, v210, v22
    v_fma_f32 v23, -v192, v211, v23
    v_cvt_pk_bf16_f32 v16, v16, v17
    v_mfma_f32_16x16x32_bf16 v[52:55], v[148:151], v[180:183], v[52:55]
    v_cvt_pk_bf16_f32 v17, v18, v19
    v_cvt_pk_bf16_f32 v18, v20, v21
    v_cvt_pk_bf16_f32 v19, v22, v23
    v_mfma_f32_16x16x32_bf16 v[72:75], v[152:155], v[176:179], v[72:75]
    v_fma_f32 v40, -v194, v204, v40
    v_fma_f32 v41, -v194, v205, v41
    v_fma_f32 v42, -v194, v206, v42
    v_mfma_f32_16x16x32_bf16 v[76:79], v[152:155], v[180:183], v[76:79]
    v_fma_f32 v43, -v194, v207, v43
    v_fma_f32 v44, -v194, v208, v44
    v_fma_f32 v45, -v194, v209, v45
    v_mfma_f32_16x16x32_bf16 v[96:99], v[156:159], v[176:179], v[96:99]
    v_fma_f32 v46, -v194, v210, v46
    v_fma_f32 v47, -v194, v211, v47
    v_cvt_pk_bf16_f32 v40, v40, v41
    v_mfma_f32_16x16x32_bf16 v[100:103], v[156:159], v[180:183], v[100:103]
    v_cvt_pk_bf16_f32 v41, v42, v43
    v_cvt_pk_bf16_f32 v42, v44, v45
    v_cvt_pk_bf16_f32 v43, v46, v47
    v_mfma_f32_16x16x32_bf16 v[8:11], v[160:163], v[144:147], v[8:11]
    v_fma_f32 v64, -v196, v204, v64
    v_fma_f32 v65, -v196, v205, v65
    v_fma_f32 v66, -v196, v206, v66
    v_mfma_f32_16x16x32_bf16 v[12:15], v[164:167], v[144:147], v[12:15]
    v_fma_f32 v67, -v196, v207, v67
    v_fma_f32 v68, -v196, v208, v68
    v_fma_f32 v69, -v196, v209, v69
    v_mfma_f32_16x16x32_bf16 v[32:35], v[160:163], v[148:151], v[32:35]
    v_fma_f32 v70, -v196, v210, v70
    v_fma_f32 v71, -v196, v211, v71
    v_cvt_pk_bf16_f32 v64, v64, v65
    v_mfma_f32_16x16x32_bf16 v[36:39], v[164:167], v[148:151], v[36:39]
    v_cvt_pk_bf16_f32 v65, v66, v67
    v_cvt_pk_bf16_f32 v66, v68, v69
    v_cvt_pk_bf16_f32 v67, v70, v71
    v_mfma_f32_16x16x32_bf16 v[56:59], v[160:163], v[152:155], v[56:59]
    v_fma_f32 v88, -v198, v204, v88
    v_fma_f32 v89, -v198, v205, v89
    v_fma_f32 v90, -v198, v206, v90
    v_mfma_f32_16x16x32_bf16 v[60:63], v[164:167], v[152:155], v[60:63]
    v_fma_f32 v91, -v198, v207, v91
    v_fma_f32 v92, -v198, v208, v92
    v_fma_f32 v93, -v198, v209, v93
    v_mfma_f32_16x16x32_bf16 v[80:83], v[160:163], v[156:159], v[80:83]
    v_fma_f32 v94, -v198, v210, v94
    v_fma_f32 v95, -v198, v211, v95
    v_cvt_pk_bf16_f32 v88, v88, v89
    v_mfma_f32_16x16x32_bf16 v[84:87], v[164:167], v[156:159], v[84:87]
    v_cvt_pk_bf16_f32 v89, v90, v91
    v_cvt_pk_bf16_f32 v90, v92, v93
    v_cvt_pk_bf16_f32 v91, v94, v95
    ds_read_b128 v[120:123], v249 offset:0
    ds_read_b128 v[124:127], v249 offset:64
    s_waitcnt lgkmcnt(2)
    s_nop 0
    v_mfma_f32_16x16x32_bf16 v[144:147], v[224:227], v[16:19], 0
    v_mfma_f32_16x16x32_bf16 v[148:151], v[228:231], v[16:19], 0
    v_mfma_f32_16x16x32_bf16 v[152:155], v[224:227], v[40:43], 0
    v_mfma_f32_16x16x32_bf16 v[156:159], v[228:231], v[40:43], 0
    v_mfma_f32_16x16x32_bf16 v[160:163], v[224:227], v[64:67], 0
    v_mfma_f32_16x16x32_bf16 v[164:167], v[228:231], v[64:67], 0
    v_mfma_f32_16x16x32_bf16 v[168:171], v[224:227], v[88:91], 0
    v_mfma_f32_16x16x32_bf16 v[172:175], v[228:231], v[88:91], 0
    v_pk_fma_f32 v[24:25], v[104:105], v[248:249], v[24:25] op_sel_hi:[1,0,1] neg_lo:[1,0,0] neg_hi:[1,0,0]
    v_pk_fma_f32 v[26:27], v[106:107], v[248:249], v[26:27] op_sel_hi:[1,0,1] neg_lo:[1,0,0] neg_hi:[1,0,0]
    v_pk_fma_f32 v[28:29], v[104:105], v[250:251], v[28:29] op_sel_hi:[1,0,1] neg_lo:[1,0,0] neg_hi:[1,0,0]
    v_pk_fma_f32 v[30:31], v[106:107], v[250:251], v[30:31] op_sel_hi:[1,0,1] neg_lo:[1,0,0] neg_hi:[1,0,0]
    v_pk_fma_f32 v[48:49], v[108:109], v[248:249], v[48:49] op_sel_hi:[1,0,1] neg_lo:[1,0,0] neg_hi:[1,0,0]
    v_pk_fma_f32 v[50:51], v[110:111], v[248:249], v[50:51] op_sel_hi:[1,0,1] neg_lo:[1,0,0] neg_hi:[1,0,0]
    v_pk_fma_f32 v[52:53], v[108:109], v[250:251], v[52:53] op_sel_hi:[1,0,1] neg_lo:[1,0,0] neg_hi:[1,0,0]
    v_pk_fma_f32 v[54:55], v[110:111], v[250:251], v[54:55] op_sel_hi:[1,0,1] neg_lo:[1,0,0] neg_hi:[1,0,0]
    v_pk_fma_f32 v[72:73], v[112:113], v[248:249], v[72:73] op_sel_hi:[1,0,1] neg_lo:[1,0,0] neg_hi:[1,0,0]
    v_pk_fma_f32 v[74:75], v[114:115], v[248:249], v[74:75] op_sel_hi:[1,0,1] neg_lo:[1,0,0] neg_hi:[1,0,0]
    v_pk_fma_f32 v[76:77], v[112:113], v[250:251], v[76:77] op_sel_hi:[1,0,1] neg_lo:[1,0,0] neg_hi:[1,0,0]
    v_pk_fma_f32 v[78:79], v[114:115], v[250:251], v[78:79] op_sel_hi:[1,0,1] neg_lo:[1,0,0] neg_hi:[1,0,0]
    v_pk_fma_f32 v[96:97], v[116:117], v[248:249], v[96:97] op_sel_hi:[1,0,1] neg_lo:[1,0,0] neg_hi:[1,0,0]
    v_pk_fma_f32 v[98:99], v[118:119], v[248:249], v[98:99] op_sel_hi:[1,0,1] neg_lo:[1,0,0] neg_hi:[1,0,0]
    v_pk_fma_f32 v[100:101], v[116:117], v[250:251], v[100:101] op_sel_hi:[1,0,1] neg_lo:[1,0,0] neg_hi:[1,0,0]
    v_pk_fma_f32 v[102:103], v[118:119], v[250:251], v[102:103] op_sel_hi:[1,0,1] neg_lo:[1,0,0] neg_hi:[1,0,0]
    v_cvt_pk_bf16_f32 v24, v24, v25
    v_cvt_pk_bf16_f32 v25, v26, v27
    v_cvt_pk_bf16_f32 v26, v48, v49
    v_cvt_pk_bf16_f32 v27, v50, v51
    v_cvt_pk_bf16_f32 v28, v28, v29
    v_cvt_pk_bf16_f32 v29, v30, v31
    v_cvt_pk_bf16_f32 v30, v52, v53
    v_cvt_pk_bf16_f32 v31, v54, v55
    v_cvt_pk_bf16_f32 v72, v72, v73
    v_cvt_pk_bf16_f32 v73, v74, v75
    v_cvt_pk_bf16_f32 v74, v96, v97
    v_cvt_pk_bf16_f32 v75, v98, v99
    v_cvt_pk_bf16_f32 v76, v76, v77
    v_cvt_pk_bf16_f32 v77, v78, v79
    v_cvt_pk_bf16_f32 v78, v100, v101
    v_cvt_pk_bf16_f32 v79, v102, v103
    ds_read_b128 v[104:107], v253 offset:0
    ds_read_b128 v[108:111], v253 offset:64
    v_max3_f32 v176, v144, v145, v146
    v_max3_f32 v184, -v144, -v145, -v146
    v_max3_f32 v178, v152, v153, v154
    v_max3_f32 v186, -v152, -v153, -v154
    v_max3_f32 v176, v176, v147, v148
    v_max3_f32 v184, v184, -v147, -v148
    v_max3_f32 v178, v178, v155, v156
    v_max3_f32 v186, v186, -v155, -v156
    v_max3_f32 v176, v176, v149, v150
    v_max3_f32 v184, v184, -v149, -v150
    v_max3_f32 v178, v178, v157, v158
    v_max3_f32 v186, v186, -v157, -v158
    v_max_f32_e64 v176, v176, v151
    v_max_f32_e64 v184, v184, -v151
    v_max_f32_e64 v178, v178, v159
    v_max_f32_e64 v186, v186, -v159
    s_nop 0
    v_permlane32_swap_b32 v176, v178
    v_permlane32_swap_b32_e64 v184, v186
    v_max3_f32 v180, v160, v161, v162
    v_max3_f32 v188, -v160, -v161, -v162
    v_max_f32 v176, v176, v178
    v_max_f32 v184, v184, v186
    v_max3_f32 v182, v168, v169, v170
    v_max3_f32 v190, -v168, -v169, -v170
    v_permlane16_swap_b32 v176, v184
    v_max_f32 v176, v176, v184
    v_max3_f32 v180, v180, v163, v164
    v_max3_f32 v188, v188, -v163, -v164
    v_mul_f32 v184, v176, v193
    v_mul_f32 v176, v176, v193
    v_max3_f32 v182, v182, v171, v172
    v_max3_f32 v190, v190, -v171, -v172
    v_permlane16_swap_b32 v176, v184
    v_mov_b32 v178, v176
    v_max3_f32 v180, v180, v165, v166
    v_max3_f32 v188, v188, -v165, -v166
    v_mov_b32_e64 v186, v184
    v_max3_f32 v182, v182, v173, v174
    v_max3_f32 v190, v190, -v173, -v174
    v_permlane32_swap_b32 v176, v178
    v_permlane32_swap_b32 v184, v186
    v_max_f32_e64 v180, v180, v167
    v_max_f32_e64 v188, v188, -v167
    v_max_f32_e64 v182, v182, v175
    v_max_f32_e64 v190, v190, -v175
    s_nop 0
    v_permlane32_swap_b32 v180, v182
    v_permlane32_swap_b32_e64 v188, v190
    v_pk_fma_f32 v[16:17], v[144:145], v[200:201], v[184:185] op_sel_hi:[1,0,0] neg_lo:[1,0,1] neg_hi:[1,0,1]
    v_pk_fma_f32 v[144:145], v[144:145], v[200:201], v[176:177] op_sel_hi:[1,0,0] neg_lo:[0,0,1] neg_hi:[0,0,1]
    v_max_f32 v180, v180, v182
    v_max_f32 v188, v188, v190
    v_pk_fma_f32 v[18:19], v[146:147], v[200:201], v[184:185] op_sel_hi:[1,0,0] neg_lo:[1,0,1] neg_hi:[1,0,1]
    v_pk_fma_f32 v[146:147], v[146:147], v[200:201], v[176:177] op_sel_hi:[1,0,0] neg_lo:[0,0,1] neg_hi:[0,0,1]
    v_permlane16_swap_b32 v180, v188
    v_max_f32 v180, v180, v188
    v_pk_fma_f32 v[20:21], v[148:149], v[200:201], v[184:185] op_sel_hi:[1,0,0] neg_lo:[1,0,1] neg_hi:[1,0,1]
    v_pk_fma_f32 v[148:149], v[148:149], v[200:201], v[176:177] op_sel_hi:[1,0,0] neg_lo:[0,0,1] neg_hi:[0,0,1]
    v_mul_f32 v188, v180, v221
    v_mul_f32 v180, v180, v221
    v_pk_fma_f32 v[22:23], v[150:151], v[200:201], v[184:185] op_sel_hi:[1,0,0] neg_lo:[1,0,1] neg_hi:[1,0,1]
    v_pk_fma_f32 v[150:151], v[150:151], v[200:201], v[176:177] op_sel_hi:[1,0,0] neg_lo:[0,0,1] neg_hi:[0,0,1]
    v_permlane16_swap_b32 v180, v188
    v_mov_b32 v182, v180
    v_pk_fma_f32 v[40:41], v[152:153], v[202:203], v[186:187] op_sel_hi:[1,0,0] neg_lo:[1,0,1] neg_hi:[1,0,1]
    v_pk_fma_f32 v[152:153], v[152:153], v[202:203], v[178:179] op_sel_hi:[1,0,0] neg_lo:[0,0,1] neg_hi:[0,0,1]
    v_mov_b32_e64 v190, v188
    v_pk_fma_f32 v[42:43], v[154:155], v[202:203], v[186:187] op_sel_hi:[1,0,0] neg_lo:[1,0,1] neg_hi:[1,0,1]
    v_pk_fma_f32 v[154:155], v[154:155], v[202:203], v[178:179] op_sel_hi:[1,0,0] neg_lo:[0,0,1] neg_hi:[0,0,1]
    v_permlane32_swap_b32 v180, v182
    v_permlane32_swap_b32 v188, v190
    v_pk_fma_f32 v[44:45], v[156:157], v[202:203], v[186:187] op_sel_hi:[1,0,0] neg_lo:[1,0,1] neg_hi:[1,0,1]
    v_pk_fma_f32 v[156:157], v[156:157], v[202:203], v[178:179] op_sel_hi:[1,0,0] neg_lo:[0,0,1] neg_hi:[0,0,1]
    v_pk_fma_f32 v[46:47], v[158:159], v[202:203], v[186:187] op_sel_hi:[1,0,0] neg_lo:[1,0,1] neg_hi:[1,0,1]
    v_pk_fma_f32 v[158:159], v[158:159], v[202:203], v[178:179] op_sel_hi:[1,0,0] neg_lo:[0,0,1] neg_hi:[0,0,1]
    v_exp_f32 v16, v16
    v_exp_f32 v144, v144
    v_exp_f32 v17, v17
    v_exp_f32 v145, v145
    v_exp_f32 v18, v18
    v_exp_f32 v146, v146
    v_exp_f32 v19, v19
    v_exp_f32 v147, v147
    v_exp_f32 v20, v20
    v_exp_f32 v148, v148
    v_exp_f32 v21, v21
    v_exp_f32 v149, v149
    v_exp_f32 v22, v22
    v_exp_f32 v150, v150
    v_exp_f32 v23, v23
    v_exp_f32 v151, v151
    v_exp_f32 v40, v40
    v_exp_f32 v152, v152
    v_exp_f32 v41, v41
    v_exp_f32 v153, v153
    v_exp_f32 v42, v42
    v_exp_f32 v154, v154
    v_exp_f32 v43, v43
    v_exp_f32 v155, v155
    v_exp_f32 v44, v44
    v_exp_f32 v156, v156
    v_exp_f32 v45, v45
    v_exp_f32 v157, v157
    v_exp_f32 v46, v46
    v_exp_f32 v158, v158
    v_exp_f32 v47, v47
    v_exp_f32 v159, v159
    v_pk_add_f32 v[128:129], v[144:145], v[146:147]
    v_pk_add_f32 v[130:131], v[16:17], v[18:19]
    v_pk_add_f32 v[132:133], v[152:153], v[154:155]
    v_pk_add_f32 v[134:135], v[40:41], v[42:43]
    v_pk_add_f32 v[128:129], v[128:129], v[148:149]
    v_pk_add_f32 v[130:131], v[130:131], v[20:21]
    v_pk_add_f32 v[132:133], v[132:133], v[156:157]
    v_pk_add_f32 v[134:135], v[134:135], v[44:45]
    v_pk_add_f32 v[128:129], v[128:129], v[150:151]
    v_pk_add_f32 v[130:131], v[130:131], v[22:23]
    v_pk_add_f32 v[132:133], v[132:133], v[158:159]
    v_pk_add_f32 v[134:135], v[134:135], v[46:47]
    v_add_f32 v176, v128, v129
    v_add_f32 v184, v130, v131
    v_add_f32 v178, v132, v133
    v_add_f32 v186, v134, v135
    s_nop 0
    v_permlane32_swap_b32 v176, v178
    v_permlane32_swap_b32_e64 v184, v186
    v_pk_fma_f32 v[64:65], v[160:161], v[220:221], v[188:189] op_sel_hi:[1,0,0] neg_lo:[1,0,1] neg_hi:[1,0,1]
    v_pk_fma_f32 v[160:161], v[160:161], v[220:221], v[180:181] op_sel_hi:[1,0,0] neg_lo:[0,0,1] neg_hi:[0,0,1]
    v_add_f32 v176, v176, v178
    v_add_f32 v184, v184, v186
    v_pk_fma_f32 v[66:67], v[162:163], v[220:221], v[188:189] op_sel_hi:[1,0,0] neg_lo:[1,0,1] neg_hi:[1,0,1]
    v_pk_fma_f32 v[162:163], v[162:163], v[220:221], v[180:181] op_sel_hi:[1,0,0] neg_lo:[0,0,1] neg_hi:[0,0,1]
    v_permlane16_swap_b32 v176, v184
    v_add_f32 v176, v176, v184
    v_pk_fma_f32 v[68:69], v[164:165], v[220:221], v[188:189] op_sel_hi:[1,0,0] neg_lo:[1,0,1] neg_hi:[1,0,1]
    v_pk_fma_f32 v[164:165], v[164:165], v[220:221], v[180:181] op_sel_hi:[1,0,0] neg_lo:[0,0,1] neg_hi:[0,0,1]
    v_rcp_f32_e64 v176, v176
    v_pk_fma_f32 v[70:71], v[166:167], v[220:221], v[188:189] op_sel_hi:[1,0,0] neg_lo:[1,0,1] neg_hi:[1,0,1]
    v_pk_fma_f32 v[166:167], v[166:167], v[220:221], v[180:181] op_sel_hi:[1,0,0] neg_lo:[0,0,1] neg_hi:[0,0,1]
    v_mul_f32 v184, v176, v195
    v_mul_f32 v176, v176, v195
    v_pk_fma_f32 v[88:89], v[168:169], v[222:223], v[190:191] op_sel_hi:[1,0,0] neg_lo:[1,0,1] neg_hi:[1,0,1]
    v_pk_fma_f32 v[168:169], v[168:169], v[222:223], v[182:183] op_sel_hi:[1,0,0] neg_lo:[0,0,1] neg_hi:[0,0,1]
    v_permlane16_swap_b32 v176, v184
    v_mov_b32 v178, v176
    v_pk_fma_f32 v[90:91], v[170:171], v[222:223], v[190:191] op_sel_hi:[1,0,0] neg_lo:[1,0,1] neg_hi:[1,0,1]
    v_pk_fma_f32 v[170:171], v[170:171], v[222:223], v[182:183] op_sel_hi:[1,0,0] neg_lo:[0,0,1] neg_hi:[0,0,1]
    v_mov_b32_e64 v186, v184
    v_pk_fma_f32 v[92:93], v[172:173], v[222:223], v[190:191] op_sel_hi:[1,0,0] neg_lo:[1,0,1] neg_hi:[1,0,1]
    v_pk_fma_f32 v[172:173], v[172:173], v[222:223], v[182:183] op_sel_hi:[1,0,0] neg_lo:[0,0,1] neg_hi:[0,0,1]
    v_permlane32_swap_b32 v176, v178
    v_permlane32_swap_b32 v184, v186
    v_pk_fma_f32 v[94:95], v[174:175], v[222:223], v[190:191] op_sel_hi:[1,0,0] neg_lo:[1,0,1] neg_hi:[1,0,1]
    v_pk_fma_f32 v[174:175], v[174:175], v[222:223], v[182:183] op_sel_hi:[1,0,0] neg_lo:[0,0,1] neg_hi:[0,0,1]
    v_pk_mul_f32 v[144:145], v[144:145], v[176:177] op_sel_hi:[1,0]
    v_pk_mul_f32 v[146:147], v[146:147], v[176:177] op_sel_hi:[1,0]
    v_pk_mul_f32 v[148:149], v[148:149], v[176:177] op_sel_hi:[1,0]
    v_pk_mul_f32 v[150:151], v[150:151], v[176:177] op_sel_hi:[1,0]
    v_cvt_pk_bf16_f32 v144, v144, v145
    v_cvt_pk_bf16_f32 v145, v146, v147
    v_cvt_pk_bf16_f32 v146, v148, v149
    v_cvt_pk_bf16_f32 v147, v150, v151
    ds_write_b64 v4, v[144:145] offset:0
    ds_write_b64 v5, v[146:147] offset:0
    ds_write_b128 v197, v[24:27] offset:0
    v_pk_mul_f32 v[16:17], v[16:17], v[184:185] op_sel_hi:[1,0]
    v_pk_mul_f32 v[18:19], v[18:19], v[184:185] op_sel_hi:[1,0]
    v_pk_mul_f32 v[20:21], v[20:21], v[184:185] op_sel_hi:[1,0]
    v_pk_mul_f32 v[22:23], v[22:23], v[184:185] op_sel_hi:[1,0]
    v_cvt_pk_bf16_f32 v16, v16, v17
    v_cvt_pk_bf16_f32 v17, v18, v19
    v_cvt_pk_bf16_f32 v18, v20, v21
    v_cvt_pk_bf16_f32 v19, v22, v23
    ds_write_b64 v6, v[16:17] offset:0
    ds_write_b64 v7, v[18:19] offset:0
    ds_write_b128 v197, v[28:31] offset:1024
    v_pk_mul_f32 v[152:153], v[152:153], v[178:179] op_sel_hi:[1,0]
    v_pk_mul_f32 v[154:155], v[154:155], v[178:179] op_sel_hi:[1,0]
    v_pk_mul_f32 v[156:157], v[156:157], v[178:179] op_sel_hi:[1,0]
    v_pk_mul_f32 v[158:159], v[158:159], v[178:179] op_sel_hi:[1,0]
    v_cvt_pk_bf16_f32 v152, v152, v153
    v_cvt_pk_bf16_f32 v153, v154, v155
    v_cvt_pk_bf16_f32 v154, v156, v157
    v_cvt_pk_bf16_f32 v155, v158, v159
    ds_write_b64 v4, v[152:153] offset:2048
    ds_write_b64 v5, v[154:155] offset:2048
    ds_write_b128 v197, v[72:75] offset:2048
    v_pk_mul_f32 v[40:41], v[40:41], v[186:187] op_sel_hi:[1,0]
    v_pk_mul_f32 v[42:43], v[42:43], v[186:187] op_sel_hi:[1,0]
    v_pk_mul_f32 v[44:45], v[44:45], v[186:187] op_sel_hi:[1,0]
    v_pk_mul_f32 v[46:47], v[46:47], v[186:187] op_sel_hi:[1,0]
    v_cvt_pk_bf16_f32 v40, v40, v41
    v_cvt_pk_bf16_f32 v41, v42, v43
    v_cvt_pk_bf16_f32 v42, v44, v45
    v_cvt_pk_bf16_f32 v43, v46, v47
    ds_write_b64 v6, v[40:41] offset:2048
    ds_write_b64 v7, v[42:43] offset:2048
    ds_write_b128 v197, v[76:79] offset:3072
    ds_read_b64_tr_b16 v[232:233], v201 offset:0
    ds_read_b64_tr_b16 v[234:235], v201 offset:2048
    ds_read_b64_tr_b16 v[236:237], v203 offset:0
    ds_read_b64_tr_b16 v[238:239], v203 offset:2048
    v_exp_f32 v64, v64
    v_exp_f32 v160, v160
    v_exp_f32 v65, v65
    v_exp_f32 v161, v161
    v_exp_f32 v66, v66
    v_exp_f32 v162, v162
    v_exp_f32 v67, v67
    v_exp_f32 v163, v163
    v_exp_f32 v68, v68
    v_exp_f32 v164, v164
    v_exp_f32 v69, v69
    v_exp_f32 v165, v165
    v_exp_f32 v70, v70
    v_exp_f32 v166, v166
    v_exp_f32 v71, v71
    v_exp_f32 v167, v167
    v_exp_f32 v88, v88
    v_exp_f32 v168, v168
    v_exp_f32 v89, v89
    v_exp_f32 v169, v169
    v_exp_f32 v90, v90
    v_exp_f32 v170, v170
    v_exp_f32 v91, v91
    v_exp_f32 v171, v171
    v_exp_f32 v92, v92
    v_exp_f32 v172, v172
    v_exp_f32 v93, v93
    v_exp_f32 v173, v173
    v_exp_f32 v94, v94
    v_exp_f32 v174, v174
    v_exp_f32 v95, v95
    v_exp_f32 v175, v175
    s_mov_b64 exec, 1
    buffer_store_dword v251, v199, s[48:51], s76 offen sc1
    s_mov_b64 exec, -1
    v_pk_add_f32 v[136:137], v[160:161], v[162:163]
    v_pk_add_f32 v[138:139], v[64:65], v[66:67]
    v_pk_add_f32 v[140:141], v[168:169], v[170:171]
    v_pk_add_f32 v[142:143], v[88:89], v[90:91]
    v_pk_add_f32 v[136:137], v[136:137], v[164:165]
    v_pk_add_f32 v[138:139], v[138:139], v[68:69]
    v_pk_add_f32 v[140:141], v[140:141], v[172:173]
    v_pk_add_f32 v[142:143], v[142:143], v[92:93]
    v_pk_add_f32 v[136:137], v[136:137], v[166:167]
    v_pk_add_f32 v[138:139], v[138:139], v[70:71]
    v_pk_add_f32 v[140:141], v[140:141], v[174:175]
    v_pk_add_f32 v[142:143], v[142:143], v[94:95]
    v_add_f32 v180, v136, v137
    v_add_f32 v188, v138, v139
    v_add_f32 v182, v140, v141
    v_add_f32 v190, v142, v143
    s_nop 0
    v_permlane32_swap_b32 v180, v182
    v_permlane32_swap_b32 v188, v190
    s_waitcnt lgkmcnt(0)
    s_nop 0
    v_mfma_f32_16x16x32_bf16 v[144:147], v[232:235], v[24:27], 0
    v_add_f32 v180, v180, v182
    v_add_f32 v188, v188, v190
    v_mfma_f32_16x16x32_bf16 v[148:151], v[236:239], v[24:27], 0
    s_nop 0
    v_permlane16_swap_b32 v180, v188
    v_add_f32 v180, v180, v188
    v_mfma_f32_16x16x32_bf16 v[152:155], v[232:235], v[28:31], 0
    v_rcp_f32_e64 v180, v180
    v_mfma_f32_16x16x32_bf16 v[156:159], v[236:239], v[28:31], 0
    v_mul_f32 v188, v180, v223
    v_mul_f32 v180, v180, v223
    v_mfma_f32_16x16x32_bf16 v[16:19], v[232:235], v[120:123], 0
    s_nop 0
    v_permlane16_swap_b32 v180, v188
    v_mov_b32_e64 v182, v180
    v_mfma_f32_16x16x32_bf16 v[20:23], v[236:239], v[120:123], 0
    v_mov_b32_e64 v190, v188
    v_permlane32_swap_b32 v180, v182
    s_nop 0
    v_permlane32_swap_b32_e64 v188, v190
    v_pk_mul_f32 v[160:161], v[160:161], v[180:181] op_sel_hi:[1,0]
    v_pk_mul_f32 v[162:163], v[162:163], v[180:181] op_sel_hi:[1,0]
    v_pk_mul_f32 v[164:165], v[164:165], v[180:181] op_sel_hi:[1,0]
    v_pk_mul_f32 v[166:167], v[166:167], v[180:181] op_sel_hi:[1,0]
    v_cvt_pk_bf16_f32 v160, v160, v161
    v_cvt_pk_bf16_f32 v161, v162, v163
    v_cvt_pk_bf16_f32 v162, v164, v165
    v_cvt_pk_bf16_f32 v163, v166, v167
    ds_write_b64 v4, v[160:161] offset:4096
    ds_write_b64 v5, v[162:163] offset:4096
    v_pk_mul_f32 v[64:65], v[64:65], v[188:189] op_sel_hi:[1,0]
    v_pk_mul_f32 v[66:67], v[66:67], v[188:189] op_sel_hi:[1,0]
    v_pk_mul_f32 v[68:69], v[68:69], v[188:189] op_sel_hi:[1,0]
    v_pk_mul_f32 v[70:71], v[70:71], v[188:189] op_sel_hi:[1,0]
    v_cvt_pk_bf16_f32 v64, v64, v65
    v_cvt_pk_bf16_f32 v65, v66, v67
    v_cvt_pk_bf16_f32 v66, v68, v69
    v_cvt_pk_bf16_f32 v67, v70, v71
    ds_write_b64 v6, v[64:65] offset:4096
    ds_write_b64 v7, v[66:67] offset:4096
    v_pk_mul_f32 v[168:169], v[168:169], v[182:183] op_sel_hi:[1,0]
    v_pk_mul_f32 v[170:171], v[170:171], v[182:183] op_sel_hi:[1,0]
    v_pk_mul_f32 v[172:173], v[172:173], v[182:183] op_sel_hi:[1,0]
    v_pk_mul_f32 v[174:175], v[174:175], v[182:183] op_sel_hi:[1,0]
    v_cvt_pk_bf16_f32 v168, v168, v169
    v_cvt_pk_bf16_f32 v169, v170, v171
    v_cvt_pk_bf16_f32 v170, v172, v173
    v_cvt_pk_bf16_f32 v171, v174, v175
    ds_write_b64 v4, v[168:169] offset:6144
    ds_write_b64 v5, v[170:171] offset:6144
    v_pk_mul_f32 v[88:89], v[88:89], v[190:191] op_sel_hi:[1,0]
    v_pk_mul_f32 v[90:91], v[90:91], v[190:191] op_sel_hi:[1,0]
    v_pk_mul_f32 v[92:93], v[92:93], v[190:191] op_sel_hi:[1,0]
    v_pk_mul_f32 v[94:95], v[94:95], v[190:191] op_sel_hi:[1,0]
    v_cvt_pk_bf16_f32 v88, v88, v89
    v_cvt_pk_bf16_f32 v89, v90, v91
    v_cvt_pk_bf16_f32 v90, v92, v93
    v_cvt_pk_bf16_f32 v91, v94, v95
    ds_write_b64 v6, v[88:89] offset:6144
    ds_write_b64 v7, v[90:91] offset:6144
    ds_read_b64_tr_b16 v[204:205], v201 offset:4096
    ds_read_b64_tr_b16 v[206:207], v201 offset:6144
    ds_read_b64_tr_b16 v[208:209], v203 offset:4096
    ds_read_b64_tr_b16 v[210:211], v203 offset:6144
    v_xor_b32 v201, 0x2000, v201
    v_xor_b32 v203, 0x2000, v203
    v_xor_b32 v197, 0x1000, v197
    s_waitcnt lgkmcnt(4)
    s_barrier
    ds_read_b64_tr_b16 v[128:129], v201 offset:0
    ds_read_b64_tr_b16 v[130:131], v201 offset:2048
    ds_read_b64_tr_b16 v[132:133], v203 offset:0
    ds_read_b64_tr_b16 v[134:135], v203 offset:2048
    ds_read_b128 v[48:51], v197 offset:0
    ds_read_b128 v[52:55], v197 offset:1024
    ds_read_b64_tr_b16 v[136:137], v201 offset:4096
    ds_read_b64_tr_b16 v[138:139], v201 offset:6144
    ds_read_b64_tr_b16 v[140:141], v203 offset:4096
    ds_read_b64_tr_b16 v[142:143], v203 offset:6144
    ds_read_b128 v[96:99], v197 offset:2048
    ds_read_b128 v[100:103], v197 offset:3072
    s_waitcnt lgkmcnt(12)
    s_nop 0
    v_mfma_f32_16x16x32_bf16 v[144:147], v[204:207], v[72:75], v[144:147]
    v_mfma_f32_16x16x32_bf16 v[148:151], v[208:211], v[72:75], v[148:151]
    v_mfma_f32_16x16x32_bf16 v[152:155], v[204:207], v[76:79], v[152:155]
    v_mfma_f32_16x16x32_bf16 v[156:159], v[208:211], v[76:79], v[156:159]
    v_mfma_f32_16x16x32_bf16 v[16:19], v[204:207], v[124:127], v[16:19]
    v_mfma_f32_16x16x32_bf16 v[20:23], v[208:211], v[124:127], v[20:23]
    s_waitcnt lgkmcnt(6)
    s_nop 0
    v_mfma_f32_16x16x32_bf16 v[144:147], v[128:131], v[48:51], v[144:147]
    v_mfma_f32_16x16x32_bf16 v[148:151], v[132:135], v[48:51], v[148:151]
    v_mfma_f32_16x16x32_bf16 v[152:155], v[128:131], v[52:55], v[152:155]
    v_mfma_f32_16x16x32_bf16 v[156:159], v[132:135], v[52:55], v[156:159]
    v_mfma_f32_16x16x32_bf16 v[16:19], v[128:131], v[104:107], v[16:19]
    v_mfma_f32_16x16x32_bf16 v[20:23], v[132:135], v[104:107], v[20:23]
    s_waitcnt lgkmcnt(0)
    s_nop 0
    v_mfma_f32_16x16x32_bf16 v[144:147], v[136:139], v[96:99], v[144:147]
    v_mfma_f32_16x16x32_bf16 v[148:151], v[140:143], v[96:99], v[148:151]
    v_mfma_f32_16x16x32_bf16 v[152:155], v[136:139], v[100:103], v[152:155]
    v_mfma_f32_16x16x32_bf16 v[156:159], v[140:143], v[100:103], v[156:159]
    v_mfma_f32_16x16x32_bf16 v[16:19], v[136:139], v[108:111], v[16:19]
    v_mfma_f32_16x16x32_bf16 v[20:23], v[140:143], v[108:111], v[20:23]
    ds_read_b64_tr_b16 v[224:225], v252 offset:8192
    ds_read_b64_tr_b16 v[226:227], v252 offset:9216
    ds_read_b64_tr_b16 v[228:229], v252 offset:8224
    ds_read_b64_tr_b16 v[230:231], v252 offset:9248
    s_xor_b32 s67, s67, 8
    s_lshl_b32 s3, s38, 2
    s_add_u32 s3, s3, 162112
    v_mov_b32 v4, s3
    v_mov_b32 v5, 1
    v_cvt_pk_bf16_f32 v144, v144, v145
    v_cvt_pk_bf16_f32 v145, v146, v147
    v_cvt_pk_bf16_f32 v146, v148, v149
    v_cvt_pk_bf16_f32 v147, v150, v151
    buffer_store_dwordx4 v[144:147], v199, s[48:51], s74 offen offset:0 sc1
    v_cvt_pk_bf16_f32 v152, v152, v153
    v_cvt_pk_bf16_f32 v153, v154, v155
    v_cvt_pk_bf16_f32 v154, v156, v157
    v_cvt_pk_bf16_f32 v155, v158, v159
    buffer_store_dwordx4 v[152:155], v199, s[48:51], s74 offen offset:1024 sc1
    v_cvt_pk_bf16_f32 v16, v16, v17
    v_cvt_pk_bf16_f32 v17, v18, v19
    v_cvt_pk_bf16_f32 v18, v20, v21
    v_cvt_pk_bf16_f32 v19, v22, v23
    s_mov_b32 exec_lo, 0x00010001
    s_mov_b32 exec_hi, 0x00010001
    buffer_store_dwordx4 v[16:19], v1, s[48:51], s75 offen sc1
    s_mov_b64 exec, -1
    ds_write_b32 v4, v5
    s_setprio 0
    v_pk_fma_f32 v[8:9], v[192:193], v[212:213], v[8:9] op_sel_hi:[0,1,1] neg_lo:[1,0,0] neg_hi:[1,0,0]
    v_pk_fma_f32 v[10:11], v[192:193], v[214:215], v[10:11] op_sel_hi:[0,1,1] neg_lo:[1,0,0] neg_hi:[1,0,0]
    v_pk_fma_f32 v[12:13], v[192:193], v[216:217], v[12:13] op_sel_hi:[0,1,1] neg_lo:[1,0,0] neg_hi:[1,0,0]
    v_pk_fma_f32 v[14:15], v[192:193], v[218:219], v[14:15] op_sel_hi:[0,1,1] neg_lo:[1,0,0] neg_hi:[1,0,0]
    v_cvt_pk_bf16_f32 v8, v8, v9
    v_cvt_pk_bf16_f32 v9, v10, v11
    v_cvt_pk_bf16_f32 v10, v12, v13
    v_cvt_pk_bf16_f32 v11, v14, v15
    v_pk_fma_f32 v[32:33], v[194:195], v[212:213], v[32:33] op_sel_hi:[0,1,1] neg_lo:[1,0,0] neg_hi:[1,0,0]
    v_pk_fma_f32 v[34:35], v[194:195], v[214:215], v[34:35] op_sel_hi:[0,1,1] neg_lo:[1,0,0] neg_hi:[1,0,0]
    v_pk_fma_f32 v[36:37], v[194:195], v[216:217], v[36:37] op_sel_hi:[0,1,1] neg_lo:[1,0,0] neg_hi:[1,0,0]
    v_pk_fma_f32 v[38:39], v[194:195], v[218:219], v[38:39] op_sel_hi:[0,1,1] neg_lo:[1,0,0] neg_hi:[1,0,0]
    v_cvt_pk_bf16_f32 v32, v32, v33
    v_cvt_pk_bf16_f32 v33, v34, v35
    v_cvt_pk_bf16_f32 v34, v36, v37
    v_cvt_pk_bf16_f32 v35, v38, v39
    v_pk_fma_f32 v[56:57], v[196:197], v[212:213], v[56:57] op_sel_hi:[0,1,1] neg_lo:[1,0,0] neg_hi:[1,0,0]
    v_pk_fma_f32 v[58:59], v[196:197], v[214:215], v[58:59] op_sel_hi:[0,1,1] neg_lo:[1,0,0] neg_hi:[1,0,0]
    v_pk_fma_f32 v[60:61], v[196:197], v[216:217], v[60:61] op_sel_hi:[0,1,1] neg_lo:[1,0,0] neg_hi:[1,0,0]
    v_pk_fma_f32 v[62:63], v[196:197], v[218:219], v[62:63] op_sel_hi:[0,1,1] neg_lo:[1,0,0] neg_hi:[1,0,0]
    v_cvt_pk_bf16_f32 v56, v56, v57
    v_cvt_pk_bf16_f32 v57, v58, v59
    v_cvt_pk_bf16_f32 v58, v60, v61
    v_cvt_pk_bf16_f32 v59, v62, v63
    v_pk_fma_f32 v[80:81], v[198:199], v[212:213], v[80:81] op_sel_hi:[0,1,1] neg_lo:[1,0,0] neg_hi:[1,0,0]
    v_pk_fma_f32 v[82:83], v[198:199], v[214:215], v[82:83] op_sel_hi:[0,1,1] neg_lo:[1,0,0] neg_hi:[1,0,0]
    v_pk_fma_f32 v[84:85], v[198:199], v[216:217], v[84:85] op_sel_hi:[0,1,1] neg_lo:[1,0,0] neg_hi:[1,0,0]
    v_pk_fma_f32 v[86:87], v[198:199], v[218:219], v[86:87] op_sel_hi:[0,1,1] neg_lo:[1,0,0] neg_hi:[1,0,0]
    v_cvt_pk_bf16_f32 v80, v80, v81
    v_cvt_pk_bf16_f32 v81, v82, v83
    v_cvt_pk_bf16_f32 v82, v84, v85
    v_cvt_pk_bf16_f32 v83, v86, v87
    s_waitcnt lgkmcnt(1)
    s_nop 0
    v_mfma_f32_16x16x32_bf16 v[144:147], v[224:227], v[8:11], 0
    v_mfma_f32_16x16x32_bf16 v[148:151], v[228:231], v[8:11], 0
    v_mfma_f32_16x16x32_bf16 v[152:155], v[224:227], v[32:35], 0
    v_mfma_f32_16x16x32_bf16 v[156:159], v[228:231], v[32:35], 0
    v_mfma_f32_16x16x32_bf16 v[160:163], v[224:227], v[56:59], 0
    v_mfma_f32_16x16x32_bf16 v[164:167], v[228:231], v[56:59], 0
    v_mfma_f32_16x16x32_bf16 v[168:171], v[224:227], v[80:83], 0
    v_mfma_f32_16x16x32_bf16 v[172:175], v[228:231], v[80:83], 0
    s_nop 0
    s_nop 0
    v_max3_f32 v176, v144, v145, v146
    v_max3_f32 v184, -v144, -v145, -v146
    v_max3_f32 v178, v152, v153, v154
    v_max3_f32 v186, -v152, -v153, -v154
    v_max3_f32 v176, v176, v147, v148
    v_max3_f32 v184, v184, -v147, -v148
    v_max3_f32 v178, v178, v155, v156
    v_max3_f32 v186, v186, -v155, -v156
    v_max3_f32 v176, v176, v149, v150
    v_max3_f32 v184, v184, -v149, -v150
    v_max3_f32 v178, v178, v157, v158
    v_max3_f32 v186, v186, -v157, -v158
    v_max_f32_e64 v176, v176, v151
    v_max_f32_e64 v184, v184, -v151
    v_max_f32_e64 v178, v178, v159
    v_max_f32_e64 v186, v186, -v159
    s_nop 0
    v_permlane32_swap_b32 v176, v178
    v_permlane32_swap_b32_e64 v184, v186
    v_max3_f32 v180, v160, v161, v162
    v_max3_f32 v188, -v160, -v161, -v162
    v_max_f32 v176, v176, v178
    v_max_f32 v184, v184, v186
    v_max3_f32 v182, v168, v169, v170
    v_max3_f32 v190, -v168, -v169, -v170
    v_permlane16_swap_b32 v176, v184
    v_max_f32 v176, v176, v184
    v_max3_f32 v180, v180, v163, v164
    v_max3_f32 v188, v188, -v163, -v164
    v_mul_f32 v184, v176, v193
    v_mul_f32 v176, v176, v193
    v_max3_f32 v182, v182, v171, v172
    v_max3_f32 v190, v190, -v171, -v172
    v_permlane16_swap_b32 v176, v184
    v_mov_b32 v178, v176
    v_max3_f32 v180, v180, v165, v166
    v_max3_f32 v188, v188, -v165, -v166
    v_mov_b32_e64 v186, v184
    v_max3_f32 v182, v182, v173, v174
    v_max3_f32 v190, v190, -v173, -v174
    v_permlane32_swap_b32 v176, v178
    v_permlane32_swap_b32 v184, v186
    v_max_f32_e64 v180, v180, v167
    v_max_f32_e64 v188, v188, -v167
    v_max_f32_e64 v182, v182, v175
    v_max_f32_e64 v190, v190, -v175
    s_nop 0
    v_permlane32_swap_b32 v180, v182
    v_permlane32_swap_b32_e64 v188, v190
    v_pk_fma_f32 v[8:9], v[144:145], v[200:201], v[184:185] op_sel_hi:[1,0,0] neg_lo:[1,0,1] neg_hi:[1,0,1]
    v_pk_fma_f32 v[144:145], v[144:145], v[200:201], v[176:177] op_sel_hi:[1,0,0] neg_lo:[0,0,1] neg_hi:[0,0,1]
    v_max_f32 v180, v180, v182
    v_max_f32 v188, v188, v190
    v_pk_fma_f32 v[10:11], v[146:147], v[200:201], v[184:185] op_sel_hi:[1,0,0] neg_lo:[1,0,1] neg_hi:[1,0,1]
    v_pk_fma_f32 v[146:147], v[146:147], v[200:201], v[176:177] op_sel_hi:[1,0,0] neg_lo:[0,0,1] neg_hi:[0,0,1]
    v_permlane16_swap_b32 v180, v188
    v_max_f32 v180, v180, v188
    v_pk_fma_f32 v[12:13], v[148:149], v[200:201], v[184:185] op_sel_hi:[1,0,0] neg_lo:[1,0,1] neg_hi:[1,0,1]
    v_pk_fma_f32 v[148:149], v[148:149], v[200:201], v[176:177] op_sel_hi:[1,0,0] neg_lo:[0,0,1] neg_hi:[0,0,1]
    v_mul_f32 v188, v180, v221
    v_mul_f32 v180, v180, v221
    v_pk_fma_f32 v[14:15], v[150:151], v[200:201], v[184:185] op_sel_hi:[1,0,0] neg_lo:[1,0,1] neg_hi:[1,0,1]
    v_pk_fma_f32 v[150:151], v[150:151], v[200:201], v[176:177] op_sel_hi:[1,0,0] neg_lo:[0,0,1] neg_hi:[0,0,1]
    v_permlane16_swap_b32 v180, v188
    v_mov_b32 v182, v180
    v_pk_fma_f32 v[32:33], v[152:153], v[202:203], v[186:187] op_sel_hi:[1,0,0] neg_lo:[1,0,1] neg_hi:[1,0,1]
    v_pk_fma_f32 v[152:153], v[152:153], v[202:203], v[178:179] op_sel_hi:[1,0,0] neg_lo:[0,0,1] neg_hi:[0,0,1]
    v_mov_b32_e64 v190, v188
    v_pk_fma_f32 v[34:35], v[154:155], v[202:203], v[186:187] op_sel_hi:[1,0,0] neg_lo:[1,0,1] neg_hi:[1,0,1]
    v_pk_fma_f32 v[154:155], v[154:155], v[202:203], v[178:179] op_sel_hi:[1,0,0] neg_lo:[0,0,1] neg_hi:[0,0,1]
    v_permlane32_swap_b32 v180, v182
    v_permlane32_swap_b32 v188, v190
    v_pk_fma_f32 v[36:37], v[156:157], v[202:203], v[186:187] op_sel_hi:[1,0,0] neg_lo:[1,0,1] neg_hi:[1,0,1]
    v_pk_fma_f32 v[156:157], v[156:157], v[202:203], v[178:179] op_sel_hi:[1,0,0] neg_lo:[0,0,1] neg_hi:[0,0,1]
    v_pk_fma_f32 v[38:39], v[158:159], v[202:203], v[186:187] op_sel_hi:[1,0,0] neg_lo:[1,0,1] neg_hi:[1,0,1]
    v_pk_fma_f32 v[158:159], v[158:159], v[202:203], v[178:179] op_sel_hi:[1,0,0] neg_lo:[0,0,1] neg_hi:[0,0,1]
    v_exp_f32 v8, v8
    v_exp_f32 v144, v144
    v_exp_f32 v9, v9
    v_exp_f32 v145, v145
    v_exp_f32 v10, v10
    v_exp_f32 v146, v146
    v_exp_f32 v11, v11
    v_exp_f32 v147, v147
    v_exp_f32 v12, v12
    v_exp_f32 v148, v148
    v_exp_f32 v13, v13
    v_exp_f32 v149, v149
    v_exp_f32 v14, v14
    v_exp_f32 v150, v150
    v_exp_f32 v15, v15
    v_exp_f32 v151, v151
    v_exp_f32 v32, v32
    v_exp_f32 v152, v152
    v_exp_f32 v33, v33
    v_exp_f32 v153, v153
    v_exp_f32 v34, v34
    v_exp_f32 v154, v154
    v_exp_f32 v35, v35
    v_exp_f32 v155, v155
    v_exp_f32 v36, v36
    v_exp_f32 v156, v156
    v_exp_f32 v37, v37
    v_exp_f32 v157, v157
    v_exp_f32 v38, v38
    v_exp_f32 v158, v158
    v_exp_f32 v39, v39
    v_exp_f32 v159, v159
    v_pk_add_f32 v[128:129], v[144:145], v[146:147]
    v_pk_add_f32 v[130:131], v[8:9], v[10:11]
    v_pk_add_f32 v[132:133], v[152:153], v[154:155]
    v_pk_add_f32 v[134:135], v[32:33], v[34:35]
    v_pk_add_f32 v[128:129], v[128:129], v[148:149]
    v_pk_add_f32 v[130:131], v[130:131], v[12:13]
    v_pk_add_f32 v[132:133], v[132:133], v[156:157]
    v_pk_add_f32 v[134:135], v[134:135], v[36:37]
    v_pk_add_f32 v[128:129], v[128:129], v[150:151]
    v_pk_add_f32 v[130:131], v[130:131], v[14:15]
    v_pk_add_f32 v[132:133], v[132:133], v[158:159]
    v_pk_add_f32 v[134:135], v[134:135], v[38:39]
    v_add_f32 v176, v128, v129
    v_add_f32 v184, v130, v131
    v_add_f32 v178, v132, v133
    v_add_f32 v186, v134, v135
    s_nop 0
    v_permlane32_swap_b32 v176, v178
    v_permlane32_swap_b32_e64 v184, v186
    v_pk_fma_f32 v[56:57], v[160:161], v[220:221], v[188:189] op_sel_hi:[1,0,0] neg_lo:[1,0,1] neg_hi:[1,0,1]
    v_pk_fma_f32 v[160:161], v[160:161], v[220:221], v[180:181] op_sel_hi:[1,0,0] neg_lo:[0,0,1] neg_hi:[0,0,1]
    v_add_f32 v176, v176, v178
    v_add_f32 v184, v184, v186
    v_pk_fma_f32 v[58:59], v[162:163], v[220:221], v[188:189] op_sel_hi:[1,0,0] neg_lo:[1,0,1] neg_hi:[1,0,1]
    v_pk_fma_f32 v[162:163], v[162:163], v[220:221], v[180:181] op_sel_hi:[1,0,0] neg_lo:[0,0,1] neg_hi:[0,0,1]
    v_permlane16_swap_b32 v176, v184
    v_add_f32 v176, v176, v184
    v_pk_fma_f32 v[60:61], v[164:165], v[220:221], v[188:189] op_sel_hi:[1,0,0] neg_lo:[1,0,1] neg_hi:[1,0,1]
    v_pk_fma_f32 v[164:165], v[164:165], v[220:221], v[180:181] op_sel_hi:[1,0,0] neg_lo:[0,0,1] neg_hi:[0,0,1]
    v_rcp_f32_e64 v176, v176
    v_pk_fma_f32 v[62:63], v[166:167], v[220:221], v[188:189] op_sel_hi:[1,0,0] neg_lo:[1,0,1] neg_hi:[1,0,1]
    v_pk_fma_f32 v[166:167], v[166:167], v[220:221], v[180:181] op_sel_hi:[1,0,0] neg_lo:[0,0,1] neg_hi:[0,0,1]
    v_mov_b32_e64 v184, v176
    v_pk_fma_f32 v[80:81], v[168:169], v[222:223], v[190:191] op_sel_hi:[1,0,0] neg_lo:[1,0,1] neg_hi:[1,0,1]
    v_pk_fma_f32 v[168:169], v[168:169], v[222:223], v[182:183] op_sel_hi:[1,0,0] neg_lo:[0,0,1] neg_hi:[0,0,1]
    v_permlane16_swap_b32 v176, v184
    v_mov_b32 v178, v176
    v_pk_fma_f32 v[82:83], v[170:171], v[222:223], v[190:191] op_sel_hi:[1,0,0] neg_lo:[1,0,1] neg_hi:[1,0,1]
    v_pk_fma_f32 v[170:171], v[170:171], v[222:223], v[182:183] op_sel_hi:[1,0,0] neg_lo:[0,0,1] neg_hi:[0,0,1]
    v_mov_b32_e64 v186, v184
    v_pk_fma_f32 v[84:85], v[172:173], v[222:223], v[190:191] op_sel_hi:[1,0,0] neg_lo:[1,0,1] neg_hi:[1,0,1]
    v_pk_fma_f32 v[172:173], v[172:173], v[222:223], v[182:183] op_sel_hi:[1,0,0] neg_lo:[0,0,1] neg_hi:[0,0,1]
    v_permlane32_swap_b32 v176, v178
    v_permlane32_swap_b32 v184, v186
    v_pk_fma_f32 v[86:87], v[174:175], v[222:223], v[190:191] op_sel_hi:[1,0,0] neg_lo:[1,0,1] neg_hi:[1,0,1]
    v_pk_fma_f32 v[174:175], v[174:175], v[222:223], v[182:183] op_sel_hi:[1,0,0] neg_lo:[0,0,1] neg_hi:[0,0,1]
    v_pk_mul_f32 v[144:145], v[144:145], v[176:177] op_sel_hi:[1,0]
    v_pk_mul_f32 v[146:147], v[146:147], v[176:177] op_sel_hi:[1,0]
    v_pk_mul_f32 v[148:149], v[148:149], v[176:177] op_sel_hi:[1,0]
    v_pk_mul_f32 v[150:151], v[150:151], v[176:177] op_sel_hi:[1,0]
    v_cvt_pk_bf16_f32 v144, v144, v145
    v_cvt_pk_bf16_f32 v145, v146, v147
    v_cvt_pk_bf16_f32 v146, v148, v149
    v_cvt_pk_bf16_f32 v147, v150, v151
    v_pk_mul_f32 v[8:9], v[8:9], v[184:185] op_sel_hi:[1,0]
    v_pk_mul_f32 v[10:11], v[10:11], v[184:185] op_sel_hi:[1,0]
    v_pk_mul_f32 v[12:13], v[12:13], v[184:185] op_sel_hi:[1,0]
    v_pk_mul_f32 v[14:15], v[14:15], v[184:185] op_sel_hi:[1,0]
    v_cvt_pk_bf16_f32 v8, v8, v9
    v_cvt_pk_bf16_f32 v9, v10, v11
    v_cvt_pk_bf16_f32 v10, v12, v13
    v_cvt_pk_bf16_f32 v11, v14, v15
    v_pk_mul_f32 v[152:153], v[152:153], v[178:179] op_sel_hi:[1,0]
    v_pk_mul_f32 v[154:155], v[154:155], v[178:179] op_sel_hi:[1,0]
    v_pk_mul_f32 v[156:157], v[156:157], v[178:179] op_sel_hi:[1,0]
    v_pk_mul_f32 v[158:159], v[158:159], v[178:179] op_sel_hi:[1,0]
    v_cvt_pk_bf16_f32 v152, v152, v153
    v_cvt_pk_bf16_f32 v153, v154, v155
    v_cvt_pk_bf16_f32 v154, v156, v157
    v_cvt_pk_bf16_f32 v155, v158, v159
    v_pk_mul_f32 v[32:33], v[32:33], v[186:187] op_sel_hi:[1,0]
    v_pk_mul_f32 v[34:35], v[34:35], v[186:187] op_sel_hi:[1,0]
    v_pk_mul_f32 v[36:37], v[36:37], v[186:187] op_sel_hi:[1,0]
    v_pk_mul_f32 v[38:39], v[38:39], v[186:187] op_sel_hi:[1,0]
    v_cvt_pk_bf16_f32 v32, v32, v33
    v_cvt_pk_bf16_f32 v33, v34, v35
    v_cvt_pk_bf16_f32 v34, v36, v37
    v_cvt_pk_bf16_f32 v35, v38, v39
    v_exp_f32 v56, v56
    v_exp_f32 v160, v160
    v_exp_f32 v57, v57
    v_exp_f32 v161, v161
    v_exp_f32 v58, v58
    v_exp_f32 v162, v162
    v_exp_f32 v59, v59
    v_exp_f32 v163, v163
    v_exp_f32 v60, v60
    v_exp_f32 v164, v164
    v_exp_f32 v61, v61
    v_exp_f32 v165, v165
    v_exp_f32 v62, v62
    v_exp_f32 v166, v166
    v_exp_f32 v63, v63
    v_exp_f32 v167, v167
    v_exp_f32 v80, v80
    v_exp_f32 v168, v168
    v_exp_f32 v81, v81
    v_exp_f32 v169, v169
    v_exp_f32 v82, v82
    v_exp_f32 v170, v170
    v_exp_f32 v83, v83
    v_exp_f32 v171, v171
    v_exp_f32 v84, v84
    v_exp_f32 v172, v172
    v_exp_f32 v85, v85
    v_exp_f32 v173, v173
    v_exp_f32 v86, v86
    v_exp_f32 v174, v174
    v_exp_f32 v87, v87
    v_exp_f32 v175, v175
    v_pk_add_f32 v[136:137], v[160:161], v[162:163]
    v_pk_add_f32 v[138:139], v[56:57], v[58:59]
    v_pk_add_f32 v[140:141], v[168:169], v[170:171]
    v_pk_add_f32 v[142:143], v[80:81], v[82:83]
    v_pk_add_f32 v[136:137], v[136:137], v[164:165]
    v_pk_add_f32 v[138:139], v[138:139], v[60:61]
    v_pk_add_f32 v[140:141], v[140:141], v[172:173]
    v_pk_add_f32 v[142:143], v[142:143], v[84:85]
    v_pk_add_f32 v[136:137], v[136:137], v[166:167]
    v_pk_add_f32 v[138:139], v[138:139], v[62:63]
    v_pk_add_f32 v[140:141], v[140:141], v[174:175]
    v_pk_add_f32 v[142:143], v[142:143], v[86:87]
    v_add_f32 v180, v136, v137
    v_add_f32 v188, v138, v139
    v_add_f32 v182, v140, v141
    v_add_f32 v190, v142, v143
    s_nop 0
    v_permlane32_swap_b32 v180, v182
    v_permlane32_swap_b32 v188, v190
    v_add_f32 v180, v180, v182
    v_add_f32 v188, v188, v190
    s_nop 1
    v_permlane16_swap_b32 v180, v188
    v_add_f32 v180, v180, v188
    v_rcp_f32_e64 v180, v180
    s_nop 0
    v_mov_b32_e64 v188, v180
    s_nop 1
    v_permlane16_swap_b32 v180, v188
    v_mov_b32 v182, v180
    v_mov_b32_e64 v190, v188
    s_nop 0
    v_permlane32_swap_b32 v180, v182
    v_permlane32_swap_b32_e64 v188, v190
    v_pk_mul_f32 v[160:161], v[160:161], v[180:181] op_sel_hi:[1,0]
    v_pk_mul_f32 v[162:163], v[162:163], v[180:181] op_sel_hi:[1,0]
    v_pk_mul_f32 v[164:165], v[164:165], v[180:181] op_sel_hi:[1,0]
    v_pk_mul_f32 v[166:167], v[166:167], v[180:181] op_sel_hi:[1,0]
    v_cvt_pk_bf16_f32 v160, v160, v161
    v_cvt_pk_bf16_f32 v161, v162, v163
    v_cvt_pk_bf16_f32 v162, v164, v165
    v_cvt_pk_bf16_f32 v163, v166, v167
    v_pk_mul_f32 v[56:57], v[56:57], v[188:189] op_sel_hi:[1,0]
    v_pk_mul_f32 v[58:59], v[58:59], v[188:189] op_sel_hi:[1,0]
    v_pk_mul_f32 v[60:61], v[60:61], v[188:189] op_sel_hi:[1,0]
    v_pk_mul_f32 v[62:63], v[62:63], v[188:189] op_sel_hi:[1,0]
    v_cvt_pk_bf16_f32 v56, v56, v57
    v_cvt_pk_bf16_f32 v57, v58, v59
    v_cvt_pk_bf16_f32 v58, v60, v61
    v_cvt_pk_bf16_f32 v59, v62, v63
    v_pk_mul_f32 v[168:169], v[168:169], v[182:183] op_sel_hi:[1,0]
    v_pk_mul_f32 v[170:171], v[170:171], v[182:183] op_sel_hi:[1,0]
    v_pk_mul_f32 v[172:173], v[172:173], v[182:183] op_sel_hi:[1,0]
    v_pk_mul_f32 v[174:175], v[174:175], v[182:183] op_sel_hi:[1,0]
    v_cvt_pk_bf16_f32 v168, v168, v169
    v_cvt_pk_bf16_f32 v169, v170, v171
    v_cvt_pk_bf16_f32 v170, v172, v173
    v_cvt_pk_bf16_f32 v171, v174, v175
    v_pk_mul_f32 v[80:81], v[80:81], v[190:191] op_sel_hi:[1,0]
    v_pk_mul_f32 v[82:83], v[82:83], v[190:191] op_sel_hi:[1,0]
    v_pk_mul_f32 v[84:85], v[84:85], v[190:191] op_sel_hi:[1,0]
    v_pk_mul_f32 v[86:87], v[86:87], v[190:191] op_sel_hi:[1,0]
    v_cvt_pk_bf16_f32 v80, v80, v81
    v_cvt_pk_bf16_f32 v81, v82, v83
    v_cvt_pk_bf16_f32 v82, v84, v85
    v_cvt_pk_bf16_f32 v83, v86, v87
    v_mov_b32 v2, 162048
    ds_read_b32 v248, v2
    v_lshrrev_b32 v5, 3, v1
    v_lshlrev_b32 v6, 11, v5
    v_bfe_u32 v5, v1, 4, 2
    v_lshlrev_b32 v5, 1, v5
    v_and_b32 v7, 7, v1
    v_xor_b32 v5, v5, v7
    v_lshl_add_u32 v6, v5, 4, v6
    s_lshl_b32 s3, s35, 7
    v_add_u32 v6, s3, v6
    v_add_u32 v216, 0, v6
    v_add_u32 v217, 15360, v6
    v_add_u32 v218, 30720, v6
    v_add_u32 v219, 46080, v6
    s_lshl_b32 s72, s38, 12
    s_lshl_b32 s73, s38, 16
    v_and_b32 v2, 15, v1
    v_add_u32 v2, s69, v2
    v_lshlrev_b32_e64 v2, 2, v2
    v_add_u32 v2, 152064, v2
    ds_read_b32 v193, v2
    ds_read_b32 v192, v2 offset:1024
    s_mul_i32 s76, s67, 4224
    s_add_u32 s76, s76, 1048576
    v_lshlrev_b32 v5, 4, v1
    v_and_b32 v6, 48, v1
    v_add_u32 v6, 4096, v6
    s_lshl_b32 s3, s38, 2
    s_add_u32 s3, s3, 162112
    v_mov_b32 v3, s3
L_gw:
    ds_read_b32 v2, v3
    s_waitcnt lgkmcnt(0)
    v_readfirstlane_b32 s3, v2
    s_nop 0
    s_cmp_eq_u32 s3, 3
    s_cbranch_scc1 L_gk
    s_sleep 1
    s_branch L_gw
L_gk:
    v_mul_f32 v196, v193, v192
    v_mov_b32 v198, 0xbfb8aa3b
    v_lshlrev_b32 v224, 16, v240
    v_and_b32 v225, 0xffff0000, v240
    v_lshlrev_b32 v226, 16, v241
    v_and_b32 v227, 0xffff0000, v241
    v_lshlrev_b32 v228, 16, v242
    v_and_b32 v229, 0xffff0000, v242
    v_lshlrev_b32 v230, 16, v243
    v_and_b32 v231, 0xffff0000, v243
    v_lshlrev_b32 v232, 16, v244
    v_and_b32 v233, 0xffff0000, v244
    v_lshlrev_b32 v234, 16, v245
    v_and_b32 v235, 0xffff0000, v245
    v_lshlrev_b32 v236, 16, v246
    v_and_b32 v237, 0xffff0000, v246
    v_lshlrev_b32 v238, 16, v247
    v_and_b32 v239, 0xffff0000, v247
    v_pk_fma_f32 v[224:225], v[224:225], v[192:193], v[196:197] op_sel_hi:[1,0,0] neg_lo:[0,0,1] neg_hi:[0,0,1]
    v_pk_fma_f32 v[226:227], v[226:227], v[192:193], v[196:197] op_sel_hi:[1,0,0] neg_lo:[0,0,1] neg_hi:[0,0,1]
    v_pk_fma_f32 v[228:229], v[228:229], v[192:193], v[196:197] op_sel_hi:[1,0,0] neg_lo:[0,0,1] neg_hi:[0,0,1]
    v_pk_fma_f32 v[230:231], v[230:231], v[192:193], v[196:197] op_sel_hi:[1,0,0] neg_lo:[0,0,1] neg_hi:[0,0,1]
    v_pk_fma_f32 v[232:233], v[232:233], v[192:193], v[196:197] op_sel_hi:[1,0,0] neg_lo:[0,0,1] neg_hi:[0,0,1]
    v_pk_fma_f32 v[234:235], v[234:235], v[192:193], v[196:197] op_sel_hi:[1,0,0] neg_lo:[0,0,1] neg_hi:[0,0,1]
    v_pk_fma_f32 v[236:237], v[236:237], v[192:193], v[196:197] op_sel_hi:[1,0,0] neg_lo:[0,0,1] neg_hi:[0,0,1]
    v_pk_fma_f32 v[238:239], v[238:239], v[192:193], v[196:197] op_sel_hi:[1,0,0] neg_lo:[0,0,1] neg_hi:[0,0,1]
    v_pk_mul_f32 v[200:201], v[224:225], v[198:199] op_sel_hi:[1,0]
    v_pk_mul_f32 v[202:203], v[226:227], v[198:199] op_sel_hi:[1,0]
    v_pk_mul_f32 v[204:205], v[228:229], v[198:199] op_sel_hi:[1,0]
    v_pk_mul_f32 v[206:207], v[230:231], v[198:199] op_sel_hi:[1,0]
    v_pk_mul_f32 v[208:209], v[232:233], v[198:199] op_sel_hi:[1,0]
    v_pk_mul_f32 v[210:211], v[234:235], v[198:199] op_sel_hi:[1,0]
    v_pk_mul_f32 v[212:213], v[236:237], v[198:199] op_sel_hi:[1,0]
    v_pk_mul_f32 v[214:215], v[238:239], v[198:199] op_sel_hi:[1,0]
    v_exp_f32 v200, v200
    v_exp_f32 v201, v201
    v_exp_f32 v202, v202
    v_exp_f32 v203, v203
    v_exp_f32 v204, v204
    v_exp_f32 v205, v205
    v_exp_f32 v206, v206
    v_exp_f32 v207, v207
    v_exp_f32 v208, v208
    v_exp_f32 v209, v209
    v_exp_f32 v210, v210
    v_exp_f32 v211, v211
    v_exp_f32 v212, v212
    v_exp_f32 v213, v213
    v_exp_f32 v214, v214
    v_exp_f32 v215, v215
    v_pk_add_f32 v[200:201], v[200:201], 1.0 op_sel_hi:[1,0]
    v_pk_add_f32 v[202:203], v[202:203], 1.0 op_sel_hi:[1,0]
    v_pk_add_f32 v[204:205], v[204:205], 1.0 op_sel_hi:[1,0]
    v_pk_add_f32 v[206:207], v[206:207], 1.0 op_sel_hi:[1,0]
    v_pk_add_f32 v[208:209], v[208:209], 1.0 op_sel_hi:[1,0]
    v_pk_add_f32 v[210:211], v[210:211], 1.0 op_sel_hi:[1,0]
    v_pk_add_f32 v[212:213], v[212:213], 1.0 op_sel_hi:[1,0]
    v_pk_add_f32 v[214:215], v[214:215], 1.0 op_sel_hi:[1,0]
    v_rcp_f32 v200, v200
    v_rcp_f32 v201, v201
    v_rcp_f32 v202, v202
    v_rcp_f32 v203, v203
    v_rcp_f32 v204, v204
    v_rcp_f32 v205, v205
    v_rcp_f32 v206, v206
    v_rcp_f32 v207, v207
    v_rcp_f32 v208, v208
    v_rcp_f32 v209, v209
    v_rcp_f32 v210, v210
    v_rcp_f32 v211, v211
    v_rcp_f32 v212, v212
    v_rcp_f32 v213, v213
    v_rcp_f32 v214, v214
    v_rcp_f32 v215, v215
    v_pk_mul_f32 v[224:225], v[224:225], v[200:201]
    v_pk_mul_f32 v[226:227], v[226:227], v[202:203]
    v_pk_mul_f32 v[228:229], v[228:229], v[204:205]
    v_pk_mul_f32 v[230:231], v[230:231], v[206:207]
    v_pk_mul_f32 v[232:233], v[232:233], v[208:209]
    v_pk_mul_f32 v[234:235], v[234:235], v[210:211]
    v_pk_mul_f32 v[236:237], v[236:237], v[212:213]
    v_pk_mul_f32 v[238:239], v[238:239], v[214:215]
    buffer_load_dwordx4 v[104:107], v5, s[48:51], s76 offen offset:0 sc1
    buffer_load_dwordx4 v[108:111], v5, s[48:51], s76 offen offset:1024 sc1
    buffer_load_dwordx4 v[112:115], v5, s[48:51], s76 offen offset:2048 sc1
    buffer_load_dwordx4 v[116:119], v5, s[48:51], s76 offen offset:3072 sc1
    buffer_load_dwordx4 v[120:123], v6, s[48:51], s76 offen offset:0 sc1
    buffer_load_dwordx4 v[124:127], v6, s[48:51], s76 offen offset:64 sc1
    s_waitcnt lgkmcnt(0)
    v_readfirstlane_b32 s70, v248
    s_nop 0
    s_and_b32 s68, s70, 0x7ff
    s_sub_u32 s68, 2047, s68
    s_lshl_b32 s3, s36, 3
    s_lshl_b32 s28, s64, 2
    s_add_u32 s3, s3, s28
    s_lshl_b32 s3, s3, 5
    s_add_u32 s3, s3, s67
    s_lshl_b32 s77, s3, 10
    s_add_u32 s77, s77, 4194304
    s_waitcnt vmcnt(0)
    s_mov_b32 s29, 0
L_k7:
    s_nop 0
    v_max3_u32 v2, v104, v105, v106
    v_max3_u32 v2, v2, v107, v108
    v_max3_u32 v2, v2, v109, v110
    v_max3_u32 v2, v2, v111, v112
    v_max3_u32 v2, v2, v113, v114
    v_max3_u32 v2, v2, v115, v116
    v_max3_u32 v2, v2, v117, v118
    v_max3_u32 v2, v2, v119, v120
    v_max3_u32 v2, v2, v121, v122
    v_max3_u32 v2, v2, v123, v124
    v_max3_u32 v2, v2, v125, v126
    v_max_u32 v2, v2, v127
    v_cmp_eq_u32 vcc, -1, v2
    s_cbranch_vccz L_k7k
    s_add_u32 s29, s29, 1
    s_cmp_ge_u32 s29, 200000
    s_cbranch_scc1 L_k7k
    s_sleep 1
    buffer_load_dwordx4 v[104:107], v5, s[48:51], s76 offen offset:0 sc1
    buffer_load_dwordx4 v[108:111], v5, s[48:51], s76 offen offset:1024 sc1
    buffer_load_dwordx4 v[112:115], v5, s[48:51], s76 offen offset:2048 sc1
    buffer_load_dwordx4 v[116:119], v5, s[48:51], s76 offen offset:3072 sc1
    buffer_load_dwordx4 v[120:123], v6, s[48:51], s76 offen offset:0 sc1
    buffer_load_dwordx4 v[124:127], v6, s[48:51], s76 offen offset:64 sc1
    s_waitcnt vmcnt(0)
    s_branch L_k7
L_k7k:
    s_setprio 2
    s_nop 0
    v_mfma_f32_16x16x32_bf16 v[24:27], v[120:123], v[144:147], 0
    v_mfma_f32_16x16x32_bf16 v[16:19], v[104:107], v[144:147], 0
    v_mfma_f32_16x16x32_bf16 v[20:23], v[108:111], v[144:147], 0
    v_mfma_f32_16x16x32_bf16 v[24:27], v[124:127], v[8:11], v[24:27]
    v_mfma_f32_16x16x32_bf16 v[16:19], v[112:115], v[8:11], v[16:19]
    v_mfma_f32_16x16x32_bf16 v[20:23], v[116:119], v[8:11], v[20:23]
    v_mfma_f32_16x16x32_bf16 v[48:51], v[120:123], v[152:155], 0
    v_mfma_f32_16x16x32_bf16 v[40:43], v[104:107], v[152:155], 0
    v_mfma_f32_16x16x32_bf16 v[44:47], v[108:111], v[152:155], 0
    v_mfma_f32_16x16x32_bf16 v[48:51], v[124:127], v[32:35], v[48:51]
    v_mfma_f32_16x16x32_bf16 v[40:43], v[112:115], v[32:35], v[40:43]
    v_mfma_f32_16x16x32_bf16 v[44:47], v[116:119], v[32:35], v[44:47]
    v_mfma_f32_16x16x32_bf16 v[72:75], v[120:123], v[160:163], 0
    v_mfma_f32_16x16x32_bf16 v[64:67], v[104:107], v[160:163], 0
    v_mfma_f32_16x16x32_bf16 v[68:71], v[108:111], v[160:163], 0
    v_mfma_f32_16x16x32_bf16 v[72:75], v[124:127], v[56:59], v[72:75]
    v_mfma_f32_16x16x32_bf16 v[64:67], v[112:115], v[56:59], v[64:67]
    v_mfma_f32_16x16x32_bf16 v[68:71], v[116:119], v[56:59], v[68:71]
    v_mfma_f32_16x16x32_bf16 v[96:99], v[120:123], v[168:171], 0
    v_mfma_f32_16x16x32_bf16 v[88:91], v[104:107], v[168:171], 0
    v_mfma_f32_16x16x32_bf16 v[92:95], v[108:111], v[168:171], 0
    v_mfma_f32_16x16x32_bf16 v[96:99], v[124:127], v[80:83], v[96:99]
    v_mfma_f32_16x16x32_bf16 v[88:91], v[112:115], v[80:83], v[88:91]
    v_mfma_f32_16x16x32_bf16 v[92:95], v[116:119], v[80:83], v[92:95]
    v_add_f32 v24, 0x358637bd, v24
    v_add_f32 v48, 0x358637bd, v48
    v_add_f32 v72, 0x358637bd, v72
    s_nop 2
    v_add_f32 v96, 0x358637bd, v96
    v_rcp_f32 v24, v24
    v_rcp_f32 v48, v48
    v_rcp_f32 v72, v72
    v_rcp_f32_e64 v96, v96
    v_pk_mul_f32 v[16:17], v[16:17], v[24:25] op_sel_hi:[1,0]
    v_pk_mul_f32 v[18:19], v[18:19], v[24:25] op_sel_hi:[1,0]
    v_pk_mul_f32 v[20:21], v[20:21], v[24:25] op_sel_hi:[1,0]
    v_pk_mul_f32 v[22:23], v[22:23], v[24:25] op_sel_hi:[1,0]
    v_cvt_pk_bf16_f32 v16, v16, v17
    v_cvt_pk_bf16_f32 v17, v18, v19
    v_cvt_pk_bf16_f32 v18, v20, v21
    v_cvt_pk_bf16_f32 v19, v22, v23
    buffer_store_dwordx4 v[16:19], v5, s[48:51], s77 offen sc1
    s_add_u32 s77, s77, 32768
    v_pk_mul_f32 v[40:41], v[40:41], v[48:49] op_sel_hi:[1,0]
    v_pk_mul_f32 v[42:43], v[42:43], v[48:49] op_sel_hi:[1,0]
    v_pk_mul_f32 v[44:45], v[44:45], v[48:49] op_sel_hi:[1,0]
    v_pk_mul_f32 v[46:47], v[46:47], v[48:49] op_sel_hi:[1,0]
    v_cvt_pk_bf16_f32 v40, v40, v41
    v_cvt_pk_bf16_f32 v41, v42, v43
    v_cvt_pk_bf16_f32 v42, v44, v45
    v_cvt_pk_bf16_f32 v43, v46, v47
    buffer_store_dwordx4 v[40:43], v5, s[48:51], s77 offen sc1
    s_add_u32 s77, s77, 32768
    v_pk_mul_f32 v[64:65], v[64:65], v[72:73] op_sel_hi:[1,0]
    v_pk_mul_f32 v[66:67], v[66:67], v[72:73] op_sel_hi:[1,0]
    v_pk_mul_f32 v[68:69], v[68:69], v[72:73] op_sel_hi:[1,0]
    v_pk_mul_f32 v[70:71], v[70:71], v[72:73] op_sel_hi:[1,0]
    v_cvt_pk_bf16_f32 v64, v64, v65
    v_cvt_pk_bf16_f32 v65, v66, v67
    v_cvt_pk_bf16_f32 v66, v68, v69
    v_cvt_pk_bf16_f32 v67, v70, v71
    buffer_store_dwordx4 v[64:67], v5, s[48:51], s77 offen sc1
    s_add_u32 s77, s77, 32768
    v_pk_mul_f32 v[88:89], v[88:89], v[96:97] op_sel_hi:[1,0]
    v_pk_mul_f32 v[90:91], v[90:91], v[96:97] op_sel_hi:[1,0]
    v_pk_mul_f32 v[92:93], v[92:93], v[96:97] op_sel_hi:[1,0]
    v_pk_mul_f32 v[94:95], v[94:95], v[96:97] op_sel_hi:[1,0]
    v_cvt_pk_bf16_f32 v88, v88, v89
    v_cvt_pk_bf16_f32 v89, v90, v91
    v_cvt_pk_bf16_f32 v90, v92, v93
    v_cvt_pk_bf16_f32 v91, v94, v95
    buffer_store_dwordx4 v[88:91], v5, s[48:51], s77 offen sc1
    v_mov_b32_e64 v2, 7
    ds_write_b32 v3, v2
    s_and_b32 s3, s68, 127
    s_lshl_b32 s3, s3, 2
    s_add_u32 s3, s3, 152064
    v_mov_b32 v2, s3
    ds_read_b32 v250, v2
    ds_read_b32 v251, v2 offset:1024
    s_setprio 0
    v_and_b32 v3, 3, v1
    v_lshlrev_b32_e64 v3, 2, v3
    v_add_u32 v3, 162112, v3
L_cw:
    ds_read_b32 v2, v3
    s_waitcnt lgkmcnt(0)
    v_cmp_ne_u32_e64 vcc, 7, v2
    s_cbranch_vccz L_cwk
    s_sleep 1
    s_branch L_cw
L_cwk:
    s_add_u32 m0, s72, 98304
    s_add_u32 s3, s73, 1572864
    buffer_load_dwordx4 v216, s[88:91], s3 offen offset:0 lds
    buffer_load_dwordx4 v217, s[88:91], s3 offen offset:1024 lds
    buffer_load_dwordx4 v218, s[88:91], s3 offen offset:2048 lds
    buffer_load_dwordx4 v219, s[88:91], s3 offen offset:3072 lds
    s_add_u32 m0, s72, 114688
    s_add_u32 s3, s73, 1835008
    buffer_load_dwordx4 v216, s[88:91], s3 offen offset:0 lds
    buffer_load_dwordx4 v217, s[88:91], s3 offen offset:1024 lds
    buffer_load_dwordx4 v218, s[88:91], s3 offen offset:2048 lds
    buffer_load_dwordx4 v219, s[88:91], s3 offen offset:3072 lds
L_p3:
    s_nop 3
    s_mov_b32 s56, s22
    s_mov_b32 s57, s23
    s_mov_b32 s58, 4194304
    s_mov_b32 s59, 0x00020000
    s_lshr_b32 s64, s39, 2
    s_lshl_b32 s3, s34, 2
    s_add_u32 s3, s3, s38
    s_lshl_b32 s3, s3, 16
    s_lshl_b32 s28, s64, 14
    s_add_u32 s3, s3, s28
    s_add_u32 s76, s3, 4194304
    s_lshl_b32 s3, s64, 15
    v_lshlrev_b32 v2, 4, v1
    v_add_u32 v116, s3, v2
    v_xor_b32 v117, 0x8000, v116
    v_lshrrev_b32 v2, 2, v1
    v_lshlrev_b32 v2, 7, v2
    v_bfe_u32 v3, v1, 3, 2
    v_lshl_add_u32 v2, v3, 5, v2
    v_and_b32 v3, 3, v1
    v_lshl_add_u32 v2, v3, 3, v2
    s_lshl_b32 s3, s64, 16
    v_add_u32 v112, s3, v2
    v_xor_b32 v113, 32, v112
    v_xor_b32 v114, 64, v112
    v_xor_b32 v115, 96, v112
    s_add_u32 s77, s76, 0
    buffer_load_dwordx4 v[40:43], v116, s[48:51], s77 offen offset:0 sc1
    buffer_load_dwordx4 v[44:47], v117, s[48:51], s77 offen offset:0 sc1
    buffer_load_dwordx4 v[48:51], v116, s[48:51], s77 offen offset:1024 sc1
    buffer_load_dwordx4 v[52:55], v117, s[48:51], s77 offen offset:1024 sc1
    buffer_load_dwordx4 v[56:59], v116, s[48:51], s77 offen offset:2048 sc1
    buffer_load_dwordx4 v[60:63], v117, s[48:51], s77 offen offset:2048 sc1
    buffer_load_dwordx4 v[64:67], v116, s[48:51], s77 offen offset:3072 sc1
    buffer_load_dwordx4 v[68:71], v117, s[48:51], s77 offen offset:3072 sc1
    s_lshr_b32 s3, s68, 7
    s_xor_b32 s83, s3, s34
    s_or_b32 s83, s83, s39
    v_lshlrev_b32 v222, 4, v1
    ds_read_b64_tr_b16 v[80:81], v112 offset:0
    ds_read_b64_tr_b16 v[82:83], v112 offset:2048
    ds_read_b64_tr_b16 v[84:85], v113 offset:0
    ds_read_b64_tr_b16 v[86:87], v113 offset:2048
    ds_read_b64_tr_b16 v[88:89], v114 offset:0
    ds_read_b64_tr_b16 v[90:91], v114 offset:2048
    ds_read_b64_tr_b16 v[92:93], v115 offset:0
    ds_read_b64_tr_b16 v[94:95], v115 offset:2048
    s_mov_b32 s29, 0
    s_waitcnt vmcnt(6)
    v_max3_u32 v2, v40, v41, v42
    v_max3_u32 v2, v2, v43, v44
    v_max3_u32 v2, v2, v45, v46
    v_max_u32 v2, v2, v47
    v_cmp_eq_u32 vcc, -1, v2
    s_cbranch_vccnz L_r0
L_g0:
    s_waitcnt lgkmcnt(0)
    v_mfma_f32_16x16x32_bf16 v[8:11], v[80:83], v[40:43], 0
    ds_read_b64_tr_b16 v[96:97], v112 offset:4096
    ds_read_b64_tr_b16 v[98:99], v112 offset:6144
    v_mfma_f32_16x16x32_bf16 v[24:27], v[80:83], v[44:47], 0
    ds_read_b64_tr_b16 v[100:101], v113 offset:4096
    ds_read_b64_tr_b16 v[102:103], v113 offset:6144
    v_mfma_f32_16x16x32_bf16 v[12:15], v[84:87], v[40:43], 0
    ds_read_b64_tr_b16 v[104:105], v114 offset:4096
    ds_read_b64_tr_b16 v[106:107], v114 offset:6144
    v_mfma_f32_16x16x32_bf16 v[28:31], v[84:87], v[44:47], 0
    ds_read_b64_tr_b16 v[108:109], v115 offset:4096
    ds_read_b64_tr_b16 v[110:111], v115 offset:6144
    v_mfma_f32_16x16x32_bf16 v[16:19], v[88:91], v[40:43], 0
    s_add_u32 s77, s76, 4096
    buffer_load_dwordx4 v[72:75], v116, s[48:51], s77 offen offset:0 sc1
    buffer_load_dwordx4 v[76:79], v117, s[48:51], s77 offen offset:0 sc1
    v_mfma_f32_16x16x32_bf16 v[32:35], v[88:91], v[44:47], 0
    s_waitcnt vmcnt(6)
    v_max3_u32 v2, v48, v49, v50
    v_mfma_f32_16x16x32_bf16 v[20:23], v[92:95], v[40:43], 0
    v_max3_u32 v2, v2, v51, v52
    v_max3_u32 v2, v2, v53, v54
    v_mfma_f32_16x16x32_bf16 v[36:39], v[92:95], v[44:47], 0
    v_max_u32 v2, v2, v55
    v_cmp_eq_u32_e64 vcc, -1, v2
    s_cbranch_vccnz L_r1
L_g1:
    s_waitcnt lgkmcnt(0)
    v_mfma_f32_16x16x32_bf16 v[8:11], v[96:99], v[48:51], v[8:11]
    ds_read_b64_tr_b16 v[80:81], v112 offset:8192
    ds_read_b64_tr_b16 v[82:83], v112 offset:10240
    v_mfma_f32_16x16x32_bf16 v[24:27], v[96:99], v[52:55], v[24:27]
    ds_read_b64_tr_b16 v[84:85], v113 offset:8192
    ds_read_b64_tr_b16 v[86:87], v113 offset:10240
    v_mfma_f32_16x16x32_bf16 v[12:15], v[100:103], v[48:51], v[12:15]
    ds_read_b64_tr_b16 v[88:89], v114 offset:8192
    ds_read_b64_tr_b16 v[90:91], v114 offset:10240
    v_mfma_f32_16x16x32_bf16 v[28:31], v[100:103], v[52:55], v[28:31]
    ds_read_b64_tr_b16 v[92:93], v115 offset:8192
    ds_read_b64_tr_b16 v[94:95], v115 offset:10240
    v_mfma_f32_16x16x32_bf16 v[16:19], v[104:107], v[48:51], v[16:19]
    buffer_load_dwordx4 v[40:43], v116, s[48:51], s77 offen offset:1024 sc1
    buffer_load_dwordx4 v[44:47], v117, s[48:51], s77 offen offset:1024 sc1
    v_mfma_f32_16x16x32_bf16 v[32:35], v[104:107], v[52:55], v[32:35]
    s_waitcnt vmcnt(6)
    v_max3_u32 v2, v56, v57, v58
    v_mfma_f32_16x16x32_bf16 v[20:23], v[108:111], v[48:51], v[20:23]
    v_max3_u32 v2, v2, v59, v60
    v_max3_u32 v2, v2, v61, v62
    v_mfma_f32_16x16x32_bf16 v[36:39], v[108:111], v[52:55], v[36:39]
    v_max_u32 v2, v2, v63
    v_cmp_eq_u32_e64 vcc, -1, v2
    s_cbranch_vccnz L_r2
L_g2:
    s_waitcnt lgkmcnt(0)
    v_mfma_f32_16x16x32_bf16 v[8:11], v[80:83], v[56:59], v[8:11]
    ds_read_b64_tr_b16 v[96:97], v112 offset:12288
    ds_read_b64_tr_b16 v[98:99], v112 offset:14336
    v_mfma_f32_16x16x32_bf16 v[24:27], v[80:83], v[60:63], v[24:27]
    ds_read_b64_tr_b16 v[100:101], v113 offset:12288
    ds_read_b64_tr_b16 v[102:103], v113 offset:14336
    v_mfma_f32_16x16x32_bf16 v[12:15], v[84:87], v[56:59], v[12:15]
    ds_read_b64_tr_b16 v[104:105], v114 offset:12288
    ds_read_b64_tr_b16 v[106:107], v114 offset:14336
    v_mfma_f32_16x16x32_bf16 v[28:31], v[84:87], v[60:63], v[28:31]
    ds_read_b64_tr_b16 v[108:109], v115 offset:12288
    ds_read_b64_tr_b16 v[110:111], v115 offset:14336
    v_mfma_f32_16x16x32_bf16 v[16:19], v[88:91], v[56:59], v[16:19]
    buffer_load_dwordx4 v[48:51], v116, s[48:51], s77 offen offset:2048 sc1
    buffer_load_dwordx4 v[52:55], v117, s[48:51], s77 offen offset:2048 sc1
    v_mfma_f32_16x16x32_bf16 v[32:35], v[88:91], v[60:63], v[32:35]
    s_waitcnt vmcnt(6)
    v_max3_u32 v2, v64, v65, v66
    v_mfma_f32_16x16x32_bf16 v[20:23], v[92:95], v[56:59], v[20:23]
    v_max3_u32 v2, v2, v67, v68
    v_max3_u32 v2, v2, v69, v70
    v_mfma_f32_16x16x32_bf16 v[36:39], v[92:95], v[60:63], v[36:39]
    v_max_u32 v2, v2, v71
    v_cmp_eq_u32 vcc, -1, v2
    s_cbranch_vccnz L_r3
L_g3:
    s_waitcnt lgkmcnt(0)
    s_cmp_eq_u32 s64, 0
    s_cbranch_scc1 L_nb3
    s_barrier
L_nb3:
    v_mfma_f32_16x16x32_bf16 v[8:11], v[96:99], v[64:67], v[8:11]
    ds_read_b64_tr_b16 v[80:81], v112 offset:16384
    ds_read_b64_tr_b16 v[82:83], v112 offset:18432
    v_mfma_f32_16x16x32_bf16 v[24:27], v[96:99], v[68:71], v[24:27]
    ds_read_b64_tr_b16 v[84:85], v113 offset:16384
    ds_read_b64_tr_b16 v[86:87], v113 offset:18432
    v_mfma_f32_16x16x32_bf16 v[12:15], v[100:103], v[64:67], v[12:15]
    ds_read_b64_tr_b16 v[88:89], v114 offset:16384
    ds_read_b64_tr_b16 v[90:91], v114 offset:18432
    v_mfma_f32_16x16x32_bf16 v[28:31], v[100:103], v[68:71], v[28:31]
    ds_read_b64_tr_b16 v[92:93], v115 offset:16384
    ds_read_b64_tr_b16 v[94:95], v115 offset:18432
    v_mfma_f32_16x16x32_bf16 v[16:19], v[104:107], v[64:67], v[16:19]
    buffer_load_dwordx4 v[56:59], v116, s[48:51], s77 offen offset:3072 sc1
    buffer_load_dwordx4 v[60:63], v117, s[48:51], s77 offen offset:3072 sc1
    v_mfma_f32_16x16x32_bf16 v[32:35], v[104:107], v[68:71], v[32:35]
    s_waitcnt vmcnt(6)
    v_max3_u32 v2, v72, v73, v74
    v_mfma_f32_16x16x32_bf16 v[20:23], v[108:111], v[64:67], v[20:23]
    v_max3_u32 v2, v2, v75, v76
    v_max3_u32 v2, v2, v77, v78
    v_mfma_f32_16x16x32_bf16 v[36:39], v[108:111], v[68:71], v[36:39]
    v_max_u32 v2, v2, v79
    v_cmp_eq_u32_e64 vcc, -1, v2
    s_cbranch_vccnz L_r4
L_g4:
    s_waitcnt lgkmcnt(0)
    v_mfma_f32_16x16x32_bf16 v[8:11], v[80:83], v[72:75], v[8:11]
    ds_read_b64_tr_b16 v[96:97], v112 offset:20480
    ds_read_b64_tr_b16 v[98:99], v112 offset:22528
    v_mfma_f32_16x16x32_bf16 v[24:27], v[80:83], v[76:79], v[24:27]
    ds_read_b64_tr_b16 v[100:101], v113 offset:20480
    ds_read_b64_tr_b16 v[102:103], v113 offset:22528
    v_mfma_f32_16x16x32_bf16 v[12:15], v[84:87], v[72:75], v[12:15]
    ds_read_b64_tr_b16 v[104:105], v114 offset:20480
    ds_read_b64_tr_b16 v[106:107], v114 offset:22528
    v_mfma_f32_16x16x32_bf16 v[28:31], v[84:87], v[76:79], v[28:31]
    ds_read_b64_tr_b16 v[108:109], v115 offset:20480
    ds_read_b64_tr_b16 v[110:111], v115 offset:22528
    v_mfma_f32_16x16x32_bf16 v[16:19], v[88:91], v[72:75], v[16:19]
    s_add_u32 s77, s76, 8192
    buffer_load_dwordx4 v[64:67], v116, s[48:51], s77 offen offset:0 sc1
    buffer_load_dwordx4 v[68:71], v117, s[48:51], s77 offen offset:0 sc1
    v_mfma_f32_16x16x32_bf16 v[32:35], v[88:91], v[76:79], v[32:35]
    s_waitcnt vmcnt(6)
    v_max3_u32 v2, v40, v41, v42
    v_mfma_f32_16x16x32_bf16 v[20:23], v[92:95], v[72:75], v[20:23]
    v_max3_u32 v2, v2, v43, v44
    v_max3_u32 v2, v2, v45, v46
    v_mfma_f32_16x16x32_bf16 v[36:39], v[92:95], v[76:79], v[36:39]
    v_max_u32 v2, v2, v47
    v_cmp_eq_u32_e64 vcc, -1, v2
    s_cbranch_vccnz L_r5
L_g5:
    s_waitcnt lgkmcnt(0)
    v_mfma_f32_16x16x32_bf16 v[8:11], v[96:99], v[40:43], v[8:11]
    ds_read_b64_tr_b16 v[80:81], v112 offset:24576
    ds_read_b64_tr_b16 v[82:83], v112 offset:26624
    v_mfma_f32_16x16x32_bf16 v[24:27], v[96:99], v[44:47], v[24:27]
    ds_read_b64_tr_b16 v[84:85], v113 offset:24576
    ds_read_b64_tr_b16 v[86:87], v113 offset:26624
    v_mfma_f32_16x16x32_bf16 v[12:15], v[100:103], v[40:43], v[12:15]
    ds_read_b64_tr_b16 v[88:89], v114 offset:24576
    ds_read_b64_tr_b16 v[90:91], v114 offset:26624
    v_mfma_f32_16x16x32_bf16 v[28:31], v[100:103], v[44:47], v[28:31]
    ds_read_b64_tr_b16 v[92:93], v115 offset:24576
    ds_read_b64_tr_b16 v[94:95], v115 offset:26624
    v_mfma_f32_16x16x32_bf16 v[16:19], v[104:107], v[40:43], v[16:19]
    buffer_load_dwordx4 v[72:75], v116, s[48:51], s77 offen offset:1024 sc1
    buffer_load_dwordx4 v[76:79], v117, s[48:51], s77 offen offset:1024 sc1
    v_mfma_f32_16x16x32_bf16 v[32:35], v[104:107], v[44:47], v[32:35]
    s_waitcnt vmcnt(6)
    v_max3_u32 v2, v48, v49, v50
    v_mfma_f32_16x16x32_bf16 v[20:23], v[108:111], v[40:43], v[20:23]
    v_max3_u32 v2, v2, v51, v52
    v_max3_u32 v2, v2, v53, v54
    v_mfma_f32_16x16x32_bf16 v[36:39], v[108:111], v[44:47], v[36:39]
    v_max_u32 v2, v2, v55
    v_cmp_eq_u32_e64 vcc, -1, v2
    s_cbranch_vccnz L_r6
L_g6:
    s_waitcnt lgkmcnt(0)
    v_mfma_f32_16x16x32_bf16 v[8:11], v[80:83], v[48:51], v[8:11]
    ds_read_b64_tr_b16 v[96:97], v112 offset:28672
    ds_read_b64_tr_b16 v[98:99], v112 offset:30720
    v_mfma_f32_16x16x32_bf16 v[24:27], v[80:83], v[52:55], v[24:27]
    ds_read_b64_tr_b16 v[100:101], v113 offset:28672
    ds_read_b64_tr_b16 v[102:103], v113 offset:30720
    v_mfma_f32_16x16x32_bf16 v[12:15], v[84:87], v[48:51], v[12:15]
    ds_read_b64_tr_b16 v[104:105], v114 offset:28672
    ds_read_b64_tr_b16 v[106:107], v114 offset:30720
    v_mfma_f32_16x16x32_bf16 v[28:31], v[84:87], v[52:55], v[28:31]
    ds_read_b64_tr_b16 v[108:109], v115 offset:28672
    ds_read_b64_tr_b16 v[110:111], v115 offset:30720
    v_mfma_f32_16x16x32_bf16 v[16:19], v[88:91], v[48:51], v[16:19]
    buffer_load_dwordx4 v[40:43], v116, s[48:51], s77 offen offset:2048 sc1
    buffer_load_dwordx4 v[44:47], v117, s[48:51], s77 offen offset:2048 sc1
    v_mfma_f32_16x16x32_bf16 v[32:35], v[88:91], v[52:55], v[32:35]
    s_waitcnt vmcnt(6)
    v_max3_u32 v2, v56, v57, v58
    v_mfma_f32_16x16x32_bf16 v[20:23], v[92:95], v[48:51], v[20:23]
    v_max3_u32 v2, v2, v59, v60
    v_max3_u32 v2, v2, v61, v62
    v_mfma_f32_16x16x32_bf16 v[36:39], v[92:95], v[52:55], v[36:39]
    v_max_u32 v2, v2, v63
    v_cmp_eq_u32 vcc, -1, v2
    s_cbranch_vccnz L_r7
L_g7:
    s_waitcnt lgkmcnt(0)
    s_cmp_eq_u32 s64, 1
    s_cbranch_scc1 L_nb7
    s_barrier
L_nb7:
    v_mfma_f32_16x16x32_bf16 v[8:11], v[96:99], v[56:59], v[8:11]
    ds_read_b64_tr_b16 v[80:81], v112 offset:32768
    ds_read_b64_tr_b16 v[82:83], v112 offset:34816
    v_mfma_f32_16x16x32_bf16 v[24:27], v[96:99], v[60:63], v[24:27]
    ds_read_b64_tr_b16 v[84:85], v113 offset:32768
    ds_read_b64_tr_b16 v[86:87], v113 offset:34816
    v_mfma_f32_16x16x32_bf16 v[12:15], v[100:103], v[56:59], v[12:15]
    ds_read_b64_tr_b16 v[88:89], v114 offset:32768
    ds_read_b64_tr_b16 v[90:91], v114 offset:34816
    v_mfma_f32_16x16x32_bf16 v[28:31], v[100:103], v[60:63], v[28:31]
    ds_read_b64_tr_b16 v[92:93], v115 offset:32768
    ds_read_b64_tr_b16 v[94:95], v115 offset:34816
    v_mfma_f32_16x16x32_bf16 v[16:19], v[104:107], v[56:59], v[16:19]
    buffer_load_dwordx4 v[48:51], v116, s[48:51], s77 offen offset:3072 sc1
    buffer_load_dwordx4 v[52:55], v117, s[48:51], s77 offen offset:3072 sc1
    v_mfma_f32_16x16x32_bf16 v[32:35], v[104:107], v[60:63], v[32:35]
    s_waitcnt vmcnt(6)
    v_max3_u32 v2, v64, v65, v66
    v_mfma_f32_16x16x32_bf16 v[20:23], v[108:111], v[56:59], v[20:23]
    v_max3_u32 v2, v2, v67, v68
    v_max3_u32 v2, v2, v69, v70
    v_mfma_f32_16x16x32_bf16 v[36:39], v[108:111], v[60:63], v[36:39]
    v_max_u32 v2, v2, v71
    v_cmp_eq_u32_e64 vcc, -1, v2
    s_cbranch_vccnz L_r8
L_g8:
    s_waitcnt lgkmcnt(0)
    v_mfma_f32_16x16x32_bf16 v[8:11], v[80:83], v[64:67], v[8:11]
    ds_read_b64_tr_b16 v[96:97], v112 offset:36864
    ds_read_b64_tr_b16 v[98:99], v112 offset:38912
    v_mfma_f32_16x16x32_bf16 v[24:27], v[80:83], v[68:71], v[24:27]
    ds_read_b64_tr_b16 v[100:101], v113 offset:36864
    ds_read_b64_tr_b16 v[102:103], v113 offset:38912
    v_mfma_f32_16x16x32_bf16 v[12:15], v[84:87], v[64:67], v[12:15]
    ds_read_b64_tr_b16 v[104:105], v114 offset:36864
    ds_read_b64_tr_b16 v[106:107], v114 offset:38912
    v_mfma_f32_16x16x32_bf16 v[28:31], v[84:87], v[68:71], v[28:31]
    ds_read_b64_tr_b16 v[108:109], v115 offset:36864
    ds_read_b64_tr_b16 v[110:111], v115 offset:38912
    v_mfma_f32_16x16x32_bf16 v[16:19], v[88:91], v[64:67], v[16:19]
    s_add_u32 s77, s76, 12288
    buffer_load_dwordx4 v[56:59], v116, s[48:51], s77 offen offset:0 sc1
    buffer_load_dwordx4 v[60:63], v117, s[48:51], s77 offen offset:0 sc1
    v_mfma_f32_16x16x32_bf16 v[32:35], v[88:91], v[68:71], v[32:35]
    s_waitcnt vmcnt(6)
    v_max3_u32 v2, v72, v73, v74
    v_mfma_f32_16x16x32_bf16 v[20:23], v[92:95], v[64:67], v[20:23]
    v_max3_u32 v2, v2, v75, v76
    v_max3_u32 v2, v2, v77, v78
    v_mfma_f32_16x16x32_bf16 v[36:39], v[92:95], v[68:71], v[36:39]
    v_max_u32 v2, v2, v79
    v_cmp_eq_u32_e64 vcc, -1, v2
    s_cbranch_vccnz L_r9
L_g9:
    s_waitcnt lgkmcnt(0)
    v_mfma_f32_16x16x32_bf16 v[8:11], v[96:99], v[72:75], v[8:11]
    ds_read_b64_tr_b16 v[80:81], v112 offset:40960
    ds_read_b64_tr_b16 v[82:83], v112 offset:43008
    v_mfma_f32_16x16x32_bf16 v[24:27], v[96:99], v[76:79], v[24:27]
    ds_read_b64_tr_b16 v[84:85], v113 offset:40960
    ds_read_b64_tr_b16 v[86:87], v113 offset:43008
    v_mfma_f32_16x16x32_bf16 v[12:15], v[100:103], v[72:75], v[12:15]
    ds_read_b64_tr_b16 v[88:89], v114 offset:40960
    ds_read_b64_tr_b16 v[90:91], v114 offset:43008
    v_mfma_f32_16x16x32_bf16 v[28:31], v[100:103], v[76:79], v[28:31]
    ds_read_b64_tr_b16 v[92:93], v115 offset:40960
    ds_read_b64_tr_b16 v[94:95], v115 offset:43008
    v_mfma_f32_16x16x32_bf16 v[16:19], v[104:107], v[72:75], v[16:19]
    buffer_load_dwordx4 v[64:67], v116, s[48:51], s77 offen offset:1024 sc1
    buffer_load_dwordx4 v[68:71], v117, s[48:51], s77 offen offset:1024 sc1
    v_mfma_f32_16x16x32_bf16 v[32:35], v[104:107], v[76:79], v[32:35]
    s_waitcnt vmcnt(6)
    v_max3_u32 v2, v40, v41, v42
    v_mfma_f32_16x16x32_bf16 v[20:23], v[108:111], v[72:75], v[20:23]
    v_max3_u32 v2, v2, v43, v44
    v_max3_u32 v2, v2, v45, v46
    v_mfma_f32_16x16x32_bf16 v[36:39], v[108:111], v[76:79], v[36:39]
    v_max_u32 v2, v2, v47
    v_cmp_eq_u32_e64 vcc, -1, v2
    s_cbranch_vccnz L_r10
L_g10:
    s_waitcnt lgkmcnt(0)
    v_mfma_f32_16x16x32_bf16 v[8:11], v[80:83], v[40:43], v[8:11]
    ds_read_b64_tr_b16 v[96:97], v112 offset:45056
    ds_read_b64_tr_b16 v[98:99], v112 offset:47104
    v_mfma_f32_16x16x32_bf16 v[24:27], v[80:83], v[44:47], v[24:27]
    ds_read_b64_tr_b16 v[100:101], v113 offset:45056
    ds_read_b64_tr_b16 v[102:103], v113 offset:47104
    v_mfma_f32_16x16x32_bf16 v[12:15], v[84:87], v[40:43], v[12:15]
    ds_read_b64_tr_b16 v[104:105], v114 offset:45056
    ds_read_b64_tr_b16 v[106:107], v114 offset:47104
    v_mfma_f32_16x16x32_bf16 v[28:31], v[84:87], v[44:47], v[28:31]
    ds_read_b64_tr_b16 v[108:109], v115 offset:45056
    ds_read_b64_tr_b16 v[110:111], v115 offset:47104
    v_mfma_f32_16x16x32_bf16 v[16:19], v[88:91], v[40:43], v[16:19]
    buffer_load_dwordx4 v[72:75], v116, s[48:51], s77 offen offset:2048 sc1
    buffer_load_dwordx4 v[76:79], v117, s[48:51], s77 offen offset:2048 sc1
    v_mfma_f32_16x16x32_bf16 v[32:35], v[88:91], v[44:47], v[32:35]
    s_waitcnt vmcnt(6)
    v_max3_u32 v2, v48, v49, v50
    v_mfma_f32_16x16x32_bf16 v[20:23], v[92:95], v[40:43], v[20:23]
    v_max3_u32 v2, v2, v51, v52
    v_max3_u32 v2, v2, v53, v54
    v_mfma_f32_16x16x32_bf16 v[36:39], v[92:95], v[44:47], v[36:39]
    v_max_u32 v2, v2, v55
    v_cmp_eq_u32_e64 vcc, -1, v2
    s_cbranch_vccnz L_r11
L_g11:
    s_waitcnt lgkmcnt(0)
    v_mfma_f32_16x16x32_bf16 v[8:11], v[96:99], v[48:51], v[8:11]
    ds_read_b64_tr_b16 v[80:81], v112 offset:49152
    ds_read_b64_tr_b16 v[82:83], v112 offset:51200
    v_mfma_f32_16x16x32_bf16 v[24:27], v[96:99], v[52:55], v[24:27]
    ds_read_b64_tr_b16 v[84:85], v113 offset:49152
    ds_read_b64_tr_b16 v[86:87], v113 offset:51200
    v_mfma_f32_16x16x32_bf16 v[12:15], v[100:103], v[48:51], v[12:15]
    ds_read_b64_tr_b16 v[88:89], v114 offset:49152
    ds_read_b64_tr_b16 v[90:91], v114 offset:51200
    v_mfma_f32_16x16x32_bf16 v[28:31], v[100:103], v[52:55], v[28:31]
    ds_read_b64_tr_b16 v[92:93], v115 offset:49152
    ds_read_b64_tr_b16 v[94:95], v115 offset:51200
    v_mfma_f32_16x16x32_bf16 v[16:19], v[104:107], v[48:51], v[16:19]
    buffer_load_dwordx4 v[40:43], v116, s[48:51], s77 offen offset:3072 sc1
    buffer_load_dwordx4 v[44:47], v117, s[48:51], s77 offen offset:3072 sc1
    v_mfma_f32_16x16x32_bf16 v[32:35], v[104:107], v[52:55], v[32:35]
    s_waitcnt vmcnt(6)
    v_max3_u32 v2, v56, v57, v58
    v_mfma_f32_16x16x32_bf16 v[20:23], v[108:111], v[48:51], v[20:23]
    v_max3_u32 v2, v2, v59, v60
    v_max3_u32 v2, v2, v61, v62
    v_mfma_f32_16x16x32_bf16 v[36:39], v[108:111], v[52:55], v[36:39]
    v_max_u32 v2, v2, v63
    v_cmp_eq_u32_e64 vcc, -1, v2
    s_cbranch_vccnz L_r12
L_g12:
    s_waitcnt lgkmcnt(0)
    v_mfma_f32_16x16x32_bf16 v[8:11], v[80:83], v[56:59], v[8:11]
    ds_read_b64_tr_b16 v[96:97], v112 offset:53248
    ds_read_b64_tr_b16 v[98:99], v112 offset:55296
    v_mfma_f32_16x16x32_bf16 v[24:27], v[80:83], v[60:63], v[24:27]
    ds_read_b64_tr_b16 v[100:101], v113 offset:53248
    ds_read_b64_tr_b16 v[102:103], v113 offset:55296
    v_mfma_f32_16x16x32_bf16 v[12:15], v[84:87], v[56:59], v[12:15]
    ds_read_b64_tr_b16 v[104:105], v114 offset:53248
    ds_read_b64_tr_b16 v[106:107], v114 offset:55296
    v_mfma_f32_16x16x32_bf16 v[28:31], v[84:87], v[60:63], v[28:31]
    ds_read_b64_tr_b16 v[108:109], v115 offset:53248
    ds_read_b64_tr_b16 v[110:111], v115 offset:55296
    v_mfma_f32_16x16x32_bf16 v[16:19], v[88:91], v[56:59], v[16:19]
    v_mfma_f32_16x16x32_bf16 v[32:35], v[88:91], v[60:63], v[32:35]
    s_waitcnt vmcnt(4)
    v_max3_u32 v2, v64, v65, v66
    v_mfma_f32_16x16x32_bf16 v[20:23], v[92:95], v[56:59], v[20:23]
    v_max3_u32 v2, v2, v67, v68
    v_max3_u32 v2, v2, v69, v70
    v_mfma_f32_16x16x32_bf16 v[36:39], v[92:95], v[60:63], v[36:39]
    v_max_u32 v2, v2, v71
    v_cmp_eq_u32_e64 vcc, -1, v2
    s_cbranch_vccnz L_r13
L_g13:
    s_waitcnt lgkmcnt(0)
    v_mfma_f32_16x16x32_bf16 v[8:11], v[96:99], v[64:67], v[8:11]
    ds_read_b64_tr_b16 v[80:81], v112 offset:57344
    ds_read_b64_tr_b16 v[82:83], v112 offset:59392
    v_mfma_f32_16x16x32_bf16 v[24:27], v[96:99], v[68:71], v[24:27]
    ds_read_b64_tr_b16 v[84:85], v113 offset:57344
    ds_read_b64_tr_b16 v[86:87], v113 offset:59392
    v_mfma_f32_16x16x32_bf16 v[12:15], v[100:103], v[64:67], v[12:15]
    ds_read_b64_tr_b16 v[88:89], v114 offset:57344
    ds_read_b64_tr_b16 v[90:91], v114 offset:59392
    v_mfma_f32_16x16x32_bf16 v[28:31], v[100:103], v[68:71], v[28:31]
    ds_read_b64_tr_b16 v[92:93], v115 offset:57344
    ds_read_b64_tr_b16 v[94:95], v115 offset:59392
    v_mfma_f32_16x16x32_bf16 v[16:19], v[104:107], v[64:67], v[16:19]
    v_mfma_f32_16x16x32_bf16 v[32:35], v[104:107], v[68:71], v[32:35]
    s_waitcnt vmcnt(2)
    v_max3_u32 v2, v72, v73, v74
    v_mfma_f32_16x16x32_bf16 v[20:23], v[108:111], v[64:67], v[20:23]
    v_max3_u32 v2, v2, v75, v76
    v_max3_u32 v2, v2, v77, v78
    v_mfma_f32_16x16x32_bf16 v[36:39], v[108:111], v[68:71], v[36:39]
    v_max_u32 v2, v2, v79
    v_cmp_eq_u32_e64 vcc, -1, v2
    s_cbranch_vccnz L_r14
L_g14:
    s_cmp_eq_u32 s83, 0
    s_cbranch_scc1 L_fx1
L_fx1r:
    s_waitcnt lgkmcnt(0)
    v_mfma_f32_16x16x32_bf16 v[8:11], v[80:83], v[72:75], v[8:11]
    ds_read_b64_tr_b16 v[96:97], v112 offset:61440
    ds_read_b64_tr_b16 v[98:99], v112 offset:63488
    v_mfma_f32_16x16x32_bf16 v[24:27], v[80:83], v[76:79], v[24:27]
    ds_read_b64_tr_b16 v[100:101], v113 offset:61440
    ds_read_b64_tr_b16 v[102:103], v113 offset:63488
    v_mfma_f32_16x16x32_bf16 v[12:15], v[84:87], v[72:75], v[12:15]
    ds_read_b64_tr_b16 v[104:105], v114 offset:61440
    ds_read_b64_tr_b16 v[106:107], v114 offset:63488
    v_mfma_f32_16x16x32_bf16 v[28:31], v[84:87], v[76:79], v[28:31]
    ds_read_b64_tr_b16 v[108:109], v115 offset:61440
    ds_read_b64_tr_b16 v[110:111], v115 offset:63488
    v_mfma_f32_16x16x32_bf16 v[16:19], v[88:91], v[72:75], v[16:19]
    v_mfma_f32_16x16x32_bf16 v[32:35], v[88:91], v[76:79], v[32:35]
    s_waitcnt vmcnt(0)
    v_max3_u32 v2, v40, v41, v42
    v_mfma_f32_16x16x32_bf16 v[20:23], v[92:95], v[72:75], v[20:23]
    v_max3_u32 v2, v2, v43, v44
    v_max3_u32 v2, v2, v45, v46
    v_mfma_f32_16x16x32_bf16 v[36:39], v[92:95], v[76:79], v[36:39]
    v_max_u32 v2, v2, v47
    v_cmp_eq_u32_e64 vcc, -1, v2
    s_cbranch_vccnz L_r15
L_g15:
    s_waitcnt lgkmcnt(0)
    v_mfma_f32_16x16x32_bf16 v[8:11], v[96:99], v[40:43], v[8:11]
    v_mfma_f32_16x16x32_bf16 v[24:27], v[96:99], v[44:47], v[24:27]
    v_mfma_f32_16x16x32_bf16 v[12:15], v[100:103], v[40:43], v[12:15]
    v_mfma_f32_16x16x32_bf16 v[28:31], v[100:103], v[44:47], v[28:31]
    v_mfma_f32_16x16x32_bf16 v[16:19], v[104:107], v[40:43], v[16:19]
    v_mfma_f32_16x16x32_bf16 v[32:35], v[104:107], v[44:47], v[32:35]
    v_mfma_f32_16x16x32_bf16 v[20:23], v[108:111], v[40:43], v[20:23]
    v_mfma_f32_16x16x32_bf16 v[36:39], v[108:111], v[44:47], v[36:39]
    s_cmp_eq_u32 s83, 0
    s_cbranch_scc1 L_fx2
L_fx2r:
    s_lshl_b32 s3, s39, 12
    s_add_u32 s3, s3, 131072
    v_lshlrev_b32 v2, 4, v1
    v_add_u32_e64 v2, s3, v2
    v_xor_b32 v3, 0x4000, v2
    s_xor_b32 s28, s3, 0x4000
    ds_write_b128 v2, v[24:27] offset:0
    ds_write_b128 v2, v[28:31] offset:1024
    ds_write_b128 v2, v[32:35] offset:2048
    ds_write_b128 v2, v[36:39] offset:3072
    v_lshlrev_b32 v40, 16, v240
    v_and_b32 v41, 0xffff0000, v240
    v_lshlrev_b32 v42, 16, v241
    v_and_b32 v43, 0xffff0000, v241
    v_lshlrev_b32 v44, 16, v242
    v_and_b32 v45, 0xffff0000, v242
    v_lshlrev_b32 v46, 16, v243
    v_and_b32 v47, 0xffff0000, v243
    v_lshlrev_b32 v48, 16, v244
    v_and_b32 v49, 0xffff0000, v244
    v_lshlrev_b32 v50, 16, v245
    v_and_b32 v51, 0xffff0000, v245
    v_lshlrev_b32 v52, 16, v246
    v_and_b32 v53, 0xffff0000, v246
    v_lshlrev_b32 v54, 16, v247
    v_and_b32 v55, 0xffff0000, v247
    v_and_b32 v4, 15, v1
    v_lshrrev_b32 v5, 4, v1
    v_lshlrev_b32 v6, 1, v4
    v_and_b32 v6, 14, v6
    v_xor_b32_e64 v5, v5, v6
    v_lshl_add_u32 v4, v4, 7, s28
    v_lshl_add_u32 v4, v5, 3, v4
    v_lshrrev_b32 v5, 3, v1
    v_and_b32 v6, 7, v1
    v_xor_b32_e64 v7, v6, v5
    v_lshl_add_u32 v7, v7, 4, s28
    v_lshl_add_u32 v7, v5, 7, v7
    s_lshl_b32 s3, s34, 7
    s_add_u32 s3, s3, s69
    v_add_u32 v5, s3, v5
    v_lshlrev_b32 v5, 11, v5
    v_lshl_add_u32 v5, v6, 4, v5
    s_lshl_b32 s3, s35, 7
    s_add_u32 s28, s3, 16384
    s_lshl_b32 s29, s34, 7
    s_add_u32 s29, s29, s69
    s_andn2_b32 s77, s68, 15
    s_cmp_lg_u32 s29, s77
    s_waitcnt lgkmcnt(0)
    s_barrier
    s_cbranch_scc1 L_nov
    v_and_b32 v2, 48, v1
    s_and_b32 s29, s68, 15
    s_lshl_b32 exec_lo, 0x00010001, s29
    s_mov_b32 exec_hi, exec_lo
    ds_read_b128 v[224:227], v2 offset:0
    ds_read_b128 v[228:231], v2 offset:64
    ds_read_b128 v[232:235], v2 offset:128
    ds_read_b128 v[236:239], v2 offset:192
    s_mov_b64 exec, -1
L_nov:
    ds_read_b128 v[24:27], v3 offset:0
    ds_read_b128 v[28:31], v3 offset:1024
    ds_read_b128 v[32:35], v3 offset:2048
    ds_read_b128 v[36:39], v3 offset:3072
    s_waitcnt lgkmcnt(3)
    s_nop 0
    v_pk_add_f32 v[8:9], v[8:9], v[24:25]
    v_pk_add_f32 v[10:11], v[10:11], v[26:27]
    v_pk_fma_f32 v[40:41], v[8:9], v[224:225], v[40:41]
    v_pk_fma_f32 v[42:43], v[10:11], v[226:227], v[42:43]
    v_cvt_pk_bf16_f32 v8, v40, v41
    v_cvt_pk_bf16_f32 v9, v42, v43
    s_waitcnt lgkmcnt(2)
    s_nop 0
    v_pk_add_f32 v[12:13], v[12:13], v[28:29]
    v_pk_add_f32 v[14:15], v[14:15], v[30:31]
    v_pk_fma_f32 v[44:45], v[12:13], v[228:229], v[44:45]
    v_pk_fma_f32 v[46:47], v[14:15], v[230:231], v[46:47]
    v_cvt_pk_bf16_f32 v10, v44, v45
    v_cvt_pk_bf16_f32 v11, v46, v47
    s_waitcnt lgkmcnt(1)
    s_nop 0
    v_pk_add_f32 v[16:17], v[16:17], v[32:33]
    v_pk_add_f32 v[18:19], v[18:19], v[34:35]
    v_pk_fma_f32 v[48:49], v[16:17], v[232:233], v[48:49]
    v_pk_fma_f32 v[50:51], v[18:19], v[234:235], v[50:51]
    v_cvt_pk_bf16_f32 v12, v48, v49
    v_cvt_pk_bf16_f32 v13, v50, v51
    s_waitcnt lgkmcnt(0)
    s_nop 0
    v_pk_add_f32 v[20:21], v[20:21], v[36:37]
    v_pk_add_f32 v[22:23], v[22:23], v[38:39]
    v_pk_fma_f32 v[52:53], v[20:21], v[236:237], v[52:53]
    v_pk_fma_f32 v[54:55], v[22:23], v[238:239], v[54:55]
    v_cvt_pk_bf16_f32 v14, v52, v53
    v_cvt_pk_bf16_f32 v15, v54, v55
    ds_write_b64 v4, v[8:9]
    v_xor_b32 v6, 32, v4
    ds_write_b64 v6, v[10:11]
    v_xor_b32 v6, 64, v4
    ds_write_b64 v6, v[12:13]
    v_xor_b32 v6, 96, v4
    ds_write_b64 v6, v[14:15]
    ds_read_b128 v[24:27], v7 offset:0
    ds_read_b128 v[28:31], v7 offset:1024
    s_waitcnt lgkmcnt(1)
    buffer_store_dwordx4 v[24:27], v5, s[56:59], s3 offen sc1
    s_waitcnt lgkmcnt(0)
    buffer_store_dwordx4 v[28:31], v5, s[56:59], s28 offen sc1
L_done:
    s_endpgm
L_fx1:
    s_lshl_b32 s78, s35, 14
    s_add_u32 s78, s78, 1413120
    v_and_b32 v2, 15, v1
    v_lshrrev_b32 v3, 4, v1
    v_lshl_add_u32 v193, v2, 2, v3
    v_and_b32 v2, 7, v193
    v_lshrrev_b32 v193, 3, v193
    v_lshl_add_u32 v193, v2, 3, v193
    v_lshlrev_b32 v2, 1, v193
    s_lshl_b32 s3, s68, 11
    s_lshl_b32 s28, s35, 7
    s_add_u32 s3, s3, s28
    buffer_load_ushort v194, v2, s[40:43], s3 offen
    s_add_u32 s3, s78, 0
    s_nop 0
    buffer_load_dwordx4 v[128:131], v222, s[48:51], s3 offen offset:0 sc1
    buffer_load_dwordx4 v[132:135], v222, s[48:51], s3 offen offset:1024 sc1
    buffer_load_dwordx4 v[136:139], v222, s[48:51], s3 offen offset:2048 sc1
    buffer_load_dwordx4 v[140:143], v222, s[48:51], s3 offen offset:3072 sc1
    s_add_u32 s3, s78, 4096
    buffer_load_dwordx4 v[144:147], v222, s[48:51], s3 offen offset:0 sc1
    buffer_load_dwordx4 v[148:151], v222, s[48:51], s3 offen offset:1024 sc1
    buffer_load_dwordx4 v[152:155], v222, s[48:51], s3 offen offset:2048 sc1
    buffer_load_dwordx4 v[156:159], v222, s[48:51], s3 offen offset:3072 sc1
    s_add_u32 s3, s78, 8192
    buffer_load_dwordx4 v[160:163], v222, s[48:51], s3 offen offset:0 sc1
    buffer_load_dwordx4 v[164:167], v222, s[48:51], s3 offen offset:1024 sc1
    buffer_load_dwordx4 v[168:171], v222, s[48:51], s3 offen offset:2048 sc1
    buffer_load_dwordx4 v[172:175], v222, s[48:51], s3 offen offset:3072 sc1
    s_add_u32 s3, s78, 12288
    buffer_load_dwordx4 v[176:179], v222, s[48:51], s3 offen offset:0 sc1
    buffer_load_dwordx4 v[180:183], v222, s[48:51], s3 offen offset:1024 sc1
    buffer_load_dwordx4 v[184:187], v222, s[48:51], s3 offen offset:2048 sc1
    buffer_load_dwordx4 v[188:191], v222, s[48:51], s3 offen offset:3072 sc1
    s_branch L_fx1r
L_fx2:
    s_and_b32 s3, s70, 0xffff0000
    s_xor_b32 s28, s3, 0x80000000
    s_not_b32 s29, s3
    s_and_b32 s29, s29, 0xffff0000
    s_bitcmp1_b32 s3, 31
    s_cselect_b32 s3, s28, s29
    v_mov_b32 v195, s3
    v_mul_f32 v195, 0xbfb8aa3b, v195
    v_exp_f32 v195, v195
    s_nop 0
    v_add_f32 v195, 1.0, v195
    v_rcp_f32 v195, v195
    s_nop 0
    v_cvt_pk_bf16_f32 v195, v195, v195
    v_lshlrev_b32 v195, 16, v195
    s_mov_b32 s29, 0
L_k6:
    v_max3_u32 v2, v128, v129, v130
    v_max3_u32 v2, v2, v131, v132
    v_max3_u32 v2, v2, v133, v134
    v_max3_u32 v2, v2, v135, v136
    v_max3_u32 v2, v2, v137, v138
    v_max3_u32 v2, v2, v139, v140
    v_max3_u32 v2, v2, v141, v142
    v_max3_u32 v2, v2, v143, v144
    v_max3_u32 v2, v2, v145, v146
    v_max3_u32 v2, v2, v147, v148
    v_max3_u32 v2, v2, v149, v150
    v_max3_u32 v2, v2, v151, v152
    v_max3_u32 v2, v2, v153, v154
    v_max3_u32 v2, v2, v155, v156
    v_max3_u32 v2, v2, v157, v158
    v_max3_u32 v2, v2, v159, v160
    v_max3_u32 v2, v2, v161, v162
    v_max3_u32 v2, v2, v163, v164
    v_max3_u32 v2, v2, v165, v166
    v_max3_u32 v2, v2, v167, v168
    v_max3_u32 v2, v2, v169, v170
    v_max3_u32 v2, v2, v171, v172
    v_max3_u32 v2, v2, v173, v174
    v_max3_u32 v2, v2, v175, v176
    v_max3_u32 v2, v2, v177, v178
    v_max3_u32 v2, v2, v179, v180
    v_max3_u32 v2, v2, v181, v182
    v_max3_u32 v2, v2, v183, v184
    v_max3_u32 v2, v2, v185, v186
    v_max3_u32 v2, v2, v187, v188
    v_max3_u32 v2, v2, v189, v190
    v_max_u32 v2, v2, v191
    v_cmp_eq_u32 vcc, -1, v2
    s_cbranch_vccz L_k6k
    s_add_u32 s29, s29, 1
    s_cmp_ge_u32 s29, 200000
    s_cbranch_scc1 L_k6k
    s_sleep 4
    s_add_u32 s3, s78, 0
    s_nop 0
    buffer_load_dwordx4 v[128:131], v222, s[48:51], s3 offen offset:0 sc1
    buffer_load_dwordx4 v[132:135], v222, s[48:51], s3 offen offset:1024 sc1
    buffer_load_dwordx4 v[136:139], v222, s[48:51], s3 offen offset:2048 sc1
    buffer_load_dwordx4 v[140:143], v222, s[48:51], s3 offen offset:3072 sc1
    s_add_u32 s3, s78, 4096
    buffer_load_dwordx4 v[144:147], v222, s[48:51], s3 offen offset:0 sc1
    buffer_load_dwordx4 v[148:151], v222, s[48:51], s3 offen offset:1024 sc1
    buffer_load_dwordx4 v[152:155], v222, s[48:51], s3 offen offset:2048 sc1
    buffer_load_dwordx4 v[156:159], v222, s[48:51], s3 offen offset:3072 sc1
    s_add_u32 s3, s78, 8192
    buffer_load_dwordx4 v[160:163], v222, s[48:51], s3 offen offset:0 sc1
    buffer_load_dwordx4 v[164:167], v222, s[48:51], s3 offen offset:1024 sc1
    buffer_load_dwordx4 v[168:171], v222, s[48:51], s3 offen offset:2048 sc1
    buffer_load_dwordx4 v[172:175], v222, s[48:51], s3 offen offset:3072 sc1
    s_add_u32 s3, s78, 12288
    buffer_load_dwordx4 v[176:179], v222, s[48:51], s3 offen offset:0 sc1
    buffer_load_dwordx4 v[180:183], v222, s[48:51], s3 offen offset:1024 sc1
    buffer_load_dwordx4 v[184:187], v222, s[48:51], s3 offen offset:2048 sc1
    buffer_load_dwordx4 v[188:191], v222, s[48:51], s3 offen offset:3072 sc1
    s_waitcnt vmcnt(0)
    s_branch L_k6
L_k6k:
    v_pk_add_f32 v[128:129], v[128:129], v[160:161]
    v_pk_add_f32 v[130:131], v[130:131], v[162:163]
    v_pk_add_f32 v[132:133], v[132:133], v[164:165]
    v_pk_add_f32 v[134:135], v[134:135], v[166:167]
    v_pk_add_f32 v[136:137], v[136:137], v[168:169]
    v_pk_add_f32 v[138:139], v[138:139], v[170:171]
    v_pk_add_f32 v[140:141], v[140:141], v[172:173]
    v_pk_add_f32 v[142:143], v[142:143], v[174:175]
    v_pk_add_f32 v[144:145], v[144:145], v[176:177]
    v_pk_add_f32 v[146:147], v[146:147], v[178:179]
    v_pk_add_f32 v[148:149], v[148:149], v[180:181]
    v_pk_add_f32 v[150:151], v[150:151], v[182:183]
    v_pk_add_f32 v[152:153], v[152:153], v[184:185]
    v_pk_add_f32 v[154:155], v[154:155], v[186:187]
    v_pk_add_f32 v[156:157], v[156:157], v[188:189]
    v_pk_add_f32 v[158:159], v[158:159], v[190:191]
    v_pk_add_f32 v[128:129], v[128:129], v[144:145]
    v_pk_add_f32 v[130:131], v[130:131], v[146:147]
    v_pk_add_f32 v[132:133], v[132:133], v[148:149]
    v_pk_add_f32 v[134:135], v[134:135], v[150:151]
    v_pk_add_f32 v[136:137], v[136:137], v[152:153]
    v_pk_add_f32 v[138:139], v[138:139], v[154:155]
    v_pk_add_f32 v[140:141], v[140:141], v[156:157]
    v_pk_add_f32 v[142:143], v[142:143], v[158:159]
    v_pk_add_f32 v[128:129], v[128:129], v[136:137]
    v_pk_add_f32 v[130:131], v[130:131], v[138:139]
    v_pk_add_f32 v[132:133], v[132:133], v[140:141]
    v_pk_add_f32 v[134:135], v[134:135], v[142:143]
    v_pk_add_f32 v[128:129], v[128:129], v[132:133]
    v_pk_add_f32 v[130:131], v[130:131], v[134:135]
    s_nop 1
    v_permlane32_swap_b32 v128, v130
    v_permlane32_swap_b32 v129, v131
    v_add_f32 v128, v128, v130
    v_add_f32 v129, v129, v131
    s_nop 1
    v_permlane16_swap_b32 v128, v129
    v_add_f32 v128, v128, v129
    v_cvt_pk_bf16_f32 v128, v128, v128
    v_lshlrev_b32 v128, 16, v128
    v_mul_f32 v128, v128, v195
    v_lshlrev_b32 v194, 16, v194
    v_sub_f32 v194, v194, v250
    v_cvt_pk_bf16_f32 v128, v128, v128
    v_lshlrev_b32 v128, 16, v128
    v_cvt_pk_bf16_f32 v194, v194, v194
    v_lshlrev_b32 v194, 16, v194
    v_mul_f32 v194, v194, v251
    v_cvt_pk_bf16_f32 v194, v194, v194
    v_lshlrev_b32 v194, 16, v194
    v_add_f32 v128, v128, v194
    v_cvt_pk_bf16_f32 v128, v128, v128
    v_lshlrev_b32 v128, 16, v128
    v_mul_f32 v2, 0xbfb8aa3b, v128
    v_exp_f32 v2, v2
    s_nop 0
    v_add_f32 v2, 1.0, v2
    v_rcp_f32 v2, v2
    s_nop 0
    v_mul_f32 v2, v128, v2
    v_lshlrev_b32 v3, 2, v193
    ds_write_b32 v3, v2
    s_branch L_fx2r
L_r0:
    s_add_u32 s29, s29, 1
    s_cmp_ge_u32 s29, 200000
    s_cbranch_scc1 L_g0
    s_add_u32 s3, s76, 0
    buffer_load_dwordx4 v[40:43], v116, s[48:51], s3 offen offset:0 sc1
    buffer_load_dwordx4 v[44:47], v117, s[48:51], s3 offen offset:0 sc1
    s_waitcnt vmcnt(0)
    v_max3_u32 v2, v40, v41, v42
    v_max3_u32 v2, v2, v43, v44
    v_max3_u32 v2, v2, v45, v46
    v_max_u32 v2, v2, v47
    v_cmp_eq_u32 vcc, -1, v2
    s_cbranch_vccnz L_r0
    s_branch L_g0
L_r1:
    s_add_u32 s29, s29, 1
    s_cmp_ge_u32 s29, 200000
    s_cbranch_scc1 L_g1
    s_add_u32 s3, s76, 0
    buffer_load_dwordx4 v[48:51], v116, s[48:51], s3 offen offset:1024 sc1
    buffer_load_dwordx4 v[52:55], v117, s[48:51], s3 offen offset:1024 sc1
    s_waitcnt vmcnt(0)
    v_max3_u32 v2, v48, v49, v50
    v_max3_u32 v2, v2, v51, v52
    v_max3_u32 v2, v2, v53, v54
    v_max_u32 v2, v2, v55
    v_cmp_eq_u32 vcc, -1, v2
    s_cbranch_vccnz L_r1
    s_branch L_g1
L_r2:
    s_add_u32 s29, s29, 1
    s_cmp_ge_u32 s29, 200000
    s_cbranch_scc1 L_g2
    s_add_u32 s3, s76, 0
    buffer_load_dwordx4 v[56:59], v116, s[48:51], s3 offen offset:2048 sc1
    buffer_load_dwordx4 v[60:63], v117, s[48:51], s3 offen offset:2048 sc1
    s_waitcnt vmcnt(0)
    v_max3_u32 v2, v56, v57, v58
    v_max3_u32 v2, v2, v59, v60
    v_max3_u32 v2, v2, v61, v62
    v_max_u32 v2, v2, v63
    v_cmp_eq_u32 vcc, -1, v2
    s_cbranch_vccnz L_r2
    s_branch L_g2
L_r3:
    s_add_u32 s29, s29, 1
    s_cmp_ge_u32 s29, 200000
    s_cbranch_scc1 L_g3
    s_add_u32 s3, s76, 0
    buffer_load_dwordx4 v[64:67], v116, s[48:51], s3 offen offset:3072 sc1
    buffer_load_dwordx4 v[68:71], v117, s[48:51], s3 offen offset:3072 sc1
    s_waitcnt vmcnt(0)
    v_max3_u32 v2, v64, v65, v66
    v_max3_u32 v2, v2, v67, v68
    v_max3_u32 v2, v2, v69, v70
    v_max_u32 v2, v2, v71
    v_cmp_eq_u32 vcc, -1, v2
    s_cbranch_vccnz L_r3
    s_branch L_g3
L_r4:
    s_add_u32 s29, s29, 1
    s_cmp_ge_u32 s29, 200000
    s_cbranch_scc1 L_g4
    s_add_u32 s3, s76, 4096
    buffer_load_dwordx4 v[72:75], v116, s[48:51], s3 offen offset:0 sc1
    buffer_load_dwordx4 v[76:79], v117, s[48:51], s3 offen offset:0 sc1
    s_waitcnt vmcnt(0)
    v_max3_u32 v2, v72, v73, v74
    v_max3_u32 v2, v2, v75, v76
    v_max3_u32 v2, v2, v77, v78
    v_max_u32 v2, v2, v79
    v_cmp_eq_u32 vcc, -1, v2
    s_cbranch_vccnz L_r4
    s_branch L_g4
L_r5:
    s_add_u32 s29, s29, 1
    s_cmp_ge_u32 s29, 200000
    s_cbranch_scc1 L_g5
    s_add_u32 s3, s76, 4096
    buffer_load_dwordx4 v[40:43], v116, s[48:51], s3 offen offset:1024 sc1
    buffer_load_dwordx4 v[44:47], v117, s[48:51], s3 offen offset:1024 sc1
    s_waitcnt vmcnt(0)
    v_max3_u32 v2, v40, v41, v42
    v_max3_u32 v2, v2, v43, v44
    v_max3_u32 v2, v2, v45, v46
    v_max_u32 v2, v2, v47
    v_cmp_eq_u32 vcc, -1, v2
    s_cbranch_vccnz L_r5
    s_branch L_g5
L_r6:
    s_add_u32 s29, s29, 1
    s_cmp_ge_u32 s29, 200000
    s_cbranch_scc1 L_g6
    s_add_u32 s3, s76, 4096
    buffer_load_dwordx4 v[48:51], v116, s[48:51], s3 offen offset:2048 sc1
    buffer_load_dwordx4 v[52:55], v117, s[48:51], s3 offen offset:2048 sc1
    s_waitcnt vmcnt(0)
    v_max3_u32 v2, v48, v49, v50
    v_max3_u32 v2, v2, v51, v52
    v_max3_u32 v2, v2, v53, v54
    v_max_u32 v2, v2, v55
    v_cmp_eq_u32 vcc, -1, v2
    s_cbranch_vccnz L_r6
    s_branch L_g6
L_r7:
    s_add_u32 s29, s29, 1
    s_cmp_ge_u32 s29, 200000
    s_cbranch_scc1 L_g7
    s_add_u32 s3, s76, 4096
    buffer_load_dwordx4 v[56:59], v116, s[48:51], s3 offen offset:3072 sc1
    buffer_load_dwordx4 v[60:63], v117, s[48:51], s3 offen offset:3072 sc1
    s_waitcnt vmcnt(0)
    v_max3_u32 v2, v56, v57, v58
    v_max3_u32 v2, v2, v59, v60
    v_max3_u32 v2, v2, v61, v62
    v_max_u32 v2, v2, v63
    v_cmp_eq_u32 vcc, -1, v2
    s_cbranch_vccnz L_r7
    s_branch L_g7
L_r8:
    s_add_u32 s29, s29, 1
    s_cmp_ge_u32 s29, 200000
    s_cbranch_scc1 L_g8
    s_add_u32 s3, s76, 8192
    buffer_load_dwordx4 v[64:67], v116, s[48:51], s3 offen offset:0 sc1
    buffer_load_dwordx4 v[68:71], v117, s[48:51], s3 offen offset:0 sc1
    s_waitcnt vmcnt(0)
    v_max3_u32 v2, v64, v65, v66
    v_max3_u32 v2, v2, v67, v68
    v_max3_u32 v2, v2, v69, v70
    v_max_u32 v2, v2, v71
    v_cmp_eq_u32 vcc, -1, v2
    s_cbranch_vccnz L_r8
    s_branch L_g8
L_r9:
    s_add_u32 s29, s29, 1
    s_cmp_ge_u32 s29, 200000
    s_cbranch_scc1 L_g9
    s_add_u32 s3, s76, 8192
    buffer_load_dwordx4 v[72:75], v116, s[48:51], s3 offen offset:1024 sc1
    buffer_load_dwordx4 v[76:79], v117, s[48:51], s3 offen offset:1024 sc1
    s_waitcnt vmcnt(0)
    v_max3_u32 v2, v72, v73, v74
    v_max3_u32 v2, v2, v75, v76
    v_max3_u32 v2, v2, v77, v78
    v_max_u32 v2, v2, v79
    v_cmp_eq_u32 vcc, -1, v2
    s_cbranch_vccnz L_r9
    s_branch L_g9
L_r10:
    s_add_u32 s29, s29, 1
    s_cmp_ge_u32 s29, 200000
    s_cbranch_scc1 L_g10
    s_add_u32 s3, s76, 8192
    buffer_load_dwordx4 v[40:43], v116, s[48:51], s3 offen offset:2048 sc1
    buffer_load_dwordx4 v[44:47], v117, s[48:51], s3 offen offset:2048 sc1
    s_waitcnt vmcnt(0)
    v_max3_u32 v2, v40, v41, v42
    v_max3_u32 v2, v2, v43, v44
    v_max3_u32 v2, v2, v45, v46
    v_max_u32 v2, v2, v47
    v_cmp_eq_u32 vcc, -1, v2
    s_cbranch_vccnz L_r10
    s_branch L_g10
L_r11:
    s_add_u32 s29, s29, 1
    s_cmp_ge_u32 s29, 200000
    s_cbranch_scc1 L_g11
    s_add_u32 s3, s76, 8192
    buffer_load_dwordx4 v[48:51], v116, s[48:51], s3 offen offset:3072 sc1
    buffer_load_dwordx4 v[52:55], v117, s[48:51], s3 offen offset:3072 sc1
    s_waitcnt vmcnt(0)
    v_max3_u32 v2, v48, v49, v50
    v_max3_u32 v2, v2, v51, v52
    v_max3_u32 v2, v2, v53, v54
    v_max_u32 v2, v2, v55
    v_cmp_eq_u32 vcc, -1, v2
    s_cbranch_vccnz L_r11
    s_branch L_g11
L_r12:
    s_add_u32 s29, s29, 1
    s_cmp_ge_u32 s29, 200000
    s_cbranch_scc1 L_g12
    s_add_u32 s3, s76, 12288
    buffer_load_dwordx4 v[56:59], v116, s[48:51], s3 offen offset:0 sc1
    buffer_load_dwordx4 v[60:63], v117, s[48:51], s3 offen offset:0 sc1
    s_waitcnt vmcnt(0)
    v_max3_u32 v2, v56, v57, v58
    v_max3_u32 v2, v2, v59, v60
    v_max3_u32 v2, v2, v61, v62
    v_max_u32 v2, v2, v63
    v_cmp_eq_u32 vcc, -1, v2
    s_cbranch_vccnz L_r12
    s_branch L_g12
L_r13:
    s_add_u32 s29, s29, 1
    s_cmp_ge_u32 s29, 200000
    s_cbranch_scc1 L_g13
    s_add_u32 s3, s76, 12288
    buffer_load_dwordx4 v[64:67], v116, s[48:51], s3 offen offset:1024 sc1
    buffer_load_dwordx4 v[68:71], v117, s[48:51], s3 offen offset:1024 sc1
    s_waitcnt vmcnt(0)
    v_max3_u32 v2, v64, v65, v66
    v_max3_u32 v2, v2, v67, v68
    v_max3_u32 v2, v2, v69, v70
    v_max_u32 v2, v2, v71
    v_cmp_eq_u32 vcc, -1, v2
    s_cbranch_vccnz L_r13
    s_branch L_g13
L_r14:
    s_add_u32 s29, s29, 1
    s_cmp_ge_u32 s29, 200000
    s_cbranch_scc1 L_g14
    s_add_u32 s3, s76, 12288
    buffer_load_dwordx4 v[72:75], v116, s[48:51], s3 offen offset:2048 sc1
    buffer_load_dwordx4 v[76:79], v117, s[48:51], s3 offen offset:2048 sc1
    s_waitcnt vmcnt(0)
    v_max3_u32 v2, v72, v73, v74
    v_max3_u32 v2, v2, v75, v76
    v_max3_u32 v2, v2, v77, v78
    v_max_u32 v2, v2, v79
    v_cmp_eq_u32 vcc, -1, v2
    s_cbranch_vccnz L_r14
    s_branch L_g14
L_r15:
    s_add_u32 s29, s29, 1
    s_cmp_ge_u32 s29, 200000
    s_cbranch_scc1 L_g15
    s_add_u32 s3, s76, 12288
    buffer_load_dwordx4 v[40:43], v116, s[48:51], s3 offen offset:3072 sc1
    buffer_load_dwordx4 v[44:47], v117, s[48:51], s3 offen offset:3072 sc1
    s_waitcnt vmcnt(0)
    v_max3_u32 v2, v40, v41, v42
    v_max3_u32 v2, v2, v43, v44
    v_max3_u32 v2, v2, v45, v46
    v_max_u32 v2, v2, v47
    v_cmp_eq_u32 vcc, -1, v2
    s_cbranch_vccnz L_r15
    s_branch L_g15
.p2align 8
.fill 4096, 4, 0xbf800000
.section .rodata,"a"
.p2align 6
.amdhsa_kernel recurrent_scan__linear_kernel_hedgehog__moe_arch_mod__prompt_kernel
  .amdhsa_next_free_vgpr 256
  .amdhsa_next_free_sgpr 102
  .amdhsa_accum_offset 256
  .amdhsa_group_segment_fixed_size 0
  .amdhsa_kernarg_size 96
  .amdhsa_user_sgpr_count 2
  .amdhsa_user_sgpr_kernarg_segment_ptr 1
  .amdhsa_system_sgpr_workgroup_id_x 1
.end_amdhsa_kernel
```

```asm
; @launch grid=(256,1,1) block=(512,1,1) lds=163840
.amdgcn_target "amdgcn-amd-amdhsa--gfx950"
.text
.globl recurrent_scan__linear_kernel_hedgehog__moe_arch_mod__prompt_kernel
.p2align 8
.type recurrent_scan__linear_kernel_hedgehog__moe_arch_mod__prompt_kernel,@function
recurrent_scan__linear_kernel_hedgehog__moe_arch_mod__prompt_kernel:
    s_cmp_ge_u32 s2, 256
    s_cbranch_scc1 L_done
    s_load_dwordx16 s[4:19], s[0:1], 0
    s_load_dwordx8 s[20:27], s[0:1], 64
    v_and_b32 v1, 63, v0
    v_lshrrev_b32 v2, 6, v0
    s_nop 0
    v_readfirstlane_b32 s39, v2
    s_and_b32 s34, s2, 1
    s_lshl_b32 s34, s34, 3
    s_bfe_u32 s3, s2, 0x30003
    s_add_u32 s36, s34, s3
    s_bfe_u32 s37, s2, 0x20001
    s_lshl_b32 s37, s37, 2
    s_lshr_b32 s28, s2, 6
    s_add_u32 s37, s37, s28
    s_and_b32 s80, s37, 12
    s_xor_b32 s80, s80, s34
    s_add_u32 s85, s36, s37
    s_and_b32 s85, s85, 3
    s_or_b32 s35, s80, s85
    s_mov_b32 s34, s36
    s_and_b32 s38, s39, 3
    s_cmp_lt_u32 s39, 4
    s_cbranch_scc1 L_C
L_H:
    v_and_b32 v4, 7, v1
    s_lshl_b32 s33, s37, 7
    s_lshl_b32 s87, s85, 7
    s_lshl_b32 s66, s80, 7
    s_lshl_b32 s30, s38, 12
    s_waitcnt lgkmcnt(0)
    s_mov_b32 s40, s4
    s_mov_b32 s41, s5
    s_mov_b32 s42, 4194304
    s_mov_b32 s43, 0x00020000
    v_lshlrev_b32_e64 v252, 4, v1
    s_mov_b32 s48, s26
    s_mov_b32 s49, s27
    s_mov_b32 s50, 268435456
    s_mov_b32 s51, 0x00020000
    v_mov_b32 v19, 16384
    buffer_load_dword v19, v19, s[48:51], 0 offen sc1
    s_lshl_b32 s3, s36, 7
    s_lshl_b32 s28, s37, 3
    s_add_u32 s3, s3, s28
    s_lshl_b32 s3, s3, 11
    s_add_u32 s3, s3, s30
    s_add_u32 m0, s30, 131072
    s_nop 0
    buffer_load_dwordx4 v252, s[40:43], s3 offen offset:0 lds
    buffer_load_dwordx4 v252, s[40:43], s3 offen offset:2048 lds
    s_lshl_b32 s3, s36, 7
    s_lshl_b32 s28, s37, 3
    s_add_u32 s3, s3, s28
    s_lshl_b32 s3, s3, 11
    s_add_u32 s3, s3, s30
    s_add_u32 m0, s30, 131072
    s_nop 0
    buffer_load_dwordx4 v252, s[40:43], s3 offen offset:1024 lds
    buffer_load_dwordx4 v252, s[40:43], s3 offen offset:3072 lds
    s_mov_b32 s60, s14
    s_mov_b32 s61, s15
    s_mov_b32 s62, 2048
    s_mov_b32 s63, 0x00020000
    s_lshl_b32 s3, s38, 9
    s_add_u32 m0, s3, 122880
    s_mov_b32 exec_hi, 0
    buffer_load_dwordx4 v252, s[60:63], s3 offen lds
    s_mov_b64 exec, -1
    s_lshr_b32 s32, s36, 1
    s_and_b32 s32, s32, 2
    s_xor_b32 s32, s32, s38
    v_lshrrev_b32 v3, 3, v1
    s_lshl_b32 s3, s32, 4
    v_add_u32_e64 v7, s3, v3
    v_mul_u32_u24 v7, 6144, v7
    v_bfe_u32 v6, v1, 4, 1
    v_lshlrev_b32 v6, 1, v6
    v_xor_b32 v5, v4, v6
    v_add_u32 v7, s33, v7
    v_xor_b32 v6, 4, v5
    v_lshl_add_u32 v6, v6, 4, v7
    v_lshl_add_u32 v7, v5, 4, v7
    v_add_u32_e64 v12, 0, v7
    v_add_u32 v13, 48128, v6
    v_add_u32 v14, 2048, v7
    v_add_u32 v15, 50176, v6
    v_add_u32 v16, 4096, v7
    v_add_u32 v17, 52224, v6
    v_xor_b32 v12, 512, v12
    v_xor_b32 v13, 512, v13
    s_lshl_b32 s31, s32, 11
    s_add_u32 s31, s31, 16384
    s_mov_b32 s44, s6
    s_mov_b32 s45, s7
    s_mov_b32 s46, 6291456
    s_mov_b32 s47, 0x00020000
    s_add_u32 s64, s87, 0
    s_and_b32 s64, s64, 511
    s_or_b32 s64, s64, 0
    s_xor_b32 s64, s64, s66
    s_mul_i32 s65, s64, 3072
    s_add_u32 m0, s31, 0
    s_nop 0
    buffer_load_dwordx4 v12, s[44:47], s65 offen offset:0 lds
    buffer_load_dwordx4 v13, s[44:47], s65 offen offset:1024 lds
    s_add_u32 m0, s31, 8192
    s_nop 0
    buffer_load_dwordx4 v14, s[44:47], s65 offen offset:0 lds
    buffer_load_dwordx4 v15, s[44:47], s65 offen offset:1024 lds
    s_add_u32 m0, s31, 16384
    s_nop 0
    buffer_load_dwordx4 v16, s[44:47], s65 offen offset:0 lds
    buffer_load_dwordx4 v17, s[44:47], s65 offen offset:1024 lds
    s_lshl_b32 s3, s36, 7
    s_lshl_b32 s28, s38, 5
    s_add_u32 s3, s3, s28
    v_add_u32 v3, s3, v3
    v_lshlrev_b32 v3, 11, v3
    v_lshrrev_b32 v5, 4, v1
    v_xor_b32 v6, v4, v5
    v_xor_b32 v5, 4, v6
    v_lshl_add_u32 v6, v6, 4, v3
    v_lshl_add_u32 v5, v5, 4, v3
    v_add_u32_e64 v8, 0, v6
    v_add_u32 v9, 15360, v5
    v_add_u32 v10, 30720, v6
    v_add_u32 v11, 46080, v5
    v_mov_b32 v248, -1
    v_mov_b32 v249, -1
    v_mov_b32 v250, -1
    v_mov_b32 v251, -1
    v_lshlrev_b32 v252, 4, v1
    s_and_b32 s85, s85, 0
    s_lshl_b32 s3, s37, 4
    s_add_u32 s3, s3, s36
    s_lshl_b32 s67, s3, 10
    s_add_u32 s67, s67, 524288
    s_lshl_b32 s3, s38, 8
    s_add_u32 s67, s67, s3
    v_mov_b32 v24, 0
    v_mov_b32 v25, 0
    v_mov_b32 v26, 0
    v_mov_b32 v27, 0
    v_mov_b32 v28, 0
    v_mov_b32 v29, 0
    v_mov_b32 v30, 0
    v_mov_b32 v31, 0
    v_lshlrev_b32 v253, 2, v1
    s_cmp_gt_u32 s37, 3
    s_subb_u32 s77, s37, 0
    s_cmp_gt_u32 s37, 11
    s_subb_u32 s77, s77, 0
    s_lshl_b32 s77, s77, 4
    s_add_u32 s77, s77, s36
    s_and_b32 s3, s37, 7
    s_cmp_eq_u32 s3, 3
    s_cselect_b32 s77, 224, s77
    s_bitcmp1_b32 s38, 0
    s_cselect_b32 s52, s18, s16
    s_cselect_b32 s53, s19, s17
    s_cmp_lt_u32 s77, 224
    s_cselect_b32 s54, 7340032, 0
    s_mov_b32 s55, 0x00020000
    s_mov_b32 s56, s20
    s_mov_b32 s57, s21
    s_mov_b32 s58, 7340032
    s_mov_b32 s59, 0x00020000
    s_and_b32 s3, s77, 3
    s_lshl_b32 s3, s3, 8
    s_lshr_b32 s28, s38, 1
    s_lshl_b32 s28, s28, 7
    s_add_u32 s3, s3, s28
    v_lshrrev_b32_e64 v5, 3, v1
    v_lshl_add_u32 v6, v5, 4, s3
    v_mul_u32_u24 v6, 7168, v6
    v_lshl_add_u32 v6, v4, 4, v6
    s_lshr_b32 s3, s77, 2
    s_lshl_b32 s3, s3, 7
    v_add_u32 v21, s3, v6
    s_lshr_b32 s3, s2, 4
    s_mul_i32 s3, s3, 224
    s_mul_i32 s28, s38, 56
    s_add_u32 s71, s3, s28
    v_lshlrev_b32 v6, 14, v5
    v_lshl_add_u32 v6, v4, 4, v6
    s_and_b32 s3, s2, 15
    s_lshl_b32 s3, s3, 7
    v_add_u32 v22, s3, v6
    s_mov_b32 s94, 1985229328
    s_mov_b32 s95, 4275878552
    s_cmp_eq_u32 s87, 128
    s_cselect_b32 s94, 1989161553, s94
    s_cselect_b32 s95, 3488135892, s95
    s_cmp_eq_u32 s87, 256
    s_cselect_b32 s94, 2052130354, s94
    s_cselect_b32 s95, 3487088276, s95
    s_cmp_eq_u32 s87, 384
    s_cselect_b32 s94, 3058856195, s94
    s_cselect_b32 s95, 3470326420, s95
    v_lshrrev_b32 v2, 2, v1
    v_and_b32 v3, 3, v1
    v_lshlrev_b32 v3, 4, v3
    v_lshl_add_u32 v232, v2, 10, v3
    v_lshlrev_b32 v2, 3, v1
    v_add_u32 v230, 152064, v2
    v_and_b32_e64 v4, 49, v1
    v_bfe_u32 v7, v1, 1, 2
    v_lshl_add_u32 v4, v7, 2, v4
    v_bfe_u32 v7, v1, 3, 1
    v_lshl_add_u32 v4, v7, 1, v4
    v_lshlrev_b32 v4, 2, v4
    v_add_u32 v231, 154624, v4
    s_lshl_b32 s3, s38, 1
    s_lshr_b32 s28, s39, 2
    s_add_u32 s3, s3, s28
    s_lshl_b32 s69, s3, 4
    v_and_b32 v2, 15, v1
    v_add_u32 v23, s69, v2
    v_lshlrev_b32 v23, 7, v23
    v_lshrrev_b32 v2, 1, v2
    v_lshrrev_b32 v3, 5, v1
    v_xor_b32_e64 v2, v2, v3
    v_lshl_add_u32 v23, v2, 4, v23
    v_bfe_u32 v3, v1, 4, 1
    v_lshl_add_u32 v23, v3, 3, v23
    v_bfe_u32 v5, v1, 4, 1
    v_lshlrev_b32 v5, 5, v5
    v_xor_b32 v5, v5, v252
    s_min_u32 s3, s38, 2
    s_lshl_b32 s3, s3, 13
    s_and_b32 s28, s36, 4
    s_lshl_b32 s28, s28, 10
    s_add_u32 s3, s3, s28
    s_add_u32 s3, s3, 16384
    v_add_u32 v18, s3, v5
    s_lshr_b32 s3, s38, 1
    s_lshl_b32 s28, s37, 1
    s_add_u32 s28, s28, s3
    s_and_b32 s29, s38, 1
    s_lshl_b32 s3, s28, 4
    s_add_u32 s3, s3, s36
    s_mul_i32 s3, s3, 4224
    s_mul_i32 s78, s29, 2112
    s_add_u32 s78, s78, s3
    s_add_u32 s78, s78, 8388608
    s_lshl_b32 s3, s36, 1
    s_add_u32 s29, s29, s3
    s_xor_b32 s28, s28, 8
    s_lshl_b32 s3, s29, 7
    s_add_u32 s3, s3, s28
    s_lshl_b32 s3, s3, 10
    s_add_u32 s79, s3, 4194304
    s_mov_b32 s88, s10
    s_mov_b32 s89, s11
    s_mov_b32 s90, 2097152
    s_mov_b32 s91, 0x00020000
    s_add_u32 s64, s87, 0
    s_and_b32 s64, s64, 511
    s_or_b32 s64, s64, 0
    s_xor_b32 s64, s64, s66
    s_mul_i32 s65, s64, 3072
    s_add_u32 m0, s30, 0
    s_nop 0
    buffer_load_dwordx4 v8, s[40:43], s64 offen offset:0 lds
    buffer_load_dwordx4 v9, s[40:43], s64 offen offset:1024 lds
    buffer_load_dwordx4 v10, s[40:43], s64 offen offset:2048 lds
    buffer_load_dwordx4 v11, s[40:43], s64 offen offset:3072 lds
    s_waitcnt vmcnt(10)
    s_barrier
    s_bfe_u32 s64, s94, 262148
    s_lshl_b32 s64, s64, 7
    s_xor_b32 s64, s64, s66
    s_mul_i32 s65, s64, 3072
    s_add_u32 m0, s30, 40960
    s_nop 0
    buffer_load_dwordx4 v8, s[40:43], s64 offen offset:0 lds
    buffer_load_dwordx4 v9, s[40:43], s64 offen offset:1024 lds
    buffer_load_dwordx4 v10, s[40:43], s64 offen offset:2048 lds
    buffer_load_dwordx4 v11, s[40:43], s64 offen offset:3072 lds
    s_add_u32 m0, s31, 40960
    s_nop 0
    buffer_load_dwordx4 v12, s[44:47], s65 offen offset:0 lds
    buffer_load_dwordx4 v13, s[44:47], s65 offen offset:1024 lds
    s_add_u32 m0, s31, 49152
    s_nop 0
    buffer_load_dwordx4 v14, s[44:47], s65 offen offset:0 lds
    buffer_load_dwordx4 v15, s[44:47], s65 offen offset:1024 lds
    s_add_u32 m0, s31, 57344
    s_nop 0
    buffer_load_dwordx4 v16, s[44:47], s65 offen offset:0 lds
    buffer_load_dwordx4 v17, s[44:47], s65 offen offset:1024 lds
    v_readfirstlane_b32 s86, v19
    s_nop 0
    s_mul_i32 s86, s86, 1664525
    s_add_u32 s86, s86, 1013904223
    s_waitcnt vmcnt(10)
    s_waitcnt lgkmcnt(0)
    s_barrier
    s_bfe_u32 s64, s94, 262152
    s_lshl_b32 s64, s64, 7
    s_xor_b32 s64, s64, s66
    s_mul_i32 s65, s64, 3072
    s_add_u32 m0, s30, 81920
    s_nop 0
    buffer_load_dwordx4 v8, s[40:43], s64 offen offset:0 lds
    buffer_load_dwordx4 v9, s[40:43], s64 offen offset:1024 lds
    buffer_load_dwordx4 v10, s[40:43], s64 offen offset:2048 lds
    buffer_load_dwordx4 v11, s[40:43], s64 offen offset:3072 lds
    s_add_u32 m0, s31, 81920
    s_nop 0
    buffer_load_dwordx4 v12, s[44:47], s65 offen offset:0 lds
    buffer_load_dwordx4 v13, s[44:47], s65 offen offset:1024 lds
    s_add_u32 m0, s31, 90112
    s_nop 0
    buffer_load_dwordx4 v14, s[44:47], s65 offen offset:0 lds
    buffer_load_dwordx4 v15, s[44:47], s65 offen offset:1024 lds
    s_add_u32 m0, s31, 98304
    s_nop 0
    buffer_load_dwordx4 v16, s[44:47], s65 offen offset:0 lds
    buffer_load_dwordx4 v17, s[44:47], s65 offen offset:1024 lds
    v_xor_b32 v4, 0, v23
    ds_read_b64 v[240:241], v4
    v_xor_b32 v5, 32, v23
    ds_read_b64 v[242:243], v5
    v_xor_b32 v6, 64, v23
    ds_read_b64 v[244:245], v6
    v_xor_b32 v7, 96, v23
    ds_read_b64 v[246:247], v7
    v_add_u32 v2, 0, v18
    v_xor_b32 v3, 64, v2
    ds_read_b128 v[32:35], v2 offset:0
    ds_read_b128 v[36:39], v3 offset:1024
    ds_read_b128 v[40:43], v2 offset:2048
    ds_read_b128 v[44:47], v3 offset:3072
    buffer_store_dwordx4 v[248:251], v252, s[48:51], s78 offen offset:0 sc1
    s_waitcnt vmcnt(11)
    s_waitcnt lgkmcnt(0)
    s_barrier
    s_cmp_eq_u32 s87, 0
    s_cbranch_scc1 L_nc1
    s_cmp_eq_u32 s87, 256
    s_cbranch_scc1 L_nc1
    s_cmp_eq_u32 s87, 384
    s_cbranch_scc1 L_nc1
    v_add_u32 v2, 40960, v18
    v_xor_b32 v3, 64, v2
    ds_read_b128 v[48:51], v2 offset:0
    ds_read_b128 v[52:55], v3 offset:1024
    ds_read_b128 v[56:59], v2 offset:2048
    ds_read_b128 v[60:63], v3 offset:3072
L_nc1:
    s_bfe_u32 s64, s94, 262156
    s_lshl_b32 s64, s64, 7
    s_xor_b32 s64, s64, s66
    s_mul_i32 s65, s64, 3072
    s_add_u32 m0, s30, 0
    s_nop 0
    buffer_load_dwordx4 v8, s[40:43], s64 offen offset:0 lds
    buffer_load_dwordx4 v9, s[40:43], s64 offen offset:1024 lds
    v_lshlrev_b32 v2, 16, v32
    v_and_b32 v3, 0xffff0000, v32
    v_add_f32 v24, v24, v2
    v_add_f32 v25, v25, v3
    buffer_load_dwordx4 v10, s[40:43], s64 offen offset:2048 lds
    v_lshlrev_b32 v4, 16, v33
    v_and_b32 v5, 0xffff0000, v33
    v_add_f32 v26, v26, v4
    v_add_f32 v27, v27, v5
    buffer_load_dwordx4 v11, s[40:43], s64 offen offset:3072 lds
    v_lshlrev_b32 v2, 16, v34
    v_and_b32 v3, 0xffff0000, v34
    v_add_f32 v28, v28, v2
    v_add_f32 v29, v29, v3
    s_add_u32 m0, s31, 0
    s_nop 0
    buffer_load_dwordx4 v12, s[44:47], s65 offen offset:0 lds
    v_lshlrev_b32 v4, 16, v35
    v_and_b32 v5, 0xffff0000, v35
    v_add_f32 v30, v30, v4
    v_add_f32 v31, v31, v5
    buffer_load_dwordx4 v13, s[44:47], s65 offen offset:1024 lds
    v_lshlrev_b32 v2, 16, v36
    v_and_b32 v3, 0xffff0000, v36
    v_add_f32 v24, v24, v2
    v_add_f32 v25, v25, v3
    s_add_u32 m0, s31, 8192
    s_nop 0
    buffer_load_dwordx4 v14, s[44:47], s65 offen offset:0 lds
    v_lshlrev_b32 v4, 16, v37
    v_and_b32 v5, 0xffff0000, v37
    v_add_f32 v26, v26, v4
    v_add_f32 v27, v27, v5
    buffer_load_dwordx4 v15, s[44:47], s65 offen offset:1024 lds
    v_lshlrev_b32 v2, 16, v38
    v_and_b32 v3, 0xffff0000, v38
    v_add_f32 v28, v28, v2
    v_add_f32 v29, v29, v3
    s_add_u32 m0, s31, 16384
    s_nop 0
    buffer_load_dwordx4 v16, s[44:47], s65 offen offset:0 lds
    v_lshlrev_b32 v4, 16, v39
    v_and_b32 v5, 0xffff0000, v39
    v_add_f32 v30, v30, v4
    v_add_f32 v31, v31, v5
    buffer_load_dwordx4 v17, s[44:47], s65 offen offset:1024 lds
    buffer_store_dwordx4 v[248:251], v252, s[48:51], s78 offen offset:1024 sc1
    s_mov_b64 exec, 15
    buffer_store_dwordx4 v[248:251], v252, s[48:51], s78 offen offset:2048 sc1
    s_mov_b64 exec, -1
    s_waitcnt vmcnt(13)
    s_waitcnt lgkmcnt(0)
    s_barrier
    s_cmp_eq_u32 s87, 0
    s_cbranch_scc1 L_nc2
    s_cmp_eq_u32 s87, 128
    s_cbranch_scc1 L_nc2
    s_cmp_eq_u32 s87, 384
    s_cbranch_scc1 L_nc2
    v_add_u32 v2, 81920, v18
    v_xor_b32 v3, 64, v2
    ds_read_b128 v[48:51], v2 offset:0
    ds_read_b128 v[52:55], v3 offset:1024
    ds_read_b128 v[56:59], v2 offset:2048
    ds_read_b128 v[60:63], v3 offset:3072
L_nc2:
    s_bfe_u32 s64, s94, 262160
    s_lshl_b32 s64, s64, 7
    s_xor_b32 s64, s64, s66
    s_mul_i32 s65, s64, 3072
    s_add_u32 m0, s30, 40960
    s_nop 0
    buffer_load_dwordx4 v8, s[40:43], s64 offen offset:0 lds
    buffer_load_dwordx4 v9, s[40:43], s64 offen offset:1024 lds
    v_lshlrev_b32 v2, 16, v40
    v_and_b32 v3, 0xffff0000, v40
    v_add_f32 v24, v24, v2
    v_add_f32 v25, v25, v3
    buffer_load_dwordx4 v10, s[40:43], s64 offen offset:2048 lds
    v_lshlrev_b32 v4, 16, v41
    v_and_b32 v5, 0xffff0000, v41
    v_add_f32 v26, v26, v4
    v_add_f32 v27, v27, v5
    buffer_load_dwordx4 v11, s[40:43], s64 offen offset:3072 lds
    v_lshlrev_b32 v2, 16, v42
    v_and_b32 v3, 0xffff0000, v42
    v_add_f32 v28, v28, v2
    v_add_f32 v29, v29, v3
    s_add_u32 m0, s31, 40960
    s_nop 0
    buffer_load_dwordx4 v12, s[44:47], s65 offen offset:0 lds
    v_lshlrev_b32 v4, 16, v43
    v_and_b32 v5, 0xffff0000, v43
    v_add_f32 v30, v30, v4
    v_add_f32 v31, v31, v5
    buffer_load_dwordx4 v13, s[44:47], s65 offen offset:1024 lds
    v_lshlrev_b32 v2, 16, v44
    v_and_b32 v3, 0xffff0000, v44
    v_add_f32 v24, v24, v2
    v_add_f32 v25, v25, v3
    s_add_u32 m0, s31, 49152
    s_nop 0
    buffer_load_dwordx4 v14, s[44:47], s65 offen offset:0 lds
    v_lshlrev_b32 v4, 16, v45
    v_and_b32 v5, 0xffff0000, v45
    v_add_f32 v26, v26, v4
    v_add_f32 v27, v27, v5
    buffer_load_dwordx4 v15, s[44:47], s65 offen offset:1024 lds
    v_lshlrev_b32 v2, 16, v46
    v_and_b32 v3, 0xffff0000, v46
    v_add_f32 v28, v28, v2
    v_add_f32 v29, v29, v3
    s_add_u32 m0, s31, 57344
    s_nop 0
    buffer_load_dwordx4 v16, s[44:47], s65 offen offset:0 lds
    v_lshlrev_b32 v4, 16, v47
    v_and_b32 v5, 0xffff0000, v47
    v_add_f32 v30, v30, v4
    v_add_f32 v31, v31, v5
    buffer_load_dwordx4 v17, s[44:47], s65 offen offset:1024 lds
    s_waitcnt vmcnt(12)
    s_waitcnt lgkmcnt(0)
    s_barrier
    s_cmp_eq_u32 s87, 0
    s_cbranch_scc1 L_nc3
    s_cmp_eq_u32 s87, 128
    s_cbranch_scc1 L_nc3
    s_cmp_eq_u32 s87, 256
    s_cbranch_scc1 L_nc3
    v_add_u32 v2, 0, v18
    v_xor_b32_e64 v3, 64, v2
    ds_read_b128 v[48:51], v2 offset:0
    ds_read_b128 v[52:55], v3 offset:1024
    ds_read_b128 v[56:59], v2 offset:2048
    ds_read_b128 v[60:63], v3 offset:3072
L_nc3:
    s_bfe_u32 s64, s94, 262164
    s_lshl_b32 s64, s64, 7
    s_xor_b32 s64, s64, s66
    s_mul_i32 s65, s64, 3072
    s_add_u32 m0, s30, 81920
    s_nop 0
    buffer_load_dwordx4 v8, s[40:43], s64 offen offset:0 lds
    buffer_load_dwordx4 v9, s[40:43], s64 offen offset:1024 lds
    buffer_load_dwordx4 v10, s[40:43], s64 offen offset:2048 lds
    buffer_load_dwordx4 v11, s[40:43], s64 offen offset:3072 lds
    s_add_u32 m0, s31, 81920
    s_nop 0
    buffer_load_dwordx4 v12, s[44:47], s65 offen offset:0 lds
    buffer_load_dwordx4 v13, s[44:47], s65 offen offset:1024 lds
    s_add_u32 m0, s31, 90112
    s_nop 0
    buffer_load_dwordx4 v14, s[44:47], s65 offen offset:0 lds
    buffer_load_dwordx4 v15, s[44:47], s65 offen offset:1024 lds
    s_add_u32 m0, s31, 98304
    s_nop 0
    buffer_load_dwordx4 v16, s[44:47], s65 offen offset:0 lds
    buffer_load_dwordx4 v17, s[44:47], s65 offen offset:1024 lds
    s_lshl_b32 s3, s36, 10
    buffer_load_dwordx4 v[72:75], v252, s[48:51], s3 offen sc1
    s_lshl_b32 s3, s37, 6
    buffer_load_dword v76, v232, s[48:51], s3 offen offset:12 sc1
    s_mov_b32 s60, s8
    s_mov_b32 s61, s9
    s_mov_b32 s62, 65536
    s_mov_b32 s63, 0x00020000
    s_lshl_b32 s3, s38, 10
    s_add_u32 m0, s3, 147712
    s_lshl_b32 s28, s37, 12
    s_add_u32 s3, s3, s28
    buffer_load_dwordx4 v252, s[60:63], s3 offen lds
    s_add_u32 m0, m0, 8192
    s_xor_b32 s3, s3, 16384
    buffer_load_dwordx4 v252, s[60:63], s3 offen lds
    s_lshl_b32 s3, s2, 13
    s_lshl_b32 s28, s38, 11
    s_add_u32 s3, s3, s28
    v_lshlrev_b32_e64 v3, 7, v1
    s_mov_b64 exec, 0xffff
    buffer_load_dword v20, v3, s[88:91], s3 offen
    s_mov_b64 exec, -1
    s_mov_b32 s3, 0
    buffer_load_dwordx4 v[128:131], v21, s[52:55], s3 offen nt
    s_mov_b32 s3, 7168
    buffer_load_dwordx4 v[132:135], v21, s[52:55], s3 offen nt
    s_mov_b32 s3, 14336
    buffer_load_dwordx4 v[136:139], v21, s[52:55], s3 offen nt
    s_mov_b32 s3, 21504
    buffer_load_dwordx4 v[140:143], v21, s[52:55], s3 offen nt
    s_waitcnt vmcnt(19)
    s_waitcnt lgkmcnt(0)
    s_barrier
    s_mul_i32 s3, s38, 48
    v_and_b32 v2, 15, v1
    v_lshrrev_b32 v3, 4, v1
    v_cmp_gt_u32 vcc, 12, v2
    v_lshl_add_u32 v4, v2, 2, s3
    v_add_u32 v2, v4, v3
    v_mov_b32 v5, 192
    v_cndmask_b32 v4, v5, v4, vcc
    v_lshlrev_b32 v4, 2, v4
    v_lshl_add_u32 v235, v3, 10, v4
    v_and_b32_e64 v5, 7, v2
    v_bfe_u32 v6, v2, 3, 3
    v_lshl_add_u32 v5, v5, 3, v6
    v_and_b32 v2, 0xc0, v2
    v_add_u32 v2, v2, v5
    v_lshlrev_b32 v2, 2, v2
    v_add_u32 v2, 154880, v2
    v_mov_b32 v5, 162048
    v_cndmask_b32 v233, v5, v2, vcc
    v_lshrrev_b32 v5, 3, v1
    v_lshlrev_b32 v6, 11, v5
    v_bfe_u32 v5, v1, 4, 2
    v_lshlrev_b32 v5, 1, v5
    v_and_b32 v7, 7, v1
    v_xor_b32 v5, v5, v7
    v_lshl_add_u32 v6, v5, 4, v6
    s_lshl_b32 s3, s35, 7
    v_add_u32 v6, s3, v6
    v_add_u32_e64 v220, 0, v6
    v_add_u32 v221, 15360, v6
    v_add_u32 v222, 30720, v6
    v_add_u32 v223, 46080, v6
    s_lshl_b32 s72, s38, 12
    s_lshl_b32 s73, s38, 16
    s_lshl_b32 s3, s36, 2
    s_add_u32 s3, s3, s38
    s_lshr_b32 s28, s3, 5
    s_and_b32 s3, s3, 31
    s_lshl_b32 s74, s3, 7
    s_lshl_b32 s3, s37, 1
    s_add_u32 s75, s3, s28
    v_lshrrev_b32 v5, 3, v1
    v_mul_u32_u24 v5, 4224, v5
    v_and_b32_e64 v7, 7, v1
    v_lshl_add_u32 v112, v7, 4, v5
    s_mul_i32 s76, s75, 67584
    s_add_u32 s76, s76, s74
    s_add_u32 s76, s76, 8388608
    s_mul_i32 s3, s75, 4224
    s_add_u32 s3, s3, s74
    s_add_u32 s74, s3, 1048576
    s_lshl_b32 s75, s37, 1
    s_add_u32 s75, s75, s36
    s_mul_i32 s81, s75, 67584
    s_add_u32 s81, s81, 8392704
    s_mul_i32 s82, s75, 4224
    s_add_u32 s82, s82, 1052672
    s_lshr_b32 s3, s36, 1
    s_or_b32 s83, s3, s38
    s_and_b32 s3, s38, 1
    s_lshl_b32 s3, s3, 3
    s_and_b32 s28, s77, 3
    s_lshl_b32 s28, s28, 1
    s_add_u32 s3, s3, s28
    s_lshr_b32 s28, s38, 1
    s_add_u32 s3, s3, s28
    s_mul_i32 s3, s3, 14336
    s_lshr_b32 s28, s77, 2
    s_lshl_b32 s28, s28, 8
    s_add_u32 s3, s3, s28
    s_add_u32 s3, s3, 1183744
    s_cmp_lt_u32 s77, 224
    s_cselect_b32 s84, s3, 268435456
    v_and_b32 v2, 15, v1
    v_bfe_u32 v3, v1, 4, 1
    v_mul_u32_u24 v3, 4, v3
    v_xor_b32_e64 v3, s37, v3
    v_lshl_add_u32 v3, v3, 4, v2
    v_lshl_add_u32 v2, v2, 4, s34
    v_lshrrev_b32 v4, 1, v1
    v_and_b32 v4, 8, v4
    v_xor_b32 v2, v2, v4
    v_cmp_gt_u32 vcc, 32, v1
    s_nop 1
    v_cndmask_b32 v2, v2, v3, vcc
    v_lshlrev_b32 v113, 7, v2
    s_cmp_eq_u32 s87, 128
    s_cbranch_scc1 L_nc4
    s_cmp_eq_u32 s87, 256
    s_cbranch_scc1 L_nc4
    s_cmp_eq_u32 s87, 384
    s_cbranch_scc1 L_nc4
    v_add_u32 v2, 40960, v18
    v_xor_b32_e64 v3, 64, v2
    ds_read_b128 v[48:51], v2 offset:0
    ds_read_b128 v[52:55], v3 offset:1024
    ds_read_b128 v[56:59], v2 offset:2048
    ds_read_b128 v[60:63], v3 offset:3072
L_nc4:
    s_waitcnt vmcnt(7)
    s_mov_b32 s29, 0
L_k1:
    v_cmp_ne_u32 vcc, s86, v75
    v_cmp_ne_u32 s[92:93], s86, v76
    s_nop 0
    s_or_b64 vcc, vcc, s[92:93]
    s_cbranch_vccz L_k1k
    s_add_u32 s29, s29, 1
    s_cmp_ge_u32 s29, 200000
    s_cbranch_scc1 L_k1k
    s_sleep 2
    s_lshl_b32 s3, s36, 10
    buffer_load_dwordx4 v[72:75], v252, s[48:51], s3 offen sc1
    s_lshl_b32 s3, s37, 6
    buffer_load_dword v76, v232, s[48:51], s3 offen offset:12 sc1
    s_waitcnt vmcnt(0)
    s_branch L_k1
L_k1k:
    v_max_u32 v74, v74, v74 quad_perm:[1,0,3,2] row_mask:0xf bank_mask:0xf
    s_nop 1
    v_max_u32 v74, v74, v74 quad_perm:[2,3,0,1] row_mask:0xf bank_mask:0xf
    s_nop 1
    v_max_u32 v74, v74, v74 row_half_mirror row_mask:0xf bank_mask:0xf
    s_nop 1
    v_max_u32 v74, v74, v74 row_mirror row_mask:0xf bank_mask:0xf
    v_and_b32 v2, 0xffff0000, v72
    v_lshlrev_b32 v224, 16, v72
    v_and_b32 v3, 0xffff0000, v73
    v_lshlrev_b32 v225, 16, v73
    v_rcp_f32 v226, v2
    v_rcp_f32 v227, v3
    v_lshrrev_b32 v2, 16, v2
    v_or_b32 v236, v2, v3
    v_mul_f32 v228, 1069066811, v226
    v_mul_f32 v229, 1069066811, v227
    v_readlane_b32 s70, v74, 0
    v_readlane_b32 s3, v74, 16
    v_readlane_b32 s28, v74, 32
    v_readlane_b32 s29, v74, 48
    s_max_u32 s70, s70, s3
    s_max_u32 s28, s28, s29
    s_max_u32 s70, s70, s28
    s_bfe_u32 s64, s94, 262168
    s_lshl_b32 s64, s64, 7
    s_xor_b32 s64, s64, s66
    s_mul_i32 s65, s64, 3072
    s_add_u32 m0, s30, 0
    s_nop 0
    buffer_load_dwordx4 v8, s[40:43], s64 offen offset:0 lds
    buffer_load_dwordx4 v9, s[40:43], s64 offen offset:1024 lds
    buffer_load_dwordx4 v10, s[40:43], s64 offen offset:2048 lds
    buffer_load_dwordx4 v11, s[40:43], s64 offen offset:3072 lds
    s_add_u32 m0, s31, 0
    s_nop 0
    buffer_load_dwordx4 v12, s[44:47], s65 offen offset:0 lds
    buffer_load_dwordx4 v13, s[44:47], s65 offen offset:1024 lds
    s_add_u32 m0, s31, 8192
    s_nop 0
    buffer_load_dwordx4 v14, s[44:47], s65 offen offset:0 lds
    buffer_load_dwordx4 v15, s[44:47], s65 offen offset:1024 lds
    s_add_u32 m0, s31, 16384
    s_nop 0
    buffer_load_dwordx4 v16, s[44:47], s65 offen offset:0 lds
    buffer_load_dwordx4 v17, s[44:47], s65 offen offset:1024 lds
    s_waitcnt lgkmcnt(0)
    s_barrier
    s_bfe_u32 s64, s94, 262172
    s_lshl_b32 s64, s64, 7
    s_xor_b32 s64, s64, s66
    s_mul_i32 s65, s64, 3072
    s_add_u32 m0, s30, 40960
    s_nop 0
    buffer_load_dwordx4 v8, s[40:43], s64 offen offset:0 lds
    buffer_load_dwordx4 v9, s[40:43], s64 offen offset:1024 lds
    v_lshlrev_b32 v2, 16, v48
    v_and_b32 v3, 0xffff0000, v48
    v_add_f32 v24, v24, v2
    v_add_f32 v25, v25, v3
    buffer_load_dwordx4 v10, s[40:43], s64 offen offset:2048 lds
    v_lshlrev_b32 v4, 16, v49
    v_and_b32 v5, 0xffff0000, v49
    v_add_f32 v26, v26, v4
    v_add_f32 v27, v27, v5
    buffer_load_dwordx4 v11, s[40:43], s64 offen offset:3072 lds
    v_lshlrev_b32 v2, 16, v50
    v_and_b32 v3, 0xffff0000, v50
    v_add_f32 v28, v28, v2
    v_add_f32 v29, v29, v3
    s_add_u32 m0, s31, 40960
    s_nop 0
    buffer_load_dwordx4 v12, s[44:47], s65 offen offset:0 lds
    v_lshlrev_b32 v4, 16, v51
    v_and_b32 v5, 0xffff0000, v51
    v_add_f32 v30, v30, v4
    v_add_f32 v31, v31, v5
    buffer_load_dwordx4 v13, s[44:47], s65 offen offset:1024 lds
    v_lshlrev_b32 v2, 16, v52
    v_and_b32 v3, 0xffff0000, v52
    v_add_f32 v24, v24, v2
    v_add_f32 v25, v25, v3
    s_add_u32 m0, s31, 49152
    s_nop 0
    buffer_load_dwordx4 v14, s[44:47], s65 offen offset:0 lds
    v_lshlrev_b32 v4, 16, v53
    v_and_b32 v5, 0xffff0000, v53
    v_add_f32 v26, v26, v4
    v_add_f32 v27, v27, v5
    buffer_load_dwordx4 v15, s[44:47], s65 offen offset:1024 lds
    v_lshlrev_b32 v2, 16, v54
    v_and_b32 v3, 0xffff0000, v54
    v_add_f32 v28, v28, v2
    v_add_f32 v29, v29, v3
    s_add_u32 m0, s31, 57344
    s_nop 0
    buffer_load_dwordx4 v16, s[44:47], s65 offen offset:0 lds
    v_lshlrev_b32 v4, 16, v55
    v_and_b32 v5, 0xffff0000, v55
    v_add_f32 v30, v30, v4
    v_add_f32 v31, v31, v5
    buffer_load_dwordx4 v17, s[44:47], s65 offen offset:1024 lds
    s_add_u32 s3, s79, 0
    buffer_store_dwordx4 v[248:251], v252, s[48:51], s3 offen sc1
    s_waitcnt vmcnt(11)
    s_waitcnt lgkmcnt(0)
    s_barrier
    s_bfe_u32 s64, s95, 262144
    s_lshl_b32 s64, s64, 7
    s_xor_b32 s64, s64, s66
    s_mul_i32 s65, s64, 3072
    s_add_u32 m0, s30, 81920
    s_nop 0
    buffer_load_dwordx4 v8, s[40:43], s64 offen offset:0 lds
    buffer_load_dwordx4 v9, s[40:43], s64 offen offset:1024 lds
    v_lshlrev_b32 v2, 16, v56
    v_and_b32 v3, 0xffff0000, v56
    v_add_f32 v24, v24, v2
    v_add_f32 v25, v25, v3
    buffer_load_dwordx4 v10, s[40:43], s64 offen offset:2048 lds
    v_lshlrev_b32 v4, 16, v57
    v_and_b32 v5, 0xffff0000, v57
    v_add_f32 v26, v26, v4
    v_add_f32 v27, v27, v5
    buffer_load_dwordx4 v11, s[40:43], s64 offen offset:3072 lds
    v_lshlrev_b32 v2, 16, v58
    v_and_b32 v3, 0xffff0000, v58
    v_add_f32 v28, v28, v2
    v_add_f32 v29, v29, v3
    s_add_u32 m0, s31, 81920
    s_nop 0
    buffer_load_dwordx4 v12, s[44:47], s65 offen offset:0 lds
    v_lshlrev_b32 v4, 16, v59
    v_and_b32 v5, 0xffff0000, v59
    v_add_f32 v30, v30, v4
    v_add_f32 v31, v31, v5
    buffer_load_dwordx4 v13, s[44:47], s65 offen offset:1024 lds
    v_lshlrev_b32 v2, 16, v60
    v_and_b32 v3, 0xffff0000, v60
    v_add_f32 v24, v24, v2
    v_add_f32 v25, v25, v3
    s_add_u32 m0, s31, 90112
    s_nop 0
    buffer_load_dwordx4 v14, s[44:47], s65 offen offset:0 lds
    v_lshlrev_b32 v4, 16, v61
    v_and_b32 v5, 0xffff0000, v61
    v_add_f32 v26, v26, v4
    v_add_f32 v27, v27, v5
    buffer_load_dwordx4 v15, s[44:47], s65 offen offset:1024 lds
    v_lshlrev_b32 v2, 16, v62
    v_and_b32 v3, 0xffff0000, v62
    v_add_f32 v28, v28, v2
    v_add_f32 v29, v29, v3
    s_add_u32 m0, s31, 98304
    s_nop 0
    buffer_load_dwordx4 v16, s[44:47], s65 offen offset:0 lds
    v_lshlrev_b32 v4, 16, v63
    v_and_b32 v5, 0xffff0000, v63
    v_add_f32 v30, v30, v4
    v_add_f32_e64 v31, v31, v5
    buffer_load_dwordx4 v17, s[44:47], s65 offen offset:1024 lds
    s_add_u32 s3, s79, 32768
    buffer_store_dwordx4 v[248:251], v252, s[48:51], s3 offen sc1
    s_waitcnt vmcnt(12)
    s_waitcnt lgkmcnt(0)
    s_barrier
    s_bfe_u32 s64, s95, 262148
    s_lshl_b32 s64, s64, 7
    s_xor_b32 s64, s64, s66
    s_mul_i32 s65, s64, 3072
    s_add_u32 m0, s30, 0
    s_nop 0
    buffer_load_dwordx4 v8, s[40:43], s64 offen offset:0 lds
    buffer_load_dwordx4 v9, s[40:43], s64 offen offset:1024 lds
    v_permlane32_swap_b32 v24, v28
    v_permlane32_swap_b32 v25, v29
    buffer_load_dwordx4 v10, s[40:43], s64 offen offset:2048 lds
    v_permlane32_swap_b32 v26, v30
    v_permlane32_swap_b32 v27, v31
    buffer_load_dwordx4 v11, s[40:43], s64 offen offset:3072 lds
    v_add_f32 v24, v24, v28
    v_add_f32 v25, v25, v29
    s_add_u32 m0, s31, 0
    s_nop 0
    buffer_load_dwordx4 v12, s[44:47], s65 offen offset:0 lds
    v_add_f32 v26, v26, v30
    v_add_f32 v27, v27, v31
    buffer_load_dwordx4 v13, s[44:47], s65 offen offset:1024 lds
    v_permlane16_swap_b32 v24, v26
    v_permlane16_swap_b32 v25, v27
    s_add_u32 m0, s31, 8192
    s_nop 0
    buffer_load_dwordx4 v14, s[44:47], s65 offen offset:0 lds
    v_add_f32 v24, v24, v26
    v_add_f32 v25, v25, v27
    buffer_load_dwordx4 v15, s[44:47], s65 offen offset:1024 lds
    v_add_f32 v24, v24, v24 row_ror:8 row_mask:0xf bank_mask:0xf
    v_add_f32 v25, v25, v25 row_ror:8 row_mask:0xf bank_mask:0xf
    s_add_u32 m0, s31, 16384
    s_nop 0
    buffer_load_dwordx4 v16, s[44:47], s65 offen offset:0 lds
    buffer_load_dwordx4 v17, s[44:47], s65 offen offset:1024 lds
    v_and_b32 v2, 8, v1
    v_cmp_eq_u32 vcc, 0, v2
    s_nop 1
    v_cndmask_b32 v24, v25, v24, vcc
    s_cmp_eq_u32 s38, 3
    s_cselect_b64 exec, -1, 0
    v_mov_b32 v24, s70
    s_mov_b64 exec, -1
    buffer_store_dword v24, v253, s[48:51], s67 offen sc1
    s_waitcnt vmcnt(12)
    s_waitcnt lgkmcnt(0)
    s_barrier
    s_bfe_u32 s64, s95, 262152
    s_lshl_b32 s64, s64, 7
    s_xor_b32 s64, s64, s66
    s_mul_i32 s65, s64, 3072
    s_add_u32 m0, s30, 40960
    s_nop 0
    buffer_load_dwordx4 v8, s[40:43], s64 offen offset:0 lds
    buffer_load_dwordx4 v9, s[40:43], s64 offen offset:1024 lds
    buffer_load_dwordx4 v10, s[40:43], s64 offen offset:2048 lds
    buffer_load_dwordx4 v11, s[40:43], s64 offen offset:3072 lds
    s_add_u32 m0, s31, 40960
    s_nop 0
    buffer_load_dwordx4 v12, s[44:47], s65 offen offset:0 lds
    buffer_load_dwordx4 v13, s[44:47], s65 offen offset:1024 lds
    s_add_u32 m0, s31, 49152
    s_nop 0
    buffer_load_dwordx4 v14, s[44:47], s65 offen offset:0 lds
    buffer_load_dwordx4 v15, s[44:47], s65 offen offset:1024 lds
    s_add_u32 m0, s31, 57344
    s_nop 0
    buffer_load_dwordx4 v16, s[44:47], s65 offen offset:0 lds
    buffer_load_dwordx4 v17, s[44:47], s65 offen offset:1024 lds
    s_add_u32 s3, s79, 65536
    buffer_store_dwordx4 v[248:251], v252, s[48:51], s3 offen sc1
    s_add_u32 s3, s79, 98304
    buffer_store_dwordx4 v[248:251], v252, s[48:51], s3 offen sc1
    s_waitcnt vmcnt(13)
    s_waitcnt lgkmcnt(0)
    s_barrier
    s_bfe_u32 s64, s95, 262156
    s_lshl_b32 s64, s64, 7
    s_xor_b32 s64, s64, s66
    s_mul_i32 s65, s64, 3072
    s_add_u32 m0, s30, 81920
    s_nop 0
    buffer_load_dwordx4 v8, s[40:43], s64 offen offset:0 lds
    buffer_load_dwordx4 v9, s[40:43], s64 offen offset:1024 lds
    buffer_load_dwordx4 v10, s[40:43], s64 offen offset:2048 lds
    buffer_load_dwordx4 v11, s[40:43], s64 offen offset:3072 lds
    s_add_u32 m0, s31, 81920
    s_nop 0
    buffer_load_dwordx4 v12, s[44:47], s65 offen offset:0 lds
    buffer_load_dwordx4 v13, s[44:47], s65 offen offset:1024 lds
    s_add_u32 m0, s31, 90112
    s_nop 0
    buffer_load_dwordx4 v14, s[44:47], s65 offen offset:0 lds
    buffer_load_dwordx4 v15, s[44:47], s65 offen offset:1024 lds
    s_add_u32 m0, s31, 98304
    s_nop 0
    buffer_load_dwordx4 v16, s[44:47], s65 offen offset:0 lds
    buffer_load_dwordx4 v17, s[44:47], s65 offen offset:1024 lds
    s_lshl_b32 s3, s37, 14
    s_add_u32 s3, s3, 524288
    s_add_u32 s28, s3, 0
    buffer_load_dwordx4 v[80:83], v235, s[48:51], s28 offen sc1
    s_add_u32 s28, s3, 4096
    buffer_load_dwordx4 v[84:87], v235, s[48:51], s28 offen sc1
    s_waitcnt vmcnt(14)
    s_waitcnt lgkmcnt(0)
    s_barrier
    s_lshl_b32 s3, s37, 14
    s_nop 0
    s_add_u32 s3, s3, 524288
    s_add_u32 s28, s3, 8192
    buffer_load_dwordx4 v[88:91], v235, s[48:51], s28 offen sc1
    s_add_u32 s28, s3, 12288
    buffer_load_dwordx4 v[92:95], v235, s[48:51], s28 offen sc1
    s_bfe_u32 s64, s95, 262160
    s_lshl_b32 s64, s64, 7
    s_xor_b32 s64, s64, s66
    s_mul_i32 s65, s64, 3072
    s_add_u32 m0, s30, 0
    s_nop 0
    buffer_load_dwordx4 v8, s[40:43], s64 offen offset:0 lds
    buffer_load_dwordx4 v9, s[40:43], s64 offen offset:1024 lds
    buffer_load_dwordx4 v10, s[40:43], s64 offen offset:2048 lds
    buffer_load_dwordx4 v11, s[40:43], s64 offen offset:3072 lds
    s_add_u32 m0, s31, 0
    s_nop 0
    buffer_load_dwordx4 v12, s[44:47], s65 offen offset:0 lds
    buffer_load_dwordx4 v13, s[44:47], s65 offen offset:1024 lds
    s_add_u32 m0, s31, 8192
    s_nop 0
    buffer_load_dwordx4 v14, s[44:47], s65 offen offset:0 lds
    buffer_load_dwordx4 v15, s[44:47], s65 offen offset:1024 lds
    s_add_u32 m0, s31, 16384
    s_nop 0
    buffer_load_dwordx4 v16, s[44:47], s65 offen offset:0 lds
    buffer_load_dwordx4 v17, s[44:47], s65 offen offset:1024 lds
    s_waitcnt vmcnt(14)
    s_waitcnt lgkmcnt(0)
    s_barrier
    s_waitcnt vmcnt(10)
    s_mov_b32 s29, 0
L_k2:
    s_nop 0
    v_max3_u32 v2, v80, v81, v82
    v_max3_u32 v2, v2, v83, v84
    v_max3_u32 v2, v2, v85, v86
    v_max3_u32 v2, v2, v87, v88
    v_max3_u32 v2, v2, v89, v90
    v_max3_u32 v2, v2, v91, v92
    v_max3_u32 v2, v2, v93, v94
    v_max_u32 v2, v2, v95
    v_cmp_eq_u32 vcc, -1, v2
    s_cbranch_vccz L_k2k
    s_add_u32 s29, s29, 1
    s_cmp_ge_u32 s29, 200000
    s_cbranch_scc1 L_k2k
    s_sleep 1
    s_lshl_b32 s3, s37, 14
    s_add_u32 s3, s3, 524288
    s_add_u32 s28, s3, 0
    buffer_load_dwordx4 v[80:83], v235, s[48:51], s28 offen sc1
    s_add_u32 s28, s3, 4096
    buffer_load_dwordx4 v[84:87], v235, s[48:51], s28 offen sc1
    s_add_u32 s28, s3, 8192
    buffer_load_dwordx4 v[88:91], v235, s[48:51], s28 offen sc1
    s_add_u32 s28, s3, 12288
    buffer_load_dwordx4 v[92:95], v235, s[48:51], s28 offen sc1
    s_waitcnt vmcnt(0)
    s_branch L_k2
L_k2k:
    s_bfe_u32 s64, s95, 262164
    s_lshl_b32 s64, s64, 7
    s_xor_b32 s64, s64, s66
    s_mul_i32 s65, s64, 3072
    s_add_u32 m0, s30, 40960
    s_nop 0
    buffer_load_dwordx4 v8, s[40:43], s64 offen offset:0 lds
    buffer_load_dwordx4 v9, s[40:43], s64 offen offset:1024 lds
    v_max3_u32 v2, v80, v84, v88
    v_max_u32 v2, v2, v92
    v_add_f32 v80, v80, v88
    buffer_load_dwordx4 v10, s[40:43], s64 offen offset:2048 lds
    v_add_f32 v81, v81, v89
    v_add_f32 v82, v82, v90
    v_add_f32 v83, v83, v91
    buffer_load_dwordx4 v11, s[40:43], s64 offen offset:3072 lds
    v_add_f32 v84, v84, v92
    v_add_f32 v85, v85, v93
    v_add_f32 v86, v86, v94
    s_add_u32 m0, s31, 40960
    s_nop 0
    buffer_load_dwordx4 v12, s[44:47], s65 offen offset:0 lds
    v_add_f32 v87, v87, v95
    v_add_f32 v80, v80, v84
    v_add_f32 v81, v81, v85
    buffer_load_dwordx4 v13, s[44:47], s65 offen offset:1024 lds
    v_add_f32 v82, v82, v86
    v_add_f32_e64 v83, v83, v87
    v_readlane_b32 s70, v2, 12
    s_add_u32 m0, s31, 49152
    s_nop 0
    buffer_load_dwordx4 v14, s[44:47], s65 offen offset:0 lds
    v_readlane_b32 s3, v2, 28
    v_readlane_b32 s28, v2, 44
    v_readlane_b32 s29, v2, 60
    buffer_load_dwordx4 v15, s[44:47], s65 offen offset:1024 lds
    s_max_u32 s70, s70, s3
    s_max_u32 s28, s28, s29
    s_max_u32 s70, s70, s28
    s_add_u32 m0, s31, 57344
    s_nop 0
    buffer_load_dwordx4 v16, s[44:47], s65 offen offset:0 lds
    v_permlane32_swap_b32 v80, v82
    v_permlane32_swap_b32 v81, v83
    v_add_f32 v80, v80, v82
    buffer_load_dwordx4 v17, s[44:47], s65 offen offset:1024 lds
    v_add_f32 v81, v81, v83
    s_nop 1
    v_permlane16_swap_b32 v80, v81
    v_add_f32 v80, v80, v81
    s_mov_b32 exec_lo, 0xf000f000
    s_mov_b32 exec_hi, 0xf000f000
    v_mov_b32 v80, s70
    s_mov_b64 exec, -1
    s_waitcnt vmcnt(10)
    s_waitcnt lgkmcnt(0)
    s_barrier
    s_bfe_u32 s64, s95, 262168
    s_lshl_b32 s64, s64, 7
    s_xor_b32 s64, s64, s66
    s_mul_i32 s65, s64, 3072
    s_add_u32 m0, s30, 81920
    s_nop 0
    buffer_load_dwordx4 v8, s[40:43], s64 offen offset:0 lds
    buffer_load_dwordx4 v9, s[40:43], s64 offen offset:1024 lds
    buffer_load_dwordx4 v10, s[40:43], s64 offen offset:2048 lds
    buffer_load_dwordx4 v11, s[40:43], s64 offen offset:3072 lds
    s_add_u32 m0, s31, 81920
    s_nop 0
    buffer_load_dwordx4 v12, s[44:47], s65 offen offset:0 lds
    buffer_load_dwordx4 v13, s[44:47], s65 offen offset:1024 lds
    s_add_u32 m0, s31, 90112
    s_nop 0
    buffer_load_dwordx4 v14, s[44:47], s65 offen offset:0 lds
    buffer_load_dwordx4 v15, s[44:47], s65 offen offset:1024 lds
    s_add_u32 m0, s31, 98304
    s_nop 0
    buffer_load_dwordx4 v16, s[44:47], s65 offen offset:0 lds
    buffer_load_dwordx4 v17, s[44:47], s65 offen offset:1024 lds
    s_and_b32 s68, s70, 0x7ff
    s_sub_u32 s68, 2047, s68
    s_lshl_b32 s3, s68, 11
    s_and_b32 s28, s77, 3
    s_lshl_b32 s28, s28, 9
    s_add_u32 s3, s3, s28
    s_lshr_b32 s28, s38, 1
    s_lshl_b32 s28, s28, 8
    s_add_u32 s3, s3, s28
    v_lshrrev_b32 v3, 3, v1
    v_lshlrev_b32 v3, 5, v3
    buffer_load_dwordx4 v[64:67], v3, s[40:43], s3 offen
    buffer_load_dwordx4 v[68:71], v3, s[40:43], s3 offen offset:16
    s_lshr_b32 s3, s68, 1
    s_lshl_b32 s3, s3, 4
    s_and_b32 s28, s68, 1
    s_lshl_b32 s28, s28, 2
    s_add_u32 s3, s3, s28
    v_mov_b32 v3, 0
    buffer_load_dword v116, v3, s[48:51], s3 offen sc1
    s_waitcnt vmcnt(13)
    s_waitcnt lgkmcnt(0)
    s_barrier
    s_bfe_u32 s64, s95, 262172
    s_lshl_b32 s64, s64, 7
    s_xor_b32 s64, s64, s66
    s_mul_i32 s65, s64, 3072
    s_add_u32 m0, s30, 0
    s_nop 0
    buffer_load_dwordx4 v8, s[40:43], s64 offen offset:0 lds
    buffer_load_dwordx4 v9, s[40:43], s64 offen offset:1024 lds
    buffer_load_dwordx4 v10, s[40:43], s64 offen offset:2048 lds
    buffer_load_dwordx4 v11, s[40:43], s64 offen offset:3072 lds
    s_add_u32 m0, s31, 0
    s_nop 0
    buffer_load_dwordx4 v12, s[44:47], s65 offen offset:0 lds
    buffer_load_dwordx4 v13, s[44:47], s65 offen offset:1024 lds
    s_add_u32 m0, s31, 8192
    s_nop 0
    buffer_load_dwordx4 v14, s[44:47], s65 offen offset:0 lds
    buffer_load_dwordx4 v15, s[44:47], s65 offen offset:1024 lds
    s_add_u32 m0, s31, 16384
    s_nop 0
    buffer_load_dwordx4 v16, s[44:47], s65 offen offset:0 lds
    buffer_load_dwordx4 v17, s[44:47], s65 offen offset:1024 lds
    s_or_b32 s3, s2, s38
    s_mov_b32 s28, 16384
    s_cmp_lg_u32 s3, 0
    s_cselect_b32 s3, 268435456, s28
    v_mov_b32 v2, s86
    s_mov_b64 exec, 1
    buffer_store_dword v2, v252, s[48:51], s3 offen sc1
    s_mov_b64 exec, -1
    s_waitcnt vmcnt(14)
    s_waitcnt lgkmcnt(0)
    s_barrier
    s_nop 0
    s_mov_b32 s3, 28672
    buffer_load_dwordx4 v[144:147], v21, s[52:55], s3 offen nt
    s_mov_b32 s3, 35840
    buffer_load_dwordx4 v[148:151], v21, s[52:55], s3 offen nt
    s_mov_b32 s3, 43008
    buffer_load_dwordx4 v[152:155], v21, s[52:55], s3 offen nt
    s_mov_b32 s3, 50176
    buffer_load_dwordx4 v[156:159], v21, s[52:55], s3 offen nt
    s_mov_b32 s3, 57344
    buffer_load_dwordx4 v[160:163], v21, s[52:55], s3 offen nt
    s_mov_b32 s3, 64512
    buffer_load_dwordx4 v[164:167], v21, s[52:55], s3 offen nt
    s_mov_b32 s3, 71680
    buffer_load_dwordx4 v[168:171], v21, s[52:55], s3 offen nt
    s_mov_b32 s3, 78848
    buffer_load_dwordx4 v[172:175], v21, s[52:55], s3 offen nt
    ds_write_b32 v233, v80
    s_lshl_b32 s3, s38, 4
    s_lshl_b64 exec, 0xffff, s3
    ds_write_b64 v230, v[224:225]
    ds_write_b64 v230, v[226:227] offset:1024
    ds_write_b64 v230, v[228:229] offset:2048
    ds_write_b32 v231, v236
    s_mov_b64 exec, -1
    s_waitcnt vmcnt(19)
    v_and_b32 v5, 0xffff0000, v116
    v_lshlrev_b32 v116, 16, v116
    v_rcp_f32 v117, v5
    v_lshlrev_b32 v96, 16, v64
    v_and_b32 v97, 0xffff0000, v64
    v_lshlrev_b32 v98, 16, v65
    v_and_b32 v99, 0xffff0000, v65
    v_lshlrev_b32 v100, 16, v66
    v_and_b32 v101, 0xffff0000, v66
    v_lshlrev_b32 v102, 16, v67
    v_and_b32 v103, 0xffff0000, v67
    v_lshlrev_b32 v104, 16, v68
    v_and_b32 v105, 0xffff0000, v68
    v_lshlrev_b32 v106, 16, v69
    v_and_b32 v107, 0xffff0000, v69
    v_lshlrev_b32 v108, 16, v70
    v_and_b32 v109, 0xffff0000, v70
    v_lshlrev_b32 v110, 16, v71
    v_and_b32 v111, 0xffff0000, v71
    v_mul_f32 v119, v116, v117
    v_fma_f32 v96, v96, v117, -v119
    v_fma_f32 v97, v97, v117, -v119
    v_fma_f32 v98, v98, v117, -v119
    v_fma_f32 v99, v99, v117, -v119
    v_fma_f32 v100, v100, v117, -v119
    v_fma_f32 v101, v101, v117, -v119
    v_fma_f32 v102, v102, v117, -v119
    v_fma_f32 v103, v103, v117, -v119
    v_fma_f32 v104, v104, v117, -v119
    v_fma_f32 v105, v105, v117, -v119
    v_fma_f32 v106, v106, v117, -v119
    v_fma_f32 v107, v107, v117, -v119
    v_fma_f32 v108, v108, v117, -v119
    v_fma_f32 v109, v109, v117, -v119
    v_fma_f32 v110, v110, v117, -v119
    v_fma_f32 v111, v111, v117, -v119
    v_mov_b32 v120, 0
    v_mov_b32 v121, 0
    v_mov_b32 v122, 0
    v_mov_b32 v123, 0
    v_mov_b32 v124, 0
    v_mov_b32 v125, 0
    v_mov_b32 v126, 0
    v_mov_b32 v127, 0
    s_waitcnt vmcnt(9)
    s_waitcnt lgkmcnt(0)
    s_barrier
    v_lshlrev_b32 v2, 16, v128
    v_and_b32 v3, 0xffff0000, v128
    v_fmac_f32 v120, v2, v96
    v_fmac_f32 v121, v3, v96
    v_lshlrev_b32 v4, 16, v129
    v_and_b32 v5, 0xffff0000, v129
    v_fmac_f32 v122, v4, v96
    v_fmac_f32 v123, v5, v96
    v_lshlrev_b32 v2, 16, v130
    v_and_b32 v3, 0xffff0000, v130
    v_fmac_f32 v124, v2, v96
    v_fmac_f32 v125, v3, v96
    v_lshlrev_b32 v4, 16, v131
    v_and_b32 v5, 0xffff0000, v131
    v_fmac_f32 v126, v4, v96
    v_fmac_f32 v127, v5, v96
    v_lshlrev_b32 v2, 16, v132
    v_and_b32 v3, 0xffff0000, v132
    v_fmac_f32 v120, v2, v97
    v_fmac_f32 v121, v3, v97
    v_lshlrev_b32 v4, 16, v133
    v_and_b32 v5, 0xffff0000, v133
    v_fmac_f32 v122, v4, v97
    v_fmac_f32 v123, v5, v97
    v_lshlrev_b32 v2, 16, v134
    v_and_b32 v3, 0xffff0000, v134
    v_fmac_f32 v124, v2, v97
    v_fmac_f32 v125, v3, v97
    v_lshlrev_b32 v4, 16, v135
    v_and_b32 v5, 0xffff0000, v135
    v_fmac_f32 v126, v4, v97
    v_fmac_f32 v127, v5, v97
    v_lshlrev_b32 v2, 16, v136
    v_and_b32 v3, 0xffff0000, v136
    v_fmac_f32 v120, v2, v98
    v_fmac_f32 v121, v3, v98
    v_lshlrev_b32 v4, 16, v137
    v_and_b32 v5, 0xffff0000, v137
    v_fmac_f32 v122, v4, v98
    v_fmac_f32 v123, v5, v98
    v_lshlrev_b32 v2, 16, v138
    v_and_b32 v3, 0xffff0000, v138
    v_fmac_f32 v124, v2, v98
    v_fmac_f32 v125, v3, v98
    v_lshlrev_b32 v4, 16, v139
    v_and_b32 v5, 0xffff0000, v139
    v_fmac_f32 v126, v4, v98
    v_fmac_f32 v127, v5, v98
    v_lshlrev_b32 v2, 16, v140
    v_and_b32 v3, 0xffff0000, v140
    v_fmac_f32 v120, v2, v99
    v_fmac_f32 v121, v3, v99
    v_lshlrev_b32 v4, 16, v141
    v_and_b32 v5, 0xffff0000, v141
    v_fmac_f32 v122, v4, v99
    v_fmac_f32 v123, v5, v99
    v_lshlrev_b32 v2, 16, v142
    v_and_b32 v3, 0xffff0000, v142
    v_fmac_f32 v124, v2, v99
    v_fmac_f32 v125, v3, v99
    v_lshlrev_b32 v4, 16, v143
    v_and_b32 v5, 0xffff0000, v143
    v_fmac_f32 v126, v4, v99
    v_fmac_f32 v127, v5, v99
    s_waitcnt lgkmcnt(0)
    s_barrier
    v_and_b32 v2, 15, v1
    v_min_u32 v2, 13, v2
    v_lshrrev_b32 v3, 4, v1
    v_mul_u32_u24 v3, 14336, v3
    v_lshl_add_u32 v13, v2, 4, v3
    s_lshl_b32 s75, s71, 2
    s_add_u32 s75, s75, 1183744
    s_add_u32 m0, s72, 0
    s_add_u32 s3, s73, 0
    s_nop 0
    buffer_load_dwordx4 v220, s[88:91], s3 offen offset:0 lds
    buffer_load_dwordx4 v221, s[88:91], s3 offen offset:1024 lds
    buffer_load_dwordx4 v222, s[88:91], s3 offen offset:2048 lds
    buffer_load_dwordx4 v223, s[88:91], s3 offen offset:3072 lds
    s_add_u32 m0, s72, 16384
    s_add_u32 s3, s73, 262144
    buffer_load_dwordx4 v220, s[88:91], s3 offen offset:0 lds
    buffer_load_dwordx4 v221, s[88:91], s3 offen offset:1024 lds
    buffer_load_dwordx4 v222, s[88:91], s3 offen offset:2048 lds
    buffer_load_dwordx4 v223, s[88:91], s3 offen offset:3072 lds
    s_add_u32 m0, s72, 65536
    s_add_u32 s3, s73, 1048576
    buffer_load_dwordx4 v220, s[88:91], s3 offen offset:0 lds
    buffer_load_dwordx4 v221, s[88:91], s3 offen offset:1024 lds
    buffer_load_dwordx4 v222, s[88:91], s3 offen offset:2048 lds
    buffer_load_dwordx4 v223, s[88:91], s3 offen offset:3072 lds
    s_mov_b32 s3, 86016
    buffer_load_dwordx4 v[176:179], v21, s[52:55], s3 offen nt
    s_mov_b32 s3, 93184
    buffer_load_dwordx4 v[180:183], v21, s[52:55], s3 offen nt
    s_mov_b32 s3, 100352
    buffer_load_dwordx4 v[184:187], v21, s[52:55], s3 offen nt
    s_mov_b32 s3, 107520
    buffer_load_dwordx4 v[188:191], v21, s[52:55], s3 offen nt
    s_lshr_b32 s3, s71, 3
    s_add_u32 s3, s3, 0
    s_and_b32 s28, s3, 7
    s_lshr_b32 s3, s3, 3
    s_lshl_b32 s3, s3, 6
    s_add_u32 s3, s3, s28
    s_lshl_b32 s3, s3, 11
    buffer_load_dwordx4 v[192:195], v22, s[56:59], s3 offen nt
    s_lshr_b32 s3, s71, 3
    s_add_u32 s3, s3, 1
    s_and_b32 s28, s3, 7
    s_lshr_b32 s3, s3, 3
    s_lshl_b32 s3, s3, 6
    s_add_u32 s3, s3, s28
    s_lshl_b32 s3, s3, 11
    buffer_load_dwordx4 v[196:199], v22, s[56:59], s3 offen nt
    s_lshr_b32 s3, s71, 3
    s_add_u32 s3, s3, 2
    s_and_b32 s28, s3, 7
    s_lshr_b32 s3, s3, 3
    s_lshl_b32 s3, s3, 6
    s_add_u32 s3, s3, s28
    s_lshl_b32 s3, s3, 11
    buffer_load_dwordx4 v[200:203], v22, s[56:59], s3 offen nt
    s_waitcnt vmcnt(19)
    v_lshlrev_b32_e64 v2, 16, v144
    v_and_b32 v3, 0xffff0000, v144
    v_pk_fma_f32 v[120:121], v[2:3], v[100:101], v[120:121] op_sel_hi:[1,0,1]
    v_lshlrev_b32_e64 v4, 16, v145
    v_and_b32 v5, 0xffff0000, v145
    v_pk_fma_f32 v[122:123], v[4:5], v[100:101], v[122:123] op_sel_hi:[1,0,1]
    v_lshlrev_b32_e64 v2, 16, v146
    v_and_b32 v3, 0xffff0000, v146
    v_pk_fma_f32 v[124:125], v[2:3], v[100:101], v[124:125] op_sel_hi:[1,0,1]
    v_lshlrev_b32_e64 v4, 16, v147
    v_and_b32 v5, 0xffff0000, v147
    v_pk_fma_f32 v[126:127], v[4:5], v[100:101], v[126:127] op_sel_hi:[1,0,1]
    v_lshlrev_b32 v2, 16, v148
    v_and_b32 v3, 0xffff0000, v148
    v_mov_b32 v100, v101
    v_pk_fma_f32 v[120:121], v[2:3], v[100:101], v[120:121] op_sel_hi:[1,0,1]
    v_lshlrev_b32_e64 v4, 16, v149
    v_and_b32 v5, 0xffff0000, v149
    v_pk_fma_f32 v[122:123], v[4:5], v[100:101], v[122:123] op_sel_hi:[1,0,1]
    v_lshlrev_b32_e64 v2, 16, v150
    v_and_b32 v3, 0xffff0000, v150
    v_pk_fma_f32 v[124:125], v[2:3], v[100:101], v[124:125] op_sel_hi:[1,0,1]
    v_lshlrev_b32_e64 v4, 16, v151
    v_and_b32 v5, 0xffff0000, v151
    v_pk_fma_f32 v[126:127], v[4:5], v[100:101], v[126:127] op_sel_hi:[1,0,1]
    v_lshlrev_b32_e64 v2, 16, v152
    v_and_b32 v3, 0xffff0000, v152
    v_pk_fma_f32 v[120:121], v[2:3], v[102:103], v[120:121] op_sel_hi:[1,0,1]
    v_lshlrev_b32_e64 v4, 16, v153
    v_and_b32 v5, 0xffff0000, v153
    v_pk_fma_f32 v[122:123], v[4:5], v[102:103], v[122:123] op_sel_hi:[1,0,1]
    v_lshlrev_b32_e64 v2, 16, v154
    v_and_b32 v3, 0xffff0000, v154
    v_pk_fma_f32 v[124:125], v[2:3], v[102:103], v[124:125] op_sel_hi:[1,0,1]
    v_lshlrev_b32_e64 v4, 16, v155
    v_and_b32 v5, 0xffff0000, v155
    v_pk_fma_f32 v[126:127], v[4:5], v[102:103], v[126:127] op_sel_hi:[1,0,1]
    v_lshlrev_b32 v2, 16, v156
    v_and_b32 v3, 0xffff0000, v156
    v_mov_b32 v102, v103
    v_pk_fma_f32 v[120:121], v[2:3], v[102:103], v[120:121] op_sel_hi:[1,0,1]
    v_lshlrev_b32_e64 v4, 16, v157
    v_and_b32 v5, 0xffff0000, v157
    v_pk_fma_f32 v[122:123], v[4:5], v[102:103], v[122:123] op_sel_hi:[1,0,1]
    v_lshlrev_b32_e64 v2, 16, v158
    v_and_b32 v3, 0xffff0000, v158
    v_pk_fma_f32 v[124:125], v[2:3], v[102:103], v[124:125] op_sel_hi:[1,0,1]
    v_lshlrev_b32_e64 v4, 16, v159
    v_and_b32 v5, 0xffff0000, v159
    v_pk_fma_f32 v[126:127], v[4:5], v[102:103], v[126:127] op_sel_hi:[1,0,1]
    v_lshlrev_b32_e64 v2, 16, v160
    v_and_b32 v3, 0xffff0000, v160
    v_pk_fma_f32 v[120:121], v[2:3], v[104:105], v[120:121] op_sel_hi:[1,0,1]
    v_lshlrev_b32_e64 v4, 16, v161
    v_and_b32 v5, 0xffff0000, v161
    v_pk_fma_f32 v[122:123], v[4:5], v[104:105], v[122:123] op_sel_hi:[1,0,1]
    v_lshlrev_b32_e64 v2, 16, v162
    v_and_b32 v3, 0xffff0000, v162
    v_pk_fma_f32 v[124:125], v[2:3], v[104:105], v[124:125] op_sel_hi:[1,0,1]
    v_lshlrev_b32_e64 v4, 16, v163
    v_and_b32 v5, 0xffff0000, v163
    v_pk_fma_f32 v[126:127], v[4:5], v[104:105], v[126:127] op_sel_hi:[1,0,1]
    v_lshlrev_b32 v2, 16, v164
    v_and_b32 v3, 0xffff0000, v164
    v_mov_b32 v104, v105
    v_pk_fma_f32 v[120:121], v[2:3], v[104:105], v[120:121] op_sel_hi:[1,0,1]
    v_lshlrev_b32_e64 v4, 16, v165
    v_and_b32 v5, 0xffff0000, v165
    v_pk_fma_f32 v[122:123], v[4:5], v[104:105], v[122:123] op_sel_hi:[1,0,1]
    v_lshlrev_b32_e64 v2, 16, v166
    v_and_b32 v3, 0xffff0000, v166
    v_pk_fma_f32 v[124:125], v[2:3], v[104:105], v[124:125] op_sel_hi:[1,0,1]
    v_lshlrev_b32_e64 v4, 16, v167
    v_and_b32 v5, 0xffff0000, v167
    v_pk_fma_f32 v[126:127], v[4:5], v[104:105], v[126:127] op_sel_hi:[1,0,1]
    v_lshlrev_b32_e64 v2, 16, v168
    v_and_b32 v3, 0xffff0000, v168
    v_pk_fma_f32 v[120:121], v[2:3], v[106:107], v[120:121] op_sel_hi:[1,0,1]
    v_lshlrev_b32_e64 v4, 16, v169
    v_and_b32 v5, 0xffff0000, v169
    v_pk_fma_f32 v[122:123], v[4:5], v[106:107], v[122:123] op_sel_hi:[1,0,1]
    v_lshlrev_b32_e64 v2, 16, v170
    v_and_b32 v3, 0xffff0000, v170
    v_pk_fma_f32 v[124:125], v[2:3], v[106:107], v[124:125] op_sel_hi:[1,0,1]
    v_lshlrev_b32_e64 v4, 16, v171
    v_and_b32 v5, 0xffff0000, v171
    v_pk_fma_f32 v[126:127], v[4:5], v[106:107], v[126:127] op_sel_hi:[1,0,1]
    v_lshlrev_b32 v2, 16, v172
    v_and_b32 v3, 0xffff0000, v172
    v_mov_b32 v106, v107
    v_pk_fma_f32 v[120:121], v[2:3], v[106:107], v[120:121] op_sel_hi:[1,0,1]
    v_lshlrev_b32_e64 v4, 16, v173
    v_and_b32 v5, 0xffff0000, v173
    v_pk_fma_f32 v[122:123], v[4:5], v[106:107], v[122:123] op_sel_hi:[1,0,1]
    v_lshlrev_b32_e64 v2, 16, v174
    v_and_b32 v3, 0xffff0000, v174
    v_pk_fma_f32 v[124:125], v[2:3], v[106:107], v[124:125] op_sel_hi:[1,0,1]
    v_lshlrev_b32_e64 v4, 16, v175
    v_and_b32 v5, 0xffff0000, v175
    v_pk_fma_f32 v[126:127], v[4:5], v[106:107], v[126:127] op_sel_hi:[1,0,1]
    s_waitcnt vmcnt(15)
    s_waitcnt vmcnt(11)
    s_waitcnt vmcnt(7)
    s_barrier
    s_add_u32 m0, s72, 32768
    s_add_u32 s3, s73, 524288
    buffer_load_dwordx4 v220, s[88:91], s3 offen offset:0 lds
    buffer_load_dwordx4 v221, s[88:91], s3 offen offset:1024 lds
    buffer_load_dwordx4 v222, s[88:91], s3 offen offset:2048 lds
    buffer_load_dwordx4 v223, s[88:91], s3 offen offset:3072 lds
    s_add_u32 m0, s72, 49152
    s_add_u32 s3, s73, 786432
    buffer_load_dwordx4 v220, s[88:91], s3 offen offset:0 lds
    buffer_load_dwordx4 v221, s[88:91], s3 offen offset:1024 lds
    buffer_load_dwordx4 v222, s[88:91], s3 offen offset:2048 lds
    buffer_load_dwordx4 v223, s[88:91], s3 offen offset:3072 lds
    s_add_u32 m0, s72, 81920
    s_add_u32 s3, s73, 1310720
    buffer_load_dwordx4 v220, s[88:91], s3 offen offset:0 lds
    buffer_load_dwordx4 v221, s[88:91], s3 offen offset:1024 lds
    buffer_load_dwordx4 v222, s[88:91], s3 offen offset:2048 lds
    buffer_load_dwordx4 v223, s[88:91], s3 offen offset:3072 lds
    s_setprio 3
    s_cmp_lg_u32 s38, 3
    s_cbranch_scc1 L_npl
    s_mov_b32 s3, 32768
    s_mov_b32 s29, 0
    s_mov_b32 exec_lo, -1
    s_mov_b32 exec_hi, 65535
L_rp:
    buffer_load_dword v118, v113, s[48:51], s3 offen sc1
    s_waitcnt vmcnt(0)
    v_cmp_ne_u32 vcc, s86, v118
    s_cbranch_vccz L_rpk
    s_mov_b64 exec, vcc
    s_add_u32 s29, s29, 1
    s_cmp_lt_u32 s29, 200000
    s_cbranch_scc1 L_rp
L_rpk:
    s_mov_b64 exec, -1
    v_mov_b32 v4, 162128
    v_mov_b32 v5, 1
    ds_write_b32 v4, v5
L_npl:
    v_min_u32 v3, 4, v1
    v_lshlrev_b32_e64 v3, 2, v3
    v_add_u32 v3, 162112, v3
L_fw:
    ds_read_b32 v4, v3
    s_waitcnt lgkmcnt(0)
    v_cmp_eq_u32 vcc, 0, v4
    s_cbranch_vccz L_fk
    s_sleep 1
    s_branch L_fw
L_fk:
    s_waitcnt vmcnt(15)
    v_lshlrev_b32_e64 v2, 16, v176
    v_and_b32 v3, 0xffff0000, v176
    v_pk_fma_f32 v[120:121], v[2:3], v[108:109], v[120:121] op_sel_hi:[1,0,1]
    v_lshlrev_b32_e64 v4, 16, v177
    v_and_b32 v5, 0xffff0000, v177
    v_pk_fma_f32 v[122:123], v[4:5], v[108:109], v[122:123] op_sel_hi:[1,0,1]
    v_lshlrev_b32_e64 v2, 16, v178
    v_and_b32 v3, 0xffff0000, v178
    v_pk_fma_f32 v[124:125], v[2:3], v[108:109], v[124:125] op_sel_hi:[1,0,1]
    v_lshlrev_b32_e64 v4, 16, v179
    v_and_b32 v5, 0xffff0000, v179
    v_pk_fma_f32 v[126:127], v[4:5], v[108:109], v[126:127] op_sel_hi:[1,0,1]
    v_lshlrev_b32 v2, 16, v180
    v_and_b32 v3, 0xffff0000, v180
    v_mov_b32 v108, v109
    v_pk_fma_f32 v[120:121], v[2:3], v[108:109], v[120:121] op_sel_hi:[1,0,1]
    v_lshlrev_b32_e64 v4, 16, v181
    v_and_b32 v5, 0xffff0000, v181
    v_pk_fma_f32 v[122:123], v[4:5], v[108:109], v[122:123] op_sel_hi:[1,0,1]
    v_lshlrev_b32_e64 v2, 16, v182
    v_and_b32 v3, 0xffff0000, v182
    v_pk_fma_f32 v[124:125], v[2:3], v[108:109], v[124:125] op_sel_hi:[1,0,1]
    v_lshlrev_b32_e64 v4, 16, v183
    v_and_b32 v5, 0xffff0000, v183
    v_pk_fma_f32 v[126:127], v[4:5], v[108:109], v[126:127] op_sel_hi:[1,0,1]
    s_add_u32 s3, s76, 0
    buffer_load_dwordx4 v[48:51], v112, s[48:51], s3 offen sc1
    s_add_u32 s3, s76, 33792
    buffer_load_dwordx4 v[52:55], v112, s[48:51], s3 offen sc1
    s_cmp_lg_u32 s83, 0
    s_cbranch_scc1 L_nz
    s_add_u32 s3, s81, 0
    buffer_load_dwordx4 v[32:35], v112, s[48:51], s3 offen sc1
    s_add_u32 s3, s81, 33792
    buffer_load_dwordx4 v[36:39], v112, s[48:51], s3 offen sc1
L_nz:
    v_lshlrev_b32_e64 v2, 16, v184
    v_and_b32 v3, 0xffff0000, v184
    v_pk_fma_f32 v[120:121], v[2:3], v[110:111], v[120:121] op_sel_hi:[1,0,1]
    v_lshlrev_b32_e64 v4, 16, v185
    v_and_b32 v5, 0xffff0000, v185
    v_pk_fma_f32 v[122:123], v[4:5], v[110:111], v[122:123] op_sel_hi:[1,0,1]
    v_lshlrev_b32_e64 v2, 16, v186
    v_and_b32 v3, 0xffff0000, v186
    v_pk_fma_f32 v[124:125], v[2:3], v[110:111], v[124:125] op_sel_hi:[1,0,1]
    v_lshlrev_b32_e64 v4, 16, v187
    v_and_b32 v5, 0xffff0000, v187
    v_pk_fma_f32 v[126:127], v[4:5], v[110:111], v[126:127] op_sel_hi:[1,0,1]
    v_lshlrev_b32 v2, 16, v188
    v_and_b32 v3, 0xffff0000, v188
    v_mov_b32 v110, v111
    v_pk_fma_f32 v[120:121], v[2:3], v[110:111], v[120:121] op_sel_hi:[1,0,1]
    v_lshlrev_b32_e64 v4, 16, v189
    v_and_b32 v5, 0xffff0000, v189
    v_pk_fma_f32 v[122:123], v[4:5], v[110:111], v[122:123] op_sel_hi:[1,0,1]
    v_lshlrev_b32_e64 v2, 16, v190
    v_and_b32 v3, 0xffff0000, v190
    v_pk_fma_f32 v[124:125], v[2:3], v[110:111], v[124:125] op_sel_hi:[1,0,1]
    v_lshlrev_b32_e64 v4, 16, v191
    v_and_b32 v5, 0xffff0000, v191
    v_pk_fma_f32 v[126:127], v[4:5], v[110:111], v[126:127] op_sel_hi:[1,0,1]
    v_permlane32_swap_b32 v120, v124
    v_permlane32_swap_b32 v121, v125
    v_permlane32_swap_b32 v122, v126
    v_permlane32_swap_b32 v123, v127
    v_add_f32 v120, v120, v124
    v_add_f32 v121, v121, v125
    v_add_f32 v122, v122, v126
    v_add_f32 v123, v123, v127
    s_nop 0
    v_permlane16_swap_b32 v120, v122
    v_permlane16_swap_b32 v121, v123
    v_add_f32 v120, v120, v122
    v_add_f32 v121, v121, v123
    s_nop 0
    v_add_f32 v120, v120, v120 row_ror:8 row_mask:0xf bank_mask:0xf
    v_add_f32 v121, v121, v121 row_ror:8 row_mask:0xf bank_mask:0xf
    v_and_b32 v2, 8, v1
    v_cmp_eq_u32 vcc, 0, v2
    s_nop 1
    v_cndmask_b32 v120, v121, v120, vcc
    buffer_store_dword v120, v253, s[48:51], s84 offen sc1
    s_lshr_b32 s3, s71, 3
    s_add_u32 s3, s3, 3
    s_and_b32 s28, s3, 7
    s_lshr_b32 s3, s3, 3
    s_lshl_b32 s3, s3, 6
    s_add_u32 s3, s3, s28
    s_lshl_b32 s3, s3, 11
    buffer_load_dwordx4 v[204:207], v22, s[56:59], s3 offen nt
    s_lshr_b32 s3, s71, 3
    s_add_u32 s3, s3, 4
    s_and_b32 s28, s3, 7
    s_lshr_b32 s3, s3, 3
    s_lshl_b32 s3, s3, 6
    s_add_u32 s3, s3, s28
    s_lshl_b32 s3, s3, 11
    buffer_load_dwordx4 v[208:211], v22, s[56:59], s3 offen nt
    s_lshr_b32 s3, s71, 3
    s_add_u32 s3, s3, 5
    s_and_b32 s28, s3, 7
    s_lshr_b32 s3, s3, 3
    s_lshl_b32 s3, s3, 6
    s_add_u32 s3, s3, s28
    s_lshl_b32 s3, s3, 11
    buffer_load_dwordx4 v[212:215], v22, s[56:59], s3 offen nt
    s_lshr_b32 s3, s71, 3
    s_add_u32 s3, s3, 6
    s_and_b32 s28, s3, 7
    s_lshr_b32 s3, s3, 3
    s_lshl_b32 s3, s3, 6
    s_add_u32 s3, s3, s28
    s_lshl_b32 s3, s3, 11
    buffer_load_dwordx4 v[216:219], v22, s[56:59], s3 offen nt
    s_waitcnt vmcnt(5)
    s_cmp_eq_u32 s83, 0
    s_cbranch_scc1 L_hz
    s_mov_b32 s29, 0
L_k4:
    v_max3_u32 v2, v48, v49, v50
    v_max3_u32 v2, v2, v51, v52
    v_max3_u32 v2, v2, v53, v54
    v_max_u32 v2, v2, v55
    v_cmp_eq_u32 vcc, -1, v2
    s_cbranch_vccz L_k4k
    s_add_u32 s29, s29, 1
    s_cmp_ge_u32 s29, 200000
    s_cbranch_scc1 L_k4k
    s_sleep 1
    s_add_u32 s3, s76, 0
    buffer_load_dwordx4 v[48:51], v112, s[48:51], s3 offen sc1
    s_add_u32 s3, s76, 33792
    buffer_load_dwordx4 v[52:55], v112, s[48:51], s3 offen sc1
    s_waitcnt vmcnt(0)
    s_branch L_k4
L_k4k:
    v_lshlrev_b32 v64, 16, v48
    v_and_b32 v65, 0xffff0000, v48
    v_lshlrev_b32 v66, 16, v49
    v_and_b32 v67, 0xffff0000, v49
    v_lshlrev_b32 v68, 16, v50
    v_and_b32 v69, 0xffff0000, v50
    v_lshlrev_b32 v70, 16, v51
    v_and_b32 v71, 0xffff0000, v51
    v_lshlrev_b32 v72, 16, v52
    v_and_b32 v73, 0xffff0000, v52
    v_pk_add_f32 v[64:65], v[64:65], v[72:73]
    v_lshlrev_b32_e64 v74, 16, v53
    v_and_b32 v75, 0xffff0000, v53
    v_pk_add_f32 v[66:67], v[66:67], v[74:75]
    v_lshlrev_b32_e64 v76, 16, v54
    v_and_b32 v77, 0xffff0000, v54
    v_pk_add_f32 v[68:69], v[68:69], v[76:77]
    v_lshlrev_b32_e64 v78, 16, v55
    v_and_b32 v79, 0xffff0000, v55
    v_pk_add_f32 v[70:71], v[70:71], v[78:79]
    v_permlane32_swap_b32 v64, v68
    v_permlane32_swap_b32 v65, v69
    v_permlane32_swap_b32 v66, v70
    v_permlane32_swap_b32 v67, v71
    v_add_f32 v64, v64, v68
    v_add_f32 v65, v65, v69
    v_add_f32 v66, v66, v70
    v_add_f32 v67, v67, v71
    s_nop 0
    v_permlane16_swap_b32 v64, v66
    v_permlane16_swap_b32 v65, v67
    v_add_f32 v64, v64, v66
    v_add_f32 v65, v65, v67
    s_nop 0
    v_add_f32 v64, v64, v64 row_ror:8 row_mask:0xf bank_mask:0xf
    v_add_f32 v65, v65, v65 row_ror:8 row_mask:0xf bank_mask:0xf
    v_cvt_pk_bf16_f32 v64, v64, v65
    v_mov_b32 v65, v64
    s_nop 1
    v_permlane16_swap_b32 v64, v65
    v_mov_b32 v66, v64
    v_mov_b32 v67, v65
    s_nop 0
    v_permlane32_swap_b32 v64, v66
    v_permlane32_swap_b32 v65, v67
    s_mov_b64 exec, 0xff
    buffer_store_dwordx4 v[64:67], v252, s[48:51], s74 offen sc1
    s_branch L_h1e
L_hz:
    s_mov_b32 s29, 0
L_k3:
    v_max3_u32 v2, v48, v49, v50
    v_max3_u32 v2, v2, v51, v52
    v_max3_u32 v2, v2, v53, v54
    v_max3_u32 v2, v2, v55, v32
    v_max3_u32 v2, v2, v33, v34
    v_max3_u32 v2, v2, v35, v36
    v_max3_u32 v2, v2, v37, v38
    v_max_u32 v2, v2, v39
    v_cmp_eq_u32 vcc, -1, v2
    s_cbranch_vccz L_k3k
    s_add_u32 s29, s29, 1
    s_cmp_ge_u32 s29, 200000
    s_cbranch_scc1 L_k3k
    s_sleep 1
    s_add_u32 s3, s76, 0
    buffer_load_dwordx4 v[48:51], v112, s[48:51], s3 offen sc1
    s_add_u32 s3, s76, 33792
    buffer_load_dwordx4 v[52:55], v112, s[48:51], s3 offen sc1
    s_add_u32 s3, s81, 0
    buffer_load_dwordx4 v[32:35], v112, s[48:51], s3 offen sc1
    s_add_u32 s3, s81, 33792
    buffer_load_dwordx4 v[36:39], v112, s[48:51], s3 offen sc1
    s_waitcnt vmcnt(0)
    s_branch L_k3
L_k3k:
    v_lshlrev_b32 v64, 16, v48
    v_lshlrev_b32 v96, 16, v32
    v_and_b32 v65, 0xffff0000, v48
    v_and_b32 v97, 0xffff0000, v32
    v_lshlrev_b32 v66, 16, v49
    v_lshlrev_b32 v98, 16, v33
    v_and_b32 v67, 0xffff0000, v49
    v_and_b32 v99, 0xffff0000, v33
    v_lshlrev_b32 v68, 16, v50
    v_lshlrev_b32 v100, 16, v34
    v_and_b32 v69, 0xffff0000, v50
    v_and_b32 v101, 0xffff0000, v34
    v_lshlrev_b32 v70, 16, v51
    v_lshlrev_b32 v102, 16, v35
    v_and_b32 v71, 0xffff0000, v51
    v_and_b32 v103, 0xffff0000, v35
    v_lshlrev_b32 v72, 16, v52
    v_lshlrev_b32 v104, 16, v36
    v_and_b32 v73, 0xffff0000, v52
    v_and_b32 v105, 0xffff0000, v36
    v_pk_add_f32 v[64:65], v[64:65], v[72:73]
    v_pk_add_f32 v[96:97], v[96:97], v[104:105]
    v_lshlrev_b32 v74, 16, v53
    v_lshlrev_b32 v106, 16, v37
    v_and_b32 v75, 0xffff0000, v53
    v_and_b32 v107, 0xffff0000, v37
    v_pk_add_f32 v[66:67], v[66:67], v[74:75]
    v_pk_add_f32 v[98:99], v[98:99], v[106:107]
    v_lshlrev_b32 v76, 16, v54
    v_lshlrev_b32 v108, 16, v38
    v_and_b32 v77, 0xffff0000, v54
    v_and_b32 v109, 0xffff0000, v38
    v_pk_add_f32 v[68:69], v[68:69], v[76:77]
    v_pk_add_f32 v[100:101], v[100:101], v[108:109]
    v_lshlrev_b32 v78, 16, v55
    v_lshlrev_b32 v110, 16, v39
    v_and_b32 v79, 0xffff0000, v55
    v_and_b32 v111, 0xffff0000, v39
    v_pk_add_f32 v[70:71], v[70:71], v[78:79]
    v_pk_add_f32 v[102:103], v[102:103], v[110:111]
    v_permlane32_swap_b32 v64, v68
    v_permlane32_swap_b32 v96, v100
    v_permlane32_swap_b32 v65, v69
    v_permlane32_swap_b32 v97, v101
    v_permlane32_swap_b32 v66, v70
    v_permlane32_swap_b32 v98, v102
    v_permlane32_swap_b32 v67, v71
    v_permlane32_swap_b32 v99, v103
    v_add_f32 v64, v64, v68
    v_add_f32 v96, v96, v100
    v_add_f32 v65, v65, v69
    v_add_f32 v97, v97, v101
    v_add_f32 v66, v66, v70
    v_add_f32 v98, v98, v102
    v_add_f32 v67, v67, v71
    v_add_f32 v99, v99, v103
    v_permlane16_swap_b32 v64, v66
    v_permlane16_swap_b32 v96, v98
    v_permlane16_swap_b32 v65, v67
    v_permlane16_swap_b32 v97, v99
    v_add_f32 v64, v64, v66
    v_add_f32 v96, v96, v98
    v_add_f32 v65, v65, v67
    v_add_f32 v97, v97, v99
    v_add_f32 v64, v64, v64 row_ror:8 row_mask:0xf bank_mask:0xf
    v_add_f32 v96, v96, v96 row_ror:8 row_mask:0xf bank_mask:0xf
    v_add_f32 v65, v65, v65 row_ror:8 row_mask:0xf bank_mask:0xf
    v_add_f32 v97, v97, v97 row_ror:8 row_mask:0xf bank_mask:0xf
    v_cvt_pk_bf16_f32 v64, v64, v65
    v_cvt_pk_bf16_f32 v96, v96, v97
    v_mov_b32 v65, v64
    v_mov_b32 v97, v96
    s_nop 0
    v_permlane16_swap_b32 v64, v65
    v_permlane16_swap_b32 v96, v97
    v_mov_b32 v66, v64
    v_mov_b32 v98, v96
    v_mov_b32 v67, v65
    v_mov_b32 v99, v97
    v_permlane32_swap_b32 v64, v66
    v_permlane32_swap_b32 v96, v98
    v_permlane32_swap_b32 v65, v67
    v_permlane32_swap_b32_e64 v97, v99
    s_mov_b64 exec, 0xff
    buffer_store_dwordx4 v[64:67], v252, s[48:51], s74 offen sc1
    buffer_store_dwordx4 v[96:99], v252, s[48:51], s82 offen sc1
L_h1e:
    s_mov_b64 exec, -1
    s_lshl_b32 s3, s38, 2
    s_add_u32 s3, s3, 162112
    v_mov_b32 v4, s3
    v_mov_b32 v5, 3
    ds_write_b32 v4, v5
    s_setprio 0
    v_and_b32 v2, 15, v1
    v_add_u32 v2, s69, v2
    v_lshlrev_b32 v2, 2, v2
    v_add_u32 v2, 152064, v2
    ds_read_b32 v9, v2
    ds_read_b32 v8, v2 offset:1024
    s_waitcnt lgkmcnt(0)
    v_mul_f32 v28, v9, v8
    v_mov_b32 v30, 0xbfb8aa3b
    v_lshlrev_b32 v224, 16, v240
    v_and_b32 v225, 0xffff0000, v240
    v_lshlrev_b32 v226, 16, v241
    v_and_b32 v227, 0xffff0000, v241
    v_lshlrev_b32 v228, 16, v242
    v_and_b32 v229, 0xffff0000, v242
    v_lshlrev_b32 v230, 16, v243
    v_and_b32 v231, 0xffff0000, v243
    v_lshlrev_b32 v232, 16, v244
    v_and_b32 v233, 0xffff0000, v244
    v_lshlrev_b32 v234, 16, v245
    v_and_b32 v235, 0xffff0000, v245
    v_lshlrev_b32 v236, 16, v246
    v_and_b32 v237, 0xffff0000, v246
    v_lshlrev_b32 v238, 16, v247
    v_and_b32 v239, 0xffff0000, v247
    v_pk_fma_f32 v[224:225], v[224:225], v[8:9], v[28:29] op_sel_hi:[1,0,0] neg_lo:[0,0,1] neg_hi:[0,0,1]
    v_pk_fma_f32 v[226:227], v[226:227], v[8:9], v[28:29] op_sel_hi:[1,0,0] neg_lo:[0,0,1] neg_hi:[0,0,1]
    v_pk_fma_f32 v[228:229], v[228:229], v[8:9], v[28:29] op_sel_hi:[1,0,0] neg_lo:[0,0,1] neg_hi:[0,0,1]
    v_pk_fma_f32 v[230:231], v[230:231], v[8:9], v[28:29] op_sel_hi:[1,0,0] neg_lo:[0,0,1] neg_hi:[0,0,1]
    v_pk_fma_f32 v[232:233], v[232:233], v[8:9], v[28:29] op_sel_hi:[1,0,0] neg_lo:[0,0,1] neg_hi:[0,0,1]
    v_pk_fma_f32 v[234:235], v[234:235], v[8:9], v[28:29] op_sel_hi:[1,0,0] neg_lo:[0,0,1] neg_hi:[0,0,1]
    v_pk_fma_f32 v[236:237], v[236:237], v[8:9], v[28:29] op_sel_hi:[1,0,0] neg_lo:[0,0,1] neg_hi:[0,0,1]
    v_pk_fma_f32 v[238:239], v[238:239], v[8:9], v[28:29] op_sel_hi:[1,0,0] neg_lo:[0,0,1] neg_hi:[0,0,1]
    v_pk_mul_f32 v[32:33], v[224:225], v[30:31] op_sel_hi:[1,0]
    v_pk_mul_f32 v[34:35], v[226:227], v[30:31] op_sel_hi:[1,0]
    v_pk_mul_f32 v[36:37], v[228:229], v[30:31] op_sel_hi:[1,0]
    v_pk_mul_f32 v[38:39], v[230:231], v[30:31] op_sel_hi:[1,0]
    v_pk_mul_f32 v[40:41], v[232:233], v[30:31] op_sel_hi:[1,0]
    v_pk_mul_f32 v[42:43], v[234:235], v[30:31] op_sel_hi:[1,0]
    v_pk_mul_f32 v[44:45], v[236:237], v[30:31] op_sel_hi:[1,0]
    v_pk_mul_f32 v[46:47], v[238:239], v[30:31] op_sel_hi:[1,0]
    v_exp_f32 v32, v32
    v_exp_f32 v33, v33
    v_exp_f32 v34, v34
    v_exp_f32 v35, v35
    v_exp_f32 v36, v36
    v_exp_f32 v37, v37
    v_exp_f32 v38, v38
    v_exp_f32 v39, v39
    v_exp_f32 v40, v40
    v_exp_f32 v41, v41
    v_exp_f32 v42, v42
    v_exp_f32 v43, v43
    v_exp_f32 v44, v44
    v_exp_f32 v45, v45
    v_exp_f32 v46, v46
    v_exp_f32 v47, v47
    v_pk_add_f32 v[32:33], v[32:33], 1.0 op_sel_hi:[1,0]
    v_pk_add_f32 v[34:35], v[34:35], 1.0 op_sel_hi:[1,0]
    v_pk_add_f32 v[36:37], v[36:37], 1.0 op_sel_hi:[1,0]
    v_pk_add_f32 v[38:39], v[38:39], 1.0 op_sel_hi:[1,0]
    v_pk_add_f32 v[40:41], v[40:41], 1.0 op_sel_hi:[1,0]
    v_pk_add_f32 v[42:43], v[42:43], 1.0 op_sel_hi:[1,0]
    v_pk_add_f32 v[44:45], v[44:45], 1.0 op_sel_hi:[1,0]
    v_pk_add_f32 v[46:47], v[46:47], 1.0 op_sel_hi:[1,0]
    v_rcp_f32 v32, v32
    v_rcp_f32 v33, v33
    v_rcp_f32 v34, v34
    v_rcp_f32 v35, v35
    v_rcp_f32 v36, v36
    v_rcp_f32 v37, v37
    v_rcp_f32 v38, v38
    v_rcp_f32 v39, v39
    v_rcp_f32 v40, v40
    v_rcp_f32 v41, v41
    v_rcp_f32 v42, v42
    v_rcp_f32 v43, v43
    v_rcp_f32 v44, v44
    v_rcp_f32 v45, v45
    v_rcp_f32 v46, v46
    v_rcp_f32 v47, v47
    v_pk_mul_f32 v[224:225], v[224:225], v[32:33]
    v_pk_mul_f32 v[226:227], v[226:227], v[34:35]
    v_pk_mul_f32 v[228:229], v[228:229], v[36:37]
    v_pk_mul_f32 v[230:231], v[230:231], v[38:39]
    v_pk_mul_f32 v[232:233], v[232:233], v[40:41]
    v_pk_mul_f32 v[234:235], v[234:235], v[42:43]
    v_pk_mul_f32 v[236:237], v[236:237], v[44:45]
    v_pk_mul_f32 v[238:239], v[238:239], v[46:47]
    s_add_u32 s3, s75, 0
    s_nop 0
    buffer_load_dwordx4 v[80:83], v13, s[48:51], s3 offen sc1
    s_add_u32 s3, s75, 57344
    buffer_load_dwordx4 v[84:87], v13, s[48:51], s3 offen sc1
    s_add_u32 s3, s75, 114688
    buffer_load_dwordx4 v[88:91], v13, s[48:51], s3 offen sc1
    s_add_u32 s3, s75, 172032
    buffer_load_dwordx4 v[92:95], v13, s[48:51], s3 offen sc1
    s_waitcnt vmcnt(0)
    s_mov_b32 s29, 0
L_k5:
    v_max3_u32 v2, v80, v81, v82
    v_max3_u32 v2, v2, v83, v84
    v_max3_u32 v2, v2, v85, v86
    v_max3_u32 v2, v2, v87, v88
    v_max3_u32 v2, v2, v89, v90
    v_max3_u32 v2, v2, v91, v92
    v_max3_u32 v2, v2, v93, v94
    v_max_u32 v2, v2, v95
    v_cmp_eq_u32 vcc, -1, v2
    s_cbranch_vccz L_k5k
    s_add_u32 s29, s29, 1
    s_cmp_ge_u32 s29, 200000
    s_cbranch_scc1 L_k5k
    s_sleep 1
    s_add_u32 s3, s75, 0
    s_nop 0
    buffer_load_dwordx4 v[80:83], v13, s[48:51], s3 offen sc1
    s_add_u32 s3, s75, 57344
    buffer_load_dwordx4 v[84:87], v13, s[48:51], s3 offen sc1
    s_add_u32 s3, s75, 114688
    buffer_load_dwordx4 v[88:91], v13, s[48:51], s3 offen sc1
    s_add_u32 s3, s75, 172032
    buffer_load_dwordx4 v[92:95], v13, s[48:51], s3 offen sc1
    s_waitcnt vmcnt(0)
    s_branch L_k5
L_k5k:
    v_pk_add_f32 v[80:81], v[80:81], v[84:85]
    v_pk_add_f32 v[82:83], v[82:83], v[86:87]
    v_pk_add_f32 v[88:89], v[88:89], v[92:93]
    v_pk_add_f32 v[90:91], v[90:91], v[94:95]
    s_nop 0
    v_permlane32_swap_b32 v80, v88
    v_permlane32_swap_b32 v81, v89
    v_permlane32_swap_b32 v82, v90
    v_permlane32_swap_b32 v83, v91
    v_add_f32 v80, v80, v88
    v_add_f32 v81, v81, v89
    v_add_f32 v82, v82, v90
    v_add_f32 v83, v83, v91
    v_permlane16_swap_b32 v80, v81
    s_nop 0
    v_permlane16_swap_b32 v82, v83
    v_add_f32 v80, v80, v81
    v_add_f32 v82, v82, v83
    s_nop 1
    v_permlane32_swap_b32 v80, v82
    v_cvt_pk_bf16_f32 v80, v80, v80
    v_lshlrev_b32 v80, 16, v80
    v_cvt_pk_bf16_f32 v82, v82, v82
    v_lshlrev_b32 v82, 16, v82
    v_mul_f32 v2, 0xbfb8aa3b, v80
    v_exp_f32 v2, v2
    s_nop 0
    v_add_f32 v2, 1.0, v2
    v_rcp_f32 v2, v2
    s_nop 0
    v_mul_f32 v80, v80, v2
    v_cvt_pk_bf16_f32 v80, v80, v80
    v_lshlrev_b32 v80, 16, v80
    v_mul_f32 v80, v80, v82
    v_cvt_pk_bf16_f32 v80, v80, v80
    v_lshlrev_b32 v80, 16, v80
    v_bfe_u32 v2, v1, 3, 2
    v_lshlrev_b32 v2, 6, v2
    v_lshrrev_b32_e64 v3, 5, v1
    v_lshl_add_u32 v2, v3, 2, v2
    ds_bpermute_b32 v128, v2, v80 offset:0
    ds_bpermute_b32 v130, v2, v80 offset:8
    ds_bpermute_b32 v132, v2, v80 offset:16
    ds_bpermute_b32 v134, v2, v80 offset:24
    ds_bpermute_b32 v136, v2, v80 offset:32
    ds_bpermute_b32 v138, v2, v80 offset:40
    ds_bpermute_b32 v140, v2, v80 offset:48
    v_mov_b64 v[120:121], 0
    v_mov_b64 v[122:123], 0
    v_mov_b64 v[124:125], 0
    v_mov_b64 v[126:127], 0
    s_waitcnt lgkmcnt(0)
    v_lshlrev_b32 v2, 16, v192
    v_and_b32 v3, 0xffff0000, v192
    v_pk_fma_f32 v[120:121], v[2:3], v[128:129], v[120:121] op_sel_hi:[1,0,1]
    v_lshlrev_b32_e64 v4, 16, v193
    v_and_b32 v5, 0xffff0000, v193
    v_pk_fma_f32 v[122:123], v[4:5], v[128:129], v[122:123] op_sel_hi:[1,0,1]
    v_lshlrev_b32_e64 v2, 16, v194
    v_and_b32 v3, 0xffff0000, v194
    v_pk_fma_f32 v[124:125], v[2:3], v[128:129], v[124:125] op_sel_hi:[1,0,1]
    v_lshlrev_b32_e64 v4, 16, v195
    v_and_b32 v5, 0xffff0000, v195
    v_pk_fma_f32 v[126:127], v[4:5], v[128:129], v[126:127] op_sel_hi:[1,0,1]
    v_lshlrev_b32_e64 v2, 16, v196
    v_and_b32 v3, 0xffff0000, v196
    v_pk_fma_f32 v[120:121], v[2:3], v[130:131], v[120:121] op_sel_hi:[1,0,1]
    v_lshlrev_b32_e64 v4, 16, v197
    v_and_b32 v5, 0xffff0000, v197
    v_pk_fma_f32 v[122:123], v[4:5], v[130:131], v[122:123] op_sel_hi:[1,0,1]
    v_lshlrev_b32_e64 v2, 16, v198
    v_and_b32 v3, 0xffff0000, v198
    v_pk_fma_f32 v[124:125], v[2:3], v[130:131], v[124:125] op_sel_hi:[1,0,1]
    v_lshlrev_b32_e64 v4, 16, v199
    v_and_b32 v5, 0xffff0000, v199
    v_pk_fma_f32 v[126:127], v[4:5], v[130:131], v[126:127] op_sel_hi:[1,0,1]
    v_lshlrev_b32_e64 v2, 16, v200
    v_and_b32 v3, 0xffff0000, v200
    v_pk_fma_f32 v[120:121], v[2:3], v[132:133], v[120:121] op_sel_hi:[1,0,1]
    v_lshlrev_b32_e64 v4, 16, v201
    v_and_b32 v5, 0xffff0000, v201
    v_pk_fma_f32 v[122:123], v[4:5], v[132:133], v[122:123] op_sel_hi:[1,0,1]
    v_lshlrev_b32_e64 v2, 16, v202
    v_and_b32 v3, 0xffff0000, v202
    v_pk_fma_f32 v[124:125], v[2:3], v[132:133], v[124:125] op_sel_hi:[1,0,1]
    v_lshlrev_b32_e64 v4, 16, v203
    v_and_b32 v5, 0xffff0000, v203
    v_pk_fma_f32 v[126:127], v[4:5], v[132:133], v[126:127] op_sel_hi:[1,0,1]
    v_lshlrev_b32_e64 v2, 16, v204
    v_and_b32 v3, 0xffff0000, v204
    v_pk_fma_f32 v[120:121], v[2:3], v[134:135], v[120:121] op_sel_hi:[1,0,1]
    v_lshlrev_b32_e64 v4, 16, v205
    v_and_b32 v5, 0xffff0000, v205
    v_pk_fma_f32 v[122:123], v[4:5], v[134:135], v[122:123] op_sel_hi:[1,0,1]
    v_lshlrev_b32_e64 v2, 16, v206
    v_and_b32 v3, 0xffff0000, v206
    v_pk_fma_f32 v[124:125], v[2:3], v[134:135], v[124:125] op_sel_hi:[1,0,1]
    v_lshlrev_b32_e64 v4, 16, v207
    v_and_b32 v5, 0xffff0000, v207
    v_pk_fma_f32 v[126:127], v[4:5], v[134:135], v[126:127] op_sel_hi:[1,0,1]
    v_lshlrev_b32_e64 v2, 16, v208
    v_and_b32 v3, 0xffff0000, v208
    v_pk_fma_f32 v[120:121], v[2:3], v[136:137], v[120:121] op_sel_hi:[1,0,1]
    v_lshlrev_b32_e64 v4, 16, v209
    v_and_b32 v5, 0xffff0000, v209
    v_pk_fma_f32 v[122:123], v[4:5], v[136:137], v[122:123] op_sel_hi:[1,0,1]
    v_lshlrev_b32_e64 v2, 16, v210
    v_and_b32 v3, 0xffff0000, v210
    v_pk_fma_f32 v[124:125], v[2:3], v[136:137], v[124:125] op_sel_hi:[1,0,1]
    v_lshlrev_b32_e64 v4, 16, v211
    v_and_b32 v5, 0xffff0000, v211
    v_pk_fma_f32 v[126:127], v[4:5], v[136:137], v[126:127] op_sel_hi:[1,0,1]
    v_lshlrev_b32_e64 v2, 16, v212
    v_and_b32 v3, 0xffff0000, v212
    v_pk_fma_f32 v[120:121], v[2:3], v[138:139], v[120:121] op_sel_hi:[1,0,1]
    v_lshlrev_b32_e64 v4, 16, v213
    v_and_b32 v5, 0xffff0000, v213
    v_pk_fma_f32 v[122:123], v[4:5], v[138:139], v[122:123] op_sel_hi:[1,0,1]
    v_lshlrev_b32_e64 v2, 16, v214
    v_and_b32 v3, 0xffff0000, v214
    v_pk_fma_f32 v[124:125], v[2:3], v[138:139], v[124:125] op_sel_hi:[1,0,1]
    v_lshlrev_b32_e64 v4, 16, v215
    v_and_b32 v5, 0xffff0000, v215
    v_pk_fma_f32 v[126:127], v[4:5], v[138:139], v[126:127] op_sel_hi:[1,0,1]
    v_lshlrev_b32_e64 v2, 16, v216
    v_and_b32 v3, 0xffff0000, v216
    v_pk_fma_f32 v[120:121], v[2:3], v[140:141], v[120:121] op_sel_hi:[1,0,1]
    v_lshlrev_b32_e64 v4, 16, v217
    v_and_b32 v5, 0xffff0000, v217
    v_pk_fma_f32 v[122:123], v[4:5], v[140:141], v[122:123] op_sel_hi:[1,0,1]
    v_lshlrev_b32_e64 v2, 16, v218
    v_and_b32 v3, 0xffff0000, v218
    v_pk_fma_f32 v[124:125], v[2:3], v[140:141], v[124:125] op_sel_hi:[1,0,1]
    v_lshlrev_b32_e64 v4, 16, v219
    v_and_b32 v5, 0xffff0000, v219
    v_pk_fma_f32 v[126:127], v[4:5], v[140:141], v[126:127] op_sel_hi:[1,0,1]
    v_permlane32_swap_b32 v120, v124
    v_permlane32_swap_b32 v121, v125
    v_permlane32_swap_b32 v122, v126
    v_permlane32_swap_b32 v123, v127
    v_add_f32 v120, v120, v124
    v_add_f32 v121, v121, v125
    v_add_f32 v122, v122, v126
    v_add_f32 v123, v123, v127
    s_nop 0
    v_permlane16_swap_b32 v120, v122
    v_permlane16_swap_b32 v121, v123
    v_add_f32 v120, v120, v122
    v_add_f32 v121, v121, v123
    s_nop 0
    v_add_f32 v120, v120, v120 row_ror:8 row_mask:0xf bank_mask:0xf
    v_add_f32 v121, v121, v121 row_ror:8 row_mask:0xf bank_mask:0xf
    v_and_b32 v2, 8, v1
    v_cmp_eq_u32 vcc, 0, v2
    s_and_b32 s3, s2, 15
    s_lshl_b32 s3, s3, 4
    s_lshr_b32 s28, s2, 4
    s_add_u32 s3, s3, s28
    s_lshl_b32 s3, s3, 2
    s_add_u32 s3, s3, s38
    s_lshl_b32 s3, s3, 8
    s_add_u32 s3, s3, 1413120
    v_cndmask_b32 v120, v121, v120, vcc
    buffer_store_dword v120, v253, s[48:51], s3 offen sc1
    v_and_b32 v3, 3, v1
    v_lshlrev_b32 v3, 2, v3
    v_add_u32 v3, 162112, v3
L_ow:
    ds_read_b32 v2, v3
    s_waitcnt lgkmcnt(0)
    v_cmp_ne_u32 vcc, 7, v2
    s_cbranch_vccz L_owk
    s_sleep 1
    s_branch L_ow
L_owk:
    s_branch L_p3
L_C:
    s_and_b32 s64, s38, 1
    s_lshr_b32 s65, s38, 1
    v_and_b32 v3, 15, v1
    v_lshlrev_b32 v3, 7, v3
    s_lshl_b32 s3, s64, 13
    v_add_u32 v3, s3, v3
    v_bfe_u32 v5, v1, 1, 3
    v_lshrrev_b32 v6, 4, v1
    v_xor_b32 v6, v6, v5
    v_lshl_add_u32 v184, v6, 4, v3
    v_xor_b32 v185, 64, v184
    v_lshrrev_b32 v6, 4, v1
    v_lshlrev_b32 v6, 3, v6
    v_bfe_u32 v7, v1, 2, 2
    v_add_u32 v6, v6, v7
    v_lshlrev_b32 v6, 7, v6
    v_and_b32 v7, 3, v1
    v_lshl_add_u32 v6, v7, 3, v6
    v_add_u32 v6, 16384, v6
    v_bfe_u32 v7, v1, 3, 2
    s_lshl_b32 s3, s65, 1
    v_xor_b32 v7, s3, v7
    v_lshl_add_u32 v186, v7, 5, v6
    v_xor_b32_e64 v187, 32, v186
    v_add_u32 v188, 81920, v184
    v_add_u32 v189, 81920, v185
    v_add_u32 v190, 81920, v186
    v_add_u32 v191, 81920, v187
    s_waitcnt lgkmcnt(0)
    s_mov_b32 s48, s26
    s_mov_b32 s49, s27
    s_mov_b32 s50, 268435456
    s_mov_b32 s51, 0x00020000
    s_mov_b32 s40, s4
    s_mov_b32 s41, s5
    s_mov_b32 s42, 4194304
    s_mov_b32 s43, 0x00020000
    s_mov_b32 s88, s10
    s_mov_b32 s89, s11
    s_mov_b32 s90, 2097152
    s_mov_b32 s91, 0x00020000
    s_lshl_b32 s3, s36, 7
    s_lshl_b32 s28, s37, 3
    s_add_u32 s3, s3, s28
    s_lshl_b32 s28, s38, 1
    s_add_u32 s71, s3, s28
    v_lshlrev_b32 v2, 4, v1
    v_mov_b32 v212, 16384
    v_mov_b32 v4, -1
    v_mov_b32 v5, -1
    v_mov_b32 v6, -1
    v_mov_b32_e64 v7, -1
    s_lshl_b32 s28, s2, 2
    s_add_u32 s28, s28, s38
    s_mul_i32 s28, s28, 768
    s_add_u32 s28, s28, 1048320
    s_lshl_b32 s3, s37, 4
    s_add_u32 s3, s3, s36
    s_lshl_b32 s3, s3, 2
    s_add_u32 s3, s3, s38
    s_lshl_b32 s3, s3, 8
    s_add_u32 s3, s3, 524288
    v_cmp_gt_u32 vcc, 16, v1
    v_add_u32 v3, s3, v2
    v_add_u32_e64 v2, s28, v2
    v_cndmask_b32 v2, v2, v3, vcc
    buffer_store_dwordx4 v[4:7], v2, s[48:51], 0 offen sc1
    buffer_load_dword v212, v212, s[48:51], 0 offen sc1
    s_getpc_b64 s[92:93]
L_pc:
    s_sub_u32 s92, s92, L_pc-recurrent_scan__linear_kernel_hedgehog__moe_arch_mod__prompt_kernel
    s_subb_u32 s93, s93, 0
    s_lshr_b32 s3, s2, 3
    s_lshl_b32 s3, s3, 2
    s_add_u32 s3, s3, s38
    s_lshl_b32 s3, s3, 8
    v_lshlrev_b32 v2, 7, v1
    v_add_u32 v2, s3, v2
    s_mov_b64 exec, 3
    global_load_dword v213, v2, s[92:93]
    s_mov_b64 exec, -1
    v_mov_b64 v[8:9], 0
    v_mov_b64 v[10:11], 0
    v_mov_b64 v[12:13], 0
    v_mov_b64 v[14:15], 0
    v_mov_b64 v[16:17], 0
    v_mov_b64 v[18:19], 0
    v_mov_b64 v[20:21], 0
    v_mov_b64 v[22:23], 0
    v_mov_b64 v[24:25], 0
    v_mov_b64 v[26:27], 0
    v_mov_b64 v[28:29], 0
    v_mov_b64 v[30:31], 0
    v_mov_b64 v[32:33], 0
    v_mov_b64 v[34:35], 0
    v_mov_b64 v[36:37], 0
    v_mov_b64 v[38:39], 0
    v_mov_b64 v[40:41], 0
    v_mov_b64 v[42:43], 0
    v_mov_b64 v[44:45], 0
    v_mov_b64 v[46:47], 0
    v_mov_b64 v[48:49], 0
    v_mov_b64 v[50:51], 0
    v_mov_b64 v[52:53], 0
    v_mov_b64 v[54:55], 0
    v_mov_b64 v[56:57], 0
    v_mov_b64 v[58:59], 0
    v_mov_b64 v[60:61], 0
    v_mov_b64 v[62:63], 0
    v_mov_b64 v[64:65], 0
    v_mov_b64 v[66:67], 0
    v_mov_b64 v[68:69], 0
    v_mov_b64 v[70:71], 0
    v_mov_b64 v[72:73], 0
    v_mov_b64 v[74:75], 0
    v_mov_b64 v[76:77], 0
    v_mov_b64 v[78:79], 0
    v_mov_b64 v[80:81], 0
    v_mov_b64 v[82:83], 0
    v_mov_b64 v[84:85], 0
    v_mov_b64 v[86:87], 0
    v_mov_b64 v[88:89], 0
    v_mov_b64 v[90:91], 0
    v_mov_b64 v[92:93], 0
    v_mov_b64 v[94:95], 0
    v_mov_b64 v[96:97], 0
    v_mov_b64 v[98:99], 0
    v_mov_b64 v[100:101], 0
    v_mov_b64 v[102:103], 0
    s_lshl_b32 s3, s38, 2
    s_add_u32 s3, s3, 162112
    v_mov_b32 v2, s3
    v_mov_b32_e64 v3, 0
    ds_write_b32 v2, v3
    ds_write_b32 v2, v3 offset:16
    s_mov_b32 s86, 0
    s_mov_b32 s66, 0
    s_setprio 2
    s_waitcnt lgkmcnt(0)
    s_lshl_b32 s3, s38, 1
    s_lshr_b32 s28, s39, 2
    s_add_u32 s3, s3, s28
    s_lshl_b32 s69, s3, 4
    v_and_b32 v237, 15, v1
    v_add_u32 v236, s69, v237
    v_lshlrev_b32 v236, 7, v236
    v_lshrrev_b32 v237, 1, v237
    v_lshrrev_b32 v238, 5, v1
    v_xor_b32 v237, v237, v238
    v_lshl_add_u32 v236, v237, 4, v236
    v_bfe_u32 v238, v1, 4, 1
    v_lshl_add_u32 v236, v238, 3, v236
    v_xor_b32 v237, 32, v236
    v_xor_b32 v238, 64, v236
    v_xor_b32 v239, 96, v236
    v_and_b32 v2, 15, v1
    v_lshrrev_b32_e64 v3, 4, v1
    s_lshl_b32 s3, s64, 8
    s_add_u32 s3, s3, 152064
    v_lshl_add_u32 v232, v2, 2, s3
    v_lshl_add_u32 v233, v3, 4, s3
    v_lshrrev_b32 v7, 5, v1
    v_lshl_add_u32 v234, v7, 6, v232
    s_lshl_b32 s3, s65, 7
    s_add_u32 s3, s3, 154880
    v_lshl_add_u32 v235, v3, 4, s3
    v_lshl_add_u32 v248, v2, 2, s3
    s_lshl_b32 s3, s64, 7
    s_add_u32 s3, s3, 154624
    v_lshl_add_u32 v249, v3, 4, s3
    v_xor_b32 v253, 128, v249
    v_lshrrev_b32 v250, 2, v1
    v_lshlrev_b32 v250, 6, v250
    v_and_b32 v251, 3, v1
    v_lshl_add_u32 v250, v251, 3, v250
    s_lshl_b32 s3, s65, 11
    s_add_u32 s3, s3, 147712
    v_add_u32 v252, s3, v250
    v_bfe_u32 v5, v1, 1, 2
    v_lshlrev_b32_e64 v5, 2, v5
    v_bfe_u32 v4, v1, 3, 1
    v_lshl_add_u32 v5, v4, 1, v5
    v_and_b32 v4, 1, v1
    v_add_u32 v5, v5, v4
    v_xor_b32 v5, v5, v3
    s_lshl_b32 s3, s38, 13
    s_add_u32 s3, s3, 98304
    v_lshl_add_u32 v2, v2, 7, s3
    v_lshl_add_u32 v4, v5, 3, v2
    v_xor_b32 v5, 32, v4
    v_xor_b32 v6, 64, v4
    v_xor_b32 v7, 96, v4
    v_bfe_u32 v2, v1, 3, 2
    v_lshlrev_b32 v2, 2, v2
    v_lshrrev_b32 v3, 5, v1
    v_lshl_add_u32 v2, v3, 1, v2
    v_bfe_u32 v3, v1, 2, 1
    v_add_u32 v2, v2, v3
    v_xor_b32 v2, v2, v251
    v_lshrrev_b32_e64 v3, 2, v1
    v_lshl_add_u32 v3, v3, 7, s3
    v_lshl_add_u32 v2, v2, 3, v3
    s_lshl_b32 s28, s64, 6
    v_xor_b32 v201, s28, v2
    v_xor_b32 v203, 32, v201
    s_lshl_b32 s3, s38, 12
    s_add_u32 s3, s3, 131072
    v_lshlrev_b32 v199, 4, v1
    v_add_u32 v197, s3, v199
    s_lshl_b32 s3, s37, 1
    s_add_u32 s67, s3, s65
    s_lshl_b32 s3, s67, 4
    s_add_u32 s3, s3, s36
    s_mul_i32 s3, s3, 4224
    s_add_u32 s75, s3, 8388608
    s_lshl_b32 s3, s64, 11
    s_add_u32 s74, s75, s3
    s_lshl_b32 s3, s64, 6
    s_add_u32 s75, s75, s3
    s_add_u32 s75, s75, 4096
    s_lshl_b32 s3, s37, 4
    s_add_u32 s3, s3, s36
    s_lshl_b32 s3, s3, 7
    s_add_u32 s3, s3, 32768
    s_cmp_lg_u32 s38, 0
    s_cselect_b32 s76, 268435456, s3
L_ln:
    s_lshl_b32 s3, s38, 12
    s_add_u32 s3, s3, 131072
    v_lshlrev_b32 v2, 4, v1
    v_add_u32 v3, s3, v2
    v_add_u32 v2, 122880, v2
    s_barrier
    ds_read_b128 v[120:123], v2 offset:0
    ds_read_b128 v[124:127], v2 offset:1024
    ds_read_b128 v[104:107], v3 offset:0
    ds_read_b128 v[108:111], v3 offset:1024
    ds_read_b128 v[112:115], v3 offset:2048
    ds_read_b128 v[116:119], v3 offset:3072
    v_mov_b32 v2, 0x3f803f80
    v_mov_b32 v128, 0
    v_mov_b32 v130, 0
    v_mov_b32 v132, 0
    v_mov_b32 v134, 0
    v_mov_b32 v136, 0
    v_mov_b32 v138, 0
    v_mov_b32 v140, 0
    v_mov_b32 v142, 0
    s_waitcnt lgkmcnt(2)
    v_dot2c_f32_bf16 v128, v104, v2
    v_dot2c_f32_bf16 v132, v104, v104
    v_dot2c_f32_bf16 v136, v104, v120
    v_dot2c_f32_bf16 v140, v120, v2
    v_dot2c_f32_bf16 v128, v105, v2
    v_dot2c_f32_bf16 v132, v105, v105
    v_dot2c_f32_bf16 v136, v105, v121
    v_dot2c_f32_bf16 v140, v121, v2
    v_dot2c_f32_bf16 v128, v106, v2
    v_dot2c_f32_bf16 v132, v106, v106
    v_dot2c_f32_bf16 v136, v106, v122
    v_dot2c_f32_bf16 v140, v122, v2
    v_dot2c_f32_bf16 v128, v107, v2
    v_dot2c_f32_bf16 v132, v107, v107
    v_dot2c_f32_bf16 v136, v107, v123
    v_dot2c_f32_bf16 v140, v123, v2
    v_dot2c_f32_bf16 v128, v108, v2
    v_dot2c_f32_bf16 v132, v108, v108
    v_dot2c_f32_bf16 v136, v108, v124
    v_dot2c_f32_bf16 v140, v124, v2
    v_dot2c_f32_bf16 v128, v109, v2
    v_dot2c_f32_bf16 v132, v109, v109
    v_dot2c_f32_bf16 v136, v109, v125
    v_dot2c_f32_bf16 v140, v125, v2
    v_dot2c_f32_bf16 v128, v110, v2
    v_dot2c_f32_bf16 v132, v110, v110
    v_dot2c_f32_bf16 v136, v110, v126
    v_dot2c_f32_bf16 v140, v126, v2
    v_dot2c_f32_bf16 v128, v111, v2
    v_dot2c_f32_bf16 v132, v111, v111
    v_dot2c_f32_bf16 v136, v111, v127
    v_dot2c_f32_bf16 v140, v127, v2
    s_waitcnt lgkmcnt(0)
    v_dot2c_f32_bf16 v130, v112, v2
    v_dot2c_f32_bf16 v134, v112, v112
    v_dot2c_f32_bf16 v138, v112, v120
    v_dot2c_f32_bf16 v142, v120, v2
    v_dot2c_f32_bf16 v130, v113, v2
    v_dot2c_f32_bf16 v134, v113, v113
    v_dot2c_f32_bf16 v138, v113, v121
    v_dot2c_f32_bf16 v142, v121, v2
    v_dot2c_f32_bf16 v130, v114, v2
    v_dot2c_f32_bf16 v134, v114, v114
    v_dot2c_f32_bf16 v138, v114, v122
    v_dot2c_f32_bf16 v142, v122, v2
    v_dot2c_f32_bf16 v130, v115, v2
    v_dot2c_f32_bf16 v134, v115, v115
    v_dot2c_f32_bf16 v138, v115, v123
    v_dot2c_f32_bf16 v142, v123, v2
    v_dot2c_f32_bf16 v130, v116, v2
    v_dot2c_f32_bf16 v134, v116, v116
    v_dot2c_f32_bf16 v138, v116, v124
    v_dot2c_f32_bf16 v142, v124, v2
    v_dot2c_f32_bf16 v130, v117, v2
    v_dot2c_f32_bf16 v134, v117, v117
    v_dot2c_f32_bf16 v138, v117, v125
    v_dot2c_f32_bf16 v142, v125, v2
    v_dot2c_f32_bf16 v130, v118, v2
    v_dot2c_f32_bf16 v134, v118, v118
    v_dot2c_f32_bf16 v138, v118, v126
    v_dot2c_f32_bf16 v142, v126, v2
    v_dot2c_f32_bf16 v130, v119, v2
    v_dot2c_f32_bf16 v134, v119, v119
    v_dot2c_f32_bf16 v138, v119, v127
    v_dot2c_f32_bf16 v142, v127, v2
    v_permlane32_swap_b32 v128, v130
    v_permlane32_swap_b32 v132, v134
    v_permlane32_swap_b32 v136, v138
    v_permlane32_swap_b32 v140, v142
    v_add_f32 v128, v128, v130
    v_add_f32 v132, v132, v134
    v_add_f32 v136, v136, v138
    v_add_f32 v140, v140, v142
    v_add_f32 v128, v128, v128 quad_perm:[1,0,3,2] row_mask:0xf bank_mask:0xf
    v_add_f32 v132, v132, v132 quad_perm:[1,0,3,2] row_mask:0xf bank_mask:0xf
    v_add_f32 v136, v136, v136 quad_perm:[1,0,3,2] row_mask:0xf bank_mask:0xf
    v_add_f32 v140, v140, v140 quad_perm:[1,0,3,2] row_mask:0xf bank_mask:0xf
    v_add_f32 v128, v128, v128 quad_perm:[2,3,0,1] row_mask:0xf bank_mask:0xf
    v_add_f32 v132, v132, v132 quad_perm:[2,3,0,1] row_mask:0xf bank_mask:0xf
    v_add_f32 v136, v136, v136 quad_perm:[2,3,0,1] row_mask:0xf bank_mask:0xf
    v_add_f32 v140, v140, v140 quad_perm:[2,3,0,1] row_mask:0xf bank_mask:0xf
    v_add_f32 v128, v128, v128 row_half_mirror row_mask:0xf bank_mask:0xf
    v_add_f32 v132, v132, v132 row_half_mirror row_mask:0xf bank_mask:0xf
    v_add_f32 v136, v136, v136 row_half_mirror row_mask:0xf bank_mask:0xf
    v_add_f32 v140, v140, v140 row_half_mirror row_mask:0xf bank_mask:0xf
    v_add_f32 v128, v128, v128 row_mirror row_mask:0xf bank_mask:0xf
    v_add_f32 v132, v132, v132 row_mirror row_mask:0xf bank_mask:0xf
    v_add_f32 v136, v136, v136 row_mirror row_mask:0xf bank_mask:0xf
    v_add_f32 v140, v140, v140 row_mirror row_mask:0xf bank_mask:0xf
    v_mov_b32 v129, v128
    v_mov_b32 v133, v132
    v_mov_b32 v137, v136
    v_mov_b32 v141, v140
    v_permlane16_swap_b32 v128, v129
    v_permlane16_swap_b32 v132, v133
    v_permlane16_swap_b32 v136, v137
    v_permlane16_swap_b32 v140, v141
    v_add_f32 v128, v128, v129
    v_add_f32 v132, v132, v133
    v_add_f32 v136, v136, v137
    v_add_f32 v140, v140, v141
    v_mul_f32 v128, 0x3a800000, v128
    v_mul_f32 v132, 0x3a800000, v132
    v_cvt_pk_bf16_f32 v129, v128, v128
    v_lshlrev_b32 v129, 16, v129
    v_fma_f32 v132, -v128, v128, v132
    v_max_f32 v132, 0, v132
    v_fma_f32 v136, -v129, v140, v136
    s_waitcnt vmcnt(0)
    v_cvt_pk_bf16_f32 v132, v132, v132
    v_lshlrev_b32 v132, 16, v132
    v_add_f32 v132, 0x3727c5ac, v132
    v_cvt_pk_bf16_f32 v132, v132, v132
    v_lshlrev_b32 v132, 16, v132
    v_sqrt_f32 v132, v132
    s_nop 0
    v_cvt_pk_bf16_f32 v132, v132, v132
    v_lshlrev_b32 v132, 16, v132
    v_rcp_f32 v2, v132
    v_lshrrev_b32 v3, 16, v129
    v_or_b32 v208, v3, v132
    v_mul_f32 v136, v136, v2
    v_cvt_pk_bf16_f32 v136, v136, v136
    v_lshlrev_b32 v136, 16, v136
    v_ashrrev_i32 v2, 31, v136
    v_or_b32 v2, 0x80000000, v2
    v_xor_b32 v2, v136, v2
    v_and_b32 v2, 0xffff0000, v2
    v_lshrrev_b32 v3, 5, v1
    v_add_u32 v209, s71, v3
    v_sub_u32 v209, 2047, v209
    v_or_b32 v210, v2, v209
    v_mov_b32 v2, v210
    v_mov_b32 v209, v208
    v_readfirstlane_b32 s86, v212
    v_mov_b32 v3, 0
    s_mul_i32 s86, s86, 1664525
    s_add_u32 s86, s86, 1013904223
    v_mov_b32 v211, s86
    v_permlane32_swap_b32 v210, v2
    v_permlane32_swap_b32 v208, v209
    v_max_u32 v210, v210, v2
    s_lshl_b32 s3, s71, 3
    s_mov_b64 exec, 1
    buffer_store_dwordx4 v[208:211], v3, s[48:51], s3 offen sc1
    s_mov_b64 exec, -1
    v_mov_b32_e64 v251, s86
    s_barrier
    ds_read_b128 v[104:107], v184 offset:0
    ds_read_b64_tr_b16 v[120:121], v186 offset:0
    ds_read_b64_tr_b16 v[122:123], v186 offset:512
    ds_read_b64_tr_b16 v[124:125], v187 offset:0
    ds_read_b64_tr_b16 v[126:127], v187 offset:512
    ds_read_b64_tr_b16 v[128:129], v186 offset:8192
    ds_read_b64_tr_b16 v[130:131], v186 offset:8704
    ds_read_b64_tr_b16 v[132:133], v187 offset:8192
    ds_read_b64_tr_b16 v[134:135], v187 offset:8704
    ds_read_b64_tr_b16 v[136:137], v186 offset:16384
    ds_read_b64_tr_b16 v[138:139], v186 offset:16896
    ds_read_b64_tr_b16 v[140:141], v187 offset:16384
    ds_read_b64_tr_b16 v[142:143], v187 offset:16896
    ds_read_b128 v[108:111], v184 offset:2048
    ds_read_b128 v[112:115], v184 offset:4096
    ds_read_b128 v[116:119], v184 offset:6144
    ds_read_b64 v[240:241], v236
    ds_read_b64 v[242:243], v237
    ds_read_b64 v[244:245], v238
    ds_read_b64 v[246:247], v239
    s_waitcnt lgkmcnt(4)
    s_branch L_cmid
.p2align 6
L_cloop:
    s_waitcnt lgkmcnt(0)
    s_barrier
    v_mfma_f32_16x16x32_bf16 v[8:11], v[160:163], v[144:147], v[8:11]
    ds_read_b128 v[104:107], v184 offset:0
    v_mfma_f32_16x16x32_bf16 v[12:15], v[164:167], v[144:147], v[12:15]
    ds_read_b64_tr_b16 v[120:121], v186 offset:0
    v_mfma_f32_16x16x32_bf16 v[16:19], v[168:171], v[144:147], v[16:19]
    ds_read_b64_tr_b16 v[122:123], v186 offset:512
    v_mfma_f32_16x16x32_bf16 v[20:23], v[172:175], v[144:147], v[20:23]
    ds_read_b64_tr_b16 v[124:125], v187 offset:0
    v_mfma_f32_16x16x32_bf16 v[24:27], v[144:147], v[176:179], v[24:27]
    ds_read_b64_tr_b16 v[126:127], v187 offset:512
    v_mfma_f32_16x16x32_bf16 v[28:31], v[144:147], v[180:183], v[28:31]
    ds_read_b64_tr_b16 v[128:129], v186 offset:8192
    v_mfma_f32_16x16x32_bf16 v[32:35], v[160:163], v[148:151], v[32:35]
    ds_read_b64_tr_b16 v[130:131], v186 offset:8704
    v_mfma_f32_16x16x32_bf16 v[36:39], v[164:167], v[148:151], v[36:39]
    ds_read_b64_tr_b16 v[132:133], v187 offset:8192
    v_mfma_f32_16x16x32_bf16 v[40:43], v[168:171], v[148:151], v[40:43]
    ds_read_b64_tr_b16 v[134:135], v187 offset:8704
    v_mfma_f32_16x16x32_bf16 v[44:47], v[172:175], v[148:151], v[44:47]
    ds_read_b64_tr_b16 v[136:137], v186 offset:16384
    v_mfma_f32_16x16x32_bf16 v[48:51], v[148:151], v[176:179], v[48:51]
    ds_read_b64_tr_b16 v[138:139], v186 offset:16896
    v_mfma_f32_16x16x32_bf16 v[52:55], v[148:151], v[180:183], v[52:55]
    ds_read_b64_tr_b16 v[140:141], v187 offset:16384
    v_mfma_f32_16x16x32_bf16 v[56:59], v[160:163], v[152:155], v[56:59]
    ds_read_b64_tr_b16 v[142:143], v187 offset:16896
    v_mfma_f32_16x16x32_bf16 v[60:63], v[164:167], v[152:155], v[60:63]
    ds_read_b128 v[108:111], v184 offset:2048
    v_mfma_f32_16x16x32_bf16 v[64:67], v[168:171], v[152:155], v[64:67]
    ds_read_b128 v[112:115], v184 offset:4096
    v_mfma_f32_16x16x32_bf16 v[68:71], v[172:175], v[152:155], v[68:71]
    ds_read_b128 v[116:119], v184 offset:6144
    v_mfma_f32_16x16x32_bf16 v[72:75], v[152:155], v[176:179], v[72:75]
    v_mfma_f32_16x16x32_bf16 v[76:79], v[152:155], v[180:183], v[76:79]
    v_mfma_f32_16x16x32_bf16 v[80:83], v[160:163], v[156:159], v[80:83]
    v_mfma_f32_16x16x32_bf16 v[84:87], v[164:167], v[156:159], v[84:87]
    v_mfma_f32_16x16x32_bf16 v[88:91], v[168:171], v[156:159], v[88:91]
    v_mfma_f32_16x16x32_bf16 v[92:95], v[172:175], v[156:159], v[92:95]
    v_mfma_f32_16x16x32_bf16 v[96:99], v[156:159], v[176:179], v[96:99]
    v_mfma_f32_16x16x32_bf16 v[100:103], v[156:159], v[180:183], v[100:103]
    s_waitcnt lgkmcnt(0)
    s_nop 0
L_cmid:
    v_mfma_f32_16x16x32_bf16 v[8:11], v[120:123], v[104:107], v[8:11]
    ds_read_b128 v[144:147], v185 offset:0
    v_mfma_f32_16x16x32_bf16 v[12:15], v[124:127], v[104:107], v[12:15]
    ds_read_b64_tr_b16 v[160:161], v186 offset:4096
    v_mfma_f32_16x16x32_bf16 v[16:19], v[128:131], v[104:107], v[16:19]
    ds_read_b64_tr_b16 v[162:163], v186 offset:4608
    v_mfma_f32_16x16x32_bf16 v[20:23], v[132:135], v[104:107], v[20:23]
    ds_read_b64_tr_b16 v[164:165], v187 offset:4096
    v_mfma_f32_16x16x32_bf16 v[24:27], v[104:107], v[136:139], v[24:27]
    ds_read_b64_tr_b16 v[166:167], v187 offset:4608
    v_mfma_f32_16x16x32_bf16 v[28:31], v[104:107], v[140:143], v[28:31]
    ds_read_b64_tr_b16 v[168:169], v186 offset:12288
    v_mfma_f32_16x16x32_bf16 v[32:35], v[120:123], v[108:111], v[32:35]
    ds_read_b64_tr_b16 v[170:171], v186 offset:12800
    v_mfma_f32_16x16x32_bf16 v[36:39], v[124:127], v[108:111], v[36:39]
    ds_read_b64_tr_b16 v[172:173], v187 offset:12288
    v_mfma_f32_16x16x32_bf16 v[40:43], v[128:131], v[108:111], v[40:43]
    ds_read_b64_tr_b16 v[174:175], v187 offset:12800
    v_mfma_f32_16x16x32_bf16 v[44:47], v[132:135], v[108:111], v[44:47]
    ds_read_b64_tr_b16 v[176:177], v186 offset:20480
    v_mfma_f32_16x16x32_bf16 v[48:51], v[108:111], v[136:139], v[48:51]
    ds_read_b64_tr_b16 v[178:179], v186 offset:20992
    v_mfma_f32_16x16x32_bf16 v[52:55], v[108:111], v[140:143], v[52:55]
    ds_read_b64_tr_b16 v[180:181], v187 offset:20480
    v_mfma_f32_16x16x32_bf16 v[56:59], v[120:123], v[112:115], v[56:59]
    ds_read_b64_tr_b16 v[182:183], v187 offset:20992
    v_mfma_f32_16x16x32_bf16 v[60:63], v[124:127], v[112:115], v[60:63]
    ds_read_b128 v[148:151], v185 offset:2048
    v_mfma_f32_16x16x32_bf16 v[64:67], v[128:131], v[112:115], v[64:67]
    ds_read_b128 v[152:155], v185 offset:4096
    v_mfma_f32_16x16x32_bf16 v[68:71], v[132:135], v[112:115], v[68:71]
    ds_read_b128 v[156:159], v185 offset:6144
    v_mfma_f32_16x16x32_bf16 v[72:75], v[112:115], v[136:139], v[72:75]
    v_mfma_f32_16x16x32_bf16 v[76:79], v[112:115], v[140:143], v[76:79]
    v_mfma_f32_16x16x32_bf16 v[80:83], v[120:123], v[116:119], v[80:83]
    v_mfma_f32_16x16x32_bf16 v[84:87], v[124:127], v[116:119], v[84:87]
    v_mfma_f32_16x16x32_bf16 v[88:91], v[128:131], v[116:119], v[88:91]
    v_mfma_f32_16x16x32_bf16 v[92:95], v[132:135], v[116:119], v[92:95]
    v_mfma_f32_16x16x32_bf16 v[96:99], v[116:119], v[136:139], v[96:99]
    v_mfma_f32_16x16x32_bf16 v[100:103], v[116:119], v[140:143], v[100:103]
    s_waitcnt lgkmcnt(0)
    s_barrier
    v_mfma_f32_16x16x32_bf16 v[8:11], v[160:163], v[144:147], v[8:11]
    ds_read_b128 v[104:107], v184 offset:40960
    v_mfma_f32_16x16x32_bf16 v[12:15], v[164:167], v[144:147], v[12:15]
    ds_read_b64_tr_b16 v[120:121], v186 offset:40960
    v_mfma_f32_16x16x32_bf16 v[16:19], v[168:171], v[144:147], v[16:19]
    ds_read_b64_tr_b16 v[122:123], v186 offset:41472
    v_mfma_f32_16x16x32_bf16 v[20:23], v[172:175], v[144:147], v[20:23]
    ds_read_b64_tr_b16 v[124:125], v187 offset:40960
    v_mfma_f32_16x16x32_bf16 v[24:27], v[144:147], v[176:179], v[24:27]
    ds_read_b64_tr_b16 v[126:127], v187 offset:41472
    v_mfma_f32_16x16x32_bf16 v[28:31], v[144:147], v[180:183], v[28:31]
    ds_read_b64_tr_b16 v[128:129], v186 offset:49152
    v_mfma_f32_16x16x32_bf16 v[32:35], v[160:163], v[148:151], v[32:35]
    ds_read_b64_tr_b16 v[130:131], v186 offset:49664
    v_mfma_f32_16x16x32_bf16 v[36:39], v[164:167], v[148:151], v[36:39]
    ds_read_b64_tr_b16 v[132:133], v187 offset:49152
    v_mfma_f32_16x16x32_bf16 v[40:43], v[168:171], v[148:151], v[40:43]
    ds_read_b64_tr_b16 v[134:135], v187 offset:49664
    v_mfma_f32_16x16x32_bf16 v[44:47], v[172:175], v[148:151], v[44:47]
    ds_read_b64_tr_b16 v[136:137], v186 offset:57344
    v_mfma_f32_16x16x32_bf16 v[48:51], v[148:151], v[176:179], v[48:51]
    ds_read_b64_tr_b16 v[138:139], v186 offset:57856
    v_mfma_f32_16x16x32_bf16 v[52:55], v[148:151], v[180:183], v[52:55]
    ds_read_b64_tr_b16 v[140:141], v187 offset:57344
    v_mfma_f32_16x16x32_bf16 v[56:59], v[160:163], v[152:155], v[56:59]
    ds_read_b64_tr_b16 v[142:143], v187 offset:57856
    v_mfma_f32_16x16x32_bf16 v[60:63], v[164:167], v[152:155], v[60:63]
    ds_read_b128 v[108:111], v184 offset:43008
    v_mfma_f32_16x16x32_bf16 v[64:67], v[168:171], v[152:155], v[64:67]
    ds_read_b128 v[112:115], v184 offset:45056
    v_mfma_f32_16x16x32_bf16 v[68:71], v[172:175], v[152:155], v[68:71]
    ds_read_b128 v[116:119], v184 offset:47104
    v_mfma_f32_16x16x32_bf16 v[72:75], v[152:155], v[176:179], v[72:75]
    v_mfma_f32_16x16x32_bf16 v[76:79], v[152:155], v[180:183], v[76:79]
    v_mfma_f32_16x16x32_bf16 v[80:83], v[160:163], v[156:159], v[80:83]
    v_mfma_f32_16x16x32_bf16 v[84:87], v[164:167], v[156:159], v[84:87]
    v_mfma_f32_16x16x32_bf16 v[88:91], v[168:171], v[156:159], v[88:91]
    v_mfma_f32_16x16x32_bf16 v[92:95], v[172:175], v[156:159], v[92:95]
    v_mfma_f32_16x16x32_bf16 v[96:99], v[156:159], v[176:179], v[96:99]
    v_mfma_f32_16x16x32_bf16 v[100:103], v[156:159], v[180:183], v[100:103]
    s_waitcnt lgkmcnt(0)
    s_nop 0
    v_mfma_f32_16x16x32_bf16 v[8:11], v[120:123], v[104:107], v[8:11]
    ds_read_b128 v[144:147], v185 offset:40960
    v_mfma_f32_16x16x32_bf16 v[12:15], v[124:127], v[104:107], v[12:15]
    ds_read_b64_tr_b16 v[160:161], v186 offset:45056
    v_mfma_f32_16x16x32_bf16 v[16:19], v[128:131], v[104:107], v[16:19]
    ds_read_b64_tr_b16 v[162:163], v186 offset:45568
    v_mfma_f32_16x16x32_bf16 v[20:23], v[132:135], v[104:107], v[20:23]
    ds_read_b64_tr_b16 v[164:165], v187 offset:45056
    v_mfma_f32_16x16x32_bf16 v[24:27], v[104:107], v[136:139], v[24:27]
    ds_read_b64_tr_b16 v[166:167], v187 offset:45568
    v_mfma_f32_16x16x32_bf16 v[28:31], v[104:107], v[140:143], v[28:31]
    ds_read_b64_tr_b16 v[168:169], v186 offset:53248
    v_mfma_f32_16x16x32_bf16 v[32:35], v[120:123], v[108:111], v[32:35]
    ds_read_b64_tr_b16 v[170:171], v186 offset:53760
    v_mfma_f32_16x16x32_bf16 v[36:39], v[124:127], v[108:111], v[36:39]
    ds_read_b64_tr_b16 v[172:173], v187 offset:53248
    v_mfma_f32_16x16x32_bf16 v[40:43], v[128:131], v[108:111], v[40:43]
    ds_read_b64_tr_b16 v[174:175], v187 offset:53760
    v_mfma_f32_16x16x32_bf16 v[44:47], v[132:135], v[108:111], v[44:47]
    ds_read_b64_tr_b16 v[176:177], v186 offset:61440
    v_mfma_f32_16x16x32_bf16 v[48:51], v[108:111], v[136:139], v[48:51]
    ds_read_b64_tr_b16 v[178:179], v186 offset:61952
    v_mfma_f32_16x16x32_bf16 v[52:55], v[108:111], v[140:143], v[52:55]
    ds_read_b64_tr_b16 v[180:181], v187 offset:61440
    v_mfma_f32_16x16x32_bf16 v[56:59], v[120:123], v[112:115], v[56:59]
    ds_read_b64_tr_b16 v[182:183], v187 offset:61952
    v_mfma_f32_16x16x32_bf16 v[60:63], v[124:127], v[112:115], v[60:63]
    ds_read_b128 v[148:151], v185 offset:43008
    v_mfma_f32_16x16x32_bf16 v[64:67], v[128:131], v[112:115], v[64:67]
    ds_read_b128 v[152:155], v185 offset:45056
    v_mfma_f32_16x16x32_bf16 v[68:71], v[132:135], v[112:115], v[68:71]
    ds_read_b128 v[156:159], v185 offset:47104
    v_mfma_f32_16x16x32_bf16 v[72:75], v[112:115], v[136:139], v[72:75]
    v_mfma_f32_16x16x32_bf16 v[76:79], v[112:115], v[140:143], v[76:79]
    v_mfma_f32_16x16x32_bf16 v[80:83], v[120:123], v[116:119], v[80:83]
    v_mfma_f32_16x16x32_bf16 v[84:87], v[124:127], v[116:119], v[84:87]
    v_mfma_f32_16x16x32_bf16 v[88:91], v[128:131], v[116:119], v[88:91]
    v_mfma_f32_16x16x32_bf16 v[92:95], v[132:135], v[116:119], v[92:95]
    v_mfma_f32_16x16x32_bf16 v[96:99], v[116:119], v[136:139], v[96:99]
    v_mfma_f32_16x16x32_bf16 v[100:103], v[116:119], v[140:143], v[100:103]
    s_waitcnt lgkmcnt(0)
    s_barrier
    v_mfma_f32_16x16x32_bf16 v[8:11], v[160:163], v[144:147], v[8:11]
    ds_read_b128 v[104:107], v188 offset:0
    v_mfma_f32_16x16x32_bf16 v[12:15], v[164:167], v[144:147], v[12:15]
    ds_read_b64_tr_b16 v[120:121], v190 offset:0
    v_mfma_f32_16x16x32_bf16 v[16:19], v[168:171], v[144:147], v[16:19]
    ds_read_b64_tr_b16 v[122:123], v190 offset:512
    v_mfma_f32_16x16x32_bf16 v[20:23], v[172:175], v[144:147], v[20:23]
    ds_read_b64_tr_b16 v[124:125], v191 offset:0
    v_mfma_f32_16x16x32_bf16 v[24:27], v[144:147], v[176:179], v[24:27]
    ds_read_b64_tr_b16 v[126:127], v191 offset:512
    v_mfma_f32_16x16x32_bf16 v[28:31], v[144:147], v[180:183], v[28:31]
    ds_read_b64_tr_b16 v[128:129], v190 offset:8192
    v_mfma_f32_16x16x32_bf16 v[32:35], v[160:163], v[148:151], v[32:35]
    ds_read_b64_tr_b16 v[130:131], v190 offset:8704
    v_mfma_f32_16x16x32_bf16 v[36:39], v[164:167], v[148:151], v[36:39]
    ds_read_b64_tr_b16 v[132:133], v191 offset:8192
    v_mfma_f32_16x16x32_bf16 v[40:43], v[168:171], v[148:151], v[40:43]
    ds_read_b64_tr_b16 v[134:135], v191 offset:8704
    v_mfma_f32_16x16x32_bf16 v[44:47], v[172:175], v[148:151], v[44:47]
    ds_read_b64_tr_b16 v[136:137], v190 offset:16384
    v_mfma_f32_16x16x32_bf16 v[48:51], v[148:151], v[176:179], v[48:51]
    ds_read_b64_tr_b16 v[138:139], v190 offset:16896
    v_mfma_f32_16x16x32_bf16 v[52:55], v[148:151], v[180:183], v[52:55]
    ds_read_b64_tr_b16 v[140:141], v191 offset:16384
    v_mfma_f32_16x16x32_bf16 v[56:59], v[160:163], v[152:155], v[56:59]
    ds_read_b64_tr_b16 v[142:143], v191 offset:16896
    v_mfma_f32_16x16x32_bf16 v[60:63], v[164:167], v[152:155], v[60:63]
    ds_read_b128 v[108:111], v188 offset:2048
    v_mfma_f32_16x16x32_bf16 v[64:67], v[168:171], v[152:155], v[64:67]
    ds_read_b128 v[112:115], v188 offset:4096
    v_mfma_f32_16x16x32_bf16 v[68:71], v[172:175], v[152:155], v[68:71]
    ds_read_b128 v[116:119], v188 offset:6144
    v_mfma_f32_16x16x32_bf16 v[72:75], v[152:155], v[176:179], v[72:75]
    v_mfma_f32_16x16x32_bf16 v[76:79], v[152:155], v[180:183], v[76:79]
    v_mfma_f32_16x16x32_bf16 v[80:83], v[160:163], v[156:159], v[80:83]
    v_mfma_f32_16x16x32_bf16 v[84:87], v[164:167], v[156:159], v[84:87]
    v_mfma_f32_16x16x32_bf16 v[88:91], v[168:171], v[156:159], v[88:91]
    v_mfma_f32_16x16x32_bf16 v[92:95], v[172:175], v[156:159], v[92:95]
    v_mfma_f32_16x16x32_bf16 v[96:99], v[156:159], v[176:179], v[96:99]
    v_mfma_f32_16x16x32_bf16 v[100:103], v[156:159], v[180:183], v[100:103]
    s_waitcnt lgkmcnt(0)
    s_nop 0
    v_mfma_f32_16x16x32_bf16 v[8:11], v[120:123], v[104:107], v[8:11]
    ds_read_b128 v[144:147], v189 offset:0
    v_mfma_f32_16x16x32_bf16 v[12:15], v[124:127], v[104:107], v[12:15]
    ds_read_b64_tr_b16 v[160:161], v190 offset:4096
    v_mfma_f32_16x16x32_bf16 v[16:19], v[128:131], v[104:107], v[16:19]
    ds_read_b64_tr_b16 v[162:163], v190 offset:4608
    v_mfma_f32_16x16x32_bf16 v[20:23], v[132:135], v[104:107], v[20:23]
    ds_read_b64_tr_b16 v[164:165], v191 offset:4096
    v_mfma_f32_16x16x32_bf16 v[24:27], v[104:107], v[136:139], v[24:27]
    ds_read_b64_tr_b16 v[166:167], v191 offset:4608
    v_mfma_f32_16x16x32_bf16 v[28:31], v[104:107], v[140:143], v[28:31]
    ds_read_b64_tr_b16 v[168:169], v190 offset:12288
    v_mfma_f32_16x16x32_bf16 v[32:35], v[120:123], v[108:111], v[32:35]
    ds_read_b64_tr_b16 v[170:171], v190 offset:12800
    v_mfma_f32_16x16x32_bf16 v[36:39], v[124:127], v[108:111], v[36:39]
    ds_read_b64_tr_b16 v[172:173], v191 offset:12288
    v_mfma_f32_16x16x32_bf16 v[40:43], v[128:131], v[108:111], v[40:43]
    ds_read_b64_tr_b16 v[174:175], v191 offset:12800
    v_mfma_f32_16x16x32_bf16 v[44:47], v[132:135], v[108:111], v[44:47]
    ds_read_b64_tr_b16 v[176:177], v190 offset:20480
    v_mfma_f32_16x16x32_bf16 v[48:51], v[108:111], v[136:139], v[48:51]
    ds_read_b64_tr_b16 v[178:179], v190 offset:20992
    v_mfma_f32_16x16x32_bf16 v[52:55], v[108:111], v[140:143], v[52:55]
    ds_read_b64_tr_b16 v[180:181], v191 offset:20480
    v_mfma_f32_16x16x32_bf16 v[56:59], v[120:123], v[112:115], v[56:59]
    ds_read_b64_tr_b16 v[182:183], v191 offset:20992
    v_mfma_f32_16x16x32_bf16 v[60:63], v[124:127], v[112:115], v[60:63]
    ds_read_b128 v[148:151], v189 offset:2048
    v_mfma_f32_16x16x32_bf16 v[64:67], v[128:131], v[112:115], v[64:67]
    ds_read_b128 v[152:155], v189 offset:4096
    v_mfma_f32_16x16x32_bf16 v[68:71], v[132:135], v[112:115], v[68:71]
    ds_read_b128 v[156:159], v189 offset:6144
    v_mfma_f32_16x16x32_bf16 v[72:75], v[112:115], v[136:139], v[72:75]
    s_add_u32 s66, s66, 1
    s_cmp_lt_u32 s66, 5
    v_mfma_f32_16x16x32_bf16 v[76:79], v[112:115], v[140:143], v[76:79]
    v_mfma_f32_16x16x32_bf16 v[80:83], v[120:123], v[116:119], v[80:83]
    v_mfma_f32_16x16x32_bf16 v[84:87], v[124:127], v[116:119], v[84:87]
    v_mfma_f32_16x16x32_bf16 v[88:91], v[128:131], v[116:119], v[88:91]
    v_mfma_f32_16x16x32_bf16 v[92:95], v[132:135], v[116:119], v[92:95]
    v_mfma_f32_16x16x32_bf16 v[96:99], v[116:119], v[136:139], v[96:99]
    v_mfma_f32_16x16x32_bf16 v[100:103], v[116:119], v[140:143], v[100:103]
    s_cbranch_scc1 L_cloop
    s_nop 0
    s_waitcnt lgkmcnt(0)
    s_barrier
    v_mfma_f32_16x16x32_bf16 v[8:11], v[160:163], v[144:147], v[8:11]
    ds_read_b128 v[104:107], v184 offset:0
    v_mfma_f32_16x16x32_bf16 v[12:15], v[164:167], v[144:147], v[12:15]
    ds_read_b64_tr_b16 v[120:121], v186 offset:0
    v_mfma_f32_16x16x32_bf16 v[16:19], v[168:171], v[144:147], v[16:19]
    ds_read_b64_tr_b16 v[122:123], v186 offset:512
    v_mfma_f32_16x16x32_bf16 v[20:23], v[172:175], v[144:147], v[20:23]
    ds_read_b64_tr_b16 v[124:125], v187 offset:0
    v_mfma_f32_16x16x32_bf16 v[24:27], v[144:147], v[176:179], v[24:27]
    ds_read_b64_tr_b16 v[126:127], v187 offset:512
    v_mfma_f32_16x16x32_bf16 v[28:31], v[144:147], v[180:183], v[28:31]
    ds_read_b64_tr_b16 v[128:129], v186 offset:8192
    v_mfma_f32_16x16x32_bf16 v[32:35], v[160:163], v[148:151], v[32:35]
    ds_read_b64_tr_b16 v[130:131], v186 offset:8704
    v_mfma_f32_16x16x32_bf16 v[36:39], v[164:167], v[148:151], v[36:39]
    ds_read_b64_tr_b16 v[132:133], v187 offset:8192
    v_mfma_f32_16x16x32_bf16 v[40:43], v[168:171], v[148:151], v[40:43]
    ds_read_b64_tr_b16 v[134:135], v187 offset:8704
    v_mfma_f32_16x16x32_bf16 v[44:47], v[172:175], v[148:151], v[44:47]
    ds_read_b64_tr_b16 v[136:137], v186 offset:16384
    v_mfma_f32_16x16x32_bf16 v[48:51], v[148:151], v[176:179], v[48:51]
    ds_read_b64_tr_b16 v[138:139], v186 offset:16896
    v_mfma_f32_16x16x32_bf16 v[52:55], v[148:151], v[180:183], v[52:55]
    ds_read_b64_tr_b16 v[140:141], v187 offset:16384
    v_mfma_f32_16x16x32_bf16 v[56:59], v[160:163], v[152:155], v[56:59]
    ds_read_b64_tr_b16 v[142:143], v187 offset:16896
    v_mfma_f32_16x16x32_bf16 v[60:63], v[164:167], v[152:155], v[60:63]
    ds_read_b128 v[108:111], v184 offset:2048
    v_mfma_f32_16x16x32_bf16 v[64:67], v[168:171], v[152:155], v[64:67]
    ds_read_b128 v[112:115], v184 offset:4096
    v_mfma_f32_16x16x32_bf16 v[68:71], v[172:175], v[152:155], v[68:71]
    ds_read_b128 v[116:119], v184 offset:6144
    v_mfma_f32_16x16x32_bf16 v[72:75], v[152:155], v[176:179], v[72:75]
    ds_read_b32 v192, v232 offset:0
    v_mfma_f32_16x16x32_bf16 v[76:79], v[152:155], v[180:183], v[76:79]
    ds_read_b32 v194, v232 offset:64
    v_mfma_f32_16x16x32_bf16 v[80:83], v[160:163], v[156:159], v[80:83]
    ds_read_b32 v196, v232 offset:128
    v_mfma_f32_16x16x32_bf16 v[84:87], v[164:167], v[156:159], v[84:87]
    ds_read_b32 v198, v232 offset:192
    v_mfma_f32_16x16x32_bf16 v[88:91], v[168:171], v[156:159], v[88:91]
    ds_read_b128 v[204:207], v235 offset:256
    v_mfma_f32_16x16x32_bf16 v[92:95], v[172:175], v[156:159], v[92:95]
    ds_read_b128 v[208:211], v235 offset:320
    v_mfma_f32_16x16x32_bf16 v[96:99], v[156:159], v[176:179], v[96:99]
    ds_read_b128 v[212:215], v235 offset:0
    v_mfma_f32_16x16x32_bf16 v[100:103], v[156:159], v[180:183], v[100:103]
    ds_read_b128 v[216:219], v235 offset:64
    s_waitcnt lgkmcnt(8)
    s_nop 0
    v_mfma_f32_16x16x32_bf16 v[8:11], v[120:123], v[104:107], v[8:11]
    ds_read_b128 v[144:147], v185 offset:0
    v_mfma_f32_16x16x32_bf16 v[12:15], v[124:127], v[104:107], v[12:15]
    ds_read_b64_tr_b16 v[160:161], v186 offset:4096
    v_mfma_f32_16x16x32_bf16 v[16:19], v[128:131], v[104:107], v[16:19]
    ds_read_b64_tr_b16 v[162:163], v186 offset:4608
    v_mfma_f32_16x16x32_bf16 v[20:23], v[132:135], v[104:107], v[20:23]
    ds_read_b64_tr_b16 v[164:165], v187 offset:4096
    v_mfma_f32_16x16x32_bf16 v[24:27], v[104:107], v[136:139], v[24:27]
    ds_read_b64_tr_b16 v[166:167], v187 offset:4608
    v_mfma_f32_16x16x32_bf16 v[28:31], v[104:107], v[140:143], v[28:31]
    ds_read_b64_tr_b16 v[168:169], v186 offset:12288
    v_mfma_f32_16x16x32_bf16 v[32:35], v[120:123], v[108:111], v[32:35]
    ds_read_b64_tr_b16 v[170:171], v186 offset:12800
    v_mfma_f32_16x16x32_bf16 v[36:39], v[124:127], v[108:111], v[36:39]
    ds_read_b64_tr_b16 v[172:173], v187 offset:12288
    v_mfma_f32_16x16x32_bf16 v[40:43], v[128:131], v[108:111], v[40:43]
    ds_read_b64_tr_b16 v[174:175], v187 offset:12800
    v_mfma_f32_16x16x32_bf16 v[44:47], v[132:135], v[108:111], v[44:47]
    ds_read_b64_tr_b16 v[176:177], v186 offset:20480
    v_mfma_f32_16x16x32_bf16 v[48:51], v[108:111], v[136:139], v[48:51]
    ds_read_b64_tr_b16 v[178:179], v186 offset:20992
    v_mfma_f32_16x16x32_bf16 v[52:55], v[108:111], v[140:143], v[52:55]
    ds_read_b64_tr_b16 v[180:181], v187 offset:20480
    v_mfma_f32_16x16x32_bf16 v[56:59], v[120:123], v[112:115], v[56:59]
    ds_read_b64_tr_b16 v[182:183], v187 offset:20992
    v_mfma_f32_16x16x32_bf16 v[60:63], v[124:127], v[112:115], v[60:63]
    ds_read_b128 v[148:151], v185 offset:2048
    v_mfma_f32_16x16x32_bf16 v[64:67], v[128:131], v[112:115], v[64:67]
    ds_read_b128 v[152:155], v185 offset:4096
    v_mfma_f32_16x16x32_bf16 v[68:71], v[132:135], v[112:115], v[68:71]
    ds_read_b128 v[156:159], v185 offset:6144
    v_mfma_f32_16x16x32_bf16 v[72:75], v[112:115], v[136:139], v[72:75]
    ds_read_b64_tr_b16 v[224:225], v252 offset:0
    v_mfma_f32_16x16x32_bf16 v[76:79], v[112:115], v[140:143], v[76:79]
    ds_read_b64_tr_b16 v[226:227], v252 offset:1024
    v_mfma_f32_16x16x32_bf16 v[80:83], v[120:123], v[116:119], v[80:83]
    ds_read_b64_tr_b16 v[228:229], v252 offset:32
    v_mfma_f32_16x16x32_bf16 v[84:87], v[124:127], v[116:119], v[84:87]
    ds_read_b64_tr_b16 v[230:231], v252 offset:1056
    v_mfma_f32_16x16x32_bf16 v[88:91], v[128:131], v[116:119], v[88:91]
    v_mfma_f32_16x16x32_bf16 v[92:95], v[132:135], v[116:119], v[92:95]
    v_mfma_f32_16x16x32_bf16 v[96:99], v[116:119], v[136:139], v[96:99]
    v_mfma_f32_16x16x32_bf16 v[100:103], v[116:119], v[140:143], v[100:103]
    s_waitcnt lgkmcnt(4)
    v_mfma_f32_16x16x32_bf16 v[16:19], v[168:171], v[144:147], v[16:19]
    s_barrier
    v_mfma_f32_16x16x32_bf16 v[20:23], v[172:175], v[144:147], v[20:23]
    ds_read_b128 v[104:107], v233 offset:0
    ds_read_b128 v[108:111], v233 offset:64
    v_mfma_f32_16x16x32_bf16 v[40:43], v[168:171], v[148:151], v[40:43]
    ds_read_b128 v[112:115], v233 offset:128
    ds_read_b128 v[116:119], v233 offset:192
    v_mfma_f32_16x16x32_bf16 v[44:47], v[172:175], v[148:151], v[44:47]
    ds_read_b32 v250, v248 offset:576
    ds_read_b32 v248, v248 offset:512
    v_mfma_f32_16x16x32_bf16 v[64:67], v[168:171], v[152:155], v[64:67]
    ds_read_b32 v200, v232 offset:2048
    ds_read_b32 v202, v232 offset:2112
    v_mfma_f32_16x16x32_bf16 v[68:71], v[172:175], v[152:155], v[68:71]
    ds_read_b32 v220, v232 offset:2176
    ds_read_b32 v222, v232 offset:2240
    v_mfma_f32_16x16x32_bf16 v[88:91], v[168:171], v[156:159], v[88:91]
    ds_read_b32 v193, v234 offset:2048
    ds_read_b32 v195, v234 offset:1024
    v_mfma_f32_16x16x32_bf16 v[92:95], v[172:175], v[156:159], v[92:95]
    ds_read_b32 v221, v234 offset:2176
    ds_read_b32 v223, v234 offset:1152
    v_mfma_f32_16x16x32_bf16 v[24:27], v[144:147], v[176:179], v[24:27]
    v_fma_f32 v16, -v192, v204, v16
    v_fma_f32 v17, -v192, v205, v17
    v_fma_f32 v18, -v192, v206, v18
    v_mfma_f32_16x16x32_bf16 v[28:31], v[144:147], v[180:183], v[28:31]
    v_fma_f32 v19, -v192, v207, v19
    v_fma_f32 v20, -v192, v208, v20
    v_fma_f32 v21, -v192, v209, v21
    v_mfma_f32_16x16x32_bf16 v[48:51], v[148:151], v[176:179], v[48:51]
    v_fma_f32 v22, -v192, v210, v22
    v_fma_f32 v23, -v192, v211, v23
    v_cvt_pk_bf16_f32 v16, v16, v17
    v_mfma_f32_16x16x32_bf16 v[52:55], v[148:151], v[180:183], v[52:55]
    v_cvt_pk_bf16_f32 v17, v18, v19
    v_cvt_pk_bf16_f32 v18, v20, v21
    v_cvt_pk_bf16_f32 v19, v22, v23
    v_mfma_f32_16x16x32_bf16 v[72:75], v[152:155], v[176:179], v[72:75]
    v_fma_f32 v40, -v194, v204, v40
    v_fma_f32 v41, -v194, v205, v41
    v_fma_f32 v42, -v194, v206, v42
    v_mfma_f32_16x16x32_bf16 v[76:79], v[152:155], v[180:183], v[76:79]
    v_fma_f32 v43, -v194, v207, v43
    v_fma_f32 v44, -v194, v208, v44
    v_fma_f32 v45, -v194, v209, v45
    v_mfma_f32_16x16x32_bf16 v[96:99], v[156:159], v[176:179], v[96:99]
    v_fma_f32 v46, -v194, v210, v46
    v_fma_f32 v47, -v194, v211, v47
    v_cvt_pk_bf16_f32 v40, v40, v41
    v_mfma_f32_16x16x32_bf16 v[100:103], v[156:159], v[180:183], v[100:103]
    v_cvt_pk_bf16_f32 v41, v42, v43
    v_cvt_pk_bf16_f32 v42, v44, v45
    v_cvt_pk_bf16_f32 v43, v46, v47
    v_mfma_f32_16x16x32_bf16 v[8:11], v[160:163], v[144:147], v[8:11]
    v_fma_f32 v64, -v196, v204, v64
    v_fma_f32 v65, -v196, v205, v65
    v_fma_f32 v66, -v196, v206, v66
    v_mfma_f32_16x16x32_bf16 v[12:15], v[164:167], v[144:147], v[12:15]
    v_fma_f32 v67, -v196, v207, v67
    v_fma_f32 v68, -v196, v208, v68
    v_fma_f32 v69, -v196, v209, v69
    v_mfma_f32_16x16x32_bf16 v[32:35], v[160:163], v[148:151], v[32:35]
    v_fma_f32 v70, -v196, v210, v70
    v_fma_f32 v71, -v196, v211, v71
    v_cvt_pk_bf16_f32 v64, v64, v65
    v_mfma_f32_16x16x32_bf16 v[36:39], v[164:167], v[148:151], v[36:39]
    v_cvt_pk_bf16_f32 v65, v66, v67
    v_cvt_pk_bf16_f32 v66, v68, v69
    v_cvt_pk_bf16_f32 v67, v70, v71
    v_mfma_f32_16x16x32_bf16 v[56:59], v[160:163], v[152:155], v[56:59]
    v_fma_f32 v88, -v198, v204, v88
    v_fma_f32 v89, -v198, v205, v89
    v_fma_f32 v90, -v198, v206, v90
    v_mfma_f32_16x16x32_bf16 v[60:63], v[164:167], v[152:155], v[60:63]
    v_fma_f32 v91, -v198, v207, v91
    v_fma_f32 v92, -v198, v208, v92
    v_fma_f32 v93, -v198, v209, v93
    v_mfma_f32_16x16x32_bf16 v[80:83], v[160:163], v[156:159], v[80:83]
    v_fma_f32 v94, -v198, v210, v94
    v_fma_f32 v95, -v198, v211, v95
    v_cvt_pk_bf16_f32 v88, v88, v89
    v_mfma_f32_16x16x32_bf16 v[84:87], v[164:167], v[156:159], v[84:87]
    v_cvt_pk_bf16_f32 v89, v90, v91
    v_cvt_pk_bf16_f32 v90, v92, v93
    v_cvt_pk_bf16_f32 v91, v94, v95
    ds_read_b128 v[120:123], v249 offset:0
    ds_read_b128 v[124:127], v249 offset:64
    s_waitcnt lgkmcnt(2)
    s_nop 0
    v_mfma_f32_16x16x32_bf16 v[144:147], v[224:227], v[16:19], 0
    v_mfma_f32_16x16x32_bf16 v[148:151], v[228:231], v[16:19], 0
    v_mfma_f32_16x16x32_bf16 v[152:155], v[224:227], v[40:43], 0
    v_mfma_f32_16x16x32_bf16 v[156:159], v[228:231], v[40:43], 0
    v_mfma_f32_16x16x32_bf16 v[160:163], v[224:227], v[64:67], 0
    v_mfma_f32_16x16x32_bf16 v[164:167], v[228:231], v[64:67], 0
    v_mfma_f32_16x16x32_bf16 v[168:171], v[224:227], v[88:91], 0
    v_mfma_f32_16x16x32_bf16 v[172:175], v[228:231], v[88:91], 0
    v_pk_fma_f32 v[24:25], v[104:105], v[248:249], v[24:25] op_sel_hi:[1,0,1] neg_lo:[1,0,0] neg_hi:[1,0,0]
    v_pk_fma_f32 v[26:27], v[106:107], v[248:249], v[26:27] op_sel_hi:[1,0,1] neg_lo:[1,0,0] neg_hi:[1,0,0]
    v_pk_fma_f32 v[28:29], v[104:105], v[250:251], v[28:29] op_sel_hi:[1,0,1] neg_lo:[1,0,0] neg_hi:[1,0,0]
    v_pk_fma_f32 v[30:31], v[106:107], v[250:251], v[30:31] op_sel_hi:[1,0,1] neg_lo:[1,0,0] neg_hi:[1,0,0]
    v_pk_fma_f32 v[48:49], v[108:109], v[248:249], v[48:49] op_sel_hi:[1,0,1] neg_lo:[1,0,0] neg_hi:[1,0,0]
    v_pk_fma_f32 v[50:51], v[110:111], v[248:249], v[50:51] op_sel_hi:[1,0,1] neg_lo:[1,0,0] neg_hi:[1,0,0]
    v_pk_fma_f32 v[52:53], v[108:109], v[250:251], v[52:53] op_sel_hi:[1,0,1] neg_lo:[1,0,0] neg_hi:[1,0,0]
    v_pk_fma_f32 v[54:55], v[110:111], v[250:251], v[54:55] op_sel_hi:[1,0,1] neg_lo:[1,0,0] neg_hi:[1,0,0]
    v_pk_fma_f32 v[72:73], v[112:113], v[248:249], v[72:73] op_sel_hi:[1,0,1] neg_lo:[1,0,0] neg_hi:[1,0,0]
    v_pk_fma_f32 v[74:75], v[114:115], v[248:249], v[74:75] op_sel_hi:[1,0,1] neg_lo:[1,0,0] neg_hi:[1,0,0]
    v_pk_fma_f32 v[76:77], v[112:113], v[250:251], v[76:77] op_sel_hi:[1,0,1] neg_lo:[1,0,0] neg_hi:[1,0,0]
    v_pk_fma_f32 v[78:79], v[114:115], v[250:251], v[78:79] op_sel_hi:[1,0,1] neg_lo:[1,0,0] neg_hi:[1,0,0]
    v_pk_fma_f32 v[96:97], v[116:117], v[248:249], v[96:97] op_sel_hi:[1,0,1] neg_lo:[1,0,0] neg_hi:[1,0,0]
    v_pk_fma_f32 v[98:99], v[118:119], v[248:249], v[98:99] op_sel_hi:[1,0,1] neg_lo:[1,0,0] neg_hi:[1,0,0]
    v_pk_fma_f32 v[100:101], v[116:117], v[250:251], v[100:101] op_sel_hi:[1,0,1] neg_lo:[1,0,0] neg_hi:[1,0,0]
    v_pk_fma_f32 v[102:103], v[118:119], v[250:251], v[102:103] op_sel_hi:[1,0,1] neg_lo:[1,0,0] neg_hi:[1,0,0]
    v_cvt_pk_bf16_f32 v24, v24, v25
    v_cvt_pk_bf16_f32 v25, v26, v27
    v_cvt_pk_bf16_f32 v26, v48, v49
    v_cvt_pk_bf16_f32 v27, v50, v51
    v_cvt_pk_bf16_f32 v28, v28, v29
    v_cvt_pk_bf16_f32 v29, v30, v31
    v_cvt_pk_bf16_f32 v30, v52, v53
    v_cvt_pk_bf16_f32 v31, v54, v55
    v_cvt_pk_bf16_f32 v72, v72, v73
    v_cvt_pk_bf16_f32 v73, v74, v75
    v_cvt_pk_bf16_f32 v74, v96, v97
    v_cvt_pk_bf16_f32 v75, v98, v99
    v_cvt_pk_bf16_f32 v76, v76, v77
    v_cvt_pk_bf16_f32 v77, v78, v79
    v_cvt_pk_bf16_f32 v78, v100, v101
    v_cvt_pk_bf16_f32 v79, v102, v103
    ds_read_b128 v[104:107], v253 offset:0
    ds_read_b128 v[108:111], v253 offset:64
    v_max3_f32 v176, v144, v145, v146
    v_max3_f32 v184, -v144, -v145, -v146
    v_max3_f32 v178, v152, v153, v154
    v_max3_f32 v186, -v152, -v153, -v154
    v_max3_f32 v176, v176, v147, v148
    v_max3_f32 v184, v184, -v147, -v148
    v_max3_f32 v178, v178, v155, v156
    v_max3_f32 v186, v186, -v155, -v156
    v_max3_f32 v176, v176, v149, v150
    v_max3_f32 v184, v184, -v149, -v150
    v_max3_f32 v178, v178, v157, v158
    v_max3_f32 v186, v186, -v157, -v158
    v_max_f32_e64 v176, v176, v151
    v_max_f32_e64 v184, v184, -v151
    v_max_f32_e64 v178, v178, v159
    v_max_f32_e64 v186, v186, -v159
    s_nop 0
    v_permlane32_swap_b32 v176, v178
    v_permlane32_swap_b32_e64 v184, v186
    v_max3_f32 v180, v160, v161, v162
    v_max3_f32 v188, -v160, -v161, -v162
    v_max_f32 v176, v176, v178
    v_max_f32 v184, v184, v186
    v_max3_f32 v182, v168, v169, v170
    v_max3_f32 v190, -v168, -v169, -v170
    v_permlane16_swap_b32 v176, v184
    v_max_f32 v176, v176, v184
    v_max3_f32 v180, v180, v163, v164
    v_max3_f32 v188, v188, -v163, -v164
    v_mul_f32 v184, v176, v193
    v_mul_f32 v176, v176, v193
    v_max3_f32 v182, v182, v171, v172
    v_max3_f32 v190, v190, -v171, -v172
    v_permlane16_swap_b32 v176, v184
    v_mov_b32 v178, v176
    v_max3_f32 v180, v180, v165, v166
    v_max3_f32 v188, v188, -v165, -v166
    v_mov_b32_e64 v186, v184
    v_max3_f32 v182, v182, v173, v174
    v_max3_f32 v190, v190, -v173, -v174
    v_permlane32_swap_b32 v176, v178
    v_permlane32_swap_b32 v184, v186
    v_max_f32_e64 v180, v180, v167
    v_max_f32_e64 v188, v188, -v167
    v_max_f32_e64 v182, v182, v175
    v_max_f32_e64 v190, v190, -v175
    s_nop 0
    v_permlane32_swap_b32 v180, v182
    v_permlane32_swap_b32_e64 v188, v190
    v_pk_fma_f32 v[16:17], v[144:145], v[200:201], v[184:185] op_sel_hi:[1,0,0] neg_lo:[1,0,1] neg_hi:[1,0,1]
    v_pk_fma_f32 v[144:145], v[144:145], v[200:201], v[176:177] op_sel_hi:[1,0,0] neg_lo:[0,0,1] neg_hi:[0,0,1]
    v_max_f32 v180, v180, v182
    v_max_f32 v188, v188, v190
    v_pk_fma_f32 v[18:19], v[146:147], v[200:201], v[184:185] op_sel_hi:[1,0,0] neg_lo:[1,0,1] neg_hi:[1,0,1]
    v_pk_fma_f32 v[146:147], v[146:147], v[200:201], v[176:177] op_sel_hi:[1,0,0] neg_lo:[0,0,1] neg_hi:[0,0,1]
    v_permlane16_swap_b32 v180, v188
    v_max_f32 v180, v180, v188
    v_pk_fma_f32 v[20:21], v[148:149], v[200:201], v[184:185] op_sel_hi:[1,0,0] neg_lo:[1,0,1] neg_hi:[1,0,1]
    v_pk_fma_f32 v[148:149], v[148:149], v[200:201], v[176:177] op_sel_hi:[1,0,0] neg_lo:[0,0,1] neg_hi:[0,0,1]
    v_mul_f32 v188, v180, v221
    v_mul_f32 v180, v180, v221
    v_pk_fma_f32 v[22:23], v[150:151], v[200:201], v[184:185] op_sel_hi:[1,0,0] neg_lo:[1,0,1] neg_hi:[1,0,1]
    v_pk_fma_f32 v[150:151], v[150:151], v[200:201], v[176:177] op_sel_hi:[1,0,0] neg_lo:[0,0,1] neg_hi:[0,0,1]
    v_permlane16_swap_b32 v180, v188
    v_mov_b32 v182, v180
    v_pk_fma_f32 v[40:41], v[152:153], v[202:203], v[186:187] op_sel_hi:[1,0,0] neg_lo:[1,0,1] neg_hi:[1,0,1]
    v_pk_fma_f32 v[152:153], v[152:153], v[202:203], v[178:179] op_sel_hi:[1,0,0] neg_lo:[0,0,1] neg_hi:[0,0,1]
    v_mov_b32_e64 v190, v188
    v_pk_fma_f32 v[42:43], v[154:155], v[202:203], v[186:187] op_sel_hi:[1,0,0] neg_lo:[1,0,1] neg_hi:[1,0,1]
    v_pk_fma_f32 v[154:155], v[154:155], v[202:203], v[178:179] op_sel_hi:[1,0,0] neg_lo:[0,0,1] neg_hi:[0,0,1]
    v_permlane32_swap_b32 v180, v182
    v_permlane32_swap_b32 v188, v190
    v_pk_fma_f32 v[44:45], v[156:157], v[202:203], v[186:187] op_sel_hi:[1,0,0] neg_lo:[1,0,1] neg_hi:[1,0,1]
    v_pk_fma_f32 v[156:157], v[156:157], v[202:203], v[178:179] op_sel_hi:[1,0,0] neg_lo:[0,0,1] neg_hi:[0,0,1]
    v_pk_fma_f32 v[46:47], v[158:159], v[202:203], v[186:187] op_sel_hi:[1,0,0] neg_lo:[1,0,1] neg_hi:[1,0,1]
    v_pk_fma_f32 v[158:159], v[158:159], v[202:203], v[178:179] op_sel_hi:[1,0,0] neg_lo:[0,0,1] neg_hi:[0,0,1]
    v_exp_f32 v16, v16
    v_exp_f32 v144, v144
    v_exp_f32 v17, v17
    v_exp_f32 v145, v145
    v_exp_f32 v18, v18
    v_exp_f32 v146, v146
    v_exp_f32 v19, v19
    v_exp_f32 v147, v147
    v_exp_f32 v20, v20
    v_exp_f32 v148, v148
    v_exp_f32 v21, v21
    v_exp_f32 v149, v149
    v_exp_f32 v22, v22
    v_exp_f32 v150, v150
    v_exp_f32 v23, v23
    v_exp_f32 v151, v151
    v_exp_f32 v40, v40
    v_exp_f32 v152, v152
    v_exp_f32 v41, v41
    v_exp_f32 v153, v153
    v_exp_f32 v42, v42
    v_exp_f32 v154, v154
    v_exp_f32 v43, v43
    v_exp_f32 v155, v155
    v_exp_f32 v44, v44
    v_exp_f32 v156, v156
    v_exp_f32 v45, v45
    v_exp_f32 v157, v157
    v_exp_f32 v46, v46
    v_exp_f32 v158, v158
    v_exp_f32 v47, v47
    v_exp_f32 v159, v159
    v_pk_add_f32 v[128:129], v[144:145], v[146:147]
    v_pk_add_f32 v[130:131], v[16:17], v[18:19]
    v_pk_add_f32 v[132:133], v[152:153], v[154:155]
    v_pk_add_f32 v[134:135], v[40:41], v[42:43]
    v_pk_add_f32 v[128:129], v[128:129], v[148:149]
    v_pk_add_f32 v[130:131], v[130:131], v[20:21]
    v_pk_add_f32 v[132:133], v[132:133], v[156:157]
    v_pk_add_f32 v[134:135], v[134:135], v[44:45]
    v_pk_add_f32 v[128:129], v[128:129], v[150:151]
    v_pk_add_f32 v[130:131], v[130:131], v[22:23]
    v_pk_add_f32 v[132:133], v[132:133], v[158:159]
    v_pk_add_f32 v[134:135], v[134:135], v[46:47]
    v_add_f32 v176, v128, v129
    v_add_f32 v184, v130, v131
    v_add_f32 v178, v132, v133
    v_add_f32 v186, v134, v135
    s_nop 0
    v_permlane32_swap_b32 v176, v178
    v_permlane32_swap_b32_e64 v184, v186
    v_pk_fma_f32 v[64:65], v[160:161], v[220:221], v[188:189] op_sel_hi:[1,0,0] neg_lo:[1,0,1] neg_hi:[1,0,1]
    v_pk_fma_f32 v[160:161], v[160:161], v[220:221], v[180:181] op_sel_hi:[1,0,0] neg_lo:[0,0,1] neg_hi:[0,0,1]
    v_add_f32 v176, v176, v178
    v_add_f32 v184, v184, v186
    v_pk_fma_f32 v[66:67], v[162:163], v[220:221], v[188:189] op_sel_hi:[1,0,0] neg_lo:[1,0,1] neg_hi:[1,0,1]
    v_pk_fma_f32 v[162:163], v[162:163], v[220:221], v[180:181] op_sel_hi:[1,0,0] neg_lo:[0,0,1] neg_hi:[0,0,1]
    v_permlane16_swap_b32 v176, v184
    v_add_f32 v176, v176, v184
    v_pk_fma_f32 v[68:69], v[164:165], v[220:221], v[188:189] op_sel_hi:[1,0,0] neg_lo:[1,0,1] neg_hi:[1,0,1]
    v_pk_fma_f32 v[164:165], v[164:165], v[220:221], v[180:181] op_sel_hi:[1,0,0] neg_lo:[0,0,1] neg_hi:[0,0,1]
    v_rcp_f32_e64 v176, v176
    v_pk_fma_f32 v[70:71], v[166:167], v[220:221], v[188:189] op_sel_hi:[1,0,0] neg_lo:[1,0,1] neg_hi:[1,0,1]
    v_pk_fma_f32 v[166:167], v[166:167], v[220:221], v[180:181] op_sel_hi:[1,0,0] neg_lo:[0,0,1] neg_hi:[0,0,1]
    v_mul_f32 v184, v176, v195
    v_mul_f32 v176, v176, v195
    v_pk_fma_f32 v[88:89], v[168:169], v[222:223], v[190:191] op_sel_hi:[1,0,0] neg_lo:[1,0,1] neg_hi:[1,0,1]
    v_pk_fma_f32 v[168:169], v[168:169], v[222:223], v[182:183] op_sel_hi:[1,0,0] neg_lo:[0,0,1] neg_hi:[0,0,1]
    v_permlane16_swap_b32 v176, v184
    v_mov_b32 v178, v176
    v_pk_fma_f32 v[90:91], v[170:171], v[222:223], v[190:191] op_sel_hi:[1,0,0] neg_lo:[1,0,1] neg_hi:[1,0,1]
    v_pk_fma_f32 v[170:171], v[170:171], v[222:223], v[182:183] op_sel_hi:[1,0,0] neg_lo:[0,0,1] neg_hi:[0,0,1]
    v_mov_b32_e64 v186, v184
    v_pk_fma_f32 v[92:93], v[172:173], v[222:223], v[190:191] op_sel_hi:[1,0,0] neg_lo:[1,0,1] neg_hi:[1,0,1]
    v_pk_fma_f32 v[172:173], v[172:173], v[222:223], v[182:183] op_sel_hi:[1,0,0] neg_lo:[0,0,1] neg_hi:[0,0,1]
    v_permlane32_swap_b32 v176, v178
    v_permlane32_swap_b32 v184, v186
    v_pk_fma_f32 v[94:95], v[174:175], v[222:223], v[190:191] op_sel_hi:[1,0,0] neg_lo:[1,0,1] neg_hi:[1,0,1]
    v_pk_fma_f32 v[174:175], v[174:175], v[222:223], v[182:183] op_sel_hi:[1,0,0] neg_lo:[0,0,1] neg_hi:[0,0,1]
    v_pk_mul_f32 v[144:145], v[144:145], v[176:177] op_sel_hi:[1,0]
    v_pk_mul_f32 v[146:147], v[146:147], v[176:177] op_sel_hi:[1,0]
    v_pk_mul_f32 v[148:149], v[148:149], v[176:177] op_sel_hi:[1,0]
    v_pk_mul_f32 v[150:151], v[150:151], v[176:177] op_sel_hi:[1,0]
    v_cvt_pk_bf16_f32 v144, v144, v145
    v_cvt_pk_bf16_f32 v145, v146, v147
    v_cvt_pk_bf16_f32 v146, v148, v149
    v_cvt_pk_bf16_f32 v147, v150, v151
    ds_write_b64 v4, v[144:145] offset:0
    ds_write_b64 v5, v[146:147] offset:0
    ds_write_b128 v197, v[24:27] offset:0
    v_pk_mul_f32 v[16:17], v[16:17], v[184:185] op_sel_hi:[1,0]
    v_pk_mul_f32 v[18:19], v[18:19], v[184:185] op_sel_hi:[1,0]
    v_pk_mul_f32 v[20:21], v[20:21], v[184:185] op_sel_hi:[1,0]
    v_pk_mul_f32 v[22:23], v[22:23], v[184:185] op_sel_hi:[1,0]
    v_cvt_pk_bf16_f32 v16, v16, v17
    v_cvt_pk_bf16_f32 v17, v18, v19
    v_cvt_pk_bf16_f32 v18, v20, v21
    v_cvt_pk_bf16_f32 v19, v22, v23
    ds_write_b64 v6, v[16:17] offset:0
    ds_write_b64 v7, v[18:19] offset:0
    ds_write_b128 v197, v[28:31] offset:1024
    v_pk_mul_f32 v[152:153], v[152:153], v[178:179] op_sel_hi:[1,0]
    v_pk_mul_f32 v[154:155], v[154:155], v[178:179] op_sel_hi:[1,0]
    v_pk_mul_f32 v[156:157], v[156:157], v[178:179] op_sel_hi:[1,0]
    v_pk_mul_f32 v[158:159], v[158:159], v[178:179] op_sel_hi:[1,0]
    v_cvt_pk_bf16_f32 v152, v152, v153
    v_cvt_pk_bf16_f32 v153, v154, v155
    v_cvt_pk_bf16_f32 v154, v156, v157
    v_cvt_pk_bf16_f32 v155, v158, v159
    ds_write_b64 v4, v[152:153] offset:2048
    ds_write_b64 v5, v[154:155] offset:2048
    ds_write_b128 v197, v[72:75] offset:2048
    v_pk_mul_f32 v[40:41], v[40:41], v[186:187] op_sel_hi:[1,0]
    v_pk_mul_f32 v[42:43], v[42:43], v[186:187] op_sel_hi:[1,0]
    v_pk_mul_f32 v[44:45], v[44:45], v[186:187] op_sel_hi:[1,0]
    v_pk_mul_f32 v[46:47], v[46:47], v[186:187] op_sel_hi:[1,0]
    v_cvt_pk_bf16_f32 v40, v40, v41
    v_cvt_pk_bf16_f32 v41, v42, v43
    v_cvt_pk_bf16_f32 v42, v44, v45
    v_cvt_pk_bf16_f32 v43, v46, v47
    ds_write_b64 v6, v[40:41] offset:2048
    ds_write_b64 v7, v[42:43] offset:2048
    ds_write_b128 v197, v[76:79] offset:3072
    ds_read_b64_tr_b16 v[232:233], v201 offset:0
    ds_read_b64_tr_b16 v[234:235], v201 offset:2048
    ds_read_b64_tr_b16 v[236:237], v203 offset:0
    ds_read_b64_tr_b16 v[238:239], v203 offset:2048
    v_exp_f32 v64, v64
    v_exp_f32 v160, v160
    v_exp_f32 v65, v65
    v_exp_f32 v161, v161
    v_exp_f32 v66, v66
    v_exp_f32 v162, v162
    v_exp_f32 v67, v67
    v_exp_f32 v163, v163
    v_exp_f32 v68, v68
    v_exp_f32 v164, v164
    v_exp_f32 v69, v69
    v_exp_f32 v165, v165
    v_exp_f32 v70, v70
    v_exp_f32 v166, v166
    v_exp_f32 v71, v71
    v_exp_f32 v167, v167
    v_exp_f32 v88, v88
    v_exp_f32 v168, v168
    v_exp_f32 v89, v89
    v_exp_f32 v169, v169
    v_exp_f32 v90, v90
    v_exp_f32 v170, v170
    v_exp_f32 v91, v91
    v_exp_f32 v171, v171
    v_exp_f32 v92, v92
    v_exp_f32 v172, v172
    v_exp_f32 v93, v93
    v_exp_f32 v173, v173
    v_exp_f32 v94, v94
    v_exp_f32 v174, v174
    v_exp_f32 v95, v95
    v_exp_f32 v175, v175
    s_mov_b64 exec, 1
    buffer_store_dword v251, v199, s[48:51], s76 offen sc1
    s_mov_b64 exec, -1
    v_pk_add_f32 v[136:137], v[160:161], v[162:163]
    v_pk_add_f32 v[138:139], v[64:65], v[66:67]
    v_pk_add_f32 v[140:141], v[168:169], v[170:171]
    v_pk_add_f32 v[142:143], v[88:89], v[90:91]
    v_pk_add_f32 v[136:137], v[136:137], v[164:165]
    v_pk_add_f32 v[138:139], v[138:139], v[68:69]
    v_pk_add_f32 v[140:141], v[140:141], v[172:173]
    v_pk_add_f32 v[142:143], v[142:143], v[92:93]
    v_pk_add_f32 v[136:137], v[136:137], v[166:167]
    v_pk_add_f32 v[138:139], v[138:139], v[70:71]
    v_pk_add_f32 v[140:141], v[140:141], v[174:175]
    v_pk_add_f32 v[142:143], v[142:143], v[94:95]
    v_add_f32 v180, v136, v137
    v_add_f32 v188, v138, v139
    v_add_f32 v182, v140, v141
    v_add_f32 v190, v142, v143
    s_nop 0
    v_permlane32_swap_b32 v180, v182
    v_permlane32_swap_b32 v188, v190
    s_waitcnt lgkmcnt(0)
    s_nop 0
    v_mfma_f32_16x16x32_bf16 v[144:147], v[232:235], v[24:27], 0
    v_add_f32 v180, v180, v182
    v_add_f32 v188, v188, v190
    v_mfma_f32_16x16x32_bf16 v[148:151], v[236:239], v[24:27], 0
    s_nop 0
    v_permlane16_swap_b32 v180, v188
    v_add_f32 v180, v180, v188
    v_mfma_f32_16x16x32_bf16 v[152:155], v[232:235], v[28:31], 0
    v_rcp_f32_e64 v180, v180
    v_mfma_f32_16x16x32_bf16 v[156:159], v[236:239], v[28:31], 0
    v_mul_f32 v188, v180, v223
    v_mul_f32 v180, v180, v223
    v_mfma_f32_16x16x32_bf16 v[16:19], v[232:235], v[120:123], 0
    s_nop 0
    v_permlane16_swap_b32 v180, v188
    v_mov_b32_e64 v182, v180
    v_mfma_f32_16x16x32_bf16 v[20:23], v[236:239], v[120:123], 0
    v_mov_b32_e64 v190, v188
    v_permlane32_swap_b32 v180, v182
    s_nop 0
    v_permlane32_swap_b32_e64 v188, v190
    v_pk_mul_f32 v[160:161], v[160:161], v[180:181] op_sel_hi:[1,0]
    v_pk_mul_f32 v[162:163], v[162:163], v[180:181] op_sel_hi:[1,0]
    v_pk_mul_f32 v[164:165], v[164:165], v[180:181] op_sel_hi:[1,0]
    v_pk_mul_f32 v[166:167], v[166:167], v[180:181] op_sel_hi:[1,0]
    v_cvt_pk_bf16_f32 v160, v160, v161
    v_cvt_pk_bf16_f32 v161, v162, v163
    v_cvt_pk_bf16_f32 v162, v164, v165
    v_cvt_pk_bf16_f32 v163, v166, v167
    ds_write_b64 v4, v[160:161] offset:4096
    ds_write_b64 v5, v[162:163] offset:4096
    v_pk_mul_f32 v[64:65], v[64:65], v[188:189] op_sel_hi:[1,0]
    v_pk_mul_f32 v[66:67], v[66:67], v[188:189] op_sel_hi:[1,0]
    v_pk_mul_f32 v[68:69], v[68:69], v[188:189] op_sel_hi:[1,0]
    v_pk_mul_f32 v[70:71], v[70:71], v[188:189] op_sel_hi:[1,0]
    v_cvt_pk_bf16_f32 v64, v64, v65
    v_cvt_pk_bf16_f32 v65, v66, v67
    v_cvt_pk_bf16_f32 v66, v68, v69
    v_cvt_pk_bf16_f32 v67, v70, v71
    ds_write_b64 v6, v[64:65] offset:4096
    ds_write_b64 v7, v[66:67] offset:4096
    v_pk_mul_f32 v[168:169], v[168:169], v[182:183] op_sel_hi:[1,0]
    v_pk_mul_f32 v[170:171], v[170:171], v[182:183] op_sel_hi:[1,0]
    v_pk_mul_f32 v[172:173], v[172:173], v[182:183] op_sel_hi:[1,0]
    v_pk_mul_f32 v[174:175], v[174:175], v[182:183] op_sel_hi:[1,0]
    v_cvt_pk_bf16_f32 v168, v168, v169
    v_cvt_pk_bf16_f32 v169, v170, v171
    v_cvt_pk_bf16_f32 v170, v172, v173
    v_cvt_pk_bf16_f32 v171, v174, v175
    ds_write_b64 v4, v[168:169] offset:6144
    ds_write_b64 v5, v[170:171] offset:6144
    v_pk_mul_f32 v[88:89], v[88:89], v[190:191] op_sel_hi:[1,0]
    v_pk_mul_f32 v[90:91], v[90:91], v[190:191] op_sel_hi:[1,0]
    v_pk_mul_f32 v[92:93], v[92:93], v[190:191] op_sel_hi:[1,0]
    v_pk_mul_f32 v[94:95], v[94:95], v[190:191] op_sel_hi:[1,0]
    v_cvt_pk_bf16_f32 v88, v88, v89
    v_cvt_pk_bf16_f32 v89, v90, v91
    v_cvt_pk_bf16_f32 v90, v92, v93
    v_cvt_pk_bf16_f32 v91, v94, v95
    ds_write_b64 v6, v[88:89] offset:6144
    ds_write_b64 v7, v[90:91] offset:6144
    ds_read_b64_tr_b16 v[204:205], v201 offset:4096
    ds_read_b64_tr_b16 v[206:207], v201 offset:6144
    ds_read_b64_tr_b16 v[208:209], v203 offset:4096
    ds_read_b64_tr_b16 v[210:211], v203 offset:6144
    v_xor_b32 v201, 0x2000, v201
    v_xor_b32 v203, 0x2000, v203
    v_xor_b32 v197, 0x1000, v197
    s_waitcnt lgkmcnt(4)
    s_barrier
    ds_read_b64_tr_b16 v[128:129], v201 offset:0
    ds_read_b64_tr_b16 v[130:131], v201 offset:2048
    ds_read_b64_tr_b16 v[132:133], v203 offset:0
    ds_read_b64_tr_b16 v[134:135], v203 offset:2048
    ds_read_b128 v[48:51], v197 offset:0
    ds_read_b128 v[52:55], v197 offset:1024
    ds_read_b64_tr_b16 v[136:137], v201 offset:4096
    ds_read_b64_tr_b16 v[138:139], v201 offset:6144
    ds_read_b64_tr_b16 v[140:141], v203 offset:4096
    ds_read_b64_tr_b16 v[142:143], v203 offset:6144
    ds_read_b128 v[96:99], v197 offset:2048
    ds_read_b128 v[100:103], v197 offset:3072
    s_waitcnt lgkmcnt(12)
    s_nop 0
    v_mfma_f32_16x16x32_bf16 v[144:147], v[204:207], v[72:75], v[144:147]
    v_mfma_f32_16x16x32_bf16 v[148:151], v[208:211], v[72:75], v[148:151]
    v_mfma_f32_16x16x32_bf16 v[152:155], v[204:207], v[76:79], v[152:155]
    v_mfma_f32_16x16x32_bf16 v[156:159], v[208:211], v[76:79], v[156:159]
    v_mfma_f32_16x16x32_bf16 v[16:19], v[204:207], v[124:127], v[16:19]
    v_mfma_f32_16x16x32_bf16 v[20:23], v[208:211], v[124:127], v[20:23]
    s_waitcnt lgkmcnt(6)
    s_nop 0
    v_mfma_f32_16x16x32_bf16 v[144:147], v[128:131], v[48:51], v[144:147]
    v_mfma_f32_16x16x32_bf16 v[148:151], v[132:135], v[48:51], v[148:151]
    v_mfma_f32_16x16x32_bf16 v[152:155], v[128:131], v[52:55], v[152:155]
    v_mfma_f32_16x16x32_bf16 v[156:159], v[132:135], v[52:55], v[156:159]
    v_mfma_f32_16x16x32_bf16 v[16:19], v[128:131], v[104:107], v[16:19]
    v_mfma_f32_16x16x32_bf16 v[20:23], v[132:135], v[104:107], v[20:23]
    s_waitcnt lgkmcnt(0)
    s_nop 0
    v_mfma_f32_16x16x32_bf16 v[144:147], v[136:139], v[96:99], v[144:147]
    v_mfma_f32_16x16x32_bf16 v[148:151], v[140:143], v[96:99], v[148:151]
    v_mfma_f32_16x16x32_bf16 v[152:155], v[136:139], v[100:103], v[152:155]
    v_mfma_f32_16x16x32_bf16 v[156:159], v[140:143], v[100:103], v[156:159]
    v_mfma_f32_16x16x32_bf16 v[16:19], v[136:139], v[108:111], v[16:19]
    v_mfma_f32_16x16x32_bf16 v[20:23], v[140:143], v[108:111], v[20:23]
    ds_read_b64_tr_b16 v[224:225], v252 offset:8192
    ds_read_b64_tr_b16 v[226:227], v252 offset:9216
    ds_read_b64_tr_b16 v[228:229], v252 offset:8224
    ds_read_b64_tr_b16 v[230:231], v252 offset:9248
    s_xor_b32 s67, s67, 8
    s_lshl_b32 s3, s38, 2
    s_add_u32 s3, s3, 162112
    v_mov_b32 v4, s3
    v_mov_b32 v5, 1
    v_cvt_pk_bf16_f32 v144, v144, v145
    v_cvt_pk_bf16_f32 v145, v146, v147
    v_cvt_pk_bf16_f32 v146, v148, v149
    v_cvt_pk_bf16_f32 v147, v150, v151
    buffer_store_dwordx4 v[144:147], v199, s[48:51], s74 offen offset:0 sc1
    v_cvt_pk_bf16_f32 v152, v152, v153
    v_cvt_pk_bf16_f32 v153, v154, v155
    v_cvt_pk_bf16_f32 v154, v156, v157
    v_cvt_pk_bf16_f32 v155, v158, v159
    buffer_store_dwordx4 v[152:155], v199, s[48:51], s74 offen offset:1024 sc1
    v_cvt_pk_bf16_f32 v16, v16, v17
    v_cvt_pk_bf16_f32 v17, v18, v19
    v_cvt_pk_bf16_f32 v18, v20, v21
    v_cvt_pk_bf16_f32 v19, v22, v23
    s_mov_b32 exec_lo, 0x00010001
    s_mov_b32 exec_hi, 0x00010001
    buffer_store_dwordx4 v[16:19], v1, s[48:51], s75 offen sc1
    s_mov_b64 exec, -1
    ds_write_b32 v4, v5
    s_setprio 0
    v_pk_fma_f32 v[8:9], v[192:193], v[212:213], v[8:9] op_sel_hi:[0,1,1] neg_lo:[1,0,0] neg_hi:[1,0,0]
    v_pk_fma_f32 v[10:11], v[192:193], v[214:215], v[10:11] op_sel_hi:[0,1,1] neg_lo:[1,0,0] neg_hi:[1,0,0]
    v_pk_fma_f32 v[12:13], v[192:193], v[216:217], v[12:13] op_sel_hi:[0,1,1] neg_lo:[1,0,0] neg_hi:[1,0,0]
    v_pk_fma_f32 v[14:15], v[192:193], v[218:219], v[14:15] op_sel_hi:[0,1,1] neg_lo:[1,0,0] neg_hi:[1,0,0]
    v_cvt_pk_bf16_f32 v8, v8, v9
    v_cvt_pk_bf16_f32 v9, v10, v11
    v_cvt_pk_bf16_f32 v10, v12, v13
    v_cvt_pk_bf16_f32 v11, v14, v15
    v_pk_fma_f32 v[32:33], v[194:195], v[212:213], v[32:33] op_sel_hi:[0,1,1] neg_lo:[1,0,0] neg_hi:[1,0,0]
    v_pk_fma_f32 v[34:35], v[194:195], v[214:215], v[34:35] op_sel_hi:[0,1,1] neg_lo:[1,0,0] neg_hi:[1,0,0]
    v_pk_fma_f32 v[36:37], v[194:195], v[216:217], v[36:37] op_sel_hi:[0,1,1] neg_lo:[1,0,0] neg_hi:[1,0,0]
    v_pk_fma_f32 v[38:39], v[194:195], v[218:219], v[38:39] op_sel_hi:[0,1,1] neg_lo:[1,0,0] neg_hi:[1,0,0]
    v_cvt_pk_bf16_f32 v32, v32, v33
    v_cvt_pk_bf16_f32 v33, v34, v35
    v_cvt_pk_bf16_f32 v34, v36, v37
    v_cvt_pk_bf16_f32 v35, v38, v39
    v_pk_fma_f32 v[56:57], v[196:197], v[212:213], v[56:57] op_sel_hi:[0,1,1] neg_lo:[1,0,0] neg_hi:[1,0,0]
    v_pk_fma_f32 v[58:59], v[196:197], v[214:215], v[58:59] op_sel_hi:[0,1,1] neg_lo:[1,0,0] neg_hi:[1,0,0]
    v_pk_fma_f32 v[60:61], v[196:197], v[216:217], v[60:61] op_sel_hi:[0,1,1] neg_lo:[1,0,0] neg_hi:[1,0,0]
    v_pk_fma_f32 v[62:63], v[196:197], v[218:219], v[62:63] op_sel_hi:[0,1,1] neg_lo:[1,0,0] neg_hi:[1,0,0]
    v_cvt_pk_bf16_f32 v56, v56, v57
    v_cvt_pk_bf16_f32 v57, v58, v59
    v_cvt_pk_bf16_f32 v58, v60, v61
    v_cvt_pk_bf16_f32 v59, v62, v63
    v_pk_fma_f32 v[80:81], v[198:199], v[212:213], v[80:81] op_sel_hi:[0,1,1] neg_lo:[1,0,0] neg_hi:[1,0,0]
    v_pk_fma_f32 v[82:83], v[198:199], v[214:215], v[82:83] op_sel_hi:[0,1,1] neg_lo:[1,0,0] neg_hi:[1,0,0]
    v_pk_fma_f32 v[84:85], v[198:199], v[216:217], v[84:85] op_sel_hi:[0,1,1] neg_lo:[1,0,0] neg_hi:[1,0,0]
    v_pk_fma_f32 v[86:87], v[198:199], v[218:219], v[86:87] op_sel_hi:[0,1,1] neg_lo:[1,0,0] neg_hi:[1,0,0]
    v_cvt_pk_bf16_f32 v80, v80, v81
    v_cvt_pk_bf16_f32 v81, v82, v83
    v_cvt_pk_bf16_f32 v82, v84, v85
    v_cvt_pk_bf16_f32 v83, v86, v87
    s_waitcnt lgkmcnt(1)
    s_nop 0
    v_mfma_f32_16x16x32_bf16 v[144:147], v[224:227], v[8:11], 0
    v_mfma_f32_16x16x32_bf16 v[148:151], v[228:231], v[8:11], 0
    v_mfma_f32_16x16x32_bf16 v[152:155], v[224:227], v[32:35], 0
    v_mfma_f32_16x16x32_bf16 v[156:159], v[228:231], v[32:35], 0
    v_mfma_f32_16x16x32_bf16 v[160:163], v[224:227], v[56:59], 0
    v_mfma_f32_16x16x32_bf16 v[164:167], v[228:231], v[56:59], 0
    v_mfma_f32_16x16x32_bf16 v[168:171], v[224:227], v[80:83], 0
    v_mfma_f32_16x16x32_bf16 v[172:175], v[228:231], v[80:83], 0
    s_nop 0
    s_nop 0
    v_max3_f32 v176, v144, v145, v146
    v_max3_f32 v184, -v144, -v145, -v146
    v_max3_f32 v178, v152, v153, v154
    v_max3_f32 v186, -v152, -v153, -v154
    v_max3_f32 v176, v176, v147, v148
    v_max3_f32 v184, v184, -v147, -v148
    v_max3_f32 v178, v178, v155, v156
    v_max3_f32 v186, v186, -v155, -v156
    v_max3_f32 v176, v176, v149, v150
    v_max3_f32 v184, v184, -v149, -v150
    v_max3_f32 v178, v178, v157, v158
    v_max3_f32 v186, v186, -v157, -v158
    v_max_f32_e64 v176, v176, v151
    v_max_f32_e64 v184, v184, -v151
    v_max_f32_e64 v178, v178, v159
    v_max_f32_e64 v186, v186, -v159
    s_nop 0
    v_permlane32_swap_b32 v176, v178
    v_permlane32_swap_b32_e64 v184, v186
    v_max3_f32 v180, v160, v161, v162
    v_max3_f32 v188, -v160, -v161, -v162
    v_max_f32 v176, v176, v178
    v_max_f32 v184, v184, v186
    v_max3_f32 v182, v168, v169, v170
    v_max3_f32 v190, -v168, -v169, -v170
    v_permlane16_swap_b32 v176, v184
    v_max_f32 v176, v176, v184
    v_max3_f32 v180, v180, v163, v164
    v_max3_f32 v188, v188, -v163, -v164
    v_mul_f32 v184, v176, v193
    v_mul_f32 v176, v176, v193
    v_max3_f32 v182, v182, v171, v172
    v_max3_f32 v190, v190, -v171, -v172
    v_permlane16_swap_b32 v176, v184
    v_mov_b32 v178, v176
    v_max3_f32 v180, v180, v165, v166
    v_max3_f32 v188, v188, -v165, -v166
    v_mov_b32_e64 v186, v184
    v_max3_f32 v182, v182, v173, v174
    v_max3_f32 v190, v190, -v173, -v174
    v_permlane32_swap_b32 v176, v178
    v_permlane32_swap_b32 v184, v186
    v_max_f32_e64 v180, v180, v167
    v_max_f32_e64 v188, v188, -v167
    v_max_f32_e64 v182, v182, v175
    v_max_f32_e64 v190, v190, -v175
    s_nop 0
    v_permlane32_swap_b32 v180, v182
    v_permlane32_swap_b32_e64 v188, v190
    v_pk_fma_f32 v[8:9], v[144:145], v[200:201], v[184:185] op_sel_hi:[1,0,0] neg_lo:[1,0,1] neg_hi:[1,0,1]
    v_pk_fma_f32 v[144:145], v[144:145], v[200:201], v[176:177] op_sel_hi:[1,0,0] neg_lo:[0,0,1] neg_hi:[0,0,1]
    v_max_f32 v180, v180, v182
    v_max_f32 v188, v188, v190
    v_pk_fma_f32 v[10:11], v[146:147], v[200:201], v[184:185] op_sel_hi:[1,0,0] neg_lo:[1,0,1] neg_hi:[1,0,1]
    v_pk_fma_f32 v[146:147], v[146:147], v[200:201], v[176:177] op_sel_hi:[1,0,0] neg_lo:[0,0,1] neg_hi:[0,0,1]
    v_permlane16_swap_b32 v180, v188
    v_max_f32 v180, v180, v188
    v_pk_fma_f32 v[12:13], v[148:149], v[200:201], v[184:185] op_sel_hi:[1,0,0] neg_lo:[1,0,1] neg_hi:[1,0,1]
    v_pk_fma_f32 v[148:149], v[148:149], v[200:201], v[176:177] op_sel_hi:[1,0,0] neg_lo:[0,0,1] neg_hi:[0,0,1]
    v_mul_f32 v188, v180, v221
    v_mul_f32 v180, v180, v221
    v_pk_fma_f32 v[14:15], v[150:151], v[200:201], v[184:185] op_sel_hi:[1,0,0] neg_lo:[1,0,1] neg_hi:[1,0,1]
    v_pk_fma_f32 v[150:151], v[150:151], v[200:201], v[176:177] op_sel_hi:[1,0,0] neg_lo:[0,0,1] neg_hi:[0,0,1]
    v_permlane16_swap_b32 v180, v188
    v_mov_b32 v182, v180
    v_pk_fma_f32 v[32:33], v[152:153], v[202:203], v[186:187] op_sel_hi:[1,0,0] neg_lo:[1,0,1] neg_hi:[1,0,1]
    v_pk_fma_f32 v[152:153], v[152:153], v[202:203], v[178:179] op_sel_hi:[1,0,0] neg_lo:[0,0,1] neg_hi:[0,0,1]
    v_mov_b32_e64 v190, v188
    v_pk_fma_f32 v[34:35], v[154:155], v[202:203], v[186:187] op_sel_hi:[1,0,0] neg_lo:[1,0,1] neg_hi:[1,0,1]
    v_pk_fma_f32 v[154:155], v[154:155], v[202:203], v[178:179] op_sel_hi:[1,0,0] neg_lo:[0,0,1] neg_hi:[0,0,1]
    v_permlane32_swap_b32 v180, v182
    v_permlane32_swap_b32 v188, v190
    v_pk_fma_f32 v[36:37], v[156:157], v[202:203], v[186:187] op_sel_hi:[1,0,0] neg_lo:[1,0,1] neg_hi:[1,0,1]
    v_pk_fma_f32 v[156:157], v[156:157], v[202:203], v[178:179] op_sel_hi:[1,0,0] neg_lo:[0,0,1] neg_hi:[0,0,1]
    v_pk_fma_f32 v[38:39], v[158:159], v[202:203], v[186:187] op_sel_hi:[1,0,0] neg_lo:[1,0,1] neg_hi:[1,0,1]
    v_pk_fma_f32 v[158:159], v[158:159], v[202:203], v[178:179] op_sel_hi:[1,0,0] neg_lo:[0,0,1] neg_hi:[0,0,1]
    v_exp_f32 v8, v8
    v_exp_f32 v144, v144
    v_exp_f32 v9, v9
    v_exp_f32 v145, v145
    v_exp_f32 v10, v10
    v_exp_f32 v146, v146
    v_exp_f32 v11, v11
    v_exp_f32 v147, v147
    v_exp_f32 v12, v12
    v_exp_f32 v148, v148
    v_exp_f32 v13, v13
    v_exp_f32 v149, v149
    v_exp_f32 v14, v14
    v_exp_f32 v150, v150
    v_exp_f32 v15, v15
    v_exp_f32 v151, v151
    v_exp_f32 v32, v32
    v_exp_f32 v152, v152
    v_exp_f32 v33, v33
    v_exp_f32 v153, v153
    v_exp_f32 v34, v34
    v_exp_f32 v154, v154
    v_exp_f32 v35, v35
    v_exp_f32 v155, v155
    v_exp_f32 v36, v36
    v_exp_f32 v156, v156
    v_exp_f32 v37, v37
    v_exp_f32 v157, v157
    v_exp_f32 v38, v38
    v_exp_f32 v158, v158
    v_exp_f32 v39, v39
    v_exp_f32 v159, v159
    v_pk_add_f32 v[128:129], v[144:145], v[146:147]
    v_pk_add_f32 v[130:131], v[8:9], v[10:11]
    v_pk_add_f32 v[132:133], v[152:153], v[154:155]
    v_pk_add_f32 v[134:135], v[32:33], v[34:35]
    v_pk_add_f32 v[128:129], v[128:129], v[148:149]
    v_pk_add_f32 v[130:131], v[130:131], v[12:13]
    v_pk_add_f32 v[132:133], v[132:133], v[156:157]
    v_pk_add_f32 v[134:135], v[134:135], v[36:37]
    v_pk_add_f32 v[128:129], v[128:129], v[150:151]
    v_pk_add_f32 v[130:131], v[130:131], v[14:15]
    v_pk_add_f32 v[132:133], v[132:133], v[158:159]
    v_pk_add_f32 v[134:135], v[134:135], v[38:39]
    v_add_f32 v176, v128, v129
    v_add_f32 v184, v130, v131
    v_add_f32 v178, v132, v133
    v_add_f32 v186, v134, v135
    s_nop 0
    v_permlane32_swap_b32 v176, v178
    v_permlane32_swap_b32_e64 v184, v186
    v_pk_fma_f32 v[56:57], v[160:161], v[220:221], v[188:189] op_sel_hi:[1,0,0] neg_lo:[1,0,1] neg_hi:[1,0,1]
    v_pk_fma_f32 v[160:161], v[160:161], v[220:221], v[180:181] op_sel_hi:[1,0,0] neg_lo:[0,0,1] neg_hi:[0,0,1]
    v_add_f32 v176, v176, v178
    v_add_f32 v184, v184, v186
    v_pk_fma_f32 v[58:59], v[162:163], v[220:221], v[188:189] op_sel_hi:[1,0,0] neg_lo:[1,0,1] neg_hi:[1,0,1]
    v_pk_fma_f32 v[162:163], v[162:163], v[220:221], v[180:181] op_sel_hi:[1,0,0] neg_lo:[0,0,1] neg_hi:[0,0,1]
    v_permlane16_swap_b32 v176, v184
    v_add_f32 v176, v176, v184
    v_pk_fma_f32 v[60:61], v[164:165], v[220:221], v[188:189] op_sel_hi:[1,0,0] neg_lo:[1,0,1] neg_hi:[1,0,1]
    v_pk_fma_f32 v[164:165], v[164:165], v[220:221], v[180:181] op_sel_hi:[1,0,0] neg_lo:[0,0,1] neg_hi:[0,0,1]
    v_rcp_f32_e64 v176, v176
    v_pk_fma_f32 v[62:63], v[166:167], v[220:221], v[188:189] op_sel_hi:[1,0,0] neg_lo:[1,0,1] neg_hi:[1,0,1]
    v_pk_fma_f32 v[166:167], v[166:167], v[220:221], v[180:181] op_sel_hi:[1,0,0] neg_lo:[0,0,1] neg_hi:[0,0,1]
    v_mov_b32_e64 v184, v176
    v_pk_fma_f32 v[80:81], v[168:169], v[222:223], v[190:191] op_sel_hi:[1,0,0] neg_lo:[1,0,1] neg_hi:[1,0,1]
    v_pk_fma_f32 v[168:169], v[168:169], v[222:223], v[182:183] op_sel_hi:[1,0,0] neg_lo:[0,0,1] neg_hi:[0,0,1]
    v_permlane16_swap_b32 v176, v184
    v_mov_b32 v178, v176
    v_pk_fma_f32 v[82:83], v[170:171], v[222:223], v[190:191] op_sel_hi:[1,0,0] neg_lo:[1,0,1] neg_hi:[1,0,1]
    v_pk_fma_f32 v[170:171], v[170:171], v[222:223], v[182:183] op_sel_hi:[1,0,0] neg_lo:[0,0,1] neg_hi:[0,0,1]
    v_mov_b32_e64 v186, v184
    v_pk_fma_f32 v[84:85], v[172:173], v[222:223], v[190:191] op_sel_hi:[1,0,0] neg_lo:[1,0,1] neg_hi:[1,0,1]
    v_pk_fma_f32 v[172:173], v[172:173], v[222:223], v[182:183] op_sel_hi:[1,0,0] neg_lo:[0,0,1] neg_hi:[0,0,1]
    v_permlane32_swap_b32 v176, v178
    v_permlane32_swap_b32 v184, v186
    v_pk_fma_f32 v[86:87], v[174:175], v[222:223], v[190:191] op_sel_hi:[1,0,0] neg_lo:[1,0,1] neg_hi:[1,0,1]
    v_pk_fma_f32 v[174:175], v[174:175], v[222:223], v[182:183] op_sel_hi:[1,0,0] neg_lo:[0,0,1] neg_hi:[0,0,1]
    v_pk_mul_f32 v[144:145], v[144:145], v[176:177] op_sel_hi:[1,0]
    v_pk_mul_f32 v[146:147], v[146:147], v[176:177] op_sel_hi:[1,0]
    v_pk_mul_f32 v[148:149], v[148:149], v[176:177] op_sel_hi:[1,0]
    v_pk_mul_f32 v[150:151], v[150:151], v[176:177] op_sel_hi:[1,0]
    v_cvt_pk_bf16_f32 v144, v144, v145
    v_cvt_pk_bf16_f32 v145, v146, v147
    v_cvt_pk_bf16_f32 v146, v148, v149
    v_cvt_pk_bf16_f32 v147, v150, v151
    v_pk_mul_f32 v[8:9], v[8:9], v[184:185] op_sel_hi:[1,0]
    v_pk_mul_f32 v[10:11], v[10:11], v[184:185] op_sel_hi:[1,0]
    v_pk_mul_f32 v[12:13], v[12:13], v[184:185] op_sel_hi:[1,0]
    v_pk_mul_f32 v[14:15], v[14:15], v[184:185] op_sel_hi:[1,0]
    v_cvt_pk_bf16_f32 v8, v8, v9
    v_cvt_pk_bf16_f32 v9, v10, v11
    v_cvt_pk_bf16_f32 v10, v12, v13
    v_cvt_pk_bf16_f32 v11, v14, v15
    v_pk_mul_f32 v[152:153], v[152:153], v[178:179] op_sel_hi:[1,0]
    v_pk_mul_f32 v[154:155], v[154:155], v[178:179] op_sel_hi:[1,0]
    v_pk_mul_f32 v[156:157], v[156:157], v[178:179] op_sel_hi:[1,0]
    v_pk_mul_f32 v[158:159], v[158:159], v[178:179] op_sel_hi:[1,0]
    v_cvt_pk_bf16_f32 v152, v152, v153
    v_cvt_pk_bf16_f32 v153, v154, v155
    v_cvt_pk_bf16_f32 v154, v156, v157
    v_cvt_pk_bf16_f32 v155, v158, v159
    v_pk_mul_f32 v[32:33], v[32:33], v[186:187] op_sel_hi:[1,0]
    v_pk_mul_f32 v[34:35], v[34:35], v[186:187] op_sel_hi:[1,0]
    v_pk_mul_f32 v[36:37], v[36:37], v[186:187] op_sel_hi:[1,0]
    v_pk_mul_f32 v[38:39], v[38:39], v[186:187] op_sel_hi:[1,0]
    v_cvt_pk_bf16_f32 v32, v32, v33
    v_cvt_pk_bf16_f32 v33, v34, v35
    v_cvt_pk_bf16_f32 v34, v36, v37
    v_cvt_pk_bf16_f32 v35, v38, v39
    v_exp_f32 v56, v56
    v_exp_f32 v160, v160
    v_exp_f32 v57, v57
    v_exp_f32 v161, v161
    v_exp_f32 v58, v58
    v_exp_f32 v162, v162
    v_exp_f32 v59, v59
    v_exp_f32 v163, v163
    v_exp_f32 v60, v60
    v_exp_f32 v164, v164
    v_exp_f32 v61, v61
    v_exp_f32 v165, v165
    v_exp_f32 v62, v62
    v_exp_f32 v166, v166
    v_exp_f32 v63, v63
    v_exp_f32 v167, v167
    v_exp_f32 v80, v80
    v_exp_f32 v168, v168
    v_exp_f32 v81, v81
    v_exp_f32 v169, v169
    v_exp_f32 v82, v82
    v_exp_f32 v170, v170
    v_exp_f32 v83, v83
    v_exp_f32 v171, v171
    v_exp_f32 v84, v84
    v_exp_f32 v172, v172
    v_exp_f32 v85, v85
    v_exp_f32 v173, v173
    v_exp_f32 v86, v86
    v_exp_f32 v174, v174
    v_exp_f32 v87, v87
    v_exp_f32 v175, v175
    v_pk_add_f32 v[136:137], v[160:161], v[162:163]
    v_pk_add_f32 v[138:139], v[56:57], v[58:59]
    v_pk_add_f32 v[140:141], v[168:169], v[170:171]
    v_pk_add_f32 v[142:143], v[80:81], v[82:83]
    v_pk_add_f32 v[136:137], v[136:137], v[164:165]
    v_pk_add_f32 v[138:139], v[138:139], v[60:61]
    v_pk_add_f32 v[140:141], v[140:141], v[172:173]
    v_pk_add_f32 v[142:143], v[142:143], v[84:85]
    v_pk_add_f32 v[136:137], v[136:137], v[166:167]
    v_pk_add_f32 v[138:139], v[138:139], v[62:63]
    v_pk_add_f32 v[140:141], v[140:141], v[174:175]
    v_pk_add_f32 v[142:143], v[142:143], v[86:87]
    v_add_f32 v180, v136, v137
    v_add_f32 v188, v138, v139
    v_add_f32 v182, v140, v141
    v_add_f32 v190, v142, v143
    s_nop 0
    v_permlane32_swap_b32 v180, v182
    v_permlane32_swap_b32 v188, v190
    v_add_f32 v180, v180, v182
    v_add_f32 v188, v188, v190
    s_nop 1
    v_permlane16_swap_b32 v180, v188
    v_add_f32 v180, v180, v188
    v_rcp_f32_e64 v180, v180
    s_nop 0
    v_mov_b32_e64 v188, v180
    s_nop 1
    v_permlane16_swap_b32 v180, v188
    v_mov_b32 v182, v180
    v_mov_b32_e64 v190, v188
    s_nop 0
    v_permlane32_swap_b32 v180, v182
    v_permlane32_swap_b32_e64 v188, v190
    v_pk_mul_f32 v[160:161], v[160:161], v[180:181] op_sel_hi:[1,0]
    v_pk_mul_f32 v[162:163], v[162:163], v[180:181] op_sel_hi:[1,0]
    v_pk_mul_f32 v[164:165], v[164:165], v[180:181] op_sel_hi:[1,0]
    v_pk_mul_f32 v[166:167], v[166:167], v[180:181] op_sel_hi:[1,0]
    v_cvt_pk_bf16_f32 v160, v160, v161
    v_cvt_pk_bf16_f32 v161, v162, v163
    v_cvt_pk_bf16_f32 v162, v164, v165
    v_cvt_pk_bf16_f32 v163, v166, v167
    v_pk_mul_f32 v[56:57], v[56:57], v[188:189] op_sel_hi:[1,0]
    v_pk_mul_f32 v[58:59], v[58:59], v[188:189] op_sel_hi:[1,0]
    v_pk_mul_f32 v[60:61], v[60:61], v[188:189] op_sel_hi:[1,0]
    v_pk_mul_f32 v[62:63], v[62:63], v[188:189] op_sel_hi:[1,0]
    v_cvt_pk_bf16_f32 v56, v56, v57
    v_cvt_pk_bf16_f32 v57, v58, v59
    v_cvt_pk_bf16_f32 v58, v60, v61
    v_cvt_pk_bf16_f32 v59, v62, v63
    v_pk_mul_f32 v[168:169], v[168:169], v[182:183] op_sel_hi:[1,0]
    v_pk_mul_f32 v[170:171], v[170:171], v[182:183] op_sel_hi:[1,0]
    v_pk_mul_f32 v[172:173], v[172:173], v[182:183] op_sel_hi:[1,0]
    v_pk_mul_f32 v[174:175], v[174:175], v[182:183] op_sel_hi:[1,0]
    v_cvt_pk_bf16_f32 v168, v168, v169
    v_cvt_pk_bf16_f32 v169, v170, v171
    v_cvt_pk_bf16_f32 v170, v172, v173
    v_cvt_pk_bf16_f32 v171, v174, v175
    v_pk_mul_f32 v[80:81], v[80:81], v[190:191] op_sel_hi:[1,0]
    v_pk_mul_f32 v[82:83], v[82:83], v[190:191] op_sel_hi:[1,0]
    v_pk_mul_f32 v[84:85], v[84:85], v[190:191] op_sel_hi:[1,0]
    v_pk_mul_f32 v[86:87], v[86:87], v[190:191] op_sel_hi:[1,0]
    v_cvt_pk_bf16_f32 v80, v80, v81
    v_cvt_pk_bf16_f32 v81, v82, v83
    v_cvt_pk_bf16_f32 v82, v84, v85
    v_cvt_pk_bf16_f32 v83, v86, v87
    v_mov_b32 v2, 162048
    ds_read_b32 v248, v2
    v_lshrrev_b32 v5, 3, v1
    v_lshlrev_b32 v6, 11, v5
    v_bfe_u32 v5, v1, 4, 2
    v_lshlrev_b32 v5, 1, v5
    v_and_b32 v7, 7, v1
    v_xor_b32 v5, v5, v7
    v_lshl_add_u32 v6, v5, 4, v6
    s_lshl_b32 s3, s35, 7
    v_add_u32 v6, s3, v6
    v_add_u32 v216, 0, v6
    v_add_u32 v217, 15360, v6
    v_add_u32 v218, 30720, v6
    v_add_u32 v219, 46080, v6
    s_lshl_b32 s72, s38, 12
    s_lshl_b32 s73, s38, 16
    v_and_b32 v2, 15, v1
    v_add_u32 v2, s69, v2
    v_lshlrev_b32_e64 v2, 2, v2
    v_add_u32 v2, 152064, v2
    ds_read_b32 v193, v2
    ds_read_b32 v192, v2 offset:1024
    s_mul_i32 s76, s67, 4224
    s_add_u32 s76, s76, 1048576
    v_lshlrev_b32 v5, 4, v1
    v_and_b32 v6, 48, v1
    v_add_u32 v6, 4096, v6
    s_lshl_b32 s3, s38, 2
    s_add_u32 s3, s3, 162112
    v_mov_b32 v3, s3
L_gw:
    ds_read_b32 v2, v3
    s_waitcnt lgkmcnt(0)
    v_readfirstlane_b32 s3, v2
    s_nop 0
    s_cmp_eq_u32 s3, 3
    s_cbranch_scc1 L_gk
    s_sleep 1
    s_branch L_gw
L_gk:
    v_mul_f32 v196, v193, v192
    v_mov_b32 v198, 0xbfb8aa3b
    v_lshlrev_b32 v224, 16, v240
    v_and_b32 v225, 0xffff0000, v240
    v_lshlrev_b32 v226, 16, v241
    v_and_b32 v227, 0xffff0000, v241
    v_lshlrev_b32 v228, 16, v242
    v_and_b32 v229, 0xffff0000, v242
    v_lshlrev_b32 v230, 16, v243
    v_and_b32 v231, 0xffff0000, v243
    v_lshlrev_b32 v232, 16, v244
    v_and_b32 v233, 0xffff0000, v244
    v_lshlrev_b32 v234, 16, v245
    v_and_b32 v235, 0xffff0000, v245
    v_lshlrev_b32 v236, 16, v246
    v_and_b32 v237, 0xffff0000, v246
    v_lshlrev_b32 v238, 16, v247
    v_and_b32 v239, 0xffff0000, v247
    v_pk_fma_f32 v[224:225], v[224:225], v[192:193], v[196:197] op_sel_hi:[1,0,0] neg_lo:[0,0,1] neg_hi:[0,0,1]
    v_pk_fma_f32 v[226:227], v[226:227], v[192:193], v[196:197] op_sel_hi:[1,0,0] neg_lo:[0,0,1] neg_hi:[0,0,1]
    v_pk_fma_f32 v[228:229], v[228:229], v[192:193], v[196:197] op_sel_hi:[1,0,0] neg_lo:[0,0,1] neg_hi:[0,0,1]
    v_pk_fma_f32 v[230:231], v[230:231], v[192:193], v[196:197] op_sel_hi:[1,0,0] neg_lo:[0,0,1] neg_hi:[0,0,1]
    v_pk_fma_f32 v[232:233], v[232:233], v[192:193], v[196:197] op_sel_hi:[1,0,0] neg_lo:[0,0,1] neg_hi:[0,0,1]
    v_pk_fma_f32 v[234:235], v[234:235], v[192:193], v[196:197] op_sel_hi:[1,0,0] neg_lo:[0,0,1] neg_hi:[0,0,1]
    v_pk_fma_f32 v[236:237], v[236:237], v[192:193], v[196:197] op_sel_hi:[1,0,0] neg_lo:[0,0,1] neg_hi:[0,0,1]
    v_pk_fma_f32 v[238:239], v[238:239], v[192:193], v[196:197] op_sel_hi:[1,0,0] neg_lo:[0,0,1] neg_hi:[0,0,1]
    v_pk_mul_f32 v[200:201], v[224:225], v[198:199] op_sel_hi:[1,0]
    v_pk_mul_f32 v[202:203], v[226:227], v[198:199] op_sel_hi:[1,0]
    v_pk_mul_f32 v[204:205], v[228:229], v[198:199] op_sel_hi:[1,0]
    v_pk_mul_f32 v[206:207], v[230:231], v[198:199] op_sel_hi:[1,0]
    v_pk_mul_f32 v[208:209], v[232:233], v[198:199] op_sel_hi:[1,0]
    v_pk_mul_f32 v[210:211], v[234:235], v[198:199] op_sel_hi:[1,0]
    v_pk_mul_f32 v[212:213], v[236:237], v[198:199] op_sel_hi:[1,0]
    v_pk_mul_f32 v[214:215], v[238:239], v[198:199] op_sel_hi:[1,0]
    v_exp_f32 v200, v200
    v_exp_f32 v201, v201
    v_exp_f32 v202, v202
    v_exp_f32 v203, v203
    v_exp_f32 v204, v204
    v_exp_f32 v205, v205
    v_exp_f32 v206, v206
    v_exp_f32 v207, v207
    v_exp_f32 v208, v208
    v_exp_f32 v209, v209
    v_exp_f32 v210, v210
    v_exp_f32 v211, v211
    v_exp_f32 v212, v212
    v_exp_f32 v213, v213
    v_exp_f32 v214, v214
    v_exp_f32 v215, v215
    v_pk_add_f32 v[200:201], v[200:201], 1.0 op_sel_hi:[1,0]
    v_pk_add_f32 v[202:203], v[202:203], 1.0 op_sel_hi:[1,0]
    v_pk_add_f32 v[204:205], v[204:205], 1.0 op_sel_hi:[1,0]
    v_pk_add_f32 v[206:207], v[206:207], 1.0 op_sel_hi:[1,0]
    v_pk_add_f32 v[208:209], v[208:209], 1.0 op_sel_hi:[1,0]
    v_pk_add_f32 v[210:211], v[210:211], 1.0 op_sel_hi:[1,0]
    v_pk_add_f32 v[212:213], v[212:213], 1.0 op_sel_hi:[1,0]
    v_pk_add_f32 v[214:215], v[214:215], 1.0 op_sel_hi:[1,0]
    v_rcp_f32 v200, v200
    v_rcp_f32 v201, v201
    v_rcp_f32 v202, v202
    v_rcp_f32 v203, v203
    v_rcp_f32 v204, v204
    v_rcp_f32 v205, v205
    v_rcp_f32 v206, v206
    v_rcp_f32 v207, v207
    v_rcp_f32 v208, v208
    v_rcp_f32 v209, v209
    v_rcp_f32 v210, v210
    v_rcp_f32 v211, v211
    v_rcp_f32 v212, v212
    v_rcp_f32 v213, v213
    v_rcp_f32 v214, v214
    v_rcp_f32 v215, v215
    v_pk_mul_f32 v[224:225], v[224:225], v[200:201]
    v_pk_mul_f32 v[226:227], v[226:227], v[202:203]
    v_pk_mul_f32 v[228:229], v[228:229], v[204:205]
    v_pk_mul_f32 v[230:231], v[230:231], v[206:207]
    v_pk_mul_f32 v[232:233], v[232:233], v[208:209]
    v_pk_mul_f32 v[234:235], v[234:235], v[210:211]
    v_pk_mul_f32 v[236:237], v[236:237], v[212:213]
    v_pk_mul_f32 v[238:239], v[238:239], v[214:215]
    buffer_load_dwordx4 v[104:107], v5, s[48:51], s76 offen offset:0 sc1
    buffer_load_dwordx4 v[108:111], v5, s[48:51], s76 offen offset:1024 sc1
    buffer_load_dwordx4 v[112:115], v5, s[48:51], s76 offen offset:2048 sc1
    buffer_load_dwordx4 v[116:119], v5, s[48:51], s76 offen offset:3072 sc1
    buffer_load_dwordx4 v[120:123], v6, s[48:51], s76 offen offset:0 sc1
    buffer_load_dwordx4 v[124:127], v6, s[48:51], s76 offen offset:64 sc1
    s_waitcnt lgkmcnt(0)
    v_readfirstlane_b32 s70, v248
    s_nop 0
    s_and_b32 s68, s70, 0x7ff
    s_sub_u32 s68, 2047, s68
    s_lshl_b32 s3, s36, 3
    s_lshl_b32 s28, s64, 2
    s_add_u32 s3, s3, s28
    s_lshl_b32 s3, s3, 5
    s_add_u32 s3, s3, s67
    s_lshl_b32 s77, s3, 10
    s_add_u32 s77, s77, 4194304
    s_waitcnt vmcnt(0)
    s_mov_b32 s29, 0
L_k7:
    s_nop 0
    v_max3_u32 v2, v104, v105, v106
    v_max3_u32 v2, v2, v107, v108
    v_max3_u32 v2, v2, v109, v110
    v_max3_u32 v2, v2, v111, v112
    v_max3_u32 v2, v2, v113, v114
    v_max3_u32 v2, v2, v115, v116
    v_max3_u32 v2, v2, v117, v118
    v_max3_u32 v2, v2, v119, v120
    v_max3_u32 v2, v2, v121, v122
    v_max3_u32 v2, v2, v123, v124
    v_max3_u32 v2, v2, v125, v126
    v_max_u32 v2, v2, v127
    v_cmp_eq_u32 vcc, -1, v2
    s_cbranch_vccz L_k7k
    s_add_u32 s29, s29, 1
    s_cmp_ge_u32 s29, 200000
    s_cbranch_scc1 L_k7k
    s_sleep 1
    buffer_load_dwordx4 v[104:107], v5, s[48:51], s76 offen offset:0 sc1
    buffer_load_dwordx4 v[108:111], v5, s[48:51], s76 offen offset:1024 sc1
    buffer_load_dwordx4 v[112:115], v5, s[48:51], s76 offen offset:2048 sc1
    buffer_load_dwordx4 v[116:119], v5, s[48:51], s76 offen offset:3072 sc1
    buffer_load_dwordx4 v[120:123], v6, s[48:51], s76 offen offset:0 sc1
    buffer_load_dwordx4 v[124:127], v6, s[48:51], s76 offen offset:64 sc1
    s_waitcnt vmcnt(0)
    s_branch L_k7
L_k7k:
    s_setprio 2
    s_nop 0
    v_mfma_f32_16x16x32_bf16 v[24:27], v[120:123], v[144:147], 0
    v_mfma_f32_16x16x32_bf16 v[24:27], v[124:127], v[8:11], v[24:27]
    v_mfma_f32_16x16x32_bf16 v[16:19], v[104:107], v[144:147], 0
    v_mfma_f32_16x16x32_bf16 v[16:19], v[112:115], v[8:11], v[16:19]
    v_mfma_f32_16x16x32_bf16 v[20:23], v[108:111], v[144:147], 0
    v_mfma_f32_16x16x32_bf16 v[20:23], v[116:119], v[8:11], v[20:23]
    v_mfma_f32_16x16x32_bf16 v[48:51], v[120:123], v[152:155], 0
    v_mfma_f32_16x16x32_bf16 v[48:51], v[124:127], v[32:35], v[48:51]
    v_mfma_f32_16x16x32_bf16 v[40:43], v[104:107], v[152:155], 0
    s_nop 0
    v_add_f32 v24, 0x358637bd, v24
    v_rcp_f32 v24, v24
    s_nop 0
    v_mul_f32 v16, v16, v24
    v_mfma_f32_16x16x32_bf16 v[40:43], v[112:115], v[32:35], v[40:43]
    v_mul_f32 v17, v17, v24
    v_mul_f32 v18, v18, v24
    v_mul_f32 v19, v19, v24
    v_mfma_f32_16x16x32_bf16 v[44:47], v[108:111], v[152:155], 0
    v_mul_f32 v20, v20, v24
    v_mul_f32 v21, v21, v24
    v_mul_f32 v22, v22, v24
    v_mfma_f32_16x16x32_bf16 v[44:47], v[116:119], v[32:35], v[44:47]
    v_mul_f32_e64 v23, v23, v24
    v_cvt_pk_bf16_f32 v16, v16, v17
    v_cvt_pk_bf16_f32 v17, v18, v19
    v_cvt_pk_bf16_f32 v18, v20, v21
    v_cvt_pk_bf16_f32 v19, v22, v23
    buffer_store_dwordx4 v[16:19], v5, s[48:51], s77 offen sc1
    s_add_u32 s77, s77, 32768
    v_mfma_f32_16x16x32_bf16 v[72:75], v[120:123], v[160:163], 0
    v_mfma_f32_16x16x32_bf16 v[72:75], v[124:127], v[56:59], v[72:75]
    v_mfma_f32_16x16x32_bf16 v[64:67], v[104:107], v[160:163], 0
    v_add_f32 v48, 0x358637bd, v48
    v_rcp_f32 v48, v48
    s_nop 0
    v_mul_f32 v40, v40, v48
    v_mfma_f32_16x16x32_bf16 v[64:67], v[112:115], v[56:59], v[64:67]
    v_mul_f32 v41, v41, v48
    v_mul_f32 v42, v42, v48
    v_mul_f32 v43, v43, v48
    v_mfma_f32_16x16x32_bf16 v[68:71], v[108:111], v[160:163], 0
    v_mul_f32 v44, v44, v48
    v_mul_f32 v45, v45, v48
    v_mul_f32 v46, v46, v48
    v_mfma_f32_16x16x32_bf16 v[68:71], v[116:119], v[56:59], v[68:71]
    v_mul_f32 v47, v47, v48
    v_cvt_pk_bf16_f32 v40, v40, v41
    v_cvt_pk_bf16_f32 v41, v42, v43
    v_cvt_pk_bf16_f32 v42, v44, v45
    v_cvt_pk_bf16_f32 v43, v46, v47
    buffer_store_dwordx4 v[40:43], v5, s[48:51], s77 offen sc1
    s_add_u32 s77, s77, 32768
    v_mfma_f32_16x16x32_bf16 v[96:99], v[120:123], v[168:171], 0
    v_mfma_f32_16x16x32_bf16 v[96:99], v[124:127], v[80:83], v[96:99]
    v_mfma_f32_16x16x32_bf16 v[88:91], v[104:107], v[168:171], 0
    v_add_f32 v72, 0x358637bd, v72
    v_rcp_f32 v72, v72
    s_nop 0
    v_mul_f32 v64, v64, v72
    v_mfma_f32_16x16x32_bf16 v[88:91], v[112:115], v[80:83], v[88:91]
    v_mul_f32 v65, v65, v72
    v_mul_f32 v66, v66, v72
    v_mul_f32 v67, v67, v72
    v_mfma_f32_16x16x32_bf16 v[92:95], v[108:111], v[168:171], 0
    v_mul_f32 v68, v68, v72
    v_mul_f32 v69, v69, v72
    v_mul_f32 v70, v70, v72
    v_mfma_f32_16x16x32_bf16 v[92:95], v[116:119], v[80:83], v[92:95]
    v_mul_f32 v71, v71, v72
    v_cvt_pk_bf16_f32 v64, v64, v65
    v_cvt_pk_bf16_f32 v65, v66, v67
    v_cvt_pk_bf16_f32 v66, v68, v69
    v_cvt_pk_bf16_f32 v67, v70, v71
    buffer_store_dwordx4 v[64:67], v5, s[48:51], s77 offen sc1
    s_add_u32 s77, s77, 32768
    v_add_f32 v96, 0x358637bd, v96
    v_rcp_f32 v96, v96
    s_nop 0
    v_pk_mul_f32 v[88:89], v[88:89], v[96:97] op_sel_hi:[1,0]
    v_pk_mul_f32 v[90:91], v[90:91], v[96:97] op_sel_hi:[1,0]
    v_pk_mul_f32 v[92:93], v[92:93], v[96:97] op_sel_hi:[1,0]
    v_pk_mul_f32 v[94:95], v[94:95], v[96:97] op_sel_hi:[1,0]
    v_cvt_pk_bf16_f32 v88, v88, v89
    v_cvt_pk_bf16_f32 v89, v90, v91
    v_cvt_pk_bf16_f32 v90, v92, v93
    v_cvt_pk_bf16_f32 v91, v94, v95
    buffer_store_dwordx4 v[88:91], v5, s[48:51], s77 offen sc1
    v_mov_b32_e64 v2, 7
    ds_write_b32 v3, v2
    s_and_b32 s3, s68, 127
    s_lshl_b32 s3, s3, 2
    s_add_u32 s3, s3, 152064
    v_mov_b32 v2, s3
    ds_read_b32 v250, v2
    ds_read_b32 v251, v2 offset:1024
    s_setprio 0
    v_and_b32 v3, 3, v1
    v_lshlrev_b32_e64 v3, 2, v3
    v_add_u32 v3, 162112, v3
L_cw:
    ds_read_b32 v2, v3
    s_waitcnt lgkmcnt(0)
    v_cmp_ne_u32_e64 vcc, 7, v2
    s_cbranch_vccz L_cwk
    s_sleep 1
    s_branch L_cw
L_cwk:
    s_add_u32 m0, s72, 98304
    s_add_u32 s3, s73, 1572864
    buffer_load_dwordx4 v216, s[88:91], s3 offen offset:0 lds
    buffer_load_dwordx4 v217, s[88:91], s3 offen offset:1024 lds
    buffer_load_dwordx4 v218, s[88:91], s3 offen offset:2048 lds
    buffer_load_dwordx4 v219, s[88:91], s3 offen offset:3072 lds
    s_add_u32 m0, s72, 114688
    s_add_u32 s3, s73, 1835008
    buffer_load_dwordx4 v216, s[88:91], s3 offen offset:0 lds
    buffer_load_dwordx4 v217, s[88:91], s3 offen offset:1024 lds
    buffer_load_dwordx4 v218, s[88:91], s3 offen offset:2048 lds
    buffer_load_dwordx4 v219, s[88:91], s3 offen offset:3072 lds
L_p3:
    s_nop 3
    s_mov_b32 s56, s22
    s_mov_b32 s57, s23
    s_mov_b32 s58, 4194304
    s_mov_b32 s59, 0x00020000
    s_lshr_b32 s64, s39, 2
    s_lshl_b32 s3, s34, 2
    s_add_u32 s3, s3, s38
    s_lshl_b32 s3, s3, 16
    s_lshl_b32 s28, s64, 14
    s_add_u32 s3, s3, s28
    s_add_u32 s76, s3, 4194304
    s_lshl_b32 s3, s64, 15
    v_lshlrev_b32 v2, 4, v1
    v_add_u32 v116, s3, v2
    v_xor_b32 v117, 0x8000, v116
    v_lshrrev_b32 v2, 2, v1
    v_lshlrev_b32 v2, 7, v2
    v_bfe_u32 v3, v1, 3, 2
    v_lshl_add_u32 v2, v3, 5, v2
    v_and_b32 v3, 3, v1
    v_lshl_add_u32 v2, v3, 3, v2
    s_lshl_b32 s3, s64, 16
    v_add_u32 v112, s3, v2
    v_xor_b32 v113, 32, v112
    v_xor_b32 v114, 64, v112
    v_xor_b32 v115, 96, v112
    s_add_u32 s77, s76, 0
    buffer_load_dwordx4 v[40:43], v116, s[48:51], s77 offen offset:0 sc1
    buffer_load_dwordx4 v[44:47], v117, s[48:51], s77 offen offset:0 sc1
    buffer_load_dwordx4 v[48:51], v116, s[48:51], s77 offen offset:1024 sc1
    buffer_load_dwordx4 v[52:55], v117, s[48:51], s77 offen offset:1024 sc1
    buffer_load_dwordx4 v[56:59], v116, s[48:51], s77 offen offset:2048 sc1
    buffer_load_dwordx4 v[60:63], v117, s[48:51], s77 offen offset:2048 sc1
    buffer_load_dwordx4 v[64:67], v116, s[48:51], s77 offen offset:3072 sc1
    buffer_load_dwordx4 v[68:71], v117, s[48:51], s77 offen offset:3072 sc1
    s_lshr_b32 s3, s68, 7
    s_xor_b32 s83, s3, s34
    s_or_b32 s83, s83, s39
    v_lshlrev_b32 v222, 4, v1
    ds_read_b64_tr_b16 v[80:81], v112 offset:0
    ds_read_b64_tr_b16 v[82:83], v112 offset:2048
    ds_read_b64_tr_b16 v[84:85], v113 offset:0
    ds_read_b64_tr_b16 v[86:87], v113 offset:2048
    ds_read_b64_tr_b16 v[88:89], v114 offset:0
    ds_read_b64_tr_b16 v[90:91], v114 offset:2048
    ds_read_b64_tr_b16 v[92:93], v115 offset:0
    ds_read_b64_tr_b16 v[94:95], v115 offset:2048
    s_mov_b32 s29, 0
    s_waitcnt vmcnt(6)
    v_max3_u32 v2, v40, v41, v42
    v_max3_u32 v2, v2, v43, v44
    v_max3_u32 v2, v2, v45, v46
    v_max_u32 v2, v2, v47
    v_cmp_eq_u32 vcc, -1, v2
    s_cbranch_vccnz L_r0
L_g0:
    s_waitcnt lgkmcnt(0)
    v_mfma_f32_16x16x32_bf16 v[8:11], v[80:83], v[40:43], 0
    ds_read_b64_tr_b16 v[96:97], v112 offset:4096
    ds_read_b64_tr_b16 v[98:99], v112 offset:6144
    v_mfma_f32_16x16x32_bf16 v[24:27], v[80:83], v[44:47], 0
    ds_read_b64_tr_b16 v[100:101], v113 offset:4096
    ds_read_b64_tr_b16 v[102:103], v113 offset:6144
    v_mfma_f32_16x16x32_bf16 v[12:15], v[84:87], v[40:43], 0
    ds_read_b64_tr_b16 v[104:105], v114 offset:4096
    ds_read_b64_tr_b16 v[106:107], v114 offset:6144
    v_mfma_f32_16x16x32_bf16 v[28:31], v[84:87], v[44:47], 0
    ds_read_b64_tr_b16 v[108:109], v115 offset:4096
    ds_read_b64_tr_b16 v[110:111], v115 offset:6144
    v_mfma_f32_16x16x32_bf16 v[16:19], v[88:91], v[40:43], 0
    s_add_u32 s77, s76, 4096
    buffer_load_dwordx4 v[72:75], v116, s[48:51], s77 offen offset:0 sc1
    buffer_load_dwordx4 v[76:79], v117, s[48:51], s77 offen offset:0 sc1
    v_mfma_f32_16x16x32_bf16 v[32:35], v[88:91], v[44:47], 0
    s_waitcnt vmcnt(6)
    v_max3_u32 v2, v48, v49, v50
    v_mfma_f32_16x16x32_bf16 v[20:23], v[92:95], v[40:43], 0
    v_max3_u32 v2, v2, v51, v52
    v_max3_u32 v2, v2, v53, v54
    v_mfma_f32_16x16x32_bf16 v[36:39], v[92:95], v[44:47], 0
    v_max_u32 v2, v2, v55
    v_cmp_eq_u32_e64 vcc, -1, v2
    s_cbranch_vccnz L_r1
L_g1:
    s_waitcnt lgkmcnt(0)
    v_mfma_f32_16x16x32_bf16 v[8:11], v[96:99], v[48:51], v[8:11]
    ds_read_b64_tr_b16 v[80:81], v112 offset:8192
    ds_read_b64_tr_b16 v[82:83], v112 offset:10240
    v_mfma_f32_16x16x32_bf16 v[24:27], v[96:99], v[52:55], v[24:27]
    ds_read_b64_tr_b16 v[84:85], v113 offset:8192
    ds_read_b64_tr_b16 v[86:87], v113 offset:10240
    v_mfma_f32_16x16x32_bf16 v[12:15], v[100:103], v[48:51], v[12:15]
    ds_read_b64_tr_b16 v[88:89], v114 offset:8192
    ds_read_b64_tr_b16 v[90:91], v114 offset:10240
    v_mfma_f32_16x16x32_bf16 v[28:31], v[100:103], v[52:55], v[28:31]
    ds_read_b64_tr_b16 v[92:93], v115 offset:8192
    ds_read_b64_tr_b16 v[94:95], v115 offset:10240
    v_mfma_f32_16x16x32_bf16 v[16:19], v[104:107], v[48:51], v[16:19]
    buffer_load_dwordx4 v[40:43], v116, s[48:51], s77 offen offset:1024 sc1
    buffer_load_dwordx4 v[44:47], v117, s[48:51], s77 offen offset:1024 sc1
    v_mfma_f32_16x16x32_bf16 v[32:35], v[104:107], v[52:55], v[32:35]
    s_waitcnt vmcnt(6)
    v_max3_u32 v2, v56, v57, v58
    v_mfma_f32_16x16x32_bf16 v[20:23], v[108:111], v[48:51], v[20:23]
    v_max3_u32 v2, v2, v59, v60
    v_max3_u32 v2, v2, v61, v62
    v_mfma_f32_16x16x32_bf16 v[36:39], v[108:111], v[52:55], v[36:39]
    v_max_u32 v2, v2, v63
    v_cmp_eq_u32_e64 vcc, -1, v2
    s_cbranch_vccnz L_r2
L_g2:
    s_waitcnt lgkmcnt(0)
    v_mfma_f32_16x16x32_bf16 v[8:11], v[80:83], v[56:59], v[8:11]
    ds_read_b64_tr_b16 v[96:97], v112 offset:12288
    ds_read_b64_tr_b16 v[98:99], v112 offset:14336
    v_mfma_f32_16x16x32_bf16 v[24:27], v[80:83], v[60:63], v[24:27]
    ds_read_b64_tr_b16 v[100:101], v113 offset:12288
    ds_read_b64_tr_b16 v[102:103], v113 offset:14336
    v_mfma_f32_16x16x32_bf16 v[12:15], v[84:87], v[56:59], v[12:15]
    ds_read_b64_tr_b16 v[104:105], v114 offset:12288
    ds_read_b64_tr_b16 v[106:107], v114 offset:14336
    v_mfma_f32_16x16x32_bf16 v[28:31], v[84:87], v[60:63], v[28:31]
    ds_read_b64_tr_b16 v[108:109], v115 offset:12288
    ds_read_b64_tr_b16 v[110:111], v115 offset:14336
    v_mfma_f32_16x16x32_bf16 v[16:19], v[88:91], v[56:59], v[16:19]
    buffer_load_dwordx4 v[48:51], v116, s[48:51], s77 offen offset:2048 sc1
    buffer_load_dwordx4 v[52:55], v117, s[48:51], s77 offen offset:2048 sc1
    v_mfma_f32_16x16x32_bf16 v[32:35], v[88:91], v[60:63], v[32:35]
    s_waitcnt vmcnt(6)
    v_max3_u32 v2, v64, v65, v66
    v_mfma_f32_16x16x32_bf16 v[20:23], v[92:95], v[56:59], v[20:23]
    v_max3_u32 v2, v2, v67, v68
    v_max3_u32 v2, v2, v69, v70
    v_mfma_f32_16x16x32_bf16 v[36:39], v[92:95], v[60:63], v[36:39]
    v_max_u32 v2, v2, v71
    v_cmp_eq_u32 vcc, -1, v2
    s_cbranch_vccnz L_r3
L_g3:
    s_waitcnt lgkmcnt(0)
    s_cmp_eq_u32 s64, 0
    s_cbranch_scc1 L_nb3
    s_barrier
L_nb3:
    v_mfma_f32_16x16x32_bf16 v[8:11], v[96:99], v[64:67], v[8:11]
    ds_read_b64_tr_b16 v[80:81], v112 offset:16384
    ds_read_b64_tr_b16 v[82:83], v112 offset:18432
    v_mfma_f32_16x16x32_bf16 v[24:27], v[96:99], v[68:71], v[24:27]
    ds_read_b64_tr_b16 v[84:85], v113 offset:16384
    ds_read_b64_tr_b16 v[86:87], v113 offset:18432
    v_mfma_f32_16x16x32_bf16 v[12:15], v[100:103], v[64:67], v[12:15]
    ds_read_b64_tr_b16 v[88:89], v114 offset:16384
    ds_read_b64_tr_b16 v[90:91], v114 offset:18432
    v_mfma_f32_16x16x32_bf16 v[28:31], v[100:103], v[68:71], v[28:31]
    ds_read_b64_tr_b16 v[92:93], v115 offset:16384
    ds_read_b64_tr_b16 v[94:95], v115 offset:18432
    v_mfma_f32_16x16x32_bf16 v[16:19], v[104:107], v[64:67], v[16:19]
    buffer_load_dwordx4 v[56:59], v116, s[48:51], s77 offen offset:3072 sc1
    buffer_load_dwordx4 v[60:63], v117, s[48:51], s77 offen offset:3072 sc1
    v_mfma_f32_16x16x32_bf16 v[32:35], v[104:107], v[68:71], v[32:35]
    s_waitcnt vmcnt(6)
    v_max3_u32 v2, v72, v73, v74
    v_mfma_f32_16x16x32_bf16 v[20:23], v[108:111], v[64:67], v[20:23]
    v_max3_u32 v2, v2, v75, v76
    v_max3_u32 v2, v2, v77, v78
    v_mfma_f32_16x16x32_bf16 v[36:39], v[108:111], v[68:71], v[36:39]
    v_max_u32 v2, v2, v79
    v_cmp_eq_u32_e64 vcc, -1, v2
    s_cbranch_vccnz L_r4
L_g4:
    s_waitcnt lgkmcnt(0)
    v_mfma_f32_16x16x32_bf16 v[8:11], v[80:83], v[72:75], v[8:11]
    ds_read_b64_tr_b16 v[96:97], v112 offset:20480
    ds_read_b64_tr_b16 v[98:99], v112 offset:22528
    v_mfma_f32_16x16x32_bf16 v[24:27], v[80:83], v[76:79], v[24:27]
    ds_read_b64_tr_b16 v[100:101], v113 offset:20480
    ds_read_b64_tr_b16 v[102:103], v113 offset:22528
    v_mfma_f32_16x16x32_bf16 v[12:15], v[84:87], v[72:75], v[12:15]
    ds_read_b64_tr_b16 v[104:105], v114 offset:20480
    ds_read_b64_tr_b16 v[106:107], v114 offset:22528
    v_mfma_f32_16x16x32_bf16 v[28:31], v[84:87], v[76:79], v[28:31]
    ds_read_b64_tr_b16 v[108:109], v115 offset:20480
    ds_read_b64_tr_b16 v[110:111], v115 offset:22528
    v_mfma_f32_16x16x32_bf16 v[16:19], v[88:91], v[72:75], v[16:19]
    s_add_u32 s77, s76, 8192
    buffer_load_dwordx4 v[64:67], v116, s[48:51], s77 offen offset:0 sc1
    buffer_load_dwordx4 v[68:71], v117, s[48:51], s77 offen offset:0 sc1
    v_mfma_f32_16x16x32_bf16 v[32:35], v[88:91], v[76:79], v[32:35]
    s_waitcnt vmcnt(6)
    v_max3_u32 v2, v40, v41, v42
    v_mfma_f32_16x16x32_bf16 v[20:23], v[92:95], v[72:75], v[20:23]
    v_max3_u32 v2, v2, v43, v44
    v_max3_u32 v2, v2, v45, v46
    v_mfma_f32_16x16x32_bf16 v[36:39], v[92:95], v[76:79], v[36:39]
    v_max_u32 v2, v2, v47
    v_cmp_eq_u32_e64 vcc, -1, v2
    s_cbranch_vccnz L_r5
L_g5:
    s_waitcnt lgkmcnt(0)
    v_mfma_f32_16x16x32_bf16 v[8:11], v[96:99], v[40:43], v[8:11]
    ds_read_b64_tr_b16 v[80:81], v112 offset:24576
    ds_read_b64_tr_b16 v[82:83], v112 offset:26624
    v_mfma_f32_16x16x32_bf16 v[24:27], v[96:99], v[44:47], v[24:27]
    ds_read_b64_tr_b16 v[84:85], v113 offset:24576
    ds_read_b64_tr_b16 v[86:87], v113 offset:26624
    v_mfma_f32_16x16x32_bf16 v[12:15], v[100:103], v[40:43], v[12:15]
    ds_read_b64_tr_b16 v[88:89], v114 offset:24576
    ds_read_b64_tr_b16 v[90:91], v114 offset:26624
    v_mfma_f32_16x16x32_bf16 v[28:31], v[100:103], v[44:47], v[28:31]
    ds_read_b64_tr_b16 v[92:93], v115 offset:24576
    ds_read_b64_tr_b16 v[94:95], v115 offset:26624
    v_mfma_f32_16x16x32_bf16 v[16:19], v[104:107], v[40:43], v[16:19]
    buffer_load_dwordx4 v[72:75], v116, s[48:51], s77 offen offset:1024 sc1
    buffer_load_dwordx4 v[76:79], v117, s[48:51], s77 offen offset:1024 sc1
    v_mfma_f32_16x16x32_bf16 v[32:35], v[104:107], v[44:47], v[32:35]
    s_waitcnt vmcnt(6)
    v_max3_u32 v2, v48, v49, v50
    v_mfma_f32_16x16x32_bf16 v[20:23], v[108:111], v[40:43], v[20:23]
    v_max3_u32 v2, v2, v51, v52
    v_max3_u32 v2, v2, v53, v54
    v_mfma_f32_16x16x32_bf16 v[36:39], v[108:111], v[44:47], v[36:39]
    v_max_u32 v2, v2, v55
    v_cmp_eq_u32_e64 vcc, -1, v2
    s_cbranch_vccnz L_r6
L_g6:
    s_waitcnt lgkmcnt(0)
    v_mfma_f32_16x16x32_bf16 v[8:11], v[80:83], v[48:51], v[8:11]
    ds_read_b64_tr_b16 v[96:97], v112 offset:28672
    ds_read_b64_tr_b16 v[98:99], v112 offset:30720
    v_mfma_f32_16x16x32_bf16 v[24:27], v[80:83], v[52:55], v[24:27]
    ds_read_b64_tr_b16 v[100:101], v113 offset:28672
    ds_read_b64_tr_b16 v[102:103], v113 offset:30720
    v_mfma_f32_16x16x32_bf16 v[12:15], v[84:87], v[48:51], v[12:15]
    ds_read_b64_tr_b16 v[104:105], v114 offset:28672
    ds_read_b64_tr_b16 v[106:107], v114 offset:30720
    v_mfma_f32_16x16x32_bf16 v[28:31], v[84:87], v[52:55], v[28:31]
    ds_read_b64_tr_b16 v[108:109], v115 offset:28672
    ds_read_b64_tr_b16 v[110:111], v115 offset:30720
    v_mfma_f32_16x16x32_bf16 v[16:19], v[88:91], v[48:51], v[16:19]
    buffer_load_dwordx4 v[40:43], v116, s[48:51], s77 offen offset:2048 sc1
    buffer_load_dwordx4 v[44:47], v117, s[48:51], s77 offen offset:2048 sc1
    v_mfma_f32_16x16x32_bf16 v[32:35], v[88:91], v[52:55], v[32:35]
    s_waitcnt vmcnt(6)
    v_max3_u32 v2, v56, v57, v58
    v_mfma_f32_16x16x32_bf16 v[20:23], v[92:95], v[48:51], v[20:23]
    v_max3_u32 v2, v2, v59, v60
    v_max3_u32 v2, v2, v61, v62
    v_mfma_f32_16x16x32_bf16 v[36:39], v[92:95], v[52:55], v[36:39]
    v_max_u32 v2, v2, v63
    v_cmp_eq_u32 vcc, -1, v2
    s_cbranch_vccnz L_r7
L_g7:
    s_waitcnt lgkmcnt(0)
    s_cmp_eq_u32 s64, 1
    s_cbranch_scc1 L_nb7
    s_barrier
L_nb7:
    v_mfma_f32_16x16x32_bf16 v[8:11], v[96:99], v[56:59], v[8:11]
    ds_read_b64_tr_b16 v[80:81], v112 offset:32768
    ds_read_b64_tr_b16 v[82:83], v112 offset:34816
    v_mfma_f32_16x16x32_bf16 v[24:27], v[96:99], v[60:63], v[24:27]
    ds_read_b64_tr_b16 v[84:85], v113 offset:32768
    ds_read_b64_tr_b16 v[86:87], v113 offset:34816
    v_mfma_f32_16x16x32_bf16 v[12:15], v[100:103], v[56:59], v[12:15]
    ds_read_b64_tr_b16 v[88:89], v114 offset:32768
    ds_read_b64_tr_b16 v[90:91], v114 offset:34816
    v_mfma_f32_16x16x32_bf16 v[28:31], v[100:103], v[60:63], v[28:31]
    ds_read_b64_tr_b16 v[92:93], v115 offset:32768
    ds_read_b64_tr_b16 v[94:95], v115 offset:34816
    v_mfma_f32_16x16x32_bf16 v[16:19], v[104:107], v[56:59], v[16:19]
    buffer_load_dwordx4 v[48:51], v116, s[48:51], s77 offen offset:3072 sc1
    buffer_load_dwordx4 v[52:55], v117, s[48:51], s77 offen offset:3072 sc1
    v_mfma_f32_16x16x32_bf16 v[32:35], v[104:107], v[60:63], v[32:35]
    s_waitcnt vmcnt(6)
    v_max3_u32 v2, v64, v65, v66
    v_mfma_f32_16x16x32_bf16 v[20:23], v[108:111], v[56:59], v[20:23]
    v_max3_u32 v2, v2, v67, v68
    v_max3_u32 v2, v2, v69, v70
    v_mfma_f32_16x16x32_bf16 v[36:39], v[108:111], v[60:63], v[36:39]
    v_max_u32 v2, v2, v71
    v_cmp_eq_u32_e64 vcc, -1, v2
    s_cbranch_vccnz L_r8
L_g8:
    s_waitcnt lgkmcnt(0)
    v_mfma_f32_16x16x32_bf16 v[8:11], v[80:83], v[64:67], v[8:11]
    ds_read_b64_tr_b16 v[96:97], v112 offset:36864
    ds_read_b64_tr_b16 v[98:99], v112 offset:38912
    v_mfma_f32_16x16x32_bf16 v[24:27], v[80:83], v[68:71], v[24:27]
    ds_read_b64_tr_b16 v[100:101], v113 offset:36864
    ds_read_b64_tr_b16 v[102:103], v113 offset:38912
    v_mfma_f32_16x16x32_bf16 v[12:15], v[84:87], v[64:67], v[12:15]
    ds_read_b64_tr_b16 v[104:105], v114 offset:36864
    ds_read_b64_tr_b16 v[106:107], v114 offset:38912
    v_mfma_f32_16x16x32_bf16 v[28:31], v[84:87], v[68:71], v[28:31]
    ds_read_b64_tr_b16 v[108:109], v115 offset:36864
    ds_read_b64_tr_b16 v[110:111], v115 offset:38912
    v_mfma_f32_16x16x32_bf16 v[16:19], v[88:91], v[64:67], v[16:19]
    s_add_u32 s77, s76, 12288
    buffer_load_dwordx4 v[56:59], v116, s[48:51], s77 offen offset:0 sc1
    buffer_load_dwordx4 v[60:63], v117, s[48:51], s77 offen offset:0 sc1
    v_mfma_f32_16x16x32_bf16 v[32:35], v[88:91], v[68:71], v[32:35]
    s_waitcnt vmcnt(6)
    v_max3_u32 v2, v72, v73, v74
    v_mfma_f32_16x16x32_bf16 v[20:23], v[92:95], v[64:67], v[20:23]
    v_max3_u32 v2, v2, v75, v76
    v_max3_u32 v2, v2, v77, v78
    v_mfma_f32_16x16x32_bf16 v[36:39], v[92:95], v[68:71], v[36:39]
    v_max_u32 v2, v2, v79
    v_cmp_eq_u32_e64 vcc, -1, v2
    s_cbranch_vccnz L_r9
L_g9:
    s_waitcnt lgkmcnt(0)
    v_mfma_f32_16x16x32_bf16 v[8:11], v[96:99], v[72:75], v[8:11]
    ds_read_b64_tr_b16 v[80:81], v112 offset:40960
    ds_read_b64_tr_b16 v[82:83], v112 offset:43008
    v_mfma_f32_16x16x32_bf16 v[24:27], v[96:99], v[76:79], v[24:27]
    ds_read_b64_tr_b16 v[84:85], v113 offset:40960
    ds_read_b64_tr_b16 v[86:87], v113 offset:43008
    v_mfma_f32_16x16x32_bf16 v[12:15], v[100:103], v[72:75], v[12:15]
    ds_read_b64_tr_b16 v[88:89], v114 offset:40960
    ds_read_b64_tr_b16 v[90:91], v114 offset:43008
    v_mfma_f32_16x16x32_bf16 v[28:31], v[100:103], v[76:79], v[28:31]
    ds_read_b64_tr_b16 v[92:93], v115 offset:40960
    ds_read_b64_tr_b16 v[94:95], v115 offset:43008
    v_mfma_f32_16x16x32_bf16 v[16:19], v[104:107], v[72:75], v[16:19]
    buffer_load_dwordx4 v[64:67], v116, s[48:51], s77 offen offset:1024 sc1
    buffer_load_dwordx4 v[68:71], v117, s[48:51], s77 offen offset:1024 sc1
    v_mfma_f32_16x16x32_bf16 v[32:35], v[104:107], v[76:79], v[32:35]
    s_waitcnt vmcnt(6)
    v_max3_u32 v2, v40, v41, v42
    v_mfma_f32_16x16x32_bf16 v[20:23], v[108:111], v[72:75], v[20:23]
    v_max3_u32 v2, v2, v43, v44
    v_max3_u32 v2, v2, v45, v46
    v_mfma_f32_16x16x32_bf16 v[36:39], v[108:111], v[76:79], v[36:39]
    v_max_u32 v2, v2, v47
    v_cmp_eq_u32_e64 vcc, -1, v2
    s_cbranch_vccnz L_r10
L_g10:
    s_waitcnt lgkmcnt(0)
    v_mfma_f32_16x16x32_bf16 v[8:11], v[80:83], v[40:43], v[8:11]
    ds_read_b64_tr_b16 v[96:97], v112 offset:45056
    ds_read_b64_tr_b16 v[98:99], v112 offset:47104
    v_mfma_f32_16x16x32_bf16 v[24:27], v[80:83], v[44:47], v[24:27]
    ds_read_b64_tr_b16 v[100:101], v113 offset:45056
    ds_read_b64_tr_b16 v[102:103], v113 offset:47104
    v_mfma_f32_16x16x32_bf16 v[12:15], v[84:87], v[40:43], v[12:15]
    ds_read_b64_tr_b16 v[104:105], v114 offset:45056
    ds_read_b64_tr_b16 v[106:107], v114 offset:47104
    v_mfma_f32_16x16x32_bf16 v[28:31], v[84:87], v[44:47], v[28:31]
    ds_read_b64_tr_b16 v[108:109], v115 offset:45056
    ds_read_b64_tr_b16 v[110:111], v115 offset:47104
    v_mfma_f32_16x16x32_bf16 v[16:19], v[88:91], v[40:43], v[16:19]
    buffer_load_dwordx4 v[72:75], v116, s[48:51], s77 offen offset:2048 sc1
    buffer_load_dwordx4 v[76:79], v117, s[48:51], s77 offen offset:2048 sc1
    v_mfma_f32_16x16x32_bf16 v[32:35], v[88:91], v[44:47], v[32:35]
    s_waitcnt vmcnt(6)
    v_max3_u32 v2, v48, v49, v50
    v_mfma_f32_16x16x32_bf16 v[20:23], v[92:95], v[40:43], v[20:23]
    v_max3_u32 v2, v2, v51, v52
    v_max3_u32 v2, v2, v53, v54
    v_mfma_f32_16x16x32_bf16 v[36:39], v[92:95], v[44:47], v[36:39]
    v_max_u32 v2, v2, v55
    v_cmp_eq_u32_e64 vcc, -1, v2
    s_cbranch_vccnz L_r11
L_g11:
    s_waitcnt lgkmcnt(0)
    v_mfma_f32_16x16x32_bf16 v[8:11], v[96:99], v[48:51], v[8:11]
    ds_read_b64_tr_b16 v[80:81], v112 offset:49152
    ds_read_b64_tr_b16 v[82:83], v112 offset:51200
    v_mfma_f32_16x16x32_bf16 v[24:27], v[96:99], v[52:55], v[24:27]
    ds_read_b64_tr_b16 v[84:85], v113 offset:49152
    ds_read_b64_tr_b16 v[86:87], v113 offset:51200
    v_mfma_f32_16x16x32_bf16 v[12:15], v[100:103], v[48:51], v[12:15]
    ds_read_b64_tr_b16 v[88:89], v114 offset:49152
    ds_read_b64_tr_b16 v[90:91], v114 offset:51200
    v_mfma_f32_16x16x32_bf16 v[28:31], v[100:103], v[52:55], v[28:31]
    ds_read_b64_tr_b16 v[92:93], v115 offset:49152
    ds_read_b64_tr_b16 v[94:95], v115 offset:51200
    v_mfma_f32_16x16x32_bf16 v[16:19], v[104:107], v[48:51], v[16:19]
    buffer_load_dwordx4 v[40:43], v116, s[48:51], s77 offen offset:3072 sc1
    buffer_load_dwordx4 v[44:47], v117, s[48:51], s77 offen offset:3072 sc1
    v_mfma_f32_16x16x32_bf16 v[32:35], v[104:107], v[52:55], v[32:35]
    s_waitcnt vmcnt(6)
    v_max3_u32 v2, v56, v57, v58
    v_mfma_f32_16x16x32_bf16 v[20:23], v[108:111], v[48:51], v[20:23]
    v_max3_u32 v2, v2, v59, v60
    v_max3_u32 v2, v2, v61, v62
    v_mfma_f32_16x16x32_bf16 v[36:39], v[108:111], v[52:55], v[36:39]
    v_max_u32 v2, v2, v63
    v_cmp_eq_u32_e64 vcc, -1, v2
    s_cbranch_vccnz L_r12
L_g12:
    s_waitcnt lgkmcnt(0)
    v_mfma_f32_16x16x32_bf16 v[8:11], v[80:83], v[56:59], v[8:11]
    ds_read_b64_tr_b16 v[96:97], v112 offset:53248
    ds_read_b64_tr_b16 v[98:99], v112 offset:55296
    v_mfma_f32_16x16x32_bf16 v[24:27], v[80:83], v[60:63], v[24:27]
    ds_read_b64_tr_b16 v[100:101], v113 offset:53248
    ds_read_b64_tr_b16 v[102:103], v113 offset:55296
    v_mfma_f32_16x16x32_bf16 v[12:15], v[84:87], v[56:59], v[12:15]
    ds_read_b64_tr_b16 v[104:105], v114 offset:53248
    ds_read_b64_tr_b16 v[106:107], v114 offset:55296
    v_mfma_f32_16x16x32_bf16 v[28:31], v[84:87], v[60:63], v[28:31]
    ds_read_b64_tr_b16 v[108:109], v115 offset:53248
    ds_read_b64_tr_b16 v[110:111], v115 offset:55296
    v_mfma_f32_16x16x32_bf16 v[16:19], v[88:91], v[56:59], v[16:19]
    v_mfma_f32_16x16x32_bf16 v[32:35], v[88:91], v[60:63], v[32:35]
    s_waitcnt vmcnt(4)
    v_max3_u32 v2, v64, v65, v66
    v_mfma_f32_16x16x32_bf16 v[20:23], v[92:95], v[56:59], v[20:23]
    v_max3_u32 v2, v2, v67, v68
    v_max3_u32 v2, v2, v69, v70
    v_mfma_f32_16x16x32_bf16 v[36:39], v[92:95], v[60:63], v[36:39]
    v_max_u32 v2, v2, v71
    v_cmp_eq_u32_e64 vcc, -1, v2
    s_cbranch_vccnz L_r13
L_g13:
    s_waitcnt lgkmcnt(0)
    v_mfma_f32_16x16x32_bf16 v[8:11], v[96:99], v[64:67], v[8:11]
    ds_read_b64_tr_b16 v[80:81], v112 offset:57344
    ds_read_b64_tr_b16 v[82:83], v112 offset:59392
    v_mfma_f32_16x16x32_bf16 v[24:27], v[96:99], v[68:71], v[24:27]
    ds_read_b64_tr_b16 v[84:85], v113 offset:57344
    ds_read_b64_tr_b16 v[86:87], v113 offset:59392
    v_mfma_f32_16x16x32_bf16 v[12:15], v[100:103], v[64:67], v[12:15]
    ds_read_b64_tr_b16 v[88:89], v114 offset:57344
    ds_read_b64_tr_b16 v[90:91], v114 offset:59392
    v_mfma_f32_16x16x32_bf16 v[28:31], v[100:103], v[68:71], v[28:31]
    ds_read_b64_tr_b16 v[92:93], v115 offset:57344
    ds_read_b64_tr_b16 v[94:95], v115 offset:59392
    v_mfma_f32_16x16x32_bf16 v[16:19], v[104:107], v[64:67], v[16:19]
    v_mfma_f32_16x16x32_bf16 v[32:35], v[104:107], v[68:71], v[32:35]
    s_waitcnt vmcnt(2)
    v_max3_u32 v2, v72, v73, v74
    v_mfma_f32_16x16x32_bf16 v[20:23], v[108:111], v[64:67], v[20:23]
    v_max3_u32 v2, v2, v75, v76
    v_max3_u32 v2, v2, v77, v78
    v_mfma_f32_16x16x32_bf16 v[36:39], v[108:111], v[68:71], v[36:39]
    v_max_u32 v2, v2, v79
    v_cmp_eq_u32_e64 vcc, -1, v2
    s_cbranch_vccnz L_r14
L_g14:
    s_cmp_eq_u32 s83, 0
    s_cbranch_scc1 L_fx1
L_fx1r:
    s_waitcnt lgkmcnt(0)
    v_mfma_f32_16x16x32_bf16 v[8:11], v[80:83], v[72:75], v[8:11]
    ds_read_b64_tr_b16 v[96:97], v112 offset:61440
    ds_read_b64_tr_b16 v[98:99], v112 offset:63488
    v_mfma_f32_16x16x32_bf16 v[24:27], v[80:83], v[76:79], v[24:27]
    ds_read_b64_tr_b16 v[100:101], v113 offset:61440
    ds_read_b64_tr_b16 v[102:103], v113 offset:63488
    v_mfma_f32_16x16x32_bf16 v[12:15], v[84:87], v[72:75], v[12:15]
    ds_read_b64_tr_b16 v[104:105], v114 offset:61440
    ds_read_b64_tr_b16 v[106:107], v114 offset:63488
    v_mfma_f32_16x16x32_bf16 v[28:31], v[84:87], v[76:79], v[28:31]
    ds_read_b64_tr_b16 v[108:109], v115 offset:61440
    ds_read_b64_tr_b16 v[110:111], v115 offset:63488
    v_mfma_f32_16x16x32_bf16 v[16:19], v[88:91], v[72:75], v[16:19]
    v_mfma_f32_16x16x32_bf16 v[32:35], v[88:91], v[76:79], v[32:35]
    s_waitcnt vmcnt(0)
    v_max3_u32 v2, v40, v41, v42
    v_mfma_f32_16x16x32_bf16 v[20:23], v[92:95], v[72:75], v[20:23]
    v_max3_u32 v2, v2, v43, v44
    v_max3_u32 v2, v2, v45, v46
    v_mfma_f32_16x16x32_bf16 v[36:39], v[92:95], v[76:79], v[36:39]
    v_max_u32 v2, v2, v47
    v_cmp_eq_u32_e64 vcc, -1, v2
    s_cbranch_vccnz L_r15
L_g15:
    s_waitcnt lgkmcnt(0)
    v_mfma_f32_16x16x32_bf16 v[8:11], v[96:99], v[40:43], v[8:11]
    v_mfma_f32_16x16x32_bf16 v[24:27], v[96:99], v[44:47], v[24:27]
    v_mfma_f32_16x16x32_bf16 v[12:15], v[100:103], v[40:43], v[12:15]
    v_mfma_f32_16x16x32_bf16 v[28:31], v[100:103], v[44:47], v[28:31]
    v_mfma_f32_16x16x32_bf16 v[16:19], v[104:107], v[40:43], v[16:19]
    v_mfma_f32_16x16x32_bf16 v[32:35], v[104:107], v[44:47], v[32:35]
    v_mfma_f32_16x16x32_bf16 v[20:23], v[108:111], v[40:43], v[20:23]
    v_mfma_f32_16x16x32_bf16 v[36:39], v[108:111], v[44:47], v[36:39]
    s_cmp_eq_u32 s83, 0
    s_cbranch_scc1 L_fx2
L_fx2r:
    s_lshl_b32 s3, s39, 12
    s_add_u32 s3, s3, 131072
    v_lshlrev_b32 v2, 4, v1
    v_add_u32_e64 v2, s3, v2
    v_xor_b32 v3, 0x4000, v2
    s_xor_b32 s28, s3, 0x4000
    ds_write_b128 v2, v[24:27] offset:0
    ds_write_b128 v2, v[28:31] offset:1024
    ds_write_b128 v2, v[32:35] offset:2048
    ds_write_b128 v2, v[36:39] offset:3072
    v_lshlrev_b32 v40, 16, v240
    v_and_b32 v41, 0xffff0000, v240
    v_lshlrev_b32 v42, 16, v241
    v_and_b32 v43, 0xffff0000, v241
    v_lshlrev_b32 v44, 16, v242
    v_and_b32 v45, 0xffff0000, v242
    v_lshlrev_b32 v46, 16, v243
    v_and_b32 v47, 0xffff0000, v243
    v_lshlrev_b32 v48, 16, v244
    v_and_b32 v49, 0xffff0000, v244
    v_lshlrev_b32 v50, 16, v245
    v_and_b32 v51, 0xffff0000, v245
    v_lshlrev_b32 v52, 16, v246
    v_and_b32 v53, 0xffff0000, v246
    v_lshlrev_b32 v54, 16, v247
    v_and_b32 v55, 0xffff0000, v247
    v_and_b32 v4, 15, v1
    v_lshrrev_b32 v5, 4, v1
    v_lshlrev_b32 v6, 1, v4
    v_and_b32 v6, 14, v6
    v_xor_b32_e64 v5, v5, v6
    v_lshl_add_u32 v4, v4, 7, s28
    v_lshl_add_u32 v4, v5, 3, v4
    v_lshrrev_b32 v5, 3, v1
    v_and_b32 v6, 7, v1
    v_xor_b32_e64 v7, v6, v5
    v_lshl_add_u32 v7, v7, 4, s28
    v_lshl_add_u32 v7, v5, 7, v7
    s_lshl_b32 s3, s34, 7
    s_add_u32 s3, s3, s69
    v_add_u32 v5, s3, v5
    v_lshlrev_b32 v5, 11, v5
    v_lshl_add_u32 v5, v6, 4, v5
    s_lshl_b32 s3, s35, 7
    s_add_u32 s28, s3, 16384
    s_lshl_b32 s29, s34, 7
    s_add_u32 s29, s29, s69
    s_andn2_b32 s77, s68, 15
    s_cmp_lg_u32 s29, s77
    s_waitcnt lgkmcnt(0)
    s_barrier
    s_cbranch_scc1 L_nov
    v_and_b32 v2, 48, v1
    s_and_b32 s29, s68, 15
    s_lshl_b32 exec_lo, 0x00010001, s29
    s_mov_b32 exec_hi, exec_lo
    ds_read_b128 v[224:227], v2 offset:0
    ds_read_b128 v[228:231], v2 offset:64
    ds_read_b128 v[232:235], v2 offset:128
    ds_read_b128 v[236:239], v2 offset:192
    s_mov_b64 exec, -1
L_nov:
    ds_read_b128 v[24:27], v3 offset:0
    ds_read_b128 v[28:31], v3 offset:1024
    ds_read_b128 v[32:35], v3 offset:2048
    ds_read_b128 v[36:39], v3 offset:3072
    s_waitcnt lgkmcnt(3)
    s_nop 0
    v_pk_add_f32 v[8:9], v[8:9], v[24:25]
    v_pk_add_f32 v[10:11], v[10:11], v[26:27]
    v_pk_fma_f32 v[40:41], v[8:9], v[224:225], v[40:41]
    v_pk_fma_f32 v[42:43], v[10:11], v[226:227], v[42:43]
    v_cvt_pk_bf16_f32 v8, v40, v41
    v_cvt_pk_bf16_f32 v9, v42, v43
    s_waitcnt lgkmcnt(2)
    s_nop 0
    v_pk_add_f32 v[12:13], v[12:13], v[28:29]
    v_pk_add_f32 v[14:15], v[14:15], v[30:31]
    v_pk_fma_f32 v[44:45], v[12:13], v[228:229], v[44:45]
    v_pk_fma_f32 v[46:47], v[14:15], v[230:231], v[46:47]
    v_cvt_pk_bf16_f32 v10, v44, v45
    v_cvt_pk_bf16_f32 v11, v46, v47
    s_waitcnt lgkmcnt(1)
    s_nop 0
    v_pk_add_f32 v[16:17], v[16:17], v[32:33]
    v_pk_add_f32 v[18:19], v[18:19], v[34:35]
    v_pk_fma_f32 v[48:49], v[16:17], v[232:233], v[48:49]
    v_pk_fma_f32 v[50:51], v[18:19], v[234:235], v[50:51]
    v_cvt_pk_bf16_f32 v12, v48, v49
    v_cvt_pk_bf16_f32 v13, v50, v51
    s_waitcnt lgkmcnt(0)
    s_nop 0
    v_pk_add_f32 v[20:21], v[20:21], v[36:37]
    v_pk_add_f32 v[22:23], v[22:23], v[38:39]
    v_pk_fma_f32 v[52:53], v[20:21], v[236:237], v[52:53]
    v_pk_fma_f32 v[54:55], v[22:23], v[238:239], v[54:55]
    v_cvt_pk_bf16_f32 v14, v52, v53
    v_cvt_pk_bf16_f32 v15, v54, v55
    ds_write_b64 v4, v[8:9]
    v_xor_b32 v6, 32, v4
    ds_write_b64 v6, v[10:11]
    v_xor_b32 v6, 64, v4
    ds_write_b64 v6, v[12:13]
    v_xor_b32 v6, 96, v4
    ds_write_b64 v6, v[14:15]
    ds_read_b128 v[24:27], v7 offset:0
    ds_read_b128 v[28:31], v7 offset:1024
    s_waitcnt lgkmcnt(1)
    buffer_store_dwordx4 v[24:27], v5, s[56:59], s3 offen sc1
    s_waitcnt lgkmcnt(0)
    buffer_store_dwordx4 v[28:31], v5, s[56:59], s28 offen sc1
L_done:
    s_endpgm
L_fx1:
    s_lshl_b32 s78, s35, 14
    s_add_u32 s78, s78, 1413120
    v_and_b32 v2, 15, v1
    v_lshrrev_b32 v3, 4, v1
    v_lshl_add_u32 v193, v2, 2, v3
    v_and_b32 v2, 7, v193
    v_lshrrev_b32 v193, 3, v193
    v_lshl_add_u32 v193, v2, 3, v193
    v_lshlrev_b32 v2, 1, v193
    s_lshl_b32 s3, s68, 11
    s_lshl_b32 s28, s35, 7
    s_add_u32 s3, s3, s28
    buffer_load_ushort v194, v2, s[40:43], s3 offen
    s_add_u32 s3, s78, 0
    s_nop 0
    buffer_load_dwordx4 v[128:131], v222, s[48:51], s3 offen offset:0 sc1
    buffer_load_dwordx4 v[132:135], v222, s[48:51], s3 offen offset:1024 sc1
    buffer_load_dwordx4 v[136:139], v222, s[48:51], s3 offen offset:2048 sc1
    buffer_load_dwordx4 v[140:143], v222, s[48:51], s3 offen offset:3072 sc1
    s_add_u32 s3, s78, 4096
    buffer_load_dwordx4 v[144:147], v222, s[48:51], s3 offen offset:0 sc1
    buffer_load_dwordx4 v[148:151], v222, s[48:51], s3 offen offset:1024 sc1
    buffer_load_dwordx4 v[152:155], v222, s[48:51], s3 offen offset:2048 sc1
    buffer_load_dwordx4 v[156:159], v222, s[48:51], s3 offen offset:3072 sc1
    s_add_u32 s3, s78, 8192
    buffer_load_dwordx4 v[160:163], v222, s[48:51], s3 offen offset:0 sc1
    buffer_load_dwordx4 v[164:167], v222, s[48:51], s3 offen offset:1024 sc1
    buffer_load_dwordx4 v[168:171], v222, s[48:51], s3 offen offset:2048 sc1
    buffer_load_dwordx4 v[172:175], v222, s[48:51], s3 offen offset:3072 sc1
    s_add_u32 s3, s78, 12288
    buffer_load_dwordx4 v[176:179], v222, s[48:51], s3 offen offset:0 sc1
    buffer_load_dwordx4 v[180:183], v222, s[48:51], s3 offen offset:1024 sc1
    buffer_load_dwordx4 v[184:187], v222, s[48:51], s3 offen offset:2048 sc1
    buffer_load_dwordx4 v[188:191], v222, s[48:51], s3 offen offset:3072 sc1
    s_branch L_fx1r
L_fx2:
    s_and_b32 s3, s70, 0xffff0000
    s_xor_b32 s28, s3, 0x80000000
    s_not_b32 s29, s3
    s_and_b32 s29, s29, 0xffff0000
    s_bitcmp1_b32 s3, 31
    s_cselect_b32 s3, s28, s29
    v_mov_b32 v195, s3
    v_mul_f32 v195, 0xbfb8aa3b, v195
    v_exp_f32 v195, v195
    s_nop 0
    v_add_f32 v195, 1.0, v195
    v_rcp_f32 v195, v195
    s_nop 0
    v_cvt_pk_bf16_f32 v195, v195, v195
    v_lshlrev_b32 v195, 16, v195
    s_mov_b32 s29, 0
L_k6:
    v_max3_u32 v2, v128, v129, v130
    v_max3_u32 v2, v2, v131, v132
    v_max3_u32 v2, v2, v133, v134
    v_max3_u32 v2, v2, v135, v136
    v_max3_u32 v2, v2, v137, v138
    v_max3_u32 v2, v2, v139, v140
    v_max3_u32 v2, v2, v141, v142
    v_max3_u32 v2, v2, v143, v144
    v_max3_u32 v2, v2, v145, v146
    v_max3_u32 v2, v2, v147, v148
    v_max3_u32 v2, v2, v149, v150
    v_max3_u32 v2, v2, v151, v152
    v_max3_u32 v2, v2, v153, v154
    v_max3_u32 v2, v2, v155, v156
    v_max3_u32 v2, v2, v157, v158
    v_max3_u32 v2, v2, v159, v160
    v_max3_u32 v2, v2, v161, v162
    v_max3_u32 v2, v2, v163, v164
    v_max3_u32 v2, v2, v165, v166
    v_max3_u32 v2, v2, v167, v168
    v_max3_u32 v2, v2, v169, v170
    v_max3_u32 v2, v2, v171, v172
    v_max3_u32 v2, v2, v173, v174
    v_max3_u32 v2, v2, v175, v176
    v_max3_u32 v2, v2, v177, v178
    v_max3_u32 v2, v2, v179, v180
    v_max3_u32 v2, v2, v181, v182
    v_max3_u32 v2, v2, v183, v184
    v_max3_u32 v2, v2, v185, v186
    v_max3_u32 v2, v2, v187, v188
    v_max3_u32 v2, v2, v189, v190
    v_max_u32 v2, v2, v191
    v_cmp_eq_u32 vcc, -1, v2
    s_cbranch_vccz L_k6k
    s_add_u32 s29, s29, 1
    s_cmp_ge_u32 s29, 200000
    s_cbranch_scc1 L_k6k
    s_sleep 4
    s_add_u32 s3, s78, 0
    s_nop 0
    buffer_load_dwordx4 v[128:131], v222, s[48:51], s3 offen offset:0 sc1
    buffer_load_dwordx4 v[132:135], v222, s[48:51], s3 offen offset:1024 sc1
    buffer_load_dwordx4 v[136:139], v222, s[48:51], s3 offen offset:2048 sc1
    buffer_load_dwordx4 v[140:143], v222, s[48:51], s3 offen offset:3072 sc1
    s_add_u32 s3, s78, 4096
    buffer_load_dwordx4 v[144:147], v222, s[48:51], s3 offen offset:0 sc1
    buffer_load_dwordx4 v[148:151], v222, s[48:51], s3 offen offset:1024 sc1
    buffer_load_dwordx4 v[152:155], v222, s[48:51], s3 offen offset:2048 sc1
    buffer_load_dwordx4 v[156:159], v222, s[48:51], s3 offen offset:3072 sc1
    s_add_u32 s3, s78, 8192
    buffer_load_dwordx4 v[160:163], v222, s[48:51], s3 offen offset:0 sc1
    buffer_load_dwordx4 v[164:167], v222, s[48:51], s3 offen offset:1024 sc1
    buffer_load_dwordx4 v[168:171], v222, s[48:51], s3 offen offset:2048 sc1
    buffer_load_dwordx4 v[172:175], v222, s[48:51], s3 offen offset:3072 sc1
    s_add_u32 s3, s78, 12288
    buffer_load_dwordx4 v[176:179], v222, s[48:51], s3 offen offset:0 sc1
    buffer_load_dwordx4 v[180:183], v222, s[48:51], s3 offen offset:1024 sc1
    buffer_load_dwordx4 v[184:187], v222, s[48:51], s3 offen offset:2048 sc1
    buffer_load_dwordx4 v[188:191], v222, s[48:51], s3 offen offset:3072 sc1
    s_waitcnt vmcnt(0)
    s_branch L_k6
L_k6k:
    v_pk_add_f32 v[128:129], v[128:129], v[160:161]
    v_pk_add_f32 v[130:131], v[130:131], v[162:163]
    v_pk_add_f32 v[132:133], v[132:133], v[164:165]
    v_pk_add_f32 v[134:135], v[134:135], v[166:167]
    v_pk_add_f32 v[136:137], v[136:137], v[168:169]
    v_pk_add_f32 v[138:139], v[138:139], v[170:171]
    v_pk_add_f32 v[140:141], v[140:141], v[172:173]
    v_pk_add_f32 v[142:143], v[142:143], v[174:175]
    v_pk_add_f32 v[144:145], v[144:145], v[176:177]
    v_pk_add_f32 v[146:147], v[146:147], v[178:179]
    v_pk_add_f32 v[148:149], v[148:149], v[180:181]
    v_pk_add_f32 v[150:151], v[150:151], v[182:183]
    v_pk_add_f32 v[152:153], v[152:153], v[184:185]
    v_pk_add_f32 v[154:155], v[154:155], v[186:187]
    v_pk_add_f32 v[156:157], v[156:157], v[188:189]
    v_pk_add_f32 v[158:159], v[158:159], v[190:191]
    v_pk_add_f32 v[128:129], v[128:129], v[144:145]
    v_pk_add_f32 v[130:131], v[130:131], v[146:147]
    v_pk_add_f32 v[132:133], v[132:133], v[148:149]
    v_pk_add_f32 v[134:135], v[134:135], v[150:151]
    v_pk_add_f32 v[136:137], v[136:137], v[152:153]
    v_pk_add_f32 v[138:139], v[138:139], v[154:155]
    v_pk_add_f32 v[140:141], v[140:141], v[156:157]
    v_pk_add_f32 v[142:143], v[142:143], v[158:159]
    v_pk_add_f32 v[128:129], v[128:129], v[136:137]
    v_pk_add_f32 v[130:131], v[130:131], v[138:139]
    v_pk_add_f32 v[132:133], v[132:133], v[140:141]
    v_pk_add_f32 v[134:135], v[134:135], v[142:143]
    v_pk_add_f32 v[128:129], v[128:129], v[132:133]
    v_pk_add_f32 v[130:131], v[130:131], v[134:135]
    s_nop 1
    v_permlane32_swap_b32 v128, v130
    v_permlane32_swap_b32 v129, v131
    v_add_f32 v128, v128, v130
    v_add_f32 v129, v129, v131
    s_nop 1
    v_permlane16_swap_b32 v128, v129
    v_add_f32 v128, v128, v129
    v_cvt_pk_bf16_f32 v128, v128, v128
    v_lshlrev_b32 v128, 16, v128
    v_mul_f32 v128, v128, v195
    v_lshlrev_b32 v194, 16, v194
    v_sub_f32 v194, v194, v250
    v_cvt_pk_bf16_f32 v128, v128, v128
    v_lshlrev_b32 v128, 16, v128
    v_cvt_pk_bf16_f32 v194, v194, v194
    v_lshlrev_b32 v194, 16, v194
    v_mul_f32 v194, v194, v251
    v_cvt_pk_bf16_f32 v194, v194, v194
    v_lshlrev_b32 v194, 16, v194
    v_add_f32 v128, v128, v194
    v_cvt_pk_bf16_f32 v128, v128, v128
    v_lshlrev_b32 v128, 16, v128
    v_mul_f32 v2, 0xbfb8aa3b, v128
    v_exp_f32 v2, v2
    s_nop 0
    v_add_f32 v2, 1.0, v2
    v_rcp_f32 v2, v2
    s_nop 0
    v_mul_f32 v2, v128, v2
    v_lshlrev_b32 v3, 2, v193
    ds_write_b32 v3, v2
    s_branch L_fx2r
L_r0:
    s_add_u32 s29, s29, 1
    s_cmp_ge_u32 s29, 200000
    s_cbranch_scc1 L_g0
    s_add_u32 s3, s76, 0
    buffer_load_dwordx4 v[40:43], v116, s[48:51], s3 offen offset:0 sc1
    buffer_load_dwordx4 v[44:47], v117, s[48:51], s3 offen offset:0 sc1
    s_waitcnt vmcnt(0)
    v_max3_u32 v2, v40, v41, v42
    v_max3_u32 v2, v2, v43, v44
    v_max3_u32 v2, v2, v45, v46
    v_max_u32 v2, v2, v47
    v_cmp_eq_u32 vcc, -1, v2
    s_cbranch_vccnz L_r0
    s_branch L_g0
L_r1:
    s_add_u32 s29, s29, 1
    s_cmp_ge_u32 s29, 200000
    s_cbranch_scc1 L_g1
    s_add_u32 s3, s76, 0
    buffer_load_dwordx4 v[48:51], v116, s[48:51], s3 offen offset:1024 sc1
    buffer_load_dwordx4 v[52:55], v117, s[48:51], s3 offen offset:1024 sc1
    s_waitcnt vmcnt(0)
    v_max3_u32 v2, v48, v49, v50
    v_max3_u32 v2, v2, v51, v52
    v_max3_u32 v2, v2, v53, v54
    v_max_u32 v2, v2, v55
    v_cmp_eq_u32 vcc, -1, v2
    s_cbranch_vccnz L_r1
    s_branch L_g1
L_r2:
    s_add_u32 s29, s29, 1
    s_cmp_ge_u32 s29, 200000
    s_cbranch_scc1 L_g2
    s_add_u32 s3, s76, 0
    buffer_load_dwordx4 v[56:59], v116, s[48:51], s3 offen offset:2048 sc1
    buffer_load_dwordx4 v[60:63], v117, s[48:51], s3 offen offset:2048 sc1
    s_waitcnt vmcnt(0)
    v_max3_u32 v2, v56, v57, v58
    v_max3_u32 v2, v2, v59, v60
    v_max3_u32 v2, v2, v61, v62
    v_max_u32 v2, v2, v63
    v_cmp_eq_u32 vcc, -1, v2
    s_cbranch_vccnz L_r2
    s_branch L_g2
L_r3:
    s_add_u32 s29, s29, 1
    s_cmp_ge_u32 s29, 200000
    s_cbranch_scc1 L_g3
    s_add_u32 s3, s76, 0
    buffer_load_dwordx4 v[64:67], v116, s[48:51], s3 offen offset:3072 sc1
    buffer_load_dwordx4 v[68:71], v117, s[48:51], s3 offen offset:3072 sc1
    s_waitcnt vmcnt(0)
    v_max3_u32 v2, v64, v65, v66
    v_max3_u32 v2, v2, v67, v68
    v_max3_u32 v2, v2, v69, v70
    v_max_u32 v2, v2, v71
    v_cmp_eq_u32 vcc, -1, v2
    s_cbranch_vccnz L_r3
    s_branch L_g3
L_r4:
    s_add_u32 s29, s29, 1
    s_cmp_ge_u32 s29, 200000
    s_cbranch_scc1 L_g4
    s_add_u32 s3, s76, 4096
    buffer_load_dwordx4 v[72:75], v116, s[48:51], s3 offen offset:0 sc1
    buffer_load_dwordx4 v[76:79], v117, s[48:51], s3 offen offset:0 sc1
    s_waitcnt vmcnt(0)
    v_max3_u32 v2, v72, v73, v74
    v_max3_u32 v2, v2, v75, v76
    v_max3_u32 v2, v2, v77, v78
    v_max_u32 v2, v2, v79
    v_cmp_eq_u32 vcc, -1, v2
    s_cbranch_vccnz L_r4
    s_branch L_g4
L_r5:
    s_add_u32 s29, s29, 1
    s_cmp_ge_u32 s29, 200000
    s_cbranch_scc1 L_g5
    s_add_u32 s3, s76, 4096
    buffer_load_dwordx4 v[40:43], v116, s[48:51], s3 offen offset:1024 sc1
    buffer_load_dwordx4 v[44:47], v117, s[48:51], s3 offen offset:1024 sc1
    s_waitcnt vmcnt(0)
    v_max3_u32 v2, v40, v41, v42
    v_max3_u32 v2, v2, v43, v44
    v_max3_u32 v2, v2, v45, v46
    v_max_u32 v2, v2, v47
    v_cmp_eq_u32 vcc, -1, v2
    s_cbranch_vccnz L_r5
    s_branch L_g5
L_r6:
    s_add_u32 s29, s29, 1
    s_cmp_ge_u32 s29, 200000
    s_cbranch_scc1 L_g6
    s_add_u32 s3, s76, 4096
    buffer_load_dwordx4 v[48:51], v116, s[48:51], s3 offen offset:2048 sc1
    buffer_load_dwordx4 v[52:55], v117, s[48:51], s3 offen offset:2048 sc1
    s_waitcnt vmcnt(0)
    v_max3_u32 v2, v48, v49, v50
    v_max3_u32 v2, v2, v51, v52
    v_max3_u32 v2, v2, v53, v54
    v_max_u32 v2, v2, v55
    v_cmp_eq_u32 vcc, -1, v2
    s_cbranch_vccnz L_r6
    s_branch L_g6
L_r7:
    s_add_u32 s29, s29, 1
    s_cmp_ge_u32 s29, 200000
    s_cbranch_scc1 L_g7
    s_add_u32 s3, s76, 4096
    buffer_load_dwordx4 v[56:59], v116, s[48:51], s3 offen offset:3072 sc1
    buffer_load_dwordx4 v[60:63], v117, s[48:51], s3 offen offset:3072 sc1
    s_waitcnt vmcnt(0)
    v_max3_u32 v2, v56, v57, v58
    v_max3_u32 v2, v2, v59, v60
    v_max3_u32 v2, v2, v61, v62
    v_max_u32 v2, v2, v63
    v_cmp_eq_u32 vcc, -1, v2
    s_cbranch_vccnz L_r7
    s_branch L_g7
L_r8:
    s_add_u32 s29, s29, 1
    s_cmp_ge_u32 s29, 200000
    s_cbranch_scc1 L_g8
    s_add_u32 s3, s76, 8192
    buffer_load_dwordx4 v[64:67], v116, s[48:51], s3 offen offset:0 sc1
    buffer_load_dwordx4 v[68:71], v117, s[48:51], s3 offen offset:0 sc1
    s_waitcnt vmcnt(0)
    v_max3_u32 v2, v64, v65, v66
    v_max3_u32 v2, v2, v67, v68
    v_max3_u32 v2, v2, v69, v70
    v_max_u32 v2, v2, v71
    v_cmp_eq_u32 vcc, -1, v2
    s_cbranch_vccnz L_r8
    s_branch L_g8
L_r9:
    s_add_u32 s29, s29, 1
    s_cmp_ge_u32 s29, 200000
    s_cbranch_scc1 L_g9
    s_add_u32 s3, s76, 8192
    buffer_load_dwordx4 v[72:75], v116, s[48:51], s3 offen offset:1024 sc1
    buffer_load_dwordx4 v[76:79], v117, s[48:51], s3 offen offset:1024 sc1
    s_waitcnt vmcnt(0)
    v_max3_u32 v2, v72, v73, v74
    v_max3_u32 v2, v2, v75, v76
    v_max3_u32 v2, v2, v77, v78
    v_max_u32 v2, v2, v79
    v_cmp_eq_u32 vcc, -1, v2
    s_cbranch_vccnz L_r9
    s_branch L_g9
L_r10:
    s_add_u32 s29, s29, 1
    s_cmp_ge_u32 s29, 200000
    s_cbranch_scc1 L_g10
    s_add_u32 s3, s76, 8192
    buffer_load_dwordx4 v[40:43], v116, s[48:51], s3 offen offset:2048 sc1
    buffer_load_dwordx4 v[44:47], v117, s[48:51], s3 offen offset:2048 sc1
    s_waitcnt vmcnt(0)
    v_max3_u32 v2, v40, v41, v42
    v_max3_u32 v2, v2, v43, v44
    v_max3_u32 v2, v2, v45, v46
    v_max_u32 v2, v2, v47
    v_cmp_eq_u32 vcc, -1, v2
    s_cbranch_vccnz L_r10
    s_branch L_g10
L_r11:
    s_add_u32 s29, s29, 1
    s_cmp_ge_u32 s29, 200000
    s_cbranch_scc1 L_g11
    s_add_u32 s3, s76, 8192
    buffer_load_dwordx4 v[48:51], v116, s[48:51], s3 offen offset:3072 sc1
    buffer_load_dwordx4 v[52:55], v117, s[48:51], s3 offen offset:3072 sc1
    s_waitcnt vmcnt(0)
    v_max3_u32 v2, v48, v49, v50
    v_max3_u32 v2, v2, v51, v52
    v_max3_u32 v2, v2, v53, v54
    v_max_u32 v2, v2, v55
    v_cmp_eq_u32 vcc, -1, v2
    s_cbranch_vccnz L_r11
    s_branch L_g11
L_r12:
    s_add_u32 s29, s29, 1
    s_cmp_ge_u32 s29, 200000
    s_cbranch_scc1 L_g12
    s_add_u32 s3, s76, 12288
    buffer_load_dwordx4 v[56:59], v116, s[48:51], s3 offen offset:0 sc1
    buffer_load_dwordx4 v[60:63], v117, s[48:51], s3 offen offset:0 sc1
    s_waitcnt vmcnt(0)
    v_max3_u32 v2, v56, v57, v58
    v_max3_u32 v2, v2, v59, v60
    v_max3_u32 v2, v2, v61, v62
    v_max_u32 v2, v2, v63
    v_cmp_eq_u32 vcc, -1, v2
    s_cbranch_vccnz L_r12
    s_branch L_g12
L_r13:
    s_add_u32 s29, s29, 1
    s_cmp_ge_u32 s29, 200000
    s_cbranch_scc1 L_g13
    s_add_u32 s3, s76, 12288
    buffer_load_dwordx4 v[64:67], v116, s[48:51], s3 offen offset:1024 sc1
    buffer_load_dwordx4 v[68:71], v117, s[48:51], s3 offen offset:1024 sc1
    s_waitcnt vmcnt(0)
    v_max3_u32 v2, v64, v65, v66
    v_max3_u32 v2, v2, v67, v68
    v_max3_u32 v2, v2, v69, v70
    v_max_u32 v2, v2, v71
    v_cmp_eq_u32 vcc, -1, v2
    s_cbranch_vccnz L_r13
    s_branch L_g13
L_r14:
    s_add_u32 s29, s29, 1
    s_cmp_ge_u32 s29, 200000
    s_cbranch_scc1 L_g14
    s_add_u32 s3, s76, 12288
    buffer_load_dwordx4 v[72:75], v116, s[48:51], s3 offen offset:2048 sc1
    buffer_load_dwordx4 v[76:79], v117, s[48:51], s3 offen offset:2048 sc1
    s_waitcnt vmcnt(0)
    v_max3_u32 v2, v72, v73, v74
    v_max3_u32 v2, v2, v75, v76
    v_max3_u32 v2, v2, v77, v78
    v_max_u32 v2, v2, v79
    v_cmp_eq_u32 vcc, -1, v2
    s_cbranch_vccnz L_r14
    s_branch L_g14
L_r15:
    s_add_u32 s29, s29, 1
    s_cmp_ge_u32 s29, 200000
    s_cbranch_scc1 L_g15
    s_add_u32 s3, s76, 12288
    buffer_load_dwordx4 v[40:43], v116, s[48:51], s3 offen offset:3072 sc1
    buffer_load_dwordx4 v[44:47], v117, s[48:51], s3 offen offset:3072 sc1
    s_waitcnt vmcnt(0)
    v_max3_u32 v2, v40, v41, v42
    v_max3_u32 v2, v2, v43, v44
    v_max3_u32 v2, v2, v45, v46
    v_max_u32 v2, v2, v47
    v_cmp_eq_u32 vcc, -1, v2
    s_cbranch_vccnz L_r15
    s_branch L_g15
.p2align 8
.fill 4096, 4, 0xbf800000
.section .rodata,"a"
.p2align 6
.amdhsa_kernel recurrent_scan__linear_kernel_hedgehog__moe_arch_mod__prompt_kernel
  .amdhsa_next_free_vgpr 256
  .amdhsa_next_free_sgpr 102
  .amdhsa_accum_offset 256
  .amdhsa_group_segment_fixed_size 0
  .amdhsa_kernarg_size 96
  .amdhsa_user_sgpr_count 2
  .amdhsa_user_sgpr_kernarg_segment_ptr 1
  .amdhsa_system_sgpr_workgroup_id_x 1
.end_amdhsa_kernel
```

```asm
; @launch grid=(256,1,1) block=(512,1,1) lds=163840
.amdgcn_target "amdgcn-amd-amdhsa--gfx950"
.text
.globl recurrent_scan__linear_kernel_hedgehog__moe_arch_mod__prompt_kernel
.p2align 8
.type recurrent_scan__linear_kernel_hedgehog__moe_arch_mod__prompt_kernel,@function
recurrent_scan__linear_kernel_hedgehog__moe_arch_mod__prompt_kernel:
    s_cmp_ge_u32 s2, 256
    s_cbranch_scc1 L_done
    s_load_dwordx16 s[4:19], s[0:1], 0
    s_load_dwordx8 s[20:27], s[0:1], 64
    v_and_b32 v1, 63, v0
    v_lshrrev_b32 v2, 6, v0
    s_nop 0
    v_readfirstlane_b32 s39, v2
    s_and_b32 s34, s2, 1
    s_lshl_b32 s34, s34, 3
    s_bfe_u32 s3, s2, 0x30003
    s_add_u32 s36, s34, s3
    s_bfe_u32 s37, s2, 0x20001
    s_lshl_b32 s37, s37, 2
    s_lshr_b32 s28, s2, 6
    s_add_u32 s37, s37, s28
    s_and_b32 s80, s37, 12
    s_xor_b32 s80, s80, s34
    s_add_u32 s85, s36, s37
    s_and_b32 s85, s85, 3
    s_or_b32 s35, s80, s85
    s_mov_b32 s34, s36
    s_and_b32 s38, s39, 3
    s_cmp_lt_u32 s39, 4
    s_cbranch_scc1 L_C
L_H:
    v_and_b32 v4, 7, v1
    s_lshl_b32 s33, s37, 7
    s_lshl_b32 s87, s85, 7
    s_lshl_b32 s66, s80, 7
    s_lshl_b32 s30, s38, 12
    s_waitcnt lgkmcnt(0)
    s_mov_b32 s40, s4
    s_mov_b32 s41, s5
    s_mov_b32 s42, 4194304
    s_mov_b32 s43, 0x00020000
    v_lshlrev_b32_e64 v252, 4, v1
    s_mov_b32 s48, s26
    s_mov_b32 s49, s27
    s_mov_b32 s50, 268435456
    s_mov_b32 s51, 0x00020000
    v_mov_b32 v19, 16384
    buffer_load_dword v19, v19, s[48:51], 0 offen sc1
    s_lshl_b32 s3, s36, 7
    s_lshl_b32 s28, s37, 3
    s_add_u32 s3, s3, s28
    s_lshl_b32 s3, s3, 11
    s_add_u32 s3, s3, s30
    s_add_u32 m0, s30, 131072
    s_nop 0
    buffer_load_dwordx4 v252, s[40:43], s3 offen offset:0 lds
    buffer_load_dwordx4 v252, s[40:43], s3 offen offset:2048 lds
    s_lshl_b32 s3, s36, 7
    s_lshl_b32 s28, s37, 3
    s_add_u32 s3, s3, s28
    s_lshl_b32 s3, s3, 11
    s_add_u32 s3, s3, s30
    s_add_u32 m0, s30, 131072
    s_nop 0
    buffer_load_dwordx4 v252, s[40:43], s3 offen offset:1024 lds
    buffer_load_dwordx4 v252, s[40:43], s3 offen offset:3072 lds
    s_mov_b32 s60, s14
    s_mov_b32 s61, s15
    s_mov_b32 s62, 2048
    s_mov_b32 s63, 0x00020000
    s_lshl_b32 s3, s38, 9
    s_add_u32 m0, s3, 122880
    s_mov_b32 exec_hi, 0
    buffer_load_dwordx4 v252, s[60:63], s3 offen lds
    s_mov_b64 exec, -1
    s_lshr_b32 s32, s36, 1
    s_and_b32 s32, s32, 2
    s_xor_b32 s32, s32, s38
    v_lshrrev_b32 v3, 3, v1
    s_lshl_b32 s3, s32, 4
    v_add_u32_e64 v7, s3, v3
    v_mul_u32_u24 v7, 6144, v7
    v_bfe_u32 v6, v1, 4, 1
    v_lshlrev_b32 v6, 1, v6
    v_xor_b32 v5, v4, v6
    v_add_u32 v7, s33, v7
    v_xor_b32 v6, 4, v5
    v_lshl_add_u32 v6, v6, 4, v7
    v_lshl_add_u32 v7, v5, 4, v7
    v_add_u32_e64 v12, 0, v7
    v_add_u32 v13, 48128, v6
    v_add_u32 v14, 2048, v7
    v_add_u32 v15, 50176, v6
    v_add_u32 v16, 4096, v7
    v_add_u32 v17, 52224, v6
    v_xor_b32 v12, 512, v12
    v_xor_b32 v13, 512, v13
    s_lshl_b32 s31, s32, 11
    s_add_u32 s31, s31, 16384
    s_mov_b32 s44, s6
    s_mov_b32 s45, s7
    s_mov_b32 s46, 6291456
    s_mov_b32 s47, 0x00020000
    s_add_u32 s64, s87, 0
    s_and_b32 s64, s64, 511
    s_or_b32 s64, s64, 0
    s_xor_b32 s64, s64, s66
    s_mul_i32 s65, s64, 3072
    s_add_u32 m0, s31, 0
    s_nop 0
    buffer_load_dwordx4 v12, s[44:47], s65 offen offset:0 lds
    buffer_load_dwordx4 v13, s[44:47], s65 offen offset:1024 lds
    s_add_u32 m0, s31, 8192
    s_nop 0
    buffer_load_dwordx4 v14, s[44:47], s65 offen offset:0 lds
    buffer_load_dwordx4 v15, s[44:47], s65 offen offset:1024 lds
    s_add_u32 m0, s31, 16384
    s_nop 0
    buffer_load_dwordx4 v16, s[44:47], s65 offen offset:0 lds
    buffer_load_dwordx4 v17, s[44:47], s65 offen offset:1024 lds
    s_lshl_b32 s3, s36, 7
    s_lshl_b32 s28, s38, 5
    s_add_u32 s3, s3, s28
    v_add_u32 v3, s3, v3
    v_lshlrev_b32 v3, 11, v3
    v_lshrrev_b32 v5, 4, v1
    v_xor_b32 v6, v4, v5
    v_xor_b32 v5, 4, v6
    v_lshl_add_u32 v6, v6, 4, v3
    v_lshl_add_u32 v5, v5, 4, v3
    v_add_u32_e64 v8, 0, v6
    v_add_u32 v9, 15360, v5
    v_add_u32 v10, 30720, v6
    v_add_u32 v11, 46080, v5
    v_mov_b32 v248, -1
    v_mov_b32 v249, -1
    v_mov_b32 v250, -1
    v_mov_b32 v251, -1
    v_lshlrev_b32 v252, 4, v1
    s_and_b32 s85, s85, 0
    s_lshl_b32 s3, s37, 4
    s_add_u32 s3, s3, s36
    s_lshl_b32 s67, s3, 10
    s_add_u32 s67, s67, 524288
    s_lshl_b32 s3, s38, 8
    s_add_u32 s67, s67, s3
    v_mov_b32 v24, 0
    v_mov_b32 v25, 0
    v_mov_b32 v26, 0
    v_mov_b32 v27, 0
    v_mov_b32 v28, 0
    v_mov_b32 v29, 0
    v_mov_b32 v30, 0
    v_mov_b32 v31, 0
    v_lshlrev_b32 v253, 2, v1
    s_cmp_gt_u32 s37, 3
    s_subb_u32 s77, s37, 0
    s_cmp_gt_u32 s37, 11
    s_subb_u32 s77, s77, 0
    s_lshl_b32 s77, s77, 4
    s_add_u32 s77, s77, s36
    s_and_b32 s3, s37, 7
    s_cmp_eq_u32 s3, 3
    s_cselect_b32 s77, 224, s77
    s_bitcmp1_b32 s38, 0
    s_cselect_b32 s52, s18, s16
    s_cselect_b32 s53, s19, s17
    s_cmp_lt_u32 s77, 224
    s_cselect_b32 s54, 7340032, 0
    s_mov_b32 s55, 0x00020000
    s_mov_b32 s56, s20
    s_mov_b32 s57, s21
    s_mov_b32 s58, 7340032
    s_mov_b32 s59, 0x00020000
    s_and_b32 s3, s77, 3
    s_lshl_b32 s3, s3, 8
    s_lshr_b32 s28, s38, 1
    s_lshl_b32 s28, s28, 7
    s_add_u32 s3, s3, s28
    v_lshrrev_b32_e64 v5, 3, v1
    v_lshl_add_u32 v6, v5, 4, s3
    v_mul_u32_u24 v6, 7168, v6
    v_lshl_add_u32 v6, v4, 4, v6
    s_lshr_b32 s3, s77, 2
    s_lshl_b32 s3, s3, 7
    v_add_u32 v21, s3, v6
    s_lshr_b32 s3, s2, 4
    s_mul_i32 s3, s3, 224
    s_mul_i32 s28, s38, 56
    s_add_u32 s71, s3, s28
    v_lshlrev_b32 v6, 14, v5
    v_lshl_add_u32 v6, v4, 4, v6
    s_and_b32 s3, s2, 15
    s_lshl_b32 s3, s3, 7
    v_add_u32 v22, s3, v6
    s_mov_b32 s94, 1985229328
    s_mov_b32 s95, 4275878552
    s_cmp_eq_u32 s87, 128
    s_cselect_b32 s94, 1989161553, s94
    s_cselect_b32 s95, 3488135892, s95
    s_cmp_eq_u32 s87, 256
    s_cselect_b32 s94, 2052130354, s94
    s_cselect_b32 s95, 3487088276, s95
    s_cmp_eq_u32 s87, 384
    s_cselect_b32 s94, 3058856195, s94
    s_cselect_b32 s95, 3470326420, s95
    v_lshrrev_b32 v2, 2, v1
    v_and_b32 v3, 3, v1
    v_lshlrev_b32 v3, 4, v3
    v_lshl_add_u32 v232, v2, 10, v3
    v_lshlrev_b32 v2, 3, v1
    v_add_u32 v230, 152064, v2
    v_and_b32_e64 v4, 49, v1
    v_bfe_u32 v7, v1, 1, 2
    v_lshl_add_u32 v4, v7, 2, v4
    v_bfe_u32 v7, v1, 3, 1
    v_lshl_add_u32 v4, v7, 1, v4
    v_lshlrev_b32 v4, 2, v4
    v_add_u32 v231, 154624, v4
    s_lshl_b32 s3, s38, 1
    s_lshr_b32 s28, s39, 2
    s_add_u32 s3, s3, s28
    s_lshl_b32 s69, s3, 4
    v_and_b32 v2, 15, v1
    v_add_u32 v23, s69, v2
    v_lshlrev_b32 v23, 7, v23
    v_lshrrev_b32 v2, 1, v2
    v_lshrrev_b32 v3, 5, v1
    v_xor_b32_e64 v2, v2, v3
    v_lshl_add_u32 v23, v2, 4, v23
    v_bfe_u32 v3, v1, 4, 1
    v_lshl_add_u32 v23, v3, 3, v23
    v_bfe_u32 v5, v1, 4, 1
    v_lshlrev_b32 v5, 5, v5
    v_xor_b32 v5, v5, v252
    s_min_u32 s3, s38, 2
    s_lshl_b32 s3, s3, 13
    s_and_b32 s28, s36, 4
    s_lshl_b32 s28, s28, 10
    s_add_u32 s3, s3, s28
    s_add_u32 s3, s3, 16384
    v_add_u32 v18, s3, v5
    s_lshr_b32 s3, s38, 1
    s_lshl_b32 s28, s37, 1
    s_add_u32 s28, s28, s3
    s_and_b32 s29, s38, 1
    s_lshl_b32 s3, s28, 4
    s_add_u32 s3, s3, s36
    s_mul_i32 s3, s3, 4224
    s_mul_i32 s78, s29, 2112
    s_add_u32 s78, s78, s3
    s_add_u32 s78, s78, 8388608
    s_lshl_b32 s3, s36, 1
    s_add_u32 s29, s29, s3
    s_xor_b32 s28, s28, 8
    s_lshl_b32 s3, s29, 7
    s_add_u32 s3, s3, s28
    s_lshl_b32 s3, s3, 10
    s_add_u32 s79, s3, 4194304
    s_mov_b32 s88, s10
    s_mov_b32 s89, s11
    s_mov_b32 s90, 2097152
    s_mov_b32 s91, 0x00020000
    s_add_u32 s64, s87, 0
    s_and_b32 s64, s64, 511
    s_or_b32 s64, s64, 0
    s_xor_b32 s64, s64, s66
    s_mul_i32 s65, s64, 3072
    s_add_u32 m0, s30, 0
    s_nop 0
    buffer_load_dwordx4 v8, s[40:43], s64 offen offset:0 lds
    buffer_load_dwordx4 v9, s[40:43], s64 offen offset:1024 lds
    buffer_load_dwordx4 v10, s[40:43], s64 offen offset:2048 lds
    buffer_load_dwordx4 v11, s[40:43], s64 offen offset:3072 lds
    s_waitcnt vmcnt(10)
    s_barrier
    s_bfe_u32 s64, s94, 262148
    s_lshl_b32 s64, s64, 7
    s_xor_b32 s64, s64, s66
    s_mul_i32 s65, s64, 3072
    s_add_u32 m0, s30, 40960
    s_nop 0
    buffer_load_dwordx4 v8, s[40:43], s64 offen offset:0 lds
    buffer_load_dwordx4 v9, s[40:43], s64 offen offset:1024 lds
    buffer_load_dwordx4 v10, s[40:43], s64 offen offset:2048 lds
    buffer_load_dwordx4 v11, s[40:43], s64 offen offset:3072 lds
    s_add_u32 m0, s31, 40960
    s_nop 0
    buffer_load_dwordx4 v12, s[44:47], s65 offen offset:0 lds
    buffer_load_dwordx4 v13, s[44:47], s65 offen offset:1024 lds
    s_add_u32 m0, s31, 49152
    s_nop 0
    buffer_load_dwordx4 v14, s[44:47], s65 offen offset:0 lds
    buffer_load_dwordx4 v15, s[44:47], s65 offen offset:1024 lds
    s_add_u32 m0, s31, 57344
    s_nop 0
    buffer_load_dwordx4 v16, s[44:47], s65 offen offset:0 lds
    buffer_load_dwordx4 v17, s[44:47], s65 offen offset:1024 lds
    v_readfirstlane_b32 s86, v19
    s_nop 0
    s_mul_i32 s86, s86, 1664525
    s_add_u32 s86, s86, 1013904223
    s_waitcnt vmcnt(10)
    s_waitcnt lgkmcnt(0)
    s_barrier
    s_bfe_u32 s64, s94, 262152
    s_lshl_b32 s64, s64, 7
    s_xor_b32 s64, s64, s66
    s_mul_i32 s65, s64, 3072
    s_add_u32 m0, s30, 81920
    s_nop 0
    buffer_load_dwordx4 v8, s[40:43], s64 offen offset:0 lds
    buffer_load_dwordx4 v9, s[40:43], s64 offen offset:1024 lds
    buffer_load_dwordx4 v10, s[40:43], s64 offen offset:2048 lds
    buffer_load_dwordx4 v11, s[40:43], s64 offen offset:3072 lds
    s_add_u32 m0, s31, 81920
    s_nop 0
    buffer_load_dwordx4 v12, s[44:47], s65 offen offset:0 lds
    buffer_load_dwordx4 v13, s[44:47], s65 offen offset:1024 lds
    s_add_u32 m0, s31, 90112
    s_nop 0
    buffer_load_dwordx4 v14, s[44:47], s65 offen offset:0 lds
    buffer_load_dwordx4 v15, s[44:47], s65 offen offset:1024 lds
    s_add_u32 m0, s31, 98304
    s_nop 0
    buffer_load_dwordx4 v16, s[44:47], s65 offen offset:0 lds
    buffer_load_dwordx4 v17, s[44:47], s65 offen offset:1024 lds
    v_xor_b32 v4, 0, v23
    ds_read_b64 v[240:241], v4
    v_xor_b32 v5, 32, v23
    ds_read_b64 v[242:243], v5
    v_xor_b32 v6, 64, v23
    ds_read_b64 v[244:245], v6
    v_xor_b32 v7, 96, v23
    ds_read_b64 v[246:247], v7
    v_add_u32 v2, 0, v18
    v_xor_b32 v3, 64, v2
    ds_read_b128 v[32:35], v2 offset:0
    ds_read_b128 v[36:39], v3 offset:1024
    ds_read_b128 v[40:43], v2 offset:2048
    ds_read_b128 v[44:47], v3 offset:3072
    buffer_store_dwordx4 v[248:251], v252, s[48:51], s78 offen offset:0 sc1
    s_waitcnt vmcnt(11)
    s_waitcnt lgkmcnt(0)
    s_barrier
    s_cmp_eq_u32 s87, 0
    s_cbranch_scc1 L_nc1
    s_cmp_eq_u32 s87, 256
    s_cbranch_scc1 L_nc1
    s_cmp_eq_u32 s87, 384
    s_cbranch_scc1 L_nc1
    v_add_u32 v2, 40960, v18
    v_xor_b32 v3, 64, v2
    ds_read_b128 v[48:51], v2 offset:0
    ds_read_b128 v[52:55], v3 offset:1024
    ds_read_b128 v[56:59], v2 offset:2048
    ds_read_b128 v[60:63], v3 offset:3072
L_nc1:
    s_bfe_u32 s64, s94, 262156
    s_lshl_b32 s64, s64, 7
    s_xor_b32 s64, s64, s66
    s_mul_i32 s65, s64, 3072
    s_add_u32 m0, s30, 0
    s_nop 0
    buffer_load_dwordx4 v8, s[40:43], s64 offen offset:0 lds
    buffer_load_dwordx4 v9, s[40:43], s64 offen offset:1024 lds
    v_lshlrev_b32 v2, 16, v32
    v_and_b32 v3, 0xffff0000, v32
    v_add_f32 v24, v24, v2
    v_add_f32 v25, v25, v3
    buffer_load_dwordx4 v10, s[40:43], s64 offen offset:2048 lds
    v_lshlrev_b32 v4, 16, v33
    v_and_b32 v5, 0xffff0000, v33
    v_add_f32 v26, v26, v4
    v_add_f32 v27, v27, v5
    buffer_load_dwordx4 v11, s[40:43], s64 offen offset:3072 lds
    v_lshlrev_b32 v2, 16, v34
    v_and_b32 v3, 0xffff0000, v34
    v_add_f32 v28, v28, v2
    v_add_f32 v29, v29, v3
    s_add_u32 m0, s31, 0
    s_nop 0
    buffer_load_dwordx4 v12, s[44:47], s65 offen offset:0 lds
    v_lshlrev_b32 v4, 16, v35
    v_and_b32 v5, 0xffff0000, v35
    v_add_f32 v30, v30, v4
    v_add_f32 v31, v31, v5
    buffer_load_dwordx4 v13, s[44:47], s65 offen offset:1024 lds
    v_lshlrev_b32 v2, 16, v36
    v_and_b32 v3, 0xffff0000, v36
    v_add_f32 v24, v24, v2
    v_add_f32 v25, v25, v3
    s_add_u32 m0, s31, 8192
    s_nop 0
    buffer_load_dwordx4 v14, s[44:47], s65 offen offset:0 lds
    v_lshlrev_b32 v4, 16, v37
    v_and_b32 v5, 0xffff0000, v37
    v_add_f32 v26, v26, v4
    v_add_f32 v27, v27, v5
    buffer_load_dwordx4 v15, s[44:47], s65 offen offset:1024 lds
    v_lshlrev_b32 v2, 16, v38
    v_and_b32 v3, 0xffff0000, v38
    v_add_f32 v28, v28, v2
    v_add_f32 v29, v29, v3
    s_add_u32 m0, s31, 16384
    s_nop 0
    buffer_load_dwordx4 v16, s[44:47], s65 offen offset:0 lds
    v_lshlrev_b32 v4, 16, v39
    v_and_b32 v5, 0xffff0000, v39
    v_add_f32 v30, v30, v4
    v_add_f32 v31, v31, v5
    buffer_load_dwordx4 v17, s[44:47], s65 offen offset:1024 lds
    buffer_store_dwordx4 v[248:251], v252, s[48:51], s78 offen offset:1024 sc1
    s_mov_b64 exec, 15
    buffer_store_dwordx4 v[248:251], v252, s[48:51], s78 offen offset:2048 sc1
    s_mov_b64 exec, -1
    s_waitcnt vmcnt(13)
    s_waitcnt lgkmcnt(0)
    s_barrier
    s_cmp_eq_u32 s87, 0
    s_cbranch_scc1 L_nc2
    s_cmp_eq_u32 s87, 128
    s_cbranch_scc1 L_nc2
    s_cmp_eq_u32 s87, 384
    s_cbranch_scc1 L_nc2
    v_add_u32 v2, 81920, v18
    v_xor_b32 v3, 64, v2
    ds_read_b128 v[48:51], v2 offset:0
    ds_read_b128 v[52:55], v3 offset:1024
    ds_read_b128 v[56:59], v2 offset:2048
    ds_read_b128 v[60:63], v3 offset:3072
L_nc2:
    s_bfe_u32 s64, s94, 262160
    s_lshl_b32 s64, s64, 7
    s_xor_b32 s64, s64, s66
    s_mul_i32 s65, s64, 3072
    s_add_u32 m0, s30, 40960
    s_nop 0
    buffer_load_dwordx4 v8, s[40:43], s64 offen offset:0 lds
    buffer_load_dwordx4 v9, s[40:43], s64 offen offset:1024 lds
    v_lshlrev_b32 v2, 16, v40
    v_and_b32 v3, 0xffff0000, v40
    v_add_f32 v24, v24, v2
    v_add_f32 v25, v25, v3
    buffer_load_dwordx4 v10, s[40:43], s64 offen offset:2048 lds
    v_lshlrev_b32 v4, 16, v41
    v_and_b32 v5, 0xffff0000, v41
    v_add_f32 v26, v26, v4
    v_add_f32 v27, v27, v5
    buffer_load_dwordx4 v11, s[40:43], s64 offen offset:3072 lds
    v_lshlrev_b32 v2, 16, v42
    v_and_b32 v3, 0xffff0000, v42
    v_add_f32 v28, v28, v2
    v_add_f32 v29, v29, v3
    s_add_u32 m0, s31, 40960
    s_nop 0
    buffer_load_dwordx4 v12, s[44:47], s65 offen offset:0 lds
    v_lshlrev_b32 v4, 16, v43
    v_and_b32 v5, 0xffff0000, v43
    v_add_f32 v30, v30, v4
    v_add_f32 v31, v31, v5
    buffer_load_dwordx4 v13, s[44:47], s65 offen offset:1024 lds
    v_lshlrev_b32 v2, 16, v44
    v_and_b32 v3, 0xffff0000, v44
    v_add_f32 v24, v24, v2
    v_add_f32 v25, v25, v3
    s_add_u32 m0, s31, 49152
    s_nop 0
    buffer_load_dwordx4 v14, s[44:47], s65 offen offset:0 lds
    v_lshlrev_b32 v4, 16, v45
    v_and_b32 v5, 0xffff0000, v45
    v_add_f32 v26, v26, v4
    v_add_f32 v27, v27, v5
    buffer_load_dwordx4 v15, s[44:47], s65 offen offset:1024 lds
    v_lshlrev_b32 v2, 16, v46
    v_and_b32 v3, 0xffff0000, v46
    v_add_f32 v28, v28, v2
    v_add_f32 v29, v29, v3
    s_add_u32 m0, s31, 57344
    s_nop 0
    buffer_load_dwordx4 v16, s[44:47], s65 offen offset:0 lds
    v_lshlrev_b32 v4, 16, v47
    v_and_b32 v5, 0xffff0000, v47
    v_add_f32 v30, v30, v4
    v_add_f32 v31, v31, v5
    buffer_load_dwordx4 v17, s[44:47], s65 offen offset:1024 lds
    s_waitcnt vmcnt(12)
    s_waitcnt lgkmcnt(0)
    s_barrier
    s_cmp_eq_u32 s87, 0
    s_cbranch_scc1 L_nc3
    s_cmp_eq_u32 s87, 128
    s_cbranch_scc1 L_nc3
    s_cmp_eq_u32 s87, 256
    s_cbranch_scc1 L_nc3
    v_add_u32 v2, 0, v18
    v_xor_b32_e64 v3, 64, v2
    ds_read_b128 v[48:51], v2 offset:0
    ds_read_b128 v[52:55], v3 offset:1024
    ds_read_b128 v[56:59], v2 offset:2048
    ds_read_b128 v[60:63], v3 offset:3072
L_nc3:
    s_bfe_u32 s64, s94, 262164
    s_lshl_b32 s64, s64, 7
    s_xor_b32 s64, s64, s66
    s_mul_i32 s65, s64, 3072
    s_add_u32 m0, s30, 81920
    s_nop 0
    buffer_load_dwordx4 v8, s[40:43], s64 offen offset:0 lds
    buffer_load_dwordx4 v9, s[40:43], s64 offen offset:1024 lds
    buffer_load_dwordx4 v10, s[40:43], s64 offen offset:2048 lds
    buffer_load_dwordx4 v11, s[40:43], s64 offen offset:3072 lds
    s_add_u32 m0, s31, 81920
    s_nop 0
    buffer_load_dwordx4 v12, s[44:47], s65 offen offset:0 lds
    buffer_load_dwordx4 v13, s[44:47], s65 offen offset:1024 lds
    s_add_u32 m0, s31, 90112
    s_nop 0
    buffer_load_dwordx4 v14, s[44:47], s65 offen offset:0 lds
    buffer_load_dwordx4 v15, s[44:47], s65 offen offset:1024 lds
    s_add_u32 m0, s31, 98304
    s_nop 0
    buffer_load_dwordx4 v16, s[44:47], s65 offen offset:0 lds
    buffer_load_dwordx4 v17, s[44:47], s65 offen offset:1024 lds
    s_lshl_b32 s3, s36, 10
    buffer_load_dwordx4 v[72:75], v252, s[48:51], s3 offen sc1
    s_lshl_b32 s3, s37, 6
    buffer_load_dword v76, v232, s[48:51], s3 offen offset:12 sc1
    s_mov_b32 s60, s8
    s_mov_b32 s61, s9
    s_mov_b32 s62, 65536
    s_mov_b32 s63, 0x00020000
    s_lshl_b32 s3, s38, 10
    s_add_u32 m0, s3, 147712
    s_lshl_b32 s28, s37, 12
    s_add_u32 s3, s3, s28
    buffer_load_dwordx4 v252, s[60:63], s3 offen lds
    s_add_u32 m0, m0, 8192
    s_xor_b32 s3, s3, 16384
    buffer_load_dwordx4 v252, s[60:63], s3 offen lds
    s_lshl_b32 s3, s2, 13
    s_lshl_b32 s28, s38, 11
    s_add_u32 s3, s3, s28
    v_lshlrev_b32_e64 v3, 7, v1
    s_mov_b64 exec, 0xffff
    buffer_load_dword v20, v3, s[88:91], s3 offen
    s_mov_b64 exec, -1
    s_mov_b32 s3, 0
    buffer_load_dwordx4 v[128:131], v21, s[52:55], s3 offen nt
    s_mov_b32 s3, 7168
    buffer_load_dwordx4 v[132:135], v21, s[52:55], s3 offen nt
    s_mov_b32 s3, 14336
    buffer_load_dwordx4 v[136:139], v21, s[52:55], s3 offen nt
    s_mov_b32 s3, 21504
    buffer_load_dwordx4 v[140:143], v21, s[52:55], s3 offen nt
    s_waitcnt vmcnt(19)
    s_waitcnt lgkmcnt(0)
    s_barrier
    s_mul_i32 s3, s38, 48
    v_and_b32 v2, 15, v1
    v_lshrrev_b32 v3, 4, v1
    v_cmp_gt_u32 vcc, 12, v2
    v_lshl_add_u32 v4, v2, 2, s3
    v_add_u32 v2, v4, v3
    v_mov_b32 v5, 192
    v_cndmask_b32 v4, v5, v4, vcc
    v_lshlrev_b32 v4, 2, v4
    v_lshl_add_u32 v235, v3, 10, v4
    v_and_b32_e64 v5, 7, v2
    v_bfe_u32 v6, v2, 3, 3
    v_lshl_add_u32 v5, v5, 3, v6
    v_and_b32 v2, 0xc0, v2
    v_add_u32 v2, v2, v5
    v_lshlrev_b32 v2, 2, v2
    v_add_u32 v2, 154880, v2
    v_mov_b32 v5, 162048
    v_cndmask_b32 v233, v5, v2, vcc
    v_lshrrev_b32 v5, 3, v1
    v_lshlrev_b32 v6, 11, v5
    v_bfe_u32 v5, v1, 4, 2
    v_lshlrev_b32 v5, 1, v5
    v_and_b32 v7, 7, v1
    v_xor_b32 v5, v5, v7
    v_lshl_add_u32 v6, v5, 4, v6
    s_lshl_b32 s3, s35, 7
    v_add_u32 v6, s3, v6
    v_add_u32_e64 v220, 0, v6
    v_add_u32 v221, 15360, v6
    v_add_u32 v222, 30720, v6
    v_add_u32 v223, 46080, v6
    s_lshl_b32 s72, s38, 12
    s_lshl_b32 s73, s38, 16
    s_and_b32 s3, s36, 0
    s_lshl_b32 s3, s3, 18
    s_or_b32 s73, s73, s3
    s_lshl_b32 s3, s36, 2
    s_add_u32 s3, s3, s38
    s_lshr_b32 s28, s3, 5
    s_and_b32 s3, s3, 31
    s_lshl_b32 s74, s3, 7
    s_lshl_b32 s3, s37, 1
    s_add_u32 s75, s3, s28
    v_lshrrev_b32 v5, 3, v1
    v_mul_u32_u24 v5, 4224, v5
    v_and_b32 v7, 7, v1
    v_lshl_add_u32 v112, v7, 4, v5
    v_bfe_u32 v5, v1, 3, 1
    s_mov_b32 s28, 626688
    v_mul_lo_u32 v5, v5, s28
    v_lshl_add_u32 v114, v7, 4, v5
    s_mul_i32 s76, s75, 67584
    s_add_u32 s76, s76, s74
    s_add_u32 s76, s76, 8388608
    s_mul_i32 s3, s75, 4224
    s_add_u32 s3, s3, s74
    s_add_u32 s74, s3, 1048576
    s_lshl_b32 s75, s37, 1
    s_add_u32 s75, s75, s36
    s_mul_i32 s81, s75, 67584
    s_add_u32 s81, s81, 8392704
    s_mul_i32 s82, s75, 4224
    s_add_u32 s82, s82, 1052672
    s_lshr_b32 s3, s36, 1
    s_or_b32 s83, s3, s38
    s_and_b32 s3, s38, 1
    s_lshl_b32 s3, s3, 3
    s_and_b32 s28, s77, 3
    s_lshl_b32 s28, s28, 1
    s_add_u32 s3, s3, s28
    s_lshr_b32 s28, s38, 1
    s_add_u32 s3, s3, s28
    s_mul_i32 s3, s3, 14336
    s_lshr_b32 s28, s77, 2
    s_lshl_b32 s28, s28, 8
    s_add_u32 s3, s3, s28
    s_add_u32 s3, s3, 1183744
    s_cmp_lt_u32 s77, 224
    s_cselect_b32 s84, s3, 268435456
    v_and_b32 v2, 15, v1
    v_bfe_u32 v3, v1, 4, 1
    v_mul_u32_u24 v3, 4, v3
    v_xor_b32_e64 v3, s37, v3
    v_lshl_add_u32 v3, v3, 4, v2
    v_lshl_add_u32 v2, v2, 4, s34
    v_lshrrev_b32 v4, 1, v1
    v_and_b32 v4, 8, v4
    v_xor_b32 v2, v2, v4
    v_cmp_gt_u32 vcc, 32, v1
    s_nop 1
    v_cndmask_b32 v2, v2, v3, vcc
    v_lshlrev_b32 v113, 7, v2
    s_cmp_eq_u32 s87, 128
    s_cbranch_scc1 L_nc4
    s_cmp_eq_u32 s87, 256
    s_cbranch_scc1 L_nc4
    s_cmp_eq_u32 s87, 384
    s_cbranch_scc1 L_nc4
    v_add_u32 v2, 40960, v18
    v_xor_b32_e64 v3, 64, v2
    ds_read_b128 v[48:51], v2 offset:0
    ds_read_b128 v[52:55], v3 offset:1024
    ds_read_b128 v[56:59], v2 offset:2048
    ds_read_b128 v[60:63], v3 offset:3072
L_nc4:
    s_waitcnt vmcnt(7)
    s_mov_b32 s29, 0
L_k1:
    v_cmp_ne_u32 vcc, s86, v75
    v_cmp_ne_u32 s[92:93], s86, v76
    s_nop 0
    s_or_b64 vcc, vcc, s[92:93]
    s_cbranch_vccz L_k1k
    s_add_u32 s29, s29, 1
    s_cmp_ge_u32 s29, 200000
    s_cbranch_scc1 L_k1k
    s_sleep 2
    s_lshl_b32 s3, s36, 10
    buffer_load_dwordx4 v[72:75], v252, s[48:51], s3 offen sc1
    s_lshl_b32 s3, s37, 6
    buffer_load_dword v76, v232, s[48:51], s3 offen offset:12 sc1
    s_waitcnt vmcnt(0)
    s_branch L_k1
L_k1k:
    v_max_u32 v74, v74, v74 quad_perm:[1,0,3,2] row_mask:0xf bank_mask:0xf
    s_nop 1
    v_max_u32 v74, v74, v74 quad_perm:[2,3,0,1] row_mask:0xf bank_mask:0xf
    s_nop 1
    v_max_u32 v74, v74, v74 row_half_mirror row_mask:0xf bank_mask:0xf
    s_nop 1
    v_max_u32 v74, v74, v74 row_mirror row_mask:0xf bank_mask:0xf
    v_and_b32 v2, 0xffff0000, v72
    v_lshlrev_b32 v224, 16, v72
    v_and_b32 v3, 0xffff0000, v73
    v_lshlrev_b32 v225, 16, v73
    v_rcp_f32 v226, v2
    v_rcp_f32 v227, v3
    v_lshrrev_b32 v2, 16, v2
    v_or_b32 v236, v2, v3
    v_mul_f32 v228, 1069066811, v226
    v_mul_f32 v229, 1069066811, v227
    v_readlane_b32 s70, v74, 0
    v_readlane_b32 s3, v74, 16
    v_readlane_b32 s28, v74, 32
    v_readlane_b32 s29, v74, 48
    s_max_u32 s70, s70, s3
    s_max_u32 s28, s28, s29
    s_max_u32 s70, s70, s28
    s_bfe_u32 s64, s94, 262168
    s_lshl_b32 s64, s64, 7
    s_xor_b32 s64, s64, s66
    s_mul_i32 s65, s64, 3072
    s_add_u32 m0, s30, 0
    s_nop 0
    buffer_load_dwordx4 v8, s[40:43], s64 offen offset:0 lds
    buffer_load_dwordx4 v9, s[40:43], s64 offen offset:1024 lds
    buffer_load_dwordx4 v10, s[40:43], s64 offen offset:2048 lds
    buffer_load_dwordx4 v11, s[40:43], s64 offen offset:3072 lds
    s_add_u32 m0, s31, 0
    s_nop 0
    buffer_load_dwordx4 v12, s[44:47], s65 offen offset:0 lds
    buffer_load_dwordx4 v13, s[44:47], s65 offen offset:1024 lds
    s_add_u32 m0, s31, 8192
    s_nop 0
    buffer_load_dwordx4 v14, s[44:47], s65 offen offset:0 lds
    buffer_load_dwordx4 v15, s[44:47], s65 offen offset:1024 lds
    s_add_u32 m0, s31, 16384
    s_nop 0
    buffer_load_dwordx4 v16, s[44:47], s65 offen offset:0 lds
    buffer_load_dwordx4 v17, s[44:47], s65 offen offset:1024 lds
    s_waitcnt lgkmcnt(0)
    s_barrier
    s_bfe_u32 s64, s94, 262172
    s_lshl_b32 s64, s64, 7
    s_xor_b32 s64, s64, s66
    s_mul_i32 s65, s64, 3072
    s_add_u32 m0, s30, 40960
    s_nop 0
    buffer_load_dwordx4 v8, s[40:43], s64 offen offset:0 lds
    buffer_load_dwordx4 v9, s[40:43], s64 offen offset:1024 lds
    v_lshlrev_b32 v2, 16, v48
    v_and_b32 v3, 0xffff0000, v48
    v_add_f32 v24, v24, v2
    v_add_f32 v25, v25, v3
    buffer_load_dwordx4 v10, s[40:43], s64 offen offset:2048 lds
    v_lshlrev_b32 v4, 16, v49
    v_and_b32 v5, 0xffff0000, v49
    v_add_f32 v26, v26, v4
    v_add_f32 v27, v27, v5
    buffer_load_dwordx4 v11, s[40:43], s64 offen offset:3072 lds
    v_lshlrev_b32 v2, 16, v50
    v_and_b32 v3, 0xffff0000, v50
    v_add_f32 v28, v28, v2
    v_add_f32 v29, v29, v3
    s_add_u32 m0, s31, 40960
    s_nop 0
    buffer_load_dwordx4 v12, s[44:47], s65 offen offset:0 lds
    v_lshlrev_b32 v4, 16, v51
    v_and_b32 v5, 0xffff0000, v51
    v_add_f32 v30, v30, v4
    v_add_f32 v31, v31, v5
    buffer_load_dwordx4 v13, s[44:47], s65 offen offset:1024 lds
    v_lshlrev_b32 v2, 16, v52
    v_and_b32 v3, 0xffff0000, v52
    v_add_f32 v24, v24, v2
    v_add_f32 v25, v25, v3
    s_add_u32 m0, s31, 49152
    s_nop 0
    buffer_load_dwordx4 v14, s[44:47], s65 offen offset:0 lds
    v_lshlrev_b32 v4, 16, v53
    v_and_b32 v5, 0xffff0000, v53
    v_add_f32 v26, v26, v4
    v_add_f32 v27, v27, v5
    buffer_load_dwordx4 v15, s[44:47], s65 offen offset:1024 lds
    v_lshlrev_b32 v2, 16, v54
    v_and_b32 v3, 0xffff0000, v54
    v_add_f32 v28, v28, v2
    v_add_f32 v29, v29, v3
    s_add_u32 m0, s31, 57344
    s_nop 0
    buffer_load_dwordx4 v16, s[44:47], s65 offen offset:0 lds
    v_lshlrev_b32 v4, 16, v55
    v_and_b32 v5, 0xffff0000, v55
    v_add_f32 v30, v30, v4
    v_add_f32 v31, v31, v5
    buffer_load_dwordx4 v17, s[44:47], s65 offen offset:1024 lds
    s_add_u32 s3, s79, 0
    buffer_store_dwordx4 v[248:251], v252, s[48:51], s3 offen sc1
    s_waitcnt vmcnt(11)
    s_waitcnt lgkmcnt(0)
    s_barrier
    s_bfe_u32 s64, s95, 262144
    s_lshl_b32 s64, s64, 7
    s_xor_b32 s64, s64, s66
    s_mul_i32 s65, s64, 3072
    s_add_u32 m0, s30, 81920
    s_nop 0
    buffer_load_dwordx4 v8, s[40:43], s64 offen offset:0 lds
    buffer_load_dwordx4 v9, s[40:43], s64 offen offset:1024 lds
    v_lshlrev_b32 v2, 16, v56
    v_and_b32 v3, 0xffff0000, v56
    v_add_f32 v24, v24, v2
    v_add_f32 v25, v25, v3
    buffer_load_dwordx4 v10, s[40:43], s64 offen offset:2048 lds
    v_lshlrev_b32 v4, 16, v57
    v_and_b32 v5, 0xffff0000, v57
    v_add_f32 v26, v26, v4
    v_add_f32 v27, v27, v5
    buffer_load_dwordx4 v11, s[40:43], s64 offen offset:3072 lds
    v_lshlrev_b32 v2, 16, v58
    v_and_b32 v3, 0xffff0000, v58
    v_add_f32 v28, v28, v2
    v_add_f32 v29, v29, v3
    s_add_u32 m0, s31, 81920
    s_nop 0
    buffer_load_dwordx4 v12, s[44:47], s65 offen offset:0 lds
    v_lshlrev_b32 v4, 16, v59
    v_and_b32 v5, 0xffff0000, v59
    v_add_f32 v30, v30, v4
    v_add_f32 v31, v31, v5
    buffer_load_dwordx4 v13, s[44:47], s65 offen offset:1024 lds
    v_lshlrev_b32 v2, 16, v60
    v_and_b32 v3, 0xffff0000, v60
    v_add_f32 v24, v24, v2
    v_add_f32 v25, v25, v3
    s_add_u32 m0, s31, 90112
    s_nop 0
    buffer_load_dwordx4 v14, s[44:47], s65 offen offset:0 lds
    v_lshlrev_b32 v4, 16, v61
    v_and_b32 v5, 0xffff0000, v61
    v_add_f32 v26, v26, v4
    v_add_f32 v27, v27, v5
    buffer_load_dwordx4 v15, s[44:47], s65 offen offset:1024 lds
    v_lshlrev_b32 v2, 16, v62
    v_and_b32 v3, 0xffff0000, v62
    v_add_f32 v28, v28, v2
    v_add_f32 v29, v29, v3
    s_add_u32 m0, s31, 98304
    s_nop 0
    buffer_load_dwordx4 v16, s[44:47], s65 offen offset:0 lds
    v_lshlrev_b32 v4, 16, v63
    v_and_b32 v5, 0xffff0000, v63
    v_add_f32 v30, v30, v4
    v_add_f32_e64 v31, v31, v5
    buffer_load_dwordx4 v17, s[44:47], s65 offen offset:1024 lds
    s_add_u32 s3, s79, 32768
    buffer_store_dwordx4 v[248:251], v252, s[48:51], s3 offen sc1
    s_waitcnt vmcnt(12)
    s_waitcnt lgkmcnt(0)
    s_barrier
    s_bfe_u32 s64, s95, 262148
    s_lshl_b32 s64, s64, 7
    s_xor_b32 s64, s64, s66
    s_mul_i32 s65, s64, 3072
    s_add_u32 m0, s30, 0
    s_nop 0
    buffer_load_dwordx4 v8, s[40:43], s64 offen offset:0 lds
    buffer_load_dwordx4 v9, s[40:43], s64 offen offset:1024 lds
    v_permlane32_swap_b32 v24, v28
    v_permlane32_swap_b32 v25, v29
    buffer_load_dwordx4 v10, s[40:43], s64 offen offset:2048 lds
    v_permlane32_swap_b32 v26, v30
    v_permlane32_swap_b32 v27, v31
    buffer_load_dwordx4 v11, s[40:43], s64 offen offset:3072 lds
    v_add_f32 v24, v24, v28
    v_add_f32 v25, v25, v29
    s_add_u32 m0, s31, 0
    s_nop 0
    buffer_load_dwordx4 v12, s[44:47], s65 offen offset:0 lds
    v_add_f32 v26, v26, v30
    v_add_f32 v27, v27, v31
    buffer_load_dwordx4 v13, s[44:47], s65 offen offset:1024 lds
    v_permlane16_swap_b32 v24, v26
    v_permlane16_swap_b32 v25, v27
    s_add_u32 m0, s31, 8192
    s_nop 0
    buffer_load_dwordx4 v14, s[44:47], s65 offen offset:0 lds
    v_add_f32 v24, v24, v26
    v_add_f32 v25, v25, v27
    buffer_load_dwordx4 v15, s[44:47], s65 offen offset:1024 lds
    v_add_f32 v24, v24, v24 row_ror:8 row_mask:0xf bank_mask:0xf
    v_add_f32 v25, v25, v25 row_ror:8 row_mask:0xf bank_mask:0xf
    s_add_u32 m0, s31, 16384
    s_nop 0
    buffer_load_dwordx4 v16, s[44:47], s65 offen offset:0 lds
    buffer_load_dwordx4 v17, s[44:47], s65 offen offset:1024 lds
    v_and_b32 v2, 8, v1
    v_cmp_eq_u32 vcc, 0, v2
    s_nop 1
    v_cndmask_b32 v24, v25, v24, vcc
    s_cmp_eq_u32 s38, 3
    s_cselect_b64 exec, -1, 0
    v_mov_b32 v24, s70
    s_mov_b64 exec, -1
    buffer_store_dword v24, v253, s[48:51], s67 offen sc1
    s_waitcnt vmcnt(12)
    s_waitcnt lgkmcnt(0)
    s_barrier
    s_bfe_u32 s64, s95, 262152
    s_lshl_b32 s64, s64, 7
    s_xor_b32 s64, s64, s66
    s_mul_i32 s65, s64, 3072
    s_add_u32 m0, s30, 40960
    s_nop 0
    buffer_load_dwordx4 v8, s[40:43], s64 offen offset:0 lds
    buffer_load_dwordx4 v9, s[40:43], s64 offen offset:1024 lds
    buffer_load_dwordx4 v10, s[40:43], s64 offen offset:2048 lds
    buffer_load_dwordx4 v11, s[40:43], s64 offen offset:3072 lds
    s_add_u32 m0, s31, 40960
    s_nop 0
    buffer_load_dwordx4 v12, s[44:47], s65 offen offset:0 lds
    buffer_load_dwordx4 v13, s[44:47], s65 offen offset:1024 lds
    s_add_u32 m0, s31, 49152
    s_nop 0
    buffer_load_dwordx4 v14, s[44:47], s65 offen offset:0 lds
    buffer_load_dwordx4 v15, s[44:47], s65 offen offset:1024 lds
    s_add_u32 m0, s31, 57344
    s_nop 0
    buffer_load_dwordx4 v16, s[44:47], s65 offen offset:0 lds
    buffer_load_dwordx4 v17, s[44:47], s65 offen offset:1024 lds
    s_add_u32 s3, s79, 65536
    buffer_store_dwordx4 v[248:251], v252, s[48:51], s3 offen sc1
    s_add_u32 s3, s79, 98304
    buffer_store_dwordx4 v[248:251], v252, s[48:51], s3 offen sc1
    s_waitcnt vmcnt(13)
    s_waitcnt lgkmcnt(0)
    s_barrier
    s_bfe_u32 s64, s95, 262156
    s_lshl_b32 s64, s64, 7
    s_xor_b32 s64, s64, s66
    s_mul_i32 s65, s64, 3072
    s_add_u32 m0, s30, 81920
    s_nop 0
    buffer_load_dwordx4 v8, s[40:43], s64 offen offset:0 lds
    buffer_load_dwordx4 v9, s[40:43], s64 offen offset:1024 lds
    buffer_load_dwordx4 v10, s[40:43], s64 offen offset:2048 lds
    buffer_load_dwordx4 v11, s[40:43], s64 offen offset:3072 lds
    s_add_u32 m0, s31, 81920
    s_nop 0
    buffer_load_dwordx4 v12, s[44:47], s65 offen offset:0 lds
    buffer_load_dwordx4 v13, s[44:47], s65 offen offset:1024 lds
    s_add_u32 m0, s31, 90112
    s_nop 0
    buffer_load_dwordx4 v14, s[44:47], s65 offen offset:0 lds
    buffer_load_dwordx4 v15, s[44:47], s65 offen offset:1024 lds
    s_add_u32 m0, s31, 98304
    s_nop 0
    buffer_load_dwordx4 v16, s[44:47], s65 offen offset:0 lds
    buffer_load_dwordx4 v17, s[44:47], s65 offen offset:1024 lds
    s_lshl_b32 s3, s37, 14
    s_add_u32 s3, s3, 524288
    s_add_u32 s28, s3, 0
    buffer_load_dwordx4 v[80:83], v235, s[48:51], s28 offen sc1
    s_add_u32 s28, s3, 4096
    buffer_load_dwordx4 v[84:87], v235, s[48:51], s28 offen sc1
    s_waitcnt vmcnt(14)
    s_waitcnt lgkmcnt(0)
    s_barrier
    s_lshl_b32 s3, s37, 14
    s_nop 0
    s_add_u32 s3, s3, 524288
    s_add_u32 s28, s3, 8192
    buffer_load_dwordx4 v[88:91], v235, s[48:51], s28 offen sc1
    s_add_u32 s28, s3, 12288
    buffer_load_dwordx4 v[92:95], v235, s[48:51], s28 offen sc1
    s_bfe_u32 s64, s95, 262160
    s_lshl_b32 s64, s64, 7
    s_xor_b32 s64, s64, s66
    s_mul_i32 s65, s64, 3072
    s_add_u32 m0, s30, 0
    s_nop 0
    buffer_load_dwordx4 v8, s[40:43], s64 offen offset:0 lds
    buffer_load_dwordx4 v9, s[40:43], s64 offen offset:1024 lds
    buffer_load_dwordx4 v10, s[40:43], s64 offen offset:2048 lds
    buffer_load_dwordx4 v11, s[40:43], s64 offen offset:3072 lds
    s_add_u32 m0, s31, 0
    s_nop 0
    buffer_load_dwordx4 v12, s[44:47], s65 offen offset:0 lds
    buffer_load_dwordx4 v13, s[44:47], s65 offen offset:1024 lds
    s_add_u32 m0, s31, 8192
    s_nop 0
    buffer_load_dwordx4 v14, s[44:47], s65 offen offset:0 lds
    buffer_load_dwordx4 v15, s[44:47], s65 offen offset:1024 lds
    s_add_u32 m0, s31, 16384
    s_nop 0
    buffer_load_dwordx4 v16, s[44:47], s65 offen offset:0 lds
    buffer_load_dwordx4 v17, s[44:47], s65 offen offset:1024 lds
    s_waitcnt vmcnt(14)
    s_waitcnt lgkmcnt(0)
    s_barrier
    s_waitcnt vmcnt(10)
    s_mov_b32 s29, 0
L_k2:
    s_nop 0
    v_max3_u32 v2, v80, v81, v82
    v_max3_u32 v2, v2, v83, v84
    v_max3_u32 v2, v2, v85, v86
    v_max3_u32 v2, v2, v87, v88
    v_max3_u32 v2, v2, v89, v90
    v_max3_u32 v2, v2, v91, v92
    v_max3_u32 v2, v2, v93, v94
    v_max_u32 v2, v2, v95
    v_cmp_eq_u32 vcc, -1, v2
    s_cbranch_vccz L_k2k
    s_add_u32 s29, s29, 1
    s_cmp_ge_u32 s29, 200000
    s_cbranch_scc1 L_k2k
    s_sleep 1
    s_lshl_b32 s3, s37, 14
    s_add_u32 s3, s3, 524288
    s_add_u32 s28, s3, 0
    buffer_load_dwordx4 v[80:83], v235, s[48:51], s28 offen sc1
    s_add_u32 s28, s3, 4096
    buffer_load_dwordx4 v[84:87], v235, s[48:51], s28 offen sc1
    s_add_u32 s28, s3, 8192
    buffer_load_dwordx4 v[88:91], v235, s[48:51], s28 offen sc1
    s_add_u32 s28, s3, 12288
    buffer_load_dwordx4 v[92:95], v235, s[48:51], s28 offen sc1
    s_waitcnt vmcnt(0)
    s_branch L_k2
L_k2k:
    s_bfe_u32 s64, s95, 262164
    s_lshl_b32 s64, s64, 7
    s_xor_b32 s64, s64, s66
    s_mul_i32 s65, s64, 3072
    s_add_u32 m0, s30, 40960
    s_nop 0
    buffer_load_dwordx4 v8, s[40:43], s64 offen offset:0 lds
    buffer_load_dwordx4 v9, s[40:43], s64 offen offset:1024 lds
    v_max3_u32 v2, v80, v84, v88
    v_max_u32 v2, v2, v92
    v_add_f32 v80, v80, v88
    buffer_load_dwordx4 v10, s[40:43], s64 offen offset:2048 lds
    v_add_f32 v81, v81, v89
    v_add_f32 v82, v82, v90
    v_add_f32 v83, v83, v91
    buffer_load_dwordx4 v11, s[40:43], s64 offen offset:3072 lds
    v_add_f32 v84, v84, v92
    v_add_f32 v85, v85, v93
    v_add_f32 v86, v86, v94
    s_add_u32 m0, s31, 40960
    s_nop 0
    buffer_load_dwordx4 v12, s[44:47], s65 offen offset:0 lds
    v_add_f32 v87, v87, v95
    v_add_f32 v80, v80, v84
    v_add_f32 v81, v81, v85
    buffer_load_dwordx4 v13, s[44:47], s65 offen offset:1024 lds
    v_add_f32 v82, v82, v86
    v_add_f32_e64 v83, v83, v87
    v_readlane_b32 s70, v2, 12
    s_add_u32 m0, s31, 49152
    s_nop 0
    buffer_load_dwordx4 v14, s[44:47], s65 offen offset:0 lds
    v_readlane_b32 s3, v2, 28
    v_readlane_b32 s28, v2, 44
    v_readlane_b32 s29, v2, 60
    buffer_load_dwordx4 v15, s[44:47], s65 offen offset:1024 lds
    s_max_u32 s70, s70, s3
    s_max_u32 s28, s28, s29
    s_max_u32 s70, s70, s28
    s_add_u32 m0, s31, 57344
    s_nop 0
    buffer_load_dwordx4 v16, s[44:47], s65 offen offset:0 lds
    v_permlane32_swap_b32 v80, v82
    v_permlane32_swap_b32 v81, v83
    v_add_f32 v80, v80, v82
    buffer_load_dwordx4 v17, s[44:47], s65 offen offset:1024 lds
    v_add_f32 v81, v81, v83
    s_nop 1
    v_permlane16_swap_b32 v80, v81
    v_add_f32 v80, v80, v81
    s_mov_b32 exec_lo, 0xf000f000
    s_mov_b32 exec_hi, 0xf000f000
    v_mov_b32 v80, s70
    s_mov_b64 exec, -1
    s_waitcnt vmcnt(10)
    s_waitcnt lgkmcnt(0)
    s_barrier
    s_bfe_u32 s64, s95, 262168
    s_lshl_b32 s64, s64, 7
    s_xor_b32 s64, s64, s66
    s_mul_i32 s65, s64, 3072
    s_add_u32 m0, s30, 81920
    s_nop 0
    buffer_load_dwordx4 v8, s[40:43], s64 offen offset:0 lds
    buffer_load_dwordx4 v9, s[40:43], s64 offen offset:1024 lds
    buffer_load_dwordx4 v10, s[40:43], s64 offen offset:2048 lds
    buffer_load_dwordx4 v11, s[40:43], s64 offen offset:3072 lds
    s_add_u32 m0, s31, 81920
    s_nop 0
    buffer_load_dwordx4 v12, s[44:47], s65 offen offset:0 lds
    buffer_load_dwordx4 v13, s[44:47], s65 offen offset:1024 lds
    s_add_u32 m0, s31, 90112
    s_nop 0
    buffer_load_dwordx4 v14, s[44:47], s65 offen offset:0 lds
    buffer_load_dwordx4 v15, s[44:47], s65 offen offset:1024 lds
    s_add_u32 m0, s31, 98304
    s_nop 0
    buffer_load_dwordx4 v16, s[44:47], s65 offen offset:0 lds
    buffer_load_dwordx4 v17, s[44:47], s65 offen offset:1024 lds
    s_and_b32 s68, s70, 0x7ff
    s_sub_u32 s68, 2047, s68
    s_lshl_b32 s3, s68, 11
    s_and_b32 s28, s77, 3
    s_lshl_b32 s28, s28, 9
    s_add_u32 s3, s3, s28
    s_lshr_b32 s28, s38, 1
    s_lshl_b32 s28, s28, 8
    s_add_u32 s3, s3, s28
    v_lshrrev_b32 v3, 3, v1
    v_lshlrev_b32 v3, 5, v3
    buffer_load_dwordx4 v[64:67], v3, s[40:43], s3 offen
    buffer_load_dwordx4 v[68:71], v3, s[40:43], s3 offen offset:16
    s_lshr_b32 s3, s68, 1
    s_lshl_b32 s3, s3, 4
    s_and_b32 s28, s68, 1
    s_lshl_b32 s28, s28, 2
    s_add_u32 s3, s3, s28
    v_mov_b32 v3, 0
    buffer_load_dword v116, v3, s[48:51], s3 offen sc1
    s_waitcnt vmcnt(13)
    s_waitcnt lgkmcnt(0)
    s_barrier
    s_bfe_u32 s64, s95, 262172
    s_lshl_b32 s64, s64, 7
    s_xor_b32 s64, s64, s66
    s_mul_i32 s65, s64, 3072
    s_add_u32 m0, s30, 0
    s_nop 0
    buffer_load_dwordx4 v8, s[40:43], s64 offen offset:0 lds
    buffer_load_dwordx4 v9, s[40:43], s64 offen offset:1024 lds
    buffer_load_dwordx4 v10, s[40:43], s64 offen offset:2048 lds
    buffer_load_dwordx4 v11, s[40:43], s64 offen offset:3072 lds
    s_add_u32 m0, s31, 0
    s_nop 0
    buffer_load_dwordx4 v12, s[44:47], s65 offen offset:0 lds
    buffer_load_dwordx4 v13, s[44:47], s65 offen offset:1024 lds
    s_add_u32 m0, s31, 8192
    s_nop 0
    buffer_load_dwordx4 v14, s[44:47], s65 offen offset:0 lds
    buffer_load_dwordx4 v15, s[44:47], s65 offen offset:1024 lds
    s_add_u32 m0, s31, 16384
    s_nop 0
    buffer_load_dwordx4 v16, s[44:47], s65 offen offset:0 lds
    buffer_load_dwordx4 v17, s[44:47], s65 offen offset:1024 lds
    s_or_b32 s3, s2, s38
    s_mov_b32 s28, 16384
    s_cmp_lg_u32 s3, 0
    s_cselect_b32 s3, 268435456, s28
    v_mov_b32 v2, s86
    s_mov_b64 exec, 1
    buffer_store_dword v2, v252, s[48:51], s3 offen sc1
    s_mov_b64 exec, -1
    s_waitcnt vmcnt(14)
    s_waitcnt lgkmcnt(0)
    s_barrier
    s_nop 0
    s_mov_b32 s3, 28672
    buffer_load_dwordx4 v[144:147], v21, s[52:55], s3 offen nt
    s_mov_b32 s3, 35840
    buffer_load_dwordx4 v[148:151], v21, s[52:55], s3 offen nt
    s_mov_b32 s3, 43008
    buffer_load_dwordx4 v[152:155], v21, s[52:55], s3 offen nt
    s_mov_b32 s3, 50176
    buffer_load_dwordx4 v[156:159], v21, s[52:55], s3 offen nt
    s_mov_b32 s3, 57344
    buffer_load_dwordx4 v[160:163], v21, s[52:55], s3 offen nt
    s_mov_b32 s3, 64512
    buffer_load_dwordx4 v[164:167], v21, s[52:55], s3 offen nt
    s_mov_b32 s3, 71680
    buffer_load_dwordx4 v[168:171], v21, s[52:55], s3 offen nt
    s_mov_b32 s3, 78848
    buffer_load_dwordx4 v[172:175], v21, s[52:55], s3 offen nt
    ds_write_b32 v233, v80
    s_lshl_b32 s3, s38, 4
    s_lshl_b64 exec, 0xffff, s3
    ds_write_b64 v230, v[224:225]
    ds_write_b64 v230, v[226:227] offset:1024
    ds_write_b64 v230, v[228:229] offset:2048
    ds_write_b32 v231, v236
    s_mov_b64 exec, -1
    s_waitcnt vmcnt(19)
    v_and_b32 v5, 0xffff0000, v116
    v_lshlrev_b32 v116, 16, v116
    v_rcp_f32 v117, v5
    v_lshlrev_b32 v96, 16, v64
    v_and_b32 v97, 0xffff0000, v64
    v_lshlrev_b32 v98, 16, v65
    v_and_b32 v99, 0xffff0000, v65
    v_lshlrev_b32 v100, 16, v66
    v_and_b32 v101, 0xffff0000, v66
    v_lshlrev_b32 v102, 16, v67
    v_and_b32 v103, 0xffff0000, v67
    v_lshlrev_b32 v104, 16, v68
    v_and_b32 v105, 0xffff0000, v68
    v_lshlrev_b32 v106, 16, v69
    v_and_b32 v107, 0xffff0000, v69
    v_lshlrev_b32 v108, 16, v70
    v_and_b32 v109, 0xffff0000, v70
    v_lshlrev_b32 v110, 16, v71
    v_and_b32 v111, 0xffff0000, v71
    v_mul_f32 v119, v116, v117
    v_fma_f32 v96, v96, v117, -v119
    v_fma_f32 v97, v97, v117, -v119
    v_fma_f32 v98, v98, v117, -v119
    v_fma_f32 v99, v99, v117, -v119
    v_fma_f32 v100, v100, v117, -v119
    v_fma_f32 v101, v101, v117, -v119
    v_fma_f32 v102, v102, v117, -v119
    v_fma_f32 v103, v103, v117, -v119
    v_fma_f32 v104, v104, v117, -v119
    v_fma_f32 v105, v105, v117, -v119
    v_fma_f32 v106, v106, v117, -v119
    v_fma_f32 v107, v107, v117, -v119
    v_fma_f32 v108, v108, v117, -v119
    v_fma_f32 v109, v109, v117, -v119
    v_fma_f32 v110, v110, v117, -v119
    v_fma_f32 v111, v111, v117, -v119
    v_mov_b32 v120, 0
    v_mov_b32 v121, 0
    v_mov_b32 v122, 0
    v_mov_b32 v123, 0
    v_mov_b32 v124, 0
    v_mov_b32 v125, 0
    v_mov_b32 v126, 0
    v_mov_b32 v127, 0
    s_waitcnt vmcnt(9)
    s_waitcnt lgkmcnt(0)
    s_barrier
    v_lshlrev_b32 v2, 16, v128
    v_and_b32 v3, 0xffff0000, v128
    v_fmac_f32 v120, v2, v96
    v_fmac_f32 v121, v3, v96
    v_lshlrev_b32 v4, 16, v129
    v_and_b32 v5, 0xffff0000, v129
    v_fmac_f32 v122, v4, v96
    v_fmac_f32 v123, v5, v96
    v_lshlrev_b32 v2, 16, v130
    v_and_b32 v3, 0xffff0000, v130
    v_fmac_f32 v124, v2, v96
    v_fmac_f32 v125, v3, v96
    v_lshlrev_b32 v4, 16, v131
    v_and_b32 v5, 0xffff0000, v131
    v_fmac_f32 v126, v4, v96
    v_fmac_f32 v127, v5, v96
    v_lshlrev_b32 v2, 16, v132
    v_and_b32 v3, 0xffff0000, v132
    v_fmac_f32 v120, v2, v97
    v_fmac_f32 v121, v3, v97
    v_lshlrev_b32 v4, 16, v133
    v_and_b32 v5, 0xffff0000, v133
    v_fmac_f32 v122, v4, v97
    v_fmac_f32 v123, v5, v97
    v_lshlrev_b32 v2, 16, v134
    v_and_b32 v3, 0xffff0000, v134
    v_fmac_f32 v124, v2, v97
    v_fmac_f32 v125, v3, v97
    v_lshlrev_b32 v4, 16, v135
    v_and_b32 v5, 0xffff0000, v135
    v_fmac_f32 v126, v4, v97
    v_fmac_f32 v127, v5, v97
    v_lshlrev_b32 v2, 16, v136
    v_and_b32 v3, 0xffff0000, v136
    v_fmac_f32 v120, v2, v98
    v_fmac_f32 v121, v3, v98
    v_lshlrev_b32 v4, 16, v137
    v_and_b32 v5, 0xffff0000, v137
    v_fmac_f32 v122, v4, v98
    v_fmac_f32 v123, v5, v98
    v_lshlrev_b32 v2, 16, v138
    v_and_b32 v3, 0xffff0000, v138
    v_fmac_f32 v124, v2, v98
    v_fmac_f32 v125, v3, v98
    v_lshlrev_b32 v4, 16, v139
    v_and_b32 v5, 0xffff0000, v139
    v_fmac_f32 v126, v4, v98
    v_fmac_f32 v127, v5, v98
    v_lshlrev_b32 v2, 16, v140
    v_and_b32 v3, 0xffff0000, v140
    v_fmac_f32 v120, v2, v99
    v_fmac_f32 v121, v3, v99
    v_lshlrev_b32 v4, 16, v141
    v_and_b32 v5, 0xffff0000, v141
    v_fmac_f32 v122, v4, v99
    v_fmac_f32 v123, v5, v99
    v_lshlrev_b32 v2, 16, v142
    v_and_b32 v3, 0xffff0000, v142
    v_fmac_f32 v124, v2, v99
    v_fmac_f32 v125, v3, v99
    v_lshlrev_b32 v4, 16, v143
    v_and_b32 v5, 0xffff0000, v143
    v_fmac_f32 v126, v4, v99
    v_fmac_f32 v127, v5, v99
    s_waitcnt lgkmcnt(0)
    s_barrier
    v_and_b32 v2, 15, v1
    v_min_u32 v2, 13, v2
    v_lshrrev_b32 v3, 4, v1
    v_mul_u32_u24 v3, 14336, v3
    v_lshl_add_u32 v13, v2, 4, v3
    s_lshl_b32 s75, s71, 2
    s_add_u32 s75, s75, 1183744
    s_add_u32 m0, s72, 0
    s_xor_b32 s3, s73, 0
    s_nop 0
    buffer_load_dwordx4 v220, s[88:91], s3 offen offset:0 lds
    buffer_load_dwordx4 v221, s[88:91], s3 offen offset:1024 lds
    buffer_load_dwordx4 v222, s[88:91], s3 offen offset:2048 lds
    buffer_load_dwordx4 v223, s[88:91], s3 offen offset:3072 lds
    s_add_u32 m0, s72, 16384
    s_xor_b32 s3, s73, 262144
    buffer_load_dwordx4 v220, s[88:91], s3 offen offset:0 lds
    buffer_load_dwordx4 v221, s[88:91], s3 offen offset:1024 lds
    buffer_load_dwordx4 v222, s[88:91], s3 offen offset:2048 lds
    buffer_load_dwordx4 v223, s[88:91], s3 offen offset:3072 lds
    s_add_u32 m0, s72, 65536
    s_xor_b32 s3, s73, 1048576
    buffer_load_dwordx4 v220, s[88:91], s3 offen offset:0 lds
    buffer_load_dwordx4 v221, s[88:91], s3 offen offset:1024 lds
    buffer_load_dwordx4 v222, s[88:91], s3 offen offset:2048 lds
    buffer_load_dwordx4 v223, s[88:91], s3 offen offset:3072 lds
    s_mov_b32 s3, 86016
    buffer_load_dwordx4 v[176:179], v21, s[52:55], s3 offen nt
    s_mov_b32 s3, 93184
    buffer_load_dwordx4 v[180:183], v21, s[52:55], s3 offen nt
    s_mov_b32 s3, 100352
    buffer_load_dwordx4 v[184:187], v21, s[52:55], s3 offen nt
    s_mov_b32 s3, 107520
    buffer_load_dwordx4 v[188:191], v21, s[52:55], s3 offen nt
    s_lshr_b32 s3, s71, 3
    s_add_u32 s3, s3, 0
    s_and_b32 s28, s3, 7
    s_lshr_b32 s3, s3, 3
    s_lshl_b32 s3, s3, 6
    s_add_u32 s3, s3, s28
    s_lshl_b32 s3, s3, 11
    buffer_load_dwordx4 v[192:195], v22, s[56:59], s3 offen nt
    s_lshr_b32 s3, s71, 3
    s_add_u32 s3, s3, 1
    s_and_b32 s28, s3, 7
    s_lshr_b32 s3, s3, 3
    s_lshl_b32 s3, s3, 6
    s_add_u32 s3, s3, s28
    s_lshl_b32 s3, s3, 11
    buffer_load_dwordx4 v[196:199], v22, s[56:59], s3 offen nt
    s_lshr_b32 s3, s71, 3
    s_add_u32 s3, s3, 2
    s_and_b32 s28, s3, 7
    s_lshr_b32 s3, s3, 3
    s_lshl_b32 s3, s3, 6
    s_add_u32 s3, s3, s28
    s_lshl_b32 s3, s3, 11
    buffer_load_dwordx4 v[200:203], v22, s[56:59], s3 offen nt
    s_waitcnt vmcnt(19)
    v_lshlrev_b32_e64 v2, 16, v144
    v_and_b32 v3, 0xffff0000, v144
    v_pk_fma_f32 v[120:121], v[2:3], v[100:101], v[120:121] op_sel_hi:[1,0,1]
    v_lshlrev_b32_e64 v4, 16, v145
    v_and_b32 v5, 0xffff0000, v145
    v_pk_fma_f32 v[122:123], v[4:5], v[100:101], v[122:123] op_sel_hi:[1,0,1]
    v_lshlrev_b32_e64 v2, 16, v146
    v_and_b32 v3, 0xffff0000, v146
    v_pk_fma_f32 v[124:125], v[2:3], v[100:101], v[124:125] op_sel_hi:[1,0,1]
    v_lshlrev_b32_e64 v4, 16, v147
    v_and_b32 v5, 0xffff0000, v147
    v_pk_fma_f32 v[126:127], v[4:5], v[100:101], v[126:127] op_sel_hi:[1,0,1]
    v_lshlrev_b32 v2, 16, v148
    v_and_b32 v3, 0xffff0000, v148
    v_mov_b32 v100, v101
    v_pk_fma_f32 v[120:121], v[2:3], v[100:101], v[120:121] op_sel_hi:[1,0,1]
    v_lshlrev_b32_e64 v4, 16, v149
    v_and_b32 v5, 0xffff0000, v149
    v_pk_fma_f32 v[122:123], v[4:5], v[100:101], v[122:123] op_sel_hi:[1,0,1]
    v_lshlrev_b32_e64 v2, 16, v150
    v_and_b32 v3, 0xffff0000, v150
    v_pk_fma_f32 v[124:125], v[2:3], v[100:101], v[124:125] op_sel_hi:[1,0,1]
    v_lshlrev_b32_e64 v4, 16, v151
    v_and_b32 v5, 0xffff0000, v151
    v_pk_fma_f32 v[126:127], v[4:5], v[100:101], v[126:127] op_sel_hi:[1,0,1]
    v_lshlrev_b32_e64 v2, 16, v152
    v_and_b32 v3, 0xffff0000, v152
    v_pk_fma_f32 v[120:121], v[2:3], v[102:103], v[120:121] op_sel_hi:[1,0,1]
    v_lshlrev_b32_e64 v4, 16, v153
    v_and_b32 v5, 0xffff0000, v153
    v_pk_fma_f32 v[122:123], v[4:5], v[102:103], v[122:123] op_sel_hi:[1,0,1]
    v_lshlrev_b32_e64 v2, 16, v154
    v_and_b32 v3, 0xffff0000, v154
    v_pk_fma_f32 v[124:125], v[2:3], v[102:103], v[124:125] op_sel_hi:[1,0,1]
    v_lshlrev_b32_e64 v4, 16, v155
    v_and_b32 v5, 0xffff0000, v155
    v_pk_fma_f32 v[126:127], v[4:5], v[102:103], v[126:127] op_sel_hi:[1,0,1]
    v_lshlrev_b32 v2, 16, v156
    v_and_b32 v3, 0xffff0000, v156
    v_mov_b32 v102, v103
    v_pk_fma_f32 v[120:121], v[2:3], v[102:103], v[120:121] op_sel_hi:[1,0,1]
    v_lshlrev_b32_e64 v4, 16, v157
    v_and_b32 v5, 0xffff0000, v157
    v_pk_fma_f32 v[122:123], v[4:5], v[102:103], v[122:123] op_sel_hi:[1,0,1]
    v_lshlrev_b32_e64 v2, 16, v158
    v_and_b32 v3, 0xffff0000, v158
    v_pk_fma_f32 v[124:125], v[2:3], v[102:103], v[124:125] op_sel_hi:[1,0,1]
    v_lshlrev_b32_e64 v4, 16, v159
    v_and_b32 v5, 0xffff0000, v159
    v_pk_fma_f32 v[126:127], v[4:5], v[102:103], v[126:127] op_sel_hi:[1,0,1]
    v_lshlrev_b32_e64 v2, 16, v160
    v_and_b32 v3, 0xffff0000, v160
    v_pk_fma_f32 v[120:121], v[2:3], v[104:105], v[120:121] op_sel_hi:[1,0,1]
    v_lshlrev_b32_e64 v4, 16, v161
    v_and_b32 v5, 0xffff0000, v161
    v_pk_fma_f32 v[122:123], v[4:5], v[104:105], v[122:123] op_sel_hi:[1,0,1]
    v_lshlrev_b32_e64 v2, 16, v162
    v_and_b32 v3, 0xffff0000, v162
    v_pk_fma_f32 v[124:125], v[2:3], v[104:105], v[124:125] op_sel_hi:[1,0,1]
    v_lshlrev_b32_e64 v4, 16, v163
    v_and_b32 v5, 0xffff0000, v163
    v_pk_fma_f32 v[126:127], v[4:5], v[104:105], v[126:127] op_sel_hi:[1,0,1]
    v_lshlrev_b32 v2, 16, v164
    v_and_b32 v3, 0xffff0000, v164
    v_mov_b32 v104, v105
    v_pk_fma_f32 v[120:121], v[2:3], v[104:105], v[120:121] op_sel_hi:[1,0,1]
    v_lshlrev_b32_e64 v4, 16, v165
    v_and_b32 v5, 0xffff0000, v165
    v_pk_fma_f32 v[122:123], v[4:5], v[104:105], v[122:123] op_sel_hi:[1,0,1]
    v_lshlrev_b32_e64 v2, 16, v166
    v_and_b32 v3, 0xffff0000, v166
    v_pk_fma_f32 v[124:125], v[2:3], v[104:105], v[124:125] op_sel_hi:[1,0,1]
    v_lshlrev_b32_e64 v4, 16, v167
    v_and_b32 v5, 0xffff0000, v167
    v_pk_fma_f32 v[126:127], v[4:5], v[104:105], v[126:127] op_sel_hi:[1,0,1]
    v_lshlrev_b32_e64 v2, 16, v168
    v_and_b32 v3, 0xffff0000, v168
    v_pk_fma_f32 v[120:121], v[2:3], v[106:107], v[120:121] op_sel_hi:[1,0,1]
    v_lshlrev_b32_e64 v4, 16, v169
    v_and_b32 v5, 0xffff0000, v169
    v_pk_fma_f32 v[122:123], v[4:5], v[106:107], v[122:123] op_sel_hi:[1,0,1]
    v_lshlrev_b32_e64 v2, 16, v170
    v_and_b32 v3, 0xffff0000, v170
    v_pk_fma_f32 v[124:125], v[2:3], v[106:107], v[124:125] op_sel_hi:[1,0,1]
    v_lshlrev_b32_e64 v4, 16, v171
    v_and_b32 v5, 0xffff0000, v171
    v_pk_fma_f32 v[126:127], v[4:5], v[106:107], v[126:127] op_sel_hi:[1,0,1]
    v_lshlrev_b32 v2, 16, v172
    v_and_b32 v3, 0xffff0000, v172
    v_mov_b32 v106, v107
    v_pk_fma_f32 v[120:121], v[2:3], v[106:107], v[120:121] op_sel_hi:[1,0,1]
    v_lshlrev_b32_e64 v4, 16, v173
    v_and_b32 v5, 0xffff0000, v173
    v_pk_fma_f32 v[122:123], v[4:5], v[106:107], v[122:123] op_sel_hi:[1,0,1]
    v_lshlrev_b32_e64 v2, 16, v174
    v_and_b32 v3, 0xffff0000, v174
    v_pk_fma_f32 v[124:125], v[2:3], v[106:107], v[124:125] op_sel_hi:[1,0,1]
    v_lshlrev_b32_e64 v4, 16, v175
    v_and_b32 v5, 0xffff0000, v175
    v_pk_fma_f32 v[126:127], v[4:5], v[106:107], v[126:127] op_sel_hi:[1,0,1]
    s_waitcnt vmcnt(15)
    s_waitcnt vmcnt(11)
    s_waitcnt vmcnt(7)
    s_barrier
    s_add_u32 m0, s72, 32768
    s_xor_b32 s3, s73, 524288
    buffer_load_dwordx4 v220, s[88:91], s3 offen offset:0 lds
    buffer_load_dwordx4 v221, s[88:91], s3 offen offset:1024 lds
    buffer_load_dwordx4 v222, s[88:91], s3 offen offset:2048 lds
    buffer_load_dwordx4 v223, s[88:91], s3 offen offset:3072 lds
    s_add_u32 m0, s72, 49152
    s_xor_b32 s3, s73, 786432
    buffer_load_dwordx4 v220, s[88:91], s3 offen offset:0 lds
    buffer_load_dwordx4 v221, s[88:91], s3 offen offset:1024 lds
    buffer_load_dwordx4 v222, s[88:91], s3 offen offset:2048 lds
    buffer_load_dwordx4 v223, s[88:91], s3 offen offset:3072 lds
    s_add_u32 m0, s72, 81920
    s_xor_b32 s3, s73, 1310720
    buffer_load_dwordx4 v220, s[88:91], s3 offen offset:0 lds
    buffer_load_dwordx4 v221, s[88:91], s3 offen offset:1024 lds
    buffer_load_dwordx4 v222, s[88:91], s3 offen offset:2048 lds
    buffer_load_dwordx4 v223, s[88:91], s3 offen offset:3072 lds
    s_setprio 3
    s_cmp_lg_u32 s38, 3
    s_cbranch_scc1 L_npl
    s_mov_b32 s3, 32768
    s_mov_b32 s29, 0
    s_mov_b32 exec_lo, -1
    s_mov_b32 exec_hi, 65535
L_rp:
    buffer_load_dword v118, v113, s[48:51], s3 offen sc1
    s_waitcnt vmcnt(0)
    v_cmp_ne_u32 vcc, s86, v118
    s_cbranch_vccz L_rpk
    s_mov_b64 exec, vcc
    s_add_u32 s29, s29, 1
    s_cmp_lt_u32 s29, 200000
    s_cbranch_scc1 L_rp
L_rpk:
    s_mov_b64 exec, -1
    v_mov_b32 v4, 162128
    v_mov_b32 v5, 1
    ds_write_b32 v4, v5
L_npl:
    v_min_u32 v3, 4, v1
    v_lshlrev_b32_e64 v3, 2, v3
    v_add_u32 v3, 162112, v3
L_fw:
    ds_read_b32 v4, v3
    s_waitcnt lgkmcnt(0)
    v_cmp_eq_u32 vcc, 0, v4
    s_cbranch_vccz L_fk
    s_sleep 1
    s_branch L_fw
L_fk:
    s_waitcnt vmcnt(15)
    v_lshlrev_b32_e64 v2, 16, v176
    v_and_b32 v3, 0xffff0000, v176
    v_pk_fma_f32 v[120:121], v[2:3], v[108:109], v[120:121] op_sel_hi:[1,0,1]
    v_lshlrev_b32_e64 v4, 16, v177
    v_and_b32 v5, 0xffff0000, v177
    v_pk_fma_f32 v[122:123], v[4:5], v[108:109], v[122:123] op_sel_hi:[1,0,1]
    v_lshlrev_b32_e64 v2, 16, v178
    v_and_b32 v3, 0xffff0000, v178
    v_pk_fma_f32 v[124:125], v[2:3], v[108:109], v[124:125] op_sel_hi:[1,0,1]
    v_lshlrev_b32_e64 v4, 16, v179
    v_and_b32 v5, 0xffff0000, v179
    v_pk_fma_f32 v[126:127], v[4:5], v[108:109], v[126:127] op_sel_hi:[1,0,1]
    v_lshlrev_b32 v2, 16, v180
    v_and_b32 v3, 0xffff0000, v180
    v_mov_b32 v108, v109
    v_pk_fma_f32 v[120:121], v[2:3], v[108:109], v[120:121] op_sel_hi:[1,0,1]
    v_lshlrev_b32_e64 v4, 16, v181
    v_and_b32 v5, 0xffff0000, v181
    v_pk_fma_f32 v[122:123], v[4:5], v[108:109], v[122:123] op_sel_hi:[1,0,1]
    v_lshlrev_b32_e64 v2, 16, v182
    v_and_b32 v3, 0xffff0000, v182
    v_pk_fma_f32 v[124:125], v[2:3], v[108:109], v[124:125] op_sel_hi:[1,0,1]
    v_lshlrev_b32_e64 v4, 16, v183
    v_and_b32 v5, 0xffff0000, v183
    v_pk_fma_f32 v[126:127], v[4:5], v[108:109], v[126:127] op_sel_hi:[1,0,1]
    s_add_u32 s3, s76, 0
    buffer_load_dwordx4 v[48:51], v112, s[48:51], s3 offen sc1
    s_add_u32 s3, s76, 33792
    buffer_load_dwordx4 v[52:55], v112, s[48:51], s3 offen sc1
    s_cmp_lg_u32 s83, 0
    s_cbranch_scc1 L_nz
    s_add_u32 s3, s81, 0
    buffer_load_dwordx4 v[32:35], v112, s[48:51], s3 offen sc1
    s_add_u32 s3, s81, 33792
    buffer_load_dwordx4 v[36:39], v112, s[48:51], s3 offen sc1
L_nz:
    v_lshlrev_b32_e64 v2, 16, v184
    v_and_b32 v3, 0xffff0000, v184
    v_pk_fma_f32 v[120:121], v[2:3], v[110:111], v[120:121] op_sel_hi:[1,0,1]
    v_lshlrev_b32_e64 v4, 16, v185
    v_and_b32 v5, 0xffff0000, v185
    v_pk_fma_f32 v[122:123], v[4:5], v[110:111], v[122:123] op_sel_hi:[1,0,1]
    v_lshlrev_b32_e64 v2, 16, v186
    v_and_b32 v3, 0xffff0000, v186
    v_pk_fma_f32 v[124:125], v[2:3], v[110:111], v[124:125] op_sel_hi:[1,0,1]
    v_lshlrev_b32_e64 v4, 16, v187
    v_and_b32 v5, 0xffff0000, v187
    v_pk_fma_f32 v[126:127], v[4:5], v[110:111], v[126:127] op_sel_hi:[1,0,1]
    v_lshlrev_b32 v2, 16, v188
    v_and_b32 v3, 0xffff0000, v188
    v_mov_b32 v110, v111
    v_pk_fma_f32 v[120:121], v[2:3], v[110:111], v[120:121] op_sel_hi:[1,0,1]
    v_lshlrev_b32_e64 v4, 16, v189
    v_and_b32 v5, 0xffff0000, v189
    v_pk_fma_f32 v[122:123], v[4:5], v[110:111], v[122:123] op_sel_hi:[1,0,1]
    v_lshlrev_b32_e64 v2, 16, v190
    v_and_b32 v3, 0xffff0000, v190
    v_pk_fma_f32 v[124:125], v[2:3], v[110:111], v[124:125] op_sel_hi:[1,0,1]
    v_lshlrev_b32_e64 v4, 16, v191
    v_and_b32 v5, 0xffff0000, v191
    v_pk_fma_f32 v[126:127], v[4:5], v[110:111], v[126:127] op_sel_hi:[1,0,1]
    v_permlane32_swap_b32 v120, v124
    v_permlane32_swap_b32 v121, v125
    v_permlane32_swap_b32 v122, v126
    v_permlane32_swap_b32 v123, v127
    v_add_f32 v120, v120, v124
    v_add_f32 v121, v121, v125
    v_add_f32 v122, v122, v126
    v_add_f32 v123, v123, v127
    s_nop 0
    v_permlane16_swap_b32 v120, v122
    v_permlane16_swap_b32 v121, v123
    v_add_f32 v120, v120, v122
    v_add_f32 v121, v121, v123
    s_nop 0
    v_add_f32 v120, v120, v120 row_ror:8 row_mask:0xf bank_mask:0xf
    v_add_f32 v121, v121, v121 row_ror:8 row_mask:0xf bank_mask:0xf
    v_and_b32 v2, 8, v1
    v_cmp_eq_u32 vcc, 0, v2
    s_nop 1
    v_cndmask_b32 v120, v121, v120, vcc
    buffer_store_dword v120, v253, s[48:51], s84 offen sc1
    s_lshr_b32 s3, s71, 3
    s_add_u32 s3, s3, 3
    s_and_b32 s28, s3, 7
    s_lshr_b32 s3, s3, 3
    s_lshl_b32 s3, s3, 6
    s_add_u32 s3, s3, s28
    s_lshl_b32 s3, s3, 11
    buffer_load_dwordx4 v[204:207], v22, s[56:59], s3 offen nt
    s_lshr_b32 s3, s71, 3
    s_add_u32 s3, s3, 4
    s_and_b32 s28, s3, 7
    s_lshr_b32 s3, s3, 3
    s_lshl_b32 s3, s3, 6
    s_add_u32 s3, s3, s28
    s_lshl_b32 s3, s3, 11
    buffer_load_dwordx4 v[208:211], v22, s[56:59], s3 offen nt
    s_lshr_b32 s3, s71, 3
    s_add_u32 s3, s3, 5
    s_and_b32 s28, s3, 7
    s_lshr_b32 s3, s3, 3
    s_lshl_b32 s3, s3, 6
    s_add_u32 s3, s3, s28
    s_lshl_b32 s3, s3, 11
    buffer_load_dwordx4 v[212:215], v22, s[56:59], s3 offen nt
    s_lshr_b32 s3, s71, 3
    s_add_u32 s3, s3, 6
    s_and_b32 s28, s3, 7
    s_lshr_b32 s3, s3, 3
    s_lshl_b32 s3, s3, 6
    s_add_u32 s3, s3, s28
    s_lshl_b32 s3, s3, 11
    buffer_load_dwordx4 v[216:219], v22, s[56:59], s3 offen nt
    s_waitcnt vmcnt(5)
    s_cmp_eq_u32 s83, 0
    s_cbranch_scc1 L_hz
    s_mov_b32 s29, 0
L_k4:
    v_max3_u32 v2, v48, v49, v50
    v_max3_u32 v2, v2, v51, v52
    v_max3_u32 v2, v2, v53, v54
    v_max_u32 v2, v2, v55
    v_cmp_eq_u32 vcc, -1, v2
    s_cbranch_vccz L_k4k
    s_add_u32 s29, s29, 1
    s_cmp_ge_u32 s29, 200000
    s_cbranch_scc1 L_k4k
    s_sleep 1
    s_add_u32 s3, s76, 0
    buffer_load_dwordx4 v[48:51], v112, s[48:51], s3 offen sc1
    s_add_u32 s3, s76, 33792
    buffer_load_dwordx4 v[52:55], v112, s[48:51], s3 offen sc1
    s_waitcnt vmcnt(0)
    s_branch L_k4
L_k4k:
    v_lshlrev_b32 v64, 16, v48
    v_and_b32 v65, 0xffff0000, v48
    v_lshlrev_b32 v66, 16, v49
    v_and_b32 v67, 0xffff0000, v49
    v_lshlrev_b32 v68, 16, v50
    v_and_b32 v69, 0xffff0000, v50
    v_lshlrev_b32 v70, 16, v51
    v_and_b32 v71, 0xffff0000, v51
    v_lshlrev_b32 v72, 16, v52
    v_and_b32 v73, 0xffff0000, v52
    v_pk_add_f32 v[64:65], v[64:65], v[72:73]
    v_lshlrev_b32_e64 v74, 16, v53
    v_and_b32 v75, 0xffff0000, v53
    v_pk_add_f32 v[66:67], v[66:67], v[74:75]
    v_lshlrev_b32_e64 v76, 16, v54
    v_and_b32 v77, 0xffff0000, v54
    v_pk_add_f32 v[68:69], v[68:69], v[76:77]
    v_lshlrev_b32_e64 v78, 16, v55
    v_and_b32 v79, 0xffff0000, v55
    v_pk_add_f32 v[70:71], v[70:71], v[78:79]
    v_permlane32_swap_b32 v64, v68
    v_permlane32_swap_b32 v65, v69
    v_permlane32_swap_b32 v66, v70
    v_permlane32_swap_b32 v67, v71
    v_add_f32 v64, v64, v68
    v_add_f32 v65, v65, v69
    v_add_f32 v66, v66, v70
    v_add_f32 v67, v67, v71
    s_nop 0
    v_permlane16_swap_b32 v64, v66
    v_permlane16_swap_b32 v65, v67
    v_add_f32 v64, v64, v66
    v_add_f32 v65, v65, v67
    s_nop 0
    v_add_f32 v64, v64, v64 row_ror:8 row_mask:0xf bank_mask:0xf
    v_add_f32 v65, v65, v65 row_ror:8 row_mask:0xf bank_mask:0xf
    v_cvt_pk_bf16_f32 v64, v64, v65
    v_mov_b32 v65, v64
    s_nop 1
    v_permlane16_swap_b32 v64, v65
    v_mov_b32 v66, v64
    v_mov_b32 v67, v65
    s_nop 0
    v_permlane32_swap_b32 v64, v66
    v_permlane32_swap_b32 v65, v67
    s_mov_b64 exec, 0xffff
    buffer_store_dwordx4 v[64:67], v114, s[48:51], s74 offen sc1
    s_branch L_h1e
L_hz:
    s_mov_b32 s29, 0
L_k3:
    v_max3_u32 v2, v48, v49, v50
    v_max3_u32 v2, v2, v51, v52
    v_max3_u32 v2, v2, v53, v54
    v_max3_u32 v2, v2, v55, v32
    v_max3_u32 v2, v2, v33, v34
    v_max3_u32 v2, v2, v35, v36
    v_max3_u32 v2, v2, v37, v38
    v_max_u32 v2, v2, v39
    v_cmp_eq_u32 vcc, -1, v2
    s_cbranch_vccz L_k3k
    s_add_u32 s29, s29, 1
    s_cmp_ge_u32 s29, 200000
    s_cbranch_scc1 L_k3k
    s_sleep 1
    s_add_u32 s3, s76, 0
    buffer_load_dwordx4 v[48:51], v112, s[48:51], s3 offen sc1
    s_add_u32 s3, s76, 33792
    buffer_load_dwordx4 v[52:55], v112, s[48:51], s3 offen sc1
    s_add_u32 s3, s81, 0
    buffer_load_dwordx4 v[32:35], v112, s[48:51], s3 offen sc1
    s_add_u32 s3, s81, 33792
    buffer_load_dwordx4 v[36:39], v112, s[48:51], s3 offen sc1
    s_waitcnt vmcnt(0)
    s_branch L_k3
L_k3k:
    v_lshlrev_b32 v64, 16, v48
    v_lshlrev_b32 v96, 16, v32
    v_and_b32 v65, 0xffff0000, v48
    v_and_b32 v97, 0xffff0000, v32
    v_lshlrev_b32 v66, 16, v49
    v_lshlrev_b32 v98, 16, v33
    v_and_b32 v67, 0xffff0000, v49
    v_and_b32 v99, 0xffff0000, v33
    v_lshlrev_b32 v68, 16, v50
    v_lshlrev_b32 v100, 16, v34
    v_and_b32 v69, 0xffff0000, v50
    v_and_b32 v101, 0xffff0000, v34
    v_lshlrev_b32 v70, 16, v51
    v_lshlrev_b32 v102, 16, v35
    v_and_b32 v71, 0xffff0000, v51
    v_and_b32 v103, 0xffff0000, v35
    v_lshlrev_b32 v72, 16, v52
    v_lshlrev_b32 v104, 16, v36
    v_and_b32 v73, 0xffff0000, v52
    v_and_b32 v105, 0xffff0000, v36
    v_pk_add_f32 v[64:65], v[64:65], v[72:73]
    v_pk_add_f32 v[96:97], v[96:97], v[104:105]
    v_lshlrev_b32 v74, 16, v53
    v_lshlrev_b32 v106, 16, v37
    v_and_b32 v75, 0xffff0000, v53
    v_and_b32 v107, 0xffff0000, v37
    v_pk_add_f32 v[66:67], v[66:67], v[74:75]
    v_pk_add_f32 v[98:99], v[98:99], v[106:107]
    v_lshlrev_b32 v76, 16, v54
    v_lshlrev_b32 v108, 16, v38
    v_and_b32 v77, 0xffff0000, v54
    v_and_b32 v109, 0xffff0000, v38
    v_pk_add_f32 v[68:69], v[68:69], v[76:77]
    v_pk_add_f32 v[100:101], v[100:101], v[108:109]
    v_lshlrev_b32 v78, 16, v55
    v_lshlrev_b32 v110, 16, v39
    v_and_b32 v79, 0xffff0000, v55
    v_and_b32 v111, 0xffff0000, v39
    v_pk_add_f32 v[70:71], v[70:71], v[78:79]
    v_pk_add_f32 v[102:103], v[102:103], v[110:111]
    v_permlane32_swap_b32 v64, v68
    v_permlane32_swap_b32 v96, v100
    v_permlane32_swap_b32 v65, v69
    v_permlane32_swap_b32 v97, v101
    v_permlane32_swap_b32 v66, v70
    v_permlane32_swap_b32 v98, v102
    v_permlane32_swap_b32 v67, v71
    v_permlane32_swap_b32 v99, v103
    v_add_f32 v64, v64, v68
    v_add_f32 v96, v96, v100
    v_add_f32 v65, v65, v69
    v_add_f32 v97, v97, v101
    v_add_f32 v66, v66, v70
    v_add_f32 v98, v98, v102
    v_add_f32 v67, v67, v71
    v_add_f32 v99, v99, v103
    v_permlane16_swap_b32 v64, v66
    v_permlane16_swap_b32 v96, v98
    v_permlane16_swap_b32 v65, v67
    v_permlane16_swap_b32 v97, v99
    v_add_f32 v64, v64, v66
    v_add_f32 v96, v96, v98
    v_add_f32 v65, v65, v67
    v_add_f32 v97, v97, v99
    v_add_f32 v64, v64, v64 row_ror:8 row_mask:0xf bank_mask:0xf
    v_add_f32 v96, v96, v96 row_ror:8 row_mask:0xf bank_mask:0xf
    v_add_f32 v65, v65, v65 row_ror:8 row_mask:0xf bank_mask:0xf
    v_add_f32 v97, v97, v97 row_ror:8 row_mask:0xf bank_mask:0xf
    v_cvt_pk_bf16_f32 v64, v64, v65
    v_cvt_pk_bf16_f32 v96, v96, v97
    v_mov_b32 v65, v64
    v_mov_b32 v97, v96
    s_nop 0
    v_permlane16_swap_b32 v64, v65
    v_permlane16_swap_b32 v96, v97
    v_mov_b32 v66, v64
    v_mov_b32 v98, v96
    v_mov_b32 v67, v65
    v_mov_b32 v99, v97
    v_permlane32_swap_b32 v64, v66
    v_permlane32_swap_b32 v96, v98
    v_permlane32_swap_b32 v65, v67
    v_permlane32_swap_b32_e64 v97, v99
    s_mov_b64 exec, 0xffff
    buffer_store_dwordx4 v[64:67], v114, s[48:51], s74 offen sc1
    buffer_store_dwordx4 v[96:99], v114, s[48:51], s82 offen sc1
L_h1e:
    s_mov_b64 exec, -1
    s_lshl_b32 s3, s38, 2
    s_add_u32 s3, s3, 162112
    v_mov_b32 v4, s3
    v_mov_b32 v5, 3
    ds_write_b32 v4, v5
    s_setprio 0
    v_and_b32 v2, 15, v1
    v_add_u32 v2, s69, v2
    v_lshlrev_b32 v2, 2, v2
    v_add_u32 v2, 152064, v2
    ds_read_b32 v9, v2
    ds_read_b32 v8, v2 offset:1024
    s_waitcnt lgkmcnt(0)
    v_mul_f32 v28, v9, v8
    v_mov_b32 v30, 0xbfb8aa3b
    v_lshlrev_b32 v224, 16, v240
    v_and_b32 v225, 0xffff0000, v240
    v_lshlrev_b32 v226, 16, v241
    v_and_b32 v227, 0xffff0000, v241
    v_lshlrev_b32 v228, 16, v242
    v_and_b32 v229, 0xffff0000, v242
    v_lshlrev_b32 v230, 16, v243
    v_and_b32 v231, 0xffff0000, v243
    v_lshlrev_b32 v232, 16, v244
    v_and_b32 v233, 0xffff0000, v244
    v_lshlrev_b32 v234, 16, v245
    v_and_b32 v235, 0xffff0000, v245
    v_lshlrev_b32 v236, 16, v246
    v_and_b32 v237, 0xffff0000, v246
    v_lshlrev_b32 v238, 16, v247
    v_and_b32 v239, 0xffff0000, v247
    v_pk_fma_f32 v[224:225], v[224:225], v[8:9], v[28:29] op_sel_hi:[1,0,0] neg_lo:[0,0,1] neg_hi:[0,0,1]
    v_pk_fma_f32 v[226:227], v[226:227], v[8:9], v[28:29] op_sel_hi:[1,0,0] neg_lo:[0,0,1] neg_hi:[0,0,1]
    v_pk_fma_f32 v[228:229], v[228:229], v[8:9], v[28:29] op_sel_hi:[1,0,0] neg_lo:[0,0,1] neg_hi:[0,0,1]
    v_pk_fma_f32 v[230:231], v[230:231], v[8:9], v[28:29] op_sel_hi:[1,0,0] neg_lo:[0,0,1] neg_hi:[0,0,1]
    v_pk_fma_f32 v[232:233], v[232:233], v[8:9], v[28:29] op_sel_hi:[1,0,0] neg_lo:[0,0,1] neg_hi:[0,0,1]
    v_pk_fma_f32 v[234:235], v[234:235], v[8:9], v[28:29] op_sel_hi:[1,0,0] neg_lo:[0,0,1] neg_hi:[0,0,1]
    v_pk_fma_f32 v[236:237], v[236:237], v[8:9], v[28:29] op_sel_hi:[1,0,0] neg_lo:[0,0,1] neg_hi:[0,0,1]
    v_pk_fma_f32 v[238:239], v[238:239], v[8:9], v[28:29] op_sel_hi:[1,0,0] neg_lo:[0,0,1] neg_hi:[0,0,1]
    v_pk_mul_f32 v[32:33], v[224:225], v[30:31] op_sel_hi:[1,0]
    v_pk_mul_f32 v[34:35], v[226:227], v[30:31] op_sel_hi:[1,0]
    v_pk_mul_f32 v[36:37], v[228:229], v[30:31] op_sel_hi:[1,0]
    v_pk_mul_f32 v[38:39], v[230:231], v[30:31] op_sel_hi:[1,0]
    v_pk_mul_f32 v[40:41], v[232:233], v[30:31] op_sel_hi:[1,0]
    v_pk_mul_f32 v[42:43], v[234:235], v[30:31] op_sel_hi:[1,0]
    v_pk_mul_f32 v[44:45], v[236:237], v[30:31] op_sel_hi:[1,0]
    v_pk_mul_f32 v[46:47], v[238:239], v[30:31] op_sel_hi:[1,0]
    v_exp_f32 v32, v32
    v_exp_f32 v33, v33
    v_exp_f32 v34, v34
    v_exp_f32 v35, v35
    v_exp_f32 v36, v36
    v_exp_f32 v37, v37
    v_exp_f32 v38, v38
    v_exp_f32 v39, v39
    v_exp_f32 v40, v40
    v_exp_f32 v41, v41
    v_exp_f32 v42, v42
    v_exp_f32 v43, v43
    v_exp_f32 v44, v44
    v_exp_f32 v45, v45
    v_exp_f32 v46, v46
    v_exp_f32 v47, v47
    v_pk_add_f32 v[32:33], v[32:33], 1.0 op_sel_hi:[1,0]
    v_pk_add_f32 v[34:35], v[34:35], 1.0 op_sel_hi:[1,0]
    v_pk_add_f32 v[36:37], v[36:37], 1.0 op_sel_hi:[1,0]
    v_pk_add_f32 v[38:39], v[38:39], 1.0 op_sel_hi:[1,0]
    v_pk_add_f32 v[40:41], v[40:41], 1.0 op_sel_hi:[1,0]
    v_pk_add_f32 v[42:43], v[42:43], 1.0 op_sel_hi:[1,0]
    v_pk_add_f32 v[44:45], v[44:45], 1.0 op_sel_hi:[1,0]
    v_pk_add_f32 v[46:47], v[46:47], 1.0 op_sel_hi:[1,0]
    v_rcp_f32 v32, v32
    v_rcp_f32 v33, v33
    v_rcp_f32 v34, v34
    v_rcp_f32 v35, v35
    v_rcp_f32 v36, v36
    v_rcp_f32 v37, v37
    v_rcp_f32 v38, v38
    v_rcp_f32 v39, v39
    v_rcp_f32 v40, v40
    v_rcp_f32 v41, v41
    v_rcp_f32 v42, v42
    v_rcp_f32 v43, v43
    v_rcp_f32 v44, v44
    v_rcp_f32 v45, v45
    v_rcp_f32 v46, v46
    v_rcp_f32 v47, v47
    v_pk_mul_f32 v[224:225], v[224:225], v[32:33]
    v_pk_mul_f32 v[226:227], v[226:227], v[34:35]
    v_pk_mul_f32 v[228:229], v[228:229], v[36:37]
    v_pk_mul_f32 v[230:231], v[230:231], v[38:39]
    v_pk_mul_f32 v[232:233], v[232:233], v[40:41]
    v_pk_mul_f32 v[234:235], v[234:235], v[42:43]
    v_pk_mul_f32 v[236:237], v[236:237], v[44:45]
    v_pk_mul_f32 v[238:239], v[238:239], v[46:47]
    s_add_u32 s3, s75, 0
    s_nop 0
    buffer_load_dwordx4 v[80:83], v13, s[48:51], s3 offen sc1
    s_add_u32 s3, s75, 57344
    buffer_load_dwordx4 v[84:87], v13, s[48:51], s3 offen sc1
    s_add_u32 s3, s75, 114688
    buffer_load_dwordx4 v[88:91], v13, s[48:51], s3 offen sc1
    s_add_u32 s3, s75, 172032
    buffer_load_dwordx4 v[92:95], v13, s[48:51], s3 offen sc1
    s_waitcnt vmcnt(0)
    s_mov_b32 s29, 0
L_k5:
    v_max3_u32 v2, v80, v81, v82
    v_max3_u32 v2, v2, v83, v84
    v_max3_u32 v2, v2, v85, v86
    v_max3_u32 v2, v2, v87, v88
    v_max3_u32 v2, v2, v89, v90
    v_max3_u32 v2, v2, v91, v92
    v_max3_u32 v2, v2, v93, v94
    v_max_u32 v2, v2, v95
    v_cmp_eq_u32 vcc, -1, v2
    s_cbranch_vccz L_k5k
    s_add_u32 s29, s29, 1
    s_cmp_ge_u32 s29, 200000
    s_cbranch_scc1 L_k5k
    s_sleep 1
    s_add_u32 s3, s75, 0
    s_nop 0
    buffer_load_dwordx4 v[80:83], v13, s[48:51], s3 offen sc1
    s_add_u32 s3, s75, 57344
    buffer_load_dwordx4 v[84:87], v13, s[48:51], s3 offen sc1
    s_add_u32 s3, s75, 114688
    buffer_load_dwordx4 v[88:91], v13, s[48:51], s3 offen sc1
    s_add_u32 s3, s75, 172032
    buffer_load_dwordx4 v[92:95], v13, s[48:51], s3 offen sc1
    s_waitcnt vmcnt(0)
    s_branch L_k5
L_k5k:
    v_pk_add_f32 v[80:81], v[80:81], v[84:85]
    v_pk_add_f32 v[82:83], v[82:83], v[86:87]
    v_pk_add_f32 v[88:89], v[88:89], v[92:93]
    v_pk_add_f32 v[90:91], v[90:91], v[94:95]
    s_nop 0
    v_permlane32_swap_b32 v80, v88
    v_permlane32_swap_b32 v81, v89
    v_permlane32_swap_b32 v82, v90
    v_permlane32_swap_b32 v83, v91
    v_add_f32 v80, v80, v88
    v_add_f32 v81, v81, v89
    v_add_f32 v82, v82, v90
    v_add_f32 v83, v83, v91
    v_permlane16_swap_b32 v80, v81
    s_nop 0
    v_permlane16_swap_b32 v82, v83
    v_add_f32 v80, v80, v81
    v_add_f32 v82, v82, v83
    s_nop 1
    v_permlane32_swap_b32 v80, v82
    v_cvt_pk_bf16_f32 v80, v80, v80
    v_lshlrev_b32 v80, 16, v80
    v_cvt_pk_bf16_f32 v82, v82, v82
    v_lshlrev_b32 v82, 16, v82
    v_mul_f32 v2, 0xbfb8aa3b, v80
    v_exp_f32 v2, v2
    s_nop 0
    v_add_f32 v2, 1.0, v2
    v_rcp_f32 v2, v2
    s_nop 0
    v_mul_f32 v80, v80, v2
    v_cvt_pk_bf16_f32 v80, v80, v80
    v_lshlrev_b32 v80, 16, v80
    v_mul_f32 v80, v80, v82
    v_cvt_pk_bf16_f32 v80, v80, v80
    v_lshlrev_b32 v80, 16, v80
    v_bfe_u32 v2, v1, 3, 2
    v_lshlrev_b32 v2, 6, v2
    v_lshrrev_b32_e64 v3, 5, v1
    v_lshl_add_u32 v2, v3, 2, v2
    ds_bpermute_b32 v128, v2, v80 offset:0
    ds_bpermute_b32 v130, v2, v80 offset:8
    ds_bpermute_b32 v132, v2, v80 offset:16
    ds_bpermute_b32 v134, v2, v80 offset:24
    ds_bpermute_b32 v136, v2, v80 offset:32
    ds_bpermute_b32 v138, v2, v80 offset:40
    ds_bpermute_b32 v140, v2, v80 offset:48
    v_mov_b64 v[120:121], 0
    v_mov_b64 v[122:123], 0
    v_mov_b64 v[124:125], 0
    v_mov_b64 v[126:127], 0
    s_waitcnt lgkmcnt(0)
    v_lshlrev_b32 v2, 16, v192
    v_and_b32 v3, 0xffff0000, v192
    v_pk_fma_f32 v[120:121], v[2:3], v[128:129], v[120:121] op_sel_hi:[1,0,1]
    v_lshlrev_b32_e64 v4, 16, v193
    v_and_b32 v5, 0xffff0000, v193
    v_pk_fma_f32 v[122:123], v[4:5], v[128:129], v[122:123] op_sel_hi:[1,0,1]
    v_lshlrev_b32_e64 v2, 16, v194
    v_and_b32 v3, 0xffff0000, v194
    v_pk_fma_f32 v[124:125], v[2:3], v[128:129], v[124:125] op_sel_hi:[1,0,1]
    v_lshlrev_b32_e64 v4, 16, v195
    v_and_b32 v5, 0xffff0000, v195
    v_pk_fma_f32 v[126:127], v[4:5], v[128:129], v[126:127] op_sel_hi:[1,0,1]
    v_lshlrev_b32_e64 v2, 16, v196
    v_and_b32 v3, 0xffff0000, v196
    v_pk_fma_f32 v[120:121], v[2:3], v[130:131], v[120:121] op_sel_hi:[1,0,1]
    v_lshlrev_b32_e64 v4, 16, v197
    v_and_b32 v5, 0xffff0000, v197
    v_pk_fma_f32 v[122:123], v[4:5], v[130:131], v[122:123] op_sel_hi:[1,0,1]
    v_lshlrev_b32_e64 v2, 16, v198
    v_and_b32 v3, 0xffff0000, v198
    v_pk_fma_f32 v[124:125], v[2:3], v[130:131], v[124:125] op_sel_hi:[1,0,1]
    v_lshlrev_b32_e64 v4, 16, v199
    v_and_b32 v5, 0xffff0000, v199
    v_pk_fma_f32 v[126:127], v[4:5], v[130:131], v[126:127] op_sel_hi:[1,0,1]
    v_lshlrev_b32_e64 v2, 16, v200
    v_and_b32 v3, 0xffff0000, v200
    v_pk_fma_f32 v[120:121], v[2:3], v[132:133], v[120:121] op_sel_hi:[1,0,1]
    v_lshlrev_b32_e64 v4, 16, v201
    v_and_b32 v5, 0xffff0000, v201
    v_pk_fma_f32 v[122:123], v[4:5], v[132:133], v[122:123] op_sel_hi:[1,0,1]
    v_lshlrev_b32_e64 v2, 16, v202
    v_and_b32 v3, 0xffff0000, v202
    v_pk_fma_f32 v[124:125], v[2:3], v[132:133], v[124:125] op_sel_hi:[1,0,1]
    v_lshlrev_b32_e64 v4, 16, v203
    v_and_b32 v5, 0xffff0000, v203
    v_pk_fma_f32 v[126:127], v[4:5], v[132:133], v[126:127] op_sel_hi:[1,0,1]
    v_lshlrev_b32_e64 v2, 16, v204
    v_and_b32 v3, 0xffff0000, v204
    v_pk_fma_f32 v[120:121], v[2:3], v[134:135], v[120:121] op_sel_hi:[1,0,1]
    v_lshlrev_b32_e64 v4, 16, v205
    v_and_b32 v5, 0xffff0000, v205
    v_pk_fma_f32 v[122:123], v[4:5], v[134:135], v[122:123] op_sel_hi:[1,0,1]
    v_lshlrev_b32_e64 v2, 16, v206
    v_and_b32 v3, 0xffff0000, v206
    v_pk_fma_f32 v[124:125], v[2:3], v[134:135], v[124:125] op_sel_hi:[1,0,1]
    v_lshlrev_b32_e64 v4, 16, v207
    v_and_b32 v5, 0xffff0000, v207
    v_pk_fma_f32 v[126:127], v[4:5], v[134:135], v[126:127] op_sel_hi:[1,0,1]
    v_lshlrev_b32_e64 v2, 16, v208
    v_and_b32 v3, 0xffff0000, v208
    v_pk_fma_f32 v[120:121], v[2:3], v[136:137], v[120:121] op_sel_hi:[1,0,1]
    v_lshlrev_b32_e64 v4, 16, v209
    v_and_b32 v5, 0xffff0000, v209
    v_pk_fma_f32 v[122:123], v[4:5], v[136:137], v[122:123] op_sel_hi:[1,0,1]
    v_lshlrev_b32_e64 v2, 16, v210
    v_and_b32 v3, 0xffff0000, v210
    v_pk_fma_f32 v[124:125], v[2:3], v[136:137], v[124:125] op_sel_hi:[1,0,1]
    v_lshlrev_b32_e64 v4, 16, v211
    v_and_b32 v5, 0xffff0000, v211
    v_pk_fma_f32 v[126:127], v[4:5], v[136:137], v[126:127] op_sel_hi:[1,0,1]
    v_lshlrev_b32_e64 v2, 16, v212
    v_and_b32 v3, 0xffff0000, v212
    v_pk_fma_f32 v[120:121], v[2:3], v[138:139], v[120:121] op_sel_hi:[1,0,1]
    v_lshlrev_b32_e64 v4, 16, v213
    v_and_b32 v5, 0xffff0000, v213
    v_pk_fma_f32 v[122:123], v[4:5], v[138:139], v[122:123] op_sel_hi:[1,0,1]
    v_lshlrev_b32_e64 v2, 16, v214
    v_and_b32 v3, 0xffff0000, v214
    v_pk_fma_f32 v[124:125], v[2:3], v[138:139], v[124:125] op_sel_hi:[1,0,1]
    v_lshlrev_b32_e64 v4, 16, v215
    v_and_b32 v5, 0xffff0000, v215
    v_pk_fma_f32 v[126:127], v[4:5], v[138:139], v[126:127] op_sel_hi:[1,0,1]
    v_lshlrev_b32_e64 v2, 16, v216
    v_and_b32 v3, 0xffff0000, v216
    v_pk_fma_f32 v[120:121], v[2:3], v[140:141], v[120:121] op_sel_hi:[1,0,1]
    v_lshlrev_b32_e64 v4, 16, v217
    v_and_b32 v5, 0xffff0000, v217
    v_pk_fma_f32 v[122:123], v[4:5], v[140:141], v[122:123] op_sel_hi:[1,0,1]
    v_lshlrev_b32_e64 v2, 16, v218
    v_and_b32 v3, 0xffff0000, v218
    v_pk_fma_f32 v[124:125], v[2:3], v[140:141], v[124:125] op_sel_hi:[1,0,1]
    v_lshlrev_b32_e64 v4, 16, v219
    v_and_b32 v5, 0xffff0000, v219
    v_pk_fma_f32 v[126:127], v[4:5], v[140:141], v[126:127] op_sel_hi:[1,0,1]
    v_permlane32_swap_b32 v120, v124
    v_permlane32_swap_b32 v121, v125
    v_permlane32_swap_b32 v122, v126
    v_permlane32_swap_b32 v123, v127
    v_add_f32 v120, v120, v124
    v_add_f32 v121, v121, v125
    v_add_f32 v122, v122, v126
    v_add_f32 v123, v123, v127
    s_nop 0
    v_permlane16_swap_b32 v120, v122
    v_permlane16_swap_b32 v121, v123
    v_add_f32 v120, v120, v122
    v_add_f32 v121, v121, v123
    s_nop 0
    v_add_f32 v120, v120, v120 row_ror:8 row_mask:0xf bank_mask:0xf
    v_add_f32 v121, v121, v121 row_ror:8 row_mask:0xf bank_mask:0xf
    v_and_b32 v2, 8, v1
    v_cmp_eq_u32 vcc, 0, v2
    s_and_b32 s3, s2, 15
    s_lshl_b32 s3, s3, 4
    s_lshr_b32 s28, s2, 4
    s_add_u32 s3, s3, s28
    s_lshl_b32 s3, s3, 2
    s_add_u32 s3, s3, s38
    s_lshl_b32 s3, s3, 8
    s_add_u32 s3, s3, 1413120
    v_cndmask_b32 v120, v121, v120, vcc
    buffer_store_dword v120, v253, s[48:51], s3 offen sc1
    v_and_b32 v3, 3, v1
    v_lshlrev_b32 v3, 2, v3
    v_add_u32 v3, 162112, v3
L_ow:
    ds_read_b32 v2, v3
    s_waitcnt lgkmcnt(0)
    v_cmp_ne_u32 vcc, 7, v2
    s_cbranch_vccz L_owk
    s_sleep 1
    s_branch L_ow
L_owk:
    s_branch L_p3
L_C:
    s_and_b32 s64, s38, 1
    s_lshr_b32 s65, s38, 1
    v_and_b32 v3, 15, v1
    v_lshlrev_b32 v3, 7, v3
    s_lshl_b32 s3, s64, 13
    v_add_u32 v3, s3, v3
    v_bfe_u32 v5, v1, 1, 3
    v_lshrrev_b32 v6, 4, v1
    v_xor_b32 v6, v6, v5
    v_lshl_add_u32 v184, v6, 4, v3
    v_xor_b32 v185, 64, v184
    v_lshrrev_b32 v6, 4, v1
    v_lshlrev_b32 v6, 3, v6
    v_bfe_u32 v7, v1, 2, 2
    v_add_u32 v6, v6, v7
    v_lshlrev_b32 v6, 7, v6
    v_and_b32 v7, 3, v1
    v_lshl_add_u32 v6, v7, 3, v6
    v_add_u32 v6, 16384, v6
    v_bfe_u32 v7, v1, 3, 2
    s_lshl_b32 s3, s65, 1
    v_xor_b32 v7, s3, v7
    v_lshl_add_u32 v186, v7, 5, v6
    v_xor_b32_e64 v187, 32, v186
    v_add_u32 v188, 81920, v184
    v_add_u32 v189, 81920, v185
    v_add_u32 v190, 81920, v186
    v_add_u32 v191, 81920, v187
    s_waitcnt lgkmcnt(0)
    s_mov_b32 s48, s26
    s_mov_b32 s49, s27
    s_mov_b32 s50, 268435456
    s_mov_b32 s51, 0x00020000
    s_mov_b32 s40, s4
    s_mov_b32 s41, s5
    s_mov_b32 s42, 4194304
    s_mov_b32 s43, 0x00020000
    s_mov_b32 s88, s10
    s_mov_b32 s89, s11
    s_mov_b32 s90, 2097152
    s_mov_b32 s91, 0x00020000
    s_lshl_b32 s3, s36, 7
    s_lshl_b32 s28, s37, 3
    s_add_u32 s3, s3, s28
    s_lshl_b32 s28, s38, 1
    s_add_u32 s71, s3, s28
    v_lshlrev_b32 v2, 4, v1
    v_mov_b32 v212, 16384
    v_mov_b32 v4, -1
    v_mov_b32 v5, -1
    v_mov_b32 v6, -1
    v_mov_b32_e64 v7, -1
    s_lshl_b32 s28, s2, 2
    s_add_u32 s28, s28, s38
    s_mul_i32 s28, s28, 768
    s_add_u32 s28, s28, 1048320
    s_lshl_b32 s3, s37, 4
    s_add_u32 s3, s3, s36
    s_lshl_b32 s3, s3, 2
    s_add_u32 s3, s3, s38
    s_lshl_b32 s3, s3, 8
    s_add_u32 s3, s3, 524288
    v_cmp_gt_u32 vcc, 16, v1
    v_add_u32 v3, s3, v2
    v_add_u32_e64 v2, s28, v2
    v_cndmask_b32 v2, v2, v3, vcc
    buffer_store_dwordx4 v[4:7], v2, s[48:51], 0 offen sc1
    buffer_load_dword v212, v212, s[48:51], 0 offen sc1
    s_getpc_b64 s[92:93]
L_pc:
    s_sub_u32 s92, s92, L_pc-recurrent_scan__linear_kernel_hedgehog__moe_arch_mod__prompt_kernel
    s_subb_u32 s93, s93, 0
    s_lshr_b32 s3, s2, 3
    s_lshl_b32 s3, s3, 2
    s_add_u32 s3, s3, s38
    s_lshl_b32 s3, s3, 8
    v_lshlrev_b32 v2, 7, v1
    v_add_u32 v2, s3, v2
    s_mov_b64 exec, 3
    global_load_dword v213, v2, s[92:93]
    s_mov_b64 exec, -1
    v_mov_b64 v[8:9], 0
    v_mov_b64 v[10:11], 0
    v_mov_b64 v[12:13], 0
    v_mov_b64 v[14:15], 0
    v_mov_b64 v[16:17], 0
    v_mov_b64 v[18:19], 0
    v_mov_b64 v[20:21], 0
    v_mov_b64 v[22:23], 0
    v_mov_b64 v[24:25], 0
    v_mov_b64 v[26:27], 0
    v_mov_b64 v[28:29], 0
    v_mov_b64 v[30:31], 0
    v_mov_b64 v[32:33], 0
    v_mov_b64 v[34:35], 0
    v_mov_b64 v[36:37], 0
    v_mov_b64 v[38:39], 0
    v_mov_b64 v[40:41], 0
    v_mov_b64 v[42:43], 0
    v_mov_b64 v[44:45], 0
    v_mov_b64 v[46:47], 0
    v_mov_b64 v[48:49], 0
    v_mov_b64 v[50:51], 0
    v_mov_b64 v[52:53], 0
    v_mov_b64 v[54:55], 0
    v_mov_b64 v[56:57], 0
    v_mov_b64 v[58:59], 0
    v_mov_b64 v[60:61], 0
    v_mov_b64 v[62:63], 0
    v_mov_b64 v[64:65], 0
    v_mov_b64 v[66:67], 0
    v_mov_b64 v[68:69], 0
    v_mov_b64 v[70:71], 0
    v_mov_b64 v[72:73], 0
    v_mov_b64 v[74:75], 0
    v_mov_b64 v[76:77], 0
    v_mov_b64 v[78:79], 0
    v_mov_b64 v[80:81], 0
    v_mov_b64 v[82:83], 0
    v_mov_b64 v[84:85], 0
    v_mov_b64 v[86:87], 0
    v_mov_b64 v[88:89], 0
    v_mov_b64 v[90:91], 0
    v_mov_b64 v[92:93], 0
    v_mov_b64 v[94:95], 0
    v_mov_b64 v[96:97], 0
    v_mov_b64 v[98:99], 0
    v_mov_b64 v[100:101], 0
    v_mov_b64 v[102:103], 0
    s_lshl_b32 s3, s38, 2
    s_add_u32 s3, s3, 162112
    v_mov_b32 v2, s3
    v_mov_b32_e64 v3, 0
    ds_write_b32 v2, v3
    ds_write_b32 v2, v3 offset:16
    s_mov_b32 s86, 0
    s_mov_b32 s66, 0
    s_setprio 2
    s_waitcnt lgkmcnt(0)
    s_lshl_b32 s3, s38, 1
    s_lshr_b32 s28, s39, 2
    s_add_u32 s3, s3, s28
    s_lshl_b32 s69, s3, 4
    v_and_b32 v237, 15, v1
    v_add_u32 v236, s69, v237
    v_lshlrev_b32 v236, 7, v236
    v_lshrrev_b32 v237, 1, v237
    v_lshrrev_b32 v238, 5, v1
    v_xor_b32 v237, v237, v238
    v_lshl_add_u32 v236, v237, 4, v236
    v_bfe_u32 v238, v1, 4, 1
    v_lshl_add_u32 v236, v238, 3, v236
    v_xor_b32 v237, 32, v236
    v_xor_b32 v238, 64, v236
    v_xor_b32 v239, 96, v236
    v_and_b32 v2, 15, v1
    v_lshrrev_b32_e64 v3, 4, v1
    s_lshl_b32 s3, s64, 8
    s_add_u32 s3, s3, 152064
    v_lshl_add_u32 v232, v2, 2, s3
    v_lshl_add_u32 v233, v3, 4, s3
    v_lshrrev_b32 v7, 5, v1
    v_lshl_add_u32 v234, v7, 6, v232
    s_lshl_b32 s3, s65, 7
    s_add_u32 s3, s3, 154880
    v_lshl_add_u32 v235, v3, 4, s3
    v_lshl_add_u32 v248, v2, 2, s3
    s_lshl_b32 s3, s64, 7
    s_add_u32 s3, s3, 154624
    v_lshl_add_u32 v249, v3, 4, s3
    v_xor_b32 v253, 128, v249
    v_lshrrev_b32 v250, 2, v1
    v_lshlrev_b32 v250, 6, v250
    v_and_b32 v251, 3, v1
    v_lshl_add_u32 v250, v251, 3, v250
    s_lshl_b32 s3, s65, 11
    s_add_u32 s3, s3, 147712
    v_add_u32 v252, s3, v250
    v_bfe_u32 v5, v1, 1, 2
    v_lshlrev_b32_e64 v5, 2, v5
    v_bfe_u32 v4, v1, 3, 1
    v_lshl_add_u32 v5, v4, 1, v5
    v_and_b32 v4, 1, v1
    v_add_u32 v5, v5, v4
    v_xor_b32 v5, v5, v3
    s_lshl_b32 s3, s38, 13
    s_add_u32 s3, s3, 98304
    v_lshl_add_u32 v2, v2, 7, s3
    v_lshl_add_u32 v4, v5, 3, v2
    v_xor_b32 v5, 32, v4
    v_xor_b32 v6, 64, v4
    v_xor_b32 v7, 96, v4
    v_bfe_u32 v2, v1, 3, 2
    v_lshlrev_b32 v2, 2, v2
    v_lshrrev_b32 v3, 5, v1
    v_lshl_add_u32 v2, v3, 1, v2
    v_bfe_u32 v3, v1, 2, 1
    v_add_u32 v2, v2, v3
    v_xor_b32 v2, v2, v251
    v_lshrrev_b32_e64 v3, 2, v1
    v_lshl_add_u32 v3, v3, 7, s3
    v_lshl_add_u32 v2, v2, 3, v3
    s_lshl_b32 s28, s64, 6
    v_xor_b32 v201, s28, v2
    v_xor_b32 v203, 32, v201
    s_lshl_b32 s3, s38, 12
    s_add_u32 s3, s3, 131072
    v_lshlrev_b32 v199, 4, v1
    v_add_u32 v197, s3, v199
    s_lshl_b32 s3, s37, 1
    s_add_u32 s67, s3, s65
    s_lshl_b32 s3, s67, 4
    s_add_u32 s3, s3, s36
    s_mul_i32 s3, s3, 4224
    s_add_u32 s75, s3, 8388608
    s_lshl_b32 s3, s64, 11
    s_add_u32 s74, s75, s3
    s_lshl_b32 s3, s64, 6
    s_add_u32 s75, s75, s3
    s_add_u32 s75, s75, 4096
    s_lshl_b32 s3, s37, 4
    s_add_u32 s3, s3, s36
    s_lshl_b32 s3, s3, 7
    s_add_u32 s3, s3, 32768
    s_cmp_lg_u32 s38, 0
    s_cselect_b32 s76, 268435456, s3
L_ln:
    s_lshl_b32 s3, s38, 12
    s_add_u32 s3, s3, 131072
    v_lshlrev_b32 v2, 4, v1
    v_add_u32 v3, s3, v2
    v_add_u32 v2, 122880, v2
    s_barrier
    ds_read_b128 v[120:123], v2 offset:0
    ds_read_b128 v[124:127], v2 offset:1024
    ds_read_b128 v[104:107], v3 offset:0
    ds_read_b128 v[108:111], v3 offset:1024
    ds_read_b128 v[112:115], v3 offset:2048
    ds_read_b128 v[116:119], v3 offset:3072
    v_mov_b32 v2, 0x3f803f80
    v_mov_b32 v128, 0
    v_mov_b32 v130, 0
    v_mov_b32 v132, 0
    v_mov_b32 v134, 0
    v_mov_b32 v136, 0
    v_mov_b32 v138, 0
    v_mov_b32 v140, 0
    v_mov_b32 v142, 0
    s_waitcnt lgkmcnt(2)
    v_dot2c_f32_bf16 v128, v104, v2
    v_dot2c_f32_bf16 v132, v104, v104
    v_dot2c_f32_bf16 v136, v104, v120
    v_dot2c_f32_bf16 v140, v120, v2
    v_dot2c_f32_bf16 v128, v105, v2
    v_dot2c_f32_bf16 v132, v105, v105
    v_dot2c_f32_bf16 v136, v105, v121
    v_dot2c_f32_bf16 v140, v121, v2
    v_dot2c_f32_bf16 v128, v106, v2
    v_dot2c_f32_bf16 v132, v106, v106
    v_dot2c_f32_bf16 v136, v106, v122
    v_dot2c_f32_bf16 v140, v122, v2
    v_dot2c_f32_bf16 v128, v107, v2
    v_dot2c_f32_bf16 v132, v107, v107
    v_dot2c_f32_bf16 v136, v107, v123
    v_dot2c_f32_bf16 v140, v123, v2
    v_dot2c_f32_bf16 v128, v108, v2
    v_dot2c_f32_bf16 v132, v108, v108
    v_dot2c_f32_bf16 v136, v108, v124
    v_dot2c_f32_bf16 v140, v124, v2
    v_dot2c_f32_bf16 v128, v109, v2
    v_dot2c_f32_bf16 v132, v109, v109
    v_dot2c_f32_bf16 v136, v109, v125
    v_dot2c_f32_bf16 v140, v125, v2
    v_dot2c_f32_bf16 v128, v110, v2
    v_dot2c_f32_bf16 v132, v110, v110
    v_dot2c_f32_bf16 v136, v110, v126
    v_dot2c_f32_bf16 v140, v126, v2
    v_dot2c_f32_bf16 v128, v111, v2
    v_dot2c_f32_bf16 v132, v111, v111
    v_dot2c_f32_bf16 v136, v111, v127
    v_dot2c_f32_bf16 v140, v127, v2
    s_waitcnt lgkmcnt(0)
    v_dot2c_f32_bf16 v130, v112, v2
    v_dot2c_f32_bf16 v134, v112, v112
    v_dot2c_f32_bf16 v138, v112, v120
    v_dot2c_f32_bf16 v142, v120, v2
    v_dot2c_f32_bf16 v130, v113, v2
    v_dot2c_f32_bf16 v134, v113, v113
    v_dot2c_f32_bf16 v138, v113, v121
    v_dot2c_f32_bf16 v142, v121, v2
    v_dot2c_f32_bf16 v130, v114, v2
    v_dot2c_f32_bf16 v134, v114, v114
    v_dot2c_f32_bf16 v138, v114, v122
    v_dot2c_f32_bf16 v142, v122, v2
    v_dot2c_f32_bf16 v130, v115, v2
    v_dot2c_f32_bf16 v134, v115, v115
    v_dot2c_f32_bf16 v138, v115, v123
    v_dot2c_f32_bf16 v142, v123, v2
    v_dot2c_f32_bf16 v130, v116, v2
    v_dot2c_f32_bf16 v134, v116, v116
    v_dot2c_f32_bf16 v138, v116, v124
    v_dot2c_f32_bf16 v142, v124, v2
    v_dot2c_f32_bf16 v130, v117, v2
    v_dot2c_f32_bf16 v134, v117, v117
    v_dot2c_f32_bf16 v138, v117, v125
    v_dot2c_f32_bf16 v142, v125, v2
    v_dot2c_f32_bf16 v130, v118, v2
    v_dot2c_f32_bf16 v134, v118, v118
    v_dot2c_f32_bf16 v138, v118, v126
    v_dot2c_f32_bf16 v142, v126, v2
    v_dot2c_f32_bf16 v130, v119, v2
    v_dot2c_f32_bf16 v134, v119, v119
    v_dot2c_f32_bf16 v138, v119, v127
    v_dot2c_f32_bf16 v142, v127, v2
    v_permlane32_swap_b32 v128, v130
    v_permlane32_swap_b32 v132, v134
    v_permlane32_swap_b32 v136, v138
    v_permlane32_swap_b32 v140, v142
    v_add_f32 v128, v128, v130
    v_add_f32 v132, v132, v134
    v_add_f32 v136, v136, v138
    v_add_f32 v140, v140, v142
    v_add_f32 v128, v128, v128 quad_perm:[1,0,3,2] row_mask:0xf bank_mask:0xf
    v_add_f32 v132, v132, v132 quad_perm:[1,0,3,2] row_mask:0xf bank_mask:0xf
    v_add_f32 v136, v136, v136 quad_perm:[1,0,3,2] row_mask:0xf bank_mask:0xf
    v_add_f32 v140, v140, v140 quad_perm:[1,0,3,2] row_mask:0xf bank_mask:0xf
    v_add_f32 v128, v128, v128 quad_perm:[2,3,0,1] row_mask:0xf bank_mask:0xf
    v_add_f32 v132, v132, v132 quad_perm:[2,3,0,1] row_mask:0xf bank_mask:0xf
    v_add_f32 v136, v136, v136 quad_perm:[2,3,0,1] row_mask:0xf bank_mask:0xf
    v_add_f32 v140, v140, v140 quad_perm:[2,3,0,1] row_mask:0xf bank_mask:0xf
    v_add_f32 v128, v128, v128 row_half_mirror row_mask:0xf bank_mask:0xf
    v_add_f32 v132, v132, v132 row_half_mirror row_mask:0xf bank_mask:0xf
    v_add_f32 v136, v136, v136 row_half_mirror row_mask:0xf bank_mask:0xf
    v_add_f32 v140, v140, v140 row_half_mirror row_mask:0xf bank_mask:0xf
    v_add_f32 v128, v128, v128 row_mirror row_mask:0xf bank_mask:0xf
    v_add_f32 v132, v132, v132 row_mirror row_mask:0xf bank_mask:0xf
    v_add_f32 v136, v136, v136 row_mirror row_mask:0xf bank_mask:0xf
    v_add_f32 v140, v140, v140 row_mirror row_mask:0xf bank_mask:0xf
    v_mov_b32 v129, v128
    v_mov_b32 v133, v132
    v_mov_b32 v137, v136
    v_mov_b32 v141, v140
    v_permlane16_swap_b32 v128, v129
    v_permlane16_swap_b32 v132, v133
    v_permlane16_swap_b32 v136, v137
    v_permlane16_swap_b32 v140, v141
    v_add_f32 v128, v128, v129
    v_add_f32 v132, v132, v133
    v_add_f32 v136, v136, v137
    v_add_f32 v140, v140, v141
    v_mul_f32 v128, 0x3a800000, v128
    v_mul_f32 v132, 0x3a800000, v132
    v_cvt_pk_bf16_f32 v129, v128, v128
    v_lshlrev_b32 v129, 16, v129
    v_fma_f32 v132, -v128, v128, v132
    v_max_f32 v132, 0, v132
    v_fma_f32 v136, -v129, v140, v136
    s_waitcnt vmcnt(0)
    v_cvt_pk_bf16_f32 v132, v132, v132
    v_lshlrev_b32 v132, 16, v132
    v_add_f32 v132, 0x3727c5ac, v132
    v_cvt_pk_bf16_f32 v132, v132, v132
    v_lshlrev_b32 v132, 16, v132
    v_sqrt_f32 v132, v132
    s_nop 0
    v_cvt_pk_bf16_f32 v132, v132, v132
    v_lshlrev_b32 v132, 16, v132
    v_rcp_f32 v2, v132
    v_lshrrev_b32 v3, 16, v129
    v_or_b32 v208, v3, v132
    v_mul_f32 v136, v136, v2
    v_cvt_pk_bf16_f32 v136, v136, v136
    v_lshlrev_b32 v136, 16, v136
    v_ashrrev_i32 v2, 31, v136
    v_or_b32 v2, 0x80000000, v2
    v_xor_b32 v2, v136, v2
    v_and_b32 v2, 0xffff0000, v2
    v_lshrrev_b32 v3, 5, v1
    v_add_u32 v209, s71, v3
    v_sub_u32 v209, 2047, v209
    v_or_b32 v210, v2, v209
    v_mov_b32 v2, v210
    v_mov_b32 v209, v208
    v_readfirstlane_b32 s86, v212
    v_mov_b32 v3, 0
    s_mul_i32 s86, s86, 1664525
    s_add_u32 s86, s86, 1013904223
    v_mov_b32 v211, s86
    v_permlane32_swap_b32 v210, v2
    v_permlane32_swap_b32 v208, v209
    v_max_u32 v210, v210, v2
    s_lshl_b32 s3, s71, 3
    s_mov_b64 exec, 1
    buffer_store_dwordx4 v[208:211], v3, s[48:51], s3 offen sc1
    s_mov_b64 exec, -1
    v_mov_b32_e64 v251, s86
    s_barrier
    ds_read_b128 v[104:107], v184 offset:0
    ds_read_b64_tr_b16 v[120:121], v186 offset:0
    ds_read_b64_tr_b16 v[122:123], v186 offset:512
    ds_read_b64_tr_b16 v[124:125], v187 offset:0
    ds_read_b64_tr_b16 v[126:127], v187 offset:512
    ds_read_b64_tr_b16 v[128:129], v186 offset:8192
    ds_read_b64_tr_b16 v[130:131], v186 offset:8704
    ds_read_b64_tr_b16 v[132:133], v187 offset:8192
    ds_read_b64_tr_b16 v[134:135], v187 offset:8704
    ds_read_b64_tr_b16 v[136:137], v186 offset:16384
    ds_read_b64_tr_b16 v[138:139], v186 offset:16896
    ds_read_b64_tr_b16 v[140:141], v187 offset:16384
    ds_read_b64_tr_b16 v[142:143], v187 offset:16896
    ds_read_b128 v[108:111], v184 offset:2048
    ds_read_b128 v[112:115], v184 offset:4096
    ds_read_b128 v[116:119], v184 offset:6144
    ds_read_b64 v[240:241], v236
    ds_read_b64 v[242:243], v237
    ds_read_b64 v[244:245], v238
    ds_read_b64 v[246:247], v239
    s_waitcnt lgkmcnt(4)
    s_branch L_cmid
.p2align 6
L_cloop:
    s_waitcnt lgkmcnt(0)
    s_barrier
    v_mfma_f32_16x16x32_bf16 v[8:11], v[160:163], v[144:147], v[8:11]
    ds_read_b128 v[104:107], v184 offset:0
    v_mfma_f32_16x16x32_bf16 v[12:15], v[164:167], v[144:147], v[12:15]
    ds_read_b64_tr_b16 v[120:121], v186 offset:0
    v_mfma_f32_16x16x32_bf16 v[16:19], v[168:171], v[144:147], v[16:19]
    ds_read_b64_tr_b16 v[122:123], v186 offset:512
    v_mfma_f32_16x16x32_bf16 v[20:23], v[172:175], v[144:147], v[20:23]
    ds_read_b64_tr_b16 v[124:125], v187 offset:0
    v_mfma_f32_16x16x32_bf16 v[24:27], v[144:147], v[176:179], v[24:27]
    ds_read_b64_tr_b16 v[126:127], v187 offset:512
    v_mfma_f32_16x16x32_bf16 v[28:31], v[144:147], v[180:183], v[28:31]
    ds_read_b64_tr_b16 v[128:129], v186 offset:8192
    v_mfma_f32_16x16x32_bf16 v[32:35], v[160:163], v[148:151], v[32:35]
    ds_read_b64_tr_b16 v[130:131], v186 offset:8704
    v_mfma_f32_16x16x32_bf16 v[36:39], v[164:167], v[148:151], v[36:39]
    ds_read_b64_tr_b16 v[132:133], v187 offset:8192
    v_mfma_f32_16x16x32_bf16 v[40:43], v[168:171], v[148:151], v[40:43]
    ds_read_b64_tr_b16 v[134:135], v187 offset:8704
    v_mfma_f32_16x16x32_bf16 v[44:47], v[172:175], v[148:151], v[44:47]
    ds_read_b64_tr_b16 v[136:137], v186 offset:16384
    v_mfma_f32_16x16x32_bf16 v[48:51], v[148:151], v[176:179], v[48:51]
    ds_read_b64_tr_b16 v[138:139], v186 offset:16896
    v_mfma_f32_16x16x32_bf16 v[52:55], v[148:151], v[180:183], v[52:55]
    ds_read_b64_tr_b16 v[140:141], v187 offset:16384
    v_mfma_f32_16x16x32_bf16 v[56:59], v[160:163], v[152:155], v[56:59]
    ds_read_b64_tr_b16 v[142:143], v187 offset:16896
    v_mfma_f32_16x16x32_bf16 v[60:63], v[164:167], v[152:155], v[60:63]
    ds_read_b128 v[108:111], v184 offset:2048
    v_mfma_f32_16x16x32_bf16 v[64:67], v[168:171], v[152:155], v[64:67]
    ds_read_b128 v[112:115], v184 offset:4096
    v_mfma_f32_16x16x32_bf16 v[68:71], v[172:175], v[152:155], v[68:71]
    ds_read_b128 v[116:119], v184 offset:6144
    v_mfma_f32_16x16x32_bf16 v[72:75], v[152:155], v[176:179], v[72:75]
    v_mfma_f32_16x16x32_bf16 v[76:79], v[152:155], v[180:183], v[76:79]
    v_mfma_f32_16x16x32_bf16 v[80:83], v[160:163], v[156:159], v[80:83]
    v_mfma_f32_16x16x32_bf16 v[84:87], v[164:167], v[156:159], v[84:87]
    v_mfma_f32_16x16x32_bf16 v[88:91], v[168:171], v[156:159], v[88:91]
    v_mfma_f32_16x16x32_bf16 v[92:95], v[172:175], v[156:159], v[92:95]
    v_mfma_f32_16x16x32_bf16 v[96:99], v[156:159], v[176:179], v[96:99]
    v_mfma_f32_16x16x32_bf16 v[100:103], v[156:159], v[180:183], v[100:103]
    s_waitcnt lgkmcnt(0)
    s_nop 0
L_cmid:
    v_mfma_f32_16x16x32_bf16 v[8:11], v[120:123], v[104:107], v[8:11]
    ds_read_b128 v[144:147], v185 offset:0
    v_mfma_f32_16x16x32_bf16 v[12:15], v[124:127], v[104:107], v[12:15]
    ds_read_b64_tr_b16 v[160:161], v186 offset:4096
    v_mfma_f32_16x16x32_bf16 v[16:19], v[128:131], v[104:107], v[16:19]
    ds_read_b64_tr_b16 v[162:163], v186 offset:4608
    v_mfma_f32_16x16x32_bf16 v[20:23], v[132:135], v[104:107], v[20:23]
    ds_read_b64_tr_b16 v[164:165], v187 offset:4096
    v_mfma_f32_16x16x32_bf16 v[24:27], v[104:107], v[136:139], v[24:27]
    ds_read_b64_tr_b16 v[166:167], v187 offset:4608
    v_mfma_f32_16x16x32_bf16 v[28:31], v[104:107], v[140:143], v[28:31]
    ds_read_b64_tr_b16 v[168:169], v186 offset:12288
    v_mfma_f32_16x16x32_bf16 v[32:35], v[120:123], v[108:111], v[32:35]
    ds_read_b64_tr_b16 v[170:171], v186 offset:12800
    v_mfma_f32_16x16x32_bf16 v[36:39], v[124:127], v[108:111], v[36:39]
    ds_read_b64_tr_b16 v[172:173], v187 offset:12288
    v_mfma_f32_16x16x32_bf16 v[40:43], v[128:131], v[108:111], v[40:43]
    ds_read_b64_tr_b16 v[174:175], v187 offset:12800
    v_mfma_f32_16x16x32_bf16 v[44:47], v[132:135], v[108:111], v[44:47]
    ds_read_b64_tr_b16 v[176:177], v186 offset:20480
    v_mfma_f32_16x16x32_bf16 v[48:51], v[108:111], v[136:139], v[48:51]
    ds_read_b64_tr_b16 v[178:179], v186 offset:20992
    v_mfma_f32_16x16x32_bf16 v[52:55], v[108:111], v[140:143], v[52:55]
    ds_read_b64_tr_b16 v[180:181], v187 offset:20480
    v_mfma_f32_16x16x32_bf16 v[56:59], v[120:123], v[112:115], v[56:59]
    ds_read_b64_tr_b16 v[182:183], v187 offset:20992
    v_mfma_f32_16x16x32_bf16 v[60:63], v[124:127], v[112:115], v[60:63]
    ds_read_b128 v[148:151], v185 offset:2048
    v_mfma_f32_16x16x32_bf16 v[64:67], v[128:131], v[112:115], v[64:67]
    ds_read_b128 v[152:155], v185 offset:4096
    v_mfma_f32_16x16x32_bf16 v[68:71], v[132:135], v[112:115], v[68:71]
    ds_read_b128 v[156:159], v185 offset:6144
    v_mfma_f32_16x16x32_bf16 v[72:75], v[112:115], v[136:139], v[72:75]
    v_mfma_f32_16x16x32_bf16 v[76:79], v[112:115], v[140:143], v[76:79]
    v_mfma_f32_16x16x32_bf16 v[80:83], v[120:123], v[116:119], v[80:83]
    v_mfma_f32_16x16x32_bf16 v[84:87], v[124:127], v[116:119], v[84:87]
    v_mfma_f32_16x16x32_bf16 v[88:91], v[128:131], v[116:119], v[88:91]
    v_mfma_f32_16x16x32_bf16 v[92:95], v[132:135], v[116:119], v[92:95]
    v_mfma_f32_16x16x32_bf16 v[96:99], v[116:119], v[136:139], v[96:99]
    v_mfma_f32_16x16x32_bf16 v[100:103], v[116:119], v[140:143], v[100:103]
    s_waitcnt lgkmcnt(0)
    s_barrier
    v_mfma_f32_16x16x32_bf16 v[8:11], v[160:163], v[144:147], v[8:11]
    ds_read_b128 v[104:107], v184 offset:40960
    v_mfma_f32_16x16x32_bf16 v[12:15], v[164:167], v[144:147], v[12:15]
    ds_read_b64_tr_b16 v[120:121], v186 offset:40960
    v_mfma_f32_16x16x32_bf16 v[16:19], v[168:171], v[144:147], v[16:19]
    ds_read_b64_tr_b16 v[122:123], v186 offset:41472
    v_mfma_f32_16x16x32_bf16 v[20:23], v[172:175], v[144:147], v[20:23]
    ds_read_b64_tr_b16 v[124:125], v187 offset:40960
    v_mfma_f32_16x16x32_bf16 v[24:27], v[144:147], v[176:179], v[24:27]
    ds_read_b64_tr_b16 v[126:127], v187 offset:41472
    v_mfma_f32_16x16x32_bf16 v[28:31], v[144:147], v[180:183], v[28:31]
    ds_read_b64_tr_b16 v[128:129], v186 offset:49152
    v_mfma_f32_16x16x32_bf16 v[32:35], v[160:163], v[148:151], v[32:35]
    ds_read_b64_tr_b16 v[130:131], v186 offset:49664
    v_mfma_f32_16x16x32_bf16 v[36:39], v[164:167], v[148:151], v[36:39]
    ds_read_b64_tr_b16 v[132:133], v187 offset:49152
    v_mfma_f32_16x16x32_bf16 v[40:43], v[168:171], v[148:151], v[40:43]
    ds_read_b64_tr_b16 v[134:135], v187 offset:49664
    v_mfma_f32_16x16x32_bf16 v[44:47], v[172:175], v[148:151], v[44:47]
    ds_read_b64_tr_b16 v[136:137], v186 offset:57344
    v_mfma_f32_16x16x32_bf16 v[48:51], v[148:151], v[176:179], v[48:51]
    ds_read_b64_tr_b16 v[138:139], v186 offset:57856
    v_mfma_f32_16x16x32_bf16 v[52:55], v[148:151], v[180:183], v[52:55]
    ds_read_b64_tr_b16 v[140:141], v187 offset:57344
    v_mfma_f32_16x16x32_bf16 v[56:59], v[160:163], v[152:155], v[56:59]
    ds_read_b64_tr_b16 v[142:143], v187 offset:57856
    v_mfma_f32_16x16x32_bf16 v[60:63], v[164:167], v[152:155], v[60:63]
    ds_read_b128 v[108:111], v184 offset:43008
    v_mfma_f32_16x16x32_bf16 v[64:67], v[168:171], v[152:155], v[64:67]
    ds_read_b128 v[112:115], v184 offset:45056
    v_mfma_f32_16x16x32_bf16 v[68:71], v[172:175], v[152:155], v[68:71]
    ds_read_b128 v[116:119], v184 offset:47104
    v_mfma_f32_16x16x32_bf16 v[72:75], v[152:155], v[176:179], v[72:75]
    v_mfma_f32_16x16x32_bf16 v[76:79], v[152:155], v[180:183], v[76:79]
    v_mfma_f32_16x16x32_bf16 v[80:83], v[160:163], v[156:159], v[80:83]
    v_mfma_f32_16x16x32_bf16 v[84:87], v[164:167], v[156:159], v[84:87]
    v_mfma_f32_16x16x32_bf16 v[88:91], v[168:171], v[156:159], v[88:91]
    v_mfma_f32_16x16x32_bf16 v[92:95], v[172:175], v[156:159], v[92:95]
    v_mfma_f32_16x16x32_bf16 v[96:99], v[156:159], v[176:179], v[96:99]
    v_mfma_f32_16x16x32_bf16 v[100:103], v[156:159], v[180:183], v[100:103]
    s_waitcnt lgkmcnt(0)
    s_nop 0
    v_mfma_f32_16x16x32_bf16 v[8:11], v[120:123], v[104:107], v[8:11]
    ds_read_b128 v[144:147], v185 offset:40960
    v_mfma_f32_16x16x32_bf16 v[12:15], v[124:127], v[104:107], v[12:15]
    ds_read_b64_tr_b16 v[160:161], v186 offset:45056
    v_mfma_f32_16x16x32_bf16 v[16:19], v[128:131], v[104:107], v[16:19]
    ds_read_b64_tr_b16 v[162:163], v186 offset:45568
    v_mfma_f32_16x16x32_bf16 v[20:23], v[132:135], v[104:107], v[20:23]
    ds_read_b64_tr_b16 v[164:165], v187 offset:45056
    v_mfma_f32_16x16x32_bf16 v[24:27], v[104:107], v[136:139], v[24:27]
    ds_read_b64_tr_b16 v[166:167], v187 offset:45568
    v_mfma_f32_16x16x32_bf16 v[28:31], v[104:107], v[140:143], v[28:31]
    ds_read_b64_tr_b16 v[168:169], v186 offset:53248
    v_mfma_f32_16x16x32_bf16 v[32:35], v[120:123], v[108:111], v[32:35]
    ds_read_b64_tr_b16 v[170:171], v186 offset:53760
    v_mfma_f32_16x16x32_bf16 v[36:39], v[124:127], v[108:111], v[36:39]
    ds_read_b64_tr_b16 v[172:173], v187 offset:53248
    v_mfma_f32_16x16x32_bf16 v[40:43], v[128:131], v[108:111], v[40:43]
    ds_read_b64_tr_b16 v[174:175], v187 offset:53760
    v_mfma_f32_16x16x32_bf16 v[44:47], v[132:135], v[108:111], v[44:47]
    ds_read_b64_tr_b16 v[176:177], v186 offset:61440
    v_mfma_f32_16x16x32_bf16 v[48:51], v[108:111], v[136:139], v[48:51]
    ds_read_b64_tr_b16 v[178:179], v186 offset:61952
    v_mfma_f32_16x16x32_bf16 v[52:55], v[108:111], v[140:143], v[52:55]
    ds_read_b64_tr_b16 v[180:181], v187 offset:61440
    v_mfma_f32_16x16x32_bf16 v[56:59], v[120:123], v[112:115], v[56:59]
    ds_read_b64_tr_b16 v[182:183], v187 offset:61952
    v_mfma_f32_16x16x32_bf16 v[60:63], v[124:127], v[112:115], v[60:63]
    ds_read_b128 v[148:151], v185 offset:43008
    v_mfma_f32_16x16x32_bf16 v[64:67], v[128:131], v[112:115], v[64:67]
    ds_read_b128 v[152:155], v185 offset:45056
    v_mfma_f32_16x16x32_bf16 v[68:71], v[132:135], v[112:115], v[68:71]
    ds_read_b128 v[156:159], v185 offset:47104
    v_mfma_f32_16x16x32_bf16 v[72:75], v[112:115], v[136:139], v[72:75]
    v_mfma_f32_16x16x32_bf16 v[76:79], v[112:115], v[140:143], v[76:79]
    v_mfma_f32_16x16x32_bf16 v[80:83], v[120:123], v[116:119], v[80:83]
    v_mfma_f32_16x16x32_bf16 v[84:87], v[124:127], v[116:119], v[84:87]
    v_mfma_f32_16x16x32_bf16 v[88:91], v[128:131], v[116:119], v[88:91]
    v_mfma_f32_16x16x32_bf16 v[92:95], v[132:135], v[116:119], v[92:95]
    v_mfma_f32_16x16x32_bf16 v[96:99], v[116:119], v[136:139], v[96:99]
    v_mfma_f32_16x16x32_bf16 v[100:103], v[116:119], v[140:143], v[100:103]
    s_waitcnt lgkmcnt(0)
    s_barrier
    v_mfma_f32_16x16x32_bf16 v[8:11], v[160:163], v[144:147], v[8:11]
    ds_read_b128 v[104:107], v188 offset:0
    v_mfma_f32_16x16x32_bf16 v[12:15], v[164:167], v[144:147], v[12:15]
    ds_read_b64_tr_b16 v[120:121], v190 offset:0
    v_mfma_f32_16x16x32_bf16 v[16:19], v[168:171], v[144:147], v[16:19]
    ds_read_b64_tr_b16 v[122:123], v190 offset:512
    v_mfma_f32_16x16x32_bf16 v[20:23], v[172:175], v[144:147], v[20:23]
    ds_read_b64_tr_b16 v[124:125], v191 offset:0
    v_mfma_f32_16x16x32_bf16 v[24:27], v[144:147], v[176:179], v[24:27]
    ds_read_b64_tr_b16 v[126:127], v191 offset:512
    v_mfma_f32_16x16x32_bf16 v[28:31], v[144:147], v[180:183], v[28:31]
    ds_read_b64_tr_b16 v[128:129], v190 offset:8192
    v_mfma_f32_16x16x32_bf16 v[32:35], v[160:163], v[148:151], v[32:35]
    ds_read_b64_tr_b16 v[130:131], v190 offset:8704
    v_mfma_f32_16x16x32_bf16 v[36:39], v[164:167], v[148:151], v[36:39]
    ds_read_b64_tr_b16 v[132:133], v191 offset:8192
    v_mfma_f32_16x16x32_bf16 v[40:43], v[168:171], v[148:151], v[40:43]
    ds_read_b64_tr_b16 v[134:135], v191 offset:8704
    v_mfma_f32_16x16x32_bf16 v[44:47], v[172:175], v[148:151], v[44:47]
    ds_read_b64_tr_b16 v[136:137], v190 offset:16384
    v_mfma_f32_16x16x32_bf16 v[48:51], v[148:151], v[176:179], v[48:51]
    ds_read_b64_tr_b16 v[138:139], v190 offset:16896
    v_mfma_f32_16x16x32_bf16 v[52:55], v[148:151], v[180:183], v[52:55]
    ds_read_b64_tr_b16 v[140:141], v191 offset:16384
    v_mfma_f32_16x16x32_bf16 v[56:59], v[160:163], v[152:155], v[56:59]
    ds_read_b64_tr_b16 v[142:143], v191 offset:16896
    v_mfma_f32_16x16x32_bf16 v[60:63], v[164:167], v[152:155], v[60:63]
    ds_read_b128 v[108:111], v188 offset:2048
    v_mfma_f32_16x16x32_bf16 v[64:67], v[168:171], v[152:155], v[64:67]
    ds_read_b128 v[112:115], v188 offset:4096
    v_mfma_f32_16x16x32_bf16 v[68:71], v[172:175], v[152:155], v[68:71]
    ds_read_b128 v[116:119], v188 offset:6144
    v_mfma_f32_16x16x32_bf16 v[72:75], v[152:155], v[176:179], v[72:75]
    v_mfma_f32_16x16x32_bf16 v[76:79], v[152:155], v[180:183], v[76:79]
    v_mfma_f32_16x16x32_bf16 v[80:83], v[160:163], v[156:159], v[80:83]
    v_mfma_f32_16x16x32_bf16 v[84:87], v[164:167], v[156:159], v[84:87]
    v_mfma_f32_16x16x32_bf16 v[88:91], v[168:171], v[156:159], v[88:91]
    v_mfma_f32_16x16x32_bf16 v[92:95], v[172:175], v[156:159], v[92:95]
    v_mfma_f32_16x16x32_bf16 v[96:99], v[156:159], v[176:179], v[96:99]
    v_mfma_f32_16x16x32_bf16 v[100:103], v[156:159], v[180:183], v[100:103]
    s_waitcnt lgkmcnt(0)
    s_nop 0
    v_mfma_f32_16x16x32_bf16 v[8:11], v[120:123], v[104:107], v[8:11]
    ds_read_b128 v[144:147], v189 offset:0
    v_mfma_f32_16x16x32_bf16 v[12:15], v[124:127], v[104:107], v[12:15]
    ds_read_b64_tr_b16 v[160:161], v190 offset:4096
    v_mfma_f32_16x16x32_bf16 v[16:19], v[128:131], v[104:107], v[16:19]
    ds_read_b64_tr_b16 v[162:163], v190 offset:4608
    v_mfma_f32_16x16x32_bf16 v[20:23], v[132:135], v[104:107], v[20:23]
    ds_read_b64_tr_b16 v[164:165], v191 offset:4096
    v_mfma_f32_16x16x32_bf16 v[24:27], v[104:107], v[136:139], v[24:27]
    ds_read_b64_tr_b16 v[166:167], v191 offset:4608
    v_mfma_f32_16x16x32_bf16 v[28:31], v[104:107], v[140:143], v[28:31]
    ds_read_b64_tr_b16 v[168:169], v190 offset:12288
    v_mfma_f32_16x16x32_bf16 v[32:35], v[120:123], v[108:111], v[32:35]
    ds_read_b64_tr_b16 v[170:171], v190 offset:12800
    v_mfma_f32_16x16x32_bf16 v[36:39], v[124:127], v[108:111], v[36:39]
    ds_read_b64_tr_b16 v[172:173], v191 offset:12288
    v_mfma_f32_16x16x32_bf16 v[40:43], v[128:131], v[108:111], v[40:43]
    ds_read_b64_tr_b16 v[174:175], v191 offset:12800
    v_mfma_f32_16x16x32_bf16 v[44:47], v[132:135], v[108:111], v[44:47]
    ds_read_b64_tr_b16 v[176:177], v190 offset:20480
    v_mfma_f32_16x16x32_bf16 v[48:51], v[108:111], v[136:139], v[48:51]
    ds_read_b64_tr_b16 v[178:179], v190 offset:20992
    v_mfma_f32_16x16x32_bf16 v[52:55], v[108:111], v[140:143], v[52:55]
    ds_read_b64_tr_b16 v[180:181], v191 offset:20480
    v_mfma_f32_16x16x32_bf16 v[56:59], v[120:123], v[112:115], v[56:59]
    ds_read_b64_tr_b16 v[182:183], v191 offset:20992
    v_mfma_f32_16x16x32_bf16 v[60:63], v[124:127], v[112:115], v[60:63]
    ds_read_b128 v[148:151], v189 offset:2048
    v_mfma_f32_16x16x32_bf16 v[64:67], v[128:131], v[112:115], v[64:67]
    ds_read_b128 v[152:155], v189 offset:4096
    v_mfma_f32_16x16x32_bf16 v[68:71], v[132:135], v[112:115], v[68:71]
    ds_read_b128 v[156:159], v189 offset:6144
    v_mfma_f32_16x16x32_bf16 v[72:75], v[112:115], v[136:139], v[72:75]
    s_add_u32 s66, s66, 1
    s_cmp_lt_u32 s66, 5
    v_mfma_f32_16x16x32_bf16 v[76:79], v[112:115], v[140:143], v[76:79]
    v_mfma_f32_16x16x32_bf16 v[80:83], v[120:123], v[116:119], v[80:83]
    v_mfma_f32_16x16x32_bf16 v[84:87], v[124:127], v[116:119], v[84:87]
    v_mfma_f32_16x16x32_bf16 v[88:91], v[128:131], v[116:119], v[88:91]
    v_mfma_f32_16x16x32_bf16 v[92:95], v[132:135], v[116:119], v[92:95]
    v_mfma_f32_16x16x32_bf16 v[96:99], v[116:119], v[136:139], v[96:99]
    v_mfma_f32_16x16x32_bf16 v[100:103], v[116:119], v[140:143], v[100:103]
    s_cbranch_scc1 L_cloop
    s_nop 0
    s_waitcnt lgkmcnt(0)
    s_barrier
    v_mfma_f32_16x16x32_bf16 v[8:11], v[160:163], v[144:147], v[8:11]
    ds_read_b128 v[104:107], v184 offset:0
    v_mfma_f32_16x16x32_bf16 v[12:15], v[164:167], v[144:147], v[12:15]
    ds_read_b64_tr_b16 v[120:121], v186 offset:0
    v_mfma_f32_16x16x32_bf16 v[16:19], v[168:171], v[144:147], v[16:19]
    ds_read_b64_tr_b16 v[122:123], v186 offset:512
    v_mfma_f32_16x16x32_bf16 v[20:23], v[172:175], v[144:147], v[20:23]
    ds_read_b64_tr_b16 v[124:125], v187 offset:0
    v_mfma_f32_16x16x32_bf16 v[24:27], v[144:147], v[176:179], v[24:27]
    ds_read_b64_tr_b16 v[126:127], v187 offset:512
    v_mfma_f32_16x16x32_bf16 v[28:31], v[144:147], v[180:183], v[28:31]
    ds_read_b64_tr_b16 v[128:129], v186 offset:8192
    v_mfma_f32_16x16x32_bf16 v[32:35], v[160:163], v[148:151], v[32:35]
    ds_read_b64_tr_b16 v[130:131], v186 offset:8704
    v_mfma_f32_16x16x32_bf16 v[36:39], v[164:167], v[148:151], v[36:39]
    ds_read_b64_tr_b16 v[132:133], v187 offset:8192
    v_mfma_f32_16x16x32_bf16 v[40:43], v[168:171], v[148:151], v[40:43]
    ds_read_b64_tr_b16 v[134:135], v187 offset:8704
    v_mfma_f32_16x16x32_bf16 v[44:47], v[172:175], v[148:151], v[44:47]
    ds_read_b64_tr_b16 v[136:137], v186 offset:16384
    v_mfma_f32_16x16x32_bf16 v[48:51], v[148:151], v[176:179], v[48:51]
    ds_read_b64_tr_b16 v[138:139], v186 offset:16896
    v_mfma_f32_16x16x32_bf16 v[52:55], v[148:151], v[180:183], v[52:55]
    ds_read_b64_tr_b16 v[140:141], v187 offset:16384
    v_mfma_f32_16x16x32_bf16 v[56:59], v[160:163], v[152:155], v[56:59]
    ds_read_b64_tr_b16 v[142:143], v187 offset:16896
    v_mfma_f32_16x16x32_bf16 v[60:63], v[164:167], v[152:155], v[60:63]
    ds_read_b128 v[108:111], v184 offset:2048
    v_mfma_f32_16x16x32_bf16 v[64:67], v[168:171], v[152:155], v[64:67]
    ds_read_b128 v[112:115], v184 offset:4096
    v_mfma_f32_16x16x32_bf16 v[68:71], v[172:175], v[152:155], v[68:71]
    ds_read_b128 v[116:119], v184 offset:6144
    v_mfma_f32_16x16x32_bf16 v[72:75], v[152:155], v[176:179], v[72:75]
    ds_read_b32 v192, v232 offset:0
    v_mfma_f32_16x16x32_bf16 v[76:79], v[152:155], v[180:183], v[76:79]
    ds_read_b32 v194, v232 offset:64
    v_mfma_f32_16x16x32_bf16 v[80:83], v[160:163], v[156:159], v[80:83]
    ds_read_b32 v196, v232 offset:128
    v_mfma_f32_16x16x32_bf16 v[84:87], v[164:167], v[156:159], v[84:87]
    ds_read_b32 v198, v232 offset:192
    v_mfma_f32_16x16x32_bf16 v[88:91], v[168:171], v[156:159], v[88:91]
    ds_read_b128 v[204:207], v235 offset:256
    v_mfma_f32_16x16x32_bf16 v[92:95], v[172:175], v[156:159], v[92:95]
    ds_read_b128 v[208:211], v235 offset:320
    v_mfma_f32_16x16x32_bf16 v[96:99], v[156:159], v[176:179], v[96:99]
    ds_read_b128 v[212:215], v235 offset:0
    v_mfma_f32_16x16x32_bf16 v[100:103], v[156:159], v[180:183], v[100:103]
    ds_read_b128 v[216:219], v235 offset:64
    s_waitcnt lgkmcnt(8)
    s_nop 0
    v_mfma_f32_16x16x32_bf16 v[8:11], v[120:123], v[104:107], v[8:11]
    ds_read_b128 v[144:147], v185 offset:0
    v_mfma_f32_16x16x32_bf16 v[12:15], v[124:127], v[104:107], v[12:15]
    ds_read_b64_tr_b16 v[160:161], v186 offset:4096
    v_mfma_f32_16x16x32_bf16 v[16:19], v[128:131], v[104:107], v[16:19]
    ds_read_b64_tr_b16 v[162:163], v186 offset:4608
    v_mfma_f32_16x16x32_bf16 v[20:23], v[132:135], v[104:107], v[20:23]
    ds_read_b64_tr_b16 v[164:165], v187 offset:4096
    v_mfma_f32_16x16x32_bf16 v[24:27], v[104:107], v[136:139], v[24:27]
    ds_read_b64_tr_b16 v[166:167], v187 offset:4608
    v_mfma_f32_16x16x32_bf16 v[28:31], v[104:107], v[140:143], v[28:31]
    ds_read_b64_tr_b16 v[168:169], v186 offset:12288
    v_mfma_f32_16x16x32_bf16 v[32:35], v[120:123], v[108:111], v[32:35]
    ds_read_b64_tr_b16 v[170:171], v186 offset:12800
    v_mfma_f32_16x16x32_bf16 v[36:39], v[124:127], v[108:111], v[36:39]
    ds_read_b64_tr_b16 v[172:173], v187 offset:12288
    v_mfma_f32_16x16x32_bf16 v[40:43], v[128:131], v[108:111], v[40:43]
    ds_read_b64_tr_b16 v[174:175], v187 offset:12800
    v_mfma_f32_16x16x32_bf16 v[44:47], v[132:135], v[108:111], v[44:47]
    ds_read_b64_tr_b16 v[176:177], v186 offset:20480
    v_mfma_f32_16x16x32_bf16 v[48:51], v[108:111], v[136:139], v[48:51]
    ds_read_b64_tr_b16 v[178:179], v186 offset:20992
    v_mfma_f32_16x16x32_bf16 v[52:55], v[108:111], v[140:143], v[52:55]
    ds_read_b64_tr_b16 v[180:181], v187 offset:20480
    v_mfma_f32_16x16x32_bf16 v[56:59], v[120:123], v[112:115], v[56:59]
    ds_read_b64_tr_b16 v[182:183], v187 offset:20992
    v_mfma_f32_16x16x32_bf16 v[60:63], v[124:127], v[112:115], v[60:63]
    ds_read_b128 v[148:151], v185 offset:2048
    v_mfma_f32_16x16x32_bf16 v[64:67], v[128:131], v[112:115], v[64:67]
    ds_read_b128 v[152:155], v185 offset:4096
    v_mfma_f32_16x16x32_bf16 v[68:71], v[132:135], v[112:115], v[68:71]
    ds_read_b128 v[156:159], v185 offset:6144
    v_mfma_f32_16x16x32_bf16 v[72:75], v[112:115], v[136:139], v[72:75]
    ds_read_b64_tr_b16 v[224:225], v252 offset:0
    v_mfma_f32_16x16x32_bf16 v[76:79], v[112:115], v[140:143], v[76:79]
    ds_read_b64_tr_b16 v[226:227], v252 offset:1024
    v_mfma_f32_16x16x32_bf16 v[80:83], v[120:123], v[116:119], v[80:83]
    ds_read_b64_tr_b16 v[228:229], v252 offset:32
    v_mfma_f32_16x16x32_bf16 v[84:87], v[124:127], v[116:119], v[84:87]
    ds_read_b64_tr_b16 v[230:231], v252 offset:1056
    v_mfma_f32_16x16x32_bf16 v[88:91], v[128:131], v[116:119], v[88:91]
    v_mfma_f32_16x16x32_bf16 v[92:95], v[132:135], v[116:119], v[92:95]
    v_mfma_f32_16x16x32_bf16 v[96:99], v[116:119], v[136:139], v[96:99]
    v_mfma_f32_16x16x32_bf16 v[100:103], v[116:119], v[140:143], v[100:103]
    s_waitcnt lgkmcnt(4)
    v_mfma_f32_16x16x32_bf16 v[16:19], v[168:171], v[144:147], v[16:19]
    s_barrier
    v_mfma_f32_16x16x32_bf16 v[20:23], v[172:175], v[144:147], v[20:23]
    ds_read_b128 v[104:107], v233 offset:0
    ds_read_b128 v[108:111], v233 offset:64
    v_mfma_f32_16x16x32_bf16 v[40:43], v[168:171], v[148:151], v[40:43]
    ds_read_b128 v[112:115], v233 offset:128
    ds_read_b128 v[116:119], v233 offset:192
    v_mfma_f32_16x16x32_bf16 v[44:47], v[172:175], v[148:151], v[44:47]
    ds_read_b32 v250, v248 offset:576
    ds_read_b32 v248, v248 offset:512
    v_mfma_f32_16x16x32_bf16 v[64:67], v[168:171], v[152:155], v[64:67]
    ds_read_b32 v200, v232 offset:2048
    ds_read_b32 v202, v232 offset:2112
    v_mfma_f32_16x16x32_bf16 v[68:71], v[172:175], v[152:155], v[68:71]
    ds_read_b32 v220, v232 offset:2176
    ds_read_b32 v222, v232 offset:2240
    v_mfma_f32_16x16x32_bf16 v[88:91], v[168:171], v[156:159], v[88:91]
    ds_read_b32 v193, v234 offset:2048
    ds_read_b32 v195, v234 offset:1024
    v_mfma_f32_16x16x32_bf16 v[92:95], v[172:175], v[156:159], v[92:95]
    ds_read_b32 v221, v234 offset:2176
    ds_read_b32 v223, v234 offset:1152
    v_mfma_f32_16x16x32_bf16 v[24:27], v[144:147], v[176:179], v[24:27]
    v_fma_f32 v16, -v192, v204, v16
    v_fma_f32 v17, -v192, v205, v17
    v_fma_f32 v18, -v192, v206, v18
    v_mfma_f32_16x16x32_bf16 v[28:31], v[144:147], v[180:183], v[28:31]
    v_fma_f32 v19, -v192, v207, v19
    v_fma_f32 v20, -v192, v208, v20
    v_fma_f32 v21, -v192, v209, v21
    v_mfma_f32_16x16x32_bf16 v[48:51], v[148:151], v[176:179], v[48:51]
    v_fma_f32 v22, -v192, v210, v22
    v_fma_f32 v23, -v192, v211, v23
    v_cvt_pk_bf16_f32 v16, v16, v17
    v_mfma_f32_16x16x32_bf16 v[52:55], v[148:151], v[180:183], v[52:55]
    v_cvt_pk_bf16_f32 v17, v18, v19
    v_cvt_pk_bf16_f32 v18, v20, v21
    v_cvt_pk_bf16_f32 v19, v22, v23
    v_mfma_f32_16x16x32_bf16 v[72:75], v[152:155], v[176:179], v[72:75]
    v_fma_f32 v40, -v194, v204, v40
    v_fma_f32 v41, -v194, v205, v41
    v_fma_f32 v42, -v194, v206, v42
    v_mfma_f32_16x16x32_bf16 v[76:79], v[152:155], v[180:183], v[76:79]
    v_fma_f32 v43, -v194, v207, v43
    v_fma_f32 v44, -v194, v208, v44
    v_fma_f32 v45, -v194, v209, v45
    v_mfma_f32_16x16x32_bf16 v[96:99], v[156:159], v[176:179], v[96:99]
    v_fma_f32 v46, -v194, v210, v46
    v_fma_f32 v47, -v194, v211, v47
    v_cvt_pk_bf16_f32 v40, v40, v41
    v_mfma_f32_16x16x32_bf16 v[100:103], v[156:159], v[180:183], v[100:103]
    v_cvt_pk_bf16_f32 v41, v42, v43
    v_cvt_pk_bf16_f32 v42, v44, v45
    v_cvt_pk_bf16_f32 v43, v46, v47
    v_mfma_f32_16x16x32_bf16 v[8:11], v[160:163], v[144:147], v[8:11]
    v_fma_f32 v64, -v196, v204, v64
    v_fma_f32 v65, -v196, v205, v65
    v_fma_f32 v66, -v196, v206, v66
    v_mfma_f32_16x16x32_bf16 v[12:15], v[164:167], v[144:147], v[12:15]
    v_fma_f32 v67, -v196, v207, v67
    v_fma_f32 v68, -v196, v208, v68
    v_fma_f32 v69, -v196, v209, v69
    v_mfma_f32_16x16x32_bf16 v[32:35], v[160:163], v[148:151], v[32:35]
    v_fma_f32 v70, -v196, v210, v70
    v_fma_f32 v71, -v196, v211, v71
    v_cvt_pk_bf16_f32 v64, v64, v65
    v_mfma_f32_16x16x32_bf16 v[36:39], v[164:167], v[148:151], v[36:39]
    v_cvt_pk_bf16_f32 v65, v66, v67
    v_cvt_pk_bf16_f32 v66, v68, v69
    v_cvt_pk_bf16_f32 v67, v70, v71
    v_mfma_f32_16x16x32_bf16 v[56:59], v[160:163], v[152:155], v[56:59]
    v_fma_f32 v88, -v198, v204, v88
    v_fma_f32 v89, -v198, v205, v89
    v_fma_f32 v90, -v198, v206, v90
    v_mfma_f32_16x16x32_bf16 v[60:63], v[164:167], v[152:155], v[60:63]
    v_fma_f32 v91, -v198, v207, v91
    v_fma_f32 v92, -v198, v208, v92
    v_fma_f32 v93, -v198, v209, v93
    v_mfma_f32_16x16x32_bf16 v[80:83], v[160:163], v[156:159], v[80:83]
    v_fma_f32 v94, -v198, v210, v94
    v_fma_f32 v95, -v198, v211, v95
    v_cvt_pk_bf16_f32 v88, v88, v89
    v_mfma_f32_16x16x32_bf16 v[84:87], v[164:167], v[156:159], v[84:87]
    v_cvt_pk_bf16_f32 v89, v90, v91
    v_cvt_pk_bf16_f32 v90, v92, v93
    v_cvt_pk_bf16_f32 v91, v94, v95
    ds_read_b128 v[120:123], v249 offset:0
    ds_read_b128 v[124:127], v249 offset:64
    s_waitcnt lgkmcnt(2)
    s_nop 0
    v_mfma_f32_16x16x32_bf16 v[144:147], v[224:227], v[16:19], 0
    v_mfma_f32_16x16x32_bf16 v[148:151], v[228:231], v[16:19], 0
    v_mfma_f32_16x16x32_bf16 v[152:155], v[224:227], v[40:43], 0
    v_mfma_f32_16x16x32_bf16 v[156:159], v[228:231], v[40:43], 0
    v_mfma_f32_16x16x32_bf16 v[160:163], v[224:227], v[64:67], 0
    v_mfma_f32_16x16x32_bf16 v[164:167], v[228:231], v[64:67], 0
    v_mfma_f32_16x16x32_bf16 v[168:171], v[224:227], v[88:91], 0
    v_mfma_f32_16x16x32_bf16 v[172:175], v[228:231], v[88:91], 0
    v_pk_fma_f32 v[24:25], v[104:105], v[248:249], v[24:25] op_sel_hi:[1,0,1] neg_lo:[1,0,0] neg_hi:[1,0,0]
    v_pk_fma_f32 v[26:27], v[106:107], v[248:249], v[26:27] op_sel_hi:[1,0,1] neg_lo:[1,0,0] neg_hi:[1,0,0]
    v_pk_fma_f32 v[28:29], v[104:105], v[250:251], v[28:29] op_sel_hi:[1,0,1] neg_lo:[1,0,0] neg_hi:[1,0,0]
    v_pk_fma_f32 v[30:31], v[106:107], v[250:251], v[30:31] op_sel_hi:[1,0,1] neg_lo:[1,0,0] neg_hi:[1,0,0]
    v_pk_fma_f32 v[48:49], v[108:109], v[248:249], v[48:49] op_sel_hi:[1,0,1] neg_lo:[1,0,0] neg_hi:[1,0,0]
    v_pk_fma_f32 v[50:51], v[110:111], v[248:249], v[50:51] op_sel_hi:[1,0,1] neg_lo:[1,0,0] neg_hi:[1,0,0]
    v_pk_fma_f32 v[52:53], v[108:109], v[250:251], v[52:53] op_sel_hi:[1,0,1] neg_lo:[1,0,0] neg_hi:[1,0,0]
    v_pk_fma_f32 v[54:55], v[110:111], v[250:251], v[54:55] op_sel_hi:[1,0,1] neg_lo:[1,0,0] neg_hi:[1,0,0]
    v_pk_fma_f32 v[72:73], v[112:113], v[248:249], v[72:73] op_sel_hi:[1,0,1] neg_lo:[1,0,0] neg_hi:[1,0,0]
    v_pk_fma_f32 v[74:75], v[114:115], v[248:249], v[74:75] op_sel_hi:[1,0,1] neg_lo:[1,0,0] neg_hi:[1,0,0]
    v_pk_fma_f32 v[76:77], v[112:113], v[250:251], v[76:77] op_sel_hi:[1,0,1] neg_lo:[1,0,0] neg_hi:[1,0,0]
    v_pk_fma_f32 v[78:79], v[114:115], v[250:251], v[78:79] op_sel_hi:[1,0,1] neg_lo:[1,0,0] neg_hi:[1,0,0]
    v_pk_fma_f32 v[96:97], v[116:117], v[248:249], v[96:97] op_sel_hi:[1,0,1] neg_lo:[1,0,0] neg_hi:[1,0,0]
    v_pk_fma_f32 v[98:99], v[118:119], v[248:249], v[98:99] op_sel_hi:[1,0,1] neg_lo:[1,0,0] neg_hi:[1,0,0]
    v_pk_fma_f32 v[100:101], v[116:117], v[250:251], v[100:101] op_sel_hi:[1,0,1] neg_lo:[1,0,0] neg_hi:[1,0,0]
    v_pk_fma_f32 v[102:103], v[118:119], v[250:251], v[102:103] op_sel_hi:[1,0,1] neg_lo:[1,0,0] neg_hi:[1,0,0]
    v_cvt_pk_bf16_f32 v24, v24, v25
    v_cvt_pk_bf16_f32 v25, v26, v27
    v_cvt_pk_bf16_f32 v26, v48, v49
    v_cvt_pk_bf16_f32 v27, v50, v51
    v_cvt_pk_bf16_f32 v28, v28, v29
    v_cvt_pk_bf16_f32 v29, v30, v31
    v_cvt_pk_bf16_f32 v30, v52, v53
    v_cvt_pk_bf16_f32 v31, v54, v55
    v_cvt_pk_bf16_f32 v72, v72, v73
    v_cvt_pk_bf16_f32 v73, v74, v75
    v_cvt_pk_bf16_f32 v74, v96, v97
    v_cvt_pk_bf16_f32 v75, v98, v99
    v_cvt_pk_bf16_f32 v76, v76, v77
    v_cvt_pk_bf16_f32 v77, v78, v79
    v_cvt_pk_bf16_f32 v78, v100, v101
    v_cvt_pk_bf16_f32 v79, v102, v103
    ds_read_b128 v[104:107], v253 offset:0
    ds_read_b128 v[108:111], v253 offset:64
    v_max3_f32 v176, v144, v145, v146
    v_max3_f32 v184, -v144, -v145, -v146
    v_max3_f32 v178, v152, v153, v154
    v_max3_f32 v186, -v152, -v153, -v154
    v_max3_f32 v176, v176, v147, v148
    v_max3_f32 v184, v184, -v147, -v148
    v_max3_f32 v178, v178, v155, v156
    v_max3_f32 v186, v186, -v155, -v156
    v_max3_f32 v176, v176, v149, v150
    v_max3_f32 v184, v184, -v149, -v150
    v_max3_f32 v178, v178, v157, v158
    v_max3_f32 v186, v186, -v157, -v158
    v_max_f32_e64 v176, v176, v151
    v_max_f32_e64 v184, v184, -v151
    v_max_f32_e64 v178, v178, v159
    v_max_f32_e64 v186, v186, -v159
    s_nop 0
    v_permlane32_swap_b32 v176, v178
    v_permlane32_swap_b32_e64 v184, v186
    v_max3_f32 v180, v160, v161, v162
    v_max3_f32 v188, -v160, -v161, -v162
    v_max_f32 v176, v176, v178
    v_max_f32 v184, v184, v186
    v_max3_f32 v182, v168, v169, v170
    v_max3_f32 v190, -v168, -v169, -v170
    v_permlane16_swap_b32 v176, v184
    v_max_f32 v176, v176, v184
    v_max3_f32 v180, v180, v163, v164
    v_max3_f32 v188, v188, -v163, -v164
    v_mul_f32 v184, v176, v193
    v_mul_f32 v176, v176, v193
    v_max3_f32 v182, v182, v171, v172
    v_max3_f32 v190, v190, -v171, -v172
    v_permlane16_swap_b32 v176, v184
    v_mov_b32 v178, v176
    v_max3_f32 v180, v180, v165, v166
    v_max3_f32 v188, v188, -v165, -v166
    v_mov_b32_e64 v186, v184
    v_max3_f32 v182, v182, v173, v174
    v_max3_f32 v190, v190, -v173, -v174
    v_permlane32_swap_b32 v176, v178
    v_permlane32_swap_b32 v184, v186
    v_max_f32_e64 v180, v180, v167
    v_max_f32_e64 v188, v188, -v167
    v_max_f32_e64 v182, v182, v175
    v_max_f32_e64 v190, v190, -v175
    s_nop 0
    v_permlane32_swap_b32 v180, v182
    v_permlane32_swap_b32_e64 v188, v190
    v_pk_fma_f32 v[16:17], v[144:145], v[200:201], v[184:185] op_sel_hi:[1,0,0] neg_lo:[1,0,1] neg_hi:[1,0,1]
    v_pk_fma_f32 v[144:145], v[144:145], v[200:201], v[176:177] op_sel_hi:[1,0,0] neg_lo:[0,0,1] neg_hi:[0,0,1]
    v_max_f32 v180, v180, v182
    v_max_f32 v188, v188, v190
    v_pk_fma_f32 v[18:19], v[146:147], v[200:201], v[184:185] op_sel_hi:[1,0,0] neg_lo:[1,0,1] neg_hi:[1,0,1]
    v_pk_fma_f32 v[146:147], v[146:147], v[200:201], v[176:177] op_sel_hi:[1,0,0] neg_lo:[0,0,1] neg_hi:[0,0,1]
    v_permlane16_swap_b32 v180, v188
    v_max_f32 v180, v180, v188
    v_pk_fma_f32 v[20:21], v[148:149], v[200:201], v[184:185] op_sel_hi:[1,0,0] neg_lo:[1,0,1] neg_hi:[1,0,1]
    v_pk_fma_f32 v[148:149], v[148:149], v[200:201], v[176:177] op_sel_hi:[1,0,0] neg_lo:[0,0,1] neg_hi:[0,0,1]
    v_mul_f32 v188, v180, v221
    v_mul_f32 v180, v180, v221
    v_pk_fma_f32 v[22:23], v[150:151], v[200:201], v[184:185] op_sel_hi:[1,0,0] neg_lo:[1,0,1] neg_hi:[1,0,1]
    v_pk_fma_f32 v[150:151], v[150:151], v[200:201], v[176:177] op_sel_hi:[1,0,0] neg_lo:[0,0,1] neg_hi:[0,0,1]
    v_permlane16_swap_b32 v180, v188
    v_mov_b32 v182, v180
    v_pk_fma_f32 v[40:41], v[152:153], v[202:203], v[186:187] op_sel_hi:[1,0,0] neg_lo:[1,0,1] neg_hi:[1,0,1]
    v_pk_fma_f32 v[152:153], v[152:153], v[202:203], v[178:179] op_sel_hi:[1,0,0] neg_lo:[0,0,1] neg_hi:[0,0,1]
    v_mov_b32_e64 v190, v188
    v_pk_fma_f32 v[42:43], v[154:155], v[202:203], v[186:187] op_sel_hi:[1,0,0] neg_lo:[1,0,1] neg_hi:[1,0,1]
    v_pk_fma_f32 v[154:155], v[154:155], v[202:203], v[178:179] op_sel_hi:[1,0,0] neg_lo:[0,0,1] neg_hi:[0,0,1]
    v_permlane32_swap_b32 v180, v182
    v_permlane32_swap_b32 v188, v190
    v_pk_fma_f32 v[44:45], v[156:157], v[202:203], v[186:187] op_sel_hi:[1,0,0] neg_lo:[1,0,1] neg_hi:[1,0,1]
    v_pk_fma_f32 v[156:157], v[156:157], v[202:203], v[178:179] op_sel_hi:[1,0,0] neg_lo:[0,0,1] neg_hi:[0,0,1]
    v_pk_fma_f32 v[46:47], v[158:159], v[202:203], v[186:187] op_sel_hi:[1,0,0] neg_lo:[1,0,1] neg_hi:[1,0,1]
    v_pk_fma_f32 v[158:159], v[158:159], v[202:203], v[178:179] op_sel_hi:[1,0,0] neg_lo:[0,0,1] neg_hi:[0,0,1]
    v_exp_f32 v16, v16
    v_exp_f32 v144, v144
    v_exp_f32 v17, v17
    v_exp_f32 v145, v145
    v_exp_f32 v18, v18
    v_exp_f32 v146, v146
    v_exp_f32 v19, v19
    v_exp_f32 v147, v147
    v_exp_f32 v20, v20
    v_exp_f32 v148, v148
    v_exp_f32 v21, v21
    v_exp_f32 v149, v149
    v_exp_f32 v22, v22
    v_exp_f32 v150, v150
    v_exp_f32 v23, v23
    v_exp_f32 v151, v151
    v_exp_f32 v40, v40
    v_exp_f32 v152, v152
    v_exp_f32 v41, v41
    v_exp_f32 v153, v153
    v_exp_f32 v42, v42
    v_exp_f32 v154, v154
    v_exp_f32 v43, v43
    v_exp_f32 v155, v155
    v_exp_f32 v44, v44
    v_exp_f32 v156, v156
    v_exp_f32 v45, v45
    v_exp_f32 v157, v157
    v_exp_f32 v46, v46
    v_exp_f32 v158, v158
    v_exp_f32 v47, v47
    v_exp_f32 v159, v159
    v_pk_add_f32 v[128:129], v[144:145], v[146:147]
    v_pk_add_f32 v[130:131], v[16:17], v[18:19]
    v_pk_add_f32 v[132:133], v[152:153], v[154:155]
    v_pk_add_f32 v[134:135], v[40:41], v[42:43]
    v_pk_add_f32 v[128:129], v[128:129], v[148:149]
    v_pk_add_f32 v[130:131], v[130:131], v[20:21]
    v_pk_add_f32 v[132:133], v[132:133], v[156:157]
    v_pk_add_f32 v[134:135], v[134:135], v[44:45]
    v_pk_add_f32 v[128:129], v[128:129], v[150:151]
    v_pk_add_f32 v[130:131], v[130:131], v[22:23]
    v_pk_add_f32 v[132:133], v[132:133], v[158:159]
    v_pk_add_f32 v[134:135], v[134:135], v[46:47]
    v_add_f32 v176, v128, v129
    v_add_f32 v184, v130, v131
    v_add_f32 v178, v132, v133
    v_add_f32 v186, v134, v135
    s_nop 0
    v_permlane32_swap_b32 v176, v178
    v_permlane32_swap_b32_e64 v184, v186
    v_pk_fma_f32 v[64:65], v[160:161], v[220:221], v[188:189] op_sel_hi:[1,0,0] neg_lo:[1,0,1] neg_hi:[1,0,1]
    v_pk_fma_f32 v[160:161], v[160:161], v[220:221], v[180:181] op_sel_hi:[1,0,0] neg_lo:[0,0,1] neg_hi:[0,0,1]
    v_add_f32 v176, v176, v178
    v_add_f32 v184, v184, v186
    v_pk_fma_f32 v[66:67], v[162:163], v[220:221], v[188:189] op_sel_hi:[1,0,0] neg_lo:[1,0,1] neg_hi:[1,0,1]
    v_pk_fma_f32 v[162:163], v[162:163], v[220:221], v[180:181] op_sel_hi:[1,0,0] neg_lo:[0,0,1] neg_hi:[0,0,1]
    v_permlane16_swap_b32 v176, v184
    v_add_f32 v176, v176, v184
    v_pk_fma_f32 v[68:69], v[164:165], v[220:221], v[188:189] op_sel_hi:[1,0,0] neg_lo:[1,0,1] neg_hi:[1,0,1]
    v_pk_fma_f32 v[164:165], v[164:165], v[220:221], v[180:181] op_sel_hi:[1,0,0] neg_lo:[0,0,1] neg_hi:[0,0,1]
    v_rcp_f32_e64 v176, v176
    v_pk_fma_f32 v[70:71], v[166:167], v[220:221], v[188:189] op_sel_hi:[1,0,0] neg_lo:[1,0,1] neg_hi:[1,0,1]
    v_pk_fma_f32 v[166:167], v[166:167], v[220:221], v[180:181] op_sel_hi:[1,0,0] neg_lo:[0,0,1] neg_hi:[0,0,1]
    v_mul_f32 v184, v176, v195
    v_mul_f32 v176, v176, v195
    v_pk_fma_f32 v[88:89], v[168:169], v[222:223], v[190:191] op_sel_hi:[1,0,0] neg_lo:[1,0,1] neg_hi:[1,0,1]
    v_pk_fma_f32 v[168:169], v[168:169], v[222:223], v[182:183] op_sel_hi:[1,0,0] neg_lo:[0,0,1] neg_hi:[0,0,1]
    v_permlane16_swap_b32 v176, v184
    v_mov_b32 v178, v176
    v_pk_fma_f32 v[90:91], v[170:171], v[222:223], v[190:191] op_sel_hi:[1,0,0] neg_lo:[1,0,1] neg_hi:[1,0,1]
    v_pk_fma_f32 v[170:171], v[170:171], v[222:223], v[182:183] op_sel_hi:[1,0,0] neg_lo:[0,0,1] neg_hi:[0,0,1]
    v_mov_b32_e64 v186, v184
    v_pk_fma_f32 v[92:93], v[172:173], v[222:223], v[190:191] op_sel_hi:[1,0,0] neg_lo:[1,0,1] neg_hi:[1,0,1]
    v_pk_fma_f32 v[172:173], v[172:173], v[222:223], v[182:183] op_sel_hi:[1,0,0] neg_lo:[0,0,1] neg_hi:[0,0,1]
    v_permlane32_swap_b32 v176, v178
    v_permlane32_swap_b32 v184, v186
    v_pk_fma_f32 v[94:95], v[174:175], v[222:223], v[190:191] op_sel_hi:[1,0,0] neg_lo:[1,0,1] neg_hi:[1,0,1]
    v_pk_fma_f32 v[174:175], v[174:175], v[222:223], v[182:183] op_sel_hi:[1,0,0] neg_lo:[0,0,1] neg_hi:[0,0,1]
    v_pk_mul_f32 v[144:145], v[144:145], v[176:177] op_sel_hi:[1,0]
    v_pk_mul_f32 v[146:147], v[146:147], v[176:177] op_sel_hi:[1,0]
    v_pk_mul_f32 v[148:149], v[148:149], v[176:177] op_sel_hi:[1,0]
    v_pk_mul_f32 v[150:151], v[150:151], v[176:177] op_sel_hi:[1,0]
    v_cvt_pk_bf16_f32 v144, v144, v145
    v_cvt_pk_bf16_f32 v145, v146, v147
    v_cvt_pk_bf16_f32 v146, v148, v149
    v_cvt_pk_bf16_f32 v147, v150, v151
    ds_write_b64 v4, v[144:145] offset:0
    ds_write_b64 v5, v[146:147] offset:0
    ds_write_b128 v197, v[24:27] offset:0
    v_pk_mul_f32 v[16:17], v[16:17], v[184:185] op_sel_hi:[1,0]
    v_pk_mul_f32 v[18:19], v[18:19], v[184:185] op_sel_hi:[1,0]
    v_pk_mul_f32 v[20:21], v[20:21], v[184:185] op_sel_hi:[1,0]
    v_pk_mul_f32 v[22:23], v[22:23], v[184:185] op_sel_hi:[1,0]
    v_cvt_pk_bf16_f32 v16, v16, v17
    v_cvt_pk_bf16_f32 v17, v18, v19
    v_cvt_pk_bf16_f32 v18, v20, v21
    v_cvt_pk_bf16_f32 v19, v22, v23
    ds_write_b64 v6, v[16:17] offset:0
    ds_write_b64 v7, v[18:19] offset:0
    ds_write_b128 v197, v[28:31] offset:1024
    v_pk_mul_f32 v[152:153], v[152:153], v[178:179] op_sel_hi:[1,0]
    v_pk_mul_f32 v[154:155], v[154:155], v[178:179] op_sel_hi:[1,0]
    v_pk_mul_f32 v[156:157], v[156:157], v[178:179] op_sel_hi:[1,0]
    v_pk_mul_f32 v[158:159], v[158:159], v[178:179] op_sel_hi:[1,0]
    v_cvt_pk_bf16_f32 v152, v152, v153
    v_cvt_pk_bf16_f32 v153, v154, v155
    v_cvt_pk_bf16_f32 v154, v156, v157
    v_cvt_pk_bf16_f32 v155, v158, v159
    ds_write_b64 v4, v[152:153] offset:2048
    ds_write_b64 v5, v[154:155] offset:2048
    ds_write_b128 v197, v[72:75] offset:2048
    v_pk_mul_f32 v[40:41], v[40:41], v[186:187] op_sel_hi:[1,0]
    v_pk_mul_f32 v[42:43], v[42:43], v[186:187] op_sel_hi:[1,0]
    v_pk_mul_f32 v[44:45], v[44:45], v[186:187] op_sel_hi:[1,0]
    v_pk_mul_f32 v[46:47], v[46:47], v[186:187] op_sel_hi:[1,0]
    v_cvt_pk_bf16_f32 v40, v40, v41
    v_cvt_pk_bf16_f32 v41, v42, v43
    v_cvt_pk_bf16_f32 v42, v44, v45
    v_cvt_pk_bf16_f32 v43, v46, v47
    ds_write_b64 v6, v[40:41] offset:2048
    ds_write_b64 v7, v[42:43] offset:2048
    ds_write_b128 v197, v[76:79] offset:3072
    ds_read_b64_tr_b16 v[232:233], v201 offset:0
    ds_read_b64_tr_b16 v[234:235], v201 offset:2048
    ds_read_b64_tr_b16 v[236:237], v203 offset:0
    ds_read_b64_tr_b16 v[238:239], v203 offset:2048
    v_exp_f32 v64, v64
    v_exp_f32 v160, v160
    v_exp_f32 v65, v65
    v_exp_f32 v161, v161
    v_exp_f32 v66, v66
    v_exp_f32 v162, v162
    v_exp_f32 v67, v67
    v_exp_f32 v163, v163
    v_exp_f32 v68, v68
    v_exp_f32 v164, v164
    v_exp_f32 v69, v69
    v_exp_f32 v165, v165
    v_exp_f32 v70, v70
    v_exp_f32 v166, v166
    v_exp_f32 v71, v71
    v_exp_f32 v167, v167
    v_exp_f32 v88, v88
    v_exp_f32 v168, v168
    v_exp_f32 v89, v89
    v_exp_f32 v169, v169
    v_exp_f32 v90, v90
    v_exp_f32 v170, v170
    v_exp_f32 v91, v91
    v_exp_f32 v171, v171
    v_exp_f32 v92, v92
    v_exp_f32 v172, v172
    v_exp_f32 v93, v93
    v_exp_f32 v173, v173
    v_exp_f32 v94, v94
    v_exp_f32 v174, v174
    v_exp_f32 v95, v95
    v_exp_f32 v175, v175
    s_mov_b64 exec, 1
    buffer_store_dword v251, v199, s[48:51], s76 offen sc1
    s_mov_b64 exec, -1
    v_pk_add_f32 v[136:137], v[160:161], v[162:163]
    v_pk_add_f32 v[138:139], v[64:65], v[66:67]
    v_pk_add_f32 v[140:141], v[168:169], v[170:171]
    v_pk_add_f32 v[142:143], v[88:89], v[90:91]
    v_pk_add_f32 v[136:137], v[136:137], v[164:165]
    v_pk_add_f32 v[138:139], v[138:139], v[68:69]
    v_pk_add_f32 v[140:141], v[140:141], v[172:173]
    v_pk_add_f32 v[142:143], v[142:143], v[92:93]
    v_pk_add_f32 v[136:137], v[136:137], v[166:167]
    v_pk_add_f32 v[138:139], v[138:139], v[70:71]
    v_pk_add_f32 v[140:141], v[140:141], v[174:175]
    v_pk_add_f32 v[142:143], v[142:143], v[94:95]
    v_add_f32 v180, v136, v137
    v_add_f32 v188, v138, v139
    v_add_f32 v182, v140, v141
    v_add_f32 v190, v142, v143
    s_nop 0
    v_permlane32_swap_b32 v180, v182
    v_permlane32_swap_b32 v188, v190
    s_waitcnt lgkmcnt(0)
    s_nop 0
    v_mfma_f32_16x16x32_bf16 v[144:147], v[232:235], v[24:27], 0
    v_add_f32 v180, v180, v182
    v_add_f32 v188, v188, v190
    v_mfma_f32_16x16x32_bf16 v[148:151], v[236:239], v[24:27], 0
    s_nop 0
    v_permlane16_swap_b32 v180, v188
    v_add_f32 v180, v180, v188
    v_mfma_f32_16x16x32_bf16 v[152:155], v[232:235], v[28:31], 0
    v_rcp_f32_e64 v180, v180
    v_mfma_f32_16x16x32_bf16 v[156:159], v[236:239], v[28:31], 0
    v_mul_f32 v188, v180, v223
    v_mul_f32 v180, v180, v223
    v_mfma_f32_16x16x32_bf16 v[16:19], v[232:235], v[120:123], 0
    s_nop 0
    v_permlane16_swap_b32 v180, v188
    v_mov_b32_e64 v182, v180
    v_mfma_f32_16x16x32_bf16 v[20:23], v[236:239], v[120:123], 0
    v_mov_b32_e64 v190, v188
    v_permlane32_swap_b32 v180, v182
    s_nop 0
    v_permlane32_swap_b32_e64 v188, v190
    v_pk_mul_f32 v[160:161], v[160:161], v[180:181] op_sel_hi:[1,0]
    v_pk_mul_f32 v[162:163], v[162:163], v[180:181] op_sel_hi:[1,0]
    v_pk_mul_f32 v[164:165], v[164:165], v[180:181] op_sel_hi:[1,0]
    v_pk_mul_f32 v[166:167], v[166:167], v[180:181] op_sel_hi:[1,0]
    v_cvt_pk_bf16_f32 v160, v160, v161
    v_cvt_pk_bf16_f32 v161, v162, v163
    v_cvt_pk_bf16_f32 v162, v164, v165
    v_cvt_pk_bf16_f32 v163, v166, v167
    ds_write_b64 v4, v[160:161] offset:4096
    ds_write_b64 v5, v[162:163] offset:4096
    v_pk_mul_f32 v[64:65], v[64:65], v[188:189] op_sel_hi:[1,0]
    v_pk_mul_f32 v[66:67], v[66:67], v[188:189] op_sel_hi:[1,0]
    v_pk_mul_f32 v[68:69], v[68:69], v[188:189] op_sel_hi:[1,0]
    v_pk_mul_f32 v[70:71], v[70:71], v[188:189] op_sel_hi:[1,0]
    v_cvt_pk_bf16_f32 v64, v64, v65
    v_cvt_pk_bf16_f32 v65, v66, v67
    v_cvt_pk_bf16_f32 v66, v68, v69
    v_cvt_pk_bf16_f32 v67, v70, v71
    ds_write_b64 v6, v[64:65] offset:4096
    ds_write_b64 v7, v[66:67] offset:4096
    v_pk_mul_f32 v[168:169], v[168:169], v[182:183] op_sel_hi:[1,0]
    v_pk_mul_f32 v[170:171], v[170:171], v[182:183] op_sel_hi:[1,0]
    v_pk_mul_f32 v[172:173], v[172:173], v[182:183] op_sel_hi:[1,0]
    v_pk_mul_f32 v[174:175], v[174:175], v[182:183] op_sel_hi:[1,0]
    v_cvt_pk_bf16_f32 v168, v168, v169
    v_cvt_pk_bf16_f32 v169, v170, v171
    v_cvt_pk_bf16_f32 v170, v172, v173
    v_cvt_pk_bf16_f32 v171, v174, v175
    ds_write_b64 v4, v[168:169] offset:6144
    ds_write_b64 v5, v[170:171] offset:6144
    v_pk_mul_f32 v[88:89], v[88:89], v[190:191] op_sel_hi:[1,0]
    v_pk_mul_f32 v[90:91], v[90:91], v[190:191] op_sel_hi:[1,0]
    v_pk_mul_f32 v[92:93], v[92:93], v[190:191] op_sel_hi:[1,0]
    v_pk_mul_f32 v[94:95], v[94:95], v[190:191] op_sel_hi:[1,0]
    v_cvt_pk_bf16_f32 v88, v88, v89
    v_cvt_pk_bf16_f32 v89, v90, v91
    v_cvt_pk_bf16_f32 v90, v92, v93
    v_cvt_pk_bf16_f32 v91, v94, v95
    ds_write_b64 v6, v[88:89] offset:6144
    ds_write_b64 v7, v[90:91] offset:6144
    ds_read_b64_tr_b16 v[204:205], v201 offset:4096
    ds_read_b64_tr_b16 v[206:207], v201 offset:6144
    ds_read_b64_tr_b16 v[208:209], v203 offset:4096
    ds_read_b64_tr_b16 v[210:211], v203 offset:6144
    v_xor_b32 v201, 0x2000, v201
    v_xor_b32 v203, 0x2000, v203
    v_xor_b32 v197, 0x1000, v197
    s_waitcnt lgkmcnt(4)
    s_barrier
    ds_read_b64_tr_b16 v[128:129], v201 offset:0
    ds_read_b64_tr_b16 v[130:131], v201 offset:2048
    ds_read_b64_tr_b16 v[132:133], v203 offset:0
    ds_read_b64_tr_b16 v[134:135], v203 offset:2048
    ds_read_b128 v[48:51], v197 offset:0
    ds_read_b128 v[52:55], v197 offset:1024
    ds_read_b64_tr_b16 v[136:137], v201 offset:4096
    ds_read_b64_tr_b16 v[138:139], v201 offset:6144
    ds_read_b64_tr_b16 v[140:141], v203 offset:4096
    ds_read_b64_tr_b16 v[142:143], v203 offset:6144
    ds_read_b128 v[96:99], v197 offset:2048
    ds_read_b128 v[100:103], v197 offset:3072
    s_waitcnt lgkmcnt(12)
    s_nop 0
    v_mfma_f32_16x16x32_bf16 v[144:147], v[204:207], v[72:75], v[144:147]
    v_mfma_f32_16x16x32_bf16 v[148:151], v[208:211], v[72:75], v[148:151]
    v_mfma_f32_16x16x32_bf16 v[152:155], v[204:207], v[76:79], v[152:155]
    v_mfma_f32_16x16x32_bf16 v[156:159], v[208:211], v[76:79], v[156:159]
    v_mfma_f32_16x16x32_bf16 v[16:19], v[204:207], v[124:127], v[16:19]
    v_mfma_f32_16x16x32_bf16 v[20:23], v[208:211], v[124:127], v[20:23]
    s_waitcnt lgkmcnt(6)
    s_nop 0
    v_mfma_f32_16x16x32_bf16 v[144:147], v[128:131], v[48:51], v[144:147]
    v_mfma_f32_16x16x32_bf16 v[148:151], v[132:135], v[48:51], v[148:151]
    v_mfma_f32_16x16x32_bf16 v[152:155], v[128:131], v[52:55], v[152:155]
    v_mfma_f32_16x16x32_bf16 v[156:159], v[132:135], v[52:55], v[156:159]
    v_mfma_f32_16x16x32_bf16 v[16:19], v[128:131], v[104:107], v[16:19]
    v_mfma_f32_16x16x32_bf16 v[20:23], v[132:135], v[104:107], v[20:23]
    s_waitcnt lgkmcnt(0)
    s_nop 0
    v_mfma_f32_16x16x32_bf16 v[144:147], v[136:139], v[96:99], v[144:147]
    v_mfma_f32_16x16x32_bf16 v[148:151], v[140:143], v[96:99], v[148:151]
    v_mfma_f32_16x16x32_bf16 v[152:155], v[136:139], v[100:103], v[152:155]
    v_mfma_f32_16x16x32_bf16 v[156:159], v[140:143], v[100:103], v[156:159]
    v_mfma_f32_16x16x32_bf16 v[16:19], v[136:139], v[108:111], v[16:19]
    v_mfma_f32_16x16x32_bf16 v[20:23], v[140:143], v[108:111], v[20:23]
    ds_read_b64_tr_b16 v[224:225], v252 offset:8192
    ds_read_b64_tr_b16 v[226:227], v252 offset:9216
    ds_read_b64_tr_b16 v[228:229], v252 offset:8224
    ds_read_b64_tr_b16 v[230:231], v252 offset:9248
    s_xor_b32 s67, s67, 8
    s_lshl_b32 s3, s38, 2
    s_add_u32 s3, s3, 162112
    v_mov_b32 v4, s3
    v_mov_b32 v5, 1
    v_cvt_pk_bf16_f32 v144, v144, v145
    v_cvt_pk_bf16_f32 v145, v146, v147
    v_cvt_pk_bf16_f32 v146, v148, v149
    v_cvt_pk_bf16_f32 v147, v150, v151
    buffer_store_dwordx4 v[144:147], v199, s[48:51], s74 offen offset:0 sc1
    v_cvt_pk_bf16_f32 v152, v152, v153
    v_cvt_pk_bf16_f32 v153, v154, v155
    v_cvt_pk_bf16_f32 v154, v156, v157
    v_cvt_pk_bf16_f32 v155, v158, v159
    buffer_store_dwordx4 v[152:155], v199, s[48:51], s74 offen offset:1024 sc1
    v_cvt_pk_bf16_f32 v16, v16, v17
    v_cvt_pk_bf16_f32 v17, v18, v19
    v_cvt_pk_bf16_f32 v18, v20, v21
    v_cvt_pk_bf16_f32 v19, v22, v23
    s_mov_b32 exec_lo, 0x00010001
    s_mov_b32 exec_hi, 0x00010001
    buffer_store_dwordx4 v[16:19], v1, s[48:51], s75 offen sc1
    s_mov_b64 exec, -1
    ds_write_b32 v4, v5
    s_setprio 0
    v_pk_fma_f32 v[8:9], v[192:193], v[212:213], v[8:9] op_sel_hi:[0,1,1] neg_lo:[1,0,0] neg_hi:[1,0,0]
    v_pk_fma_f32 v[10:11], v[192:193], v[214:215], v[10:11] op_sel_hi:[0,1,1] neg_lo:[1,0,0] neg_hi:[1,0,0]
    v_pk_fma_f32 v[12:13], v[192:193], v[216:217], v[12:13] op_sel_hi:[0,1,1] neg_lo:[1,0,0] neg_hi:[1,0,0]
    v_pk_fma_f32 v[14:15], v[192:193], v[218:219], v[14:15] op_sel_hi:[0,1,1] neg_lo:[1,0,0] neg_hi:[1,0,0]
    v_cvt_pk_bf16_f32 v8, v8, v9
    v_cvt_pk_bf16_f32 v9, v10, v11
    v_cvt_pk_bf16_f32 v10, v12, v13
    v_cvt_pk_bf16_f32 v11, v14, v15
    v_pk_fma_f32 v[32:33], v[194:195], v[212:213], v[32:33] op_sel_hi:[0,1,1] neg_lo:[1,0,0] neg_hi:[1,0,0]
    v_pk_fma_f32 v[34:35], v[194:195], v[214:215], v[34:35] op_sel_hi:[0,1,1] neg_lo:[1,0,0] neg_hi:[1,0,0]
    v_pk_fma_f32 v[36:37], v[194:195], v[216:217], v[36:37] op_sel_hi:[0,1,1] neg_lo:[1,0,0] neg_hi:[1,0,0]
    v_pk_fma_f32 v[38:39], v[194:195], v[218:219], v[38:39] op_sel_hi:[0,1,1] neg_lo:[1,0,0] neg_hi:[1,0,0]
    v_cvt_pk_bf16_f32 v32, v32, v33
    v_cvt_pk_bf16_f32 v33, v34, v35
    v_cvt_pk_bf16_f32 v34, v36, v37
    v_cvt_pk_bf16_f32 v35, v38, v39
    v_pk_fma_f32 v[56:57], v[196:197], v[212:213], v[56:57] op_sel_hi:[0,1,1] neg_lo:[1,0,0] neg_hi:[1,0,0]
    v_pk_fma_f32 v[58:59], v[196:197], v[214:215], v[58:59] op_sel_hi:[0,1,1] neg_lo:[1,0,0] neg_hi:[1,0,0]
    v_pk_fma_f32 v[60:61], v[196:197], v[216:217], v[60:61] op_sel_hi:[0,1,1] neg_lo:[1,0,0] neg_hi:[1,0,0]
    v_pk_fma_f32 v[62:63], v[196:197], v[218:219], v[62:63] op_sel_hi:[0,1,1] neg_lo:[1,0,0] neg_hi:[1,0,0]
    v_cvt_pk_bf16_f32 v56, v56, v57
    v_cvt_pk_bf16_f32 v57, v58, v59
    v_cvt_pk_bf16_f32 v58, v60, v61
    v_cvt_pk_bf16_f32 v59, v62, v63
    v_pk_fma_f32 v[80:81], v[198:199], v[212:213], v[80:81] op_sel_hi:[0,1,1] neg_lo:[1,0,0] neg_hi:[1,0,0]
    v_pk_fma_f32 v[82:83], v[198:199], v[214:215], v[82:83] op_sel_hi:[0,1,1] neg_lo:[1,0,0] neg_hi:[1,0,0]
    v_pk_fma_f32 v[84:85], v[198:199], v[216:217], v[84:85] op_sel_hi:[0,1,1] neg_lo:[1,0,0] neg_hi:[1,0,0]
    v_pk_fma_f32 v[86:87], v[198:199], v[218:219], v[86:87] op_sel_hi:[0,1,1] neg_lo:[1,0,0] neg_hi:[1,0,0]
    v_cvt_pk_bf16_f32 v80, v80, v81
    v_cvt_pk_bf16_f32 v81, v82, v83
    v_cvt_pk_bf16_f32 v82, v84, v85
    v_cvt_pk_bf16_f32 v83, v86, v87
    s_waitcnt lgkmcnt(1)
    s_nop 0
    v_mfma_f32_16x16x32_bf16 v[144:147], v[224:227], v[8:11], 0
    v_mfma_f32_16x16x32_bf16 v[148:151], v[228:231], v[8:11], 0
    v_mfma_f32_16x16x32_bf16 v[152:155], v[224:227], v[32:35], 0
    v_mfma_f32_16x16x32_bf16 v[156:159], v[228:231], v[32:35], 0
    v_mfma_f32_16x16x32_bf16 v[160:163], v[224:227], v[56:59], 0
    v_mfma_f32_16x16x32_bf16 v[164:167], v[228:231], v[56:59], 0
    v_mfma_f32_16x16x32_bf16 v[168:171], v[224:227], v[80:83], 0
    v_mfma_f32_16x16x32_bf16 v[172:175], v[228:231], v[80:83], 0
    s_nop 0
    s_nop 0
    v_max3_f32 v176, v144, v145, v146
    v_max3_f32 v184, -v144, -v145, -v146
    v_max3_f32 v178, v152, v153, v154
    v_max3_f32 v186, -v152, -v153, -v154
    v_max3_f32 v176, v176, v147, v148
    v_max3_f32 v184, v184, -v147, -v148
    v_max3_f32 v178, v178, v155, v156
    v_max3_f32 v186, v186, -v155, -v156
    v_max3_f32 v176, v176, v149, v150
    v_max3_f32 v184, v184, -v149, -v150
    v_max3_f32 v178, v178, v157, v158
    v_max3_f32 v186, v186, -v157, -v158
    v_max_f32_e64 v176, v176, v151
    v_max_f32_e64 v184, v184, -v151
    v_max_f32_e64 v178, v178, v159
    v_max_f32_e64 v186, v186, -v159
    s_nop 0
    v_permlane32_swap_b32 v176, v178
    v_permlane32_swap_b32_e64 v184, v186
    v_max3_f32 v180, v160, v161, v162
    v_max3_f32 v188, -v160, -v161, -v162
    v_max_f32 v176, v176, v178
    v_max_f32 v184, v184, v186
    v_max3_f32 v182, v168, v169, v170
    v_max3_f32 v190, -v168, -v169, -v170
    v_permlane16_swap_b32 v176, v184
    v_max_f32 v176, v176, v184
    v_max3_f32 v180, v180, v163, v164
    v_max3_f32 v188, v188, -v163, -v164
    v_mul_f32 v184, v176, v193
    v_mul_f32 v176, v176, v193
    v_max3_f32 v182, v182, v171, v172
    v_max3_f32 v190, v190, -v171, -v172
    v_permlane16_swap_b32 v176, v184
    v_mov_b32 v178, v176
    v_max3_f32 v180, v180, v165, v166
    v_max3_f32 v188, v188, -v165, -v166
    v_mov_b32_e64 v186, v184
    v_max3_f32 v182, v182, v173, v174
    v_max3_f32 v190, v190, -v173, -v174
    v_permlane32_swap_b32 v176, v178
    v_permlane32_swap_b32 v184, v186
    v_max_f32_e64 v180, v180, v167
    v_max_f32_e64 v188, v188, -v167
    v_max_f32_e64 v182, v182, v175
    v_max_f32_e64 v190, v190, -v175
    s_nop 0
    v_permlane32_swap_b32 v180, v182
    v_permlane32_swap_b32_e64 v188, v190
    v_pk_fma_f32 v[8:9], v[144:145], v[200:201], v[184:185] op_sel_hi:[1,0,0] neg_lo:[1,0,1] neg_hi:[1,0,1]
    v_pk_fma_f32 v[144:145], v[144:145], v[200:201], v[176:177] op_sel_hi:[1,0,0] neg_lo:[0,0,1] neg_hi:[0,0,1]
    v_max_f32 v180, v180, v182
    v_max_f32 v188, v188, v190
    v_pk_fma_f32 v[10:11], v[146:147], v[200:201], v[184:185] op_sel_hi:[1,0,0] neg_lo:[1,0,1] neg_hi:[1,0,1]
    v_pk_fma_f32 v[146:147], v[146:147], v[200:201], v[176:177] op_sel_hi:[1,0,0] neg_lo:[0,0,1] neg_hi:[0,0,1]
    v_permlane16_swap_b32 v180, v188
    v_max_f32 v180, v180, v188
    v_pk_fma_f32 v[12:13], v[148:149], v[200:201], v[184:185] op_sel_hi:[1,0,0] neg_lo:[1,0,1] neg_hi:[1,0,1]
    v_pk_fma_f32 v[148:149], v[148:149], v[200:201], v[176:177] op_sel_hi:[1,0,0] neg_lo:[0,0,1] neg_hi:[0,0,1]
    v_mul_f32 v188, v180, v221
    v_mul_f32 v180, v180, v221
    v_pk_fma_f32 v[14:15], v[150:151], v[200:201], v[184:185] op_sel_hi:[1,0,0] neg_lo:[1,0,1] neg_hi:[1,0,1]
    v_pk_fma_f32 v[150:151], v[150:151], v[200:201], v[176:177] op_sel_hi:[1,0,0] neg_lo:[0,0,1] neg_hi:[0,0,1]
    v_permlane16_swap_b32 v180, v188
    v_mov_b32 v182, v180
    v_pk_fma_f32 v[32:33], v[152:153], v[202:203], v[186:187] op_sel_hi:[1,0,0] neg_lo:[1,0,1] neg_hi:[1,0,1]
    v_pk_fma_f32 v[152:153], v[152:153], v[202:203], v[178:179] op_sel_hi:[1,0,0] neg_lo:[0,0,1] neg_hi:[0,0,1]
    v_mov_b32_e64 v190, v188
    v_pk_fma_f32 v[34:35], v[154:155], v[202:203], v[186:187] op_sel_hi:[1,0,0] neg_lo:[1,0,1] neg_hi:[1,0,1]
    v_pk_fma_f32 v[154:155], v[154:155], v[202:203], v[178:179] op_sel_hi:[1,0,0] neg_lo:[0,0,1] neg_hi:[0,0,1]
    v_permlane32_swap_b32 v180, v182
    v_permlane32_swap_b32 v188, v190
    v_pk_fma_f32 v[36:37], v[156:157], v[202:203], v[186:187] op_sel_hi:[1,0,0] neg_lo:[1,0,1] neg_hi:[1,0,1]
    v_pk_fma_f32 v[156:157], v[156:157], v[202:203], v[178:179] op_sel_hi:[1,0,0] neg_lo:[0,0,1] neg_hi:[0,0,1]
    v_pk_fma_f32 v[38:39], v[158:159], v[202:203], v[186:187] op_sel_hi:[1,0,0] neg_lo:[1,0,1] neg_hi:[1,0,1]
    v_pk_fma_f32 v[158:159], v[158:159], v[202:203], v[178:179] op_sel_hi:[1,0,0] neg_lo:[0,0,1] neg_hi:[0,0,1]
    v_exp_f32 v8, v8
    v_exp_f32 v144, v144
    v_exp_f32 v9, v9
    v_exp_f32 v145, v145
    v_exp_f32 v10, v10
    v_exp_f32 v146, v146
    v_exp_f32 v11, v11
    v_exp_f32 v147, v147
    v_exp_f32 v12, v12
    v_exp_f32 v148, v148
    v_exp_f32 v13, v13
    v_exp_f32 v149, v149
    v_exp_f32 v14, v14
    v_exp_f32 v150, v150
    v_exp_f32 v15, v15
    v_exp_f32 v151, v151
    v_exp_f32 v32, v32
    v_exp_f32 v152, v152
    v_exp_f32 v33, v33
    v_exp_f32 v153, v153
    v_exp_f32 v34, v34
    v_exp_f32 v154, v154
    v_exp_f32 v35, v35
    v_exp_f32 v155, v155
    v_exp_f32 v36, v36
    v_exp_f32 v156, v156
    v_exp_f32 v37, v37
    v_exp_f32 v157, v157
    v_exp_f32 v38, v38
    v_exp_f32 v158, v158
    v_exp_f32 v39, v39
    v_exp_f32 v159, v159
    v_pk_add_f32 v[128:129], v[144:145], v[146:147]
    v_pk_add_f32 v[130:131], v[8:9], v[10:11]
    v_pk_add_f32 v[132:133], v[152:153], v[154:155]
    v_pk_add_f32 v[134:135], v[32:33], v[34:35]
    v_pk_add_f32 v[128:129], v[128:129], v[148:149]
    v_pk_add_f32 v[130:131], v[130:131], v[12:13]
    v_pk_add_f32 v[132:133], v[132:133], v[156:157]
    v_pk_add_f32 v[134:135], v[134:135], v[36:37]
    v_pk_add_f32 v[128:129], v[128:129], v[150:151]
    v_pk_add_f32 v[130:131], v[130:131], v[14:15]
    v_pk_add_f32 v[132:133], v[132:133], v[158:159]
    v_pk_add_f32 v[134:135], v[134:135], v[38:39]
    v_add_f32 v176, v128, v129
    v_add_f32 v184, v130, v131
    v_add_f32 v178, v132, v133
    v_add_f32 v186, v134, v135
    s_nop 0
    v_permlane32_swap_b32 v176, v178
    v_permlane32_swap_b32_e64 v184, v186
    v_pk_fma_f32 v[56:57], v[160:161], v[220:221], v[188:189] op_sel_hi:[1,0,0] neg_lo:[1,0,1] neg_hi:[1,0,1]
    v_pk_fma_f32 v[160:161], v[160:161], v[220:221], v[180:181] op_sel_hi:[1,0,0] neg_lo:[0,0,1] neg_hi:[0,0,1]
    v_add_f32 v176, v176, v178
    v_add_f32 v184, v184, v186
    v_pk_fma_f32 v[58:59], v[162:163], v[220:221], v[188:189] op_sel_hi:[1,0,0] neg_lo:[1,0,1] neg_hi:[1,0,1]
    v_pk_fma_f32 v[162:163], v[162:163], v[220:221], v[180:181] op_sel_hi:[1,0,0] neg_lo:[0,0,1] neg_hi:[0,0,1]
    v_permlane16_swap_b32 v176, v184
    v_add_f32 v176, v176, v184
    v_pk_fma_f32 v[60:61], v[164:165], v[220:221], v[188:189] op_sel_hi:[1,0,0] neg_lo:[1,0,1] neg_hi:[1,0,1]
    v_pk_fma_f32 v[164:165], v[164:165], v[220:221], v[180:181] op_sel_hi:[1,0,0] neg_lo:[0,0,1] neg_hi:[0,0,1]
    v_rcp_f32_e64 v176, v176
    v_pk_fma_f32 v[62:63], v[166:167], v[220:221], v[188:189] op_sel_hi:[1,0,0] neg_lo:[1,0,1] neg_hi:[1,0,1]
    v_pk_fma_f32 v[166:167], v[166:167], v[220:221], v[180:181] op_sel_hi:[1,0,0] neg_lo:[0,0,1] neg_hi:[0,0,1]
    v_mov_b32_e64 v184, v176
    v_pk_fma_f32 v[80:81], v[168:169], v[222:223], v[190:191] op_sel_hi:[1,0,0] neg_lo:[1,0,1] neg_hi:[1,0,1]
    v_pk_fma_f32 v[168:169], v[168:169], v[222:223], v[182:183] op_sel_hi:[1,0,0] neg_lo:[0,0,1] neg_hi:[0,0,1]
    v_permlane16_swap_b32 v176, v184
    v_mov_b32 v178, v176
    v_pk_fma_f32 v[82:83], v[170:171], v[222:223], v[190:191] op_sel_hi:[1,0,0] neg_lo:[1,0,1] neg_hi:[1,0,1]
    v_pk_fma_f32 v[170:171], v[170:171], v[222:223], v[182:183] op_sel_hi:[1,0,0] neg_lo:[0,0,1] neg_hi:[0,0,1]
    v_mov_b32_e64 v186, v184
    v_pk_fma_f32 v[84:85], v[172:173], v[222:223], v[190:191] op_sel_hi:[1,0,0] neg_lo:[1,0,1] neg_hi:[1,0,1]
    v_pk_fma_f32 v[172:173], v[172:173], v[222:223], v[182:183] op_sel_hi:[1,0,0] neg_lo:[0,0,1] neg_hi:[0,0,1]
    v_permlane32_swap_b32 v176, v178
    v_permlane32_swap_b32 v184, v186
    v_pk_fma_f32 v[86:87], v[174:175], v[222:223], v[190:191] op_sel_hi:[1,0,0] neg_lo:[1,0,1] neg_hi:[1,0,1]
    v_pk_fma_f32 v[174:175], v[174:175], v[222:223], v[182:183] op_sel_hi:[1,0,0] neg_lo:[0,0,1] neg_hi:[0,0,1]
    v_pk_mul_f32 v[144:145], v[144:145], v[176:177] op_sel_hi:[1,0]
    v_pk_mul_f32 v[146:147], v[146:147], v[176:177] op_sel_hi:[1,0]
    v_pk_mul_f32 v[148:149], v[148:149], v[176:177] op_sel_hi:[1,0]
    v_pk_mul_f32 v[150:151], v[150:151], v[176:177] op_sel_hi:[1,0]
    v_cvt_pk_bf16_f32 v144, v144, v145
    v_cvt_pk_bf16_f32 v145, v146, v147
    v_cvt_pk_bf16_f32 v146, v148, v149
    v_cvt_pk_bf16_f32 v147, v150, v151
    v_pk_mul_f32 v[8:9], v[8:9], v[184:185] op_sel_hi:[1,0]
    v_pk_mul_f32 v[10:11], v[10:11], v[184:185] op_sel_hi:[1,0]
    v_pk_mul_f32 v[12:13], v[12:13], v[184:185] op_sel_hi:[1,0]
    v_pk_mul_f32 v[14:15], v[14:15], v[184:185] op_sel_hi:[1,0]
    v_cvt_pk_bf16_f32 v8, v8, v9
    v_cvt_pk_bf16_f32 v9, v10, v11
    v_cvt_pk_bf16_f32 v10, v12, v13
    v_cvt_pk_bf16_f32 v11, v14, v15
    v_pk_mul_f32 v[152:153], v[152:153], v[178:179] op_sel_hi:[1,0]
    v_pk_mul_f32 v[154:155], v[154:155], v[178:179] op_sel_hi:[1,0]
    v_pk_mul_f32 v[156:157], v[156:157], v[178:179] op_sel_hi:[1,0]
    v_pk_mul_f32 v[158:159], v[158:159], v[178:179] op_sel_hi:[1,0]
    v_cvt_pk_bf16_f32 v152, v152, v153
    v_cvt_pk_bf16_f32 v153, v154, v155
    v_cvt_pk_bf16_f32 v154, v156, v157
    v_cvt_pk_bf16_f32 v155, v158, v159
    v_pk_mul_f32 v[32:33], v[32:33], v[186:187] op_sel_hi:[1,0]
    v_pk_mul_f32 v[34:35], v[34:35], v[186:187] op_sel_hi:[1,0]
    v_pk_mul_f32 v[36:37], v[36:37], v[186:187] op_sel_hi:[1,0]
    v_pk_mul_f32 v[38:39], v[38:39], v[186:187] op_sel_hi:[1,0]
    v_cvt_pk_bf16_f32 v32, v32, v33
    v_cvt_pk_bf16_f32 v33, v34, v35
    v_cvt_pk_bf16_f32 v34, v36, v37
    v_cvt_pk_bf16_f32 v35, v38, v39
    v_exp_f32 v56, v56
    v_exp_f32 v160, v160
    v_exp_f32 v57, v57
    v_exp_f32 v161, v161
    v_exp_f32 v58, v58
    v_exp_f32 v162, v162
    v_exp_f32 v59, v59
    v_exp_f32 v163, v163
    v_exp_f32 v60, v60
    v_exp_f32 v164, v164
    v_exp_f32 v61, v61
    v_exp_f32 v165, v165
    v_exp_f32 v62, v62
    v_exp_f32 v166, v166
    v_exp_f32 v63, v63
    v_exp_f32 v167, v167
    v_exp_f32 v80, v80
    v_exp_f32 v168, v168
    v_exp_f32 v81, v81
    v_exp_f32 v169, v169
    v_exp_f32 v82, v82
    v_exp_f32 v170, v170
    v_exp_f32 v83, v83
    v_exp_f32 v171, v171
    v_exp_f32 v84, v84
    v_exp_f32 v172, v172
    v_exp_f32 v85, v85
    v_exp_f32 v173, v173
    v_exp_f32 v86, v86
    v_exp_f32 v174, v174
    v_exp_f32 v87, v87
    v_exp_f32 v175, v175
    v_pk_add_f32 v[136:137], v[160:161], v[162:163]
    v_pk_add_f32 v[138:139], v[56:57], v[58:59]
    v_pk_add_f32 v[140:141], v[168:169], v[170:171]
    v_pk_add_f32 v[142:143], v[80:81], v[82:83]
    v_pk_add_f32 v[136:137], v[136:137], v[164:165]
    v_pk_add_f32 v[138:139], v[138:139], v[60:61]
    v_pk_add_f32 v[140:141], v[140:141], v[172:173]
    v_pk_add_f32 v[142:143], v[142:143], v[84:85]
    v_pk_add_f32 v[136:137], v[136:137], v[166:167]
    v_pk_add_f32 v[138:139], v[138:139], v[62:63]
    v_pk_add_f32 v[140:141], v[140:141], v[174:175]
    v_pk_add_f32 v[142:143], v[142:143], v[86:87]
    v_add_f32 v180, v136, v137
    v_add_f32 v188, v138, v139
    v_add_f32 v182, v140, v141
    v_add_f32 v190, v142, v143
    s_nop 0
    v_permlane32_swap_b32 v180, v182
    v_permlane32_swap_b32 v188, v190
    v_add_f32 v180, v180, v182
    v_add_f32 v188, v188, v190
    s_nop 1
    v_permlane16_swap_b32 v180, v188
    v_add_f32 v180, v180, v188
    v_rcp_f32_e64 v180, v180
    s_nop 0
    v_mov_b32_e64 v188, v180
    s_nop 1
    v_permlane16_swap_b32 v180, v188
    v_mov_b32 v182, v180
    v_mov_b32_e64 v190, v188
    s_nop 0
    v_permlane32_swap_b32 v180, v182
    v_permlane32_swap_b32_e64 v188, v190
    v_pk_mul_f32 v[160:161], v[160:161], v[180:181] op_sel_hi:[1,0]
    v_pk_mul_f32 v[162:163], v[162:163], v[180:181] op_sel_hi:[1,0]
    v_pk_mul_f32 v[164:165], v[164:165], v[180:181] op_sel_hi:[1,0]
    v_pk_mul_f32 v[166:167], v[166:167], v[180:181] op_sel_hi:[1,0]
    v_cvt_pk_bf16_f32 v160, v160, v161
    v_cvt_pk_bf16_f32 v161, v162, v163
    v_cvt_pk_bf16_f32 v162, v164, v165
    v_cvt_pk_bf16_f32 v163, v166, v167
    v_pk_mul_f32 v[56:57], v[56:57], v[188:189] op_sel_hi:[1,0]
    v_pk_mul_f32 v[58:59], v[58:59], v[188:189] op_sel_hi:[1,0]
    v_pk_mul_f32 v[60:61], v[60:61], v[188:189] op_sel_hi:[1,0]
    v_pk_mul_f32 v[62:63], v[62:63], v[188:189] op_sel_hi:[1,0]
    v_cvt_pk_bf16_f32 v56, v56, v57
    v_cvt_pk_bf16_f32 v57, v58, v59
    v_cvt_pk_bf16_f32 v58, v60, v61
    v_cvt_pk_bf16_f32 v59, v62, v63
    v_pk_mul_f32 v[168:169], v[168:169], v[182:183] op_sel_hi:[1,0]
    v_pk_mul_f32 v[170:171], v[170:171], v[182:183] op_sel_hi:[1,0]
    v_pk_mul_f32 v[172:173], v[172:173], v[182:183] op_sel_hi:[1,0]
    v_pk_mul_f32 v[174:175], v[174:175], v[182:183] op_sel_hi:[1,0]
    v_cvt_pk_bf16_f32 v168, v168, v169
    v_cvt_pk_bf16_f32 v169, v170, v171
    v_cvt_pk_bf16_f32 v170, v172, v173
    v_cvt_pk_bf16_f32 v171, v174, v175
    v_pk_mul_f32 v[80:81], v[80:81], v[190:191] op_sel_hi:[1,0]
    v_pk_mul_f32 v[82:83], v[82:83], v[190:191] op_sel_hi:[1,0]
    v_pk_mul_f32 v[84:85], v[84:85], v[190:191] op_sel_hi:[1,0]
    v_pk_mul_f32 v[86:87], v[86:87], v[190:191] op_sel_hi:[1,0]
    v_cvt_pk_bf16_f32 v80, v80, v81
    v_cvt_pk_bf16_f32 v81, v82, v83
    v_cvt_pk_bf16_f32 v82, v84, v85
    v_cvt_pk_bf16_f32 v83, v86, v87
    v_mov_b32 v2, 162048
    ds_read_b32 v248, v2
    v_lshrrev_b32 v5, 3, v1
    v_lshlrev_b32 v6, 11, v5
    v_bfe_u32 v5, v1, 4, 2
    v_lshlrev_b32 v5, 1, v5
    v_and_b32 v7, 7, v1
    v_xor_b32 v5, v5, v7
    v_lshl_add_u32 v6, v5, 4, v6
    s_lshl_b32 s3, s35, 7
    v_add_u32 v6, s3, v6
    v_add_u32 v216, 0, v6
    v_add_u32 v217, 15360, v6
    v_add_u32 v218, 30720, v6
    v_add_u32 v219, 46080, v6
    s_lshl_b32 s72, s38, 12
    s_lshl_b32 s73, s38, 16
    s_and_b32 s3, s36, 0
    s_lshl_b32 s3, s3, 18
    s_or_b32 s73, s73, s3
    v_and_b32 v2, 15, v1
    v_add_u32 v2, s69, v2
    v_lshlrev_b32 v2, 2, v2
    v_add_u32 v2, 152064, v2
    ds_read_b32 v193, v2
    ds_read_b32 v192, v2 offset:1024
    s_mul_i32 s76, s67, 4224
    s_add_u32 s76, s76, 1048576
    v_lshlrev_b32 v5, 4, v1
    v_and_b32 v6, 48, v1
    v_add_u32 v6, 4096, v6
    s_lshl_b32 s3, s38, 2
    s_add_u32 s3, s3, 162112
    v_mov_b32 v3, s3
L_gw:
    ds_read_b32 v2, v3
    s_waitcnt lgkmcnt(0)
    v_readfirstlane_b32 s3, v2
    s_nop 0
    s_cmp_eq_u32 s3, 3
    s_cbranch_scc1 L_gk
    s_sleep 1
    s_branch L_gw
L_gk:
    v_mul_f32 v196, v193, v192
    v_mov_b32 v198, 0xbfb8aa3b
    v_lshlrev_b32 v224, 16, v240
    v_and_b32 v225, 0xffff0000, v240
    v_lshlrev_b32 v226, 16, v241
    v_and_b32 v227, 0xffff0000, v241
    v_lshlrev_b32 v228, 16, v242
    v_and_b32 v229, 0xffff0000, v242
    v_lshlrev_b32 v230, 16, v243
    v_and_b32 v231, 0xffff0000, v243
    v_lshlrev_b32 v232, 16, v244
    v_and_b32 v233, 0xffff0000, v244
    v_lshlrev_b32 v234, 16, v245
    v_and_b32 v235, 0xffff0000, v245
    v_lshlrev_b32 v236, 16, v246
    v_and_b32 v237, 0xffff0000, v246
    v_lshlrev_b32 v238, 16, v247
    v_and_b32 v239, 0xffff0000, v247
    v_pk_fma_f32 v[224:225], v[224:225], v[192:193], v[196:197] op_sel_hi:[1,0,0] neg_lo:[0,0,1] neg_hi:[0,0,1]
    v_pk_fma_f32 v[226:227], v[226:227], v[192:193], v[196:197] op_sel_hi:[1,0,0] neg_lo:[0,0,1] neg_hi:[0,0,1]
    v_pk_fma_f32 v[228:229], v[228:229], v[192:193], v[196:197] op_sel_hi:[1,0,0] neg_lo:[0,0,1] neg_hi:[0,0,1]
    v_pk_fma_f32 v[230:231], v[230:231], v[192:193], v[196:197] op_sel_hi:[1,0,0] neg_lo:[0,0,1] neg_hi:[0,0,1]
    v_pk_fma_f32 v[232:233], v[232:233], v[192:193], v[196:197] op_sel_hi:[1,0,0] neg_lo:[0,0,1] neg_hi:[0,0,1]
    v_pk_fma_f32 v[234:235], v[234:235], v[192:193], v[196:197] op_sel_hi:[1,0,0] neg_lo:[0,0,1] neg_hi:[0,0,1]
    v_pk_fma_f32 v[236:237], v[236:237], v[192:193], v[196:197] op_sel_hi:[1,0,0] neg_lo:[0,0,1] neg_hi:[0,0,1]
    v_pk_fma_f32 v[238:239], v[238:239], v[192:193], v[196:197] op_sel_hi:[1,0,0] neg_lo:[0,0,1] neg_hi:[0,0,1]
    v_pk_mul_f32 v[200:201], v[224:225], v[198:199] op_sel_hi:[1,0]
    v_pk_mul_f32 v[202:203], v[226:227], v[198:199] op_sel_hi:[1,0]
    v_pk_mul_f32 v[204:205], v[228:229], v[198:199] op_sel_hi:[1,0]
    v_pk_mul_f32 v[206:207], v[230:231], v[198:199] op_sel_hi:[1,0]
    v_pk_mul_f32 v[208:209], v[232:233], v[198:199] op_sel_hi:[1,0]
    v_pk_mul_f32 v[210:211], v[234:235], v[198:199] op_sel_hi:[1,0]
    v_pk_mul_f32 v[212:213], v[236:237], v[198:199] op_sel_hi:[1,0]
    v_pk_mul_f32 v[214:215], v[238:239], v[198:199] op_sel_hi:[1,0]
    v_exp_f32 v200, v200
    v_exp_f32 v201, v201
    v_exp_f32 v202, v202
    v_exp_f32 v203, v203
    v_exp_f32 v204, v204
    v_exp_f32 v205, v205
    v_exp_f32 v206, v206
    v_exp_f32 v207, v207
    v_exp_f32 v208, v208
    v_exp_f32 v209, v209
    v_exp_f32 v210, v210
    v_exp_f32 v211, v211
    v_exp_f32 v212, v212
    v_exp_f32 v213, v213
    v_exp_f32 v214, v214
    v_exp_f32 v215, v215
    v_pk_add_f32 v[200:201], v[200:201], 1.0 op_sel_hi:[1,0]
    v_pk_add_f32 v[202:203], v[202:203], 1.0 op_sel_hi:[1,0]
    v_pk_add_f32 v[204:205], v[204:205], 1.0 op_sel_hi:[1,0]
    v_pk_add_f32 v[206:207], v[206:207], 1.0 op_sel_hi:[1,0]
    v_pk_add_f32 v[208:209], v[208:209], 1.0 op_sel_hi:[1,0]
    v_pk_add_f32 v[210:211], v[210:211], 1.0 op_sel_hi:[1,0]
    v_pk_add_f32 v[212:213], v[212:213], 1.0 op_sel_hi:[1,0]
    v_pk_add_f32 v[214:215], v[214:215], 1.0 op_sel_hi:[1,0]
    v_rcp_f32 v200, v200
    v_rcp_f32 v201, v201
    v_rcp_f32 v202, v202
    v_rcp_f32 v203, v203
    v_rcp_f32 v204, v204
    v_rcp_f32 v205, v205
    v_rcp_f32 v206, v206
    v_rcp_f32 v207, v207
    v_rcp_f32 v208, v208
    v_rcp_f32 v209, v209
    v_rcp_f32 v210, v210
    v_rcp_f32 v211, v211
    v_rcp_f32 v212, v212
    v_rcp_f32 v213, v213
    v_rcp_f32 v214, v214
    v_rcp_f32 v215, v215
    v_pk_mul_f32 v[224:225], v[224:225], v[200:201]
    v_pk_mul_f32 v[226:227], v[226:227], v[202:203]
    v_pk_mul_f32 v[228:229], v[228:229], v[204:205]
    v_pk_mul_f32 v[230:231], v[230:231], v[206:207]
    v_pk_mul_f32 v[232:233], v[232:233], v[208:209]
    v_pk_mul_f32 v[234:235], v[234:235], v[210:211]
    v_pk_mul_f32 v[236:237], v[236:237], v[212:213]
    v_pk_mul_f32 v[238:239], v[238:239], v[214:215]
    buffer_load_dwordx4 v[104:107], v5, s[48:51], s76 offen offset:0 sc1
    buffer_load_dwordx4 v[108:111], v5, s[48:51], s76 offen offset:1024 sc1
    buffer_load_dwordx4 v[112:115], v5, s[48:51], s76 offen offset:2048 sc1
    buffer_load_dwordx4 v[116:119], v5, s[48:51], s76 offen offset:3072 sc1
    buffer_load_dwordx4 v[120:123], v6, s[48:51], s76 offen offset:0 sc1
    buffer_load_dwordx4 v[124:127], v6, s[48:51], s76 offen offset:64 sc1
    s_waitcnt lgkmcnt(0)
    v_readfirstlane_b32 s70, v248
    s_nop 0
    s_and_b32 s68, s70, 0x7ff
    s_sub_u32 s68, 2047, s68
    s_lshl_b32 s3, s36, 3
    s_lshl_b32 s28, s64, 2
    s_add_u32 s3, s3, s28
    s_lshl_b32 s3, s3, 5
    s_add_u32 s3, s3, s67
    s_lshl_b32 s77, s3, 10
    s_add_u32 s77, s77, 4194304
    s_waitcnt vmcnt(0)
    s_add_u32 s76, s76, 626688
    s_mov_b32 s29, 0
L_k7:
    s_nop 0
    v_max3_u32 v2, v104, v105, v106
    v_max3_u32 v2, v2, v107, v108
    v_max3_u32 v2, v2, v109, v110
    v_max3_u32 v2, v2, v111, v112
    v_max3_u32 v2, v2, v113, v114
    v_max3_u32 v2, v2, v115, v116
    v_max3_u32 v2, v2, v117, v118
    v_max3_u32 v2, v2, v119, v120
    v_max3_u32 v2, v2, v121, v122
    v_max3_u32 v2, v2, v123, v124
    v_max3_u32 v2, v2, v125, v126
    v_max_u32 v2, v2, v127
    v_cmp_eq_u32 vcc, -1, v2
    s_cbranch_vccz L_k7k
    s_add_u32 s29, s29, 1
    s_cmp_ge_u32 s29, 200000
    s_cbranch_scc1 L_k7k
    v_max3_u32 v2, v104, v105, v106
    v_max_u32 v2, v2, v107
    v_cmp_eq_u32 vcc, -1, v2
    s_cbranch_vccz L_hm0
    s_mov_b64 exec, vcc
    buffer_load_dwordx4 v[104:107], v5, s[48:51], s76 offen offset:0 sc1
    s_mov_b64 exec, -1
L_hm0:
    v_max3_u32 v2, v108, v109, v110
    v_max_u32 v2, v2, v111
    v_cmp_eq_u32 vcc, -1, v2
    s_cbranch_vccz L_hm1
    s_mov_b64 exec, vcc
    buffer_load_dwordx4 v[108:111], v5, s[48:51], s76 offen offset:1024 sc1
    s_mov_b64 exec, -1
L_hm1:
    v_max3_u32 v2, v112, v113, v114
    v_max_u32 v2, v2, v115
    v_cmp_eq_u32 vcc, -1, v2
    s_cbranch_vccz L_hm2
    s_mov_b64 exec, vcc
    buffer_load_dwordx4 v[112:115], v5, s[48:51], s76 offen offset:2048 sc1
    s_mov_b64 exec, -1
L_hm2:
    v_max3_u32 v2, v116, v117, v118
    v_max_u32 v2, v2, v119
    v_cmp_eq_u32 vcc, -1, v2
    s_cbranch_vccz L_hm3
    s_mov_b64 exec, vcc
    buffer_load_dwordx4 v[116:119], v5, s[48:51], s76 offen offset:3072 sc1
    s_mov_b64 exec, -1
L_hm3:
    v_max3_u32 v2, v120, v121, v122
    v_max_u32 v2, v2, v123
    v_cmp_eq_u32 vcc, -1, v2
    s_cbranch_vccz L_hm4
    s_mov_b64 exec, vcc
    buffer_load_dwordx4 v[120:123], v6, s[48:51], s76 offen offset:0 sc1
    s_mov_b64 exec, -1
L_hm4:
    v_max3_u32 v2, v124, v125, v126
    v_max_u32 v2, v2, v127
    v_cmp_eq_u32 vcc, -1, v2
    s_cbranch_vccz L_hm5
    s_mov_b64 exec, vcc
    buffer_load_dwordx4 v[124:127], v6, s[48:51], s76 offen offset:64 sc1
    s_mov_b64 exec, -1
L_hm5:
    s_waitcnt vmcnt(0)
    s_branch L_k7
L_k7k:
    s_setprio 2
    v_mfma_f32_16x16x32_bf16 v[24:27], v[120:123], v[144:147], 0
    v_mfma_f32_16x16x32_bf16 v[24:27], v[124:127], v[8:11], v[24:27]
    v_mfma_f32_16x16x32_bf16 v[16:19], v[104:107], v[144:147], 0
    v_mfma_f32_16x16x32_bf16 v[16:19], v[112:115], v[8:11], v[16:19]
    v_mfma_f32_16x16x32_bf16 v[20:23], v[108:111], v[144:147], 0
    v_mfma_f32_16x16x32_bf16 v[20:23], v[116:119], v[8:11], v[20:23]
    v_mfma_f32_16x16x32_bf16 v[48:51], v[120:123], v[152:155], 0
    v_mfma_f32_16x16x32_bf16 v[48:51], v[124:127], v[32:35], v[48:51]
    v_mfma_f32_16x16x32_bf16 v[40:43], v[104:107], v[152:155], 0
    s_nop 0
    v_add_f32 v24, 0x358637bd, v24
    v_rcp_f32 v24, v24
    s_nop 0
    v_mul_f32 v16, v16, v24
    v_mfma_f32_16x16x32_bf16 v[40:43], v[112:115], v[32:35], v[40:43]
    v_mul_f32 v17, v17, v24
    v_mul_f32 v18, v18, v24
    v_mul_f32 v19, v19, v24
    v_mfma_f32_16x16x32_bf16 v[44:47], v[108:111], v[152:155], 0
    v_mul_f32 v20, v20, v24
    v_mul_f32 v21, v21, v24
    v_mul_f32 v22, v22, v24
    v_mfma_f32_16x16x32_bf16 v[44:47], v[116:119], v[32:35], v[44:47]
    v_mul_f32_e64 v23, v23, v24
    v_cvt_pk_bf16_f32 v16, v16, v17
    v_cvt_pk_bf16_f32 v17, v18, v19
    v_cvt_pk_bf16_f32 v18, v20, v21
    v_cvt_pk_bf16_f32 v19, v22, v23
    buffer_store_dwordx4 v[16:19], v5, s[48:51], s77 offen sc1
    s_add_u32 s77, s77, 32768
    v_mfma_f32_16x16x32_bf16 v[72:75], v[120:123], v[160:163], 0
    v_mfma_f32_16x16x32_bf16 v[72:75], v[124:127], v[56:59], v[72:75]
    v_mfma_f32_16x16x32_bf16 v[64:67], v[104:107], v[160:163], 0
    v_add_f32 v48, 0x358637bd, v48
    v_rcp_f32 v48, v48
    s_nop 0
    v_mul_f32 v40, v40, v48
    v_mfma_f32_16x16x32_bf16 v[64:67], v[112:115], v[56:59], v[64:67]
    v_mul_f32 v41, v41, v48
    v_mul_f32 v42, v42, v48
    v_mul_f32 v43, v43, v48
    v_mfma_f32_16x16x32_bf16 v[68:71], v[108:111], v[160:163], 0
    v_mul_f32 v44, v44, v48
    v_mul_f32 v45, v45, v48
    v_mul_f32 v46, v46, v48
    v_mfma_f32_16x16x32_bf16 v[68:71], v[116:119], v[56:59], v[68:71]
    v_mul_f32 v47, v47, v48
    v_cvt_pk_bf16_f32 v40, v40, v41
    v_cvt_pk_bf16_f32 v41, v42, v43
    v_cvt_pk_bf16_f32 v42, v44, v45
    v_cvt_pk_bf16_f32 v43, v46, v47
    buffer_store_dwordx4 v[40:43], v5, s[48:51], s77 offen sc1
    s_add_u32 s77, s77, 32768
    v_mfma_f32_16x16x32_bf16 v[96:99], v[120:123], v[168:171], 0
    v_mfma_f32_16x16x32_bf16 v[96:99], v[124:127], v[80:83], v[96:99]
    v_mfma_f32_16x16x32_bf16 v[88:91], v[104:107], v[168:171], 0
    v_add_f32 v72, 0x358637bd, v72
    v_rcp_f32 v72, v72
    s_nop 0
    v_mul_f32 v64, v64, v72
    v_mfma_f32_16x16x32_bf16 v[88:91], v[112:115], v[80:83], v[88:91]
    v_mul_f32 v65, v65, v72
    v_mul_f32 v66, v66, v72
    v_mul_f32 v67, v67, v72
    v_mfma_f32_16x16x32_bf16 v[92:95], v[108:111], v[168:171], 0
    v_mul_f32 v68, v68, v72
    v_mul_f32 v69, v69, v72
    v_mul_f32 v70, v70, v72
    v_mfma_f32_16x16x32_bf16 v[92:95], v[116:119], v[80:83], v[92:95]
    v_mul_f32 v71, v71, v72
    v_cvt_pk_bf16_f32 v64, v64, v65
    v_cvt_pk_bf16_f32 v65, v66, v67
    v_cvt_pk_bf16_f32 v66, v68, v69
    v_cvt_pk_bf16_f32 v67, v70, v71
    buffer_store_dwordx4 v[64:67], v5, s[48:51], s77 offen sc1
    s_add_u32 s77, s77, 32768
    v_add_f32 v96, 0x358637bd, v96
    v_rcp_f32 v96, v96
    s_nop 0
    v_pk_mul_f32 v[88:89], v[88:89], v[96:97] op_sel_hi:[1,0]
    v_pk_mul_f32 v[90:91], v[90:91], v[96:97] op_sel_hi:[1,0]
    v_pk_mul_f32 v[92:93], v[92:93], v[96:97] op_sel_hi:[1,0]
    v_pk_mul_f32 v[94:95], v[94:95], v[96:97] op_sel_hi:[1,0]
    v_cvt_pk_bf16_f32 v88, v88, v89
    v_cvt_pk_bf16_f32 v89, v90, v91
    v_cvt_pk_bf16_f32 v90, v92, v93
    v_cvt_pk_bf16_f32 v91, v94, v95
    buffer_store_dwordx4 v[88:91], v5, s[48:51], s77 offen sc1
    v_mov_b32_e64 v2, 7
    ds_write_b32 v3, v2
    s_and_b32 s3, s68, 127
    s_lshl_b32 s3, s3, 2
    s_add_u32 s3, s3, 152064
    v_mov_b32 v2, s3
    ds_read_b32 v250, v2
    ds_read_b32 v251, v2 offset:1024
    s_setprio 0
    v_and_b32 v3, 3, v1
    v_lshlrev_b32_e64 v3, 2, v3
    v_add_u32 v3, 162112, v3
L_cw:
    ds_read_b32 v2, v3
    s_waitcnt lgkmcnt(0)
    v_cmp_ne_u32_e64 vcc, 7, v2
    s_cbranch_vccz L_cwk
    s_sleep 1
    s_branch L_cw
L_cwk:
    s_add_u32 m0, s72, 98304
    s_xor_b32 s3, s73, 1572864
    buffer_load_dwordx4 v216, s[88:91], s3 offen offset:0 lds
    buffer_load_dwordx4 v217, s[88:91], s3 offen offset:1024 lds
    buffer_load_dwordx4 v218, s[88:91], s3 offen offset:2048 lds
    buffer_load_dwordx4 v219, s[88:91], s3 offen offset:3072 lds
    s_add_u32 m0, s72, 114688
    s_xor_b32 s3, s73, 1835008
    buffer_load_dwordx4 v216, s[88:91], s3 offen offset:0 lds
    buffer_load_dwordx4 v217, s[88:91], s3 offen offset:1024 lds
    buffer_load_dwordx4 v218, s[88:91], s3 offen offset:2048 lds
    buffer_load_dwordx4 v219, s[88:91], s3 offen offset:3072 lds
L_p3:
    s_nop 3
    s_mov_b32 s56, s22
    s_mov_b32 s57, s23
    s_mov_b32 s58, 4194304
    s_mov_b32 s59, 0x00020000
    s_lshr_b32 s64, s39, 2
    s_lshl_b32 s3, s34, 2
    s_add_u32 s3, s3, s38
    s_lshl_b32 s3, s3, 16
    s_lshl_b32 s28, s64, 14
    s_add_u32 s3, s3, s28
    s_add_u32 s76, s3, 4194304
    s_lshr_b32 s3, s73, 18
    s_lshl_b32 s3, s3, 12
    s_xor_b32 s76, s76, s3
    s_lshl_b32 s3, s64, 15
    v_lshlrev_b32 v2, 4, v1
    v_add_u32 v116, s3, v2
    v_xor_b32 v117, 0x8000, v116
    v_lshrrev_b32 v2, 2, v1
    v_lshlrev_b32_e64 v2, 7, v2
    v_bfe_u32 v3, v1, 3, 2
    v_lshl_add_u32 v2, v3, 5, v2
    v_and_b32 v3, 3, v1
    v_lshl_add_u32 v2, v3, 3, v2
    s_lshl_b32 s3, s64, 16
    v_add_u32 v112, s3, v2
    v_xor_b32 v113, 32, v112
    v_xor_b32 v114, 64, v112
    v_xor_b32 v115, 96, v112
    s_xor_b32 s77, s76, 0
    buffer_load_dwordx4 v[40:43], v116, s[48:51], s77 offen offset:0 sc1
    buffer_load_dwordx4 v[44:47], v117, s[48:51], s77 offen offset:0 sc1
    buffer_load_dwordx4 v[48:51], v116, s[48:51], s77 offen offset:1024 sc1
    buffer_load_dwordx4 v[52:55], v117, s[48:51], s77 offen offset:1024 sc1
    buffer_load_dwordx4 v[56:59], v116, s[48:51], s77 offen offset:2048 sc1
    buffer_load_dwordx4 v[60:63], v117, s[48:51], s77 offen offset:2048 sc1
    buffer_load_dwordx4 v[64:67], v116, s[48:51], s77 offen offset:3072 sc1
    buffer_load_dwordx4 v[68:71], v117, s[48:51], s77 offen offset:3072 sc1
    s_lshr_b32 s3, s68, 7
    s_xor_b32 s83, s3, s34
    s_or_b32 s83, s83, s39
    v_lshlrev_b32 v222, 4, v1
    ds_read_b64_tr_b16 v[80:81], v112 offset:0
    ds_read_b64_tr_b16 v[82:83], v112 offset:2048
    ds_read_b64_tr_b16 v[84:85], v113 offset:0
    ds_read_b64_tr_b16 v[86:87], v113 offset:2048
    ds_read_b64_tr_b16 v[88:89], v114 offset:0
    ds_read_b64_tr_b16 v[90:91], v114 offset:2048
    ds_read_b64_tr_b16 v[92:93], v115 offset:0
    ds_read_b64_tr_b16 v[94:95], v115 offset:2048
    s_mov_b32 s29, 0
    s_waitcnt vmcnt(6)
    v_max3_u32 v2, v40, v41, v42
    v_max3_u32 v2, v2, v43, v44
    v_max3_u32 v2, v2, v45, v46
    v_max_u32 v2, v2, v47
    v_cmp_eq_u32 vcc, -1, v2
    s_cbranch_vccnz L_r0
L_g0:
    s_waitcnt lgkmcnt(0)
    v_mfma_f32_16x16x32_bf16 v[8:11], v[80:83], v[40:43], 0
    ds_read_b64_tr_b16 v[96:97], v112 offset:4096
    ds_read_b64_tr_b16 v[98:99], v112 offset:6144
    v_mfma_f32_16x16x32_bf16 v[24:27], v[80:83], v[44:47], 0
    ds_read_b64_tr_b16 v[100:101], v113 offset:4096
    ds_read_b64_tr_b16 v[102:103], v113 offset:6144
    v_mfma_f32_16x16x32_bf16 v[12:15], v[84:87], v[40:43], 0
    ds_read_b64_tr_b16 v[104:105], v114 offset:4096
    ds_read_b64_tr_b16 v[106:107], v114 offset:6144
    v_mfma_f32_16x16x32_bf16 v[28:31], v[84:87], v[44:47], 0
    ds_read_b64_tr_b16 v[108:109], v115 offset:4096
    ds_read_b64_tr_b16 v[110:111], v115 offset:6144
    v_mfma_f32_16x16x32_bf16 v[16:19], v[88:91], v[40:43], 0
    s_xor_b32 s77, s76, 4096
    buffer_load_dwordx4 v[72:75], v116, s[48:51], s77 offen offset:0 sc1
    buffer_load_dwordx4 v[76:79], v117, s[48:51], s77 offen offset:0 sc1
    v_mfma_f32_16x16x32_bf16 v[32:35], v[88:91], v[44:47], 0
    s_waitcnt vmcnt(6)
    v_max3_u32 v2, v48, v49, v50
    v_mfma_f32_16x16x32_bf16 v[20:23], v[92:95], v[40:43], 0
    v_max3_u32 v2, v2, v51, v52
    v_max3_u32 v2, v2, v53, v54
    v_mfma_f32_16x16x32_bf16 v[36:39], v[92:95], v[44:47], 0
    v_max_u32 v2, v2, v55
    v_cmp_eq_u32_e64 vcc, -1, v2
    s_cbranch_vccnz L_r1
L_g1:
    s_waitcnt lgkmcnt(0)
    v_mfma_f32_16x16x32_bf16 v[8:11], v[96:99], v[48:51], v[8:11]
    ds_read_b64_tr_b16 v[80:81], v112 offset:8192
    ds_read_b64_tr_b16 v[82:83], v112 offset:10240
    v_mfma_f32_16x16x32_bf16 v[24:27], v[96:99], v[52:55], v[24:27]
    ds_read_b64_tr_b16 v[84:85], v113 offset:8192
    ds_read_b64_tr_b16 v[86:87], v113 offset:10240
    v_mfma_f32_16x16x32_bf16 v[12:15], v[100:103], v[48:51], v[12:15]
    ds_read_b64_tr_b16 v[88:89], v114 offset:8192
    ds_read_b64_tr_b16 v[90:91], v114 offset:10240
    v_mfma_f32_16x16x32_bf16 v[28:31], v[100:103], v[52:55], v[28:31]
    ds_read_b64_tr_b16 v[92:93], v115 offset:8192
    ds_read_b64_tr_b16 v[94:95], v115 offset:10240
    v_mfma_f32_16x16x32_bf16 v[16:19], v[104:107], v[48:51], v[16:19]
    buffer_load_dwordx4 v[40:43], v116, s[48:51], s77 offen offset:1024 sc1
    buffer_load_dwordx4 v[44:47], v117, s[48:51], s77 offen offset:1024 sc1
    v_mfma_f32_16x16x32_bf16 v[32:35], v[104:107], v[52:55], v[32:35]
    s_waitcnt vmcnt(6)
    v_max3_u32 v2, v56, v57, v58
    v_mfma_f32_16x16x32_bf16 v[20:23], v[108:111], v[48:51], v[20:23]
    v_max3_u32 v2, v2, v59, v60
    v_max3_u32 v2, v2, v61, v62
    v_mfma_f32_16x16x32_bf16 v[36:39], v[108:111], v[52:55], v[36:39]
    v_max_u32 v2, v2, v63
    v_cmp_eq_u32_e64 vcc, -1, v2
    s_cbranch_vccnz L_r2
L_g2:
    s_waitcnt lgkmcnt(0)
    v_mfma_f32_16x16x32_bf16 v[8:11], v[80:83], v[56:59], v[8:11]
    ds_read_b64_tr_b16 v[96:97], v112 offset:12288
    ds_read_b64_tr_b16 v[98:99], v112 offset:14336
    v_mfma_f32_16x16x32_bf16 v[24:27], v[80:83], v[60:63], v[24:27]
    ds_read_b64_tr_b16 v[100:101], v113 offset:12288
    ds_read_b64_tr_b16 v[102:103], v113 offset:14336
    v_mfma_f32_16x16x32_bf16 v[12:15], v[84:87], v[56:59], v[12:15]
    ds_read_b64_tr_b16 v[104:105], v114 offset:12288
    ds_read_b64_tr_b16 v[106:107], v114 offset:14336
    v_mfma_f32_16x16x32_bf16 v[28:31], v[84:87], v[60:63], v[28:31]
    ds_read_b64_tr_b16 v[108:109], v115 offset:12288
    ds_read_b64_tr_b16 v[110:111], v115 offset:14336
    v_mfma_f32_16x16x32_bf16 v[16:19], v[88:91], v[56:59], v[16:19]
    buffer_load_dwordx4 v[48:51], v116, s[48:51], s77 offen offset:2048 sc1
    buffer_load_dwordx4 v[52:55], v117, s[48:51], s77 offen offset:2048 sc1
    v_mfma_f32_16x16x32_bf16 v[32:35], v[88:91], v[60:63], v[32:35]
    s_waitcnt vmcnt(6)
    v_max3_u32 v2, v64, v65, v66
    v_mfma_f32_16x16x32_bf16 v[20:23], v[92:95], v[56:59], v[20:23]
    v_max3_u32 v2, v2, v67, v68
    v_max3_u32 v2, v2, v69, v70
    v_mfma_f32_16x16x32_bf16 v[36:39], v[92:95], v[60:63], v[36:39]
    v_max_u32 v2, v2, v71
    v_cmp_eq_u32 vcc, -1, v2
    s_cbranch_vccnz L_r3
L_g3:
    s_waitcnt lgkmcnt(0)
    s_cmp_eq_u32 s64, 0
    s_cbranch_scc1 L_nb3
    s_barrier
L_nb3:
    v_mfma_f32_16x16x32_bf16 v[8:11], v[96:99], v[64:67], v[8:11]
    ds_read_b64_tr_b16 v[80:81], v112 offset:16384
    ds_read_b64_tr_b16 v[82:83], v112 offset:18432
    v_mfma_f32_16x16x32_bf16 v[24:27], v[96:99], v[68:71], v[24:27]
    ds_read_b64_tr_b16 v[84:85], v113 offset:16384
    ds_read_b64_tr_b16 v[86:87], v113 offset:18432
    v_mfma_f32_16x16x32_bf16 v[12:15], v[100:103], v[64:67], v[12:15]
    ds_read_b64_tr_b16 v[88:89], v114 offset:16384
    ds_read_b64_tr_b16 v[90:91], v114 offset:18432
    v_mfma_f32_16x16x32_bf16 v[28:31], v[100:103], v[68:71], v[28:31]
    ds_read_b64_tr_b16 v[92:93], v115 offset:16384
    ds_read_b64_tr_b16 v[94:95], v115 offset:18432
    v_mfma_f32_16x16x32_bf16 v[16:19], v[104:107], v[64:67], v[16:19]
    buffer_load_dwordx4 v[56:59], v116, s[48:51], s77 offen offset:3072 sc1
    buffer_load_dwordx4 v[60:63], v117, s[48:51], s77 offen offset:3072 sc1
    v_mfma_f32_16x16x32_bf16 v[32:35], v[104:107], v[68:71], v[32:35]
    s_waitcnt vmcnt(6)
    v_max3_u32 v2, v72, v73, v74
    v_mfma_f32_16x16x32_bf16 v[20:23], v[108:111], v[64:67], v[20:23]
    v_max3_u32 v2, v2, v75, v76
    v_max3_u32 v2, v2, v77, v78
    v_mfma_f32_16x16x32_bf16 v[36:39], v[108:111], v[68:71], v[36:39]
    v_max_u32 v2, v2, v79
    v_cmp_eq_u32_e64 vcc, -1, v2
    s_cbranch_vccnz L_r4
L_g4:
    s_waitcnt lgkmcnt(0)
    v_mfma_f32_16x16x32_bf16 v[8:11], v[80:83], v[72:75], v[8:11]
    ds_read_b64_tr_b16 v[96:97], v112 offset:20480
    ds_read_b64_tr_b16 v[98:99], v112 offset:22528
    v_mfma_f32_16x16x32_bf16 v[24:27], v[80:83], v[76:79], v[24:27]
    ds_read_b64_tr_b16 v[100:101], v113 offset:20480
    ds_read_b64_tr_b16 v[102:103], v113 offset:22528
    v_mfma_f32_16x16x32_bf16 v[12:15], v[84:87], v[72:75], v[12:15]
    ds_read_b64_tr_b16 v[104:105], v114 offset:20480
    ds_read_b64_tr_b16 v[106:107], v114 offset:22528
    v_mfma_f32_16x16x32_bf16 v[28:31], v[84:87], v[76:79], v[28:31]
    ds_read_b64_tr_b16 v[108:109], v115 offset:20480
    ds_read_b64_tr_b16 v[110:111], v115 offset:22528
    v_mfma_f32_16x16x32_bf16 v[16:19], v[88:91], v[72:75], v[16:19]
    s_xor_b32 s77, s76, 8192
    buffer_load_dwordx4 v[64:67], v116, s[48:51], s77 offen offset:0 sc1
    buffer_load_dwordx4 v[68:71], v117, s[48:51], s77 offen offset:0 sc1
    v_mfma_f32_16x16x32_bf16 v[32:35], v[88:91], v[76:79], v[32:35]
    s_waitcnt vmcnt(6)
    v_max3_u32 v2, v40, v41, v42
    v_mfma_f32_16x16x32_bf16 v[20:23], v[92:95], v[72:75], v[20:23]
    v_max3_u32 v2, v2, v43, v44
    v_max3_u32 v2, v2, v45, v46
    v_mfma_f32_16x16x32_bf16 v[36:39], v[92:95], v[76:79], v[36:39]
    v_max_u32 v2, v2, v47
    v_cmp_eq_u32_e64 vcc, -1, v2
    s_cbranch_vccnz L_r5
L_g5:
    s_waitcnt lgkmcnt(0)
    v_mfma_f32_16x16x32_bf16 v[8:11], v[96:99], v[40:43], v[8:11]
    ds_read_b64_tr_b16 v[80:81], v112 offset:24576
    ds_read_b64_tr_b16 v[82:83], v112 offset:26624
    v_mfma_f32_16x16x32_bf16 v[24:27], v[96:99], v[44:47], v[24:27]
    ds_read_b64_tr_b16 v[84:85], v113 offset:24576
    ds_read_b64_tr_b16 v[86:87], v113 offset:26624
    v_mfma_f32_16x16x32_bf16 v[12:15], v[100:103], v[40:43], v[12:15]
    ds_read_b64_tr_b16 v[88:89], v114 offset:24576
    ds_read_b64_tr_b16 v[90:91], v114 offset:26624
    v_mfma_f32_16x16x32_bf16 v[28:31], v[100:103], v[44:47], v[28:31]
    ds_read_b64_tr_b16 v[92:93], v115 offset:24576
    ds_read_b64_tr_b16 v[94:95], v115 offset:26624
    v_mfma_f32_16x16x32_bf16 v[16:19], v[104:107], v[40:43], v[16:19]
    buffer_load_dwordx4 v[72:75], v116, s[48:51], s77 offen offset:1024 sc1
    buffer_load_dwordx4 v[76:79], v117, s[48:51], s77 offen offset:1024 sc1
    v_mfma_f32_16x16x32_bf16 v[32:35], v[104:107], v[44:47], v[32:35]
    s_waitcnt vmcnt(6)
    v_max3_u32 v2, v48, v49, v50
    v_mfma_f32_16x16x32_bf16 v[20:23], v[108:111], v[40:43], v[20:23]
    v_max3_u32 v2, v2, v51, v52
    v_max3_u32 v2, v2, v53, v54
    v_mfma_f32_16x16x32_bf16 v[36:39], v[108:111], v[44:47], v[36:39]
    v_max_u32 v2, v2, v55
    v_cmp_eq_u32_e64 vcc, -1, v2
    s_cbranch_vccnz L_r6
L_g6:
    s_waitcnt lgkmcnt(0)
    v_mfma_f32_16x16x32_bf16 v[8:11], v[80:83], v[48:51], v[8:11]
    ds_read_b64_tr_b16 v[96:97], v112 offset:28672
    ds_read_b64_tr_b16 v[98:99], v112 offset:30720
    v_mfma_f32_16x16x32_bf16 v[24:27], v[80:83], v[52:55], v[24:27]
    ds_read_b64_tr_b16 v[100:101], v113 offset:28672
    ds_read_b64_tr_b16 v[102:103], v113 offset:30720
    v_mfma_f32_16x16x32_bf16 v[12:15], v[84:87], v[48:51], v[12:15]
    ds_read_b64_tr_b16 v[104:105], v114 offset:28672
    ds_read_b64_tr_b16 v[106:107], v114 offset:30720
    v_mfma_f32_16x16x32_bf16 v[28:31], v[84:87], v[52:55], v[28:31]
    ds_read_b64_tr_b16 v[108:109], v115 offset:28672
    ds_read_b64_tr_b16 v[110:111], v115 offset:30720
    v_mfma_f32_16x16x32_bf16 v[16:19], v[88:91], v[48:51], v[16:19]
    buffer_load_dwordx4 v[40:43], v116, s[48:51], s77 offen offset:2048 sc1
    buffer_load_dwordx4 v[44:47], v117, s[48:51], s77 offen offset:2048 sc1
    v_mfma_f32_16x16x32_bf16 v[32:35], v[88:91], v[52:55], v[32:35]
    s_waitcnt vmcnt(6)
    v_max3_u32 v2, v56, v57, v58
    v_mfma_f32_16x16x32_bf16 v[20:23], v[92:95], v[48:51], v[20:23]
    v_max3_u32 v2, v2, v59, v60
    v_max3_u32 v2, v2, v61, v62
    v_mfma_f32_16x16x32_bf16 v[36:39], v[92:95], v[52:55], v[36:39]
    v_max_u32 v2, v2, v63
    v_cmp_eq_u32 vcc, -1, v2
    s_cbranch_vccnz L_r7
L_g7:
    s_waitcnt lgkmcnt(0)
    s_cmp_eq_u32 s64, 1
    s_cbranch_scc1 L_nb7
    s_barrier
L_nb7:
    v_mfma_f32_16x16x32_bf16 v[8:11], v[96:99], v[56:59], v[8:11]
    ds_read_b64_tr_b16 v[80:81], v112 offset:32768
    ds_read_b64_tr_b16 v[82:83], v112 offset:34816
    v_mfma_f32_16x16x32_bf16 v[24:27], v[96:99], v[60:63], v[24:27]
    ds_read_b64_tr_b16 v[84:85], v113 offset:32768
    ds_read_b64_tr_b16 v[86:87], v113 offset:34816
    v_mfma_f32_16x16x32_bf16 v[12:15], v[100:103], v[56:59], v[12:15]
    ds_read_b64_tr_b16 v[88:89], v114 offset:32768
    ds_read_b64_tr_b16 v[90:91], v114 offset:34816
    v_mfma_f32_16x16x32_bf16 v[28:31], v[100:103], v[60:63], v[28:31]
    ds_read_b64_tr_b16 v[92:93], v115 offset:32768
    ds_read_b64_tr_b16 v[94:95], v115 offset:34816
    v_mfma_f32_16x16x32_bf16 v[16:19], v[104:107], v[56:59], v[16:19]
    buffer_load_dwordx4 v[48:51], v116, s[48:51], s77 offen offset:3072 sc1
    buffer_load_dwordx4 v[52:55], v117, s[48:51], s77 offen offset:3072 sc1
    v_mfma_f32_16x16x32_bf16 v[32:35], v[104:107], v[60:63], v[32:35]
    s_waitcnt vmcnt(6)
    v_max3_u32 v2, v64, v65, v66
    v_mfma_f32_16x16x32_bf16 v[20:23], v[108:111], v[56:59], v[20:23]
    v_max3_u32 v2, v2, v67, v68
    v_max3_u32 v2, v2, v69, v70
    v_mfma_f32_16x16x32_bf16 v[36:39], v[108:111], v[60:63], v[36:39]
    v_max_u32 v2, v2, v71
    v_cmp_eq_u32_e64 vcc, -1, v2
    s_cbranch_vccnz L_r8
L_g8:
    s_waitcnt lgkmcnt(0)
    v_mfma_f32_16x16x32_bf16 v[8:11], v[80:83], v[64:67], v[8:11]
    ds_read_b64_tr_b16 v[96:97], v112 offset:36864
    ds_read_b64_tr_b16 v[98:99], v112 offset:38912
    v_mfma_f32_16x16x32_bf16 v[24:27], v[80:83], v[68:71], v[24:27]
    ds_read_b64_tr_b16 v[100:101], v113 offset:36864
    ds_read_b64_tr_b16 v[102:103], v113 offset:38912
    v_mfma_f32_16x16x32_bf16 v[12:15], v[84:87], v[64:67], v[12:15]
    ds_read_b64_tr_b16 v[104:105], v114 offset:36864
    ds_read_b64_tr_b16 v[106:107], v114 offset:38912
    v_mfma_f32_16x16x32_bf16 v[28:31], v[84:87], v[68:71], v[28:31]
    ds_read_b64_tr_b16 v[108:109], v115 offset:36864
    ds_read_b64_tr_b16 v[110:111], v115 offset:38912
    v_mfma_f32_16x16x32_bf16 v[16:19], v[88:91], v[64:67], v[16:19]
    s_xor_b32 s77, s76, 12288
    buffer_load_dwordx4 v[56:59], v116, s[48:51], s77 offen offset:0 sc1
    buffer_load_dwordx4 v[60:63], v117, s[48:51], s77 offen offset:0 sc1
    v_mfma_f32_16x16x32_bf16 v[32:35], v[88:91], v[68:71], v[32:35]
    s_waitcnt vmcnt(6)
    v_max3_u32 v2, v72, v73, v74
    v_mfma_f32_16x16x32_bf16 v[20:23], v[92:95], v[64:67], v[20:23]
    v_max3_u32 v2, v2, v75, v76
    v_max3_u32 v2, v2, v77, v78
    v_mfma_f32_16x16x32_bf16 v[36:39], v[92:95], v[68:71], v[36:39]
    v_max_u32 v2, v2, v79
    v_cmp_eq_u32_e64 vcc, -1, v2
    s_cbranch_vccnz L_r9
L_g9:
    s_waitcnt lgkmcnt(0)
    v_mfma_f32_16x16x32_bf16 v[8:11], v[96:99], v[72:75], v[8:11]
    ds_read_b64_tr_b16 v[80:81], v112 offset:40960
    ds_read_b64_tr_b16 v[82:83], v112 offset:43008
    v_mfma_f32_16x16x32_bf16 v[24:27], v[96:99], v[76:79], v[24:27]
    ds_read_b64_tr_b16 v[84:85], v113 offset:40960
    ds_read_b64_tr_b16 v[86:87], v113 offset:43008
    v_mfma_f32_16x16x32_bf16 v[12:15], v[100:103], v[72:75], v[12:15]
    ds_read_b64_tr_b16 v[88:89], v114 offset:40960
    ds_read_b64_tr_b16 v[90:91], v114 offset:43008
    v_mfma_f32_16x16x32_bf16 v[28:31], v[100:103], v[76:79], v[28:31]
    ds_read_b64_tr_b16 v[92:93], v115 offset:40960
    ds_read_b64_tr_b16 v[94:95], v115 offset:43008
    v_mfma_f32_16x16x32_bf16 v[16:19], v[104:107], v[72:75], v[16:19]
    buffer_load_dwordx4 v[64:67], v116, s[48:51], s77 offen offset:1024 sc1
    buffer_load_dwordx4 v[68:71], v117, s[48:51], s77 offen offset:1024 sc1
    v_mfma_f32_16x16x32_bf16 v[32:35], v[104:107], v[76:79], v[32:35]
    s_waitcnt vmcnt(6)
    v_max3_u32 v2, v40, v41, v42
    v_mfma_f32_16x16x32_bf16 v[20:23], v[108:111], v[72:75], v[20:23]
    v_max3_u32 v2, v2, v43, v44
    v_max3_u32 v2, v2, v45, v46
    v_mfma_f32_16x16x32_bf16 v[36:39], v[108:111], v[76:79], v[36:39]
    v_max_u32 v2, v2, v47
    v_cmp_eq_u32_e64 vcc, -1, v2
    s_cbranch_vccnz L_r10
L_g10:
    s_waitcnt lgkmcnt(0)
    v_mfma_f32_16x16x32_bf16 v[8:11], v[80:83], v[40:43], v[8:11]
    ds_read_b64_tr_b16 v[96:97], v112 offset:45056
    ds_read_b64_tr_b16 v[98:99], v112 offset:47104
    v_mfma_f32_16x16x32_bf16 v[24:27], v[80:83], v[44:47], v[24:27]
    ds_read_b64_tr_b16 v[100:101], v113 offset:45056
    ds_read_b64_tr_b16 v[102:103], v113 offset:47104
    v_mfma_f32_16x16x32_bf16 v[12:15], v[84:87], v[40:43], v[12:15]
    ds_read_b64_tr_b16 v[104:105], v114 offset:45056
    ds_read_b64_tr_b16 v[106:107], v114 offset:47104
    v_mfma_f32_16x16x32_bf16 v[28:31], v[84:87], v[44:47], v[28:31]
    ds_read_b64_tr_b16 v[108:109], v115 offset:45056
    ds_read_b64_tr_b16 v[110:111], v115 offset:47104
    v_mfma_f32_16x16x32_bf16 v[16:19], v[88:91], v[40:43], v[16:19]
    buffer_load_dwordx4 v[72:75], v116, s[48:51], s77 offen offset:2048 sc1
    buffer_load_dwordx4 v[76:79], v117, s[48:51], s77 offen offset:2048 sc1
    v_mfma_f32_16x16x32_bf16 v[32:35], v[88:91], v[44:47], v[32:35]
    s_waitcnt vmcnt(6)
    v_max3_u32 v2, v48, v49, v50
    v_mfma_f32_16x16x32_bf16 v[20:23], v[92:95], v[40:43], v[20:23]
    v_max3_u32 v2, v2, v51, v52
    v_max3_u32 v2, v2, v53, v54
    v_mfma_f32_16x16x32_bf16 v[36:39], v[92:95], v[44:47], v[36:39]
    v_max_u32 v2, v2, v55
    v_cmp_eq_u32_e64 vcc, -1, v2
    s_cbranch_vccnz L_r11
L_g11:
    s_waitcnt lgkmcnt(0)
    v_mfma_f32_16x16x32_bf16 v[8:11], v[96:99], v[48:51], v[8:11]
    ds_read_b64_tr_b16 v[80:81], v112 offset:49152
    ds_read_b64_tr_b16 v[82:83], v112 offset:51200
    v_mfma_f32_16x16x32_bf16 v[24:27], v[96:99], v[52:55], v[24:27]
    ds_read_b64_tr_b16 v[84:85], v113 offset:49152
    ds_read_b64_tr_b16 v[86:87], v113 offset:51200
    v_mfma_f32_16x16x32_bf16 v[12:15], v[100:103], v[48:51], v[12:15]
    ds_read_b64_tr_b16 v[88:89], v114 offset:49152
    ds_read_b64_tr_b16 v[90:91], v114 offset:51200
    v_mfma_f32_16x16x32_bf16 v[28:31], v[100:103], v[52:55], v[28:31]
    ds_read_b64_tr_b16 v[92:93], v115 offset:49152
    ds_read_b64_tr_b16 v[94:95], v115 offset:51200
    v_mfma_f32_16x16x32_bf16 v[16:19], v[104:107], v[48:51], v[16:19]
    buffer_load_dwordx4 v[40:43], v116, s[48:51], s77 offen offset:3072 sc1
    buffer_load_dwordx4 v[44:47], v117, s[48:51], s77 offen offset:3072 sc1
    v_mfma_f32_16x16x32_bf16 v[32:35], v[104:107], v[52:55], v[32:35]
    s_waitcnt vmcnt(6)
    v_max3_u32 v2, v56, v57, v58
    v_mfma_f32_16x16x32_bf16 v[20:23], v[108:111], v[48:51], v[20:23]
    v_max3_u32 v2, v2, v59, v60
    v_max3_u32 v2, v2, v61, v62
    v_mfma_f32_16x16x32_bf16 v[36:39], v[108:111], v[52:55], v[36:39]
    v_max_u32 v2, v2, v63
    v_cmp_eq_u32_e64 vcc, -1, v2
    s_cbranch_vccnz L_r12
L_g12:
    s_waitcnt lgkmcnt(0)
    v_mfma_f32_16x16x32_bf16 v[8:11], v[80:83], v[56:59], v[8:11]
    ds_read_b64_tr_b16 v[96:97], v112 offset:53248
    ds_read_b64_tr_b16 v[98:99], v112 offset:55296
    v_mfma_f32_16x16x32_bf16 v[24:27], v[80:83], v[60:63], v[24:27]
    ds_read_b64_tr_b16 v[100:101], v113 offset:53248
    ds_read_b64_tr_b16 v[102:103], v113 offset:55296
    v_mfma_f32_16x16x32_bf16 v[12:15], v[84:87], v[56:59], v[12:15]
    ds_read_b64_tr_b16 v[104:105], v114 offset:53248
    ds_read_b64_tr_b16 v[106:107], v114 offset:55296
    v_mfma_f32_16x16x32_bf16 v[28:31], v[84:87], v[60:63], v[28:31]
    ds_read_b64_tr_b16 v[108:109], v115 offset:53248
    ds_read_b64_tr_b16 v[110:111], v115 offset:55296
    v_mfma_f32_16x16x32_bf16 v[16:19], v[88:91], v[56:59], v[16:19]
    v_mfma_f32_16x16x32_bf16 v[32:35], v[88:91], v[60:63], v[32:35]
    s_waitcnt vmcnt(4)
    v_max3_u32 v2, v64, v65, v66
    v_mfma_f32_16x16x32_bf16 v[20:23], v[92:95], v[56:59], v[20:23]
    v_max3_u32 v2, v2, v67, v68
    v_max3_u32 v2, v2, v69, v70
    v_mfma_f32_16x16x32_bf16 v[36:39], v[92:95], v[60:63], v[36:39]
    v_max_u32 v2, v2, v71
    v_cmp_eq_u32_e64 vcc, -1, v2
    s_cbranch_vccnz L_r13
L_g13:
    s_waitcnt lgkmcnt(0)
    v_mfma_f32_16x16x32_bf16 v[8:11], v[96:99], v[64:67], v[8:11]
    ds_read_b64_tr_b16 v[80:81], v112 offset:57344
    ds_read_b64_tr_b16 v[82:83], v112 offset:59392
    v_mfma_f32_16x16x32_bf16 v[24:27], v[96:99], v[68:71], v[24:27]
    ds_read_b64_tr_b16 v[84:85], v113 offset:57344
    ds_read_b64_tr_b16 v[86:87], v113 offset:59392
    v_mfma_f32_16x16x32_bf16 v[12:15], v[100:103], v[64:67], v[12:15]
    ds_read_b64_tr_b16 v[88:89], v114 offset:57344
    ds_read_b64_tr_b16 v[90:91], v114 offset:59392
    v_mfma_f32_16x16x32_bf16 v[28:31], v[100:103], v[68:71], v[28:31]
    ds_read_b64_tr_b16 v[92:93], v115 offset:57344
    ds_read_b64_tr_b16 v[94:95], v115 offset:59392
    v_mfma_f32_16x16x32_bf16 v[16:19], v[104:107], v[64:67], v[16:19]
    v_mfma_f32_16x16x32_bf16 v[32:35], v[104:107], v[68:71], v[32:35]
    s_waitcnt vmcnt(2)
    v_max3_u32 v2, v72, v73, v74
    v_mfma_f32_16x16x32_bf16 v[20:23], v[108:111], v[64:67], v[20:23]
    v_max3_u32 v2, v2, v75, v76
    v_max3_u32 v2, v2, v77, v78
    v_mfma_f32_16x16x32_bf16 v[36:39], v[108:111], v[68:71], v[36:39]
    v_max_u32 v2, v2, v79
    v_cmp_eq_u32_e64 vcc, -1, v2
    s_cbranch_vccnz L_r14
L_g14:
    s_cmp_eq_u32 s83, 0
    s_cbranch_scc1 L_fx1
L_fx1r:
    s_waitcnt lgkmcnt(0)
    v_mfma_f32_16x16x32_bf16 v[8:11], v[80:83], v[72:75], v[8:11]
    ds_read_b64_tr_b16 v[96:97], v112 offset:61440
    ds_read_b64_tr_b16 v[98:99], v112 offset:63488
    v_mfma_f32_16x16x32_bf16 v[24:27], v[80:83], v[76:79], v[24:27]
    ds_read_b64_tr_b16 v[100:101], v113 offset:61440
    ds_read_b64_tr_b16 v[102:103], v113 offset:63488
    v_mfma_f32_16x16x32_bf16 v[12:15], v[84:87], v[72:75], v[12:15]
    ds_read_b64_tr_b16 v[104:105], v114 offset:61440
    ds_read_b64_tr_b16 v[106:107], v114 offset:63488
    v_mfma_f32_16x16x32_bf16 v[28:31], v[84:87], v[76:79], v[28:31]
    ds_read_b64_tr_b16 v[108:109], v115 offset:61440
    ds_read_b64_tr_b16 v[110:111], v115 offset:63488
    v_mfma_f32_16x16x32_bf16 v[16:19], v[88:91], v[72:75], v[16:19]
    v_mfma_f32_16x16x32_bf16 v[32:35], v[88:91], v[76:79], v[32:35]
    s_waitcnt vmcnt(0)
    v_max3_u32 v2, v40, v41, v42
    v_mfma_f32_16x16x32_bf16 v[20:23], v[92:95], v[72:75], v[20:23]
    v_max3_u32 v2, v2, v43, v44
    v_max3_u32 v2, v2, v45, v46
    v_mfma_f32_16x16x32_bf16 v[36:39], v[92:95], v[76:79], v[36:39]
    v_max_u32 v2, v2, v47
    v_cmp_eq_u32_e64 vcc, -1, v2
    s_cbranch_vccnz L_r15
L_g15:
    s_waitcnt lgkmcnt(0)
    v_mfma_f32_16x16x32_bf16 v[8:11], v[96:99], v[40:43], v[8:11]
    v_mfma_f32_16x16x32_bf16 v[24:27], v[96:99], v[44:47], v[24:27]
    v_mfma_f32_16x16x32_bf16 v[12:15], v[100:103], v[40:43], v[12:15]
    v_mfma_f32_16x16x32_bf16 v[28:31], v[100:103], v[44:47], v[28:31]
    v_mfma_f32_16x16x32_bf16 v[16:19], v[104:107], v[40:43], v[16:19]
    v_mfma_f32_16x16x32_bf16 v[32:35], v[104:107], v[44:47], v[32:35]
    v_mfma_f32_16x16x32_bf16 v[20:23], v[108:111], v[40:43], v[20:23]
    v_mfma_f32_16x16x32_bf16 v[36:39], v[108:111], v[44:47], v[36:39]
    s_cmp_eq_u32 s83, 0
    s_cbranch_scc1 L_fx2
L_fx2r:
    s_lshl_b32 s3, s39, 12
    s_add_u32 s3, s3, 131072
    v_lshlrev_b32 v2, 4, v1
    v_add_u32_e64 v2, s3, v2
    v_xor_b32 v3, 0x4000, v2
    s_xor_b32 s28, s3, 0x4000
    ds_write_b128 v2, v[24:27] offset:0
    ds_write_b128 v2, v[28:31] offset:1024
    ds_write_b128 v2, v[32:35] offset:2048
    ds_write_b128 v2, v[36:39] offset:3072
    v_lshlrev_b32 v40, 16, v240
    v_and_b32 v41, 0xffff0000, v240
    v_lshlrev_b32 v42, 16, v241
    v_and_b32 v43, 0xffff0000, v241
    v_lshlrev_b32 v44, 16, v242
    v_and_b32 v45, 0xffff0000, v242
    v_lshlrev_b32 v46, 16, v243
    v_and_b32 v47, 0xffff0000, v243
    v_lshlrev_b32 v48, 16, v244
    v_and_b32 v49, 0xffff0000, v244
    v_lshlrev_b32 v50, 16, v245
    v_and_b32 v51, 0xffff0000, v245
    v_lshlrev_b32 v52, 16, v246
    v_and_b32 v53, 0xffff0000, v246
    v_lshlrev_b32 v54, 16, v247
    v_and_b32 v55, 0xffff0000, v247
    v_and_b32 v4, 15, v1
    v_lshrrev_b32 v5, 4, v1
    v_lshlrev_b32 v6, 1, v4
    v_and_b32 v6, 14, v6
    v_xor_b32_e64 v5, v5, v6
    v_lshl_add_u32 v4, v4, 7, s28
    v_lshl_add_u32 v4, v5, 3, v4
    v_lshrrev_b32 v5, 3, v1
    v_and_b32 v6, 7, v1
    v_xor_b32_e64 v7, v6, v5
    v_lshl_add_u32 v7, v7, 4, s28
    v_lshl_add_u32 v7, v5, 7, v7
    s_lshl_b32 s3, s34, 7
    s_add_u32 s3, s3, s69
    v_add_u32 v5, s3, v5
    v_lshlrev_b32 v5, 11, v5
    v_lshl_add_u32 v5, v6, 4, v5
    s_lshl_b32 s3, s35, 7
    s_add_u32 s28, s3, 16384
    s_lshl_b32 s29, s34, 7
    s_add_u32 s29, s29, s69
    s_andn2_b32 s77, s68, 15
    s_cmp_lg_u32 s29, s77
    s_waitcnt lgkmcnt(0)
    s_barrier
    s_cbranch_scc1 L_nov
    v_and_b32 v2, 48, v1
    s_and_b32 s29, s68, 15
    s_lshl_b32 exec_lo, 0x00010001, s29
    s_mov_b32 exec_hi, exec_lo
    ds_read_b128 v[224:227], v2 offset:0
    ds_read_b128 v[228:231], v2 offset:64
    ds_read_b128 v[232:235], v2 offset:128
    ds_read_b128 v[236:239], v2 offset:192
    s_mov_b64 exec, -1
L_nov:
    ds_read_b128 v[24:27], v3 offset:0
    ds_read_b128 v[28:31], v3 offset:1024
    ds_read_b128 v[32:35], v3 offset:2048
    ds_read_b128 v[36:39], v3 offset:3072
    s_waitcnt lgkmcnt(3)
    s_nop 0
    v_pk_add_f32 v[8:9], v[8:9], v[24:25]
    v_pk_add_f32 v[10:11], v[10:11], v[26:27]
    v_pk_fma_f32 v[40:41], v[8:9], v[224:225], v[40:41]
    v_pk_fma_f32 v[42:43], v[10:11], v[226:227], v[42:43]
    v_cvt_pk_bf16_f32 v8, v40, v41
    v_cvt_pk_bf16_f32 v9, v42, v43
    s_waitcnt lgkmcnt(2)
    s_nop 0
    v_pk_add_f32 v[12:13], v[12:13], v[28:29]
    v_pk_add_f32 v[14:15], v[14:15], v[30:31]
    v_pk_fma_f32 v[44:45], v[12:13], v[228:229], v[44:45]
    v_pk_fma_f32 v[46:47], v[14:15], v[230:231], v[46:47]
    v_cvt_pk_bf16_f32 v10, v44, v45
    v_cvt_pk_bf16_f32 v11, v46, v47
    s_waitcnt lgkmcnt(1)
    s_nop 0
    v_pk_add_f32 v[16:17], v[16:17], v[32:33]
    v_pk_add_f32 v[18:19], v[18:19], v[34:35]
    v_pk_fma_f32 v[48:49], v[16:17], v[232:233], v[48:49]
    v_pk_fma_f32 v[50:51], v[18:19], v[234:235], v[50:51]
    v_cvt_pk_bf16_f32 v12, v48, v49
    v_cvt_pk_bf16_f32 v13, v50, v51
    s_waitcnt lgkmcnt(0)
    s_nop 0
    v_pk_add_f32 v[20:21], v[20:21], v[36:37]
    v_pk_add_f32 v[22:23], v[22:23], v[38:39]
    v_pk_fma_f32 v[52:53], v[20:21], v[236:237], v[52:53]
    v_pk_fma_f32 v[54:55], v[22:23], v[238:239], v[54:55]
    v_cvt_pk_bf16_f32 v14, v52, v53
    v_cvt_pk_bf16_f32 v15, v54, v55
    ds_write_b64 v4, v[8:9]
    v_xor_b32 v6, 32, v4
    ds_write_b64 v6, v[10:11]
    v_xor_b32 v6, 64, v4
    ds_write_b64 v6, v[12:13]
    v_xor_b32 v6, 96, v4
    ds_write_b64 v6, v[14:15]
    ds_read_b128 v[24:27], v7 offset:0
    ds_read_b128 v[28:31], v7 offset:1024
    s_waitcnt lgkmcnt(1)
    buffer_store_dwordx4 v[24:27], v5, s[56:59], s3 offen sc1
    s_waitcnt lgkmcnt(0)
    buffer_store_dwordx4 v[28:31], v5, s[56:59], s28 offen sc1
L_done:
    s_endpgm
L_fx1:
    s_lshl_b32 s78, s35, 14
    s_add_u32 s78, s78, 1413120
    v_and_b32 v2, 15, v1
    v_lshrrev_b32 v3, 4, v1
    v_lshl_add_u32 v193, v2, 2, v3
    v_and_b32 v2, 7, v193
    v_lshrrev_b32 v193, 3, v193
    v_lshl_add_u32 v193, v2, 3, v193
    v_lshlrev_b32 v2, 1, v193
    s_lshl_b32 s3, s68, 11
    s_lshl_b32 s28, s35, 7
    s_add_u32 s3, s3, s28
    buffer_load_ushort v194, v2, s[40:43], s3 offen
    s_add_u32 s3, s78, 0
    s_nop 0
    buffer_load_dwordx4 v[128:131], v222, s[48:51], s3 offen offset:0 sc1
    buffer_load_dwordx4 v[132:135], v222, s[48:51], s3 offen offset:1024 sc1
    buffer_load_dwordx4 v[136:139], v222, s[48:51], s3 offen offset:2048 sc1
    buffer_load_dwordx4 v[140:143], v222, s[48:51], s3 offen offset:3072 sc1
    s_add_u32 s3, s78, 4096
    buffer_load_dwordx4 v[144:147], v222, s[48:51], s3 offen offset:0 sc1
    buffer_load_dwordx4 v[148:151], v222, s[48:51], s3 offen offset:1024 sc1
    buffer_load_dwordx4 v[152:155], v222, s[48:51], s3 offen offset:2048 sc1
    buffer_load_dwordx4 v[156:159], v222, s[48:51], s3 offen offset:3072 sc1
    s_add_u32 s3, s78, 8192
    buffer_load_dwordx4 v[160:163], v222, s[48:51], s3 offen offset:0 sc1
    buffer_load_dwordx4 v[164:167], v222, s[48:51], s3 offen offset:1024 sc1
    buffer_load_dwordx4 v[168:171], v222, s[48:51], s3 offen offset:2048 sc1
    buffer_load_dwordx4 v[172:175], v222, s[48:51], s3 offen offset:3072 sc1
    s_add_u32 s3, s78, 12288
    buffer_load_dwordx4 v[176:179], v222, s[48:51], s3 offen offset:0 sc1
    buffer_load_dwordx4 v[180:183], v222, s[48:51], s3 offen offset:1024 sc1
    buffer_load_dwordx4 v[184:187], v222, s[48:51], s3 offen offset:2048 sc1
    buffer_load_dwordx4 v[188:191], v222, s[48:51], s3 offen offset:3072 sc1
    s_branch L_fx1r
L_fx2:
    s_and_b32 s3, s70, 0xffff0000
    s_xor_b32 s28, s3, 0x80000000
    s_not_b32 s29, s3
    s_and_b32 s29, s29, 0xffff0000
    s_bitcmp1_b32 s3, 31
    s_cselect_b32 s3, s28, s29
    v_mov_b32 v195, s3
    v_mul_f32 v195, 0xbfb8aa3b, v195
    v_exp_f32 v195, v195
    s_nop 0
    v_add_f32 v195, 1.0, v195
    v_rcp_f32 v195, v195
    s_nop 0
    v_cvt_pk_bf16_f32 v195, v195, v195
    v_lshlrev_b32 v195, 16, v195
    s_mov_b32 s29, 0
L_k6:
    v_max3_u32 v2, v128, v129, v130
    v_max3_u32 v2, v2, v131, v132
    v_max3_u32 v2, v2, v133, v134
    v_max3_u32 v2, v2, v135, v136
    v_max3_u32 v2, v2, v137, v138
    v_max3_u32 v2, v2, v139, v140
    v_max3_u32 v2, v2, v141, v142
    v_max3_u32 v2, v2, v143, v144
    v_max3_u32 v2, v2, v145, v146
    v_max3_u32 v2, v2, v147, v148
    v_max3_u32 v2, v2, v149, v150
    v_max3_u32 v2, v2, v151, v152
    v_max3_u32 v2, v2, v153, v154
    v_max3_u32 v2, v2, v155, v156
    v_max3_u32 v2, v2, v157, v158
    v_max3_u32 v2, v2, v159, v160
    v_max3_u32 v2, v2, v161, v162
    v_max3_u32 v2, v2, v163, v164
    v_max3_u32 v2, v2, v165, v166
    v_max3_u32 v2, v2, v167, v168
    v_max3_u32 v2, v2, v169, v170
    v_max3_u32 v2, v2, v171, v172
    v_max3_u32 v2, v2, v173, v174
    v_max3_u32 v2, v2, v175, v176
    v_max3_u32 v2, v2, v177, v178
    v_max3_u32 v2, v2, v179, v180
    v_max3_u32 v2, v2, v181, v182
    v_max3_u32 v2, v2, v183, v184
    v_max3_u32 v2, v2, v185, v186
    v_max3_u32 v2, v2, v187, v188
    v_max3_u32 v2, v2, v189, v190
    v_max_u32 v2, v2, v191
    v_cmp_eq_u32 vcc, -1, v2
    s_cbranch_vccz L_k6k
    s_add_u32 s29, s29, 1
    s_cmp_ge_u32 s29, 200000
    s_cbranch_scc1 L_k6k
    s_sleep 4
    s_add_u32 s3, s78, 0
    s_nop 0
    buffer_load_dwordx4 v[128:131], v222, s[48:51], s3 offen offset:0 sc1
    buffer_load_dwordx4 v[132:135], v222, s[48:51], s3 offen offset:1024 sc1
    buffer_load_dwordx4 v[136:139], v222, s[48:51], s3 offen offset:2048 sc1
    buffer_load_dwordx4 v[140:143], v222, s[48:51], s3 offen offset:3072 sc1
    s_add_u32 s3, s78, 4096
    buffer_load_dwordx4 v[144:147], v222, s[48:51], s3 offen offset:0 sc1
    buffer_load_dwordx4 v[148:151], v222, s[48:51], s3 offen offset:1024 sc1
    buffer_load_dwordx4 v[152:155], v222, s[48:51], s3 offen offset:2048 sc1
    buffer_load_dwordx4 v[156:159], v222, s[48:51], s3 offen offset:3072 sc1
    s_add_u32 s3, s78, 8192
    buffer_load_dwordx4 v[160:163], v222, s[48:51], s3 offen offset:0 sc1
    buffer_load_dwordx4 v[164:167], v222, s[48:51], s3 offen offset:1024 sc1
    buffer_load_dwordx4 v[168:171], v222, s[48:51], s3 offen offset:2048 sc1
    buffer_load_dwordx4 v[172:175], v222, s[48:51], s3 offen offset:3072 sc1
    s_add_u32 s3, s78, 12288
    buffer_load_dwordx4 v[176:179], v222, s[48:51], s3 offen offset:0 sc1
    buffer_load_dwordx4 v[180:183], v222, s[48:51], s3 offen offset:1024 sc1
    buffer_load_dwordx4 v[184:187], v222, s[48:51], s3 offen offset:2048 sc1
    buffer_load_dwordx4 v[188:191], v222, s[48:51], s3 offen offset:3072 sc1
    s_waitcnt vmcnt(0)
    s_branch L_k6
L_k6k:
    v_pk_add_f32 v[128:129], v[128:129], v[160:161]
    v_pk_add_f32 v[130:131], v[130:131], v[162:163]
    v_pk_add_f32 v[132:133], v[132:133], v[164:165]
    v_pk_add_f32 v[134:135], v[134:135], v[166:167]
    v_pk_add_f32 v[136:137], v[136:137], v[168:169]
    v_pk_add_f32 v[138:139], v[138:139], v[170:171]
    v_pk_add_f32 v[140:141], v[140:141], v[172:173]
    v_pk_add_f32 v[142:143], v[142:143], v[174:175]
    v_pk_add_f32 v[144:145], v[144:145], v[176:177]
    v_pk_add_f32 v[146:147], v[146:147], v[178:179]
    v_pk_add_f32 v[148:149], v[148:149], v[180:181]
    v_pk_add_f32 v[150:151], v[150:151], v[182:183]
    v_pk_add_f32 v[152:153], v[152:153], v[184:185]
    v_pk_add_f32 v[154:155], v[154:155], v[186:187]
    v_pk_add_f32 v[156:157], v[156:157], v[188:189]
    v_pk_add_f32 v[158:159], v[158:159], v[190:191]
    v_pk_add_f32 v[128:129], v[128:129], v[144:145]
    v_pk_add_f32 v[130:131], v[130:131], v[146:147]
    v_pk_add_f32 v[132:133], v[132:133], v[148:149]
    v_pk_add_f32 v[134:135], v[134:135], v[150:151]
    v_pk_add_f32 v[136:137], v[136:137], v[152:153]
    v_pk_add_f32 v[138:139], v[138:139], v[154:155]
    v_pk_add_f32 v[140:141], v[140:141], v[156:157]
    v_pk_add_f32 v[142:143], v[142:143], v[158:159]
    v_pk_add_f32 v[128:129], v[128:129], v[136:137]
    v_pk_add_f32 v[130:131], v[130:131], v[138:139]
    v_pk_add_f32 v[132:133], v[132:133], v[140:141]
    v_pk_add_f32 v[134:135], v[134:135], v[142:143]
    v_pk_add_f32 v[128:129], v[128:129], v[132:133]
    v_pk_add_f32 v[130:131], v[130:131], v[134:135]
    s_nop 1
    v_permlane32_swap_b32 v128, v130
    v_permlane32_swap_b32 v129, v131
    v_add_f32 v128, v128, v130
    v_add_f32 v129, v129, v131
    s_nop 1
    v_permlane16_swap_b32 v128, v129
    v_add_f32 v128, v128, v129
    v_cvt_pk_bf16_f32 v128, v128, v128
    v_lshlrev_b32 v128, 16, v128
    v_mul_f32 v128, v128, v195
    v_lshlrev_b32 v194, 16, v194
    v_sub_f32 v194, v194, v250
    v_cvt_pk_bf16_f32 v128, v128, v128
    v_lshlrev_b32 v128, 16, v128
    v_cvt_pk_bf16_f32 v194, v194, v194
    v_lshlrev_b32 v194, 16, v194
    v_mul_f32 v194, v194, v251
    v_cvt_pk_bf16_f32 v194, v194, v194
    v_lshlrev_b32 v194, 16, v194
    v_add_f32 v128, v128, v194
    v_cvt_pk_bf16_f32 v128, v128, v128
    v_lshlrev_b32 v128, 16, v128
    v_mul_f32 v2, 0xbfb8aa3b, v128
    v_exp_f32 v2, v2
    s_nop 0
    v_add_f32 v2, 1.0, v2
    v_rcp_f32 v2, v2
    s_nop 0
    v_mul_f32 v2, v128, v2
    v_lshlrev_b32 v3, 2, v193
    ds_write_b32 v3, v2
    s_branch L_fx2r
L_r0:
    s_add_u32 s29, s29, 1
    s_cmp_ge_u32 s29, 200000
    s_cbranch_scc1 L_g0
    s_xor_b32 s3, s76, 0
    buffer_load_dwordx4 v[40:43], v116, s[48:51], s3 offen offset:0 sc1
    buffer_load_dwordx4 v[44:47], v117, s[48:51], s3 offen offset:0 sc1
    s_waitcnt vmcnt(0)
    v_max3_u32 v2, v40, v41, v42
    v_max3_u32 v2, v2, v43, v44
    v_max3_u32 v2, v2, v45, v46
    v_max_u32 v2, v2, v47
    v_cmp_eq_u32 vcc, -1, v2
    s_cbranch_vccnz L_r0
    s_branch L_g0
L_r1:
    s_add_u32 s29, s29, 1
    s_cmp_ge_u32 s29, 200000
    s_cbranch_scc1 L_g1
    s_xor_b32 s3, s76, 0
    buffer_load_dwordx4 v[48:51], v116, s[48:51], s3 offen offset:1024 sc1
    buffer_load_dwordx4 v[52:55], v117, s[48:51], s3 offen offset:1024 sc1
    s_waitcnt vmcnt(0)
    v_max3_u32 v2, v48, v49, v50
    v_max3_u32 v2, v2, v51, v52
    v_max3_u32 v2, v2, v53, v54
    v_max_u32 v2, v2, v55
    v_cmp_eq_u32 vcc, -1, v2
    s_cbranch_vccnz L_r1
    s_branch L_g1
L_r2:
    s_add_u32 s29, s29, 1
    s_cmp_ge_u32 s29, 200000
    s_cbranch_scc1 L_g2
    s_xor_b32 s3, s76, 0
    buffer_load_dwordx4 v[56:59], v116, s[48:51], s3 offen offset:2048 sc1
    buffer_load_dwordx4 v[60:63], v117, s[48:51], s3 offen offset:2048 sc1
    s_waitcnt vmcnt(0)
    v_max3_u32 v2, v56, v57, v58
    v_max3_u32 v2, v2, v59, v60
    v_max3_u32 v2, v2, v61, v62
    v_max_u32 v2, v2, v63
    v_cmp_eq_u32 vcc, -1, v2
    s_cbranch_vccnz L_r2
    s_branch L_g2
L_r3:
    s_add_u32 s29, s29, 1
    s_cmp_ge_u32 s29, 200000
    s_cbranch_scc1 L_g3
    s_xor_b32 s3, s76, 0
    buffer_load_dwordx4 v[64:67], v116, s[48:51], s3 offen offset:3072 sc1
    buffer_load_dwordx4 v[68:71], v117, s[48:51], s3 offen offset:3072 sc1
    s_waitcnt vmcnt(0)
    v_max3_u32 v2, v64, v65, v66
    v_max3_u32 v2, v2, v67, v68
    v_max3_u32 v2, v2, v69, v70
    v_max_u32 v2, v2, v71
    v_cmp_eq_u32 vcc, -1, v2
    s_cbranch_vccnz L_r3
    s_branch L_g3
L_r4:
    s_add_u32 s29, s29, 1
    s_cmp_ge_u32 s29, 200000
    s_cbranch_scc1 L_g4
    s_xor_b32 s3, s76, 4096
    buffer_load_dwordx4 v[72:75], v116, s[48:51], s3 offen offset:0 sc1
    buffer_load_dwordx4 v[76:79], v117, s[48:51], s3 offen offset:0 sc1
    s_waitcnt vmcnt(0)
    v_max3_u32 v2, v72, v73, v74
    v_max3_u32 v2, v2, v75, v76
    v_max3_u32 v2, v2, v77, v78
    v_max_u32 v2, v2, v79
    v_cmp_eq_u32 vcc, -1, v2
    s_cbranch_vccnz L_r4
    s_branch L_g4
L_r5:
    s_add_u32 s29, s29, 1
    s_cmp_ge_u32 s29, 200000
    s_cbranch_scc1 L_g5
    s_xor_b32 s3, s76, 4096
    buffer_load_dwordx4 v[40:43], v116, s[48:51], s3 offen offset:1024 sc1
    buffer_load_dwordx4 v[44:47], v117, s[48:51], s3 offen offset:1024 sc1
    s_waitcnt vmcnt(0)
    v_max3_u32 v2, v40, v41, v42
    v_max3_u32 v2, v2, v43, v44
    v_max3_u32 v2, v2, v45, v46
    v_max_u32 v2, v2, v47
    v_cmp_eq_u32 vcc, -1, v2
    s_cbranch_vccnz L_r5
    s_branch L_g5
L_r6:
    s_add_u32 s29, s29, 1
    s_cmp_ge_u32 s29, 200000
    s_cbranch_scc1 L_g6
    s_xor_b32 s3, s76, 4096
    buffer_load_dwordx4 v[48:51], v116, s[48:51], s3 offen offset:2048 sc1
    buffer_load_dwordx4 v[52:55], v117, s[48:51], s3 offen offset:2048 sc1
    s_waitcnt vmcnt(0)
    v_max3_u32 v2, v48, v49, v50
    v_max3_u32 v2, v2, v51, v52
    v_max3_u32 v2, v2, v53, v54
    v_max_u32 v2, v2, v55
    v_cmp_eq_u32 vcc, -1, v2
    s_cbranch_vccnz L_r6
    s_branch L_g6
L_r7:
    s_add_u32 s29, s29, 1
    s_cmp_ge_u32 s29, 200000
    s_cbranch_scc1 L_g7
    s_xor_b32 s3, s76, 4096
    buffer_load_dwordx4 v[56:59], v116, s[48:51], s3 offen offset:3072 sc1
    buffer_load_dwordx4 v[60:63], v117, s[48:51], s3 offen offset:3072 sc1
    s_waitcnt vmcnt(0)
    v_max3_u32 v2, v56, v57, v58
    v_max3_u32 v2, v2, v59, v60
    v_max3_u32 v2, v2, v61, v62
    v_max_u32 v2, v2, v63
    v_cmp_eq_u32 vcc, -1, v2
    s_cbranch_vccnz L_r7
    s_branch L_g7
L_r8:
    s_add_u32 s29, s29, 1
    s_cmp_ge_u32 s29, 200000
    s_cbranch_scc1 L_g8
    s_xor_b32 s3, s76, 8192
    buffer_load_dwordx4 v[64:67], v116, s[48:51], s3 offen offset:0 sc1
    buffer_load_dwordx4 v[68:71], v117, s[48:51], s3 offen offset:0 sc1
    s_waitcnt vmcnt(0)
    v_max3_u32 v2, v64, v65, v66
    v_max3_u32 v2, v2, v67, v68
    v_max3_u32 v2, v2, v69, v70
    v_max_u32 v2, v2, v71
    v_cmp_eq_u32 vcc, -1, v2
    s_cbranch_vccnz L_r8
    s_branch L_g8
L_r9:
    s_add_u32 s29, s29, 1
    s_cmp_ge_u32 s29, 200000
    s_cbranch_scc1 L_g9
    s_xor_b32 s3, s76, 8192
    buffer_load_dwordx4 v[72:75], v116, s[48:51], s3 offen offset:1024 sc1
    buffer_load_dwordx4 v[76:79], v117, s[48:51], s3 offen offset:1024 sc1
    s_waitcnt vmcnt(0)
    v_max3_u32 v2, v72, v73, v74
    v_max3_u32 v2, v2, v75, v76
    v_max3_u32 v2, v2, v77, v78
    v_max_u32 v2, v2, v79
    v_cmp_eq_u32 vcc, -1, v2
    s_cbranch_vccnz L_r9
    s_branch L_g9
L_r10:
    s_add_u32 s29, s29, 1
    s_cmp_ge_u32 s29, 200000
    s_cbranch_scc1 L_g10
    s_xor_b32 s3, s76, 8192
    buffer_load_dwordx4 v[40:43], v116, s[48:51], s3 offen offset:2048 sc1
    buffer_load_dwordx4 v[44:47], v117, s[48:51], s3 offen offset:2048 sc1
    s_waitcnt vmcnt(0)
    v_max3_u32 v2, v40, v41, v42
    v_max3_u32 v2, v2, v43, v44
    v_max3_u32 v2, v2, v45, v46
    v_max_u32 v2, v2, v47
    v_cmp_eq_u32 vcc, -1, v2
    s_cbranch_vccnz L_r10
    s_branch L_g10
L_r11:
    s_add_u32 s29, s29, 1
    s_cmp_ge_u32 s29, 200000
    s_cbranch_scc1 L_g11
    s_xor_b32 s3, s76, 8192
    buffer_load_dwordx4 v[48:51], v116, s[48:51], s3 offen offset:3072 sc1
    buffer_load_dwordx4 v[52:55], v117, s[48:51], s3 offen offset:3072 sc1
    s_waitcnt vmcnt(0)
    v_max3_u32 v2, v48, v49, v50
    v_max3_u32 v2, v2, v51, v52
    v_max3_u32 v2, v2, v53, v54
    v_max_u32 v2, v2, v55
    v_cmp_eq_u32 vcc, -1, v2
    s_cbranch_vccnz L_r11
    s_branch L_g11
L_r12:
    s_add_u32 s29, s29, 1
    s_cmp_ge_u32 s29, 200000
    s_cbranch_scc1 L_g12
    s_xor_b32 s3, s76, 12288
    buffer_load_dwordx4 v[56:59], v116, s[48:51], s3 offen offset:0 sc1
    buffer_load_dwordx4 v[60:63], v117, s[48:51], s3 offen offset:0 sc1
    s_waitcnt vmcnt(0)
    v_max3_u32 v2, v56, v57, v58
    v_max3_u32 v2, v2, v59, v60
    v_max3_u32 v2, v2, v61, v62
    v_max_u32 v2, v2, v63
    v_cmp_eq_u32 vcc, -1, v2
    s_cbranch_vccnz L_r12
    s_branch L_g12
L_r13:
    s_add_u32 s29, s29, 1
    s_cmp_ge_u32 s29, 200000
    s_cbranch_scc1 L_g13
    s_xor_b32 s3, s76, 12288
    buffer_load_dwordx4 v[64:67], v116, s[48:51], s3 offen offset:1024 sc1
    buffer_load_dwordx4 v[68:71], v117, s[48:51], s3 offen offset:1024 sc1
    s_waitcnt vmcnt(0)
    v_max3_u32 v2, v64, v65, v66
    v_max3_u32 v2, v2, v67, v68
    v_max3_u32 v2, v2, v69, v70
    v_max_u32 v2, v2, v71
    v_cmp_eq_u32 vcc, -1, v2
    s_cbranch_vccnz L_r13
    s_branch L_g13
L_r14:
    s_add_u32 s29, s29, 1
    s_cmp_ge_u32 s29, 200000
    s_cbranch_scc1 L_g14
    s_xor_b32 s3, s76, 12288
    buffer_load_dwordx4 v[72:75], v116, s[48:51], s3 offen offset:2048 sc1
    buffer_load_dwordx4 v[76:79], v117, s[48:51], s3 offen offset:2048 sc1
    s_waitcnt vmcnt(0)
    v_max3_u32 v2, v72, v73, v74
    v_max3_u32 v2, v2, v75, v76
    v_max3_u32 v2, v2, v77, v78
    v_max_u32 v2, v2, v79
    v_cmp_eq_u32 vcc, -1, v2
    s_cbranch_vccnz L_r14
    s_branch L_g14
L_r15:
    s_add_u32 s29, s29, 1
    s_cmp_ge_u32 s29, 200000
    s_cbranch_scc1 L_g15
    s_xor_b32 s3, s76, 12288
    buffer_load_dwordx4 v[40:43], v116, s[48:51], s3 offen offset:3072 sc1
    buffer_load_dwordx4 v[44:47], v117, s[48:51], s3 offen offset:3072 sc1
    s_waitcnt vmcnt(0)
    v_max3_u32 v2, v40, v41, v42
    v_max3_u32 v2, v2, v43, v44
    v_max3_u32 v2, v2, v45, v46
    v_max_u32 v2, v2, v47
    v_cmp_eq_u32 vcc, -1, v2
    s_cbranch_vccnz L_r15
    s_branch L_g15
.p2align 8
.fill 4096, 4, 0xbf800000
.section .rodata,"a"
.p2align 6
.amdhsa_kernel recurrent_scan__linear_kernel_hedgehog__moe_arch_mod__prompt_kernel
  .amdhsa_next_free_vgpr 256
  .amdhsa_next_free_sgpr 102
  .amdhsa_accum_offset 256
  .amdhsa_group_segment_fixed_size 0
  .amdhsa_kernarg_size 96
  .amdhsa_user_sgpr_count 2
  .amdhsa_user_sgpr_kernarg_segment_ptr 1
  .amdhsa_system_sgpr_workgroup_id_x 1
.end_amdhsa_kernel
```

```asm
; @launch grid=(256,1,1) block=(512,1,1) lds=163840
.amdgcn_target "amdgcn-amd-amdhsa--gfx950"
.text
.globl recurrent_scan__linear_kernel_hedgehog__moe_arch_mod__prompt_kernel
.p2align 8
.type recurrent_scan__linear_kernel_hedgehog__moe_arch_mod__prompt_kernel,@function
recurrent_scan__linear_kernel_hedgehog__moe_arch_mod__prompt_kernel:
    s_cmp_ge_u32 s2, 256
    s_cbranch_scc1 L_done
    s_load_dwordx16 s[4:19], s[0:1], 0
    s_load_dwordx8 s[20:27], s[0:1], 64
    v_and_b32 v1, 63, v0
    v_lshrrev_b32 v2, 6, v0
    s_nop 0
    v_readfirstlane_b32 s39, v2
    s_and_b32 s34, s2, 1
    s_lshl_b32 s34, s34, 3
    s_bfe_u32 s3, s2, 0x30003
    s_add_u32 s36, s34, s3
    s_bfe_u32 s37, s2, 0x20001
    s_lshl_b32 s37, s37, 2
    s_lshr_b32 s28, s2, 6
    s_add_u32 s37, s37, s28
    s_and_b32 s80, s37, 12
    s_xor_b32 s80, s80, s34
    s_add_u32 s85, s36, s37
    s_and_b32 s85, s85, 3
    s_or_b32 s35, s80, s85
    s_mov_b32 s34, s36
    s_and_b32 s38, s39, 3
    s_cmp_lt_u32 s39, 4
    s_cbranch_scc1 L_C
L_H:
    v_and_b32 v4, 7, v1
    s_lshl_b32 s33, s37, 7
    s_lshl_b32 s87, s85, 7
    s_lshl_b32 s66, s80, 7
    s_lshl_b32 s30, s38, 12
    s_waitcnt lgkmcnt(0)
    s_mov_b32 s40, s4
    s_mov_b32 s41, s5
    s_mov_b32 s42, 4194304
    s_mov_b32 s43, 0x00020000
    v_lshlrev_b32_e64 v252, 4, v1
    s_mov_b32 s48, s26
    s_mov_b32 s49, s27
    s_mov_b32 s50, 268435456
    s_mov_b32 s51, 0x00020000
    v_mov_b32 v19, 16384
    buffer_load_dword v19, v19, s[48:51], 0 offen sc1
    s_lshl_b32 s3, s36, 7
    s_lshl_b32 s28, s37, 3
    s_add_u32 s3, s3, s28
    s_lshl_b32 s3, s3, 11
    s_add_u32 s3, s3, s30
    s_add_u32 m0, s30, 131072
    s_nop 0
    buffer_load_dwordx4 v252, s[40:43], s3 offen offset:0 lds
    buffer_load_dwordx4 v252, s[40:43], s3 offen offset:2048 lds
    s_lshl_b32 s3, s36, 7
    s_lshl_b32 s28, s37, 3
    s_add_u32 s3, s3, s28
    s_lshl_b32 s3, s3, 11
    s_add_u32 s3, s3, s30
    s_add_u32 m0, s30, 131072
    s_nop 0
    buffer_load_dwordx4 v252, s[40:43], s3 offen offset:1024 lds
    buffer_load_dwordx4 v252, s[40:43], s3 offen offset:3072 lds
    s_mov_b32 s60, s14
    s_mov_b32 s61, s15
    s_mov_b32 s62, 2048
    s_mov_b32 s63, 0x00020000
    s_lshl_b32 s3, s38, 9
    s_add_u32 m0, s3, 122880
    s_mov_b32 exec_hi, 0
    buffer_load_dwordx4 v252, s[60:63], s3 offen lds
    s_mov_b64 exec, -1
    s_lshr_b32 s32, s36, 1
    s_and_b32 s32, s32, 2
    s_xor_b32 s32, s32, s38
    v_lshrrev_b32 v3, 3, v1
    s_lshl_b32 s3, s32, 4
    v_add_u32_e64 v7, s3, v3
    v_mul_u32_u24 v7, 6144, v7
    v_bfe_u32 v6, v1, 4, 1
    v_lshlrev_b32 v6, 1, v6
    v_xor_b32 v5, v4, v6
    v_add_u32 v7, s33, v7
    v_xor_b32 v6, 4, v5
    v_lshl_add_u32 v6, v6, 4, v7
    v_lshl_add_u32 v7, v5, 4, v7
    v_add_u32_e64 v12, 0, v7
    v_add_u32 v13, 48128, v6
    v_add_u32 v14, 2048, v7
    v_add_u32 v15, 50176, v6
    v_add_u32 v16, 4096, v7
    v_add_u32 v17, 52224, v6
    v_xor_b32 v12, 512, v12
    v_xor_b32 v13, 512, v13
    s_lshl_b32 s31, s32, 11
    s_add_u32 s31, s31, 16384
    s_mov_b32 s44, s6
    s_mov_b32 s45, s7
    s_mov_b32 s46, 6291456
    s_mov_b32 s47, 0x00020000
    s_add_u32 s64, s87, 0
    s_and_b32 s64, s64, 511
    s_or_b32 s64, s64, 0
    s_xor_b32 s64, s64, s66
    s_mul_i32 s65, s64, 3072
    s_add_u32 m0, s31, 0
    s_nop 0
    buffer_load_dwordx4 v12, s[44:47], s65 offen offset:0 lds
    buffer_load_dwordx4 v13, s[44:47], s65 offen offset:1024 lds
    s_add_u32 m0, s31, 8192
    s_nop 0
    buffer_load_dwordx4 v14, s[44:47], s65 offen offset:0 lds
    buffer_load_dwordx4 v15, s[44:47], s65 offen offset:1024 lds
    s_add_u32 m0, s31, 16384
    s_nop 0
    buffer_load_dwordx4 v16, s[44:47], s65 offen offset:0 lds
    buffer_load_dwordx4 v17, s[44:47], s65 offen offset:1024 lds
    s_lshl_b32 s3, s36, 7
    s_lshl_b32 s28, s38, 5
    s_add_u32 s3, s3, s28
    v_add_u32 v3, s3, v3
    v_lshlrev_b32 v3, 11, v3
    v_lshrrev_b32 v5, 4, v1
    v_xor_b32 v6, v4, v5
    v_xor_b32 v5, 4, v6
    v_lshl_add_u32 v6, v6, 4, v3
    v_lshl_add_u32 v5, v5, 4, v3
    v_add_u32_e64 v8, 0, v6
    v_add_u32 v9, 15360, v5
    v_add_u32 v10, 30720, v6
    v_add_u32 v11, 46080, v5
    v_mov_b32 v248, -1
    v_mov_b32 v249, -1
    v_mov_b32 v250, -1
    v_mov_b32 v251, -1
    v_lshlrev_b32 v252, 4, v1
    s_and_b32 s85, s85, 0
    s_lshl_b32 s3, s37, 4
    s_add_u32 s3, s3, s36
    s_lshl_b32 s67, s3, 10
    s_add_u32 s67, s67, 524288
    s_lshl_b32 s3, s38, 8
    s_add_u32 s67, s67, s3
    v_mov_b32 v24, 0
    v_mov_b32 v25, 0
    v_mov_b32 v26, 0
    v_mov_b32 v27, 0
    v_mov_b32 v28, 0
    v_mov_b32 v29, 0
    v_mov_b32 v30, 0
    v_mov_b32 v31, 0
    v_lshlrev_b32 v253, 2, v1
    s_cmp_gt_u32 s37, 3
    s_subb_u32 s77, s37, 0
    s_cmp_gt_u32 s37, 11
    s_subb_u32 s77, s77, 0
    s_lshl_b32 s77, s77, 4
    s_add_u32 s77, s77, s36
    s_and_b32 s3, s37, 7
    s_cmp_eq_u32 s3, 3
    s_cselect_b32 s77, 224, s77
    s_bitcmp1_b32 s38, 0
    s_cselect_b32 s52, s18, s16
    s_cselect_b32 s53, s19, s17
    s_cmp_lt_u32 s77, 224
    s_cselect_b32 s54, 7340032, 0
    s_mov_b32 s55, 0x00020000
    s_mov_b32 s56, s20
    s_mov_b32 s57, s21
    s_mov_b32 s58, 7340032
    s_mov_b32 s59, 0x00020000
    s_and_b32 s3, s77, 3
    s_lshl_b32 s3, s3, 8
    s_lshr_b32 s28, s38, 1
    s_lshl_b32 s28, s28, 7
    s_add_u32 s3, s3, s28
    v_lshrrev_b32_e64 v5, 3, v1
    v_lshl_add_u32 v6, v5, 4, s3
    v_mul_u32_u24 v6, 7168, v6
    v_lshl_add_u32 v6, v4, 4, v6
    s_lshr_b32 s3, s77, 2
    s_lshl_b32 s3, s3, 7
    v_add_u32 v21, s3, v6
    s_lshr_b32 s3, s2, 4
    s_mul_i32 s3, s3, 224
    s_mul_i32 s28, s38, 56
    s_add_u32 s71, s3, s28
    v_lshlrev_b32 v6, 14, v5
    v_lshl_add_u32 v6, v4, 4, v6
    s_and_b32 s3, s2, 15
    s_lshl_b32 s3, s3, 7
    v_add_u32 v22, s3, v6
    s_mov_b32 s94, 1985229328
    s_mov_b32 s95, 4275878552
    s_cmp_eq_u32 s87, 128
    s_cselect_b32 s94, 1989161553, s94
    s_cselect_b32 s95, 3488135892, s95
    s_cmp_eq_u32 s87, 256
    s_cselect_b32 s94, 2052130354, s94
    s_cselect_b32 s95, 3487088276, s95
    s_cmp_eq_u32 s87, 384
    s_cselect_b32 s94, 3058856195, s94
    s_cselect_b32 s95, 3470326420, s95
    v_lshrrev_b32 v2, 2, v1
    v_and_b32 v3, 3, v1
    v_lshlrev_b32 v3, 4, v3
    v_lshl_add_u32 v232, v2, 10, v3
    v_lshlrev_b32 v2, 3, v1
    v_add_u32 v230, 152064, v2
    v_and_b32_e64 v4, 49, v1
    v_bfe_u32 v7, v1, 1, 2
    v_lshl_add_u32 v4, v7, 2, v4
    v_bfe_u32 v7, v1, 3, 1
    v_lshl_add_u32 v4, v7, 1, v4
    v_lshlrev_b32 v4, 2, v4
    v_add_u32 v231, 154624, v4
    s_lshl_b32 s3, s38, 1
    s_lshr_b32 s28, s39, 2
    s_add_u32 s3, s3, s28
    s_lshl_b32 s69, s3, 4
    v_and_b32 v2, 15, v1
    v_add_u32 v23, s69, v2
    v_lshlrev_b32 v23, 7, v23
    v_lshrrev_b32 v2, 1, v2
    v_lshrrev_b32 v3, 5, v1
    v_xor_b32_e64 v2, v2, v3
    v_lshl_add_u32 v23, v2, 4, v23
    v_bfe_u32 v3, v1, 4, 1
    v_lshl_add_u32 v23, v3, 3, v23
    v_bfe_u32 v5, v1, 4, 1
    v_lshlrev_b32 v5, 5, v5
    v_xor_b32 v5, v5, v252
    s_min_u32 s3, s38, 2
    s_lshl_b32 s3, s3, 13
    s_and_b32 s28, s36, 4
    s_lshl_b32 s28, s28, 10
    s_add_u32 s3, s3, s28
    s_add_u32 s3, s3, 16384
    v_add_u32 v18, s3, v5
    s_lshr_b32 s3, s38, 1
    s_lshl_b32 s28, s37, 1
    s_add_u32 s28, s28, s3
    s_and_b32 s29, s38, 1
    s_lshl_b32 s3, s28, 4
    s_add_u32 s3, s3, s36
    s_mul_i32 s3, s3, 4224
    s_mul_i32 s78, s29, 2112
    s_add_u32 s78, s78, s3
    s_add_u32 s78, s78, 8388608
    s_lshl_b32 s3, s36, 1
    s_add_u32 s29, s29, s3
    s_xor_b32 s28, s28, 8
    s_lshl_b32 s3, s29, 7
    s_add_u32 s3, s3, s28
    s_lshl_b32 s3, s3, 10
    s_add_u32 s79, s3, 4194304
    s_mov_b32 s88, s10
    s_mov_b32 s89, s11
    s_mov_b32 s90, 2097152
    s_mov_b32 s91, 0x00020000
    s_add_u32 s64, s87, 0
    s_and_b32 s64, s64, 511
    s_or_b32 s64, s64, 0
    s_xor_b32 s64, s64, s66
    s_mul_i32 s65, s64, 3072
    s_add_u32 m0, s30, 0
    s_nop 0
    buffer_load_dwordx4 v8, s[40:43], s64 offen offset:0 lds
    buffer_load_dwordx4 v9, s[40:43], s64 offen offset:1024 lds
    buffer_load_dwordx4 v10, s[40:43], s64 offen offset:2048 lds
    buffer_load_dwordx4 v11, s[40:43], s64 offen offset:3072 lds
    s_waitcnt vmcnt(10)
    s_barrier
    s_bfe_u32 s64, s94, 262148
    s_lshl_b32 s64, s64, 7
    s_xor_b32 s64, s64, s66
    s_mul_i32 s65, s64, 3072
    s_add_u32 m0, s30, 40960
    s_nop 0
    buffer_load_dwordx4 v8, s[40:43], s64 offen offset:0 lds
    buffer_load_dwordx4 v9, s[40:43], s64 offen offset:1024 lds
    buffer_load_dwordx4 v10, s[40:43], s64 offen offset:2048 lds
    buffer_load_dwordx4 v11, s[40:43], s64 offen offset:3072 lds
    s_add_u32 m0, s31, 40960
    s_nop 0
    buffer_load_dwordx4 v12, s[44:47], s65 offen offset:0 lds
    buffer_load_dwordx4 v13, s[44:47], s65 offen offset:1024 lds
    s_add_u32 m0, s31, 49152
    s_nop 0
    buffer_load_dwordx4 v14, s[44:47], s65 offen offset:0 lds
    buffer_load_dwordx4 v15, s[44:47], s65 offen offset:1024 lds
    s_add_u32 m0, s31, 57344
    s_nop 0
    buffer_load_dwordx4 v16, s[44:47], s65 offen offset:0 lds
    buffer_load_dwordx4 v17, s[44:47], s65 offen offset:1024 lds
    v_readfirstlane_b32 s86, v19
    s_nop 0
    s_mul_i32 s86, s86, 1664525
    s_add_u32 s86, s86, 1013904223
    s_setprio 3
    s_waitcnt vmcnt(10)
    s_waitcnt lgkmcnt(0)
    s_barrier
    s_bfe_u32 s64, s94, 262152
    s_lshl_b32 s64, s64, 7
    s_xor_b32 s64, s64, s66
    s_mul_i32 s65, s64, 3072
    s_add_u32 m0, s30, 81920
    s_nop 0
    buffer_load_dwordx4 v8, s[40:43], s64 offen offset:0 lds
    buffer_load_dwordx4 v9, s[40:43], s64 offen offset:1024 lds
    buffer_load_dwordx4 v10, s[40:43], s64 offen offset:2048 lds
    buffer_load_dwordx4 v11, s[40:43], s64 offen offset:3072 lds
    s_add_u32 m0, s31, 81920
    s_nop 0
    buffer_load_dwordx4 v12, s[44:47], s65 offen offset:0 lds
    buffer_load_dwordx4 v13, s[44:47], s65 offen offset:1024 lds
    s_add_u32 m0, s31, 90112
    s_nop 0
    buffer_load_dwordx4 v14, s[44:47], s65 offen offset:0 lds
    buffer_load_dwordx4 v15, s[44:47], s65 offen offset:1024 lds
    s_add_u32 m0, s31, 98304
    s_nop 0
    buffer_load_dwordx4 v16, s[44:47], s65 offen offset:0 lds
    buffer_load_dwordx4 v17, s[44:47], s65 offen offset:1024 lds
    v_xor_b32 v4, 0, v23
    ds_read_b64 v[240:241], v4
    v_xor_b32 v5, 32, v23
    ds_read_b64 v[242:243], v5
    v_xor_b32_e64 v6, 64, v23
    ds_read_b64 v[244:245], v6
    v_xor_b32 v7, 96, v23
    ds_read_b64 v[246:247], v7
    v_add_u32 v2, 0, v18
    v_xor_b32 v3, 64, v2
    ds_read_b128 v[32:35], v2 offset:0
    ds_read_b128 v[36:39], v3 offset:1024
    ds_read_b128 v[40:43], v2 offset:2048
    ds_read_b128 v[44:47], v3 offset:3072
    buffer_store_dwordx4 v[248:251], v252, s[48:51], s78 offen offset:0 sc1
    s_waitcnt vmcnt(11)
    s_waitcnt lgkmcnt(0)
    s_barrier
    s_cmp_eq_u32 s87, 0
    s_cbranch_scc1 L_nc1
    s_cmp_eq_u32 s87, 256
    s_cbranch_scc1 L_nc1
    s_cmp_eq_u32 s87, 384
    s_cbranch_scc1 L_nc1
    v_add_u32 v2, 40960, v18
    v_xor_b32 v3, 64, v2
    ds_read_b128 v[48:51], v2 offset:0
    ds_read_b128 v[52:55], v3 offset:1024
    ds_read_b128 v[56:59], v2 offset:2048
    ds_read_b128 v[60:63], v3 offset:3072
L_nc1:
    s_bfe_u32 s64, s94, 262156
    s_lshl_b32 s64, s64, 7
    s_xor_b32 s64, s64, s66
    s_mul_i32 s65, s64, 3072
    s_add_u32 m0, s30, 0
    s_nop 0
    buffer_load_dwordx4 v8, s[40:43], s64 offen offset:0 lds
    buffer_load_dwordx4 v9, s[40:43], s64 offen offset:1024 lds
    v_lshlrev_b32 v2, 16, v32
    v_and_b32 v3, 0xffff0000, v32
    v_add_f32 v24, v24, v2
    v_add_f32 v25, v25, v3
    buffer_load_dwordx4 v10, s[40:43], s64 offen offset:2048 lds
    v_lshlrev_b32 v4, 16, v33
    v_and_b32 v5, 0xffff0000, v33
    v_add_f32 v26, v26, v4
    v_add_f32 v27, v27, v5
    buffer_load_dwordx4 v11, s[40:43], s64 offen offset:3072 lds
    v_lshlrev_b32 v2, 16, v34
    v_and_b32 v3, 0xffff0000, v34
    v_add_f32 v28, v28, v2
    v_add_f32 v29, v29, v3
    s_add_u32 m0, s31, 0
    s_nop 0
    buffer_load_dwordx4 v12, s[44:47], s65 offen offset:0 lds
    v_lshlrev_b32 v4, 16, v35
    v_and_b32 v5, 0xffff0000, v35
    v_add_f32 v30, v30, v4
    v_add_f32 v31, v31, v5
    buffer_load_dwordx4 v13, s[44:47], s65 offen offset:1024 lds
    v_lshlrev_b32 v2, 16, v36
    v_and_b32 v3, 0xffff0000, v36
    v_add_f32 v24, v24, v2
    v_add_f32 v25, v25, v3
    s_add_u32 m0, s31, 8192
    s_nop 0
    buffer_load_dwordx4 v14, s[44:47], s65 offen offset:0 lds
    v_lshlrev_b32 v4, 16, v37
    v_and_b32 v5, 0xffff0000, v37
    v_add_f32 v26, v26, v4
    v_add_f32 v27, v27, v5
    buffer_load_dwordx4 v15, s[44:47], s65 offen offset:1024 lds
    v_lshlrev_b32 v2, 16, v38
    v_and_b32 v3, 0xffff0000, v38
    v_add_f32 v28, v28, v2
    v_add_f32 v29, v29, v3
    s_add_u32 m0, s31, 16384
    s_nop 0
    buffer_load_dwordx4 v16, s[44:47], s65 offen offset:0 lds
    v_lshlrev_b32 v4, 16, v39
    v_and_b32 v5, 0xffff0000, v39
    v_add_f32 v30, v30, v4
    v_add_f32 v31, v31, v5
    buffer_load_dwordx4 v17, s[44:47], s65 offen offset:1024 lds
    buffer_store_dwordx4 v[248:251], v252, s[48:51], s78 offen offset:1024 sc1
    s_mov_b64 exec, 15
    buffer_store_dwordx4 v[248:251], v252, s[48:51], s78 offen offset:2048 sc1
    s_mov_b64 exec, -1
    s_waitcnt vmcnt(13)
    s_waitcnt lgkmcnt(0)
    s_barrier
    s_cmp_eq_u32 s87, 0
    s_cbranch_scc1 L_nc2
    s_cmp_eq_u32 s87, 128
    s_cbranch_scc1 L_nc2
    s_cmp_eq_u32 s87, 384
    s_cbranch_scc1 L_nc2
    v_add_u32 v2, 81920, v18
    v_xor_b32 v3, 64, v2
    ds_read_b128 v[48:51], v2 offset:0
    ds_read_b128 v[52:55], v3 offset:1024
    ds_read_b128 v[56:59], v2 offset:2048
    ds_read_b128 v[60:63], v3 offset:3072
L_nc2:
    s_bfe_u32 s64, s94, 262160
    s_lshl_b32 s64, s64, 7
    s_xor_b32 s64, s64, s66
    s_mul_i32 s65, s64, 3072
    s_add_u32 m0, s30, 40960
    s_nop 0
    buffer_load_dwordx4 v8, s[40:43], s64 offen offset:0 lds
    buffer_load_dwordx4 v9, s[40:43], s64 offen offset:1024 lds
    v_lshlrev_b32 v2, 16, v40
    v_and_b32 v3, 0xffff0000, v40
    v_add_f32 v24, v24, v2
    v_add_f32 v25, v25, v3
    buffer_load_dwordx4 v10, s[40:43], s64 offen offset:2048 lds
    v_lshlrev_b32 v4, 16, v41
    v_and_b32 v5, 0xffff0000, v41
    v_add_f32 v26, v26, v4
    v_add_f32 v27, v27, v5
    buffer_load_dwordx4 v11, s[40:43], s64 offen offset:3072 lds
    v_lshlrev_b32 v2, 16, v42
    v_and_b32 v3, 0xffff0000, v42
    v_add_f32 v28, v28, v2
    v_add_f32 v29, v29, v3
    s_add_u32 m0, s31, 40960
    s_nop 0
    buffer_load_dwordx4 v12, s[44:47], s65 offen offset:0 lds
    v_lshlrev_b32 v4, 16, v43
    v_and_b32 v5, 0xffff0000, v43
    v_add_f32 v30, v30, v4
    v_add_f32 v31, v31, v5
    buffer_load_dwordx4 v13, s[44:47], s65 offen offset:1024 lds
    v_lshlrev_b32 v2, 16, v44
    v_and_b32 v3, 0xffff0000, v44
    v_add_f32 v24, v24, v2
    v_add_f32 v25, v25, v3
    s_add_u32 m0, s31, 49152
    s_nop 0
    buffer_load_dwordx4 v14, s[44:47], s65 offen offset:0 lds
    v_lshlrev_b32 v4, 16, v45
    v_and_b32 v5, 0xffff0000, v45
    v_add_f32 v26, v26, v4
    v_add_f32 v27, v27, v5
    buffer_load_dwordx4 v15, s[44:47], s65 offen offset:1024 lds
    v_lshlrev_b32 v2, 16, v46
    v_and_b32 v3, 0xffff0000, v46
    v_add_f32 v28, v28, v2
    v_add_f32 v29, v29, v3
    s_add_u32 m0, s31, 57344
    s_nop 0
    buffer_load_dwordx4 v16, s[44:47], s65 offen offset:0 lds
    v_lshlrev_b32 v4, 16, v47
    v_and_b32 v5, 0xffff0000, v47
    v_add_f32 v30, v30, v4
    v_add_f32 v31, v31, v5
    buffer_load_dwordx4 v17, s[44:47], s65 offen offset:1024 lds
    s_waitcnt vmcnt(12)
    s_waitcnt lgkmcnt(0)
    s_barrier
    s_cmp_eq_u32 s87, 0
    s_cbranch_scc1 L_nc3
    s_cmp_eq_u32 s87, 128
    s_cbranch_scc1 L_nc3
    s_cmp_eq_u32 s87, 256
    s_cbranch_scc1 L_nc3
    v_add_u32 v2, 0, v18
    v_xor_b32_e64 v3, 64, v2
    ds_read_b128 v[48:51], v2 offset:0
    ds_read_b128 v[52:55], v3 offset:1024
    ds_read_b128 v[56:59], v2 offset:2048
    ds_read_b128 v[60:63], v3 offset:3072
L_nc3:
    s_bfe_u32 s64, s94, 262164
    s_lshl_b32 s64, s64, 7
    s_xor_b32 s64, s64, s66
    s_mul_i32 s65, s64, 3072
    s_add_u32 m0, s30, 81920
    s_nop 0
    buffer_load_dwordx4 v8, s[40:43], s64 offen offset:0 lds
    buffer_load_dwordx4 v9, s[40:43], s64 offen offset:1024 lds
    buffer_load_dwordx4 v10, s[40:43], s64 offen offset:2048 lds
    buffer_load_dwordx4 v11, s[40:43], s64 offen offset:3072 lds
    s_add_u32 m0, s31, 81920
    s_nop 0
    buffer_load_dwordx4 v12, s[44:47], s65 offen offset:0 lds
    buffer_load_dwordx4 v13, s[44:47], s65 offen offset:1024 lds
    s_add_u32 m0, s31, 90112
    s_nop 0
    buffer_load_dwordx4 v14, s[44:47], s65 offen offset:0 lds
    buffer_load_dwordx4 v15, s[44:47], s65 offen offset:1024 lds
    s_add_u32 m0, s31, 98304
    s_nop 0
    buffer_load_dwordx4 v16, s[44:47], s65 offen offset:0 lds
    buffer_load_dwordx4 v17, s[44:47], s65 offen offset:1024 lds
    s_lshl_b32 s3, s36, 10
    buffer_load_dwordx4 v[72:75], v252, s[48:51], s3 offen sc1
    s_lshl_b32 s3, s37, 6
    buffer_load_dword v76, v232, s[48:51], s3 offen offset:12 sc1
    s_mov_b32 s60, s8
    s_mov_b32 s61, s9
    s_mov_b32 s62, 65536
    s_mov_b32 s63, 0x00020000
    s_lshl_b32 s3, s38, 10
    s_add_u32 m0, s3, 147712
    s_lshl_b32 s28, s37, 12
    s_add_u32 s3, s3, s28
    buffer_load_dwordx4 v252, s[60:63], s3 offen lds
    s_add_u32 m0, m0, 8192
    s_xor_b32 s3, s3, 16384
    buffer_load_dwordx4 v252, s[60:63], s3 offen lds
    s_lshl_b32 s3, s2, 13
    s_lshl_b32 s28, s38, 11
    s_add_u32 s3, s3, s28
    v_lshlrev_b32_e64 v3, 7, v1
    s_mov_b64 exec, 0xffff
    buffer_load_dword v20, v3, s[88:91], s3 offen
    s_mov_b64 exec, -1
    s_mov_b32 s3, 0
    buffer_load_dwordx4 v[128:131], v21, s[52:55], s3 offen nt
    s_mov_b32 s3, 7168
    buffer_load_dwordx4 v[132:135], v21, s[52:55], s3 offen nt
    s_mov_b32 s3, 14336
    buffer_load_dwordx4 v[136:139], v21, s[52:55], s3 offen nt
    s_mov_b32 s3, 21504
    buffer_load_dwordx4 v[140:143], v21, s[52:55], s3 offen nt
    s_waitcnt vmcnt(19)
    s_waitcnt lgkmcnt(0)
    s_barrier
    s_mul_i32 s3, s38, 48
    v_and_b32 v2, 15, v1
    v_lshrrev_b32 v3, 4, v1
    v_cmp_gt_u32 vcc, 12, v2
    v_lshl_add_u32 v4, v2, 2, s3
    v_add_u32 v2, v4, v3
    v_mov_b32 v5, 192
    v_cndmask_b32 v4, v5, v4, vcc
    v_lshlrev_b32 v4, 2, v4
    v_lshl_add_u32 v235, v3, 10, v4
    v_and_b32_e64 v5, 7, v2
    v_bfe_u32 v6, v2, 3, 3
    v_lshl_add_u32 v5, v5, 3, v6
    v_and_b32 v2, 0xc0, v2
    v_add_u32 v2, v2, v5
    v_lshlrev_b32 v2, 2, v2
    v_add_u32 v2, 154880, v2
    v_mov_b32 v5, 162048
    v_cndmask_b32 v233, v5, v2, vcc
    v_lshrrev_b32 v5, 3, v1
    v_lshlrev_b32 v6, 11, v5
    v_bfe_u32 v5, v1, 4, 2
    v_lshlrev_b32 v5, 1, v5
    v_and_b32 v7, 7, v1
    v_xor_b32 v5, v5, v7
    v_lshl_add_u32 v6, v5, 4, v6
    s_lshl_b32 s3, s35, 7
    v_add_u32 v6, s3, v6
    v_add_u32_e64 v220, 0, v6
    v_add_u32 v221, 15360, v6
    v_add_u32 v222, 30720, v6
    v_add_u32 v223, 46080, v6
    s_lshl_b32 s72, s38, 12
    s_lshl_b32 s73, s38, 16
    s_and_b32 s3, s36, 0
    s_lshl_b32 s3, s3, 18
    s_or_b32 s73, s73, s3
    s_lshl_b32 s3, s36, 2
    s_add_u32 s3, s3, s38
    s_lshr_b32 s28, s3, 5
    s_and_b32 s3, s3, 31
    s_lshl_b32 s74, s3, 7
    s_lshl_b32 s3, s37, 1
    s_add_u32 s75, s3, s28
    s_xor_b32 s75, s75, 0
    v_lshrrev_b32 v5, 3, v1
    v_mul_u32_u24 v5, 4224, v5
    v_and_b32_e64 v7, 7, v1
    v_lshl_add_u32 v112, v7, 4, v5
    v_bfe_u32 v5, v1, 3, 1
    s_mov_b32 s28, 626688
    v_mul_lo_u32 v5, v5, s28
    v_lshl_add_u32 v114, v7, 4, v5
    s_mul_i32 s76, s75, 67584
    s_add_u32 s76, s76, s74
    s_add_u32 s76, s76, 8388608
    s_mul_i32 s3, s75, 4224
    s_add_u32 s3, s3, s74
    s_add_u32 s74, s3, 1048576
    s_xor_b32 s75, s37, 0
    s_lshl_b32 s75, s75, 1
    s_add_u32 s75, s75, s36
    s_mul_i32 s81, s75, 67584
    s_add_u32 s81, s81, 8392704
    s_mul_i32 s82, s75, 4224
    s_add_u32 s82, s82, 1052672
    s_lshr_b32 s3, s36, 1
    s_or_b32 s83, s3, s38
    s_and_b32 s3, s38, 1
    s_lshl_b32 s3, s3, 3
    s_and_b32 s28, s77, 3
    s_lshl_b32 s28, s28, 1
    s_add_u32 s3, s3, s28
    s_lshr_b32 s28, s38, 1
    s_add_u32 s3, s3, s28
    s_mul_i32 s3, s3, 14336
    s_lshr_b32 s28, s77, 2
    s_lshl_b32 s28, s28, 8
    s_add_u32 s3, s3, s28
    s_add_u32 s3, s3, 1183744
    s_cmp_lt_u32 s77, 224
    s_cselect_b32 s84, s3, 268435456
    v_and_b32 v2, 15, v1
    v_bfe_u32 v3, v1, 4, 1
    v_mul_u32_u24 v3, 4, v3
    v_xor_b32 v3, s37, v3
    v_xor_b32_e64 v3, 0, v3
    v_lshl_add_u32 v3, v3, 4, v2
    v_lshl_add_u32 v2, v2, 4, s34
    v_lshrrev_b32 v4, 1, v1
    v_and_b32 v4, 8, v4
    v_xor_b32 v2, v2, v4
    v_cmp_gt_u32 vcc, 32, v1
    s_nop 1
    v_cndmask_b32 v2, v2, v3, vcc
    v_lshlrev_b32 v113, 7, v2
    s_cmp_eq_u32 s87, 128
    s_cbranch_scc1 L_nc4
    s_cmp_eq_u32 s87, 256
    s_cbranch_scc1 L_nc4
    s_cmp_eq_u32 s87, 384
    s_cbranch_scc1 L_nc4
    v_add_u32 v2, 40960, v18
    v_xor_b32_e64 v3, 64, v2
    ds_read_b128 v[48:51], v2 offset:0
    ds_read_b128 v[52:55], v3 offset:1024
    ds_read_b128 v[56:59], v2 offset:2048
    ds_read_b128 v[60:63], v3 offset:3072
L_nc4:
    s_waitcnt vmcnt(7)
    s_mov_b32 s29, 0
L_k1:
    v_cmp_ne_u32 vcc, s86, v75
    v_cmp_ne_u32 s[92:93], s86, v76
    s_nop 0
    s_or_b64 vcc, vcc, s[92:93]
    s_cbranch_vccz L_k1k
    s_add_u32 s29, s29, 1
    s_cmp_ge_u32 s29, 200000
    s_cbranch_scc1 L_k1k
    s_sleep 2
    s_lshl_b32 s3, s36, 10
    buffer_load_dwordx4 v[72:75], v252, s[48:51], s3 offen sc1
    s_lshl_b32 s3, s37, 6
    buffer_load_dword v76, v232, s[48:51], s3 offen offset:12 sc1
    s_waitcnt vmcnt(0)
    s_branch L_k1
L_k1k:
    v_max_u32 v74, v74, v74 quad_perm:[1,0,3,2] row_mask:0xf bank_mask:0xf
    s_nop 1
    v_max_u32 v74, v74, v74 quad_perm:[2,3,0,1] row_mask:0xf bank_mask:0xf
    s_nop 1
    v_max_u32 v74, v74, v74 row_half_mirror row_mask:0xf bank_mask:0xf
    s_nop 1
    v_max_u32 v74, v74, v74 row_mirror row_mask:0xf bank_mask:0xf
    v_and_b32 v2, 0xffff0000, v72
    v_lshlrev_b32 v224, 16, v72
    v_and_b32 v3, 0xffff0000, v73
    v_lshlrev_b32 v225, 16, v73
    v_rcp_f32 v226, v2
    v_rcp_f32 v227, v3
    v_lshrrev_b32 v2, 16, v2
    v_or_b32 v236, v2, v3
    v_mul_f32 v228, 1069066811, v226
    v_mul_f32 v229, 1069066811, v227
    v_readlane_b32 s70, v74, 0
    v_readlane_b32 s3, v74, 16
    v_readlane_b32 s28, v74, 32
    v_readlane_b32 s29, v74, 48
    s_max_u32 s70, s70, s3
    s_max_u32 s28, s28, s29
    s_max_u32 s70, s70, s28
    s_bfe_u32 s64, s94, 262168
    s_lshl_b32 s64, s64, 7
    s_xor_b32 s64, s64, s66
    s_mul_i32 s65, s64, 3072
    s_add_u32 m0, s30, 0
    s_nop 0
    buffer_load_dwordx4 v8, s[40:43], s64 offen offset:0 lds
    buffer_load_dwordx4 v9, s[40:43], s64 offen offset:1024 lds
    buffer_load_dwordx4 v10, s[40:43], s64 offen offset:2048 lds
    buffer_load_dwordx4 v11, s[40:43], s64 offen offset:3072 lds
    s_add_u32 m0, s31, 0
    s_nop 0
    buffer_load_dwordx4 v12, s[44:47], s65 offen offset:0 lds
    buffer_load_dwordx4 v13, s[44:47], s65 offen offset:1024 lds
    s_add_u32 m0, s31, 8192
    s_nop 0
    buffer_load_dwordx4 v14, s[44:47], s65 offen offset:0 lds
    buffer_load_dwordx4 v15, s[44:47], s65 offen offset:1024 lds
    s_add_u32 m0, s31, 16384
    s_nop 0
    buffer_load_dwordx4 v16, s[44:47], s65 offen offset:0 lds
    buffer_load_dwordx4 v17, s[44:47], s65 offen offset:1024 lds
    s_waitcnt lgkmcnt(0)
    s_barrier
    s_bfe_u32 s64, s94, 262172
    s_lshl_b32 s64, s64, 7
    s_xor_b32 s64, s64, s66
    s_mul_i32 s65, s64, 3072
    s_add_u32 m0, s30, 40960
    s_nop 0
    buffer_load_dwordx4 v8, s[40:43], s64 offen offset:0 lds
    buffer_load_dwordx4 v9, s[40:43], s64 offen offset:1024 lds
    v_lshlrev_b32 v2, 16, v48
    v_and_b32 v3, 0xffff0000, v48
    v_add_f32 v24, v24, v2
    v_add_f32 v25, v25, v3
    buffer_load_dwordx4 v10, s[40:43], s64 offen offset:2048 lds
    v_lshlrev_b32 v4, 16, v49
    v_and_b32 v5, 0xffff0000, v49
    v_add_f32 v26, v26, v4
    v_add_f32 v27, v27, v5
    buffer_load_dwordx4 v11, s[40:43], s64 offen offset:3072 lds
    v_lshlrev_b32 v2, 16, v50
    v_and_b32 v3, 0xffff0000, v50
    v_add_f32 v28, v28, v2
    v_add_f32 v29, v29, v3
    s_add_u32 m0, s31, 40960
    s_nop 0
    buffer_load_dwordx4 v12, s[44:47], s65 offen offset:0 lds
    v_lshlrev_b32 v4, 16, v51
    v_and_b32 v5, 0xffff0000, v51
    v_add_f32 v30, v30, v4
    v_add_f32 v31, v31, v5
    buffer_load_dwordx4 v13, s[44:47], s65 offen offset:1024 lds
    v_lshlrev_b32 v2, 16, v52
    v_and_b32 v3, 0xffff0000, v52
    v_add_f32 v24, v24, v2
    v_add_f32 v25, v25, v3
    s_add_u32 m0, s31, 49152
    s_nop 0
    buffer_load_dwordx4 v14, s[44:47], s65 offen offset:0 lds
    v_lshlrev_b32 v4, 16, v53
    v_and_b32 v5, 0xffff0000, v53
    v_add_f32 v26, v26, v4
    v_add_f32 v27, v27, v5
    buffer_load_dwordx4 v15, s[44:47], s65 offen offset:1024 lds
    v_lshlrev_b32 v2, 16, v54
    v_and_b32 v3, 0xffff0000, v54
    v_add_f32 v28, v28, v2
    v_add_f32 v29, v29, v3
    s_add_u32 m0, s31, 57344
    s_nop 0
    buffer_load_dwordx4 v16, s[44:47], s65 offen offset:0 lds
    v_lshlrev_b32 v4, 16, v55
    v_and_b32 v5, 0xffff0000, v55
    v_add_f32 v30, v30, v4
    v_add_f32 v31, v31, v5
    buffer_load_dwordx4 v17, s[44:47], s65 offen offset:1024 lds
    s_add_u32 s3, s79, 0
    buffer_store_dwordx4 v[248:251], v252, s[48:51], s3 offen sc1
    s_waitcnt vmcnt(11)
    s_waitcnt lgkmcnt(0)
    s_barrier
    s_bfe_u32 s64, s95, 262144
    s_lshl_b32 s64, s64, 7
    s_xor_b32 s64, s64, s66
    s_mul_i32 s65, s64, 3072
    s_add_u32 m0, s30, 81920
    s_nop 0
    buffer_load_dwordx4 v8, s[40:43], s64 offen offset:0 lds
    buffer_load_dwordx4 v9, s[40:43], s64 offen offset:1024 lds
    v_lshlrev_b32 v2, 16, v56
    v_and_b32 v3, 0xffff0000, v56
    v_add_f32 v24, v24, v2
    v_add_f32 v25, v25, v3
    buffer_load_dwordx4 v10, s[40:43], s64 offen offset:2048 lds
    v_lshlrev_b32 v4, 16, v57
    v_and_b32 v5, 0xffff0000, v57
    v_add_f32 v26, v26, v4
    v_add_f32 v27, v27, v5
    buffer_load_dwordx4 v11, s[40:43], s64 offen offset:3072 lds
    v_lshlrev_b32 v2, 16, v58
    v_and_b32 v3, 0xffff0000, v58
    v_add_f32 v28, v28, v2
    v_add_f32 v29, v29, v3
    s_add_u32 m0, s31, 81920
    s_nop 0
    buffer_load_dwordx4 v12, s[44:47], s65 offen offset:0 lds
    v_lshlrev_b32 v4, 16, v59
    v_and_b32 v5, 0xffff0000, v59
    v_add_f32 v30, v30, v4
    v_add_f32 v31, v31, v5
    buffer_load_dwordx4 v13, s[44:47], s65 offen offset:1024 lds
    v_lshlrev_b32 v2, 16, v60
    v_and_b32 v3, 0xffff0000, v60
    v_add_f32 v24, v24, v2
    v_add_f32 v25, v25, v3
    s_add_u32 m0, s31, 90112
    s_nop 0
    buffer_load_dwordx4 v14, s[44:47], s65 offen offset:0 lds
    v_lshlrev_b32 v4, 16, v61
    v_and_b32 v5, 0xffff0000, v61
    v_add_f32 v26, v26, v4
    v_add_f32 v27, v27, v5
    buffer_load_dwordx4 v15, s[44:47], s65 offen offset:1024 lds
    v_lshlrev_b32 v2, 16, v62
    v_and_b32 v3, 0xffff0000, v62
    v_add_f32 v28, v28, v2
    v_add_f32 v29, v29, v3
    s_add_u32 m0, s31, 98304
    s_nop 0
    buffer_load_dwordx4 v16, s[44:47], s65 offen offset:0 lds
    v_lshlrev_b32 v4, 16, v63
    v_and_b32 v5, 0xffff0000, v63
    v_add_f32 v30, v30, v4
    v_add_f32_e64 v31, v31, v5
    buffer_load_dwordx4 v17, s[44:47], s65 offen offset:1024 lds
    s_add_u32 s3, s79, 32768
    buffer_store_dwordx4 v[248:251], v252, s[48:51], s3 offen sc1
    s_waitcnt vmcnt(12)
    s_waitcnt lgkmcnt(0)
    s_barrier
    s_bfe_u32 s64, s95, 262148
    s_lshl_b32 s64, s64, 7
    s_xor_b32 s64, s64, s66
    s_mul_i32 s65, s64, 3072
    s_add_u32 m0, s30, 0
    s_nop 0
    buffer_load_dwordx4 v8, s[40:43], s64 offen offset:0 lds
    buffer_load_dwordx4 v9, s[40:43], s64 offen offset:1024 lds
    v_permlane32_swap_b32 v24, v28
    v_permlane32_swap_b32 v25, v29
    buffer_load_dwordx4 v10, s[40:43], s64 offen offset:2048 lds
    v_permlane32_swap_b32 v26, v30
    v_permlane32_swap_b32 v27, v31
    buffer_load_dwordx4 v11, s[40:43], s64 offen offset:3072 lds
    v_add_f32 v24, v24, v28
    v_add_f32 v25, v25, v29
    s_add_u32 m0, s31, 0
    s_nop 0
    buffer_load_dwordx4 v12, s[44:47], s65 offen offset:0 lds
    v_add_f32 v26, v26, v30
    v_add_f32 v27, v27, v31
    buffer_load_dwordx4 v13, s[44:47], s65 offen offset:1024 lds
    v_permlane16_swap_b32 v24, v26
    v_permlane16_swap_b32 v25, v27
    s_add_u32 m0, s31, 8192
    s_nop 0
    buffer_load_dwordx4 v14, s[44:47], s65 offen offset:0 lds
    v_add_f32 v24, v24, v26
    v_add_f32 v25, v25, v27
    buffer_load_dwordx4 v15, s[44:47], s65 offen offset:1024 lds
    v_add_f32 v24, v24, v24 row_ror:8 row_mask:0xf bank_mask:0xf
    v_add_f32 v25, v25, v25 row_ror:8 row_mask:0xf bank_mask:0xf
    s_add_u32 m0, s31, 16384
    s_nop 0
    buffer_load_dwordx4 v16, s[44:47], s65 offen offset:0 lds
    buffer_load_dwordx4 v17, s[44:47], s65 offen offset:1024 lds
    v_and_b32 v2, 8, v1
    v_cmp_eq_u32 vcc, 0, v2
    s_nop 1
    v_cndmask_b32 v24, v25, v24, vcc
    s_cmp_eq_u32 s38, 3
    s_cselect_b64 exec, -1, 0
    v_mov_b32 v24, s70
    s_mov_b64 exec, -1
    buffer_store_dword v24, v253, s[48:51], s67 offen sc1
    s_waitcnt vmcnt(12)
    s_waitcnt lgkmcnt(0)
    s_barrier
    s_bfe_u32 s64, s95, 262152
    s_lshl_b32 s64, s64, 7
    s_xor_b32 s64, s64, s66
    s_mul_i32 s65, s64, 3072
    s_add_u32 m0, s30, 40960
    s_nop 0
    buffer_load_dwordx4 v8, s[40:43], s64 offen offset:0 lds
    buffer_load_dwordx4 v9, s[40:43], s64 offen offset:1024 lds
    buffer_load_dwordx4 v10, s[40:43], s64 offen offset:2048 lds
    buffer_load_dwordx4 v11, s[40:43], s64 offen offset:3072 lds
    s_add_u32 m0, s31, 40960
    s_nop 0
    buffer_load_dwordx4 v12, s[44:47], s65 offen offset:0 lds
    buffer_load_dwordx4 v13, s[44:47], s65 offen offset:1024 lds
    s_add_u32 m0, s31, 49152
    s_nop 0
    buffer_load_dwordx4 v14, s[44:47], s65 offen offset:0 lds
    buffer_load_dwordx4 v15, s[44:47], s65 offen offset:1024 lds
    s_add_u32 m0, s31, 57344
    s_nop 0
    buffer_load_dwordx4 v16, s[44:47], s65 offen offset:0 lds
    buffer_load_dwordx4 v17, s[44:47], s65 offen offset:1024 lds
    s_add_u32 s3, s79, 65536
    buffer_store_dwordx4 v[248:251], v252, s[48:51], s3 offen sc1
    s_add_u32 s3, s79, 98304
    buffer_store_dwordx4 v[248:251], v252, s[48:51], s3 offen sc1
    s_waitcnt vmcnt(13)
    s_waitcnt lgkmcnt(0)
    s_barrier
    s_bfe_u32 s64, s95, 262156
    s_lshl_b32 s64, s64, 7
    s_xor_b32 s64, s64, s66
    s_mul_i32 s65, s64, 3072
    s_add_u32 m0, s30, 81920
    s_nop 0
    buffer_load_dwordx4 v8, s[40:43], s64 offen offset:0 lds
    buffer_load_dwordx4 v9, s[40:43], s64 offen offset:1024 lds
    buffer_load_dwordx4 v10, s[40:43], s64 offen offset:2048 lds
    buffer_load_dwordx4 v11, s[40:43], s64 offen offset:3072 lds
    s_add_u32 m0, s31, 81920
    s_nop 0
    buffer_load_dwordx4 v12, s[44:47], s65 offen offset:0 lds
    buffer_load_dwordx4 v13, s[44:47], s65 offen offset:1024 lds
    s_add_u32 m0, s31, 90112
    s_nop 0
    buffer_load_dwordx4 v14, s[44:47], s65 offen offset:0 lds
    buffer_load_dwordx4 v15, s[44:47], s65 offen offset:1024 lds
    s_add_u32 m0, s31, 98304
    s_nop 0
    buffer_load_dwordx4 v16, s[44:47], s65 offen offset:0 lds
    buffer_load_dwordx4 v17, s[44:47], s65 offen offset:1024 lds
    s_lshl_b32 s3, s37, 14
    s_add_u32 s3, s3, 524288
    s_add_u32 s28, s3, 0
    buffer_load_dwordx4 v[80:83], v235, s[48:51], s28 offen sc1
    s_add_u32 s28, s3, 4096
    buffer_load_dwordx4 v[84:87], v235, s[48:51], s28 offen sc1
    s_waitcnt vmcnt(14)
    s_waitcnt lgkmcnt(0)
    s_barrier
    s_lshl_b32 s3, s37, 14
    s_nop 0
    s_add_u32 s3, s3, 524288
    s_add_u32 s28, s3, 8192
    buffer_load_dwordx4 v[88:91], v235, s[48:51], s28 offen sc1
    s_add_u32 s28, s3, 12288
    buffer_load_dwordx4 v[92:95], v235, s[48:51], s28 offen sc1
    s_bfe_u32 s64, s95, 262160
    s_lshl_b32 s64, s64, 7
    s_xor_b32 s64, s64, s66
    s_mul_i32 s65, s64, 3072
    s_add_u32 m0, s30, 0
    s_nop 0
    buffer_load_dwordx4 v8, s[40:43], s64 offen offset:0 lds
    buffer_load_dwordx4 v9, s[40:43], s64 offen offset:1024 lds
    buffer_load_dwordx4 v10, s[40:43], s64 offen offset:2048 lds
    buffer_load_dwordx4 v11, s[40:43], s64 offen offset:3072 lds
    s_add_u32 m0, s31, 0
    s_nop 0
    buffer_load_dwordx4 v12, s[44:47], s65 offen offset:0 lds
    buffer_load_dwordx4 v13, s[44:47], s65 offen offset:1024 lds
    s_add_u32 m0, s31, 8192
    s_nop 0
    buffer_load_dwordx4 v14, s[44:47], s65 offen offset:0 lds
    buffer_load_dwordx4 v15, s[44:47], s65 offen offset:1024 lds
    s_add_u32 m0, s31, 16384
    s_nop 0
    buffer_load_dwordx4 v16, s[44:47], s65 offen offset:0 lds
    buffer_load_dwordx4 v17, s[44:47], s65 offen offset:1024 lds
    s_waitcnt vmcnt(14)
    s_waitcnt lgkmcnt(0)
    s_barrier
    s_waitcnt vmcnt(10)
    s_mov_b32 s29, 0
L_k2:
    s_nop 0
    v_max3_u32 v2, v80, v81, v82
    v_max3_u32 v2, v2, v83, v84
    v_max3_u32 v2, v2, v85, v86
    v_max3_u32 v2, v2, v87, v88
    v_max3_u32 v2, v2, v89, v90
    v_max3_u32 v2, v2, v91, v92
    v_max3_u32 v2, v2, v93, v94
    v_max_u32 v2, v2, v95
    v_cmp_eq_u32 vcc, -1, v2
    s_cbranch_vccz L_k2k
    s_add_u32 s29, s29, 1
    s_cmp_ge_u32 s29, 200000
    s_cbranch_scc1 L_k2k
    s_sleep 1
    s_lshl_b32 s3, s37, 14
    s_add_u32 s3, s3, 524288
    s_add_u32 s28, s3, 0
    buffer_load_dwordx4 v[80:83], v235, s[48:51], s28 offen sc1
    s_add_u32 s28, s3, 4096
    buffer_load_dwordx4 v[84:87], v235, s[48:51], s28 offen sc1
    s_add_u32 s28, s3, 8192
    buffer_load_dwordx4 v[88:91], v235, s[48:51], s28 offen sc1
    s_add_u32 s28, s3, 12288
    buffer_load_dwordx4 v[92:95], v235, s[48:51], s28 offen sc1
    s_waitcnt vmcnt(0)
    s_branch L_k2
L_k2k:
    s_bfe_u32 s64, s95, 262164
    s_lshl_b32 s64, s64, 7
    s_xor_b32 s64, s64, s66
    s_mul_i32 s65, s64, 3072
    s_add_u32 m0, s30, 40960
    s_nop 0
    buffer_load_dwordx4 v8, s[40:43], s64 offen offset:0 lds
    buffer_load_dwordx4 v9, s[40:43], s64 offen offset:1024 lds
    v_max3_u32 v2, v80, v84, v88
    v_max_u32 v2, v2, v92
    v_add_f32 v80, v80, v88
    buffer_load_dwordx4 v10, s[40:43], s64 offen offset:2048 lds
    v_add_f32 v81, v81, v89
    v_add_f32 v82, v82, v90
    v_add_f32 v83, v83, v91
    buffer_load_dwordx4 v11, s[40:43], s64 offen offset:3072 lds
    v_add_f32 v84, v84, v92
    v_add_f32 v85, v85, v93
    v_add_f32 v86, v86, v94
    s_add_u32 m0, s31, 40960
    s_nop 0
    buffer_load_dwordx4 v12, s[44:47], s65 offen offset:0 lds
    v_add_f32 v87, v87, v95
    v_add_f32 v80, v80, v84
    v_add_f32 v81, v81, v85
    buffer_load_dwordx4 v13, s[44:47], s65 offen offset:1024 lds
    v_add_f32 v82, v82, v86
    v_add_f32_e64 v83, v83, v87
    v_readlane_b32 s70, v2, 12
    s_add_u32 m0, s31, 49152
    s_nop 0
    buffer_load_dwordx4 v14, s[44:47], s65 offen offset:0 lds
    v_readlane_b32 s3, v2, 28
    v_readlane_b32 s28, v2, 44
    v_readlane_b32 s29, v2, 60
    buffer_load_dwordx4 v15, s[44:47], s65 offen offset:1024 lds
    s_max_u32 s70, s70, s3
    s_max_u32 s28, s28, s29
    s_max_u32 s70, s70, s28
    s_add_u32 m0, s31, 57344
    s_nop 0
    buffer_load_dwordx4 v16, s[44:47], s65 offen offset:0 lds
    v_permlane32_swap_b32 v80, v82
    v_permlane32_swap_b32 v81, v83
    v_add_f32 v80, v80, v82
    buffer_load_dwordx4 v17, s[44:47], s65 offen offset:1024 lds
    v_add_f32 v81, v81, v83
    s_nop 1
    v_permlane16_swap_b32 v80, v81
    v_add_f32 v80, v80, v81
    s_mov_b32 exec_lo, 0xf000f000
    s_mov_b32 exec_hi, 0xf000f000
    v_mov_b32 v80, s70
    s_mov_b64 exec, -1
    s_waitcnt vmcnt(10)
    s_waitcnt lgkmcnt(0)
    s_barrier
    s_bfe_u32 s64, s95, 262168
    s_lshl_b32 s64, s64, 7
    s_xor_b32 s64, s64, s66
    s_mul_i32 s65, s64, 3072
    s_add_u32 m0, s30, 81920
    s_nop 0
    buffer_load_dwordx4 v8, s[40:43], s64 offen offset:0 lds
    buffer_load_dwordx4 v9, s[40:43], s64 offen offset:1024 lds
    buffer_load_dwordx4 v10, s[40:43], s64 offen offset:2048 lds
    buffer_load_dwordx4 v11, s[40:43], s64 offen offset:3072 lds
    s_add_u32 m0, s31, 81920
    s_nop 0
    buffer_load_dwordx4 v12, s[44:47], s65 offen offset:0 lds
    buffer_load_dwordx4 v13, s[44:47], s65 offen offset:1024 lds
    s_add_u32 m0, s31, 90112
    s_nop 0
    buffer_load_dwordx4 v14, s[44:47], s65 offen offset:0 lds
    buffer_load_dwordx4 v15, s[44:47], s65 offen offset:1024 lds
    s_add_u32 m0, s31, 98304
    s_nop 0
    buffer_load_dwordx4 v16, s[44:47], s65 offen offset:0 lds
    buffer_load_dwordx4 v17, s[44:47], s65 offen offset:1024 lds
    s_and_b32 s68, s70, 0x7ff
    s_sub_u32 s68, 2047, s68
    s_lshl_b32 s3, s68, 11
    s_and_b32 s28, s77, 3
    s_lshl_b32 s28, s28, 9
    s_add_u32 s3, s3, s28
    s_lshr_b32 s28, s38, 1
    s_lshl_b32 s28, s28, 8
    s_add_u32 s3, s3, s28
    v_lshrrev_b32 v3, 3, v1
    v_lshlrev_b32 v3, 5, v3
    buffer_load_dwordx4 v[64:67], v3, s[40:43], s3 offen
    buffer_load_dwordx4 v[68:71], v3, s[40:43], s3 offen offset:16
    s_lshr_b32 s3, s68, 1
    s_lshl_b32 s3, s3, 4
    s_and_b32 s28, s68, 1
    s_lshl_b32 s28, s28, 2
    s_add_u32 s3, s3, s28
    v_mov_b32 v3, 0
    buffer_load_dword v116, v3, s[48:51], s3 offen sc1
    s_waitcnt vmcnt(13)
    s_waitcnt lgkmcnt(0)
    s_barrier
    s_bfe_u32 s64, s95, 262172
    s_lshl_b32 s64, s64, 7
    s_xor_b32 s64, s64, s66
    s_mul_i32 s65, s64, 3072
    s_add_u32 m0, s30, 0
    s_nop 0
    buffer_load_dwordx4 v8, s[40:43], s64 offen offset:0 lds
    buffer_load_dwordx4 v9, s[40:43], s64 offen offset:1024 lds
    buffer_load_dwordx4 v10, s[40:43], s64 offen offset:2048 lds
    buffer_load_dwordx4 v11, s[40:43], s64 offen offset:3072 lds
    s_add_u32 m0, s31, 0
    s_nop 0
    buffer_load_dwordx4 v12, s[44:47], s65 offen offset:0 lds
    buffer_load_dwordx4 v13, s[44:47], s65 offen offset:1024 lds
    s_add_u32 m0, s31, 8192
    s_nop 0
    buffer_load_dwordx4 v14, s[44:47], s65 offen offset:0 lds
    buffer_load_dwordx4 v15, s[44:47], s65 offen offset:1024 lds
    s_add_u32 m0, s31, 16384
    s_nop 0
    buffer_load_dwordx4 v16, s[44:47], s65 offen offset:0 lds
    buffer_load_dwordx4 v17, s[44:47], s65 offen offset:1024 lds
    s_or_b32 s3, s2, s38
    s_mov_b32 s28, 16384
    s_cmp_lg_u32 s3, 0
    s_cselect_b32 s3, 268435456, s28
    v_mov_b32 v2, s86
    s_mov_b64 exec, 1
    buffer_store_dword v2, v252, s[48:51], s3 offen sc1
    s_mov_b64 exec, -1
    s_waitcnt vmcnt(14)
    s_waitcnt lgkmcnt(0)
    s_barrier
    s_nop 0
    s_mov_b32 s3, 28672
    buffer_load_dwordx4 v[144:147], v21, s[52:55], s3 offen nt
    s_mov_b32 s3, 35840
    buffer_load_dwordx4 v[148:151], v21, s[52:55], s3 offen nt
    s_mov_b32 s3, 43008
    buffer_load_dwordx4 v[152:155], v21, s[52:55], s3 offen nt
    s_mov_b32 s3, 50176
    buffer_load_dwordx4 v[156:159], v21, s[52:55], s3 offen nt
    s_mov_b32 s3, 57344
    buffer_load_dwordx4 v[160:163], v21, s[52:55], s3 offen nt
    s_mov_b32 s3, 64512
    buffer_load_dwordx4 v[164:167], v21, s[52:55], s3 offen nt
    s_mov_b32 s3, 71680
    buffer_load_dwordx4 v[168:171], v21, s[52:55], s3 offen nt
    s_mov_b32 s3, 78848
    buffer_load_dwordx4 v[172:175], v21, s[52:55], s3 offen nt
    ds_write_b32 v233, v80
    s_lshl_b32 s3, s38, 4
    s_lshl_b64 exec, 0xffff, s3
    ds_write_b64 v230, v[224:225]
    ds_write_b64 v230, v[226:227] offset:1024
    ds_write_b64 v230, v[228:229] offset:2048
    ds_write_b32 v231, v236
    s_mov_b64 exec, -1
    s_waitcnt vmcnt(19)
    v_and_b32 v5, 0xffff0000, v116
    v_lshlrev_b32 v116, 16, v116
    v_rcp_f32 v117, v5
    v_lshlrev_b32 v96, 16, v64
    v_and_b32 v97, 0xffff0000, v64
    v_lshlrev_b32 v98, 16, v65
    v_and_b32 v99, 0xffff0000, v65
    v_lshlrev_b32 v100, 16, v66
    v_and_b32 v101, 0xffff0000, v66
    v_lshlrev_b32 v102, 16, v67
    v_and_b32 v103, 0xffff0000, v67
    v_lshlrev_b32 v104, 16, v68
    v_and_b32 v105, 0xffff0000, v68
    v_lshlrev_b32 v106, 16, v69
    v_and_b32 v107, 0xffff0000, v69
    v_lshlrev_b32 v108, 16, v70
    v_and_b32 v109, 0xffff0000, v70
    v_lshlrev_b32 v110, 16, v71
    v_and_b32 v111, 0xffff0000, v71
    v_mul_f32 v119, v116, v117
    v_fma_f32 v96, v96, v117, -v119
    v_fma_f32 v97, v97, v117, -v119
    v_fma_f32 v98, v98, v117, -v119
    v_fma_f32 v99, v99, v117, -v119
    v_fma_f32 v100, v100, v117, -v119
    v_fma_f32 v101, v101, v117, -v119
    v_fma_f32 v102, v102, v117, -v119
    v_fma_f32 v103, v103, v117, -v119
    v_fma_f32 v104, v104, v117, -v119
    v_fma_f32 v105, v105, v117, -v119
    v_fma_f32 v106, v106, v117, -v119
    v_fma_f32 v107, v107, v117, -v119
    v_fma_f32 v108, v108, v117, -v119
    v_fma_f32 v109, v109, v117, -v119
    v_fma_f32 v110, v110, v117, -v119
    v_fma_f32 v111, v111, v117, -v119
    v_mov_b32 v120, 0
    v_mov_b32 v121, 0
    v_mov_b32 v122, 0
    v_mov_b32 v123, 0
    v_mov_b32 v124, 0
    v_mov_b32 v125, 0
    v_mov_b32 v126, 0
    v_mov_b32 v127, 0
    s_waitcnt vmcnt(9)
    s_waitcnt lgkmcnt(0)
    s_barrier
    v_lshlrev_b32 v2, 16, v128
    v_and_b32 v3, 0xffff0000, v128
    v_fmac_f32 v120, v2, v96
    v_fmac_f32 v121, v3, v96
    v_lshlrev_b32 v4, 16, v129
    v_and_b32 v5, 0xffff0000, v129
    v_fmac_f32 v122, v4, v96
    v_fmac_f32 v123, v5, v96
    v_lshlrev_b32 v2, 16, v130
    v_and_b32 v3, 0xffff0000, v130
    v_fmac_f32 v124, v2, v96
    v_fmac_f32 v125, v3, v96
    v_lshlrev_b32 v4, 16, v131
    v_and_b32 v5, 0xffff0000, v131
    v_fmac_f32 v126, v4, v96
    v_fmac_f32 v127, v5, v96
    v_lshlrev_b32 v2, 16, v132
    v_and_b32 v3, 0xffff0000, v132
    v_fmac_f32 v120, v2, v97
    v_fmac_f32 v121, v3, v97
    v_lshlrev_b32 v4, 16, v133
    v_and_b32 v5, 0xffff0000, v133
    v_fmac_f32 v122, v4, v97
    v_fmac_f32 v123, v5, v97
    v_lshlrev_b32 v2, 16, v134
    v_and_b32 v3, 0xffff0000, v134
    v_fmac_f32 v124, v2, v97
    v_fmac_f32 v125, v3, v97
    v_lshlrev_b32 v4, 16, v135
    v_and_b32 v5, 0xffff0000, v135
    v_fmac_f32 v126, v4, v97
    v_fmac_f32 v127, v5, v97
    v_lshlrev_b32 v2, 16, v136
    v_and_b32 v3, 0xffff0000, v136
    v_fmac_f32 v120, v2, v98
    v_fmac_f32 v121, v3, v98
    v_lshlrev_b32 v4, 16, v137
    v_and_b32 v5, 0xffff0000, v137
    v_fmac_f32 v122, v4, v98
    v_fmac_f32 v123, v5, v98
    v_lshlrev_b32 v2, 16, v138
    v_and_b32 v3, 0xffff0000, v138
    v_fmac_f32 v124, v2, v98
    v_fmac_f32 v125, v3, v98
    v_lshlrev_b32 v4, 16, v139
    v_and_b32 v5, 0xffff0000, v139
    v_fmac_f32 v126, v4, v98
    v_fmac_f32 v127, v5, v98
    v_lshlrev_b32 v2, 16, v140
    v_and_b32 v3, 0xffff0000, v140
    v_fmac_f32 v120, v2, v99
    v_fmac_f32 v121, v3, v99
    v_lshlrev_b32 v4, 16, v141
    v_and_b32 v5, 0xffff0000, v141
    v_fmac_f32 v122, v4, v99
    v_fmac_f32 v123, v5, v99
    v_lshlrev_b32 v2, 16, v142
    v_and_b32 v3, 0xffff0000, v142
    v_fmac_f32 v124, v2, v99
    v_fmac_f32 v125, v3, v99
    v_lshlrev_b32 v4, 16, v143
    v_and_b32 v5, 0xffff0000, v143
    v_fmac_f32 v126, v4, v99
    v_fmac_f32 v127, v5, v99
    s_setprio 0
    s_waitcnt lgkmcnt(0)
    s_barrier
    v_and_b32 v2, 15, v1
    v_min_u32 v2, 13, v2
    v_lshrrev_b32_e64 v3, 4, v1
    v_mul_u32_u24 v3, 14336, v3
    v_lshl_add_u32 v13, v2, 4, v3
    s_lshl_b32 s75, s71, 2
    s_add_u32 s75, s75, 1183744
    s_add_u32 m0, s72, 0
    s_xor_b32 s3, s73, 0
    s_nop 0
    buffer_load_dwordx4 v220, s[88:91], s3 offen offset:0 lds
    buffer_load_dwordx4 v221, s[88:91], s3 offen offset:1024 lds
    buffer_load_dwordx4 v222, s[88:91], s3 offen offset:2048 lds
    buffer_load_dwordx4 v223, s[88:91], s3 offen offset:3072 lds
    s_add_u32 m0, s72, 16384
    s_xor_b32 s3, s73, 262144
    buffer_load_dwordx4 v220, s[88:91], s3 offen offset:0 lds
    buffer_load_dwordx4 v221, s[88:91], s3 offen offset:1024 lds
    buffer_load_dwordx4 v222, s[88:91], s3 offen offset:2048 lds
    buffer_load_dwordx4 v223, s[88:91], s3 offen offset:3072 lds
    s_add_u32 m0, s72, 65536
    s_xor_b32 s3, s73, 1048576
    buffer_load_dwordx4 v220, s[88:91], s3 offen offset:0 lds
    buffer_load_dwordx4 v221, s[88:91], s3 offen offset:1024 lds
    buffer_load_dwordx4 v222, s[88:91], s3 offen offset:2048 lds
    buffer_load_dwordx4 v223, s[88:91], s3 offen offset:3072 lds
    s_mov_b32 s3, 86016
    buffer_load_dwordx4 v[176:179], v21, s[52:55], s3 offen nt
    s_mov_b32 s3, 93184
    buffer_load_dwordx4 v[180:183], v21, s[52:55], s3 offen nt
    s_mov_b32 s3, 100352
    buffer_load_dwordx4 v[184:187], v21, s[52:55], s3 offen nt
    s_mov_b32 s3, 107520
    buffer_load_dwordx4 v[188:191], v21, s[52:55], s3 offen nt
    s_lshr_b32 s3, s71, 3
    s_add_u32 s3, s3, 0
    s_and_b32 s28, s3, 7
    s_lshr_b32 s3, s3, 3
    s_lshl_b32 s3, s3, 6
    s_add_u32 s3, s3, s28
    s_lshl_b32 s3, s3, 11
    buffer_load_dwordx4 v[192:195], v22, s[56:59], s3 offen nt
    s_lshr_b32 s3, s71, 3
    s_add_u32 s3, s3, 1
    s_and_b32 s28, s3, 7
    s_lshr_b32 s3, s3, 3
    s_lshl_b32 s3, s3, 6
    s_add_u32 s3, s3, s28
    s_lshl_b32 s3, s3, 11
    buffer_load_dwordx4 v[196:199], v22, s[56:59], s3 offen nt
    s_lshr_b32 s3, s71, 3
    s_add_u32 s3, s3, 2
    s_and_b32 s28, s3, 7
    s_lshr_b32 s3, s3, 3
    s_lshl_b32 s3, s3, 6
    s_add_u32 s3, s3, s28
    s_lshl_b32 s3, s3, 11
    buffer_load_dwordx4 v[200:203], v22, s[56:59], s3 offen nt
    s_waitcnt vmcnt(19)
    v_lshlrev_b32_e64 v2, 16, v144
    v_and_b32 v3, 0xffff0000, v144
    v_pk_fma_f32 v[120:121], v[2:3], v[100:101], v[120:121] op_sel_hi:[1,0,1]
    v_lshlrev_b32_e64 v4, 16, v145
    v_and_b32 v5, 0xffff0000, v145
    v_pk_fma_f32 v[122:123], v[4:5], v[100:101], v[122:123] op_sel_hi:[1,0,1]
    v_lshlrev_b32_e64 v2, 16, v146
    v_and_b32 v3, 0xffff0000, v146
    v_pk_fma_f32 v[124:125], v[2:3], v[100:101], v[124:125] op_sel_hi:[1,0,1]
    v_lshlrev_b32_e64 v4, 16, v147
    v_and_b32 v5, 0xffff0000, v147
    v_pk_fma_f32 v[126:127], v[4:5], v[100:101], v[126:127] op_sel_hi:[1,0,1]
    v_lshlrev_b32 v2, 16, v148
    v_and_b32 v3, 0xffff0000, v148
    v_mov_b32 v100, v101
    v_pk_fma_f32 v[120:121], v[2:3], v[100:101], v[120:121] op_sel_hi:[1,0,1]
    v_lshlrev_b32_e64 v4, 16, v149
    v_and_b32 v5, 0xffff0000, v149
    v_pk_fma_f32 v[122:123], v[4:5], v[100:101], v[122:123] op_sel_hi:[1,0,1]
    v_lshlrev_b32_e64 v2, 16, v150
    v_and_b32 v3, 0xffff0000, v150
    v_pk_fma_f32 v[124:125], v[2:3], v[100:101], v[124:125] op_sel_hi:[1,0,1]
    v_lshlrev_b32_e64 v4, 16, v151
    v_and_b32 v5, 0xffff0000, v151
    v_pk_fma_f32 v[126:127], v[4:5], v[100:101], v[126:127] op_sel_hi:[1,0,1]
    v_lshlrev_b32_e64 v2, 16, v152
    v_and_b32 v3, 0xffff0000, v152
    v_pk_fma_f32 v[120:121], v[2:3], v[102:103], v[120:121] op_sel_hi:[1,0,1]
    v_lshlrev_b32_e64 v4, 16, v153
    v_and_b32 v5, 0xffff0000, v153
    v_pk_fma_f32 v[122:123], v[4:5], v[102:103], v[122:123] op_sel_hi:[1,0,1]
    v_lshlrev_b32_e64 v2, 16, v154
    v_and_b32 v3, 0xffff0000, v154
    v_pk_fma_f32 v[124:125], v[2:3], v[102:103], v[124:125] op_sel_hi:[1,0,1]
    v_lshlrev_b32_e64 v4, 16, v155
    v_and_b32 v5, 0xffff0000, v155
    v_pk_fma_f32 v[126:127], v[4:5], v[102:103], v[126:127] op_sel_hi:[1,0,1]
    v_lshlrev_b32 v2, 16, v156
    v_and_b32 v3, 0xffff0000, v156
    v_mov_b32 v102, v103
    v_pk_fma_f32 v[120:121], v[2:3], v[102:103], v[120:121] op_sel_hi:[1,0,1]
    v_lshlrev_b32_e64 v4, 16, v157
    v_and_b32 v5, 0xffff0000, v157
    v_pk_fma_f32 v[122:123], v[4:5], v[102:103], v[122:123] op_sel_hi:[1,0,1]
    v_lshlrev_b32_e64 v2, 16, v158
    v_and_b32 v3, 0xffff0000, v158
    v_pk_fma_f32 v[124:125], v[2:3], v[102:103], v[124:125] op_sel_hi:[1,0,1]
    v_lshlrev_b32_e64 v4, 16, v159
    v_and_b32 v5, 0xffff0000, v159
    v_pk_fma_f32 v[126:127], v[4:5], v[102:103], v[126:127] op_sel_hi:[1,0,1]
    v_lshlrev_b32_e64 v2, 16, v160
    v_and_b32 v3, 0xffff0000, v160
    v_pk_fma_f32 v[120:121], v[2:3], v[104:105], v[120:121] op_sel_hi:[1,0,1]
    v_lshlrev_b32_e64 v4, 16, v161
    v_and_b32 v5, 0xffff0000, v161
    v_pk_fma_f32 v[122:123], v[4:5], v[104:105], v[122:123] op_sel_hi:[1,0,1]
    v_lshlrev_b32_e64 v2, 16, v162
    v_and_b32 v3, 0xffff0000, v162
    v_pk_fma_f32 v[124:125], v[2:3], v[104:105], v[124:125] op_sel_hi:[1,0,1]
    v_lshlrev_b32_e64 v4, 16, v163
    v_and_b32 v5, 0xffff0000, v163
    v_pk_fma_f32 v[126:127], v[4:5], v[104:105], v[126:127] op_sel_hi:[1,0,1]
    v_lshlrev_b32 v2, 16, v164
    v_and_b32 v3, 0xffff0000, v164
    v_mov_b32 v104, v105
    v_pk_fma_f32 v[120:121], v[2:3], v[104:105], v[120:121] op_sel_hi:[1,0,1]
    v_lshlrev_b32_e64 v4, 16, v165
    v_and_b32 v5, 0xffff0000, v165
    v_pk_fma_f32 v[122:123], v[4:5], v[104:105], v[122:123] op_sel_hi:[1,0,1]
    v_lshlrev_b32_e64 v2, 16, v166
    v_and_b32 v3, 0xffff0000, v166
    v_pk_fma_f32 v[124:125], v[2:3], v[104:105], v[124:125] op_sel_hi:[1,0,1]
    v_lshlrev_b32_e64 v4, 16, v167
    v_and_b32 v5, 0xffff0000, v167
    v_pk_fma_f32 v[126:127], v[4:5], v[104:105], v[126:127] op_sel_hi:[1,0,1]
    v_lshlrev_b32_e64 v2, 16, v168
    v_and_b32 v3, 0xffff0000, v168
    v_pk_fma_f32 v[120:121], v[2:3], v[106:107], v[120:121] op_sel_hi:[1,0,1]
    v_lshlrev_b32_e64 v4, 16, v169
    v_and_b32 v5, 0xffff0000, v169
    v_pk_fma_f32 v[122:123], v[4:5], v[106:107], v[122:123] op_sel_hi:[1,0,1]
    v_lshlrev_b32_e64 v2, 16, v170
    v_and_b32 v3, 0xffff0000, v170
    v_pk_fma_f32 v[124:125], v[2:3], v[106:107], v[124:125] op_sel_hi:[1,0,1]
    v_lshlrev_b32_e64 v4, 16, v171
    v_and_b32 v5, 0xffff0000, v171
    v_pk_fma_f32 v[126:127], v[4:5], v[106:107], v[126:127] op_sel_hi:[1,0,1]
    v_lshlrev_b32 v2, 16, v172
    v_and_b32 v3, 0xffff0000, v172
    v_mov_b32 v106, v107
    v_pk_fma_f32 v[120:121], v[2:3], v[106:107], v[120:121] op_sel_hi:[1,0,1]
    v_lshlrev_b32_e64 v4, 16, v173
    v_and_b32 v5, 0xffff0000, v173
    v_pk_fma_f32 v[122:123], v[4:5], v[106:107], v[122:123] op_sel_hi:[1,0,1]
    v_lshlrev_b32_e64 v2, 16, v174
    v_and_b32 v3, 0xffff0000, v174
    v_pk_fma_f32 v[124:125], v[2:3], v[106:107], v[124:125] op_sel_hi:[1,0,1]
    v_lshlrev_b32_e64 v4, 16, v175
    v_and_b32 v5, 0xffff0000, v175
    v_pk_fma_f32 v[126:127], v[4:5], v[106:107], v[126:127] op_sel_hi:[1,0,1]
    s_waitcnt vmcnt(15)
    s_waitcnt vmcnt(11)
    s_waitcnt vmcnt(7)
    s_barrier
    s_add_u32 m0, s72, 32768
    s_xor_b32 s3, s73, 524288
    buffer_load_dwordx4 v220, s[88:91], s3 offen offset:0 lds
    buffer_load_dwordx4 v221, s[88:91], s3 offen offset:1024 lds
    buffer_load_dwordx4 v222, s[88:91], s3 offen offset:2048 lds
    buffer_load_dwordx4 v223, s[88:91], s3 offen offset:3072 lds
    s_add_u32 m0, s72, 49152
    s_xor_b32 s3, s73, 786432
    buffer_load_dwordx4 v220, s[88:91], s3 offen offset:0 lds
    buffer_load_dwordx4 v221, s[88:91], s3 offen offset:1024 lds
    buffer_load_dwordx4 v222, s[88:91], s3 offen offset:2048 lds
    buffer_load_dwordx4 v223, s[88:91], s3 offen offset:3072 lds
    s_add_u32 m0, s72, 81920
    s_xor_b32 s3, s73, 1310720
    buffer_load_dwordx4 v220, s[88:91], s3 offen offset:0 lds
    buffer_load_dwordx4 v221, s[88:91], s3 offen offset:1024 lds
    buffer_load_dwordx4 v222, s[88:91], s3 offen offset:2048 lds
    buffer_load_dwordx4 v223, s[88:91], s3 offen offset:3072 lds
    s_setprio 3
    s_cmp_lg_u32 s38, 3
    s_cbranch_scc1 L_npl
    s_mov_b32 s3, 32768
    s_mov_b32 s29, 0
    s_mov_b32 exec_lo, -1
    s_mov_b32 exec_hi, 65535
L_rp:
    buffer_load_dword v118, v113, s[48:51], s3 offen sc1
    s_waitcnt vmcnt(0)
    v_cmp_ne_u32 vcc, s86, v118
    s_cbranch_vccz L_rpk
    s_mov_b64 exec, vcc
    s_add_u32 s29, s29, 1
    s_cmp_lt_u32 s29, 200000
    s_cbranch_scc1 L_rp
L_rpk:
    s_mov_b64 exec, -1
    v_mov_b32 v4, 162128
    v_mov_b32 v5, 1
    ds_write_b32 v4, v5
L_npl:
    v_min_u32 v3, 4, v1
    v_lshlrev_b32_e64 v3, 2, v3
    v_add_u32 v3, 162112, v3
L_fw:
    ds_read_b32 v4, v3
    s_waitcnt lgkmcnt(0)
    v_cmp_eq_u32 vcc, 0, v4
    s_cbranch_vccz L_fk
    s_sleep 1
    s_branch L_fw
L_fk:
    s_waitcnt vmcnt(15)
    v_lshlrev_b32_e64 v2, 16, v176
    v_and_b32 v3, 0xffff0000, v176
    v_pk_fma_f32 v[120:121], v[2:3], v[108:109], v[120:121] op_sel_hi:[1,0,1]
    v_lshlrev_b32_e64 v4, 16, v177
    v_and_b32 v5, 0xffff0000, v177
    v_pk_fma_f32 v[122:123], v[4:5], v[108:109], v[122:123] op_sel_hi:[1,0,1]
    v_lshlrev_b32_e64 v2, 16, v178
    v_and_b32 v3, 0xffff0000, v178
    v_pk_fma_f32 v[124:125], v[2:3], v[108:109], v[124:125] op_sel_hi:[1,0,1]
    v_lshlrev_b32_e64 v4, 16, v179
    v_and_b32 v5, 0xffff0000, v179
    v_pk_fma_f32 v[126:127], v[4:5], v[108:109], v[126:127] op_sel_hi:[1,0,1]
    v_lshlrev_b32 v2, 16, v180
    v_and_b32 v3, 0xffff0000, v180
    v_mov_b32 v108, v109
    v_pk_fma_f32 v[120:121], v[2:3], v[108:109], v[120:121] op_sel_hi:[1,0,1]
    v_lshlrev_b32_e64 v4, 16, v181
    v_and_b32 v5, 0xffff0000, v181
    v_pk_fma_f32 v[122:123], v[4:5], v[108:109], v[122:123] op_sel_hi:[1,0,1]
    v_lshlrev_b32_e64 v2, 16, v182
    v_and_b32 v3, 0xffff0000, v182
    v_pk_fma_f32 v[124:125], v[2:3], v[108:109], v[124:125] op_sel_hi:[1,0,1]
    v_lshlrev_b32_e64 v4, 16, v183
    v_and_b32 v5, 0xffff0000, v183
    v_pk_fma_f32 v[126:127], v[4:5], v[108:109], v[126:127] op_sel_hi:[1,0,1]
    s_add_u32 s3, s76, 0
    buffer_load_dwordx4 v[48:51], v112, s[48:51], s3 offen sc1
    s_add_u32 s3, s76, 33792
    buffer_load_dwordx4 v[52:55], v112, s[48:51], s3 offen sc1
    s_cmp_lg_u32 s83, 0
    s_cbranch_scc1 L_nz
    s_add_u32 s3, s81, 0
    buffer_load_dwordx4 v[32:35], v112, s[48:51], s3 offen sc1
    s_add_u32 s3, s81, 33792
    buffer_load_dwordx4 v[36:39], v112, s[48:51], s3 offen sc1
L_nz:
    v_lshlrev_b32_e64 v2, 16, v184
    v_and_b32 v3, 0xffff0000, v184
    v_pk_fma_f32 v[120:121], v[2:3], v[110:111], v[120:121] op_sel_hi:[1,0,1]
    v_lshlrev_b32_e64 v4, 16, v185
    v_and_b32 v5, 0xffff0000, v185
    v_pk_fma_f32 v[122:123], v[4:5], v[110:111], v[122:123] op_sel_hi:[1,0,1]
    v_lshlrev_b32_e64 v2, 16, v186
    v_and_b32 v3, 0xffff0000, v186
    v_pk_fma_f32 v[124:125], v[2:3], v[110:111], v[124:125] op_sel_hi:[1,0,1]
    v_lshlrev_b32_e64 v4, 16, v187
    v_and_b32 v5, 0xffff0000, v187
    v_pk_fma_f32 v[126:127], v[4:5], v[110:111], v[126:127] op_sel_hi:[1,0,1]
    v_lshlrev_b32 v2, 16, v188
    v_and_b32 v3, 0xffff0000, v188
    v_mov_b32 v110, v111
    v_pk_fma_f32 v[120:121], v[2:3], v[110:111], v[120:121] op_sel_hi:[1,0,1]
    v_lshlrev_b32_e64 v4, 16, v189
    v_and_b32 v5, 0xffff0000, v189
    v_pk_fma_f32 v[122:123], v[4:5], v[110:111], v[122:123] op_sel_hi:[1,0,1]
    v_lshlrev_b32_e64 v2, 16, v190
    v_and_b32 v3, 0xffff0000, v190
    v_pk_fma_f32 v[124:125], v[2:3], v[110:111], v[124:125] op_sel_hi:[1,0,1]
    v_lshlrev_b32_e64 v4, 16, v191
    v_and_b32 v5, 0xffff0000, v191
    v_pk_fma_f32 v[126:127], v[4:5], v[110:111], v[126:127] op_sel_hi:[1,0,1]
    v_permlane32_swap_b32 v120, v124
    v_permlane32_swap_b32 v121, v125
    v_permlane32_swap_b32 v122, v126
    v_permlane32_swap_b32 v123, v127
    v_add_f32 v120, v120, v124
    v_add_f32 v121, v121, v125
    v_add_f32 v122, v122, v126
    v_add_f32 v123, v123, v127
    s_nop 0
    v_permlane16_swap_b32 v120, v122
    v_permlane16_swap_b32 v121, v123
    v_add_f32 v120, v120, v122
    v_add_f32 v121, v121, v123
    s_nop 0
    v_add_f32 v120, v120, v120 row_ror:8 row_mask:0xf bank_mask:0xf
    v_add_f32 v121, v121, v121 row_ror:8 row_mask:0xf bank_mask:0xf
    v_and_b32 v2, 8, v1
    v_cmp_eq_u32 vcc, 0, v2
    s_nop 1
    v_cndmask_b32 v120, v121, v120, vcc
    buffer_store_dword v120, v253, s[48:51], s84 offen sc1
    s_lshr_b32 s3, s71, 3
    s_add_u32 s3, s3, 3
    s_and_b32 s28, s3, 7
    s_lshr_b32 s3, s3, 3
    s_lshl_b32 s3, s3, 6
    s_add_u32 s3, s3, s28
    s_lshl_b32 s3, s3, 11
    buffer_load_dwordx4 v[204:207], v22, s[56:59], s3 offen nt
    s_lshr_b32 s3, s71, 3
    s_add_u32 s3, s3, 4
    s_and_b32 s28, s3, 7
    s_lshr_b32 s3, s3, 3
    s_lshl_b32 s3, s3, 6
    s_add_u32 s3, s3, s28
    s_lshl_b32 s3, s3, 11
    buffer_load_dwordx4 v[208:211], v22, s[56:59], s3 offen nt
    s_lshr_b32 s3, s71, 3
    s_add_u32 s3, s3, 5
    s_and_b32 s28, s3, 7
    s_lshr_b32 s3, s3, 3
    s_lshl_b32 s3, s3, 6
    s_add_u32 s3, s3, s28
    s_lshl_b32 s3, s3, 11
    buffer_load_dwordx4 v[212:215], v22, s[56:59], s3 offen nt
    s_lshr_b32 s3, s71, 3
    s_add_u32 s3, s3, 6
    s_and_b32 s28, s3, 7
    s_lshr_b32 s3, s3, 3
    s_lshl_b32 s3, s3, 6
    s_add_u32 s3, s3, s28
    s_lshl_b32 s3, s3, 11
    buffer_load_dwordx4 v[216:219], v22, s[56:59], s3 offen nt
    s_waitcnt vmcnt(5)
    s_cmp_eq_u32 s83, 0
    s_cbranch_scc1 L_hz
    s_mov_b32 s29, 0
L_k4:
    v_max3_u32 v2, v48, v49, v50
    v_max3_u32 v2, v2, v51, v52
    v_max3_u32 v2, v2, v53, v54
    v_max_u32 v2, v2, v55
    v_cmp_eq_u32 vcc, -1, v2
    s_cbranch_vccz L_k4k
    s_add_u32 s29, s29, 1
    s_cmp_ge_u32 s29, 200000
    s_cbranch_scc1 L_k4k
    s_sleep 1
    s_add_u32 s3, s76, 0
    buffer_load_dwordx4 v[48:51], v112, s[48:51], s3 offen sc1
    s_add_u32 s3, s76, 33792
    buffer_load_dwordx4 v[52:55], v112, s[48:51], s3 offen sc1
    s_waitcnt vmcnt(0)
    s_branch L_k4
L_k4k:
    v_lshlrev_b32 v64, 16, v48
    v_and_b32 v65, 0xffff0000, v48
    v_lshlrev_b32 v66, 16, v49
    v_and_b32 v67, 0xffff0000, v49
    v_lshlrev_b32 v68, 16, v50
    v_and_b32 v69, 0xffff0000, v50
    v_lshlrev_b32 v70, 16, v51
    v_and_b32 v71, 0xffff0000, v51
    v_lshlrev_b32 v72, 16, v52
    v_and_b32 v73, 0xffff0000, v52
    v_pk_add_f32 v[64:65], v[64:65], v[72:73]
    v_lshlrev_b32_e64 v74, 16, v53
    v_and_b32 v75, 0xffff0000, v53
    v_pk_add_f32 v[66:67], v[66:67], v[74:75]
    v_lshlrev_b32_e64 v76, 16, v54
    v_and_b32 v77, 0xffff0000, v54
    v_pk_add_f32 v[68:69], v[68:69], v[76:77]
    v_lshlrev_b32_e64 v78, 16, v55
    v_and_b32 v79, 0xffff0000, v55
    v_pk_add_f32 v[70:71], v[70:71], v[78:79]
    v_permlane32_swap_b32 v64, v68
    v_permlane32_swap_b32 v65, v69
    v_permlane32_swap_b32 v66, v70
    v_permlane32_swap_b32 v67, v71
    v_add_f32 v64, v64, v68
    v_add_f32 v65, v65, v69
    v_add_f32 v66, v66, v70
    v_add_f32 v67, v67, v71
    s_nop 0
    v_permlane16_swap_b32 v64, v66
    v_permlane16_swap_b32 v65, v67
    v_add_f32 v64, v64, v66
    v_add_f32 v65, v65, v67
    s_nop 0
    v_add_f32 v64, v64, v64 row_ror:8 row_mask:0xf bank_mask:0xf
    v_add_f32 v65, v65, v65 row_ror:8 row_mask:0xf bank_mask:0xf
    v_cvt_pk_bf16_f32 v64, v64, v65
    v_mov_b32 v65, v64
    s_nop 1
    v_permlane16_swap_b32 v64, v65
    v_mov_b32 v66, v64
    v_mov_b32 v67, v65
    s_nop 0
    v_permlane32_swap_b32 v64, v66
    v_permlane32_swap_b32 v65, v67
    s_mov_b64 exec, 0xffff
    buffer_store_dwordx4 v[64:67], v114, s[48:51], s74 offen sc1
    s_branch L_h1e
L_hz:
    s_mov_b32 s29, 0
L_k3:
    v_max3_u32 v2, v48, v49, v50
    v_max3_u32 v2, v2, v51, v52
    v_max3_u32 v2, v2, v53, v54
    v_max3_u32 v2, v2, v55, v32
    v_max3_u32 v2, v2, v33, v34
    v_max3_u32 v2, v2, v35, v36
    v_max3_u32 v2, v2, v37, v38
    v_max_u32 v2, v2, v39
    v_cmp_eq_u32 vcc, -1, v2
    s_cbranch_vccz L_k3k
    s_add_u32 s29, s29, 1
    s_cmp_ge_u32 s29, 200000
    s_cbranch_scc1 L_k3k
    s_sleep 1
    s_add_u32 s3, s76, 0
    buffer_load_dwordx4 v[48:51], v112, s[48:51], s3 offen sc1
    s_add_u32 s3, s76, 33792
    buffer_load_dwordx4 v[52:55], v112, s[48:51], s3 offen sc1
    s_add_u32 s3, s81, 0
    buffer_load_dwordx4 v[32:35], v112, s[48:51], s3 offen sc1
    s_add_u32 s3, s81, 33792
    buffer_load_dwordx4 v[36:39], v112, s[48:51], s3 offen sc1
    s_waitcnt vmcnt(0)
    s_branch L_k3
L_k3k:
    v_lshlrev_b32 v64, 16, v48
    v_lshlrev_b32 v96, 16, v32
    v_and_b32 v65, 0xffff0000, v48
    v_and_b32 v97, 0xffff0000, v32
    v_lshlrev_b32 v66, 16, v49
    v_lshlrev_b32 v98, 16, v33
    v_and_b32 v67, 0xffff0000, v49
    v_and_b32 v99, 0xffff0000, v33
    v_lshlrev_b32 v68, 16, v50
    v_lshlrev_b32 v100, 16, v34
    v_and_b32 v69, 0xffff0000, v50
    v_and_b32 v101, 0xffff0000, v34
    v_lshlrev_b32 v70, 16, v51
    v_lshlrev_b32 v102, 16, v35
    v_and_b32 v71, 0xffff0000, v51
    v_and_b32 v103, 0xffff0000, v35
    v_lshlrev_b32 v72, 16, v52
    v_lshlrev_b32 v104, 16, v36
    v_and_b32 v73, 0xffff0000, v52
    v_and_b32 v105, 0xffff0000, v36
    v_pk_add_f32 v[64:65], v[64:65], v[72:73]
    v_pk_add_f32 v[96:97], v[96:97], v[104:105]
    v_lshlrev_b32 v74, 16, v53
    v_lshlrev_b32 v106, 16, v37
    v_and_b32 v75, 0xffff0000, v53
    v_and_b32 v107, 0xffff0000, v37
    v_pk_add_f32 v[66:67], v[66:67], v[74:75]
    v_pk_add_f32 v[98:99], v[98:99], v[106:107]
    v_lshlrev_b32 v76, 16, v54
    v_lshlrev_b32 v108, 16, v38
    v_and_b32 v77, 0xffff0000, v54
    v_and_b32 v109, 0xffff0000, v38
    v_pk_add_f32 v[68:69], v[68:69], v[76:77]
    v_pk_add_f32 v[100:101], v[100:101], v[108:109]
    v_lshlrev_b32 v78, 16, v55
    v_lshlrev_b32 v110, 16, v39
    v_and_b32 v79, 0xffff0000, v55
    v_and_b32 v111, 0xffff0000, v39
    v_pk_add_f32 v[70:71], v[70:71], v[78:79]
    v_pk_add_f32 v[102:103], v[102:103], v[110:111]
    v_permlane32_swap_b32 v64, v68
    v_permlane32_swap_b32 v96, v100
    v_permlane32_swap_b32 v65, v69
    v_permlane32_swap_b32 v97, v101
    v_permlane32_swap_b32 v66, v70
    v_permlane32_swap_b32 v98, v102
    v_permlane32_swap_b32 v67, v71
    v_permlane32_swap_b32 v99, v103
    v_add_f32 v64, v64, v68
    v_add_f32 v96, v96, v100
    v_add_f32 v65, v65, v69
    v_add_f32 v97, v97, v101
    v_add_f32 v66, v66, v70
    v_add_f32 v98, v98, v102
    v_add_f32 v67, v67, v71
    v_add_f32 v99, v99, v103
    v_permlane16_swap_b32 v64, v66
    v_permlane16_swap_b32 v96, v98
    v_permlane16_swap_b32 v65, v67
    v_permlane16_swap_b32 v97, v99
    v_add_f32 v64, v64, v66
    v_add_f32 v96, v96, v98
    v_add_f32 v65, v65, v67
    v_add_f32 v97, v97, v99
    v_add_f32 v64, v64, v64 row_ror:8 row_mask:0xf bank_mask:0xf
    v_add_f32 v96, v96, v96 row_ror:8 row_mask:0xf bank_mask:0xf
    v_add_f32 v65, v65, v65 row_ror:8 row_mask:0xf bank_mask:0xf
    v_add_f32 v97, v97, v97 row_ror:8 row_mask:0xf bank_mask:0xf
    v_cvt_pk_bf16_f32 v64, v64, v65
    v_cvt_pk_bf16_f32 v96, v96, v97
    v_mov_b32 v65, v64
    v_mov_b32 v97, v96
    s_nop 0
    v_permlane16_swap_b32 v64, v65
    v_permlane16_swap_b32 v96, v97
    v_mov_b32 v66, v64
    v_mov_b32 v98, v96
    v_mov_b32 v67, v65
    v_mov_b32 v99, v97
    v_permlane32_swap_b32 v64, v66
    v_permlane32_swap_b32 v96, v98
    v_permlane32_swap_b32 v65, v67
    v_permlane32_swap_b32_e64 v97, v99
    s_mov_b64 exec, 0xffff
    buffer_store_dwordx4 v[64:67], v114, s[48:51], s74 offen sc1
    buffer_store_dwordx4 v[96:99], v114, s[48:51], s82 offen sc1
L_h1e:
    s_mov_b64 exec, -1
    s_lshl_b32 s3, s38, 2
    s_add_u32 s3, s3, 162112
    v_mov_b32 v4, s3
    v_mov_b32 v5, 3
    ds_write_b32 v4, v5
    s_setprio 0
    v_and_b32 v2, 15, v1
    v_add_u32 v2, s69, v2
    v_lshlrev_b32 v2, 2, v2
    v_add_u32 v2, 152064, v2
    ds_read_b32 v9, v2
    ds_read_b32 v8, v2 offset:1024
    s_waitcnt lgkmcnt(0)
    v_mul_f32 v28, v9, v8
    v_mov_b32 v30, 0xbfb8aa3b
    v_lshlrev_b32 v224, 16, v240
    v_and_b32 v225, 0xffff0000, v240
    v_lshlrev_b32 v226, 16, v241
    v_and_b32 v227, 0xffff0000, v241
    v_lshlrev_b32 v228, 16, v242
    v_and_b32 v229, 0xffff0000, v242
    v_lshlrev_b32 v230, 16, v243
    v_and_b32 v231, 0xffff0000, v243
    v_lshlrev_b32 v232, 16, v244
    v_and_b32 v233, 0xffff0000, v244
    v_lshlrev_b32 v234, 16, v245
    v_and_b32 v235, 0xffff0000, v245
    v_lshlrev_b32 v236, 16, v246
    v_and_b32 v237, 0xffff0000, v246
    v_lshlrev_b32 v238, 16, v247
    v_and_b32 v239, 0xffff0000, v247
    v_pk_fma_f32 v[224:225], v[224:225], v[8:9], v[28:29] op_sel_hi:[1,0,0] neg_lo:[0,0,1] neg_hi:[0,0,1]
    v_pk_fma_f32 v[226:227], v[226:227], v[8:9], v[28:29] op_sel_hi:[1,0,0] neg_lo:[0,0,1] neg_hi:[0,0,1]
    v_pk_fma_f32 v[228:229], v[228:229], v[8:9], v[28:29] op_sel_hi:[1,0,0] neg_lo:[0,0,1] neg_hi:[0,0,1]
    v_pk_fma_f32 v[230:231], v[230:231], v[8:9], v[28:29] op_sel_hi:[1,0,0] neg_lo:[0,0,1] neg_hi:[0,0,1]
    v_pk_fma_f32 v[232:233], v[232:233], v[8:9], v[28:29] op_sel_hi:[1,0,0] neg_lo:[0,0,1] neg_hi:[0,0,1]
    v_pk_fma_f32 v[234:235], v[234:235], v[8:9], v[28:29] op_sel_hi:[1,0,0] neg_lo:[0,0,1] neg_hi:[0,0,1]
    v_pk_fma_f32 v[236:237], v[236:237], v[8:9], v[28:29] op_sel_hi:[1,0,0] neg_lo:[0,0,1] neg_hi:[0,0,1]
    v_pk_fma_f32 v[238:239], v[238:239], v[8:9], v[28:29] op_sel_hi:[1,0,0] neg_lo:[0,0,1] neg_hi:[0,0,1]
    v_pk_mul_f32 v[32:33], v[224:225], v[30:31] op_sel_hi:[1,0]
    v_pk_mul_f32 v[34:35], v[226:227], v[30:31] op_sel_hi:[1,0]
    v_pk_mul_f32 v[36:37], v[228:229], v[30:31] op_sel_hi:[1,0]
    v_pk_mul_f32 v[38:39], v[230:231], v[30:31] op_sel_hi:[1,0]
    v_pk_mul_f32 v[40:41], v[232:233], v[30:31] op_sel_hi:[1,0]
    v_pk_mul_f32 v[42:43], v[234:235], v[30:31] op_sel_hi:[1,0]
    v_pk_mul_f32 v[44:45], v[236:237], v[30:31] op_sel_hi:[1,0]
    v_pk_mul_f32 v[46:47], v[238:239], v[30:31] op_sel_hi:[1,0]
    v_exp_f32 v32, v32
    v_exp_f32 v33, v33
    v_exp_f32 v34, v34
    v_exp_f32 v35, v35
    v_exp_f32 v36, v36
    v_exp_f32 v37, v37
    v_exp_f32 v38, v38
    v_exp_f32 v39, v39
    v_exp_f32 v40, v40
    v_exp_f32 v41, v41
    v_exp_f32 v42, v42
    v_exp_f32 v43, v43
    v_exp_f32 v44, v44
    v_exp_f32 v45, v45
    v_exp_f32 v46, v46
    v_exp_f32 v47, v47
    v_pk_add_f32 v[32:33], v[32:33], 1.0 op_sel_hi:[1,0]
    v_pk_add_f32 v[34:35], v[34:35], 1.0 op_sel_hi:[1,0]
    v_pk_add_f32 v[36:37], v[36:37], 1.0 op_sel_hi:[1,0]
    v_pk_add_f32 v[38:39], v[38:39], 1.0 op_sel_hi:[1,0]
    v_pk_add_f32 v[40:41], v[40:41], 1.0 op_sel_hi:[1,0]
    v_pk_add_f32 v[42:43], v[42:43], 1.0 op_sel_hi:[1,0]
    v_pk_add_f32 v[44:45], v[44:45], 1.0 op_sel_hi:[1,0]
    v_pk_add_f32 v[46:47], v[46:47], 1.0 op_sel_hi:[1,0]
    v_rcp_f32 v32, v32
    v_rcp_f32 v33, v33
    v_rcp_f32 v34, v34
    v_rcp_f32 v35, v35
    v_rcp_f32 v36, v36
    v_rcp_f32 v37, v37
    v_rcp_f32 v38, v38
    v_rcp_f32 v39, v39
    v_rcp_f32 v40, v40
    v_rcp_f32 v41, v41
    v_rcp_f32 v42, v42
    v_rcp_f32 v43, v43
    v_rcp_f32 v44, v44
    v_rcp_f32 v45, v45
    v_rcp_f32 v46, v46
    v_rcp_f32 v47, v47
    v_pk_mul_f32 v[224:225], v[224:225], v[32:33]
    v_pk_mul_f32 v[226:227], v[226:227], v[34:35]
    v_pk_mul_f32 v[228:229], v[228:229], v[36:37]
    v_pk_mul_f32 v[230:231], v[230:231], v[38:39]
    v_pk_mul_f32 v[232:233], v[232:233], v[40:41]
    v_pk_mul_f32 v[234:235], v[234:235], v[42:43]
    v_pk_mul_f32 v[236:237], v[236:237], v[44:45]
    v_pk_mul_f32 v[238:239], v[238:239], v[46:47]
    s_add_u32 s3, s75, 0
    s_nop 0
    buffer_load_dwordx4 v[80:83], v13, s[48:51], s3 offen sc1
    s_add_u32 s3, s75, 57344
    buffer_load_dwordx4 v[84:87], v13, s[48:51], s3 offen sc1
    s_add_u32 s3, s75, 114688
    buffer_load_dwordx4 v[88:91], v13, s[48:51], s3 offen sc1
    s_add_u32 s3, s75, 172032
    buffer_load_dwordx4 v[92:95], v13, s[48:51], s3 offen sc1
    s_waitcnt vmcnt(0)
    s_mov_b32 s29, 0
L_k5:
    v_max3_u32 v2, v80, v81, v82
    v_max3_u32 v2, v2, v83, v84
    v_max3_u32 v2, v2, v85, v86
    v_max3_u32 v2, v2, v87, v88
    v_max3_u32 v2, v2, v89, v90
    v_max3_u32 v2, v2, v91, v92
    v_max3_u32 v2, v2, v93, v94
    v_max_u32 v2, v2, v95
    v_cmp_eq_u32 vcc, -1, v2
    s_cbranch_vccz L_k5k
    s_add_u32 s29, s29, 1
    s_cmp_ge_u32 s29, 200000
    s_cbranch_scc1 L_k5k
    s_sleep 1
    s_add_u32 s3, s75, 0
    s_nop 0
    buffer_load_dwordx4 v[80:83], v13, s[48:51], s3 offen sc1
    s_add_u32 s3, s75, 57344
    buffer_load_dwordx4 v[84:87], v13, s[48:51], s3 offen sc1
    s_add_u32 s3, s75, 114688
    buffer_load_dwordx4 v[88:91], v13, s[48:51], s3 offen sc1
    s_add_u32 s3, s75, 172032
    buffer_load_dwordx4 v[92:95], v13, s[48:51], s3 offen sc1
    s_waitcnt vmcnt(0)
    s_branch L_k5
L_k5k:
    v_pk_add_f32 v[80:81], v[80:81], v[84:85]
    v_pk_add_f32 v[82:83], v[82:83], v[86:87]
    v_pk_add_f32 v[88:89], v[88:89], v[92:93]
    v_pk_add_f32 v[90:91], v[90:91], v[94:95]
    s_nop 0
    v_permlane32_swap_b32 v80, v88
    v_permlane32_swap_b32 v81, v89
    v_permlane32_swap_b32 v82, v90
    v_permlane32_swap_b32 v83, v91
    v_add_f32 v80, v80, v88
    v_add_f32 v81, v81, v89
    v_add_f32 v82, v82, v90
    v_add_f32 v83, v83, v91
    v_permlane16_swap_b32 v80, v81
    s_nop 0
    v_permlane16_swap_b32 v82, v83
    v_add_f32 v80, v80, v81
    v_add_f32 v82, v82, v83
    s_nop 1
    v_permlane32_swap_b32 v80, v82
    v_cvt_pk_bf16_f32 v80, v80, v80
    v_lshlrev_b32 v80, 16, v80
    v_cvt_pk_bf16_f32 v82, v82, v82
    v_lshlrev_b32 v82, 16, v82
    v_mul_f32 v2, 0xbfb8aa3b, v80
    v_exp_f32 v2, v2
    s_nop 0
    v_add_f32 v2, 1.0, v2
    v_rcp_f32 v2, v2
    s_nop 0
    v_mul_f32 v80, v80, v2
    v_cvt_pk_bf16_f32 v80, v80, v80
    v_lshlrev_b32 v80, 16, v80
    v_mul_f32 v80, v80, v82
    v_cvt_pk_bf16_f32 v80, v80, v80
    v_lshlrev_b32 v80, 16, v80
    v_bfe_u32 v2, v1, 3, 2
    v_lshlrev_b32 v2, 6, v2
    v_lshrrev_b32_e64 v3, 5, v1
    v_lshl_add_u32 v2, v3, 2, v2
    ds_bpermute_b32 v128, v2, v80 offset:0
    ds_bpermute_b32 v130, v2, v80 offset:8
    ds_bpermute_b32 v132, v2, v80 offset:16
    ds_bpermute_b32 v134, v2, v80 offset:24
    ds_bpermute_b32 v136, v2, v80 offset:32
    ds_bpermute_b32 v138, v2, v80 offset:40
    ds_bpermute_b32 v140, v2, v80 offset:48
    v_mov_b64 v[120:121], 0
    v_mov_b64 v[122:123], 0
    v_mov_b64 v[124:125], 0
    v_mov_b64 v[126:127], 0
    s_waitcnt lgkmcnt(0)
    v_lshlrev_b32 v2, 16, v192
    v_and_b32 v3, 0xffff0000, v192
    v_pk_fma_f32 v[120:121], v[2:3], v[128:129], v[120:121] op_sel_hi:[1,0,1]
    v_lshlrev_b32_e64 v4, 16, v193
    v_and_b32 v5, 0xffff0000, v193
    v_pk_fma_f32 v[122:123], v[4:5], v[128:129], v[122:123] op_sel_hi:[1,0,1]
    v_lshlrev_b32_e64 v2, 16, v194
    v_and_b32 v3, 0xffff0000, v194
    v_pk_fma_f32 v[124:125], v[2:3], v[128:129], v[124:125] op_sel_hi:[1,0,1]
    v_lshlrev_b32_e64 v4, 16, v195
    v_and_b32 v5, 0xffff0000, v195
    v_pk_fma_f32 v[126:127], v[4:5], v[128:129], v[126:127] op_sel_hi:[1,0,1]
    v_lshlrev_b32_e64 v2, 16, v196
    v_and_b32 v3, 0xffff0000, v196
    v_pk_fma_f32 v[120:121], v[2:3], v[130:131], v[120:121] op_sel_hi:[1,0,1]
    v_lshlrev_b32_e64 v4, 16, v197
    v_and_b32 v5, 0xffff0000, v197
    v_pk_fma_f32 v[122:123], v[4:5], v[130:131], v[122:123] op_sel_hi:[1,0,1]
    v_lshlrev_b32_e64 v2, 16, v198
    v_and_b32 v3, 0xffff0000, v198
    v_pk_fma_f32 v[124:125], v[2:3], v[130:131], v[124:125] op_sel_hi:[1,0,1]
    v_lshlrev_b32_e64 v4, 16, v199
    v_and_b32 v5, 0xffff0000, v199
    v_pk_fma_f32 v[126:127], v[4:5], v[130:131], v[126:127] op_sel_hi:[1,0,1]
    v_lshlrev_b32_e64 v2, 16, v200
    v_and_b32 v3, 0xffff0000, v200
    v_pk_fma_f32 v[120:121], v[2:3], v[132:133], v[120:121] op_sel_hi:[1,0,1]
    v_lshlrev_b32_e64 v4, 16, v201
    v_and_b32 v5, 0xffff0000, v201
    v_pk_fma_f32 v[122:123], v[4:5], v[132:133], v[122:123] op_sel_hi:[1,0,1]
    v_lshlrev_b32_e64 v2, 16, v202
    v_and_b32 v3, 0xffff0000, v202
    v_pk_fma_f32 v[124:125], v[2:3], v[132:133], v[124:125] op_sel_hi:[1,0,1]
    v_lshlrev_b32_e64 v4, 16, v203
    v_and_b32 v5, 0xffff0000, v203
    v_pk_fma_f32 v[126:127], v[4:5], v[132:133], v[126:127] op_sel_hi:[1,0,1]
    v_lshlrev_b32_e64 v2, 16, v204
    v_and_b32 v3, 0xffff0000, v204
    v_pk_fma_f32 v[120:121], v[2:3], v[134:135], v[120:121] op_sel_hi:[1,0,1]
    v_lshlrev_b32_e64 v4, 16, v205
    v_and_b32 v5, 0xffff0000, v205
    v_pk_fma_f32 v[122:123], v[4:5], v[134:135], v[122:123] op_sel_hi:[1,0,1]
    v_lshlrev_b32_e64 v2, 16, v206
    v_and_b32 v3, 0xffff0000, v206
    v_pk_fma_f32 v[124:125], v[2:3], v[134:135], v[124:125] op_sel_hi:[1,0,1]
    v_lshlrev_b32_e64 v4, 16, v207
    v_and_b32 v5, 0xffff0000, v207
    v_pk_fma_f32 v[126:127], v[4:5], v[134:135], v[126:127] op_sel_hi:[1,0,1]
    v_lshlrev_b32_e64 v2, 16, v208
    v_and_b32 v3, 0xffff0000, v208
    v_pk_fma_f32 v[120:121], v[2:3], v[136:137], v[120:121] op_sel_hi:[1,0,1]
    v_lshlrev_b32_e64 v4, 16, v209
    v_and_b32 v5, 0xffff0000, v209
    v_pk_fma_f32 v[122:123], v[4:5], v[136:137], v[122:123] op_sel_hi:[1,0,1]
    v_lshlrev_b32_e64 v2, 16, v210
    v_and_b32 v3, 0xffff0000, v210
    v_pk_fma_f32 v[124:125], v[2:3], v[136:137], v[124:125] op_sel_hi:[1,0,1]
    v_lshlrev_b32_e64 v4, 16, v211
    v_and_b32 v5, 0xffff0000, v211
    v_pk_fma_f32 v[126:127], v[4:5], v[136:137], v[126:127] op_sel_hi:[1,0,1]
    v_lshlrev_b32_e64 v2, 16, v212
    v_and_b32 v3, 0xffff0000, v212
    v_pk_fma_f32 v[120:121], v[2:3], v[138:139], v[120:121] op_sel_hi:[1,0,1]
    v_lshlrev_b32_e64 v4, 16, v213
    v_and_b32 v5, 0xffff0000, v213
    v_pk_fma_f32 v[122:123], v[4:5], v[138:139], v[122:123] op_sel_hi:[1,0,1]
    v_lshlrev_b32_e64 v2, 16, v214
    v_and_b32 v3, 0xffff0000, v214
    v_pk_fma_f32 v[124:125], v[2:3], v[138:139], v[124:125] op_sel_hi:[1,0,1]
    v_lshlrev_b32_e64 v4, 16, v215
    v_and_b32 v5, 0xffff0000, v215
    v_pk_fma_f32 v[126:127], v[4:5], v[138:139], v[126:127] op_sel_hi:[1,0,1]
    v_lshlrev_b32_e64 v2, 16, v216
    v_and_b32 v3, 0xffff0000, v216
    v_pk_fma_f32 v[120:121], v[2:3], v[140:141], v[120:121] op_sel_hi:[1,0,1]
    v_lshlrev_b32_e64 v4, 16, v217
    v_and_b32 v5, 0xffff0000, v217
    v_pk_fma_f32 v[122:123], v[4:5], v[140:141], v[122:123] op_sel_hi:[1,0,1]
    v_lshlrev_b32_e64 v2, 16, v218
    v_and_b32 v3, 0xffff0000, v218
    v_pk_fma_f32 v[124:125], v[2:3], v[140:141], v[124:125] op_sel_hi:[1,0,1]
    v_lshlrev_b32_e64 v4, 16, v219
    v_and_b32 v5, 0xffff0000, v219
    v_pk_fma_f32 v[126:127], v[4:5], v[140:141], v[126:127] op_sel_hi:[1,0,1]
    v_permlane32_swap_b32 v120, v124
    v_permlane32_swap_b32 v121, v125
    v_permlane32_swap_b32 v122, v126
    v_permlane32_swap_b32 v123, v127
    v_add_f32 v120, v120, v124
    v_add_f32 v121, v121, v125
    v_add_f32 v122, v122, v126
    v_add_f32 v123, v123, v127
    s_nop 0
    v_permlane16_swap_b32 v120, v122
    v_permlane16_swap_b32 v121, v123
    v_add_f32 v120, v120, v122
    v_add_f32 v121, v121, v123
    s_nop 0
    v_add_f32 v120, v120, v120 row_ror:8 row_mask:0xf bank_mask:0xf
    v_add_f32 v121, v121, v121 row_ror:8 row_mask:0xf bank_mask:0xf
    v_and_b32 v2, 8, v1
    v_cmp_eq_u32 vcc, 0, v2
    s_and_b32 s3, s2, 15
    s_lshl_b32 s3, s3, 4
    s_lshr_b32 s28, s2, 4
    s_add_u32 s3, s3, s28
    s_lshl_b32 s3, s3, 2
    s_add_u32 s3, s3, s38
    s_lshl_b32 s3, s3, 8
    s_add_u32 s3, s3, 1413120
    v_cndmask_b32 v120, v121, v120, vcc
    buffer_store_dword v120, v253, s[48:51], s3 offen sc1
    v_and_b32 v3, 3, v1
    v_lshlrev_b32 v3, 2, v3
    v_add_u32 v3, 162112, v3
L_ow:
    ds_read_b32 v2, v3
    s_waitcnt lgkmcnt(0)
    v_cmp_ne_u32 vcc, 7, v2
    s_cbranch_vccz L_owk
    s_sleep 1
    s_branch L_ow
L_owk:
    s_branch L_p3
L_C:
    s_and_b32 s64, s38, 1
    s_lshr_b32 s65, s38, 1
    v_and_b32 v3, 15, v1
    v_lshlrev_b32 v3, 7, v3
    s_lshl_b32 s3, s64, 13
    v_add_u32 v3, s3, v3
    v_bfe_u32 v5, v1, 1, 3
    v_lshrrev_b32 v6, 4, v1
    v_xor_b32 v6, v6, v5
    v_lshl_add_u32 v184, v6, 4, v3
    v_xor_b32 v185, 64, v184
    v_lshrrev_b32 v6, 4, v1
    v_lshlrev_b32 v6, 3, v6
    v_bfe_u32 v7, v1, 2, 2
    v_add_u32 v6, v6, v7
    v_lshlrev_b32 v6, 7, v6
    v_and_b32 v7, 3, v1
    v_lshl_add_u32 v6, v7, 3, v6
    v_add_u32 v6, 16384, v6
    v_bfe_u32 v7, v1, 3, 2
    s_lshl_b32 s3, s65, 1
    v_xor_b32 v7, s3, v7
    v_lshl_add_u32 v186, v7, 5, v6
    v_xor_b32_e64 v187, 32, v186
    v_add_u32 v188, 81920, v184
    v_add_u32 v189, 81920, v185
    v_add_u32 v190, 81920, v186
    v_add_u32 v191, 81920, v187
    s_waitcnt lgkmcnt(0)
    s_mov_b32 s48, s26
    s_mov_b32 s49, s27
    s_mov_b32 s50, 268435456
    s_mov_b32 s51, 0x00020000
    s_mov_b32 s40, s4
    s_mov_b32 s41, s5
    s_mov_b32 s42, 4194304
    s_mov_b32 s43, 0x00020000
    s_mov_b32 s88, s10
    s_mov_b32 s89, s11
    s_mov_b32 s90, 2097152
    s_mov_b32 s91, 0x00020000
    s_lshl_b32 s3, s36, 7
    s_lshl_b32 s28, s37, 3
    s_add_u32 s3, s3, s28
    s_lshl_b32 s28, s38, 1
    s_add_u32 s71, s3, s28
    v_lshlrev_b32 v2, 4, v1
    v_mov_b32 v212, 16384
    v_mov_b32 v4, -1
    v_mov_b32 v5, -1
    v_mov_b32 v6, -1
    v_mov_b32_e64 v7, -1
    s_lshl_b32 s28, s2, 2
    s_add_u32 s28, s28, s38
    s_mul_i32 s28, s28, 768
    s_add_u32 s28, s28, 1048320
    s_lshl_b32 s3, s37, 4
    s_add_u32 s3, s3, s36
    s_lshl_b32 s3, s3, 2
    s_add_u32 s3, s3, s38
    s_lshl_b32 s3, s3, 8
    s_add_u32 s3, s3, 524288
    v_cmp_gt_u32 vcc, 16, v1
    v_add_u32 v3, s3, v2
    v_add_u32_e64 v2, s28, v2
    v_cndmask_b32 v2, v2, v3, vcc
    buffer_store_dwordx4 v[4:7], v2, s[48:51], 0 offen sc1
    buffer_load_dword v212, v212, s[48:51], 0 offen sc1
    s_getpc_b64 s[92:93]
L_pc:
    s_sub_u32 s92, s92, L_pc-recurrent_scan__linear_kernel_hedgehog__moe_arch_mod__prompt_kernel
    s_subb_u32 s93, s93, 0
    s_lshr_b32 s3, s2, 3
    s_lshl_b32 s3, s3, 2
    s_add_u32 s3, s3, s38
    s_lshl_b32 s3, s3, 8
    v_lshlrev_b32 v2, 7, v1
    v_add_u32 v2, s3, v2
    s_mov_b64 exec, 3
    global_load_dword v213, v2, s[92:93]
    s_mov_b64 exec, -1
    v_mov_b64 v[8:9], 0
    v_mov_b64 v[10:11], 0
    v_mov_b64 v[12:13], 0
    v_mov_b64 v[14:15], 0
    v_mov_b64 v[16:17], 0
    v_mov_b64 v[18:19], 0
    v_mov_b64 v[20:21], 0
    v_mov_b64 v[22:23], 0
    v_mov_b64 v[24:25], 0
    v_mov_b64 v[26:27], 0
    v_mov_b64 v[28:29], 0
    v_mov_b64 v[30:31], 0
    v_mov_b64 v[32:33], 0
    v_mov_b64 v[34:35], 0
    v_mov_b64 v[36:37], 0
    v_mov_b64 v[38:39], 0
    v_mov_b64 v[40:41], 0
    v_mov_b64 v[42:43], 0
    v_mov_b64 v[44:45], 0
    v_mov_b64 v[46:47], 0
    v_mov_b64 v[48:49], 0
    v_mov_b64 v[50:51], 0
    v_mov_b64 v[52:53], 0
    v_mov_b64 v[54:55], 0
    v_mov_b64 v[56:57], 0
    v_mov_b64 v[58:59], 0
    v_mov_b64 v[60:61], 0
    v_mov_b64 v[62:63], 0
    v_mov_b64 v[64:65], 0
    v_mov_b64 v[66:67], 0
    v_mov_b64 v[68:69], 0
    v_mov_b64 v[70:71], 0
    v_mov_b64 v[72:73], 0
    v_mov_b64 v[74:75], 0
    v_mov_b64 v[76:77], 0
    v_mov_b64 v[78:79], 0
    v_mov_b64 v[80:81], 0
    v_mov_b64 v[82:83], 0
    v_mov_b64 v[84:85], 0
    v_mov_b64 v[86:87], 0
    v_mov_b64 v[88:89], 0
    v_mov_b64 v[90:91], 0
    v_mov_b64 v[92:93], 0
    v_mov_b64 v[94:95], 0
    v_mov_b64 v[96:97], 0
    v_mov_b64 v[98:99], 0
    v_mov_b64 v[100:101], 0
    v_mov_b64 v[102:103], 0
    s_lshl_b32 s3, s38, 2
    s_add_u32 s3, s3, 162112
    v_mov_b32 v2, s3
    v_mov_b32_e64 v3, 0
    ds_write_b32 v2, v3
    ds_write_b32 v2, v3 offset:16
    s_mov_b32 s86, 0
    s_mov_b32 s66, 0
    s_setprio 2
    s_waitcnt lgkmcnt(0)
    s_lshl_b32 s3, s38, 1
    s_lshr_b32 s28, s39, 2
    s_add_u32 s3, s3, s28
    s_lshl_b32 s69, s3, 4
    v_and_b32 v237, 15, v1
    v_add_u32 v236, s69, v237
    v_lshlrev_b32 v236, 7, v236
    v_lshrrev_b32 v237, 1, v237
    v_lshrrev_b32 v238, 5, v1
    v_xor_b32 v237, v237, v238
    v_lshl_add_u32 v236, v237, 4, v236
    v_bfe_u32 v238, v1, 4, 1
    v_lshl_add_u32 v236, v238, 3, v236
    v_xor_b32 v237, 32, v236
    v_xor_b32 v238, 64, v236
    v_xor_b32 v239, 96, v236
    v_and_b32 v2, 15, v1
    v_lshrrev_b32_e64 v3, 4, v1
    s_lshl_b32 s3, s64, 8
    s_add_u32 s3, s3, 152064
    v_lshl_add_u32 v232, v2, 2, s3
    v_lshl_add_u32 v233, v3, 4, s3
    v_lshrrev_b32 v7, 5, v1
    v_lshl_add_u32 v234, v7, 6, v232
    s_lshl_b32 s3, s65, 7
    s_add_u32 s3, s3, 154880
    v_lshl_add_u32 v235, v3, 4, s3
    v_lshl_add_u32 v248, v2, 2, s3
    s_lshl_b32 s3, s64, 7
    s_add_u32 s3, s3, 154624
    v_lshl_add_u32 v249, v3, 4, s3
    v_xor_b32 v253, 128, v249
    v_lshrrev_b32 v250, 2, v1
    v_lshlrev_b32 v250, 6, v250
    v_and_b32 v251, 3, v1
    v_lshl_add_u32 v250, v251, 3, v250
    s_lshl_b32 s3, s65, 11
    s_add_u32 s3, s3, 147712
    v_add_u32 v252, s3, v250
    v_bfe_u32 v5, v1, 1, 2
    v_lshlrev_b32_e64 v5, 2, v5
    v_bfe_u32 v4, v1, 3, 1
    v_lshl_add_u32 v5, v4, 1, v5
    v_and_b32 v4, 1, v1
    v_add_u32 v5, v5, v4
    v_xor_b32 v5, v5, v3
    s_lshl_b32 s3, s38, 13
    s_add_u32 s3, s3, 98304
    v_lshl_add_u32 v2, v2, 7, s3
    v_lshl_add_u32 v4, v5, 3, v2
    v_xor_b32 v5, 32, v4
    v_xor_b32 v6, 64, v4
    v_xor_b32 v7, 96, v4
    v_bfe_u32 v2, v1, 3, 2
    v_lshlrev_b32 v2, 2, v2
    v_lshrrev_b32 v3, 5, v1
    v_lshl_add_u32 v2, v3, 1, v2
    v_bfe_u32 v3, v1, 2, 1
    v_add_u32 v2, v2, v3
    v_xor_b32 v2, v2, v251
    v_lshrrev_b32_e64 v3, 2, v1
    v_lshl_add_u32 v3, v3, 7, s3
    v_lshl_add_u32 v2, v2, 3, v3
    s_lshl_b32 s28, s64, 6
    v_xor_b32 v201, s28, v2
    v_xor_b32 v203, 32, v201
    s_lshl_b32 s3, s38, 12
    s_add_u32 s3, s3, 131072
    v_lshlrev_b32 v199, 4, v1
    v_add_u32 v197, s3, v199
    s_lshl_b32 s3, s37, 1
    s_add_u32 s67, s3, s65
    s_lshl_b32 s3, s67, 4
    s_add_u32 s3, s3, s36
    s_mul_i32 s3, s3, 4224
    s_add_u32 s75, s3, 8388608
    s_lshl_b32 s3, s64, 11
    s_add_u32 s74, s75, s3
    s_lshl_b32 s3, s64, 6
    s_add_u32 s75, s75, s3
    s_add_u32 s75, s75, 4096
    s_lshl_b32 s3, s37, 4
    s_add_u32 s3, s3, s36
    s_lshl_b32 s3, s3, 7
    s_add_u32 s3, s3, 32768
    s_cmp_lg_u32 s38, 0
    s_cselect_b32 s76, 268435456, s3
L_ln:
    s_lshl_b32 s3, s38, 12
    s_add_u32 s3, s3, 131072
    v_lshlrev_b32 v2, 4, v1
    v_add_u32 v3, s3, v2
    v_add_u32 v2, 122880, v2
    s_barrier
    ds_read_b128 v[120:123], v2 offset:0
    ds_read_b128 v[124:127], v2 offset:1024
    ds_read_b128 v[104:107], v3 offset:0
    ds_read_b128 v[108:111], v3 offset:1024
    ds_read_b128 v[112:115], v3 offset:2048
    ds_read_b128 v[116:119], v3 offset:3072
    v_mov_b32 v2, 0x3f803f80
    v_mov_b32 v128, 0
    v_mov_b32 v130, 0
    v_mov_b32 v132, 0
    v_mov_b32 v134, 0
    v_mov_b32 v136, 0
    v_mov_b32 v138, 0
    v_mov_b32 v140, 0
    v_mov_b32 v142, 0
    s_waitcnt lgkmcnt(2)
    v_dot2c_f32_bf16 v128, v104, v2
    v_dot2c_f32_bf16 v132, v104, v104
    v_dot2c_f32_bf16 v136, v104, v120
    v_dot2c_f32_bf16 v140, v120, v2
    v_dot2c_f32_bf16 v128, v105, v2
    v_dot2c_f32_bf16 v132, v105, v105
    v_dot2c_f32_bf16 v136, v105, v121
    v_dot2c_f32_bf16 v140, v121, v2
    v_dot2c_f32_bf16 v128, v106, v2
    v_dot2c_f32_bf16 v132, v106, v106
    v_dot2c_f32_bf16 v136, v106, v122
    v_dot2c_f32_bf16 v140, v122, v2
    v_dot2c_f32_bf16 v128, v107, v2
    v_dot2c_f32_bf16 v132, v107, v107
    v_dot2c_f32_bf16 v136, v107, v123
    v_dot2c_f32_bf16 v140, v123, v2
    v_dot2c_f32_bf16 v128, v108, v2
    v_dot2c_f32_bf16 v132, v108, v108
    v_dot2c_f32_bf16 v136, v108, v124
    v_dot2c_f32_bf16 v140, v124, v2
    v_dot2c_f32_bf16 v128, v109, v2
    v_dot2c_f32_bf16 v132, v109, v109
    v_dot2c_f32_bf16 v136, v109, v125
    v_dot2c_f32_bf16 v140, v125, v2
    v_dot2c_f32_bf16 v128, v110, v2
    v_dot2c_f32_bf16 v132, v110, v110
    v_dot2c_f32_bf16 v136, v110, v126
    v_dot2c_f32_bf16 v140, v126, v2
    v_dot2c_f32_bf16 v128, v111, v2
    v_dot2c_f32_bf16 v132, v111, v111
    v_dot2c_f32_bf16 v136, v111, v127
    v_dot2c_f32_bf16 v140, v127, v2
    s_waitcnt lgkmcnt(0)
    v_dot2c_f32_bf16 v130, v112, v2
    v_dot2c_f32_bf16 v134, v112, v112
    v_dot2c_f32_bf16 v138, v112, v120
    v_dot2c_f32_bf16 v142, v120, v2
    v_dot2c_f32_bf16 v130, v113, v2
    v_dot2c_f32_bf16 v134, v113, v113
    v_dot2c_f32_bf16 v138, v113, v121
    v_dot2c_f32_bf16 v142, v121, v2
    v_dot2c_f32_bf16 v130, v114, v2
    v_dot2c_f32_bf16 v134, v114, v114
    v_dot2c_f32_bf16 v138, v114, v122
    v_dot2c_f32_bf16 v142, v122, v2
    v_dot2c_f32_bf16 v130, v115, v2
    v_dot2c_f32_bf16 v134, v115, v115
    v_dot2c_f32_bf16 v138, v115, v123
    v_dot2c_f32_bf16 v142, v123, v2
    v_dot2c_f32_bf16 v130, v116, v2
    v_dot2c_f32_bf16 v134, v116, v116
    v_dot2c_f32_bf16 v138, v116, v124
    v_dot2c_f32_bf16 v142, v124, v2
    v_dot2c_f32_bf16 v130, v117, v2
    v_dot2c_f32_bf16 v134, v117, v117
    v_dot2c_f32_bf16 v138, v117, v125
    v_dot2c_f32_bf16 v142, v125, v2
    v_dot2c_f32_bf16 v130, v118, v2
    v_dot2c_f32_bf16 v134, v118, v118
    v_dot2c_f32_bf16 v138, v118, v126
    v_dot2c_f32_bf16 v142, v126, v2
    v_dot2c_f32_bf16 v130, v119, v2
    v_dot2c_f32_bf16 v134, v119, v119
    v_dot2c_f32_bf16 v138, v119, v127
    v_dot2c_f32_bf16 v142, v127, v2
    v_permlane32_swap_b32 v128, v130
    v_permlane32_swap_b32 v132, v134
    v_permlane32_swap_b32 v136, v138
    v_permlane32_swap_b32 v140, v142
    v_add_f32 v128, v128, v130
    v_add_f32 v132, v132, v134
    v_add_f32 v136, v136, v138
    v_add_f32 v140, v140, v142
    v_add_f32 v128, v128, v128 quad_perm:[1,0,3,2] row_mask:0xf bank_mask:0xf
    v_add_f32 v132, v132, v132 quad_perm:[1,0,3,2] row_mask:0xf bank_mask:0xf
    v_add_f32 v136, v136, v136 quad_perm:[1,0,3,2] row_mask:0xf bank_mask:0xf
    v_add_f32 v140, v140, v140 quad_perm:[1,0,3,2] row_mask:0xf bank_mask:0xf
    v_add_f32 v128, v128, v128 quad_perm:[2,3,0,1] row_mask:0xf bank_mask:0xf
    v_add_f32 v132, v132, v132 quad_perm:[2,3,0,1] row_mask:0xf bank_mask:0xf
    v_add_f32 v136, v136, v136 quad_perm:[2,3,0,1] row_mask:0xf bank_mask:0xf
    v_add_f32 v140, v140, v140 quad_perm:[2,3,0,1] row_mask:0xf bank_mask:0xf
    v_add_f32 v128, v128, v128 row_half_mirror row_mask:0xf bank_mask:0xf
    v_add_f32 v132, v132, v132 row_half_mirror row_mask:0xf bank_mask:0xf
    v_add_f32 v136, v136, v136 row_half_mirror row_mask:0xf bank_mask:0xf
    v_add_f32 v140, v140, v140 row_half_mirror row_mask:0xf bank_mask:0xf
    v_add_f32 v128, v128, v128 row_mirror row_mask:0xf bank_mask:0xf
    v_add_f32 v132, v132, v132 row_mirror row_mask:0xf bank_mask:0xf
    v_add_f32 v136, v136, v136 row_mirror row_mask:0xf bank_mask:0xf
    v_add_f32 v140, v140, v140 row_mirror row_mask:0xf bank_mask:0xf
    v_mov_b32 v129, v128
    v_mov_b32 v133, v132
    v_mov_b32 v137, v136
    v_mov_b32 v141, v140
    v_permlane16_swap_b32 v128, v129
    v_permlane16_swap_b32 v132, v133
    v_permlane16_swap_b32 v136, v137
    v_permlane16_swap_b32 v140, v141
    v_add_f32 v128, v128, v129
    v_add_f32 v132, v132, v133
    v_add_f32 v136, v136, v137
    v_add_f32 v140, v140, v141
    v_mul_f32 v128, 0x3a800000, v128
    v_mul_f32 v132, 0x3a800000, v132
    v_cvt_pk_bf16_f32 v129, v128, v128
    v_lshlrev_b32 v129, 16, v129
    v_fma_f32 v132, -v128, v128, v132
    v_max_f32 v132, 0, v132
    v_fma_f32 v136, -v129, v140, v136
    s_waitcnt vmcnt(0)
    v_cvt_pk_bf16_f32 v132, v132, v132
    v_lshlrev_b32 v132, 16, v132
    v_add_f32 v132, 0x3727c5ac, v132
    v_cvt_pk_bf16_f32 v132, v132, v132
    v_lshlrev_b32 v132, 16, v132
    v_sqrt_f32 v132, v132
    s_nop 0
    v_cvt_pk_bf16_f32 v132, v132, v132
    v_lshlrev_b32 v132, 16, v132
    v_rcp_f32 v2, v132
    v_lshrrev_b32 v3, 16, v129
    v_or_b32 v208, v3, v132
    v_mul_f32 v136, v136, v2
    v_cvt_pk_bf16_f32 v136, v136, v136
    v_lshlrev_b32 v136, 16, v136
    v_ashrrev_i32 v2, 31, v136
    v_or_b32 v2, 0x80000000, v2
    v_xor_b32 v2, v136, v2
    v_and_b32 v2, 0xffff0000, v2
    v_lshrrev_b32 v3, 5, v1
    v_add_u32 v209, s71, v3
    v_sub_u32 v209, 2047, v209
    v_or_b32 v210, v2, v209
    v_mov_b32 v2, v210
    v_mov_b32 v209, v208
    v_readfirstlane_b32 s86, v212
    v_mov_b32 v3, 0
    s_mul_i32 s86, s86, 1664525
    s_add_u32 s86, s86, 1013904223
    v_mov_b32 v211, s86
    v_permlane32_swap_b32 v210, v2
    v_permlane32_swap_b32 v208, v209
    v_max_u32 v210, v210, v2
    s_lshl_b32 s3, s71, 3
    s_mov_b64 exec, 1
    buffer_store_dwordx4 v[208:211], v3, s[48:51], s3 offen sc1
    s_mov_b64 exec, -1
    v_mov_b32_e64 v251, s86
    s_barrier
    ds_read_b128 v[104:107], v184 offset:0
    ds_read_b64_tr_b16 v[120:121], v186 offset:0
    ds_read_b64_tr_b16 v[122:123], v186 offset:512
    ds_read_b64_tr_b16 v[124:125], v187 offset:0
    ds_read_b64_tr_b16 v[126:127], v187 offset:512
    ds_read_b64_tr_b16 v[128:129], v186 offset:8192
    ds_read_b64_tr_b16 v[130:131], v186 offset:8704
    ds_read_b64_tr_b16 v[132:133], v187 offset:8192
    ds_read_b64_tr_b16 v[134:135], v187 offset:8704
    ds_read_b64_tr_b16 v[136:137], v186 offset:16384
    ds_read_b64_tr_b16 v[138:139], v186 offset:16896
    ds_read_b64_tr_b16 v[140:141], v187 offset:16384
    ds_read_b64_tr_b16 v[142:143], v187 offset:16896
    ds_read_b128 v[108:111], v184 offset:2048
    ds_read_b128 v[112:115], v184 offset:4096
    ds_read_b128 v[116:119], v184 offset:6144
    ds_read_b64 v[240:241], v236
    ds_read_b64 v[242:243], v237
    ds_read_b64 v[244:245], v238
    ds_read_b64 v[246:247], v239
    s_waitcnt lgkmcnt(4)
    s_branch L_cmid
.p2align 6
L_cloop:
    s_waitcnt lgkmcnt(0)
    s_barrier
    v_mfma_f32_16x16x32_bf16 v[8:11], v[160:163], v[144:147], v[8:11]
    ds_read_b128 v[104:107], v184 offset:0
    v_mfma_f32_16x16x32_bf16 v[12:15], v[164:167], v[144:147], v[12:15]
    ds_read_b64_tr_b16 v[120:121], v186 offset:0
    v_mfma_f32_16x16x32_bf16 v[16:19], v[168:171], v[144:147], v[16:19]
    ds_read_b64_tr_b16 v[122:123], v186 offset:512
    v_mfma_f32_16x16x32_bf16 v[20:23], v[172:175], v[144:147], v[20:23]
    ds_read_b64_tr_b16 v[124:125], v187 offset:0
    v_mfma_f32_16x16x32_bf16 v[24:27], v[144:147], v[176:179], v[24:27]
    ds_read_b64_tr_b16 v[126:127], v187 offset:512
    v_mfma_f32_16x16x32_bf16 v[28:31], v[144:147], v[180:183], v[28:31]
    ds_read_b64_tr_b16 v[128:129], v186 offset:8192
    v_mfma_f32_16x16x32_bf16 v[32:35], v[160:163], v[148:151], v[32:35]
    ds_read_b64_tr_b16 v[130:131], v186 offset:8704
    v_mfma_f32_16x16x32_bf16 v[36:39], v[164:167], v[148:151], v[36:39]
    ds_read_b64_tr_b16 v[132:133], v187 offset:8192
    v_mfma_f32_16x16x32_bf16 v[40:43], v[168:171], v[148:151], v[40:43]
    ds_read_b64_tr_b16 v[134:135], v187 offset:8704
    v_mfma_f32_16x16x32_bf16 v[44:47], v[172:175], v[148:151], v[44:47]
    ds_read_b64_tr_b16 v[136:137], v186 offset:16384
    v_mfma_f32_16x16x32_bf16 v[48:51], v[148:151], v[176:179], v[48:51]
    ds_read_b64_tr_b16 v[138:139], v186 offset:16896
    v_mfma_f32_16x16x32_bf16 v[52:55], v[148:151], v[180:183], v[52:55]
    ds_read_b64_tr_b16 v[140:141], v187 offset:16384
    v_mfma_f32_16x16x32_bf16 v[56:59], v[160:163], v[152:155], v[56:59]
    ds_read_b64_tr_b16 v[142:143], v187 offset:16896
    v_mfma_f32_16x16x32_bf16 v[60:63], v[164:167], v[152:155], v[60:63]
    ds_read_b128 v[108:111], v184 offset:2048
    v_mfma_f32_16x16x32_bf16 v[64:67], v[168:171], v[152:155], v[64:67]
    ds_read_b128 v[112:115], v184 offset:4096
    v_mfma_f32_16x16x32_bf16 v[68:71], v[172:175], v[152:155], v[68:71]
    ds_read_b128 v[116:119], v184 offset:6144
    v_mfma_f32_16x16x32_bf16 v[72:75], v[152:155], v[176:179], v[72:75]
    v_mfma_f32_16x16x32_bf16 v[76:79], v[152:155], v[180:183], v[76:79]
    v_mfma_f32_16x16x32_bf16 v[80:83], v[160:163], v[156:159], v[80:83]
    v_mfma_f32_16x16x32_bf16 v[84:87], v[164:167], v[156:159], v[84:87]
    v_mfma_f32_16x16x32_bf16 v[88:91], v[168:171], v[156:159], v[88:91]
    v_mfma_f32_16x16x32_bf16 v[92:95], v[172:175], v[156:159], v[92:95]
    v_mfma_f32_16x16x32_bf16 v[96:99], v[156:159], v[176:179], v[96:99]
    v_mfma_f32_16x16x32_bf16 v[100:103], v[156:159], v[180:183], v[100:103]
    s_waitcnt lgkmcnt(0)
    s_nop 0
L_cmid:
    v_mfma_f32_16x16x32_bf16 v[8:11], v[120:123], v[104:107], v[8:11]
    ds_read_b128 v[144:147], v185 offset:0
    v_mfma_f32_16x16x32_bf16 v[12:15], v[124:127], v[104:107], v[12:15]
    ds_read_b64_tr_b16 v[160:161], v186 offset:4096
    v_mfma_f32_16x16x32_bf16 v[16:19], v[128:131], v[104:107], v[16:19]
    ds_read_b64_tr_b16 v[162:163], v186 offset:4608
    v_mfma_f32_16x16x32_bf16 v[20:23], v[132:135], v[104:107], v[20:23]
    ds_read_b64_tr_b16 v[164:165], v187 offset:4096
    v_mfma_f32_16x16x32_bf16 v[24:27], v[104:107], v[136:139], v[24:27]
    ds_read_b64_tr_b16 v[166:167], v187 offset:4608
    v_mfma_f32_16x16x32_bf16 v[28:31], v[104:107], v[140:143], v[28:31]
    ds_read_b64_tr_b16 v[168:169], v186 offset:12288
    v_mfma_f32_16x16x32_bf16 v[32:35], v[120:123], v[108:111], v[32:35]
    ds_read_b64_tr_b16 v[170:171], v186 offset:12800
    v_mfma_f32_16x16x32_bf16 v[36:39], v[124:127], v[108:111], v[36:39]
    ds_read_b64_tr_b16 v[172:173], v187 offset:12288
    v_mfma_f32_16x16x32_bf16 v[40:43], v[128:131], v[108:111], v[40:43]
    ds_read_b64_tr_b16 v[174:175], v187 offset:12800
    v_mfma_f32_16x16x32_bf16 v[44:47], v[132:135], v[108:111], v[44:47]
    ds_read_b64_tr_b16 v[176:177], v186 offset:20480
    v_mfma_f32_16x16x32_bf16 v[48:51], v[108:111], v[136:139], v[48:51]
    ds_read_b64_tr_b16 v[178:179], v186 offset:20992
    v_mfma_f32_16x16x32_bf16 v[52:55], v[108:111], v[140:143], v[52:55]
    ds_read_b64_tr_b16 v[180:181], v187 offset:20480
    v_mfma_f32_16x16x32_bf16 v[56:59], v[120:123], v[112:115], v[56:59]
    ds_read_b64_tr_b16 v[182:183], v187 offset:20992
    v_mfma_f32_16x16x32_bf16 v[60:63], v[124:127], v[112:115], v[60:63]
    ds_read_b128 v[148:151], v185 offset:2048
    v_mfma_f32_16x16x32_bf16 v[64:67], v[128:131], v[112:115], v[64:67]
    ds_read_b128 v[152:155], v185 offset:4096
    v_mfma_f32_16x16x32_bf16 v[68:71], v[132:135], v[112:115], v[68:71]
    ds_read_b128 v[156:159], v185 offset:6144
    v_mfma_f32_16x16x32_bf16 v[72:75], v[112:115], v[136:139], v[72:75]
    v_mfma_f32_16x16x32_bf16 v[76:79], v[112:115], v[140:143], v[76:79]
    v_mfma_f32_16x16x32_bf16 v[80:83], v[120:123], v[116:119], v[80:83]
    v_mfma_f32_16x16x32_bf16 v[84:87], v[124:127], v[116:119], v[84:87]
    v_mfma_f32_16x16x32_bf16 v[88:91], v[128:131], v[116:119], v[88:91]
    v_mfma_f32_16x16x32_bf16 v[92:95], v[132:135], v[116:119], v[92:95]
    v_mfma_f32_16x16x32_bf16 v[96:99], v[116:119], v[136:139], v[96:99]
    v_mfma_f32_16x16x32_bf16 v[100:103], v[116:119], v[140:143], v[100:103]
    s_waitcnt lgkmcnt(0)
    s_barrier
    v_mfma_f32_16x16x32_bf16 v[8:11], v[160:163], v[144:147], v[8:11]
    ds_read_b128 v[104:107], v184 offset:40960
    v_mfma_f32_16x16x32_bf16 v[12:15], v[164:167], v[144:147], v[12:15]
    ds_read_b64_tr_b16 v[120:121], v186 offset:40960
    v_mfma_f32_16x16x32_bf16 v[16:19], v[168:171], v[144:147], v[16:19]
    ds_read_b64_tr_b16 v[122:123], v186 offset:41472
    v_mfma_f32_16x16x32_bf16 v[20:23], v[172:175], v[144:147], v[20:23]
    ds_read_b64_tr_b16 v[124:125], v187 offset:40960
    v_mfma_f32_16x16x32_bf16 v[24:27], v[144:147], v[176:179], v[24:27]
    ds_read_b64_tr_b16 v[126:127], v187 offset:41472
    v_mfma_f32_16x16x32_bf16 v[28:31], v[144:147], v[180:183], v[28:31]
    ds_read_b64_tr_b16 v[128:129], v186 offset:49152
    v_mfma_f32_16x16x32_bf16 v[32:35], v[160:163], v[148:151], v[32:35]
    ds_read_b64_tr_b16 v[130:131], v186 offset:49664
    v_mfma_f32_16x16x32_bf16 v[36:39], v[164:167], v[148:151], v[36:39]
    ds_read_b64_tr_b16 v[132:133], v187 offset:49152
    v_mfma_f32_16x16x32_bf16 v[40:43], v[168:171], v[148:151], v[40:43]
    ds_read_b64_tr_b16 v[134:135], v187 offset:49664
    v_mfma_f32_16x16x32_bf16 v[44:47], v[172:175], v[148:151], v[44:47]
    ds_read_b64_tr_b16 v[136:137], v186 offset:57344
    v_mfma_f32_16x16x32_bf16 v[48:51], v[148:151], v[176:179], v[48:51]
    ds_read_b64_tr_b16 v[138:139], v186 offset:57856
    v_mfma_f32_16x16x32_bf16 v[52:55], v[148:151], v[180:183], v[52:55]
    ds_read_b64_tr_b16 v[140:141], v187 offset:57344
    v_mfma_f32_16x16x32_bf16 v[56:59], v[160:163], v[152:155], v[56:59]
    ds_read_b64_tr_b16 v[142:143], v187 offset:57856
    v_mfma_f32_16x16x32_bf16 v[60:63], v[164:167], v[152:155], v[60:63]
    ds_read_b128 v[108:111], v184 offset:43008
    v_mfma_f32_16x16x32_bf16 v[64:67], v[168:171], v[152:155], v[64:67]
    ds_read_b128 v[112:115], v184 offset:45056
    v_mfma_f32_16x16x32_bf16 v[68:71], v[172:175], v[152:155], v[68:71]
    ds_read_b128 v[116:119], v184 offset:47104
    v_mfma_f32_16x16x32_bf16 v[72:75], v[152:155], v[176:179], v[72:75]
    v_mfma_f32_16x16x32_bf16 v[76:79], v[152:155], v[180:183], v[76:79]
    v_mfma_f32_16x16x32_bf16 v[80:83], v[160:163], v[156:159], v[80:83]
    v_mfma_f32_16x16x32_bf16 v[84:87], v[164:167], v[156:159], v[84:87]
    v_mfma_f32_16x16x32_bf16 v[88:91], v[168:171], v[156:159], v[88:91]
    v_mfma_f32_16x16x32_bf16 v[92:95], v[172:175], v[156:159], v[92:95]
    v_mfma_f32_16x16x32_bf16 v[96:99], v[156:159], v[176:179], v[96:99]
    v_mfma_f32_16x16x32_bf16 v[100:103], v[156:159], v[180:183], v[100:103]
    s_waitcnt lgkmcnt(0)
    s_nop 0
    v_mfma_f32_16x16x32_bf16 v[8:11], v[120:123], v[104:107], v[8:11]
    ds_read_b128 v[144:147], v185 offset:40960
    v_mfma_f32_16x16x32_bf16 v[12:15], v[124:127], v[104:107], v[12:15]
    ds_read_b64_tr_b16 v[160:161], v186 offset:45056
    v_mfma_f32_16x16x32_bf16 v[16:19], v[128:131], v[104:107], v[16:19]
    ds_read_b64_tr_b16 v[162:163], v186 offset:45568
    v_mfma_f32_16x16x32_bf16 v[20:23], v[132:135], v[104:107], v[20:23]
    ds_read_b64_tr_b16 v[164:165], v187 offset:45056
    v_mfma_f32_16x16x32_bf16 v[24:27], v[104:107], v[136:139], v[24:27]
    ds_read_b64_tr_b16 v[166:167], v187 offset:45568
    v_mfma_f32_16x16x32_bf16 v[28:31], v[104:107], v[140:143], v[28:31]
    ds_read_b64_tr_b16 v[168:169], v186 offset:53248
    v_mfma_f32_16x16x32_bf16 v[32:35], v[120:123], v[108:111], v[32:35]
    ds_read_b64_tr_b16 v[170:171], v186 offset:53760
    v_mfma_f32_16x16x32_bf16 v[36:39], v[124:127], v[108:111], v[36:39]
    ds_read_b64_tr_b16 v[172:173], v187 offset:53248
    v_mfma_f32_16x16x32_bf16 v[40:43], v[128:131], v[108:111], v[40:43]
    ds_read_b64_tr_b16 v[174:175], v187 offset:53760
    v_mfma_f32_16x16x32_bf16 v[44:47], v[132:135], v[108:111], v[44:47]
    ds_read_b64_tr_b16 v[176:177], v186 offset:61440
    v_mfma_f32_16x16x32_bf16 v[48:51], v[108:111], v[136:139], v[48:51]
    ds_read_b64_tr_b16 v[178:179], v186 offset:61952
    v_mfma_f32_16x16x32_bf16 v[52:55], v[108:111], v[140:143], v[52:55]
    ds_read_b64_tr_b16 v[180:181], v187 offset:61440
    v_mfma_f32_16x16x32_bf16 v[56:59], v[120:123], v[112:115], v[56:59]
    ds_read_b64_tr_b16 v[182:183], v187 offset:61952
    v_mfma_f32_16x16x32_bf16 v[60:63], v[124:127], v[112:115], v[60:63]
    ds_read_b128 v[148:151], v185 offset:43008
    v_mfma_f32_16x16x32_bf16 v[64:67], v[128:131], v[112:115], v[64:67]
    ds_read_b128 v[152:155], v185 offset:45056
    v_mfma_f32_16x16x32_bf16 v[68:71], v[132:135], v[112:115], v[68:71]
    ds_read_b128 v[156:159], v185 offset:47104
    v_mfma_f32_16x16x32_bf16 v[72:75], v[112:115], v[136:139], v[72:75]
    v_mfma_f32_16x16x32_bf16 v[76:79], v[112:115], v[140:143], v[76:79]
    v_mfma_f32_16x16x32_bf16 v[80:83], v[120:123], v[116:119], v[80:83]
    v_mfma_f32_16x16x32_bf16 v[84:87], v[124:127], v[116:119], v[84:87]
    v_mfma_f32_16x16x32_bf16 v[88:91], v[128:131], v[116:119], v[88:91]
    v_mfma_f32_16x16x32_bf16 v[92:95], v[132:135], v[116:119], v[92:95]
    v_mfma_f32_16x16x32_bf16 v[96:99], v[116:119], v[136:139], v[96:99]
    v_mfma_f32_16x16x32_bf16 v[100:103], v[116:119], v[140:143], v[100:103]
    s_waitcnt lgkmcnt(0)
    s_barrier
    v_mfma_f32_16x16x32_bf16 v[8:11], v[160:163], v[144:147], v[8:11]
    ds_read_b128 v[104:107], v188 offset:0
    v_mfma_f32_16x16x32_bf16 v[12:15], v[164:167], v[144:147], v[12:15]
    ds_read_b64_tr_b16 v[120:121], v190 offset:0
    v_mfma_f32_16x16x32_bf16 v[16:19], v[168:171], v[144:147], v[16:19]
    ds_read_b64_tr_b16 v[122:123], v190 offset:512
    v_mfma_f32_16x16x32_bf16 v[20:23], v[172:175], v[144:147], v[20:23]
    ds_read_b64_tr_b16 v[124:125], v191 offset:0
    v_mfma_f32_16x16x32_bf16 v[24:27], v[144:147], v[176:179], v[24:27]
    ds_read_b64_tr_b16 v[126:127], v191 offset:512
    v_mfma_f32_16x16x32_bf16 v[28:31], v[144:147], v[180:183], v[28:31]
    ds_read_b64_tr_b16 v[128:129], v190 offset:8192
    v_mfma_f32_16x16x32_bf16 v[32:35], v[160:163], v[148:151], v[32:35]
    ds_read_b64_tr_b16 v[130:131], v190 offset:8704
    v_mfma_f32_16x16x32_bf16 v[36:39], v[164:167], v[148:151], v[36:39]
    ds_read_b64_tr_b16 v[132:133], v191 offset:8192
    v_mfma_f32_16x16x32_bf16 v[40:43], v[168:171], v[148:151], v[40:43]
    ds_read_b64_tr_b16 v[134:135], v191 offset:8704
    v_mfma_f32_16x16x32_bf16 v[44:47], v[172:175], v[148:151], v[44:47]
    ds_read_b64_tr_b16 v[136:137], v190 offset:16384
    v_mfma_f32_16x16x32_bf16 v[48:51], v[148:151], v[176:179], v[48:51]
    ds_read_b64_tr_b16 v[138:139], v190 offset:16896
    v_mfma_f32_16x16x32_bf16 v[52:55], v[148:151], v[180:183], v[52:55]
    ds_read_b64_tr_b16 v[140:141], v191 offset:16384
    v_mfma_f32_16x16x32_bf16 v[56:59], v[160:163], v[152:155], v[56:59]
    ds_read_b64_tr_b16 v[142:143], v191 offset:16896
    v_mfma_f32_16x16x32_bf16 v[60:63], v[164:167], v[152:155], v[60:63]
    ds_read_b128 v[108:111], v188 offset:2048
    v_mfma_f32_16x16x32_bf16 v[64:67], v[168:171], v[152:155], v[64:67]
    ds_read_b128 v[112:115], v188 offset:4096
    v_mfma_f32_16x16x32_bf16 v[68:71], v[172:175], v[152:155], v[68:71]
    ds_read_b128 v[116:119], v188 offset:6144
    v_mfma_f32_16x16x32_bf16 v[72:75], v[152:155], v[176:179], v[72:75]
    v_mfma_f32_16x16x32_bf16 v[76:79], v[152:155], v[180:183], v[76:79]
    v_mfma_f32_16x16x32_bf16 v[80:83], v[160:163], v[156:159], v[80:83]
    v_mfma_f32_16x16x32_bf16 v[84:87], v[164:167], v[156:159], v[84:87]
    v_mfma_f32_16x16x32_bf16 v[88:91], v[168:171], v[156:159], v[88:91]
    v_mfma_f32_16x16x32_bf16 v[92:95], v[172:175], v[156:159], v[92:95]
    v_mfma_f32_16x16x32_bf16 v[96:99], v[156:159], v[176:179], v[96:99]
    v_mfma_f32_16x16x32_bf16 v[100:103], v[156:159], v[180:183], v[100:103]
    s_waitcnt lgkmcnt(0)
    s_nop 0
    v_mfma_f32_16x16x32_bf16 v[8:11], v[120:123], v[104:107], v[8:11]
    ds_read_b128 v[144:147], v189 offset:0
    v_mfma_f32_16x16x32_bf16 v[12:15], v[124:127], v[104:107], v[12:15]
    ds_read_b64_tr_b16 v[160:161], v190 offset:4096
    v_mfma_f32_16x16x32_bf16 v[16:19], v[128:131], v[104:107], v[16:19]
    ds_read_b64_tr_b16 v[162:163], v190 offset:4608
    v_mfma_f32_16x16x32_bf16 v[20:23], v[132:135], v[104:107], v[20:23]
    ds_read_b64_tr_b16 v[164:165], v191 offset:4096
    v_mfma_f32_16x16x32_bf16 v[24:27], v[104:107], v[136:139], v[24:27]
    ds_read_b64_tr_b16 v[166:167], v191 offset:4608
    v_mfma_f32_16x16x32_bf16 v[28:31], v[104:107], v[140:143], v[28:31]
    ds_read_b64_tr_b16 v[168:169], v190 offset:12288
    v_mfma_f32_16x16x32_bf16 v[32:35], v[120:123], v[108:111], v[32:35]
    ds_read_b64_tr_b16 v[170:171], v190 offset:12800
    v_mfma_f32_16x16x32_bf16 v[36:39], v[124:127], v[108:111], v[36:39]
    ds_read_b64_tr_b16 v[172:173], v191 offset:12288
    v_mfma_f32_16x16x32_bf16 v[40:43], v[128:131], v[108:111], v[40:43]
    ds_read_b64_tr_b16 v[174:175], v191 offset:12800
    v_mfma_f32_16x16x32_bf16 v[44:47], v[132:135], v[108:111], v[44:47]
    ds_read_b64_tr_b16 v[176:177], v190 offset:20480
    v_mfma_f32_16x16x32_bf16 v[48:51], v[108:111], v[136:139], v[48:51]
    ds_read_b64_tr_b16 v[178:179], v190 offset:20992
    v_mfma_f32_16x16x32_bf16 v[52:55], v[108:111], v[140:143], v[52:55]
    ds_read_b64_tr_b16 v[180:181], v191 offset:20480
    v_mfma_f32_16x16x32_bf16 v[56:59], v[120:123], v[112:115], v[56:59]
    ds_read_b64_tr_b16 v[182:183], v191 offset:20992
    v_mfma_f32_16x16x32_bf16 v[60:63], v[124:127], v[112:115], v[60:63]
    ds_read_b128 v[148:151], v189 offset:2048
    v_mfma_f32_16x16x32_bf16 v[64:67], v[128:131], v[112:115], v[64:67]
    ds_read_b128 v[152:155], v189 offset:4096
    v_mfma_f32_16x16x32_bf16 v[68:71], v[132:135], v[112:115], v[68:71]
    ds_read_b128 v[156:159], v189 offset:6144
    v_mfma_f32_16x16x32_bf16 v[72:75], v[112:115], v[136:139], v[72:75]
    s_add_u32 s66, s66, 1
    s_cmp_lt_u32 s66, 5
    v_mfma_f32_16x16x32_bf16 v[76:79], v[112:115], v[140:143], v[76:79]
    v_mfma_f32_16x16x32_bf16 v[80:83], v[120:123], v[116:119], v[80:83]
    v_mfma_f32_16x16x32_bf16 v[84:87], v[124:127], v[116:119], v[84:87]
    v_mfma_f32_16x16x32_bf16 v[88:91], v[128:131], v[116:119], v[88:91]
    v_mfma_f32_16x16x32_bf16 v[92:95], v[132:135], v[116:119], v[92:95]
    v_mfma_f32_16x16x32_bf16 v[96:99], v[116:119], v[136:139], v[96:99]
    v_mfma_f32_16x16x32_bf16 v[100:103], v[116:119], v[140:143], v[100:103]
    s_cbranch_scc1 L_cloop
    s_nop 0
    s_waitcnt lgkmcnt(0)
    s_barrier
    v_mfma_f32_16x16x32_bf16 v[8:11], v[160:163], v[144:147], v[8:11]
    ds_read_b128 v[104:107], v184 offset:0
    v_mfma_f32_16x16x32_bf16 v[12:15], v[164:167], v[144:147], v[12:15]
    ds_read_b64_tr_b16 v[120:121], v186 offset:0
    v_mfma_f32_16x16x32_bf16 v[16:19], v[168:171], v[144:147], v[16:19]
    ds_read_b64_tr_b16 v[122:123], v186 offset:512
    v_mfma_f32_16x16x32_bf16 v[20:23], v[172:175], v[144:147], v[20:23]
    ds_read_b64_tr_b16 v[124:125], v187 offset:0
    v_mfma_f32_16x16x32_bf16 v[24:27], v[144:147], v[176:179], v[24:27]
    ds_read_b64_tr_b16 v[126:127], v187 offset:512
    v_mfma_f32_16x16x32_bf16 v[28:31], v[144:147], v[180:183], v[28:31]
    ds_read_b64_tr_b16 v[128:129], v186 offset:8192
    v_mfma_f32_16x16x32_bf16 v[32:35], v[160:163], v[148:151], v[32:35]
    ds_read_b64_tr_b16 v[130:131], v186 offset:8704
    v_mfma_f32_16x16x32_bf16 v[36:39], v[164:167], v[148:151], v[36:39]
    ds_read_b64_tr_b16 v[132:133], v187 offset:8192
    v_mfma_f32_16x16x32_bf16 v[40:43], v[168:171], v[148:151], v[40:43]
    ds_read_b64_tr_b16 v[134:135], v187 offset:8704
    v_mfma_f32_16x16x32_bf16 v[44:47], v[172:175], v[148:151], v[44:47]
    ds_read_b64_tr_b16 v[136:137], v186 offset:16384
    v_mfma_f32_16x16x32_bf16 v[48:51], v[148:151], v[176:179], v[48:51]
    ds_read_b64_tr_b16 v[138:139], v186 offset:16896
    v_mfma_f32_16x16x32_bf16 v[52:55], v[148:151], v[180:183], v[52:55]
    ds_read_b64_tr_b16 v[140:141], v187 offset:16384
    v_mfma_f32_16x16x32_bf16 v[56:59], v[160:163], v[152:155], v[56:59]
    ds_read_b64_tr_b16 v[142:143], v187 offset:16896
    v_mfma_f32_16x16x32_bf16 v[60:63], v[164:167], v[152:155], v[60:63]
    ds_read_b128 v[108:111], v184 offset:2048
    v_mfma_f32_16x16x32_bf16 v[64:67], v[168:171], v[152:155], v[64:67]
    ds_read_b128 v[112:115], v184 offset:4096
    v_mfma_f32_16x16x32_bf16 v[68:71], v[172:175], v[152:155], v[68:71]
    ds_read_b128 v[116:119], v184 offset:6144
    v_mfma_f32_16x16x32_bf16 v[72:75], v[152:155], v[176:179], v[72:75]
    ds_read_b32 v192, v232 offset:0
    v_mfma_f32_16x16x32_bf16 v[76:79], v[152:155], v[180:183], v[76:79]
    ds_read_b32 v194, v232 offset:64
    v_mfma_f32_16x16x32_bf16 v[80:83], v[160:163], v[156:159], v[80:83]
    ds_read_b32 v196, v232 offset:128
    v_mfma_f32_16x16x32_bf16 v[84:87], v[164:167], v[156:159], v[84:87]
    ds_read_b32 v198, v232 offset:192
    v_mfma_f32_16x16x32_bf16 v[88:91], v[168:171], v[156:159], v[88:91]
    ds_read_b128 v[204:207], v235 offset:256
    v_mfma_f32_16x16x32_bf16 v[92:95], v[172:175], v[156:159], v[92:95]
    ds_read_b128 v[208:211], v235 offset:320
    v_mfma_f32_16x16x32_bf16 v[96:99], v[156:159], v[176:179], v[96:99]
    ds_read_b128 v[212:215], v235 offset:0
    v_mfma_f32_16x16x32_bf16 v[100:103], v[156:159], v[180:183], v[100:103]
    ds_read_b128 v[216:219], v235 offset:64
    s_waitcnt lgkmcnt(8)
    s_nop 0
    v_mfma_f32_16x16x32_bf16 v[8:11], v[120:123], v[104:107], v[8:11]
    ds_read_b128 v[144:147], v185 offset:0
    v_mfma_f32_16x16x32_bf16 v[12:15], v[124:127], v[104:107], v[12:15]
    ds_read_b64_tr_b16 v[160:161], v186 offset:4096
    v_mfma_f32_16x16x32_bf16 v[16:19], v[128:131], v[104:107], v[16:19]
    ds_read_b64_tr_b16 v[162:163], v186 offset:4608
    v_mfma_f32_16x16x32_bf16 v[20:23], v[132:135], v[104:107], v[20:23]
    ds_read_b64_tr_b16 v[164:165], v187 offset:4096
    v_mfma_f32_16x16x32_bf16 v[24:27], v[104:107], v[136:139], v[24:27]
    ds_read_b64_tr_b16 v[166:167], v187 offset:4608
    v_mfma_f32_16x16x32_bf16 v[28:31], v[104:107], v[140:143], v[28:31]
    ds_read_b64_tr_b16 v[168:169], v186 offset:12288
    v_mfma_f32_16x16x32_bf16 v[32:35], v[120:123], v[108:111], v[32:35]
    ds_read_b64_tr_b16 v[170:171], v186 offset:12800
    v_mfma_f32_16x16x32_bf16 v[36:39], v[124:127], v[108:111], v[36:39]
    ds_read_b64_tr_b16 v[172:173], v187 offset:12288
    v_mfma_f32_16x16x32_bf16 v[40:43], v[128:131], v[108:111], v[40:43]
    ds_read_b64_tr_b16 v[174:175], v187 offset:12800
    v_mfma_f32_16x16x32_bf16 v[44:47], v[132:135], v[108:111], v[44:47]
    ds_read_b64_tr_b16 v[176:177], v186 offset:20480
    v_mfma_f32_16x16x32_bf16 v[48:51], v[108:111], v[136:139], v[48:51]
    ds_read_b64_tr_b16 v[178:179], v186 offset:20992
    v_mfma_f32_16x16x32_bf16 v[52:55], v[108:111], v[140:143], v[52:55]
    ds_read_b64_tr_b16 v[180:181], v187 offset:20480
    v_mfma_f32_16x16x32_bf16 v[56:59], v[120:123], v[112:115], v[56:59]
    ds_read_b64_tr_b16 v[182:183], v187 offset:20992
    v_mfma_f32_16x16x32_bf16 v[60:63], v[124:127], v[112:115], v[60:63]
    ds_read_b128 v[148:151], v185 offset:2048
    v_mfma_f32_16x16x32_bf16 v[64:67], v[128:131], v[112:115], v[64:67]
    ds_read_b128 v[152:155], v185 offset:4096
    v_mfma_f32_16x16x32_bf16 v[68:71], v[132:135], v[112:115], v[68:71]
    ds_read_b128 v[156:159], v185 offset:6144
    v_mfma_f32_16x16x32_bf16 v[72:75], v[112:115], v[136:139], v[72:75]
    ds_read_b64_tr_b16 v[224:225], v252 offset:0
    v_mfma_f32_16x16x32_bf16 v[76:79], v[112:115], v[140:143], v[76:79]
    ds_read_b64_tr_b16 v[226:227], v252 offset:1024
    v_mfma_f32_16x16x32_bf16 v[80:83], v[120:123], v[116:119], v[80:83]
    ds_read_b64_tr_b16 v[228:229], v252 offset:32
    v_mfma_f32_16x16x32_bf16 v[84:87], v[124:127], v[116:119], v[84:87]
    ds_read_b64_tr_b16 v[230:231], v252 offset:1056
    v_mfma_f32_16x16x32_bf16 v[88:91], v[128:131], v[116:119], v[88:91]
    v_mfma_f32_16x16x32_bf16 v[92:95], v[132:135], v[116:119], v[92:95]
    v_mfma_f32_16x16x32_bf16 v[96:99], v[116:119], v[136:139], v[96:99]
    v_mfma_f32_16x16x32_bf16 v[100:103], v[116:119], v[140:143], v[100:103]
    s_waitcnt lgkmcnt(4)
    v_mfma_f32_16x16x32_bf16 v[16:19], v[168:171], v[144:147], v[16:19]
    s_barrier
    v_mfma_f32_16x16x32_bf16 v[20:23], v[172:175], v[144:147], v[20:23]
    ds_read_b128 v[104:107], v233 offset:0
    ds_read_b128 v[108:111], v233 offset:64
    v_mfma_f32_16x16x32_bf16 v[40:43], v[168:171], v[148:151], v[40:43]
    ds_read_b128 v[112:115], v233 offset:128
    ds_read_b128 v[116:119], v233 offset:192
    v_mfma_f32_16x16x32_bf16 v[44:47], v[172:175], v[148:151], v[44:47]
    ds_read_b32 v250, v248 offset:576
    ds_read_b32 v248, v248 offset:512
    v_mfma_f32_16x16x32_bf16 v[64:67], v[168:171], v[152:155], v[64:67]
    ds_read_b32 v200, v232 offset:2048
    ds_read_b32 v202, v232 offset:2112
    v_mfma_f32_16x16x32_bf16 v[68:71], v[172:175], v[152:155], v[68:71]
    ds_read_b32 v220, v232 offset:2176
    ds_read_b32 v222, v232 offset:2240
    v_mfma_f32_16x16x32_bf16 v[88:91], v[168:171], v[156:159], v[88:91]
    ds_read_b32 v193, v234 offset:2048
    ds_read_b32 v195, v234 offset:1024
    v_mfma_f32_16x16x32_bf16 v[92:95], v[172:175], v[156:159], v[92:95]
    ds_read_b32 v221, v234 offset:2176
    ds_read_b32 v223, v234 offset:1152
    v_mfma_f32_16x16x32_bf16 v[24:27], v[144:147], v[176:179], v[24:27]
    v_fma_f32 v16, -v192, v204, v16
    v_fma_f32 v17, -v192, v205, v17
    v_fma_f32 v18, -v192, v206, v18
    v_mfma_f32_16x16x32_bf16 v[28:31], v[144:147], v[180:183], v[28:31]
    v_fma_f32 v19, -v192, v207, v19
    v_fma_f32 v20, -v192, v208, v20
    v_fma_f32 v21, -v192, v209, v21
    v_mfma_f32_16x16x32_bf16 v[48:51], v[148:151], v[176:179], v[48:51]
    v_fma_f32 v22, -v192, v210, v22
    v_fma_f32 v23, -v192, v211, v23
    v_cvt_pk_bf16_f32 v16, v16, v17
    v_mfma_f32_16x16x32_bf16 v[52:55], v[148:151], v[180:183], v[52:55]
    v_cvt_pk_bf16_f32 v17, v18, v19
    v_cvt_pk_bf16_f32 v18, v20, v21
    v_cvt_pk_bf16_f32 v19, v22, v23
    v_mfma_f32_16x16x32_bf16 v[72:75], v[152:155], v[176:179], v[72:75]
    v_fma_f32 v40, -v194, v204, v40
    v_fma_f32 v41, -v194, v205, v41
    v_fma_f32 v42, -v194, v206, v42
    v_mfma_f32_16x16x32_bf16 v[76:79], v[152:155], v[180:183], v[76:79]
    v_fma_f32 v43, -v194, v207, v43
    v_fma_f32 v44, -v194, v208, v44
    v_fma_f32 v45, -v194, v209, v45
    v_mfma_f32_16x16x32_bf16 v[96:99], v[156:159], v[176:179], v[96:99]
    v_fma_f32 v46, -v194, v210, v46
    v_fma_f32 v47, -v194, v211, v47
    v_cvt_pk_bf16_f32 v40, v40, v41
    v_mfma_f32_16x16x32_bf16 v[100:103], v[156:159], v[180:183], v[100:103]
    v_cvt_pk_bf16_f32 v41, v42, v43
    v_cvt_pk_bf16_f32 v42, v44, v45
    v_cvt_pk_bf16_f32 v43, v46, v47
    v_mfma_f32_16x16x32_bf16 v[8:11], v[160:163], v[144:147], v[8:11]
    v_fma_f32 v64, -v196, v204, v64
    v_fma_f32 v65, -v196, v205, v65
    v_fma_f32 v66, -v196, v206, v66
    v_mfma_f32_16x16x32_bf16 v[12:15], v[164:167], v[144:147], v[12:15]
    v_fma_f32 v67, -v196, v207, v67
    v_fma_f32 v68, -v196, v208, v68
    v_fma_f32 v69, -v196, v209, v69
    v_mfma_f32_16x16x32_bf16 v[32:35], v[160:163], v[148:151], v[32:35]
    v_fma_f32 v70, -v196, v210, v70
    v_fma_f32 v71, -v196, v211, v71
    v_cvt_pk_bf16_f32 v64, v64, v65
    v_mfma_f32_16x16x32_bf16 v[36:39], v[164:167], v[148:151], v[36:39]
    v_cvt_pk_bf16_f32 v65, v66, v67
    v_cvt_pk_bf16_f32 v66, v68, v69
    v_cvt_pk_bf16_f32 v67, v70, v71
    v_mfma_f32_16x16x32_bf16 v[56:59], v[160:163], v[152:155], v[56:59]
    v_fma_f32 v88, -v198, v204, v88
    v_fma_f32 v89, -v198, v205, v89
    v_fma_f32 v90, -v198, v206, v90
    v_mfma_f32_16x16x32_bf16 v[60:63], v[164:167], v[152:155], v[60:63]
    v_fma_f32 v91, -v198, v207, v91
    v_fma_f32 v92, -v198, v208, v92
    v_fma_f32 v93, -v198, v209, v93
    v_mfma_f32_16x16x32_bf16 v[80:83], v[160:163], v[156:159], v[80:83]
    v_fma_f32 v94, -v198, v210, v94
    v_fma_f32 v95, -v198, v211, v95
    v_cvt_pk_bf16_f32 v88, v88, v89
    v_mfma_f32_16x16x32_bf16 v[84:87], v[164:167], v[156:159], v[84:87]
    v_cvt_pk_bf16_f32 v89, v90, v91
    v_cvt_pk_bf16_f32 v90, v92, v93
    v_cvt_pk_bf16_f32 v91, v94, v95
    ds_read_b128 v[120:123], v249 offset:0
    ds_read_b128 v[124:127], v249 offset:64
    s_waitcnt lgkmcnt(2)
    s_nop 0
    v_mfma_f32_16x16x32_bf16 v[144:147], v[224:227], v[16:19], 0
    v_mfma_f32_16x16x32_bf16 v[148:151], v[228:231], v[16:19], 0
    v_mfma_f32_16x16x32_bf16 v[152:155], v[224:227], v[40:43], 0
    v_mfma_f32_16x16x32_bf16 v[156:159], v[228:231], v[40:43], 0
    v_mfma_f32_16x16x32_bf16 v[160:163], v[224:227], v[64:67], 0
    v_mfma_f32_16x16x32_bf16 v[164:167], v[228:231], v[64:67], 0
    v_mfma_f32_16x16x32_bf16 v[168:171], v[224:227], v[88:91], 0
    v_mfma_f32_16x16x32_bf16 v[172:175], v[228:231], v[88:91], 0
    v_pk_fma_f32 v[24:25], v[104:105], v[248:249], v[24:25] op_sel_hi:[1,0,1] neg_lo:[1,0,0] neg_hi:[1,0,0]
    v_pk_fma_f32 v[26:27], v[106:107], v[248:249], v[26:27] op_sel_hi:[1,0,1] neg_lo:[1,0,0] neg_hi:[1,0,0]
    v_pk_fma_f32 v[28:29], v[104:105], v[250:251], v[28:29] op_sel_hi:[1,0,1] neg_lo:[1,0,0] neg_hi:[1,0,0]
    v_pk_fma_f32 v[30:31], v[106:107], v[250:251], v[30:31] op_sel_hi:[1,0,1] neg_lo:[1,0,0] neg_hi:[1,0,0]
    v_pk_fma_f32 v[48:49], v[108:109], v[248:249], v[48:49] op_sel_hi:[1,0,1] neg_lo:[1,0,0] neg_hi:[1,0,0]
    v_pk_fma_f32 v[50:51], v[110:111], v[248:249], v[50:51] op_sel_hi:[1,0,1] neg_lo:[1,0,0] neg_hi:[1,0,0]
    v_pk_fma_f32 v[52:53], v[108:109], v[250:251], v[52:53] op_sel_hi:[1,0,1] neg_lo:[1,0,0] neg_hi:[1,0,0]
    v_pk_fma_f32 v[54:55], v[110:111], v[250:251], v[54:55] op_sel_hi:[1,0,1] neg_lo:[1,0,0] neg_hi:[1,0,0]
    v_pk_fma_f32 v[72:73], v[112:113], v[248:249], v[72:73] op_sel_hi:[1,0,1] neg_lo:[1,0,0] neg_hi:[1,0,0]
    v_pk_fma_f32 v[74:75], v[114:115], v[248:249], v[74:75] op_sel_hi:[1,0,1] neg_lo:[1,0,0] neg_hi:[1,0,0]
    v_pk_fma_f32 v[76:77], v[112:113], v[250:251], v[76:77] op_sel_hi:[1,0,1] neg_lo:[1,0,0] neg_hi:[1,0,0]
    v_pk_fma_f32 v[78:79], v[114:115], v[250:251], v[78:79] op_sel_hi:[1,0,1] neg_lo:[1,0,0] neg_hi:[1,0,0]
    v_pk_fma_f32 v[96:97], v[116:117], v[248:249], v[96:97] op_sel_hi:[1,0,1] neg_lo:[1,0,0] neg_hi:[1,0,0]
    v_pk_fma_f32 v[98:99], v[118:119], v[248:249], v[98:99] op_sel_hi:[1,0,1] neg_lo:[1,0,0] neg_hi:[1,0,0]
    v_pk_fma_f32 v[100:101], v[116:117], v[250:251], v[100:101] op_sel_hi:[1,0,1] neg_lo:[1,0,0] neg_hi:[1,0,0]
    v_pk_fma_f32 v[102:103], v[118:119], v[250:251], v[102:103] op_sel_hi:[1,0,1] neg_lo:[1,0,0] neg_hi:[1,0,0]
    v_cvt_pk_bf16_f32 v24, v24, v25
    v_cvt_pk_bf16_f32 v25, v26, v27
    v_cvt_pk_bf16_f32 v26, v48, v49
    v_cvt_pk_bf16_f32 v27, v50, v51
    v_cvt_pk_bf16_f32 v28, v28, v29
    v_cvt_pk_bf16_f32 v29, v30, v31
    v_cvt_pk_bf16_f32 v30, v52, v53
    v_cvt_pk_bf16_f32 v31, v54, v55
    v_cvt_pk_bf16_f32 v72, v72, v73
    v_cvt_pk_bf16_f32 v73, v74, v75
    v_cvt_pk_bf16_f32 v74, v96, v97
    v_cvt_pk_bf16_f32 v75, v98, v99
    v_cvt_pk_bf16_f32 v76, v76, v77
    v_cvt_pk_bf16_f32 v77, v78, v79
    v_cvt_pk_bf16_f32 v78, v100, v101
    v_cvt_pk_bf16_f32 v79, v102, v103
    ds_read_b128 v[104:107], v253 offset:0
    ds_read_b128 v[108:111], v253 offset:64
    v_max3_f32 v176, v144, v145, v146
    v_max3_f32 v184, -v144, -v145, -v146
    v_max3_f32 v178, v152, v153, v154
    v_max3_f32 v186, -v152, -v153, -v154
    v_max3_f32 v176, v176, v147, v148
    v_max3_f32 v184, v184, -v147, -v148
    v_max3_f32 v178, v178, v155, v156
    v_max3_f32 v186, v186, -v155, -v156
    v_max3_f32 v176, v176, v149, v150
    v_max3_f32 v184, v184, -v149, -v150
    v_max3_f32 v178, v178, v157, v158
    v_max3_f32 v186, v186, -v157, -v158
    v_max_f32_e64 v176, v176, v151
    v_max_f32_e64 v184, v184, -v151
    v_max_f32_e64 v178, v178, v159
    v_max_f32_e64 v186, v186, -v159
    s_nop 0
    v_permlane32_swap_b32 v176, v178
    v_permlane32_swap_b32_e64 v184, v186
    v_max3_f32 v180, v160, v161, v162
    v_max3_f32 v188, -v160, -v161, -v162
    v_max_f32 v176, v176, v178
    v_max_f32 v184, v184, v186
    v_max3_f32 v182, v168, v169, v170
    v_max3_f32 v190, -v168, -v169, -v170
    v_permlane16_swap_b32 v176, v184
    v_max_f32 v176, v176, v184
    v_max3_f32 v180, v180, v163, v164
    v_max3_f32 v188, v188, -v163, -v164
    v_mul_f32 v184, v176, v193
    v_mul_f32 v176, v176, v193
    v_max3_f32 v182, v182, v171, v172
    v_max3_f32 v190, v190, -v171, -v172
    v_permlane16_swap_b32 v176, v184
    v_mov_b32 v178, v176
    v_max3_f32 v180, v180, v165, v166
    v_max3_f32 v188, v188, -v165, -v166
    v_mov_b32_e64 v186, v184
    v_max3_f32 v182, v182, v173, v174
    v_max3_f32 v190, v190, -v173, -v174
    v_permlane32_swap_b32 v176, v178
    v_permlane32_swap_b32 v184, v186
    v_max_f32_e64 v180, v180, v167
    v_max_f32_e64 v188, v188, -v167
    v_max_f32_e64 v182, v182, v175
    v_max_f32_e64 v190, v190, -v175
    s_nop 0
    v_permlane32_swap_b32 v180, v182
    v_permlane32_swap_b32_e64 v188, v190
    v_pk_fma_f32 v[16:17], v[144:145], v[200:201], v[184:185] op_sel_hi:[1,0,0] neg_lo:[1,0,1] neg_hi:[1,0,1]
    v_pk_fma_f32 v[144:145], v[144:145], v[200:201], v[176:177] op_sel_hi:[1,0,0] neg_lo:[0,0,1] neg_hi:[0,0,1]
    v_max_f32 v180, v180, v182
    v_max_f32 v188, v188, v190
    v_pk_fma_f32 v[18:19], v[146:147], v[200:201], v[184:185] op_sel_hi:[1,0,0] neg_lo:[1,0,1] neg_hi:[1,0,1]
    v_pk_fma_f32 v[146:147], v[146:147], v[200:201], v[176:177] op_sel_hi:[1,0,0] neg_lo:[0,0,1] neg_hi:[0,0,1]
    v_permlane16_swap_b32 v180, v188
    v_max_f32 v180, v180, v188
    v_pk_fma_f32 v[20:21], v[148:149], v[200:201], v[184:185] op_sel_hi:[1,0,0] neg_lo:[1,0,1] neg_hi:[1,0,1]
    v_pk_fma_f32 v[148:149], v[148:149], v[200:201], v[176:177] op_sel_hi:[1,0,0] neg_lo:[0,0,1] neg_hi:[0,0,1]
    v_mul_f32 v188, v180, v221
    v_mul_f32 v180, v180, v221
    v_pk_fma_f32 v[22:23], v[150:151], v[200:201], v[184:185] op_sel_hi:[1,0,0] neg_lo:[1,0,1] neg_hi:[1,0,1]
    v_pk_fma_f32 v[150:151], v[150:151], v[200:201], v[176:177] op_sel_hi:[1,0,0] neg_lo:[0,0,1] neg_hi:[0,0,1]
    v_permlane16_swap_b32 v180, v188
    v_mov_b32 v182, v180
    v_pk_fma_f32 v[40:41], v[152:153], v[202:203], v[186:187] op_sel_hi:[1,0,0] neg_lo:[1,0,1] neg_hi:[1,0,1]
    v_pk_fma_f32 v[152:153], v[152:153], v[202:203], v[178:179] op_sel_hi:[1,0,0] neg_lo:[0,0,1] neg_hi:[0,0,1]
    v_mov_b32_e64 v190, v188
    v_pk_fma_f32 v[42:43], v[154:155], v[202:203], v[186:187] op_sel_hi:[1,0,0] neg_lo:[1,0,1] neg_hi:[1,0,1]
    v_pk_fma_f32 v[154:155], v[154:155], v[202:203], v[178:179] op_sel_hi:[1,0,0] neg_lo:[0,0,1] neg_hi:[0,0,1]
    v_permlane32_swap_b32 v180, v182
    v_permlane32_swap_b32 v188, v190
    v_pk_fma_f32 v[44:45], v[156:157], v[202:203], v[186:187] op_sel_hi:[1,0,0] neg_lo:[1,0,1] neg_hi:[1,0,1]
    v_pk_fma_f32 v[156:157], v[156:157], v[202:203], v[178:179] op_sel_hi:[1,0,0] neg_lo:[0,0,1] neg_hi:[0,0,1]
    v_pk_fma_f32 v[46:47], v[158:159], v[202:203], v[186:187] op_sel_hi:[1,0,0] neg_lo:[1,0,1] neg_hi:[1,0,1]
    v_pk_fma_f32 v[158:159], v[158:159], v[202:203], v[178:179] op_sel_hi:[1,0,0] neg_lo:[0,0,1] neg_hi:[0,0,1]
    v_exp_f32 v16, v16
    v_exp_f32 v144, v144
    v_exp_f32 v17, v17
    v_exp_f32 v145, v145
    v_exp_f32 v18, v18
    v_exp_f32 v146, v146
    v_exp_f32 v19, v19
    v_exp_f32 v147, v147
    v_exp_f32 v20, v20
    v_exp_f32 v148, v148
    v_exp_f32 v21, v21
    v_exp_f32 v149, v149
    v_exp_f32 v22, v22
    v_exp_f32 v150, v150
    v_exp_f32 v23, v23
    v_exp_f32 v151, v151
    v_exp_f32 v40, v40
    v_exp_f32 v152, v152
    v_exp_f32 v41, v41
    v_exp_f32 v153, v153
    v_exp_f32 v42, v42
    v_exp_f32 v154, v154
    v_exp_f32 v43, v43
    v_exp_f32 v155, v155
    v_exp_f32 v44, v44
    v_exp_f32 v156, v156
    v_exp_f32 v45, v45
    v_exp_f32 v157, v157
    v_exp_f32 v46, v46
    v_exp_f32 v158, v158
    v_exp_f32 v47, v47
    v_exp_f32 v159, v159
    v_pk_add_f32 v[128:129], v[144:145], v[146:147]
    v_pk_add_f32 v[130:131], v[16:17], v[18:19]
    v_pk_add_f32 v[132:133], v[152:153], v[154:155]
    v_pk_add_f32 v[134:135], v[40:41], v[42:43]
    v_pk_add_f32 v[128:129], v[128:129], v[148:149]
    v_pk_add_f32 v[130:131], v[130:131], v[20:21]
    v_pk_add_f32 v[132:133], v[132:133], v[156:157]
    v_pk_add_f32 v[134:135], v[134:135], v[44:45]
    v_pk_add_f32 v[128:129], v[128:129], v[150:151]
    v_pk_add_f32 v[130:131], v[130:131], v[22:23]
    v_pk_add_f32 v[132:133], v[132:133], v[158:159]
    v_pk_add_f32 v[134:135], v[134:135], v[46:47]
    v_add_f32 v176, v128, v129
    v_add_f32 v184, v130, v131
    v_add_f32 v178, v132, v133
    v_add_f32 v186, v134, v135
    s_nop 0
    v_permlane32_swap_b32 v176, v178
    v_permlane32_swap_b32_e64 v184, v186
    v_pk_fma_f32 v[64:65], v[160:161], v[220:221], v[188:189] op_sel_hi:[1,0,0] neg_lo:[1,0,1] neg_hi:[1,0,1]
    v_pk_fma_f32 v[160:161], v[160:161], v[220:221], v[180:181] op_sel_hi:[1,0,0] neg_lo:[0,0,1] neg_hi:[0,0,1]
    v_add_f32 v176, v176, v178
    v_add_f32 v184, v184, v186
    v_pk_fma_f32 v[66:67], v[162:163], v[220:221], v[188:189] op_sel_hi:[1,0,0] neg_lo:[1,0,1] neg_hi:[1,0,1]
    v_pk_fma_f32 v[162:163], v[162:163], v[220:221], v[180:181] op_sel_hi:[1,0,0] neg_lo:[0,0,1] neg_hi:[0,0,1]
    v_permlane16_swap_b32 v176, v184
    v_add_f32 v176, v176, v184
    v_pk_fma_f32 v[68:69], v[164:165], v[220:221], v[188:189] op_sel_hi:[1,0,0] neg_lo:[1,0,1] neg_hi:[1,0,1]
    v_pk_fma_f32 v[164:165], v[164:165], v[220:221], v[180:181] op_sel_hi:[1,0,0] neg_lo:[0,0,1] neg_hi:[0,0,1]
    v_rcp_f32_e64 v176, v176
    v_pk_fma_f32 v[70:71], v[166:167], v[220:221], v[188:189] op_sel_hi:[1,0,0] neg_lo:[1,0,1] neg_hi:[1,0,1]
    v_pk_fma_f32 v[166:167], v[166:167], v[220:221], v[180:181] op_sel_hi:[1,0,0] neg_lo:[0,0,1] neg_hi:[0,0,1]
    v_mul_f32 v184, v176, v195
    v_mul_f32 v176, v176, v195
    v_pk_fma_f32 v[88:89], v[168:169], v[222:223], v[190:191] op_sel_hi:[1,0,0] neg_lo:[1,0,1] neg_hi:[1,0,1]
    v_pk_fma_f32 v[168:169], v[168:169], v[222:223], v[182:183] op_sel_hi:[1,0,0] neg_lo:[0,0,1] neg_hi:[0,0,1]
    v_permlane16_swap_b32 v176, v184
    v_mov_b32 v178, v176
    v_pk_fma_f32 v[90:91], v[170:171], v[222:223], v[190:191] op_sel_hi:[1,0,0] neg_lo:[1,0,1] neg_hi:[1,0,1]
    v_pk_fma_f32 v[170:171], v[170:171], v[222:223], v[182:183] op_sel_hi:[1,0,0] neg_lo:[0,0,1] neg_hi:[0,0,1]
    v_mov_b32_e64 v186, v184
    v_pk_fma_f32 v[92:93], v[172:173], v[222:223], v[190:191] op_sel_hi:[1,0,0] neg_lo:[1,0,1] neg_hi:[1,0,1]
    v_pk_fma_f32 v[172:173], v[172:173], v[222:223], v[182:183] op_sel_hi:[1,0,0] neg_lo:[0,0,1] neg_hi:[0,0,1]
    v_permlane32_swap_b32 v176, v178
    v_permlane32_swap_b32 v184, v186
    v_pk_fma_f32 v[94:95], v[174:175], v[222:223], v[190:191] op_sel_hi:[1,0,0] neg_lo:[1,0,1] neg_hi:[1,0,1]
    v_pk_fma_f32 v[174:175], v[174:175], v[222:223], v[182:183] op_sel_hi:[1,0,0] neg_lo:[0,0,1] neg_hi:[0,0,1]
    v_pk_mul_f32 v[144:145], v[144:145], v[176:177] op_sel_hi:[1,0]
    v_pk_mul_f32 v[146:147], v[146:147], v[176:177] op_sel_hi:[1,0]
    v_pk_mul_f32 v[148:149], v[148:149], v[176:177] op_sel_hi:[1,0]
    v_pk_mul_f32 v[150:151], v[150:151], v[176:177] op_sel_hi:[1,0]
    v_cvt_pk_bf16_f32 v144, v144, v145
    v_cvt_pk_bf16_f32 v145, v146, v147
    v_cvt_pk_bf16_f32 v146, v148, v149
    v_cvt_pk_bf16_f32 v147, v150, v151
    ds_write_b64 v4, v[144:145] offset:0
    ds_write_b64 v5, v[146:147] offset:0
    ds_write_b128 v197, v[24:27] offset:0
    v_pk_mul_f32 v[16:17], v[16:17], v[184:185] op_sel_hi:[1,0]
    v_pk_mul_f32 v[18:19], v[18:19], v[184:185] op_sel_hi:[1,0]
    v_pk_mul_f32 v[20:21], v[20:21], v[184:185] op_sel_hi:[1,0]
    v_pk_mul_f32 v[22:23], v[22:23], v[184:185] op_sel_hi:[1,0]
    v_cvt_pk_bf16_f32 v16, v16, v17
    v_cvt_pk_bf16_f32 v17, v18, v19
    v_cvt_pk_bf16_f32 v18, v20, v21
    v_cvt_pk_bf16_f32 v19, v22, v23
    ds_write_b64 v6, v[16:17] offset:0
    ds_write_b64 v7, v[18:19] offset:0
    ds_write_b128 v197, v[28:31] offset:1024
    v_pk_mul_f32 v[152:153], v[152:153], v[178:179] op_sel_hi:[1,0]
    v_pk_mul_f32 v[154:155], v[154:155], v[178:179] op_sel_hi:[1,0]
    v_pk_mul_f32 v[156:157], v[156:157], v[178:179] op_sel_hi:[1,0]
    v_pk_mul_f32 v[158:159], v[158:159], v[178:179] op_sel_hi:[1,0]
    v_cvt_pk_bf16_f32 v152, v152, v153
    v_cvt_pk_bf16_f32 v153, v154, v155
    v_cvt_pk_bf16_f32 v154, v156, v157
    v_cvt_pk_bf16_f32 v155, v158, v159
    ds_write_b64 v4, v[152:153] offset:2048
    ds_write_b64 v5, v[154:155] offset:2048
    ds_write_b128 v197, v[72:75] offset:2048
    v_pk_mul_f32 v[40:41], v[40:41], v[186:187] op_sel_hi:[1,0]
    v_pk_mul_f32 v[42:43], v[42:43], v[186:187] op_sel_hi:[1,0]
    v_pk_mul_f32 v[44:45], v[44:45], v[186:187] op_sel_hi:[1,0]
    v_pk_mul_f32 v[46:47], v[46:47], v[186:187] op_sel_hi:[1,0]
    v_cvt_pk_bf16_f32 v40, v40, v41
    v_cvt_pk_bf16_f32 v41, v42, v43
    v_cvt_pk_bf16_f32 v42, v44, v45
    v_cvt_pk_bf16_f32 v43, v46, v47
    ds_write_b64 v6, v[40:41] offset:2048
    ds_write_b64 v7, v[42:43] offset:2048
    ds_write_b128 v197, v[76:79] offset:3072
    ds_read_b64_tr_b16 v[232:233], v201 offset:0
    ds_read_b64_tr_b16 v[234:235], v201 offset:2048
    ds_read_b64_tr_b16 v[236:237], v203 offset:0
    ds_read_b64_tr_b16 v[238:239], v203 offset:2048
    v_exp_f32 v64, v64
    v_exp_f32 v160, v160
    v_exp_f32 v65, v65
    v_exp_f32 v161, v161
    v_exp_f32 v66, v66
    v_exp_f32 v162, v162
    v_exp_f32 v67, v67
    v_exp_f32 v163, v163
    v_exp_f32 v68, v68
    v_exp_f32 v164, v164
    v_exp_f32 v69, v69
    v_exp_f32 v165, v165
    v_exp_f32 v70, v70
    v_exp_f32 v166, v166
    v_exp_f32 v71, v71
    v_exp_f32 v167, v167
    v_exp_f32 v88, v88
    v_exp_f32 v168, v168
    v_exp_f32 v89, v89
    v_exp_f32 v169, v169
    v_exp_f32 v90, v90
    v_exp_f32 v170, v170
    v_exp_f32 v91, v91
    v_exp_f32 v171, v171
    v_exp_f32 v92, v92
    v_exp_f32 v172, v172
    v_exp_f32 v93, v93
    v_exp_f32 v173, v173
    v_exp_f32 v94, v94
    v_exp_f32 v174, v174
    v_exp_f32 v95, v95
    v_exp_f32 v175, v175
    s_mov_b64 exec, 1
    buffer_store_dword v251, v199, s[48:51], s76 offen sc1
    s_mov_b64 exec, -1
    v_pk_add_f32 v[136:137], v[160:161], v[162:163]
    v_pk_add_f32 v[138:139], v[64:65], v[66:67]
    v_pk_add_f32 v[140:141], v[168:169], v[170:171]
    v_pk_add_f32 v[142:143], v[88:89], v[90:91]
    v_pk_add_f32 v[136:137], v[136:137], v[164:165]
    v_pk_add_f32 v[138:139], v[138:139], v[68:69]
    v_pk_add_f32 v[140:141], v[140:141], v[172:173]
    v_pk_add_f32 v[142:143], v[142:143], v[92:93]
    v_pk_add_f32 v[136:137], v[136:137], v[166:167]
    v_pk_add_f32 v[138:139], v[138:139], v[70:71]
    v_pk_add_f32 v[140:141], v[140:141], v[174:175]
    v_pk_add_f32 v[142:143], v[142:143], v[94:95]
    v_add_f32 v180, v136, v137
    v_add_f32 v188, v138, v139
    v_add_f32 v182, v140, v141
    v_add_f32 v190, v142, v143
    s_nop 0
    v_permlane32_swap_b32 v180, v182
    v_permlane32_swap_b32 v188, v190
    s_waitcnt lgkmcnt(0)
    s_nop 0
    v_mfma_f32_16x16x32_bf16 v[144:147], v[232:235], v[24:27], 0
    v_add_f32 v180, v180, v182
    v_add_f32 v188, v188, v190
    v_mfma_f32_16x16x32_bf16 v[148:151], v[236:239], v[24:27], 0
    s_nop 0
    v_permlane16_swap_b32 v180, v188
    v_add_f32 v180, v180, v188
    v_mfma_f32_16x16x32_bf16 v[152:155], v[232:235], v[28:31], 0
    v_rcp_f32_e64 v180, v180
    v_mfma_f32_16x16x32_bf16 v[156:159], v[236:239], v[28:31], 0
    v_mul_f32 v188, v180, v223
    v_mul_f32 v180, v180, v223
    v_mfma_f32_16x16x32_bf16 v[16:19], v[232:235], v[120:123], 0
    s_nop 0
    v_permlane16_swap_b32 v180, v188
    v_mov_b32_e64 v182, v180
    v_mfma_f32_16x16x32_bf16 v[20:23], v[236:239], v[120:123], 0
    v_mov_b32_e64 v190, v188
    v_permlane32_swap_b32 v180, v182
    s_nop 0
    v_permlane32_swap_b32_e64 v188, v190
    v_pk_mul_f32 v[160:161], v[160:161], v[180:181] op_sel_hi:[1,0]
    v_pk_mul_f32 v[162:163], v[162:163], v[180:181] op_sel_hi:[1,0]
    v_pk_mul_f32 v[164:165], v[164:165], v[180:181] op_sel_hi:[1,0]
    v_pk_mul_f32 v[166:167], v[166:167], v[180:181] op_sel_hi:[1,0]
    v_cvt_pk_bf16_f32 v160, v160, v161
    v_cvt_pk_bf16_f32 v161, v162, v163
    v_cvt_pk_bf16_f32 v162, v164, v165
    v_cvt_pk_bf16_f32 v163, v166, v167
    ds_write_b64 v4, v[160:161] offset:4096
    ds_write_b64 v5, v[162:163] offset:4096
    v_pk_mul_f32 v[64:65], v[64:65], v[188:189] op_sel_hi:[1,0]
    v_pk_mul_f32 v[66:67], v[66:67], v[188:189] op_sel_hi:[1,0]
    v_pk_mul_f32 v[68:69], v[68:69], v[188:189] op_sel_hi:[1,0]
    v_pk_mul_f32 v[70:71], v[70:71], v[188:189] op_sel_hi:[1,0]
    v_cvt_pk_bf16_f32 v64, v64, v65
    v_cvt_pk_bf16_f32 v65, v66, v67
    v_cvt_pk_bf16_f32 v66, v68, v69
    v_cvt_pk_bf16_f32 v67, v70, v71
    ds_write_b64 v6, v[64:65] offset:4096
    ds_write_b64 v7, v[66:67] offset:4096
    v_pk_mul_f32 v[168:169], v[168:169], v[182:183] op_sel_hi:[1,0]
    v_pk_mul_f32 v[170:171], v[170:171], v[182:183] op_sel_hi:[1,0]
    v_pk_mul_f32 v[172:173], v[172:173], v[182:183] op_sel_hi:[1,0]
    v_pk_mul_f32 v[174:175], v[174:175], v[182:183] op_sel_hi:[1,0]
    v_cvt_pk_bf16_f32 v168, v168, v169
    v_cvt_pk_bf16_f32 v169, v170, v171
    v_cvt_pk_bf16_f32 v170, v172, v173
    v_cvt_pk_bf16_f32 v171, v174, v175
    ds_write_b64 v4, v[168:169] offset:6144
    ds_write_b64 v5, v[170:171] offset:6144
    v_pk_mul_f32 v[88:89], v[88:89], v[190:191] op_sel_hi:[1,0]
    v_pk_mul_f32 v[90:91], v[90:91], v[190:191] op_sel_hi:[1,0]
    v_pk_mul_f32 v[92:93], v[92:93], v[190:191] op_sel_hi:[1,0]
    v_pk_mul_f32 v[94:95], v[94:95], v[190:191] op_sel_hi:[1,0]
    v_cvt_pk_bf16_f32 v88, v88, v89
    v_cvt_pk_bf16_f32 v89, v90, v91
    v_cvt_pk_bf16_f32 v90, v92, v93
    v_cvt_pk_bf16_f32 v91, v94, v95
    ds_write_b64 v6, v[88:89] offset:6144
    ds_write_b64 v7, v[90:91] offset:6144
    ds_read_b64_tr_b16 v[204:205], v201 offset:4096
    ds_read_b64_tr_b16 v[206:207], v201 offset:6144
    ds_read_b64_tr_b16 v[208:209], v203 offset:4096
    ds_read_b64_tr_b16 v[210:211], v203 offset:6144
    v_xor_b32 v201, 0x2000, v201
    v_xor_b32 v203, 0x2000, v203
    v_xor_b32 v197, 0x1000, v197
    s_waitcnt lgkmcnt(4)
    s_barrier
    ds_read_b64_tr_b16 v[128:129], v201 offset:0
    ds_read_b64_tr_b16 v[130:131], v201 offset:2048
    ds_read_b64_tr_b16 v[132:133], v203 offset:0
    ds_read_b64_tr_b16 v[134:135], v203 offset:2048
    ds_read_b128 v[48:51], v197 offset:0
    ds_read_b128 v[52:55], v197 offset:1024
    ds_read_b64_tr_b16 v[136:137], v201 offset:4096
    ds_read_b64_tr_b16 v[138:139], v201 offset:6144
    ds_read_b64_tr_b16 v[140:141], v203 offset:4096
    ds_read_b64_tr_b16 v[142:143], v203 offset:6144
    ds_read_b128 v[96:99], v197 offset:2048
    ds_read_b128 v[100:103], v197 offset:3072
    s_waitcnt lgkmcnt(12)
    s_nop 0
    v_mfma_f32_16x16x32_bf16 v[144:147], v[204:207], v[72:75], v[144:147]
    v_mfma_f32_16x16x32_bf16 v[148:151], v[208:211], v[72:75], v[148:151]
    v_mfma_f32_16x16x32_bf16 v[152:155], v[204:207], v[76:79], v[152:155]
    v_mfma_f32_16x16x32_bf16 v[156:159], v[208:211], v[76:79], v[156:159]
    v_mfma_f32_16x16x32_bf16 v[16:19], v[204:207], v[124:127], v[16:19]
    v_mfma_f32_16x16x32_bf16 v[20:23], v[208:211], v[124:127], v[20:23]
    s_waitcnt lgkmcnt(6)
    s_nop 0
    v_mfma_f32_16x16x32_bf16 v[144:147], v[128:131], v[48:51], v[144:147]
    v_mfma_f32_16x16x32_bf16 v[148:151], v[132:135], v[48:51], v[148:151]
    v_mfma_f32_16x16x32_bf16 v[152:155], v[128:131], v[52:55], v[152:155]
    v_mfma_f32_16x16x32_bf16 v[156:159], v[132:135], v[52:55], v[156:159]
    v_mfma_f32_16x16x32_bf16 v[16:19], v[128:131], v[104:107], v[16:19]
    v_mfma_f32_16x16x32_bf16 v[20:23], v[132:135], v[104:107], v[20:23]
    s_waitcnt lgkmcnt(0)
    s_nop 0
    v_mfma_f32_16x16x32_bf16 v[144:147], v[136:139], v[96:99], v[144:147]
    v_mfma_f32_16x16x32_bf16 v[148:151], v[140:143], v[96:99], v[148:151]
    v_mfma_f32_16x16x32_bf16 v[152:155], v[136:139], v[100:103], v[152:155]
    v_mfma_f32_16x16x32_bf16 v[156:159], v[140:143], v[100:103], v[156:159]
    v_mfma_f32_16x16x32_bf16 v[16:19], v[136:139], v[108:111], v[16:19]
    v_mfma_f32_16x16x32_bf16 v[20:23], v[140:143], v[108:111], v[20:23]
    ds_read_b64_tr_b16 v[224:225], v252 offset:8192
    ds_read_b64_tr_b16 v[226:227], v252 offset:9216
    ds_read_b64_tr_b16 v[228:229], v252 offset:8224
    ds_read_b64_tr_b16 v[230:231], v252 offset:9248
    s_xor_b32 s67, s67, 8
    s_lshl_b32 s3, s38, 2
    s_add_u32 s3, s3, 162112
    v_mov_b32 v4, s3
    v_mov_b32 v5, 1
    v_cvt_pk_bf16_f32 v144, v144, v145
    v_cvt_pk_bf16_f32 v145, v146, v147
    v_cvt_pk_bf16_f32 v146, v148, v149
    v_cvt_pk_bf16_f32 v147, v150, v151
    buffer_store_dwordx4 v[144:147], v199, s[48:51], s74 offen offset:0 sc1
    v_cvt_pk_bf16_f32 v152, v152, v153
    v_cvt_pk_bf16_f32 v153, v154, v155
    v_cvt_pk_bf16_f32 v154, v156, v157
    v_cvt_pk_bf16_f32 v155, v158, v159
    buffer_store_dwordx4 v[152:155], v199, s[48:51], s74 offen offset:1024 sc1
    v_cvt_pk_bf16_f32 v16, v16, v17
    v_cvt_pk_bf16_f32 v17, v18, v19
    v_cvt_pk_bf16_f32 v18, v20, v21
    v_cvt_pk_bf16_f32 v19, v22, v23
    s_mov_b32 exec_lo, 0x00010001
    s_mov_b32 exec_hi, 0x00010001
    buffer_store_dwordx4 v[16:19], v1, s[48:51], s75 offen sc1
    s_mov_b64 exec, -1
    ds_write_b32 v4, v5
    s_setprio 0
    v_pk_fma_f32 v[8:9], v[192:193], v[212:213], v[8:9] op_sel_hi:[0,1,1] neg_lo:[1,0,0] neg_hi:[1,0,0]
    v_pk_fma_f32 v[10:11], v[192:193], v[214:215], v[10:11] op_sel_hi:[0,1,1] neg_lo:[1,0,0] neg_hi:[1,0,0]
    v_pk_fma_f32 v[12:13], v[192:193], v[216:217], v[12:13] op_sel_hi:[0,1,1] neg_lo:[1,0,0] neg_hi:[1,0,0]
    v_pk_fma_f32 v[14:15], v[192:193], v[218:219], v[14:15] op_sel_hi:[0,1,1] neg_lo:[1,0,0] neg_hi:[1,0,0]
    v_cvt_pk_bf16_f32 v8, v8, v9
    v_cvt_pk_bf16_f32 v9, v10, v11
    v_cvt_pk_bf16_f32 v10, v12, v13
    v_cvt_pk_bf16_f32 v11, v14, v15
    v_pk_fma_f32 v[32:33], v[194:195], v[212:213], v[32:33] op_sel_hi:[0,1,1] neg_lo:[1,0,0] neg_hi:[1,0,0]
    v_pk_fma_f32 v[34:35], v[194:195], v[214:215], v[34:35] op_sel_hi:[0,1,1] neg_lo:[1,0,0] neg_hi:[1,0,0]
    v_pk_fma_f32 v[36:37], v[194:195], v[216:217], v[36:37] op_sel_hi:[0,1,1] neg_lo:[1,0,0] neg_hi:[1,0,0]
    v_pk_fma_f32 v[38:39], v[194:195], v[218:219], v[38:39] op_sel_hi:[0,1,1] neg_lo:[1,0,0] neg_hi:[1,0,0]
    v_cvt_pk_bf16_f32 v32, v32, v33
    v_cvt_pk_bf16_f32 v33, v34, v35
    v_cvt_pk_bf16_f32 v34, v36, v37
    v_cvt_pk_bf16_f32 v35, v38, v39
    v_pk_fma_f32 v[56:57], v[196:197], v[212:213], v[56:57] op_sel_hi:[0,1,1] neg_lo:[1,0,0] neg_hi:[1,0,0]
    v_pk_fma_f32 v[58:59], v[196:197], v[214:215], v[58:59] op_sel_hi:[0,1,1] neg_lo:[1,0,0] neg_hi:[1,0,0]
    v_pk_fma_f32 v[60:61], v[196:197], v[216:217], v[60:61] op_sel_hi:[0,1,1] neg_lo:[1,0,0] neg_hi:[1,0,0]
    v_pk_fma_f32 v[62:63], v[196:197], v[218:219], v[62:63] op_sel_hi:[0,1,1] neg_lo:[1,0,0] neg_hi:[1,0,0]
    v_cvt_pk_bf16_f32 v56, v56, v57
    v_cvt_pk_bf16_f32 v57, v58, v59
    v_cvt_pk_bf16_f32 v58, v60, v61
    v_cvt_pk_bf16_f32 v59, v62, v63
    v_pk_fma_f32 v[80:81], v[198:199], v[212:213], v[80:81] op_sel_hi:[0,1,1] neg_lo:[1,0,0] neg_hi:[1,0,0]
    v_pk_fma_f32 v[82:83], v[198:199], v[214:215], v[82:83] op_sel_hi:[0,1,1] neg_lo:[1,0,0] neg_hi:[1,0,0]
    v_pk_fma_f32 v[84:85], v[198:199], v[216:217], v[84:85] op_sel_hi:[0,1,1] neg_lo:[1,0,0] neg_hi:[1,0,0]
    v_pk_fma_f32 v[86:87], v[198:199], v[218:219], v[86:87] op_sel_hi:[0,1,1] neg_lo:[1,0,0] neg_hi:[1,0,0]
    v_cvt_pk_bf16_f32 v80, v80, v81
    v_cvt_pk_bf16_f32 v81, v82, v83
    v_cvt_pk_bf16_f32 v82, v84, v85
    v_cvt_pk_bf16_f32 v83, v86, v87
    s_waitcnt lgkmcnt(1)
    s_nop 0
    v_mfma_f32_16x16x32_bf16 v[144:147], v[224:227], v[8:11], 0
    v_mfma_f32_16x16x32_bf16 v[148:151], v[228:231], v[8:11], 0
    v_mfma_f32_16x16x32_bf16 v[152:155], v[224:227], v[32:35], 0
    v_mfma_f32_16x16x32_bf16 v[156:159], v[228:231], v[32:35], 0
    v_mfma_f32_16x16x32_bf16 v[160:163], v[224:227], v[56:59], 0
    v_mfma_f32_16x16x32_bf16 v[164:167], v[228:231], v[56:59], 0
    v_mfma_f32_16x16x32_bf16 v[168:171], v[224:227], v[80:83], 0
    v_mfma_f32_16x16x32_bf16 v[172:175], v[228:231], v[80:83], 0
    s_nop 0
    s_nop 0
    v_max3_f32 v176, v144, v145, v146
    v_max3_f32 v184, -v144, -v145, -v146
    v_max3_f32 v178, v152, v153, v154
    v_max3_f32 v186, -v152, -v153, -v154
    v_max3_f32 v176, v176, v147, v148
    v_max3_f32 v184, v184, -v147, -v148
    v_max3_f32 v178, v178, v155, v156
    v_max3_f32 v186, v186, -v155, -v156
    v_max3_f32 v176, v176, v149, v150
    v_max3_f32 v184, v184, -v149, -v150
    v_max3_f32 v178, v178, v157, v158
    v_max3_f32 v186, v186, -v157, -v158
    v_max_f32_e64 v176, v176, v151
    v_max_f32_e64 v184, v184, -v151
    v_max_f32_e64 v178, v178, v159
    v_max_f32_e64 v186, v186, -v159
    s_nop 0
    v_permlane32_swap_b32 v176, v178
    v_permlane32_swap_b32_e64 v184, v186
    v_max3_f32 v180, v160, v161, v162
    v_max3_f32 v188, -v160, -v161, -v162
    v_max_f32 v176, v176, v178
    v_max_f32 v184, v184, v186
    v_max3_f32 v182, v168, v169, v170
    v_max3_f32 v190, -v168, -v169, -v170
    v_permlane16_swap_b32 v176, v184
    v_max_f32 v176, v176, v184
    v_max3_f32 v180, v180, v163, v164
    v_max3_f32 v188, v188, -v163, -v164
    v_mul_f32 v184, v176, v193
    v_mul_f32 v176, v176, v193
    v_max3_f32 v182, v182, v171, v172
    v_max3_f32 v190, v190, -v171, -v172
    v_permlane16_swap_b32 v176, v184
    v_mov_b32 v178, v176
    v_max3_f32 v180, v180, v165, v166
    v_max3_f32 v188, v188, -v165, -v166
    v_mov_b32_e64 v186, v184
    v_max3_f32 v182, v182, v173, v174
    v_max3_f32 v190, v190, -v173, -v174
    v_permlane32_swap_b32 v176, v178
    v_permlane32_swap_b32 v184, v186
    v_max_f32_e64 v180, v180, v167
    v_max_f32_e64 v188, v188, -v167
    v_max_f32_e64 v182, v182, v175
    v_max_f32_e64 v190, v190, -v175
    s_nop 0
    v_permlane32_swap_b32 v180, v182
    v_permlane32_swap_b32_e64 v188, v190
    v_pk_fma_f32 v[8:9], v[144:145], v[200:201], v[184:185] op_sel_hi:[1,0,0] neg_lo:[1,0,1] neg_hi:[1,0,1]
    v_pk_fma_f32 v[144:145], v[144:145], v[200:201], v[176:177] op_sel_hi:[1,0,0] neg_lo:[0,0,1] neg_hi:[0,0,1]
    v_max_f32 v180, v180, v182
    v_max_f32 v188, v188, v190
    v_pk_fma_f32 v[10:11], v[146:147], v[200:201], v[184:185] op_sel_hi:[1,0,0] neg_lo:[1,0,1] neg_hi:[1,0,1]
    v_pk_fma_f32 v[146:147], v[146:147], v[200:201], v[176:177] op_sel_hi:[1,0,0] neg_lo:[0,0,1] neg_hi:[0,0,1]
    v_permlane16_swap_b32 v180, v188
    v_max_f32 v180, v180, v188
    v_pk_fma_f32 v[12:13], v[148:149], v[200:201], v[184:185] op_sel_hi:[1,0,0] neg_lo:[1,0,1] neg_hi:[1,0,1]
    v_pk_fma_f32 v[148:149], v[148:149], v[200:201], v[176:177] op_sel_hi:[1,0,0] neg_lo:[0,0,1] neg_hi:[0,0,1]
    v_mul_f32 v188, v180, v221
    v_mul_f32 v180, v180, v221
    v_pk_fma_f32 v[14:15], v[150:151], v[200:201], v[184:185] op_sel_hi:[1,0,0] neg_lo:[1,0,1] neg_hi:[1,0,1]
    v_pk_fma_f32 v[150:151], v[150:151], v[200:201], v[176:177] op_sel_hi:[1,0,0] neg_lo:[0,0,1] neg_hi:[0,0,1]
    v_permlane16_swap_b32 v180, v188
    v_mov_b32 v182, v180
    v_pk_fma_f32 v[32:33], v[152:153], v[202:203], v[186:187] op_sel_hi:[1,0,0] neg_lo:[1,0,1] neg_hi:[1,0,1]
    v_pk_fma_f32 v[152:153], v[152:153], v[202:203], v[178:179] op_sel_hi:[1,0,0] neg_lo:[0,0,1] neg_hi:[0,0,1]
    v_mov_b32_e64 v190, v188
    v_pk_fma_f32 v[34:35], v[154:155], v[202:203], v[186:187] op_sel_hi:[1,0,0] neg_lo:[1,0,1] neg_hi:[1,0,1]
    v_pk_fma_f32 v[154:155], v[154:155], v[202:203], v[178:179] op_sel_hi:[1,0,0] neg_lo:[0,0,1] neg_hi:[0,0,1]
    v_permlane32_swap_b32 v180, v182
    v_permlane32_swap_b32 v188, v190
    v_pk_fma_f32 v[36:37], v[156:157], v[202:203], v[186:187] op_sel_hi:[1,0,0] neg_lo:[1,0,1] neg_hi:[1,0,1]
    v_pk_fma_f32 v[156:157], v[156:157], v[202:203], v[178:179] op_sel_hi:[1,0,0] neg_lo:[0,0,1] neg_hi:[0,0,1]
    v_pk_fma_f32 v[38:39], v[158:159], v[202:203], v[186:187] op_sel_hi:[1,0,0] neg_lo:[1,0,1] neg_hi:[1,0,1]
    v_pk_fma_f32 v[158:159], v[158:159], v[202:203], v[178:179] op_sel_hi:[1,0,0] neg_lo:[0,0,1] neg_hi:[0,0,1]
    v_exp_f32 v8, v8
    v_exp_f32 v144, v144
    v_exp_f32 v9, v9
    v_exp_f32 v145, v145
    v_exp_f32 v10, v10
    v_exp_f32 v146, v146
    v_exp_f32 v11, v11
    v_exp_f32 v147, v147
    v_exp_f32 v12, v12
    v_exp_f32 v148, v148
    v_exp_f32 v13, v13
    v_exp_f32 v149, v149
    v_exp_f32 v14, v14
    v_exp_f32 v150, v150
    v_exp_f32 v15, v15
    v_exp_f32 v151, v151
    v_exp_f32 v32, v32
    v_exp_f32 v152, v152
    v_exp_f32 v33, v33
    v_exp_f32 v153, v153
    v_exp_f32 v34, v34
    v_exp_f32 v154, v154
    v_exp_f32 v35, v35
    v_exp_f32 v155, v155
    v_exp_f32 v36, v36
    v_exp_f32 v156, v156
    v_exp_f32 v37, v37
    v_exp_f32 v157, v157
    v_exp_f32 v38, v38
    v_exp_f32 v158, v158
    v_exp_f32 v39, v39
    v_exp_f32 v159, v159
    v_pk_add_f32 v[128:129], v[144:145], v[146:147]
    v_pk_add_f32 v[130:131], v[8:9], v[10:11]
    v_pk_add_f32 v[132:133], v[152:153], v[154:155]
    v_pk_add_f32 v[134:135], v[32:33], v[34:35]
    v_pk_add_f32 v[128:129], v[128:129], v[148:149]
    v_pk_add_f32 v[130:131], v[130:131], v[12:13]
    v_pk_add_f32 v[132:133], v[132:133], v[156:157]
    v_pk_add_f32 v[134:135], v[134:135], v[36:37]
    v_pk_add_f32 v[128:129], v[128:129], v[150:151]
    v_pk_add_f32 v[130:131], v[130:131], v[14:15]
    v_pk_add_f32 v[132:133], v[132:133], v[158:159]
    v_pk_add_f32 v[134:135], v[134:135], v[38:39]
    v_add_f32 v176, v128, v129
    v_add_f32 v184, v130, v131
    v_add_f32 v178, v132, v133
    v_add_f32 v186, v134, v135
    s_nop 0
    v_permlane32_swap_b32 v176, v178
    v_permlane32_swap_b32_e64 v184, v186
    v_pk_fma_f32 v[56:57], v[160:161], v[220:221], v[188:189] op_sel_hi:[1,0,0] neg_lo:[1,0,1] neg_hi:[1,0,1]
    v_pk_fma_f32 v[160:161], v[160:161], v[220:221], v[180:181] op_sel_hi:[1,0,0] neg_lo:[0,0,1] neg_hi:[0,0,1]
    v_add_f32 v176, v176, v178
    v_add_f32 v184, v184, v186
    v_pk_fma_f32 v[58:59], v[162:163], v[220:221], v[188:189] op_sel_hi:[1,0,0] neg_lo:[1,0,1] neg_hi:[1,0,1]
    v_pk_fma_f32 v[162:163], v[162:163], v[220:221], v[180:181] op_sel_hi:[1,0,0] neg_lo:[0,0,1] neg_hi:[0,0,1]
    v_permlane16_swap_b32 v176, v184
    v_add_f32 v176, v176, v184
    v_pk_fma_f32 v[60:61], v[164:165], v[220:221], v[188:189] op_sel_hi:[1,0,0] neg_lo:[1,0,1] neg_hi:[1,0,1]
    v_pk_fma_f32 v[164:165], v[164:165], v[220:221], v[180:181] op_sel_hi:[1,0,0] neg_lo:[0,0,1] neg_hi:[0,0,1]
    v_rcp_f32_e64 v176, v176
    v_pk_fma_f32 v[62:63], v[166:167], v[220:221], v[188:189] op_sel_hi:[1,0,0] neg_lo:[1,0,1] neg_hi:[1,0,1]
    v_pk_fma_f32 v[166:167], v[166:167], v[220:221], v[180:181] op_sel_hi:[1,0,0] neg_lo:[0,0,1] neg_hi:[0,0,1]
    v_mov_b32_e64 v184, v176
    v_pk_fma_f32 v[80:81], v[168:169], v[222:223], v[190:191] op_sel_hi:[1,0,0] neg_lo:[1,0,1] neg_hi:[1,0,1]
    v_pk_fma_f32 v[168:169], v[168:169], v[222:223], v[182:183] op_sel_hi:[1,0,0] neg_lo:[0,0,1] neg_hi:[0,0,1]
    v_permlane16_swap_b32 v176, v184
    v_mov_b32 v178, v176
    v_pk_fma_f32 v[82:83], v[170:171], v[222:223], v[190:191] op_sel_hi:[1,0,0] neg_lo:[1,0,1] neg_hi:[1,0,1]
    v_pk_fma_f32 v[170:171], v[170:171], v[222:223], v[182:183] op_sel_hi:[1,0,0] neg_lo:[0,0,1] neg_hi:[0,0,1]
    v_mov_b32_e64 v186, v184
    v_pk_fma_f32 v[84:85], v[172:173], v[222:223], v[190:191] op_sel_hi:[1,0,0] neg_lo:[1,0,1] neg_hi:[1,0,1]
    v_pk_fma_f32 v[172:173], v[172:173], v[222:223], v[182:183] op_sel_hi:[1,0,0] neg_lo:[0,0,1] neg_hi:[0,0,1]
    v_permlane32_swap_b32 v176, v178
    v_permlane32_swap_b32 v184, v186
    v_pk_fma_f32 v[86:87], v[174:175], v[222:223], v[190:191] op_sel_hi:[1,0,0] neg_lo:[1,0,1] neg_hi:[1,0,1]
    v_pk_fma_f32 v[174:175], v[174:175], v[222:223], v[182:183] op_sel_hi:[1,0,0] neg_lo:[0,0,1] neg_hi:[0,0,1]
    v_pk_mul_f32 v[144:145], v[144:145], v[176:177] op_sel_hi:[1,0]
    v_pk_mul_f32 v[146:147], v[146:147], v[176:177] op_sel_hi:[1,0]
    v_pk_mul_f32 v[148:149], v[148:149], v[176:177] op_sel_hi:[1,0]
    v_pk_mul_f32 v[150:151], v[150:151], v[176:177] op_sel_hi:[1,0]
    v_cvt_pk_bf16_f32 v144, v144, v145
    v_cvt_pk_bf16_f32 v145, v146, v147
    v_cvt_pk_bf16_f32 v146, v148, v149
    v_cvt_pk_bf16_f32 v147, v150, v151
    v_pk_mul_f32 v[8:9], v[8:9], v[184:185] op_sel_hi:[1,0]
    v_pk_mul_f32 v[10:11], v[10:11], v[184:185] op_sel_hi:[1,0]
    v_pk_mul_f32 v[12:13], v[12:13], v[184:185] op_sel_hi:[1,0]
    v_pk_mul_f32 v[14:15], v[14:15], v[184:185] op_sel_hi:[1,0]
    v_cvt_pk_bf16_f32 v8, v8, v9
    v_cvt_pk_bf16_f32 v9, v10, v11
    v_cvt_pk_bf16_f32 v10, v12, v13
    v_cvt_pk_bf16_f32 v11, v14, v15
    v_pk_mul_f32 v[152:153], v[152:153], v[178:179] op_sel_hi:[1,0]
    v_pk_mul_f32 v[154:155], v[154:155], v[178:179] op_sel_hi:[1,0]
    v_pk_mul_f32 v[156:157], v[156:157], v[178:179] op_sel_hi:[1,0]
    v_pk_mul_f32 v[158:159], v[158:159], v[178:179] op_sel_hi:[1,0]
    v_cvt_pk_bf16_f32 v152, v152, v153
    v_cvt_pk_bf16_f32 v153, v154, v155
    v_cvt_pk_bf16_f32 v154, v156, v157
    v_cvt_pk_bf16_f32 v155, v158, v159
    v_pk_mul_f32 v[32:33], v[32:33], v[186:187] op_sel_hi:[1,0]
    v_pk_mul_f32 v[34:35], v[34:35], v[186:187] op_sel_hi:[1,0]
    v_pk_mul_f32 v[36:37], v[36:37], v[186:187] op_sel_hi:[1,0]
    v_pk_mul_f32 v[38:39], v[38:39], v[186:187] op_sel_hi:[1,0]
    v_cvt_pk_bf16_f32 v32, v32, v33
    v_cvt_pk_bf16_f32 v33, v34, v35
    v_cvt_pk_bf16_f32 v34, v36, v37
    v_cvt_pk_bf16_f32 v35, v38, v39
    v_exp_f32 v56, v56
    v_exp_f32 v160, v160
    v_exp_f32 v57, v57
    v_exp_f32 v161, v161
    v_exp_f32 v58, v58
    v_exp_f32 v162, v162
    v_exp_f32 v59, v59
    v_exp_f32 v163, v163
    v_exp_f32 v60, v60
    v_exp_f32 v164, v164
    v_exp_f32 v61, v61
    v_exp_f32 v165, v165
    v_exp_f32 v62, v62
    v_exp_f32 v166, v166
    v_exp_f32 v63, v63
    v_exp_f32 v167, v167
    v_exp_f32 v80, v80
    v_exp_f32 v168, v168
    v_exp_f32 v81, v81
    v_exp_f32 v169, v169
    v_exp_f32 v82, v82
    v_exp_f32 v170, v170
    v_exp_f32 v83, v83
    v_exp_f32 v171, v171
    v_exp_f32 v84, v84
    v_exp_f32 v172, v172
    v_exp_f32 v85, v85
    v_exp_f32 v173, v173
    v_exp_f32 v86, v86
    v_exp_f32 v174, v174
    v_exp_f32 v87, v87
    v_exp_f32 v175, v175
    v_pk_add_f32 v[136:137], v[160:161], v[162:163]
    v_pk_add_f32 v[138:139], v[56:57], v[58:59]
    v_pk_add_f32 v[140:141], v[168:169], v[170:171]
    v_pk_add_f32 v[142:143], v[80:81], v[82:83]
    v_pk_add_f32 v[136:137], v[136:137], v[164:165]
    v_pk_add_f32 v[138:139], v[138:139], v[60:61]
    v_pk_add_f32 v[140:141], v[140:141], v[172:173]
    v_pk_add_f32 v[142:143], v[142:143], v[84:85]
    v_pk_add_f32 v[136:137], v[136:137], v[166:167]
    v_pk_add_f32 v[138:139], v[138:139], v[62:63]
    v_pk_add_f32 v[140:141], v[140:141], v[174:175]
    v_pk_add_f32 v[142:143], v[142:143], v[86:87]
    v_add_f32 v180, v136, v137
    v_add_f32 v188, v138, v139
    v_add_f32 v182, v140, v141
    v_add_f32 v190, v142, v143
    s_nop 0
    v_permlane32_swap_b32 v180, v182
    v_permlane32_swap_b32 v188, v190
    v_add_f32 v180, v180, v182
    v_add_f32 v188, v188, v190
    s_nop 1
    v_permlane16_swap_b32 v180, v188
    v_add_f32 v180, v180, v188
    v_rcp_f32_e64 v180, v180
    s_nop 0
    v_mov_b32_e64 v188, v180
    s_nop 1
    v_permlane16_swap_b32 v180, v188
    v_mov_b32 v182, v180
    v_mov_b32_e64 v190, v188
    s_nop 0
    v_permlane32_swap_b32 v180, v182
    v_permlane32_swap_b32_e64 v188, v190
    v_pk_mul_f32 v[160:161], v[160:161], v[180:181] op_sel_hi:[1,0]
    v_pk_mul_f32 v[162:163], v[162:163], v[180:181] op_sel_hi:[1,0]
    v_pk_mul_f32 v[164:165], v[164:165], v[180:181] op_sel_hi:[1,0]
    v_pk_mul_f32 v[166:167], v[166:167], v[180:181] op_sel_hi:[1,0]
    v_cvt_pk_bf16_f32 v160, v160, v161
    v_cvt_pk_bf16_f32 v161, v162, v163
    v_cvt_pk_bf16_f32 v162, v164, v165
    v_cvt_pk_bf16_f32 v163, v166, v167
    v_pk_mul_f32 v[56:57], v[56:57], v[188:189] op_sel_hi:[1,0]
    v_pk_mul_f32 v[58:59], v[58:59], v[188:189] op_sel_hi:[1,0]
    v_pk_mul_f32 v[60:61], v[60:61], v[188:189] op_sel_hi:[1,0]
    v_pk_mul_f32 v[62:63], v[62:63], v[188:189] op_sel_hi:[1,0]
    v_cvt_pk_bf16_f32 v56, v56, v57
    v_cvt_pk_bf16_f32 v57, v58, v59
    v_cvt_pk_bf16_f32 v58, v60, v61
    v_cvt_pk_bf16_f32 v59, v62, v63
    v_pk_mul_f32 v[168:169], v[168:169], v[182:183] op_sel_hi:[1,0]
    v_pk_mul_f32 v[170:171], v[170:171], v[182:183] op_sel_hi:[1,0]
    v_pk_mul_f32 v[172:173], v[172:173], v[182:183] op_sel_hi:[1,0]
    v_pk_mul_f32 v[174:175], v[174:175], v[182:183] op_sel_hi:[1,0]
    v_cvt_pk_bf16_f32 v168, v168, v169
    v_cvt_pk_bf16_f32 v169, v170, v171
    v_cvt_pk_bf16_f32 v170, v172, v173
    v_cvt_pk_bf16_f32 v171, v174, v175
    v_pk_mul_f32 v[80:81], v[80:81], v[190:191] op_sel_hi:[1,0]
    v_pk_mul_f32 v[82:83], v[82:83], v[190:191] op_sel_hi:[1,0]
    v_pk_mul_f32 v[84:85], v[84:85], v[190:191] op_sel_hi:[1,0]
    v_pk_mul_f32 v[86:87], v[86:87], v[190:191] op_sel_hi:[1,0]
    v_cvt_pk_bf16_f32 v80, v80, v81
    v_cvt_pk_bf16_f32 v81, v82, v83
    v_cvt_pk_bf16_f32 v82, v84, v85
    v_cvt_pk_bf16_f32 v83, v86, v87
    v_mov_b32 v2, 162048
    ds_read_b32 v248, v2
    v_lshrrev_b32 v5, 3, v1
    v_lshlrev_b32 v6, 11, v5
    v_bfe_u32 v5, v1, 4, 2
    v_lshlrev_b32 v5, 1, v5
    v_and_b32 v7, 7, v1
    v_xor_b32 v5, v5, v7
    v_lshl_add_u32 v6, v5, 4, v6
    s_lshl_b32 s3, s35, 7
    v_add_u32 v6, s3, v6
    v_add_u32 v216, 0, v6
    v_add_u32 v217, 15360, v6
    v_add_u32 v218, 30720, v6
    v_add_u32 v219, 46080, v6
    s_lshl_b32 s72, s38, 12
    s_lshl_b32 s73, s38, 16
    s_and_b32 s3, s36, 0
    s_lshl_b32 s3, s3, 18
    s_or_b32 s73, s73, s3
    v_and_b32 v2, 15, v1
    v_add_u32 v2, s69, v2
    v_lshlrev_b32 v2, 2, v2
    v_add_u32 v2, 152064, v2
    ds_read_b32 v193, v2
    ds_read_b32 v192, v2 offset:1024
    s_mul_i32 s76, s67, 4224
    s_add_u32 s76, s76, 1048576
    v_lshlrev_b32 v5, 4, v1
    v_and_b32 v6, 48, v1
    v_add_u32 v6, 4096, v6
    s_lshl_b32 s3, s38, 2
    s_add_u32 s3, s3, 162112
    v_mov_b32 v3, s3
L_gw:
    ds_read_b32 v2, v3
    s_waitcnt lgkmcnt(0)
    v_readfirstlane_b32 s3, v2
    s_nop 0
    s_cmp_eq_u32 s3, 3
    s_cbranch_scc1 L_gk
    s_sleep 1
    s_branch L_gw
L_gk:
    v_mul_f32 v196, v193, v192
    v_mov_b32 v198, 0xbfb8aa3b
    v_lshlrev_b32 v224, 16, v240
    v_and_b32 v225, 0xffff0000, v240
    v_lshlrev_b32 v226, 16, v241
    v_and_b32 v227, 0xffff0000, v241
    v_lshlrev_b32 v228, 16, v242
    v_and_b32 v229, 0xffff0000, v242
    v_lshlrev_b32 v230, 16, v243
    v_and_b32 v231, 0xffff0000, v243
    v_lshlrev_b32 v232, 16, v244
    v_and_b32 v233, 0xffff0000, v244
    v_lshlrev_b32 v234, 16, v245
    v_and_b32 v235, 0xffff0000, v245
    v_lshlrev_b32 v236, 16, v246
    v_and_b32 v237, 0xffff0000, v246
    v_lshlrev_b32 v238, 16, v247
    v_and_b32 v239, 0xffff0000, v247
    v_pk_fma_f32 v[224:225], v[224:225], v[192:193], v[196:197] op_sel_hi:[1,0,0] neg_lo:[0,0,1] neg_hi:[0,0,1]
    v_pk_fma_f32 v[226:227], v[226:227], v[192:193], v[196:197] op_sel_hi:[1,0,0] neg_lo:[0,0,1] neg_hi:[0,0,1]
    v_pk_fma_f32 v[228:229], v[228:229], v[192:193], v[196:197] op_sel_hi:[1,0,0] neg_lo:[0,0,1] neg_hi:[0,0,1]
    v_pk_fma_f32 v[230:231], v[230:231], v[192:193], v[196:197] op_sel_hi:[1,0,0] neg_lo:[0,0,1] neg_hi:[0,0,1]
    v_pk_fma_f32 v[232:233], v[232:233], v[192:193], v[196:197] op_sel_hi:[1,0,0] neg_lo:[0,0,1] neg_hi:[0,0,1]
    v_pk_fma_f32 v[234:235], v[234:235], v[192:193], v[196:197] op_sel_hi:[1,0,0] neg_lo:[0,0,1] neg_hi:[0,0,1]
    v_pk_fma_f32 v[236:237], v[236:237], v[192:193], v[196:197] op_sel_hi:[1,0,0] neg_lo:[0,0,1] neg_hi:[0,0,1]
    v_pk_fma_f32 v[238:239], v[238:239], v[192:193], v[196:197] op_sel_hi:[1,0,0] neg_lo:[0,0,1] neg_hi:[0,0,1]
    v_pk_mul_f32 v[200:201], v[224:225], v[198:199] op_sel_hi:[1,0]
    v_pk_mul_f32 v[202:203], v[226:227], v[198:199] op_sel_hi:[1,0]
    v_pk_mul_f32 v[204:205], v[228:229], v[198:199] op_sel_hi:[1,0]
    v_pk_mul_f32 v[206:207], v[230:231], v[198:199] op_sel_hi:[1,0]
    v_pk_mul_f32 v[208:209], v[232:233], v[198:199] op_sel_hi:[1,0]
    v_pk_mul_f32 v[210:211], v[234:235], v[198:199] op_sel_hi:[1,0]
    v_pk_mul_f32 v[212:213], v[236:237], v[198:199] op_sel_hi:[1,0]
    v_pk_mul_f32 v[214:215], v[238:239], v[198:199] op_sel_hi:[1,0]
    v_exp_f32 v200, v200
    v_exp_f32 v201, v201
    v_exp_f32 v202, v202
    v_exp_f32 v203, v203
    v_exp_f32 v204, v204
    v_exp_f32 v205, v205
    v_exp_f32 v206, v206
    v_exp_f32 v207, v207
    v_exp_f32 v208, v208
    v_exp_f32 v209, v209
    v_exp_f32 v210, v210
    v_exp_f32 v211, v211
    v_exp_f32 v212, v212
    v_exp_f32 v213, v213
    v_exp_f32 v214, v214
    v_exp_f32 v215, v215
    v_pk_add_f32 v[200:201], v[200:201], 1.0 op_sel_hi:[1,0]
    v_pk_add_f32 v[202:203], v[202:203], 1.0 op_sel_hi:[1,0]
    v_pk_add_f32 v[204:205], v[204:205], 1.0 op_sel_hi:[1,0]
    v_pk_add_f32 v[206:207], v[206:207], 1.0 op_sel_hi:[1,0]
    v_pk_add_f32 v[208:209], v[208:209], 1.0 op_sel_hi:[1,0]
    v_pk_add_f32 v[210:211], v[210:211], 1.0 op_sel_hi:[1,0]
    v_pk_add_f32 v[212:213], v[212:213], 1.0 op_sel_hi:[1,0]
    v_pk_add_f32 v[214:215], v[214:215], 1.0 op_sel_hi:[1,0]
    v_rcp_f32 v200, v200
    v_rcp_f32 v201, v201
    v_rcp_f32 v202, v202
    v_rcp_f32 v203, v203
    v_rcp_f32 v204, v204
    v_rcp_f32 v205, v205
    v_rcp_f32 v206, v206
    v_rcp_f32 v207, v207
    v_rcp_f32 v208, v208
    v_rcp_f32 v209, v209
    v_rcp_f32 v210, v210
    v_rcp_f32 v211, v211
    v_rcp_f32 v212, v212
    v_rcp_f32 v213, v213
    v_rcp_f32 v214, v214
    v_rcp_f32 v215, v215
    v_pk_mul_f32 v[224:225], v[224:225], v[200:201]
    v_pk_mul_f32 v[226:227], v[226:227], v[202:203]
    v_pk_mul_f32 v[228:229], v[228:229], v[204:205]
    v_pk_mul_f32 v[230:231], v[230:231], v[206:207]
    v_pk_mul_f32 v[232:233], v[232:233], v[208:209]
    v_pk_mul_f32 v[234:235], v[234:235], v[210:211]
    v_pk_mul_f32 v[236:237], v[236:237], v[212:213]
    v_pk_mul_f32 v[238:239], v[238:239], v[214:215]
    buffer_load_dwordx4 v[104:107], v5, s[48:51], s76 offen offset:0 sc1
    buffer_load_dwordx4 v[108:111], v5, s[48:51], s76 offen offset:1024 sc1
    buffer_load_dwordx4 v[112:115], v5, s[48:51], s76 offen offset:2048 sc1
    buffer_load_dwordx4 v[116:119], v5, s[48:51], s76 offen offset:3072 sc1
    buffer_load_dwordx4 v[120:123], v6, s[48:51], s76 offen offset:0 sc1
    buffer_load_dwordx4 v[124:127], v6, s[48:51], s76 offen offset:64 sc1
    s_waitcnt lgkmcnt(0)
    v_readfirstlane_b32 s70, v248
    s_nop 0
    s_and_b32 s68, s70, 0x7ff
    s_sub_u32 s68, 2047, s68
    s_lshl_b32 s3, s36, 3
    s_lshl_b32 s28, s64, 2
    s_add_u32 s3, s3, s28
    s_lshl_b32 s3, s3, 5
    s_add_u32 s3, s3, s67
    s_lshl_b32 s77, s3, 10
    s_add_u32 s77, s77, 4194304
    s_waitcnt vmcnt(0)
    s_add_u32 s76, s76, 626688
    s_mov_b32 s29, 0
L_k7:
    s_nop 0
    v_max3_u32 v2, v104, v105, v106
    v_max3_u32 v2, v2, v107, v108
    v_max3_u32 v2, v2, v109, v110
    v_max3_u32 v2, v2, v111, v112
    v_max3_u32 v2, v2, v113, v114
    v_max3_u32 v2, v2, v115, v116
    v_max3_u32 v2, v2, v117, v118
    v_max3_u32 v2, v2, v119, v120
    v_max3_u32 v2, v2, v121, v122
    v_max3_u32 v2, v2, v123, v124
    v_max3_u32 v2, v2, v125, v126
    v_max_u32 v2, v2, v127
    v_cmp_eq_u32 vcc, -1, v2
    s_cbranch_vccz L_k7k
    s_add_u32 s29, s29, 1
    s_cmp_ge_u32 s29, 200000
    s_cbranch_scc1 L_k7k
    v_max3_u32 v2, v104, v105, v106
    v_max_u32 v2, v2, v107
    v_cmp_eq_u32 vcc, -1, v2
    s_cbranch_vccz L_hm0
    s_mov_b64 exec, vcc
    buffer_load_dwordx4 v[104:107], v5, s[48:51], s76 offen offset:0 sc1
    s_mov_b64 exec, -1
L_hm0:
    v_max3_u32 v2, v108, v109, v110
    v_max_u32 v2, v2, v111
    v_cmp_eq_u32 vcc, -1, v2
    s_cbranch_vccz L_hm1
    s_mov_b64 exec, vcc
    buffer_load_dwordx4 v[108:111], v5, s[48:51], s76 offen offset:1024 sc1
    s_mov_b64 exec, -1
L_hm1:
    v_max3_u32 v2, v112, v113, v114
    v_max_u32 v2, v2, v115
    v_cmp_eq_u32 vcc, -1, v2
    s_cbranch_vccz L_hm2
    s_mov_b64 exec, vcc
    buffer_load_dwordx4 v[112:115], v5, s[48:51], s76 offen offset:2048 sc1
    s_mov_b64 exec, -1
L_hm2:
    v_max3_u32 v2, v116, v117, v118
    v_max_u32 v2, v2, v119
    v_cmp_eq_u32 vcc, -1, v2
    s_cbranch_vccz L_hm3
    s_mov_b64 exec, vcc
    buffer_load_dwordx4 v[116:119], v5, s[48:51], s76 offen offset:3072 sc1
    s_mov_b64 exec, -1
L_hm3:
    v_max3_u32 v2, v120, v121, v122
    v_max_u32 v2, v2, v123
    v_cmp_eq_u32 vcc, -1, v2
    s_cbranch_vccz L_hm4
    s_mov_b64 exec, vcc
    buffer_load_dwordx4 v[120:123], v6, s[48:51], s76 offen offset:0 sc1
    s_mov_b64 exec, -1
L_hm4:
    v_max3_u32 v2, v124, v125, v126
    v_max_u32 v2, v2, v127
    v_cmp_eq_u32 vcc, -1, v2
    s_cbranch_vccz L_hm5
    s_mov_b64 exec, vcc
    buffer_load_dwordx4 v[124:127], v6, s[48:51], s76 offen offset:64 sc1
    s_mov_b64 exec, -1
L_hm5:
    s_waitcnt vmcnt(0)
    s_branch L_k7
L_k7k:
    s_setprio 2
    v_mfma_f32_16x16x32_bf16 v[24:27], v[120:123], v[144:147], 0
    v_mfma_f32_16x16x32_bf16 v[24:27], v[124:127], v[8:11], v[24:27]
    v_mfma_f32_16x16x32_bf16 v[16:19], v[104:107], v[144:147], 0
    v_mfma_f32_16x16x32_bf16 v[16:19], v[112:115], v[8:11], v[16:19]
    v_mfma_f32_16x16x32_bf16 v[20:23], v[108:111], v[144:147], 0
    v_mfma_f32_16x16x32_bf16 v[20:23], v[116:119], v[8:11], v[20:23]
    v_mfma_f32_16x16x32_bf16 v[48:51], v[120:123], v[152:155], 0
    v_mfma_f32_16x16x32_bf16 v[48:51], v[124:127], v[32:35], v[48:51]
    v_mfma_f32_16x16x32_bf16 v[40:43], v[104:107], v[152:155], 0
    s_nop 0
    v_add_f32 v24, 0x358637bd, v24
    v_rcp_f32 v24, v24
    s_nop 0
    v_mul_f32 v16, v16, v24
    v_mfma_f32_16x16x32_bf16 v[40:43], v[112:115], v[32:35], v[40:43]
    v_mul_f32 v17, v17, v24
    v_mul_f32 v18, v18, v24
    v_mul_f32 v19, v19, v24
    v_mfma_f32_16x16x32_bf16 v[44:47], v[108:111], v[152:155], 0
    v_mul_f32 v20, v20, v24
    v_mul_f32 v21, v21, v24
    v_mul_f32 v22, v22, v24
    v_mfma_f32_16x16x32_bf16 v[44:47], v[116:119], v[32:35], v[44:47]
    v_mul_f32_e64 v23, v23, v24
    v_cvt_pk_bf16_f32 v16, v16, v17
    v_cvt_pk_bf16_f32 v17, v18, v19
    v_cvt_pk_bf16_f32 v18, v20, v21
    v_cvt_pk_bf16_f32 v19, v22, v23
    buffer_store_dwordx4 v[16:19], v5, s[48:51], s77 offen sc1
    s_add_u32 s77, s77, 32768
    v_mfma_f32_16x16x32_bf16 v[72:75], v[120:123], v[160:163], 0
    v_mfma_f32_16x16x32_bf16 v[72:75], v[124:127], v[56:59], v[72:75]
    v_mfma_f32_16x16x32_bf16 v[64:67], v[104:107], v[160:163], 0
    v_add_f32 v48, 0x358637bd, v48
    v_rcp_f32 v48, v48
    s_nop 0
    v_mul_f32 v40, v40, v48
    v_mfma_f32_16x16x32_bf16 v[64:67], v[112:115], v[56:59], v[64:67]
    v_mul_f32 v41, v41, v48
    v_mul_f32 v42, v42, v48
    v_mul_f32 v43, v43, v48
    v_mfma_f32_16x16x32_bf16 v[68:71], v[108:111], v[160:163], 0
    v_mul_f32 v44, v44, v48
    v_mul_f32 v45, v45, v48
    v_mul_f32 v46, v46, v48
    v_mfma_f32_16x16x32_bf16 v[68:71], v[116:119], v[56:59], v[68:71]
    v_mul_f32 v47, v47, v48
    v_cvt_pk_bf16_f32 v40, v40, v41
    v_cvt_pk_bf16_f32 v41, v42, v43
    v_cvt_pk_bf16_f32 v42, v44, v45
    v_cvt_pk_bf16_f32 v43, v46, v47
    buffer_store_dwordx4 v[40:43], v5, s[48:51], s77 offen sc1
    s_add_u32 s77, s77, 32768
    v_mfma_f32_16x16x32_bf16 v[96:99], v[120:123], v[168:171], 0
    v_mfma_f32_16x16x32_bf16 v[96:99], v[124:127], v[80:83], v[96:99]
    v_mfma_f32_16x16x32_bf16 v[88:91], v[104:107], v[168:171], 0
    v_add_f32 v72, 0x358637bd, v72
    v_rcp_f32 v72, v72
    s_nop 0
    v_mul_f32 v64, v64, v72
    v_mfma_f32_16x16x32_bf16 v[88:91], v[112:115], v[80:83], v[88:91]
    v_mul_f32 v65, v65, v72
    v_mul_f32 v66, v66, v72
    v_mul_f32 v67, v67, v72
    v_mfma_f32_16x16x32_bf16 v[92:95], v[108:111], v[168:171], 0
    v_mul_f32 v68, v68, v72
    v_mul_f32 v69, v69, v72
    v_mul_f32 v70, v70, v72
    v_mfma_f32_16x16x32_bf16 v[92:95], v[116:119], v[80:83], v[92:95]
    v_mul_f32 v71, v71, v72
    v_cvt_pk_bf16_f32 v64, v64, v65
    v_cvt_pk_bf16_f32 v65, v66, v67
    v_cvt_pk_bf16_f32 v66, v68, v69
    v_cvt_pk_bf16_f32 v67, v70, v71
    buffer_store_dwordx4 v[64:67], v5, s[48:51], s77 offen sc1
    s_add_u32 s77, s77, 32768
    v_add_f32 v96, 0x358637bd, v96
    v_rcp_f32 v96, v96
    s_nop 0
    v_pk_mul_f32 v[88:89], v[88:89], v[96:97] op_sel_hi:[1,0]
    v_pk_mul_f32 v[90:91], v[90:91], v[96:97] op_sel_hi:[1,0]
    v_pk_mul_f32 v[92:93], v[92:93], v[96:97] op_sel_hi:[1,0]
    v_pk_mul_f32 v[94:95], v[94:95], v[96:97] op_sel_hi:[1,0]
    v_cvt_pk_bf16_f32 v88, v88, v89
    v_cvt_pk_bf16_f32 v89, v90, v91
    v_cvt_pk_bf16_f32 v90, v92, v93
    v_cvt_pk_bf16_f32 v91, v94, v95
    buffer_store_dwordx4 v[88:91], v5, s[48:51], s77 offen sc1
    v_mov_b32_e64 v2, 7
    ds_write_b32 v3, v2
    s_and_b32 s3, s68, 127
    s_lshl_b32 s3, s3, 2
    s_add_u32 s3, s3, 152064
    v_mov_b32 v2, s3
    ds_read_b32 v250, v2
    ds_read_b32 v251, v2 offset:1024
    s_setprio 0
    v_and_b32 v3, 3, v1
    v_lshlrev_b32_e64 v3, 2, v3
    v_add_u32 v3, 162112, v3
L_cw:
    ds_read_b32 v2, v3
    s_waitcnt lgkmcnt(0)
    v_cmp_ne_u32_e64 vcc, 7, v2
    s_cbranch_vccz L_cwk
    s_sleep 1
    s_branch L_cw
L_cwk:
    s_add_u32 m0, s72, 98304
    s_xor_b32 s3, s73, 1572864
    buffer_load_dwordx4 v216, s[88:91], s3 offen offset:0 lds
    buffer_load_dwordx4 v217, s[88:91], s3 offen offset:1024 lds
    buffer_load_dwordx4 v218, s[88:91], s3 offen offset:2048 lds
    buffer_load_dwordx4 v219, s[88:91], s3 offen offset:3072 lds
    s_add_u32 m0, s72, 114688
    s_xor_b32 s3, s73, 1835008
    buffer_load_dwordx4 v216, s[88:91], s3 offen offset:0 lds
    buffer_load_dwordx4 v217, s[88:91], s3 offen offset:1024 lds
    buffer_load_dwordx4 v218, s[88:91], s3 offen offset:2048 lds
    buffer_load_dwordx4 v219, s[88:91], s3 offen offset:3072 lds
L_p3:
    s_nop 3
    s_mov_b32 s56, s22
    s_mov_b32 s57, s23
    s_mov_b32 s58, 4194304
    s_mov_b32 s59, 0x00020000
    s_lshr_b32 s64, s39, 2
    s_lshl_b32 s3, s34, 2
    s_add_u32 s3, s3, s38
    s_lshl_b32 s3, s3, 16
    s_lshl_b32 s28, s64, 14
    s_add_u32 s3, s3, s28
    s_add_u32 s76, s3, 4194304
    s_lshr_b32 s3, s73, 18
    s_lshl_b32 s3, s3, 12
    s_xor_b32 s76, s76, s3
    s_lshl_b32 s3, s64, 15
    v_lshlrev_b32 v2, 4, v1
    v_add_u32 v116, s3, v2
    v_xor_b32 v117, 0x8000, v116
    v_lshrrev_b32 v2, 2, v1
    v_lshlrev_b32_e64 v2, 7, v2
    v_bfe_u32 v3, v1, 3, 2
    v_lshl_add_u32 v2, v3, 5, v2
    v_and_b32 v3, 3, v1
    v_lshl_add_u32 v2, v3, 3, v2
    s_lshl_b32 s3, s64, 16
    v_add_u32 v112, s3, v2
    v_xor_b32 v113, 32, v112
    v_xor_b32 v114, 64, v112
    v_xor_b32 v115, 96, v112
    s_xor_b32 s77, s76, 0
    buffer_load_dwordx4 v[40:43], v116, s[48:51], s77 offen offset:0 sc1
    buffer_load_dwordx4 v[44:47], v117, s[48:51], s77 offen offset:0 sc1
    buffer_load_dwordx4 v[48:51], v116, s[48:51], s77 offen offset:1024 sc1
    buffer_load_dwordx4 v[52:55], v117, s[48:51], s77 offen offset:1024 sc1
    buffer_load_dwordx4 v[56:59], v116, s[48:51], s77 offen offset:2048 sc1
    buffer_load_dwordx4 v[60:63], v117, s[48:51], s77 offen offset:2048 sc1
    buffer_load_dwordx4 v[64:67], v116, s[48:51], s77 offen offset:3072 sc1
    buffer_load_dwordx4 v[68:71], v117, s[48:51], s77 offen offset:3072 sc1
    s_lshr_b32 s3, s68, 7
    s_xor_b32 s83, s3, s34
    s_or_b32 s83, s83, s39
    v_lshlrev_b32 v222, 4, v1
    ds_read_b64_tr_b16 v[80:81], v112 offset:0
    ds_read_b64_tr_b16 v[82:83], v112 offset:2048
    ds_read_b64_tr_b16 v[84:85], v113 offset:0
    ds_read_b64_tr_b16 v[86:87], v113 offset:2048
    ds_read_b64_tr_b16 v[88:89], v114 offset:0
    ds_read_b64_tr_b16 v[90:91], v114 offset:2048
    ds_read_b64_tr_b16 v[92:93], v115 offset:0
    ds_read_b64_tr_b16 v[94:95], v115 offset:2048
    s_mov_b32 s29, 0
    s_waitcnt vmcnt(6)
    v_max3_u32 v2, v40, v41, v42
    v_max3_u32 v2, v2, v43, v44
    v_max3_u32 v2, v2, v45, v46
    v_max_u32 v2, v2, v47
    v_cmp_eq_u32 vcc, -1, v2
    s_cbranch_vccnz L_r0
L_g0:
    s_waitcnt lgkmcnt(0)
    v_mfma_f32_16x16x32_bf16 v[8:11], v[80:83], v[40:43], 0
    ds_read_b64_tr_b16 v[96:97], v112 offset:4096
    ds_read_b64_tr_b16 v[98:99], v112 offset:6144
    v_mfma_f32_16x16x32_bf16 v[24:27], v[80:83], v[44:47], 0
    ds_read_b64_tr_b16 v[100:101], v113 offset:4096
    ds_read_b64_tr_b16 v[102:103], v113 offset:6144
    v_mfma_f32_16x16x32_bf16 v[12:15], v[84:87], v[40:43], 0
    ds_read_b64_tr_b16 v[104:105], v114 offset:4096
    ds_read_b64_tr_b16 v[106:107], v114 offset:6144
    v_mfma_f32_16x16x32_bf16 v[28:31], v[84:87], v[44:47], 0
    ds_read_b64_tr_b16 v[108:109], v115 offset:4096
    ds_read_b64_tr_b16 v[110:111], v115 offset:6144
    v_mfma_f32_16x16x32_bf16 v[16:19], v[88:91], v[40:43], 0
    s_xor_b32 s77, s76, 4096
    buffer_load_dwordx4 v[72:75], v116, s[48:51], s77 offen offset:0 sc1
    buffer_load_dwordx4 v[76:79], v117, s[48:51], s77 offen offset:0 sc1
    v_mfma_f32_16x16x32_bf16 v[32:35], v[88:91], v[44:47], 0
    s_waitcnt vmcnt(6)
    v_max3_u32 v2, v48, v49, v50
    v_mfma_f32_16x16x32_bf16 v[20:23], v[92:95], v[40:43], 0
    v_max3_u32 v2, v2, v51, v52
    v_max3_u32 v2, v2, v53, v54
    v_mfma_f32_16x16x32_bf16 v[36:39], v[92:95], v[44:47], 0
    v_max_u32 v2, v2, v55
    v_cmp_eq_u32_e64 vcc, -1, v2
    s_cbranch_vccnz L_r1
L_g1:
    s_waitcnt lgkmcnt(0)
    v_mfma_f32_16x16x32_bf16 v[8:11], v[96:99], v[48:51], v[8:11]
    ds_read_b64_tr_b16 v[80:81], v112 offset:8192
    ds_read_b64_tr_b16 v[82:83], v112 offset:10240
    v_mfma_f32_16x16x32_bf16 v[24:27], v[96:99], v[52:55], v[24:27]
    ds_read_b64_tr_b16 v[84:85], v113 offset:8192
    ds_read_b64_tr_b16 v[86:87], v113 offset:10240
    v_mfma_f32_16x16x32_bf16 v[12:15], v[100:103], v[48:51], v[12:15]
    ds_read_b64_tr_b16 v[88:89], v114 offset:8192
    ds_read_b64_tr_b16 v[90:91], v114 offset:10240
    v_mfma_f32_16x16x32_bf16 v[28:31], v[100:103], v[52:55], v[28:31]
    ds_read_b64_tr_b16 v[92:93], v115 offset:8192
    ds_read_b64_tr_b16 v[94:95], v115 offset:10240
    v_mfma_f32_16x16x32_bf16 v[16:19], v[104:107], v[48:51], v[16:19]
    buffer_load_dwordx4 v[40:43], v116, s[48:51], s77 offen offset:1024 sc1
    buffer_load_dwordx4 v[44:47], v117, s[48:51], s77 offen offset:1024 sc1
    v_mfma_f32_16x16x32_bf16 v[32:35], v[104:107], v[52:55], v[32:35]
    s_waitcnt vmcnt(6)
    v_max3_u32 v2, v56, v57, v58
    v_mfma_f32_16x16x32_bf16 v[20:23], v[108:111], v[48:51], v[20:23]
    v_max3_u32 v2, v2, v59, v60
    v_max3_u32 v2, v2, v61, v62
    v_mfma_f32_16x16x32_bf16 v[36:39], v[108:111], v[52:55], v[36:39]
    v_max_u32 v2, v2, v63
    v_cmp_eq_u32_e64 vcc, -1, v2
    s_cbranch_vccnz L_r2
L_g2:
    s_waitcnt lgkmcnt(0)
    v_mfma_f32_16x16x32_bf16 v[8:11], v[80:83], v[56:59], v[8:11]
    ds_read_b64_tr_b16 v[96:97], v112 offset:12288
    ds_read_b64_tr_b16 v[98:99], v112 offset:14336
    v_mfma_f32_16x16x32_bf16 v[24:27], v[80:83], v[60:63], v[24:27]
    ds_read_b64_tr_b16 v[100:101], v113 offset:12288
    ds_read_b64_tr_b16 v[102:103], v113 offset:14336
    v_mfma_f32_16x16x32_bf16 v[12:15], v[84:87], v[56:59], v[12:15]
    ds_read_b64_tr_b16 v[104:105], v114 offset:12288
    ds_read_b64_tr_b16 v[106:107], v114 offset:14336
    v_mfma_f32_16x16x32_bf16 v[28:31], v[84:87], v[60:63], v[28:31]
    ds_read_b64_tr_b16 v[108:109], v115 offset:12288
    ds_read_b64_tr_b16 v[110:111], v115 offset:14336
    v_mfma_f32_16x16x32_bf16 v[16:19], v[88:91], v[56:59], v[16:19]
    buffer_load_dwordx4 v[48:51], v116, s[48:51], s77 offen offset:2048 sc1
    buffer_load_dwordx4 v[52:55], v117, s[48:51], s77 offen offset:2048 sc1
    v_mfma_f32_16x16x32_bf16 v[32:35], v[88:91], v[60:63], v[32:35]
    s_waitcnt vmcnt(6)
    v_max3_u32 v2, v64, v65, v66
    v_mfma_f32_16x16x32_bf16 v[20:23], v[92:95], v[56:59], v[20:23]
    v_max3_u32 v2, v2, v67, v68
    v_max3_u32 v2, v2, v69, v70
    v_mfma_f32_16x16x32_bf16 v[36:39], v[92:95], v[60:63], v[36:39]
    v_max_u32 v2, v2, v71
    v_cmp_eq_u32 vcc, -1, v2
    s_cbranch_vccnz L_r3
L_g3:
    s_waitcnt lgkmcnt(0)
    s_cmp_eq_u32 s64, 0
    s_cbranch_scc1 L_nb3
    s_barrier
L_nb3:
    v_mfma_f32_16x16x32_bf16 v[8:11], v[96:99], v[64:67], v[8:11]
    ds_read_b64_tr_b16 v[80:81], v112 offset:16384
    ds_read_b64_tr_b16 v[82:83], v112 offset:18432
    v_mfma_f32_16x16x32_bf16 v[24:27], v[96:99], v[68:71], v[24:27]
    ds_read_b64_tr_b16 v[84:85], v113 offset:16384
    ds_read_b64_tr_b16 v[86:87], v113 offset:18432
    v_mfma_f32_16x16x32_bf16 v[12:15], v[100:103], v[64:67], v[12:15]
    ds_read_b64_tr_b16 v[88:89], v114 offset:16384
    ds_read_b64_tr_b16 v[90:91], v114 offset:18432
    v_mfma_f32_16x16x32_bf16 v[28:31], v[100:103], v[68:71], v[28:31]
    ds_read_b64_tr_b16 v[92:93], v115 offset:16384
    ds_read_b64_tr_b16 v[94:95], v115 offset:18432
    v_mfma_f32_16x16x32_bf16 v[16:19], v[104:107], v[64:67], v[16:19]
    buffer_load_dwordx4 v[56:59], v116, s[48:51], s77 offen offset:3072 sc1
    buffer_load_dwordx4 v[60:63], v117, s[48:51], s77 offen offset:3072 sc1
    v_mfma_f32_16x16x32_bf16 v[32:35], v[104:107], v[68:71], v[32:35]
    s_waitcnt vmcnt(6)
    v_max3_u32 v2, v72, v73, v74
    v_mfma_f32_16x16x32_bf16 v[20:23], v[108:111], v[64:67], v[20:23]
    v_max3_u32 v2, v2, v75, v76
    v_max3_u32 v2, v2, v77, v78
    v_mfma_f32_16x16x32_bf16 v[36:39], v[108:111], v[68:71], v[36:39]
    v_max_u32 v2, v2, v79
    v_cmp_eq_u32_e64 vcc, -1, v2
    s_cbranch_vccnz L_r4
L_g4:
    s_waitcnt lgkmcnt(0)
    v_mfma_f32_16x16x32_bf16 v[8:11], v[80:83], v[72:75], v[8:11]
    ds_read_b64_tr_b16 v[96:97], v112 offset:20480
    ds_read_b64_tr_b16 v[98:99], v112 offset:22528
    v_mfma_f32_16x16x32_bf16 v[24:27], v[80:83], v[76:79], v[24:27]
    ds_read_b64_tr_b16 v[100:101], v113 offset:20480
    ds_read_b64_tr_b16 v[102:103], v113 offset:22528
    v_mfma_f32_16x16x32_bf16 v[12:15], v[84:87], v[72:75], v[12:15]
    ds_read_b64_tr_b16 v[104:105], v114 offset:20480
    ds_read_b64_tr_b16 v[106:107], v114 offset:22528
    v_mfma_f32_16x16x32_bf16 v[28:31], v[84:87], v[76:79], v[28:31]
    ds_read_b64_tr_b16 v[108:109], v115 offset:20480
    ds_read_b64_tr_b16 v[110:111], v115 offset:22528
    v_mfma_f32_16x16x32_bf16 v[16:19], v[88:91], v[72:75], v[16:19]
    s_xor_b32 s77, s76, 8192
    buffer_load_dwordx4 v[64:67], v116, s[48:51], s77 offen offset:0 sc1
    buffer_load_dwordx4 v[68:71], v117, s[48:51], s77 offen offset:0 sc1
    v_mfma_f32_16x16x32_bf16 v[32:35], v[88:91], v[76:79], v[32:35]
    s_waitcnt vmcnt(6)
    v_max3_u32 v2, v40, v41, v42
    v_mfma_f32_16x16x32_bf16 v[20:23], v[92:95], v[72:75], v[20:23]
    v_max3_u32 v2, v2, v43, v44
    v_max3_u32 v2, v2, v45, v46
    v_mfma_f32_16x16x32_bf16 v[36:39], v[92:95], v[76:79], v[36:39]
    v_max_u32 v2, v2, v47
    v_cmp_eq_u32_e64 vcc, -1, v2
    s_cbranch_vccnz L_r5
L_g5:
    s_waitcnt lgkmcnt(0)
    v_mfma_f32_16x16x32_bf16 v[8:11], v[96:99], v[40:43], v[8:11]
    ds_read_b64_tr_b16 v[80:81], v112 offset:24576
    ds_read_b64_tr_b16 v[82:83], v112 offset:26624
    v_mfma_f32_16x16x32_bf16 v[24:27], v[96:99], v[44:47], v[24:27]
    ds_read_b64_tr_b16 v[84:85], v113 offset:24576
    ds_read_b64_tr_b16 v[86:87], v113 offset:26624
    v_mfma_f32_16x16x32_bf16 v[12:15], v[100:103], v[40:43], v[12:15]
    ds_read_b64_tr_b16 v[88:89], v114 offset:24576
    ds_read_b64_tr_b16 v[90:91], v114 offset:26624
    v_mfma_f32_16x16x32_bf16 v[28:31], v[100:103], v[44:47], v[28:31]
    ds_read_b64_tr_b16 v[92:93], v115 offset:24576
    ds_read_b64_tr_b16 v[94:95], v115 offset:26624
    v_mfma_f32_16x16x32_bf16 v[16:19], v[104:107], v[40:43], v[16:19]
    buffer_load_dwordx4 v[72:75], v116, s[48:51], s77 offen offset:1024 sc1
    buffer_load_dwordx4 v[76:79], v117, s[48:51], s77 offen offset:1024 sc1
    v_mfma_f32_16x16x32_bf16 v[32:35], v[104:107], v[44:47], v[32:35]
    s_waitcnt vmcnt(6)
    v_max3_u32 v2, v48, v49, v50
    v_mfma_f32_16x16x32_bf16 v[20:23], v[108:111], v[40:43], v[20:23]
    v_max3_u32 v2, v2, v51, v52
    v_max3_u32 v2, v2, v53, v54
    v_mfma_f32_16x16x32_bf16 v[36:39], v[108:111], v[44:47], v[36:39]
    v_max_u32 v2, v2, v55
    v_cmp_eq_u32_e64 vcc, -1, v2
    s_cbranch_vccnz L_r6
L_g6:
    s_waitcnt lgkmcnt(0)
    v_mfma_f32_16x16x32_bf16 v[8:11], v[80:83], v[48:51], v[8:11]
    ds_read_b64_tr_b16 v[96:97], v112 offset:28672
    ds_read_b64_tr_b16 v[98:99], v112 offset:30720
    v_mfma_f32_16x16x32_bf16 v[24:27], v[80:83], v[52:55], v[24:27]
    ds_read_b64_tr_b16 v[100:101], v113 offset:28672
    ds_read_b64_tr_b16 v[102:103], v113 offset:30720
    v_mfma_f32_16x16x32_bf16 v[12:15], v[84:87], v[48:51], v[12:15]
    ds_read_b64_tr_b16 v[104:105], v114 offset:28672
    ds_read_b64_tr_b16 v[106:107], v114 offset:30720
    v_mfma_f32_16x16x32_bf16 v[28:31], v[84:87], v[52:55], v[28:31]
    ds_read_b64_tr_b16 v[108:109], v115 offset:28672
    ds_read_b64_tr_b16 v[110:111], v115 offset:30720
    v_mfma_f32_16x16x32_bf16 v[16:19], v[88:91], v[48:51], v[16:19]
    buffer_load_dwordx4 v[40:43], v116, s[48:51], s77 offen offset:2048 sc1
    buffer_load_dwordx4 v[44:47], v117, s[48:51], s77 offen offset:2048 sc1
    v_mfma_f32_16x16x32_bf16 v[32:35], v[88:91], v[52:55], v[32:35]
    s_waitcnt vmcnt(6)
    v_max3_u32 v2, v56, v57, v58
    v_mfma_f32_16x16x32_bf16 v[20:23], v[92:95], v[48:51], v[20:23]
    v_max3_u32 v2, v2, v59, v60
    v_max3_u32 v2, v2, v61, v62
    v_mfma_f32_16x16x32_bf16 v[36:39], v[92:95], v[52:55], v[36:39]
    v_max_u32 v2, v2, v63
    v_cmp_eq_u32 vcc, -1, v2
    s_cbranch_vccnz L_r7
L_g7:
    s_waitcnt lgkmcnt(0)
    s_cmp_eq_u32 s64, 1
    s_cbranch_scc1 L_nb7
    s_barrier
L_nb7:
    v_mfma_f32_16x16x32_bf16 v[8:11], v[96:99], v[56:59], v[8:11]
    ds_read_b64_tr_b16 v[80:81], v112 offset:32768
    ds_read_b64_tr_b16 v[82:83], v112 offset:34816
    v_mfma_f32_16x16x32_bf16 v[24:27], v[96:99], v[60:63], v[24:27]
    ds_read_b64_tr_b16 v[84:85], v113 offset:32768
    ds_read_b64_tr_b16 v[86:87], v113 offset:34816
    v_mfma_f32_16x16x32_bf16 v[12:15], v[100:103], v[56:59], v[12:15]
    ds_read_b64_tr_b16 v[88:89], v114 offset:32768
    ds_read_b64_tr_b16 v[90:91], v114 offset:34816
    v_mfma_f32_16x16x32_bf16 v[28:31], v[100:103], v[60:63], v[28:31]
    ds_read_b64_tr_b16 v[92:93], v115 offset:32768
    ds_read_b64_tr_b16 v[94:95], v115 offset:34816
    v_mfma_f32_16x16x32_bf16 v[16:19], v[104:107], v[56:59], v[16:19]
    buffer_load_dwordx4 v[48:51], v116, s[48:51], s77 offen offset:3072 sc1
    buffer_load_dwordx4 v[52:55], v117, s[48:51], s77 offen offset:3072 sc1
    v_mfma_f32_16x16x32_bf16 v[32:35], v[104:107], v[60:63], v[32:35]
    s_waitcnt vmcnt(6)
    v_max3_u32 v2, v64, v65, v66
    v_mfma_f32_16x16x32_bf16 v[20:23], v[108:111], v[56:59], v[20:23]
    v_max3_u32 v2, v2, v67, v68
    v_max3_u32 v2, v2, v69, v70
    v_mfma_f32_16x16x32_bf16 v[36:39], v[108:111], v[60:63], v[36:39]
    v_max_u32 v2, v2, v71
    v_cmp_eq_u32_e64 vcc, -1, v2
    s_cbranch_vccnz L_r8
L_g8:
    s_waitcnt lgkmcnt(0)
    v_mfma_f32_16x16x32_bf16 v[8:11], v[80:83], v[64:67], v[8:11]
    ds_read_b64_tr_b16 v[96:97], v112 offset:36864
    ds_read_b64_tr_b16 v[98:99], v112 offset:38912
    v_mfma_f32_16x16x32_bf16 v[24:27], v[80:83], v[68:71], v[24:27]
    ds_read_b64_tr_b16 v[100:101], v113 offset:36864
    ds_read_b64_tr_b16 v[102:103], v113 offset:38912
    v_mfma_f32_16x16x32_bf16 v[12:15], v[84:87], v[64:67], v[12:15]
    ds_read_b64_tr_b16 v[104:105], v114 offset:36864
    ds_read_b64_tr_b16 v[106:107], v114 offset:38912
    v_mfma_f32_16x16x32_bf16 v[28:31], v[84:87], v[68:71], v[28:31]
    ds_read_b64_tr_b16 v[108:109], v115 offset:36864
    ds_read_b64_tr_b16 v[110:111], v115 offset:38912
    v_mfma_f32_16x16x32_bf16 v[16:19], v[88:91], v[64:67], v[16:19]
    s_xor_b32 s77, s76, 12288
    buffer_load_dwordx4 v[56:59], v116, s[48:51], s77 offen offset:0 sc1
    buffer_load_dwordx4 v[60:63], v117, s[48:51], s77 offen offset:0 sc1
    v_mfma_f32_16x16x32_bf16 v[32:35], v[88:91], v[68:71], v[32:35]
    s_waitcnt vmcnt(6)
    v_max3_u32 v2, v72, v73, v74
    v_mfma_f32_16x16x32_bf16 v[20:23], v[92:95], v[64:67], v[20:23]
    v_max3_u32 v2, v2, v75, v76
    v_max3_u32 v2, v2, v77, v78
    v_mfma_f32_16x16x32_bf16 v[36:39], v[92:95], v[68:71], v[36:39]
    v_max_u32 v2, v2, v79
    v_cmp_eq_u32_e64 vcc, -1, v2
    s_cbranch_vccnz L_r9
L_g9:
    s_waitcnt lgkmcnt(0)
    v_mfma_f32_16x16x32_bf16 v[8:11], v[96:99], v[72:75], v[8:11]
    ds_read_b64_tr_b16 v[80:81], v112 offset:40960
    ds_read_b64_tr_b16 v[82:83], v112 offset:43008
    v_mfma_f32_16x16x32_bf16 v[24:27], v[96:99], v[76:79], v[24:27]
    ds_read_b64_tr_b16 v[84:85], v113 offset:40960
    ds_read_b64_tr_b16 v[86:87], v113 offset:43008
    v_mfma_f32_16x16x32_bf16 v[12:15], v[100:103], v[72:75], v[12:15]
    ds_read_b64_tr_b16 v[88:89], v114 offset:40960
    ds_read_b64_tr_b16 v[90:91], v114 offset:43008
    v_mfma_f32_16x16x32_bf16 v[28:31], v[100:103], v[76:79], v[28:31]
    ds_read_b64_tr_b16 v[92:93], v115 offset:40960
    ds_read_b64_tr_b16 v[94:95], v115 offset:43008
    v_mfma_f32_16x16x32_bf16 v[16:19], v[104:107], v[72:75], v[16:19]
    buffer_load_dwordx4 v[64:67], v116, s[48:51], s77 offen offset:1024 sc1
    buffer_load_dwordx4 v[68:71], v117, s[48:51], s77 offen offset:1024 sc1
    v_mfma_f32_16x16x32_bf16 v[32:35], v[104:107], v[76:79], v[32:35]
    s_waitcnt vmcnt(6)
    v_max3_u32 v2, v40, v41, v42
    v_mfma_f32_16x16x32_bf16 v[20:23], v[108:111], v[72:75], v[20:23]
    v_max3_u32 v2, v2, v43, v44
    v_max3_u32 v2, v2, v45, v46
    v_mfma_f32_16x16x32_bf16 v[36:39], v[108:111], v[76:79], v[36:39]
    v_max_u32 v2, v2, v47
    v_cmp_eq_u32_e64 vcc, -1, v2
    s_cbranch_vccnz L_r10
L_g10:
    s_waitcnt lgkmcnt(0)
    v_mfma_f32_16x16x32_bf16 v[8:11], v[80:83], v[40:43], v[8:11]
    ds_read_b64_tr_b16 v[96:97], v112 offset:45056
    ds_read_b64_tr_b16 v[98:99], v112 offset:47104
    v_mfma_f32_16x16x32_bf16 v[24:27], v[80:83], v[44:47], v[24:27]
    ds_read_b64_tr_b16 v[100:101], v113 offset:45056
    ds_read_b64_tr_b16 v[102:103], v113 offset:47104
    v_mfma_f32_16x16x32_bf16 v[12:15], v[84:87], v[40:43], v[12:15]
    ds_read_b64_tr_b16 v[104:105], v114 offset:45056
    ds_read_b64_tr_b16 v[106:107], v114 offset:47104
    v_mfma_f32_16x16x32_bf16 v[28:31], v[84:87], v[44:47], v[28:31]
    ds_read_b64_tr_b16 v[108:109], v115 offset:45056
    ds_read_b64_tr_b16 v[110:111], v115 offset:47104
    v_mfma_f32_16x16x32_bf16 v[16:19], v[88:91], v[40:43], v[16:19]
    buffer_load_dwordx4 v[72:75], v116, s[48:51], s77 offen offset:2048 sc1
    buffer_load_dwordx4 v[76:79], v117, s[48:51], s77 offen offset:2048 sc1
    v_mfma_f32_16x16x32_bf16 v[32:35], v[88:91], v[44:47], v[32:35]
    s_waitcnt vmcnt(6)
    v_max3_u32 v2, v48, v49, v50
    v_mfma_f32_16x16x32_bf16 v[20:23], v[92:95], v[40:43], v[20:23]
    v_max3_u32 v2, v2, v51, v52
    v_max3_u32 v2, v2, v53, v54
    v_mfma_f32_16x16x32_bf16 v[36:39], v[92:95], v[44:47], v[36:39]
    v_max_u32 v2, v2, v55
    v_cmp_eq_u32_e64 vcc, -1, v2
    s_cbranch_vccnz L_r11
L_g11:
    s_waitcnt lgkmcnt(0)
    v_mfma_f32_16x16x32_bf16 v[8:11], v[96:99], v[48:51], v[8:11]
    ds_read_b64_tr_b16 v[80:81], v112 offset:49152
    ds_read_b64_tr_b16 v[82:83], v112 offset:51200
    v_mfma_f32_16x16x32_bf16 v[24:27], v[96:99], v[52:55], v[24:27]
    ds_read_b64_tr_b16 v[84:85], v113 offset:49152
    ds_read_b64_tr_b16 v[86:87], v113 offset:51200
    v_mfma_f32_16x16x32_bf16 v[12:15], v[100:103], v[48:51], v[12:15]
    ds_read_b64_tr_b16 v[88:89], v114 offset:49152
    ds_read_b64_tr_b16 v[90:91], v114 offset:51200
    v_mfma_f32_16x16x32_bf16 v[28:31], v[100:103], v[52:55], v[28:31]
    ds_read_b64_tr_b16 v[92:93], v115 offset:49152
    ds_read_b64_tr_b16 v[94:95], v115 offset:51200
    v_mfma_f32_16x16x32_bf16 v[16:19], v[104:107], v[48:51], v[16:19]
    buffer_load_dwordx4 v[40:43], v116, s[48:51], s77 offen offset:3072 sc1
    buffer_load_dwordx4 v[44:47], v117, s[48:51], s77 offen offset:3072 sc1
    v_mfma_f32_16x16x32_bf16 v[32:35], v[104:107], v[52:55], v[32:35]
    s_waitcnt vmcnt(6)
    v_max3_u32 v2, v56, v57, v58
    v_mfma_f32_16x16x32_bf16 v[20:23], v[108:111], v[48:51], v[20:23]
    v_max3_u32 v2, v2, v59, v60
    v_max3_u32 v2, v2, v61, v62
    v_mfma_f32_16x16x32_bf16 v[36:39], v[108:111], v[52:55], v[36:39]
    v_max_u32 v2, v2, v63
    v_cmp_eq_u32_e64 vcc, -1, v2
    s_cbranch_vccnz L_r12
L_g12:
    s_waitcnt lgkmcnt(0)
    v_mfma_f32_16x16x32_bf16 v[8:11], v[80:83], v[56:59], v[8:11]
    ds_read_b64_tr_b16 v[96:97], v112 offset:53248
    ds_read_b64_tr_b16 v[98:99], v112 offset:55296
    v_mfma_f32_16x16x32_bf16 v[24:27], v[80:83], v[60:63], v[24:27]
    ds_read_b64_tr_b16 v[100:101], v113 offset:53248
    ds_read_b64_tr_b16 v[102:103], v113 offset:55296
    v_mfma_f32_16x16x32_bf16 v[12:15], v[84:87], v[56:59], v[12:15]
    ds_read_b64_tr_b16 v[104:105], v114 offset:53248
    ds_read_b64_tr_b16 v[106:107], v114 offset:55296
    v_mfma_f32_16x16x32_bf16 v[28:31], v[84:87], v[60:63], v[28:31]
    ds_read_b64_tr_b16 v[108:109], v115 offset:53248
    ds_read_b64_tr_b16 v[110:111], v115 offset:55296
    v_mfma_f32_16x16x32_bf16 v[16:19], v[88:91], v[56:59], v[16:19]
    v_mfma_f32_16x16x32_bf16 v[32:35], v[88:91], v[60:63], v[32:35]
    s_waitcnt vmcnt(4)
    v_max3_u32 v2, v64, v65, v66
    v_mfma_f32_16x16x32_bf16 v[20:23], v[92:95], v[56:59], v[20:23]
    v_max3_u32 v2, v2, v67, v68
    v_max3_u32 v2, v2, v69, v70
    v_mfma_f32_16x16x32_bf16 v[36:39], v[92:95], v[60:63], v[36:39]
    v_max_u32 v2, v2, v71
    v_cmp_eq_u32_e64 vcc, -1, v2
    s_cbranch_vccnz L_r13
L_g13:
    s_waitcnt lgkmcnt(0)
    v_mfma_f32_16x16x32_bf16 v[8:11], v[96:99], v[64:67], v[8:11]
    ds_read_b64_tr_b16 v[80:81], v112 offset:57344
    ds_read_b64_tr_b16 v[82:83], v112 offset:59392
    v_mfma_f32_16x16x32_bf16 v[24:27], v[96:99], v[68:71], v[24:27]
    ds_read_b64_tr_b16 v[84:85], v113 offset:57344
    ds_read_b64_tr_b16 v[86:87], v113 offset:59392
    v_mfma_f32_16x16x32_bf16 v[12:15], v[100:103], v[64:67], v[12:15]
    ds_read_b64_tr_b16 v[88:89], v114 offset:57344
    ds_read_b64_tr_b16 v[90:91], v114 offset:59392
    v_mfma_f32_16x16x32_bf16 v[28:31], v[100:103], v[68:71], v[28:31]
    ds_read_b64_tr_b16 v[92:93], v115 offset:57344
    ds_read_b64_tr_b16 v[94:95], v115 offset:59392
    v_mfma_f32_16x16x32_bf16 v[16:19], v[104:107], v[64:67], v[16:19]
    v_mfma_f32_16x16x32_bf16 v[32:35], v[104:107], v[68:71], v[32:35]
    s_waitcnt vmcnt(2)
    v_max3_u32 v2, v72, v73, v74
    v_mfma_f32_16x16x32_bf16 v[20:23], v[108:111], v[64:67], v[20:23]
    v_max3_u32 v2, v2, v75, v76
    v_max3_u32 v2, v2, v77, v78
    v_mfma_f32_16x16x32_bf16 v[36:39], v[108:111], v[68:71], v[36:39]
    v_max_u32 v2, v2, v79
    v_cmp_eq_u32_e64 vcc, -1, v2
    s_cbranch_vccnz L_r14
L_g14:
    s_cmp_eq_u32 s83, 0
    s_cbranch_scc1 L_fx1
L_fx1r:
    s_waitcnt lgkmcnt(0)
    v_mfma_f32_16x16x32_bf16 v[8:11], v[80:83], v[72:75], v[8:11]
    ds_read_b64_tr_b16 v[96:97], v112 offset:61440
    ds_read_b64_tr_b16 v[98:99], v112 offset:63488
    v_mfma_f32_16x16x32_bf16 v[24:27], v[80:83], v[76:79], v[24:27]
    ds_read_b64_tr_b16 v[100:101], v113 offset:61440
    ds_read_b64_tr_b16 v[102:103], v113 offset:63488
    v_mfma_f32_16x16x32_bf16 v[12:15], v[84:87], v[72:75], v[12:15]
    ds_read_b64_tr_b16 v[104:105], v114 offset:61440
    ds_read_b64_tr_b16 v[106:107], v114 offset:63488
    v_mfma_f32_16x16x32_bf16 v[28:31], v[84:87], v[76:79], v[28:31]
    ds_read_b64_tr_b16 v[108:109], v115 offset:61440
    ds_read_b64_tr_b16 v[110:111], v115 offset:63488
    v_mfma_f32_16x16x32_bf16 v[16:19], v[88:91], v[72:75], v[16:19]
    v_mfma_f32_16x16x32_bf16 v[32:35], v[88:91], v[76:79], v[32:35]
    s_waitcnt vmcnt(0)
    v_max3_u32 v2, v40, v41, v42
    v_mfma_f32_16x16x32_bf16 v[20:23], v[92:95], v[72:75], v[20:23]
    v_max3_u32 v2, v2, v43, v44
    v_max3_u32 v2, v2, v45, v46
    v_mfma_f32_16x16x32_bf16 v[36:39], v[92:95], v[76:79], v[36:39]
    v_max_u32 v2, v2, v47
    v_cmp_eq_u32_e64 vcc, -1, v2
    s_cbranch_vccnz L_r15
L_g15:
    s_waitcnt lgkmcnt(0)
    v_mfma_f32_16x16x32_bf16 v[8:11], v[96:99], v[40:43], v[8:11]
    v_mfma_f32_16x16x32_bf16 v[24:27], v[96:99], v[44:47], v[24:27]
    v_mfma_f32_16x16x32_bf16 v[12:15], v[100:103], v[40:43], v[12:15]
    v_mfma_f32_16x16x32_bf16 v[28:31], v[100:103], v[44:47], v[28:31]
    v_mfma_f32_16x16x32_bf16 v[16:19], v[104:107], v[40:43], v[16:19]
    v_mfma_f32_16x16x32_bf16 v[32:35], v[104:107], v[44:47], v[32:35]
    v_mfma_f32_16x16x32_bf16 v[20:23], v[108:111], v[40:43], v[20:23]
    v_mfma_f32_16x16x32_bf16 v[36:39], v[108:111], v[44:47], v[36:39]
    s_cmp_eq_u32 s83, 0
    s_cbranch_scc1 L_fx2
L_fx2r:
    s_lshl_b32 s3, s39, 12
    s_add_u32 s3, s3, 131072
    v_lshlrev_b32 v2, 4, v1
    v_add_u32_e64 v2, s3, v2
    v_xor_b32 v3, 0x4000, v2
    s_xor_b32 s28, s3, 0x4000
    ds_write_b128 v2, v[24:27] offset:0
    ds_write_b128 v2, v[28:31] offset:1024
    ds_write_b128 v2, v[32:35] offset:2048
    ds_write_b128 v2, v[36:39] offset:3072
    v_lshlrev_b32 v40, 16, v240
    v_and_b32 v41, 0xffff0000, v240
    v_lshlrev_b32 v42, 16, v241
    v_and_b32 v43, 0xffff0000, v241
    v_lshlrev_b32 v44, 16, v242
    v_and_b32 v45, 0xffff0000, v242
    v_lshlrev_b32 v46, 16, v243
    v_and_b32 v47, 0xffff0000, v243
    v_lshlrev_b32 v48, 16, v244
    v_and_b32 v49, 0xffff0000, v244
    v_lshlrev_b32 v50, 16, v245
    v_and_b32 v51, 0xffff0000, v245
    v_lshlrev_b32 v52, 16, v246
    v_and_b32 v53, 0xffff0000, v246
    v_lshlrev_b32 v54, 16, v247
    v_and_b32 v55, 0xffff0000, v247
    v_and_b32 v4, 15, v1
    v_lshrrev_b32 v5, 4, v1
    v_lshlrev_b32 v6, 1, v4
    v_and_b32 v6, 14, v6
    v_xor_b32_e64 v5, v5, v6
    v_lshl_add_u32 v4, v4, 7, s28
    v_lshl_add_u32 v4, v5, 3, v4
    v_lshrrev_b32 v5, 3, v1
    v_and_b32 v6, 7, v1
    v_xor_b32_e64 v7, v6, v5
    v_lshl_add_u32 v7, v7, 4, s28
    v_lshl_add_u32 v7, v5, 7, v7
    s_lshl_b32 s3, s34, 7
    s_add_u32 s3, s3, s69
    v_add_u32 v5, s3, v5
    v_lshlrev_b32 v5, 11, v5
    v_lshl_add_u32 v5, v6, 4, v5
    s_lshl_b32 s3, s35, 7
    s_add_u32 s28, s3, 16384
    s_lshl_b32 s29, s34, 7
    s_add_u32 s29, s29, s69
    s_andn2_b32 s77, s68, 15
    s_cmp_lg_u32 s29, s77
    s_waitcnt lgkmcnt(0)
    s_barrier
    s_cbranch_scc1 L_nov
    v_and_b32 v2, 48, v1
    s_and_b32 s29, s68, 15
    s_lshl_b32 exec_lo, 0x00010001, s29
    s_mov_b32 exec_hi, exec_lo
    ds_read_b128 v[224:227], v2 offset:0
    ds_read_b128 v[228:231], v2 offset:64
    ds_read_b128 v[232:235], v2 offset:128
    ds_read_b128 v[236:239], v2 offset:192
    s_mov_b64 exec, -1
L_nov:
    ds_read_b128 v[24:27], v3 offset:0
    ds_read_b128 v[28:31], v3 offset:1024
    ds_read_b128 v[32:35], v3 offset:2048
    ds_read_b128 v[36:39], v3 offset:3072
    s_waitcnt lgkmcnt(3)
    s_nop 0
    v_pk_add_f32 v[8:9], v[8:9], v[24:25]
    v_pk_add_f32 v[10:11], v[10:11], v[26:27]
    v_pk_fma_f32 v[40:41], v[8:9], v[224:225], v[40:41]
    v_pk_fma_f32 v[42:43], v[10:11], v[226:227], v[42:43]
    v_cvt_pk_bf16_f32 v8, v40, v41
    v_cvt_pk_bf16_f32 v9, v42, v43
    s_waitcnt lgkmcnt(2)
    s_nop 0
    v_pk_add_f32 v[12:13], v[12:13], v[28:29]
    v_pk_add_f32 v[14:15], v[14:15], v[30:31]
    v_pk_fma_f32 v[44:45], v[12:13], v[228:229], v[44:45]
    v_pk_fma_f32 v[46:47], v[14:15], v[230:231], v[46:47]
    v_cvt_pk_bf16_f32 v10, v44, v45
    v_cvt_pk_bf16_f32 v11, v46, v47
    s_waitcnt lgkmcnt(1)
    s_nop 0
    v_pk_add_f32 v[16:17], v[16:17], v[32:33]
    v_pk_add_f32 v[18:19], v[18:19], v[34:35]
    v_pk_fma_f32 v[48:49], v[16:17], v[232:233], v[48:49]
    v_pk_fma_f32 v[50:51], v[18:19], v[234:235], v[50:51]
    v_cvt_pk_bf16_f32 v12, v48, v49
    v_cvt_pk_bf16_f32 v13, v50, v51
    s_waitcnt lgkmcnt(0)
    s_nop 0
    v_pk_add_f32 v[20:21], v[20:21], v[36:37]
    v_pk_add_f32 v[22:23], v[22:23], v[38:39]
    v_pk_fma_f32 v[52:53], v[20:21], v[236:237], v[52:53]
    v_pk_fma_f32 v[54:55], v[22:23], v[238:239], v[54:55]
    v_cvt_pk_bf16_f32 v14, v52, v53
    v_cvt_pk_bf16_f32 v15, v54, v55
    ds_write_b64 v4, v[8:9]
    v_xor_b32 v6, 32, v4
    ds_write_b64 v6, v[10:11]
    v_xor_b32 v6, 64, v4
    ds_write_b64 v6, v[12:13]
    v_xor_b32 v6, 96, v4
    ds_write_b64 v6, v[14:15]
    ds_read_b128 v[24:27], v7 offset:0
    ds_read_b128 v[28:31], v7 offset:1024
    s_waitcnt lgkmcnt(1)
    buffer_store_dwordx4 v[24:27], v5, s[56:59], s3 offen sc1
    s_waitcnt lgkmcnt(0)
    buffer_store_dwordx4 v[28:31], v5, s[56:59], s28 offen sc1
L_done:
    s_endpgm
L_fx1:
    s_lshl_b32 s78, s35, 14
    s_add_u32 s78, s78, 1413120
    v_and_b32 v2, 15, v1
    v_lshrrev_b32 v3, 4, v1
    v_lshl_add_u32 v193, v2, 2, v3
    v_and_b32 v2, 7, v193
    v_lshrrev_b32 v193, 3, v193
    v_lshl_add_u32 v193, v2, 3, v193
    v_lshlrev_b32 v2, 1, v193
    s_lshl_b32 s3, s68, 11
    s_lshl_b32 s28, s35, 7
    s_add_u32 s3, s3, s28
    buffer_load_ushort v194, v2, s[40:43], s3 offen
    s_add_u32 s3, s78, 0
    s_nop 0
    buffer_load_dwordx4 v[128:131], v222, s[48:51], s3 offen offset:0 sc1
    buffer_load_dwordx4 v[132:135], v222, s[48:51], s3 offen offset:1024 sc1
    buffer_load_dwordx4 v[136:139], v222, s[48:51], s3 offen offset:2048 sc1
    buffer_load_dwordx4 v[140:143], v222, s[48:51], s3 offen offset:3072 sc1
    s_add_u32 s3, s78, 4096
    buffer_load_dwordx4 v[144:147], v222, s[48:51], s3 offen offset:0 sc1
    buffer_load_dwordx4 v[148:151], v222, s[48:51], s3 offen offset:1024 sc1
    buffer_load_dwordx4 v[152:155], v222, s[48:51], s3 offen offset:2048 sc1
    buffer_load_dwordx4 v[156:159], v222, s[48:51], s3 offen offset:3072 sc1
    s_add_u32 s3, s78, 8192
    buffer_load_dwordx4 v[160:163], v222, s[48:51], s3 offen offset:0 sc1
    buffer_load_dwordx4 v[164:167], v222, s[48:51], s3 offen offset:1024 sc1
    buffer_load_dwordx4 v[168:171], v222, s[48:51], s3 offen offset:2048 sc1
    buffer_load_dwordx4 v[172:175], v222, s[48:51], s3 offen offset:3072 sc1
    s_add_u32 s3, s78, 12288
    buffer_load_dwordx4 v[176:179], v222, s[48:51], s3 offen offset:0 sc1
    buffer_load_dwordx4 v[180:183], v222, s[48:51], s3 offen offset:1024 sc1
    buffer_load_dwordx4 v[184:187], v222, s[48:51], s3 offen offset:2048 sc1
    buffer_load_dwordx4 v[188:191], v222, s[48:51], s3 offen offset:3072 sc1
    s_branch L_fx1r
L_fx2:
    s_and_b32 s3, s70, 0xffff0000
    s_xor_b32 s28, s3, 0x80000000
    s_not_b32 s29, s3
    s_and_b32 s29, s29, 0xffff0000
    s_bitcmp1_b32 s3, 31
    s_cselect_b32 s3, s28, s29
    v_mov_b32 v195, s3
    v_mul_f32 v195, 0xbfb8aa3b, v195
    v_exp_f32 v195, v195
    s_nop 0
    v_add_f32 v195, 1.0, v195
    v_rcp_f32 v195, v195
    s_nop 0
    v_cvt_pk_bf16_f32 v195, v195, v195
    v_lshlrev_b32 v195, 16, v195
    s_mov_b32 s29, 0
L_k6:
    v_max3_u32 v2, v128, v129, v130
    v_max3_u32 v2, v2, v131, v132
    v_max3_u32 v2, v2, v133, v134
    v_max3_u32 v2, v2, v135, v136
    v_max3_u32 v2, v2, v137, v138
    v_max3_u32 v2, v2, v139, v140
    v_max3_u32 v2, v2, v141, v142
    v_max3_u32 v2, v2, v143, v144
    v_max3_u32 v2, v2, v145, v146
    v_max3_u32 v2, v2, v147, v148
    v_max3_u32 v2, v2, v149, v150
    v_max3_u32 v2, v2, v151, v152
    v_max3_u32 v2, v2, v153, v154
    v_max3_u32 v2, v2, v155, v156
    v_max3_u32 v2, v2, v157, v158
    v_max3_u32 v2, v2, v159, v160
    v_max3_u32 v2, v2, v161, v162
    v_max3_u32 v2, v2, v163, v164
    v_max3_u32 v2, v2, v165, v166
    v_max3_u32 v2, v2, v167, v168
    v_max3_u32 v2, v2, v169, v170
    v_max3_u32 v2, v2, v171, v172
    v_max3_u32 v2, v2, v173, v174
    v_max3_u32 v2, v2, v175, v176
    v_max3_u32 v2, v2, v177, v178
    v_max3_u32 v2, v2, v179, v180
    v_max3_u32 v2, v2, v181, v182
    v_max3_u32 v2, v2, v183, v184
    v_max3_u32 v2, v2, v185, v186
    v_max3_u32 v2, v2, v187, v188
    v_max3_u32 v2, v2, v189, v190
    v_max_u32 v2, v2, v191
    v_cmp_eq_u32 vcc, -1, v2
    s_cbranch_vccz L_k6k
    s_add_u32 s29, s29, 1
    s_cmp_ge_u32 s29, 200000
    s_cbranch_scc1 L_k6k
    s_sleep 4
    s_add_u32 s3, s78, 0
    s_nop 0
    buffer_load_dwordx4 v[128:131], v222, s[48:51], s3 offen offset:0 sc1
    buffer_load_dwordx4 v[132:135], v222, s[48:51], s3 offen offset:1024 sc1
    buffer_load_dwordx4 v[136:139], v222, s[48:51], s3 offen offset:2048 sc1
    buffer_load_dwordx4 v[140:143], v222, s[48:51], s3 offen offset:3072 sc1
    s_add_u32 s3, s78, 4096
    buffer_load_dwordx4 v[144:147], v222, s[48:51], s3 offen offset:0 sc1
    buffer_load_dwordx4 v[148:151], v222, s[48:51], s3 offen offset:1024 sc1
    buffer_load_dwordx4 v[152:155], v222, s[48:51], s3 offen offset:2048 sc1
    buffer_load_dwordx4 v[156:159], v222, s[48:51], s3 offen offset:3072 sc1
    s_add_u32 s3, s78, 8192
    buffer_load_dwordx4 v[160:163], v222, s[48:51], s3 offen offset:0 sc1
    buffer_load_dwordx4 v[164:167], v222, s[48:51], s3 offen offset:1024 sc1
    buffer_load_dwordx4 v[168:171], v222, s[48:51], s3 offen offset:2048 sc1
    buffer_load_dwordx4 v[172:175], v222, s[48:51], s3 offen offset:3072 sc1
    s_add_u32 s3, s78, 12288
    buffer_load_dwordx4 v[176:179], v222, s[48:51], s3 offen offset:0 sc1
    buffer_load_dwordx4 v[180:183], v222, s[48:51], s3 offen offset:1024 sc1
    buffer_load_dwordx4 v[184:187], v222, s[48:51], s3 offen offset:2048 sc1
    buffer_load_dwordx4 v[188:191], v222, s[48:51], s3 offen offset:3072 sc1
    s_waitcnt vmcnt(0)
    s_branch L_k6
L_k6k:
    v_pk_add_f32 v[128:129], v[128:129], v[160:161]
    v_pk_add_f32 v[130:131], v[130:131], v[162:163]
    v_pk_add_f32 v[132:133], v[132:133], v[164:165]
    v_pk_add_f32 v[134:135], v[134:135], v[166:167]
    v_pk_add_f32 v[136:137], v[136:137], v[168:169]
    v_pk_add_f32 v[138:139], v[138:139], v[170:171]
    v_pk_add_f32 v[140:141], v[140:141], v[172:173]
    v_pk_add_f32 v[142:143], v[142:143], v[174:175]
    v_pk_add_f32 v[144:145], v[144:145], v[176:177]
    v_pk_add_f32 v[146:147], v[146:147], v[178:179]
    v_pk_add_f32 v[148:149], v[148:149], v[180:181]
    v_pk_add_f32 v[150:151], v[150:151], v[182:183]
    v_pk_add_f32 v[152:153], v[152:153], v[184:185]
    v_pk_add_f32 v[154:155], v[154:155], v[186:187]
    v_pk_add_f32 v[156:157], v[156:157], v[188:189]
    v_pk_add_f32 v[158:159], v[158:159], v[190:191]
    v_pk_add_f32 v[128:129], v[128:129], v[144:145]
    v_pk_add_f32 v[130:131], v[130:131], v[146:147]
    v_pk_add_f32 v[132:133], v[132:133], v[148:149]
    v_pk_add_f32 v[134:135], v[134:135], v[150:151]
    v_pk_add_f32 v[136:137], v[136:137], v[152:153]
    v_pk_add_f32 v[138:139], v[138:139], v[154:155]
    v_pk_add_f32 v[140:141], v[140:141], v[156:157]
    v_pk_add_f32 v[142:143], v[142:143], v[158:159]
    v_pk_add_f32 v[128:129], v[128:129], v[136:137]
    v_pk_add_f32 v[130:131], v[130:131], v[138:139]
    v_pk_add_f32 v[132:133], v[132:133], v[140:141]
    v_pk_add_f32 v[134:135], v[134:135], v[142:143]
    v_pk_add_f32 v[128:129], v[128:129], v[132:133]
    v_pk_add_f32 v[130:131], v[130:131], v[134:135]
    s_nop 1
    v_permlane32_swap_b32 v128, v130
    v_permlane32_swap_b32 v129, v131
    v_add_f32 v128, v128, v130
    v_add_f32 v129, v129, v131
    s_nop 1
    v_permlane16_swap_b32 v128, v129
    v_add_f32 v128, v128, v129
    v_cvt_pk_bf16_f32 v128, v128, v128
    v_lshlrev_b32 v128, 16, v128
    v_mul_f32 v128, v128, v195
    v_lshlrev_b32 v194, 16, v194
    v_sub_f32 v194, v194, v250
    v_cvt_pk_bf16_f32 v128, v128, v128
    v_lshlrev_b32 v128, 16, v128
    v_cvt_pk_bf16_f32 v194, v194, v194
    v_lshlrev_b32 v194, 16, v194
    v_mul_f32 v194, v194, v251
    v_cvt_pk_bf16_f32 v194, v194, v194
    v_lshlrev_b32 v194, 16, v194
    v_add_f32 v128, v128, v194
    v_cvt_pk_bf16_f32 v128, v128, v128
    v_lshlrev_b32 v128, 16, v128
    v_mul_f32 v2, 0xbfb8aa3b, v128
    v_exp_f32 v2, v2
    s_nop 0
    v_add_f32 v2, 1.0, v2
    v_rcp_f32 v2, v2
    s_nop 0
    v_mul_f32 v2, v128, v2
    v_lshlrev_b32 v3, 2, v193
    ds_write_b32 v3, v2
    s_branch L_fx2r
L_r0:
    s_add_u32 s29, s29, 1
    s_cmp_ge_u32 s29, 200000
    s_cbranch_scc1 L_g0
    s_xor_b32 s3, s76, 0
    buffer_load_dwordx4 v[40:43], v116, s[48:51], s3 offen offset:0 sc1
    buffer_load_dwordx4 v[44:47], v117, s[48:51], s3 offen offset:0 sc1
    s_waitcnt vmcnt(0)
    v_max3_u32 v2, v40, v41, v42
    v_max3_u32 v2, v2, v43, v44
    v_max3_u32 v2, v2, v45, v46
    v_max_u32 v2, v2, v47
    v_cmp_eq_u32 vcc, -1, v2
    s_cbranch_vccnz L_r0
    s_branch L_g0
L_r1:
    s_add_u32 s29, s29, 1
    s_cmp_ge_u32 s29, 200000
    s_cbranch_scc1 L_g1
    s_xor_b32 s3, s76, 0
    buffer_load_dwordx4 v[48:51], v116, s[48:51], s3 offen offset:1024 sc1
    buffer_load_dwordx4 v[52:55], v117, s[48:51], s3 offen offset:1024 sc1
    s_waitcnt vmcnt(0)
    v_max3_u32 v2, v48, v49, v50
    v_max3_u32 v2, v2, v51, v52
    v_max3_u32 v2, v2, v53, v54
    v_max_u32 v2, v2, v55
    v_cmp_eq_u32 vcc, -1, v2
    s_cbranch_vccnz L_r1
    s_branch L_g1
L_r2:
    s_add_u32 s29, s29, 1
    s_cmp_ge_u32 s29, 200000
    s_cbranch_scc1 L_g2
    s_xor_b32 s3, s76, 0
    buffer_load_dwordx4 v[56:59], v116, s[48:51], s3 offen offset:2048 sc1
    buffer_load_dwordx4 v[60:63], v117, s[48:51], s3 offen offset:2048 sc1
    s_waitcnt vmcnt(0)
    v_max3_u32 v2, v56, v57, v58
    v_max3_u32 v2, v2, v59, v60
    v_max3_u32 v2, v2, v61, v62
    v_max_u32 v2, v2, v63
    v_cmp_eq_u32 vcc, -1, v2
    s_cbranch_vccnz L_r2
    s_branch L_g2
L_r3:
    s_add_u32 s29, s29, 1
    s_cmp_ge_u32 s29, 200000
    s_cbranch_scc1 L_g3
    s_xor_b32 s3, s76, 0
    buffer_load_dwordx4 v[64:67], v116, s[48:51], s3 offen offset:3072 sc1
    buffer_load_dwordx4 v[68:71], v117, s[48:51], s3 offen offset:3072 sc1
    s_waitcnt vmcnt(0)
    v_max3_u32 v2, v64, v65, v66
    v_max3_u32 v2, v2, v67, v68
    v_max3_u32 v2, v2, v69, v70
    v_max_u32 v2, v2, v71
    v_cmp_eq_u32 vcc, -1, v2
    s_cbranch_vccnz L_r3
    s_branch L_g3
L_r4:
    s_add_u32 s29, s29, 1
    s_cmp_ge_u32 s29, 200000
    s_cbranch_scc1 L_g4
    s_xor_b32 s3, s76, 4096
    buffer_load_dwordx4 v[72:75], v116, s[48:51], s3 offen offset:0 sc1
    buffer_load_dwordx4 v[76:79], v117, s[48:51], s3 offen offset:0 sc1
    s_waitcnt vmcnt(0)
    v_max3_u32 v2, v72, v73, v74
    v_max3_u32 v2, v2, v75, v76
    v_max3_u32 v2, v2, v77, v78
    v_max_u32 v2, v2, v79
    v_cmp_eq_u32 vcc, -1, v2
    s_cbranch_vccnz L_r4
    s_branch L_g4
L_r5:
    s_add_u32 s29, s29, 1
    s_cmp_ge_u32 s29, 200000
    s_cbranch_scc1 L_g5
    s_xor_b32 s3, s76, 4096
    buffer_load_dwordx4 v[40:43], v116, s[48:51], s3 offen offset:1024 sc1
    buffer_load_dwordx4 v[44:47], v117, s[48:51], s3 offen offset:1024 sc1
    s_waitcnt vmcnt(0)
    v_max3_u32 v2, v40, v41, v42
    v_max3_u32 v2, v2, v43, v44
    v_max3_u32 v2, v2, v45, v46
    v_max_u32 v2, v2, v47
    v_cmp_eq_u32 vcc, -1, v2
    s_cbranch_vccnz L_r5
    s_branch L_g5
L_r6:
    s_add_u32 s29, s29, 1
    s_cmp_ge_u32 s29, 200000
    s_cbranch_scc1 L_g6
    s_xor_b32 s3, s76, 4096
    buffer_load_dwordx4 v[48:51], v116, s[48:51], s3 offen offset:2048 sc1
    buffer_load_dwordx4 v[52:55], v117, s[48:51], s3 offen offset:2048 sc1
    s_waitcnt vmcnt(0)
    v_max3_u32 v2, v48, v49, v50
    v_max3_u32 v2, v2, v51, v52
    v_max3_u32 v2, v2, v53, v54
    v_max_u32 v2, v2, v55
    v_cmp_eq_u32 vcc, -1, v2
    s_cbranch_vccnz L_r6
    s_branch L_g6
L_r7:
    s_add_u32 s29, s29, 1
    s_cmp_ge_u32 s29, 200000
    s_cbranch_scc1 L_g7
    s_xor_b32 s3, s76, 4096
    buffer_load_dwordx4 v[56:59], v116, s[48:51], s3 offen offset:3072 sc1
    buffer_load_dwordx4 v[60:63], v117, s[48:51], s3 offen offset:3072 sc1
    s_waitcnt vmcnt(0)
    v_max3_u32 v2, v56, v57, v58
    v_max3_u32 v2, v2, v59, v60
    v_max3_u32 v2, v2, v61, v62
    v_max_u32 v2, v2, v63
    v_cmp_eq_u32 vcc, -1, v2
    s_cbranch_vccnz L_r7
    s_branch L_g7
L_r8:
    s_add_u32 s29, s29, 1
    s_cmp_ge_u32 s29, 200000
    s_cbranch_scc1 L_g8
    s_xor_b32 s3, s76, 8192
    buffer_load_dwordx4 v[64:67], v116, s[48:51], s3 offen offset:0 sc1
    buffer_load_dwordx4 v[68:71], v117, s[48:51], s3 offen offset:0 sc1
    s_waitcnt vmcnt(0)
    v_max3_u32 v2, v64, v65, v66
    v_max3_u32 v2, v2, v67, v68
    v_max3_u32 v2, v2, v69, v70
    v_max_u32 v2, v2, v71
    v_cmp_eq_u32 vcc, -1, v2
    s_cbranch_vccnz L_r8
    s_branch L_g8
L_r9:
    s_add_u32 s29, s29, 1
    s_cmp_ge_u32 s29, 200000
    s_cbranch_scc1 L_g9
    s_xor_b32 s3, s76, 8192
    buffer_load_dwordx4 v[72:75], v116, s[48:51], s3 offen offset:1024 sc1
    buffer_load_dwordx4 v[76:79], v117, s[48:51], s3 offen offset:1024 sc1
    s_waitcnt vmcnt(0)
    v_max3_u32 v2, v72, v73, v74
    v_max3_u32 v2, v2, v75, v76
    v_max3_u32 v2, v2, v77, v78
    v_max_u32 v2, v2, v79
    v_cmp_eq_u32 vcc, -1, v2
    s_cbranch_vccnz L_r9
    s_branch L_g9
L_r10:
    s_add_u32 s29, s29, 1
    s_cmp_ge_u32 s29, 200000
    s_cbranch_scc1 L_g10
    s_xor_b32 s3, s76, 8192
    buffer_load_dwordx4 v[40:43], v116, s[48:51], s3 offen offset:2048 sc1
    buffer_load_dwordx4 v[44:47], v117, s[48:51], s3 offen offset:2048 sc1
    s_waitcnt vmcnt(0)
    v_max3_u32 v2, v40, v41, v42
    v_max3_u32 v2, v2, v43, v44
    v_max3_u32 v2, v2, v45, v46
    v_max_u32 v2, v2, v47
    v_cmp_eq_u32 vcc, -1, v2
    s_cbranch_vccnz L_r10
    s_branch L_g10
L_r11:
    s_add_u32 s29, s29, 1
    s_cmp_ge_u32 s29, 200000
    s_cbranch_scc1 L_g11
    s_xor_b32 s3, s76, 8192
    buffer_load_dwordx4 v[48:51], v116, s[48:51], s3 offen offset:3072 sc1
    buffer_load_dwordx4 v[52:55], v117, s[48:51], s3 offen offset:3072 sc1
    s_waitcnt vmcnt(0)
    v_max3_u32 v2, v48, v49, v50
    v_max3_u32 v2, v2, v51, v52
    v_max3_u32 v2, v2, v53, v54
    v_max_u32 v2, v2, v55
    v_cmp_eq_u32 vcc, -1, v2
    s_cbranch_vccnz L_r11
    s_branch L_g11
L_r12:
    s_add_u32 s29, s29, 1
    s_cmp_ge_u32 s29, 200000
    s_cbranch_scc1 L_g12
    s_xor_b32 s3, s76, 12288
    buffer_load_dwordx4 v[56:59], v116, s[48:51], s3 offen offset:0 sc1
    buffer_load_dwordx4 v[60:63], v117, s[48:51], s3 offen offset:0 sc1
    s_waitcnt vmcnt(0)
    v_max3_u32 v2, v56, v57, v58
    v_max3_u32 v2, v2, v59, v60
    v_max3_u32 v2, v2, v61, v62
    v_max_u32 v2, v2, v63
    v_cmp_eq_u32 vcc, -1, v2
    s_cbranch_vccnz L_r12
    s_branch L_g12
L_r13:
    s_add_u32 s29, s29, 1
    s_cmp_ge_u32 s29, 200000
    s_cbranch_scc1 L_g13
    s_xor_b32 s3, s76, 12288
    buffer_load_dwordx4 v[64:67], v116, s[48:51], s3 offen offset:1024 sc1
    buffer_load_dwordx4 v[68:71], v117, s[48:51], s3 offen offset:1024 sc1
    s_waitcnt vmcnt(0)
    v_max3_u32 v2, v64, v65, v66
    v_max3_u32 v2, v2, v67, v68
    v_max3_u32 v2, v2, v69, v70
    v_max_u32 v2, v2, v71
    v_cmp_eq_u32 vcc, -1, v2
    s_cbranch_vccnz L_r13
    s_branch L_g13
L_r14:
    s_add_u32 s29, s29, 1
    s_cmp_ge_u32 s29, 200000
    s_cbranch_scc1 L_g14
    s_xor_b32 s3, s76, 12288
    buffer_load_dwordx4 v[72:75], v116, s[48:51], s3 offen offset:2048 sc1
    buffer_load_dwordx4 v[76:79], v117, s[48:51], s3 offen offset:2048 sc1
    s_waitcnt vmcnt(0)
    v_max3_u32 v2, v72, v73, v74
    v_max3_u32 v2, v2, v75, v76
    v_max3_u32 v2, v2, v77, v78
    v_max_u32 v2, v2, v79
    v_cmp_eq_u32 vcc, -1, v2
    s_cbranch_vccnz L_r14
    s_branch L_g14
L_r15:
    s_add_u32 s29, s29, 1
    s_cmp_ge_u32 s29, 200000
    s_cbranch_scc1 L_g15
    s_xor_b32 s3, s76, 12288
    buffer_load_dwordx4 v[40:43], v116, s[48:51], s3 offen offset:3072 sc1
    buffer_load_dwordx4 v[44:47], v117, s[48:51], s3 offen offset:3072 sc1
    s_waitcnt vmcnt(0)
    v_max3_u32 v2, v40, v41, v42
    v_max3_u32 v2, v2, v43, v44
    v_max3_u32 v2, v2, v45, v46
    v_max_u32 v2, v2, v47
    v_cmp_eq_u32 vcc, -1, v2
    s_cbranch_vccnz L_r15
    s_branch L_g15
.p2align 8
.fill 4096, 4, 0xbf800000
.section .rodata,"a"
.p2align 6
.amdhsa_kernel recurrent_scan__linear_kernel_hedgehog__moe_arch_mod__prompt_kernel
  .amdhsa_next_free_vgpr 256
  .amdhsa_next_free_sgpr 102
  .amdhsa_accum_offset 256
  .amdhsa_group_segment_fixed_size 0
  .amdhsa_kernarg_size 96
  .amdhsa_user_sgpr_count 2
  .amdhsa_user_sgpr_kernarg_segment_ptr 1
  .amdhsa_system_sgpr_workgroup_id_x 1
.end_amdhsa_kernel
```
